```python
import torch

def _softmax(x, axis=-1):
    return torch.softmax(x, dim=axis)

def _gelu(x):
    return torch.nn.functional.gelu(x, approximate='tanh')

def _silu(x):
    return torch.nn.functional.silu(x)

def _sigmoid(x):
    return torch.sigmoid(x)

def _layernorm(x, axis=-1, eps=1e-05):
    m = x.mean(dim=axis, keepdim=True)
    v = x.var(dim=axis, keepdim=True, unbiased=False)
    return (x - m) / torch.sqrt(v + eps)

def _scatter_add(tgt, idx, src, axis=0):
    return tgt.clone().index_add_(axis, idx, src)

def _segment_sum(src, seg, n):
    out = torch.zeros((n,) + src.shape[1:], dtype=src.dtype)
    return out.index_add_(0, seg, src)

def _pad(x, pw):
    flat = tuple((v for pair in reversed(pw) for v in pair))
    return torch.nn.functional.pad(x, flat)
kernel_name = 'interleave_layers__memory_aug_recurrent_mem_tr__ssm_conv_h3__prompt'

def setup_inputs():

    _w = lambda a: (lambda t: t.to(torch.bfloat16) if t.is_floating_point() else t)(torch.as_tensor(a))

    def _A_setup():
        B, S, Dm = (1, 2048, 640)
        H, Dh = (32, 128)
        M, seg = (8, 32)
        seg = min(seg, S)
        S = S // seg * seg
        return {'x': _w((lambda *s: torch.randn(*s, dtype=torch.bfloat16) * 0.05)(B, S, Dm)), 'mem0': _w((lambda *s: torch.randn(*s, dtype=torch.bfloat16) * 0.4)(B, M, Dm)), 'Wq': _w((lambda *s: torch.randn(*s, dtype=torch.bfloat16) * 1.6)(Dm, H, Dh) * Dm ** (-0.5)), 'Wk': _w((lambda *s: torch.randn(*s, dtype=torch.bfloat16) * 1.6)(Dm, H, Dh) * Dm ** (-0.5)), 'Wv': _w((lambda *s: torch.randn(*s, dtype=torch.bfloat16) * 0.4)(Dm, H, Dh) * Dm ** (-0.5)), 'Wo': _w((lambda *s: torch.randn(*s, dtype=torch.bfloat16) * 0.4)(H, Dh, Dm) * (H * Dh) ** (-0.5)), 'seg_len': seg}
    _A_in = _A_setup()

    def _B_setup():
        B, S, D = (1, 2048, 640)
        ks = 4
        return {'q': _w((lambda *s: torch.randn(*s, dtype=torch.bfloat16) * 0.05)(B, S, D)), 'k': _w((lambda *s: torch.randn(*s, dtype=torch.bfloat16) * 0.4)(B, S, D)), 'v': _w((lambda *s: torch.randn(*s, dtype=torch.bfloat16) * 0.4)(B, S, D)), 'shift_k': _w((lambda *s: torch.randn(*s, dtype=torch.bfloat16) * 0.4)(D, ks) * 0.5), 'ssm_k': _w((lambda *s: torch.randn(*s, dtype=torch.bfloat16) * 0.8)(D, S) * (1.0 / S ** 0.5)), 'ssm_D': _w((lambda *s: torch.randn(*s, dtype=torch.bfloat16) * 0.4)(D))}
    _B_in = _B_setup()
    return {'A_x': _A_in['x'], 'A_mem0': _A_in['mem0'], 'A_Wq': _A_in['Wq'], 'A_Wk': _A_in['Wk'], 'A_Wv': _A_in['Wv'], 'A_Wo': _A_in['Wo'], 'A_seg_len': _A_in['seg_len'], 'B_q': _B_in['q'], 'B_k': _B_in['k'], 'B_v': _B_in['v'], 'B_shift_k': _B_in['shift_k'], 'B_ssm_k': _B_in['ssm_k'], 'B_ssm_D': _B_in['ssm_D']}

def reference(A_x, A_mem0, A_Wq, A_Wk, A_Wv, A_Wo, A_seg_len, B_q, B_k, B_v, B_shift_k, B_ssm_k, B_ssm_D):

    def _A_ref(x, mem0, Wq, Wk, Wv, Wo, seg_len):
        B, S, Dm = x.shape
        H, Dh = (Wq.shape[1], Wq.shape[2])
        M = mem0.shape[1]
        scale = Dh ** (-0.5)
        n_seg = S // seg_len
        L = M + seg_len
        idx = torch.arange(L)
        mask = (idx[:, None] < M) | (idx[:, None] >= idx[None, :])
        mem = mem0
        outs = []
        for s in range(n_seg):
            xs = x[:, s * seg_len:(s + 1) * seg_len, :].clone()
            h = torch.concatenate([mem, xs], axis=1)
            q = torch.einsum('btd,dhe->bhte', h, Wq)
            k = torch.einsum('btd,dhe->bhte', h, Wk)
            v = torch.einsum('btd,dhe->bhte', h, Wv)
            scores = torch.einsum('bhqe,bhke->bhqk', q, k) * scale
            scores = torch.where(mask[None, None], scores, -1000000000.0)
            p = _softmax(scores, axis=-1)
            o = torch.einsum('bhqk,bhke->bhqe', p, v)
            o = torch.einsum('bhte,hed->btd', o, Wo)
            mem = o[:, :M, :].clone()
            outs.append(o[:, M:, :])
        return torch.concatenate(outs, axis=1)

    def _B_ref(q, k, v, shift_k, ssm_k, ssm_D):
        B, S, D = q.shape
        ks = shift_k.shape[-1]
        k_pad = _pad(k, ((0, 0), (ks - 1, 0), (0, 0)))
        k_shift = torch.zeros_like(k)
        for t in range(ks):
            k_shift = k_shift + k_pad[:, t:t + S, :] * shift_k[:, ks - 1 - t][None, None, :]
        kv = k_shift * v
        L = 2 * S
        kv_pad = _pad(kv, ((0, 0), (0, S), (0, 0)))
        kf_pad = _pad(ssm_k, ((0, 0), (0, S)))
        kv_f = (lambda x, axes=(-2, -1): torch.fft.rfft2(x.float(), dim=axes))(kv_pad[:, None, :, :], axes=(1, 2))
        kf_f = (lambda x, axes=(-2, -1): torch.fft.rfft2(x.float(), dim=axes))(kf_pad[:, None, :], axes=(1, 2))
        kf_f = (lambda x, *d: x.permute(*d))(kf_f, 1, 2, 0)
        y_f = kv_f * kf_f[None, :, :, :]
        y = (lambda x, s, axes=(-2, -1): torch.fft.irfft2(x, s=s, dim=axes).to(torch.bfloat16))(y_f, (1, L), axes=(1, 2))[:, 0, :S, :]
        y = y + kv * ssm_D[None, None, :]
        return q * y
    x = A_x
    x = x + _A_ref(_layernorm(x, axis=-1), A_mem0, A_Wq, A_Wk, A_Wv, A_Wo, A_seg_len)
    x = x + _B_ref(_layernorm(x, axis=-1), B_k, B_v, B_shift_k, B_ssm_k, B_ssm_D)
    x = x + _A_ref(_layernorm(x, axis=-1), A_mem0, A_Wq, A_Wk, A_Wv, A_Wo, A_seg_len)
    x = x + _B_ref(_layernorm(x, axis=-1), B_k, B_v, B_shift_k, B_ssm_k, B_ssm_D)
    return x
```

```asm
; @launch grid=(256,1,1) block=(256,1,1) lds=163840
.amdgcn_target "amdgcn-amd-amdhsa--gfx950"
.text
.globl interleave_layers__memory_aug_recurrent_mem_tr__ssm_conv_h3__prompt_kernel
.p2align 8
.type interleave_layers__memory_aug_recurrent_mem_tr__ssm_conv_h3__prompt_kernel,@function
interleave_layers__memory_aug_recurrent_mem_tr__ssm_conv_h3__prompt_kernel:
 s_cmp_ge_u32 s2, 256
 s_cbranch_scc1 L_bail
 s_load_dwordx16 s[16:31], s[0:1], 0
 s_load_dwordx16 s[32:47], s[0:1], 64
 s_getreg_b32 s48, hwreg(HW_REG_XCC_ID, 0, 3)
 v_lshrrev_b32 v1, 6, v0
 v_and_b32 v0, 63, v0
 s_nop 0
 v_readfirstlane_b32 s50, v1
 s_waitcnt lgkmcnt(0)
 s_mov_b32 s4, s46
 s_and_b32 s5, s47, 0xffff
 s_mov_b32 s6, 268435456
 s_mov_b32 s7, 0x00020000
 s_mov_b32 s8, s46
 s_and_b32 s9, s47, 0xffff
 s_mov_b32 s10, 268435456
 s_mov_b32 s11, 0x00020000
 s_mov_b32 s12, s46
 s_and_b32 s13, s47, 0xffff
 s_mov_b32 s14, 268435456
 s_mov_b32 s15, 0x00020000
 s_mov_b32 s96, s44
 s_and_b32 s97, s45, 0xffff
 s_mov_b32 s98, 256
 s_mov_b32 s99, 0x00020000
 s_cmp_lg_u32 s50, 0
 s_cbranch_scc1 L_tk_wait
 s_mov_b32 s96, s44
 s_and_b32 s97, s45, 0xffff
 s_mov_b32 s98, 256
 s_mov_b32 s99, 0x00020000
 s_lshl_b32 s3, s48, 5
 v_mov_b32 v1, 1
 v_mov_b32 v2, 0
 s_mov_b64 exec, 1
 buffer_atomic_add v1, off, s[96:99], s3 sc0
 s_waitcnt vmcnt(0)
 s_mov_b64 exec, -1
 v_readfirstlane_b32 s60, v1
 s_nop 3
 s_cmp_lt_u32 s60, 32
 s_cbranch_scc1 L_tk_ok
 v_lshlrev_b32 v3, 5, v0
 s_mov_b32 s51, 0
L_tk_lp:
 buffer_load_dword v4, v3, s[96:99], 0 offen sc1
 s_waitcnt vmcnt(0)
 s_mov_b32 s61, 0
 v_readlane_b32 s64, v4, 0
 s_nop 3
 s_add_u32 s61, s61, s64
 v_readlane_b32 s65, v4, 1
 s_nop 3
 s_add_u32 s61, s61, s65
 v_readlane_b32 s66, v4, 2
 s_nop 3
 s_add_u32 s61, s61, s66
 v_readlane_b32 s67, v4, 3
 s_nop 3
 s_add_u32 s61, s61, s67
 v_readlane_b32 s68, v4, 4
 s_nop 3
 s_add_u32 s61, s61, s68
 v_readlane_b32 s69, v4, 5
 s_nop 3
 s_add_u32 s61, s61, s69
 v_readlane_b32 s70, v4, 6
 s_nop 3
 s_add_u32 s61, s61, s70
 v_readlane_b32 s71, v4, 7
 s_nop 3
 s_add_u32 s61, s61, s71
 s_cmp_ge_u32 s61, 256
 s_cbranch_scc1 L_tk_all
 s_sleep 4
 s_add_u32 s51, s51, 1
 s_cmp_lt_u32 s51, 131072
 s_cbranch_scc1 L_tk_lp
 s_branch L_bail
L_tk_all:
 v_mov_b32 v1, 1
 s_mov_b64 exec, 1
 buffer_atomic_add v1, off, s[96:99], 0 offset:20 sc0
 s_waitcnt vmcnt(0)
 s_mov_b64 exec, -1
 v_readfirstlane_b32 s61, v1
 s_nop 3
 s_min_u32 s62, s64, 32
 s_add_u32 s60, s62, s61
 s_mov_b32 s48, 0
 s_cmp_lt_u32 s60, 32
 s_cbranch_scc1 L_tk_ok
 s_sub_u32 s61, s60, 32
 s_min_u32 s62, s65, 32
 s_add_u32 s60, s62, s61
 s_mov_b32 s48, 1
 s_cmp_lt_u32 s60, 32
 s_cbranch_scc1 L_tk_ok
 s_sub_u32 s61, s60, 32
 s_min_u32 s62, s66, 32
 s_add_u32 s60, s62, s61
 s_mov_b32 s48, 2
 s_cmp_lt_u32 s60, 32
 s_cbranch_scc1 L_tk_ok
 s_sub_u32 s61, s60, 32
 s_min_u32 s62, s67, 32
 s_add_u32 s60, s62, s61
 s_mov_b32 s48, 3
 s_cmp_lt_u32 s60, 32
 s_cbranch_scc1 L_tk_ok
 s_sub_u32 s61, s60, 32
 s_min_u32 s62, s68, 32
 s_add_u32 s60, s62, s61
 s_mov_b32 s48, 4
 s_cmp_lt_u32 s60, 32
 s_cbranch_scc1 L_tk_ok
 s_sub_u32 s61, s60, 32
 s_min_u32 s62, s69, 32
 s_add_u32 s60, s62, s61
 s_mov_b32 s48, 5
 s_cmp_lt_u32 s60, 32
 s_cbranch_scc1 L_tk_ok
 s_sub_u32 s61, s60, 32
 s_min_u32 s62, s70, 32
 s_add_u32 s60, s62, s61
 s_mov_b32 s48, 6
 s_cmp_lt_u32 s60, 32
 s_cbranch_scc1 L_tk_ok
 s_sub_u32 s61, s60, 32
 s_min_u32 s62, s71, 32
 s_add_u32 s60, s62, s61
 s_mov_b32 s48, 7
 s_cmp_lt_u32 s60, 32
 s_cbranch_scc1 L_tk_ok
 s_sub_u32 s61, s60, 32
 s_mov_b32 s48, 8
 s_mov_b32 s60, 0
L_tk_ok:
 s_lshl_b32 s3, s48, 5
 s_add_u32 s3, s3, s60
 v_mov_b32 v1, s3
 ds_write_b32 v2, v1
 s_waitcnt lgkmcnt(0)
L_tk_wait:
 s_barrier
 v_mov_b32 v2, 0
 ds_read_b32 v1, v2
 s_waitcnt lgkmcnt(0)
 v_readfirstlane_b32 s101, v1
 s_barrier
 s_mov_b32 s51, 0
 s_cmp_ge_u32 s101, 256
 s_cbranch_scc1 L_bail
 s_lshr_b32 s48, s101, 5
 s_and_b32 s48, s48, 7
 s_and_b32 s49, s101, 31
 s_mov_b32 s53, 0
 s_cmp_eq_u32 s48, 0
 s_cbranch_scc1 L_ch
 s_mov_b32 s53, 1
 s_cmp_eq_u32 s48, 4
 s_cbranch_scc1 L_ch
 s_cmp_gt_u32 s48, 4
 s_cselect_b32 s60, 2, 1
 s_sub_u32 s60, s48, s60
 s_lshl_b32 s3, s60, 4
 s_add_u32 s3, s3, s49
 s_cmp_lt_u32 s49, 16
 s_cbranch_scc1 L_qkv_idx
 s_lshl_b32 s82, s60, 2
 s_add_u32 s82, s82, s49
 s_add_u32 s82, s82, 56
 s_mov_b32 s83, 2
 s_cmp_lt_u32 s49, 20
 s_cbranch_scc1 L_helper
 s_min_u32 s61, s60, 2
 s_add_u32 s62, s61, s60
 s_mul_i32 s62, s62, 5
 s_mul_i32 s63, s60, 12
 s_sub_u32 s63, s63, s62
 s_cmp_lt_u32 s60, 2
 s_cselect_b32 s61, 30, 25
 s_sub_u32 s52, s49, s61
 s_add_u32 s52, s52, s63
 s_mov_b32 s82, s52
 s_mov_b32 s83, 0
 s_cmp_ge_u32 s49, s61
 s_cbranch_scc1 L_helper
 s_add_u32 s3, s62, s49
 s_sub_u32 s3, s3, 20
 s_mul_i32 s52, s3, 13108
 s_lshr_b32 s52, s52, 16
 s_mul_i32 s53, s52, 5
 s_sub_u32 s53, s3, s53
 s_add_u32 s82, s3, 32
 s_mov_b32 s83, 1
 s_branch L_helper
L_qkv_idx:
 s_mul_i32 s52, s3, 21846
 s_lshr_b32 s52, s52, 16
 s_mul_i32 s53, s52, 3
 s_sub_u32 s53, s3, s53
 s_mov_b32 s8, s24
 s_and_b32 s9, s25, 0xffff
 s_mov_b32 s10, 5242880
 s_mov_b32 s11, 0x00020000
 s_cmp_eq_u32 s53, 2
 s_cbranch_scc1 L_qkvv
 s_cmp_eq_u32 s53, 0
 s_cselect_b32 s8, s20, s22
 s_cselect_b32 s9, s21, s23
 s_and_b32 s9, s9, 0xffff
 s_branch L_qkvq
L_conv0:
 s_mov_b32 s8, s38
 s_and_b32 s9, s39, 0xffff
 s_mov_b32 s10, 2621440
 s_mov_b32 s11, 0x00020000
 s_mov_b32 s12, s40
 s_and_b32 s13, s41, 0xffff
 s_mov_b32 s14, 1280
 s_mov_b32 s15, 0x00020000
 v_lshlrev_b32 v130, 4, v0
 v_add_u32 v7, s71, v130
 v_mov_b32 v8, 0
 v_mov_b32 v9, 0
 v_mov_b32 v10, 0
 v_mov_b32 v11, 0
 s_mov_b32 exec_hi, 0
 ds_write_b128 v7, v[8:11] offset:0
 s_mov_b32 exec_lo, 3
 ds_write_b128 v7, v[8:11] offset:4608
 ds_write_b128 v7, v[8:11] offset:8768
 s_mov_b64 exec, -1
 v_and_b32 v8, 15, v0
 v_lshrrev_b32 v9, 5, v0
 v_sub_u32 v10, v8, v9
 v_lshlrev_b32 v10, 5, v10
 v_and_b32 v11, 16, v0
 v_add_u32 v10, v10, v11
 s_add_u32 s3, s71, 64
 v_add_u32 v14, s3, v10
 v_lshlrev_b32 v10, 5, v9
 v_lshl_add_u32 v10, v8, 1, v10
 v_sub_u32 v10, v10, v11
 v_and_b32 v11, 1, v0
 v_cmp_eq_u32 vcc, 1, v11
 v_mov_b32 v12, 8784
 v_mov_b32 v11, 4626
 s_nop 0
 v_cndmask_b32 v11, v12, v11, vcc
 v_add3_u32 v16, v10, v11, s71
 v_add_u32 v17, 512, v16
 v_add_u32 v18, 1024, v16
 v_add_u32 v19, 1536, v16
 v_lshlrev_b32 v10, 5, v8
 v_lshl_add_u32 v10, v9, 4, v10
 v_and_b32 v11, 16, v0
 v_lshrrev_b32 v11, 1, v11
 v_xor_b32 v11, 8, v11
 s_add_u32 s3, s71, 512
 v_add3_u32 v15, v10, v11, s3
 v_and_b32 v10, 1, v0
 v_lshlrev_b32 v10, 4, v10
 v_lshrrev_b32 v11, 4, v0
 v_lshl_add_u32 v10, v11, 2, v10
 s_mov_b32 s3, 40960
 v_mul_lo_u32 v13, v10, s3
 v_lshrrev_b32 v11, 1, v8
 v_lshl_add_u32 v13, v11, 3, v13
 s_cmp_lg_u32 s50, 0
 s_cbranch_scc1 L_ww_1
 s_mov_b32 s96, s44
 s_and_b32 s97, s45, 0xffff
 s_mov_b32 s98, 256
 s_mov_b32 s99, 0x00020000
 v_mov_b32 v24, 196
 s_mov_b32 s51, 0
 s_mov_b64 exec, 1
L_wb_2:
 buffer_load_dword v25, v24, s[96:99], 0 offen sc1
 s_waitcnt vmcnt(0)
 v_cmp_eq_u32 vcc, 0, v25
 s_cbranch_vccz L_wbd_3
 s_sleep 2
 s_add_u32 s51, s51, 1
 s_cmp_lt_u32 s51, 131072
 s_cbranch_scc1 L_wb_2
 s_branch L_bail
L_wbd_3:
 s_mov_b64 exec, -1
L_ww_1:
 s_barrier
 s_lshl_b32 s3, s70, 12
 s_add_u32 s3, s3, 231735296
 buffer_load_dwordx4 v[104:107], v130, s[4:7], s3 offen offset:0 sc1
 buffer_load_dwordx4 v[108:111], v130, s[4:7], s3 offen offset:1024 sc1
 s_waitcnt vmcnt(0)
L_cv_4:
 s_waitcnt vmcnt(4)
 ds_write_b128 v7, v[104:107] offset:512
 ds_write_b128 v7, v[96:99] offset:4640
 ds_write_b128 v7, v[112:115] offset:8800
 ds_write_b128 v7, v[108:111] offset:1536
 ds_write_b128 v7, v[100:103] offset:5664
 ds_write_b128 v7, v[116:119] offset:9824
 v_lshlrev_b32 v8, 16, v96
 v_lshlrev_b32 v12, 16, v128
 s_mov_b64 exec, 1
 ds_write_b32 v7, v8 offset:8796
 s_mov_b64 exec, -1
 s_lshl_b32 s72, s70, 6
 s_add_u32 s72, s72, 234356736
 s_add_u32 s70, s70, s69
 s_waitcnt lgkmcnt(0)
 s_lshl_b32 s73, s70, 12
 s_add_u32 s74, s73, 2
 buffer_load_dwordx4 v[96:99], v130, s[8:11], s73 offen offset:0
 buffer_load_dwordx4 v[100:103], v130, s[8:11], s73 offen offset:1024
 buffer_load_dwordx4 v[112:115], v130, s[8:11], s74 offen offset:0
 buffer_load_dwordx4 v[116:119], v130, s[8:11], s74 offen offset:1024
 s_lshl_b32 s3, s70, 1
 buffer_load_ushort v128, off, s[12:15], s3
 s_lshl_b32 s3, s70, 12
 s_add_u32 s3, s3, 231735296
 buffer_load_dwordx4 v[104:107], v130, s[4:7], s3 offen offset:0 sc1
 buffer_load_dwordx4 v[108:111], v130, s[4:7], s3 offen offset:1024 sc1
 ds_read_b128 v[32:35], v14 offset:448
 ds_read2_b32 v[64:65], v16 offset0:0 offset1:1
 ds_read2_b32 v[66:67], v16 offset0:2 offset1:3
 ds_read_b128 v[36:39], v14 offset:960
 ds_read2_b32 v[68:69], v17 offset0:0 offset1:1
 ds_read2_b32 v[70:71], v17 offset0:2 offset1:3
 ds_read_b128 v[40:43], v14 offset:1472
 ds_read2_b32 v[72:73], v18 offset0:0 offset1:1
 ds_read2_b32 v[74:75], v18 offset0:2 offset1:3
 ds_read_b128 v[44:47], v14 offset:1984
 ds_read2_b32 v[76:77], v19 offset0:0 offset1:1
 ds_read2_b32 v[78:79], v19 offset0:2 offset1:3
 s_waitcnt lgkmcnt(0)
 v_mfma_f32_16x16x32_bf16 v[144:147], v[64:67], v[32:35], 0
 ds_read_b128 v[176:179], v14 offset:384
 ds_read2_b32 v[208:209], v16 offset0:16 offset1:17
 v_mfma_f32_16x16x32_bf16 v[148:151], v[64:67], v[36:39], 0
 ds_read2_b32 v[210:211], v16 offset0:18 offset1:19
 ds_read_b128 v[180:183], v14 offset:896
 v_mfma_f32_16x16x32_bf16 v[152:155], v[64:67], v[40:43], 0
 ds_read2_b32 v[212:213], v17 offset0:16 offset1:17
 ds_read2_b32 v[214:215], v17 offset0:18 offset1:19
 v_mfma_f32_16x16x32_bf16 v[156:159], v[64:67], v[44:47], 0
 ds_read_b128 v[184:187], v14 offset:1408
 ds_read2_b32 v[216:217], v18 offset0:16 offset1:17
 v_mfma_f32_16x16x32_bf16 v[148:151], v[68:71], v[32:35], v[148:151]
 ds_read2_b32 v[218:219], v18 offset0:18 offset1:19
 ds_read_b128 v[188:191], v14 offset:1920
 v_mfma_f32_16x16x32_bf16 v[152:155], v[68:71], v[36:39], v[152:155]
 ds_read2_b32 v[220:221], v19 offset0:16 offset1:17
 ds_read2_b32 v[222:223], v19 offset0:18 offset1:19
 v_mfma_f32_16x16x32_bf16 v[156:159], v[68:71], v[40:43], v[156:159]
 v_mfma_f32_16x16x32_bf16 v[152:155], v[72:75], v[32:35], v[152:155]
 v_mfma_f32_16x16x32_bf16 v[156:159], v[72:75], v[36:39], v[156:159]
 v_mfma_f32_16x16x32_bf16 v[156:159], v[76:79], v[32:35], v[156:159]
 s_waitcnt lgkmcnt(0)
 v_mfma_f32_16x16x32_bf16 v[144:147], v[208:211], v[176:179], v[144:147]
 ds_read_b128 v[32:35], v14 offset:320
 ds_read2_b32 v[64:65], v16 offset0:32 offset1:33
 v_mfma_f32_16x16x32_bf16 v[148:151], v[208:211], v[180:183], v[148:151]
 ds_read2_b32 v[66:67], v16 offset0:34 offset1:35
 ds_read_b128 v[36:39], v14 offset:832
 v_mfma_f32_16x16x32_bf16 v[152:155], v[208:211], v[184:187], v[152:155]
 ds_read2_b32 v[68:69], v17 offset0:32 offset1:33
 ds_read2_b32 v[70:71], v17 offset0:34 offset1:35
 v_mfma_f32_16x16x32_bf16 v[156:159], v[208:211], v[188:191], v[156:159]
 ds_read_b128 v[40:43], v14 offset:1344
 ds_read2_b32 v[72:73], v18 offset0:32 offset1:33
 v_mfma_f32_16x16x32_bf16 v[148:151], v[212:215], v[176:179], v[148:151]
 ds_read2_b32 v[74:75], v18 offset0:34 offset1:35
 ds_read_b128 v[44:47], v14 offset:1856
 v_mfma_f32_16x16x32_bf16 v[152:155], v[212:215], v[180:183], v[152:155]
 ds_read2_b32 v[76:77], v19 offset0:32 offset1:33
 ds_read2_b32 v[78:79], v19 offset0:34 offset1:35
 v_mfma_f32_16x16x32_bf16 v[156:159], v[212:215], v[184:187], v[156:159]
 v_mfma_f32_16x16x32_bf16 v[152:155], v[216:219], v[176:179], v[152:155]
 v_mfma_f32_16x16x32_bf16 v[156:159], v[216:219], v[180:183], v[156:159]
 v_mfma_f32_16x16x32_bf16 v[156:159], v[220:223], v[176:179], v[156:159]
 s_waitcnt lgkmcnt(0)
 v_mfma_f32_16x16x32_bf16 v[144:147], v[64:67], v[32:35], v[144:147]
 ds_read_b128 v[176:179], v14 offset:256
 ds_read2_b32 v[208:209], v16 offset0:48 offset1:49
 v_mfma_f32_16x16x32_bf16 v[148:151], v[64:67], v[36:39], v[148:151]
 ds_read2_b32 v[210:211], v16 offset0:50 offset1:51
 ds_read_b128 v[180:183], v14 offset:768
 v_mfma_f32_16x16x32_bf16 v[152:155], v[64:67], v[40:43], v[152:155]
 ds_read2_b32 v[212:213], v17 offset0:48 offset1:49
 ds_read2_b32 v[214:215], v17 offset0:50 offset1:51
 v_mfma_f32_16x16x32_bf16 v[156:159], v[64:67], v[44:47], v[156:159]
 ds_read_b128 v[184:187], v14 offset:1280
 ds_read2_b32 v[216:217], v18 offset0:48 offset1:49
 v_mfma_f32_16x16x32_bf16 v[148:151], v[68:71], v[32:35], v[148:151]
 ds_read2_b32 v[218:219], v18 offset0:50 offset1:51
 ds_read_b128 v[188:191], v14 offset:1792
 v_mfma_f32_16x16x32_bf16 v[152:155], v[68:71], v[36:39], v[152:155]
 ds_read2_b32 v[220:221], v19 offset0:48 offset1:49
 ds_read2_b32 v[222:223], v19 offset0:50 offset1:51
 v_mfma_f32_16x16x32_bf16 v[156:159], v[68:71], v[40:43], v[156:159]
 v_mfma_f32_16x16x32_bf16 v[152:155], v[72:75], v[32:35], v[152:155]
 v_mfma_f32_16x16x32_bf16 v[156:159], v[72:75], v[36:39], v[156:159]
 v_mfma_f32_16x16x32_bf16 v[156:159], v[76:79], v[32:35], v[156:159]
 s_waitcnt lgkmcnt(0)
 v_mfma_f32_16x16x32_bf16 v[144:147], v[208:211], v[176:179], v[144:147]
 ds_read_b128 v[32:35], v14 offset:192
 ds_read2_b32 v[64:65], v16 offset0:64 offset1:65
 v_mfma_f32_16x16x32_bf16 v[148:151], v[208:211], v[180:183], v[148:151]
 ds_read2_b32 v[66:67], v16 offset0:66 offset1:67
 ds_read_b128 v[36:39], v14 offset:704
 v_mfma_f32_16x16x32_bf16 v[152:155], v[208:211], v[184:187], v[152:155]
 ds_read2_b32 v[68:69], v17 offset0:64 offset1:65
 ds_read2_b32 v[70:71], v17 offset0:66 offset1:67
 v_mfma_f32_16x16x32_bf16 v[156:159], v[208:211], v[188:191], v[156:159]
 ds_read_b128 v[40:43], v14 offset:1216
 ds_read2_b32 v[72:73], v18 offset0:64 offset1:65
 v_mfma_f32_16x16x32_bf16 v[148:151], v[212:215], v[176:179], v[148:151]
 ds_read2_b32 v[74:75], v18 offset0:66 offset1:67
 ds_read_b128 v[44:47], v14 offset:1728
 v_mfma_f32_16x16x32_bf16 v[152:155], v[212:215], v[180:183], v[152:155]
 ds_read2_b32 v[76:77], v19 offset0:64 offset1:65
 ds_read2_b32 v[78:79], v19 offset0:66 offset1:67
 v_mfma_f32_16x16x32_bf16 v[156:159], v[212:215], v[184:187], v[156:159]
 v_mfma_f32_16x16x32_bf16 v[152:155], v[216:219], v[176:179], v[152:155]
 v_mfma_f32_16x16x32_bf16 v[156:159], v[216:219], v[180:183], v[156:159]
 v_mfma_f32_16x16x32_bf16 v[156:159], v[220:223], v[176:179], v[156:159]
 s_waitcnt lgkmcnt(0)
 v_mfma_f32_16x16x32_bf16 v[144:147], v[64:67], v[32:35], v[144:147]
 ds_read_b128 v[176:179], v14 offset:128
 ds_read2_b32 v[208:209], v16 offset0:80 offset1:81
 v_mfma_f32_16x16x32_bf16 v[148:151], v[64:67], v[36:39], v[148:151]
 ds_read2_b32 v[210:211], v16 offset0:82 offset1:83
 ds_read_b128 v[180:183], v14 offset:640
 v_mfma_f32_16x16x32_bf16 v[152:155], v[64:67], v[40:43], v[152:155]
 ds_read2_b32 v[212:213], v17 offset0:80 offset1:81
 ds_read2_b32 v[214:215], v17 offset0:82 offset1:83
 v_mfma_f32_16x16x32_bf16 v[156:159], v[64:67], v[44:47], v[156:159]
 ds_read_b128 v[184:187], v14 offset:1152
 ds_read2_b32 v[216:217], v18 offset0:80 offset1:81
 v_mfma_f32_16x16x32_bf16 v[148:151], v[68:71], v[32:35], v[148:151]
 ds_read2_b32 v[218:219], v18 offset0:82 offset1:83
 ds_read_b128 v[188:191], v14 offset:1664
 v_mfma_f32_16x16x32_bf16 v[152:155], v[68:71], v[36:39], v[152:155]
 ds_read2_b32 v[220:221], v19 offset0:80 offset1:81
 ds_read2_b32 v[222:223], v19 offset0:82 offset1:83
 v_mfma_f32_16x16x32_bf16 v[156:159], v[68:71], v[40:43], v[156:159]
 v_mfma_f32_16x16x32_bf16 v[152:155], v[72:75], v[32:35], v[152:155]
 v_mfma_f32_16x16x32_bf16 v[156:159], v[72:75], v[36:39], v[156:159]
 v_mfma_f32_16x16x32_bf16 v[156:159], v[76:79], v[32:35], v[156:159]
 s_waitcnt lgkmcnt(0)
 v_mfma_f32_16x16x32_bf16 v[144:147], v[208:211], v[176:179], v[144:147]
 ds_read_b128 v[32:35], v14 offset:64
 ds_read2_b32 v[64:65], v16 offset0:96 offset1:97
 v_mfma_f32_16x16x32_bf16 v[148:151], v[208:211], v[180:183], v[148:151]
 ds_read2_b32 v[66:67], v16 offset0:98 offset1:99
 ds_read_b128 v[36:39], v14 offset:576
 v_mfma_f32_16x16x32_bf16 v[152:155], v[208:211], v[184:187], v[152:155]
 ds_read2_b32 v[68:69], v17 offset0:96 offset1:97
 ds_read2_b32 v[70:71], v17 offset0:98 offset1:99
 v_mfma_f32_16x16x32_bf16 v[156:159], v[208:211], v[188:191], v[156:159]
 ds_read_b128 v[40:43], v14 offset:1088
 ds_read2_b32 v[72:73], v18 offset0:96 offset1:97
 v_mfma_f32_16x16x32_bf16 v[148:151], v[212:215], v[176:179], v[148:151]
 ds_read2_b32 v[74:75], v18 offset0:98 offset1:99
 ds_read_b128 v[44:47], v14 offset:1600
 v_mfma_f32_16x16x32_bf16 v[152:155], v[212:215], v[180:183], v[152:155]
 ds_read2_b32 v[76:77], v19 offset0:96 offset1:97
 ds_read2_b32 v[78:79], v19 offset0:98 offset1:99
 v_mfma_f32_16x16x32_bf16 v[156:159], v[212:215], v[184:187], v[156:159]
 v_mfma_f32_16x16x32_bf16 v[152:155], v[216:219], v[176:179], v[152:155]
 v_mfma_f32_16x16x32_bf16 v[156:159], v[216:219], v[180:183], v[156:159]
 v_mfma_f32_16x16x32_bf16 v[156:159], v[220:223], v[176:179], v[156:159]
 s_waitcnt lgkmcnt(0)
 v_mfma_f32_16x16x32_bf16 v[144:147], v[64:67], v[32:35], v[144:147]
 ds_read_b128 v[176:179], v14 offset:0
 ds_read2_b32 v[208:209], v16 offset0:112 offset1:113
 v_mfma_f32_16x16x32_bf16 v[148:151], v[64:67], v[36:39], v[148:151]
 ds_read2_b32 v[210:211], v16 offset0:114 offset1:115
 ds_read_b128 v[180:183], v14 offset:512
 v_mfma_f32_16x16x32_bf16 v[152:155], v[64:67], v[40:43], v[152:155]
 ds_read2_b32 v[212:213], v17 offset0:112 offset1:113
 ds_read2_b32 v[214:215], v17 offset0:114 offset1:115
 v_mfma_f32_16x16x32_bf16 v[156:159], v[64:67], v[44:47], v[156:159]
 ds_read_b128 v[184:187], v14 offset:1024
 ds_read2_b32 v[216:217], v18 offset0:112 offset1:113
 v_mfma_f32_16x16x32_bf16 v[148:151], v[68:71], v[32:35], v[148:151]
 ds_read2_b32 v[218:219], v18 offset0:114 offset1:115
 ds_read_b128 v[188:191], v14 offset:1536
 v_mfma_f32_16x16x32_bf16 v[152:155], v[68:71], v[36:39], v[152:155]
 ds_read2_b32 v[220:221], v19 offset0:112 offset1:113
 ds_read2_b32 v[222:223], v19 offset0:114 offset1:115
 v_mfma_f32_16x16x32_bf16 v[156:159], v[68:71], v[40:43], v[156:159]
 v_mfma_f32_16x16x32_bf16 v[152:155], v[72:75], v[32:35], v[152:155]
 v_mfma_f32_16x16x32_bf16 v[156:159], v[72:75], v[36:39], v[156:159]
 v_mfma_f32_16x16x32_bf16 v[156:159], v[76:79], v[32:35], v[156:159]
 s_waitcnt lgkmcnt(0)
 v_mfma_f32_16x16x32_bf16 v[144:147], v[208:211], v[176:179], v[144:147]
 ds_read_b64 v[32:33], v15 offset:0
 ds_read_b64 v[34:35], v15 offset:512
 v_mfma_f32_16x16x32_bf16 v[148:151], v[208:211], v[180:183], v[148:151]
 ds_read_b64 v[36:37], v15 offset:1024
 ds_read_b64 v[38:39], v15 offset:1536
 v_mfma_f32_16x16x32_bf16 v[152:155], v[208:211], v[184:187], v[152:155]
 v_mfma_f32_16x16x32_bf16 v[156:159], v[208:211], v[188:191], v[156:159]
 v_mfma_f32_16x16x32_bf16 v[148:151], v[212:215], v[176:179], v[148:151]
 v_mfma_f32_16x16x32_bf16 v[152:155], v[212:215], v[180:183], v[152:155]
 v_mfma_f32_16x16x32_bf16 v[156:159], v[212:215], v[184:187], v[156:159]
 v_mfma_f32_16x16x32_bf16 v[152:155], v[216:219], v[176:179], v[152:155]
 v_mfma_f32_16x16x32_bf16 v[156:159], v[216:219], v[180:183], v[156:159]
 v_mfma_f32_16x16x32_bf16 v[156:159], v[220:223], v[176:179], v[156:159]
 s_waitcnt lgkmcnt(0)
 v_and_b32 v64, 0xffff0000, v33
 v_lshlrev_b32 v65, 16, v33
 v_and_b32 v66, 0xffff0000, v32
 v_lshlrev_b32 v67, 16, v32
 v_mul_f32 v64, v64, v12
 v_mul_f32 v65, v65, v12
 v_mul_f32 v66, v66, v12
 v_mul_f32 v67, v67, v12
 v_and_b32 v68, 0xffff0000, v35
 v_lshlrev_b32 v69, 16, v35
 v_and_b32 v70, 0xffff0000, v34
 v_lshlrev_b32 v71, 16, v34
 v_mul_f32 v68, v68, v12
 v_mul_f32 v69, v69, v12
 v_mul_f32 v70, v70, v12
 v_mul_f32 v71, v71, v12
 v_and_b32 v72, 0xffff0000, v37
 v_lshlrev_b32 v73, 16, v37
 v_and_b32 v74, 0xffff0000, v36
 v_lshlrev_b32 v75, 16, v36
 v_mul_f32 v72, v72, v12
 v_mul_f32 v73, v73, v12
 v_mul_f32 v74, v74, v12
 v_mul_f32 v75, v75, v12
 v_and_b32 v76, 0xffff0000, v39
 v_lshlrev_b32 v77, 16, v39
 v_and_b32 v78, 0xffff0000, v38
 v_lshlrev_b32 v79, 16, v38
 v_mul_f32 v76, v76, v12
 v_mul_f32 v77, v77, v12
 v_mul_f32 v78, v78, v12
 v_mul_f32 v79, v79, v12
 v_cvt_pk_bf16_f32 v8, v64, v65
 v_lshlrev_b32 v64, 16, v8
 v_and_b32 v65, 0xffff0000, v8
 v_cvt_pk_bf16_f32 v8, v66, v67
 v_lshlrev_b32 v66, 16, v8
 v_and_b32 v67, 0xffff0000, v8
 v_cvt_pk_bf16_f32 v8, v68, v69
 v_lshlrev_b32 v68, 16, v8
 v_and_b32 v69, 0xffff0000, v8
 v_cvt_pk_bf16_f32 v8, v70, v71
 v_lshlrev_b32 v70, 16, v8
 v_and_b32 v71, 0xffff0000, v8
 v_cvt_pk_bf16_f32 v8, v72, v73
 v_lshlrev_b32 v72, 16, v8
 v_and_b32 v73, 0xffff0000, v8
 v_cvt_pk_bf16_f32 v8, v74, v75
 v_lshlrev_b32 v74, 16, v8
 v_and_b32 v75, 0xffff0000, v8
 v_cvt_pk_bf16_f32 v8, v76, v77
 v_lshlrev_b32 v76, 16, v8
 v_and_b32 v77, 0xffff0000, v8
 v_cvt_pk_bf16_f32 v8, v78, v79
 v_lshlrev_b32 v78, 16, v8
 v_and_b32 v79, 0xffff0000, v8
 v_cvt_pk_bf16_f32 v8, v144, v145
 v_lshlrev_b32 v144, 16, v8
 v_and_b32 v145, 0xffff0000, v8
 v_cvt_pk_bf16_f32 v8, v146, v147
 v_lshlrev_b32 v146, 16, v8
 v_and_b32 v147, 0xffff0000, v8
 v_cvt_pk_bf16_f32 v8, v148, v149
 v_lshlrev_b32 v148, 16, v8
 v_and_b32 v149, 0xffff0000, v8
 v_cvt_pk_bf16_f32 v8, v150, v151
 v_lshlrev_b32 v150, 16, v8
 v_and_b32 v151, 0xffff0000, v8
 v_cvt_pk_bf16_f32 v8, v152, v153
 v_lshlrev_b32 v152, 16, v8
 v_and_b32 v153, 0xffff0000, v8
 v_cvt_pk_bf16_f32 v8, v154, v155
 v_lshlrev_b32 v154, 16, v8
 v_and_b32 v155, 0xffff0000, v8
 v_cvt_pk_bf16_f32 v8, v156, v157
 v_lshlrev_b32 v156, 16, v8
 v_and_b32 v157, 0xffff0000, v8
 v_cvt_pk_bf16_f32 v8, v158, v159
 v_lshlrev_b32 v158, 16, v8
 v_and_b32 v159, 0xffff0000, v8
 v_pk_add_f32 v[144:145], v[144:145], v[64:65]
 v_pk_add_f32 v[146:147], v[146:147], v[66:67]
 v_pk_add_f32 v[148:149], v[148:149], v[68:69]
 v_pk_add_f32 v[150:151], v[150:151], v[70:71]
 v_pk_add_f32 v[152:153], v[152:153], v[72:73]
 v_pk_add_f32 v[154:155], v[154:155], v[74:75]
 v_pk_add_f32 v[156:157], v[156:157], v[76:77]
 v_pk_add_f32 v[158:159], v[158:159], v[78:79]
 v_cvt_pk_bf16_f32 v160, v144, v148
 v_cvt_pk_bf16_f32 v161, v152, v156
 buffer_store_dwordx2 v[160:161], v13, s[4:7], s72 offen sc1
 s_add_u32 s72, s72, 40960
 v_cvt_pk_bf16_f32 v162, v145, v149
 v_cvt_pk_bf16_f32 v163, v153, v157
 buffer_store_dwordx2 v[162:163], v13, s[4:7], s72 offen sc1
 s_add_u32 s72, s72, 40960
 v_cvt_pk_bf16_f32 v164, v146, v150
 v_cvt_pk_bf16_f32 v165, v154, v158
 buffer_store_dwordx2 v[164:165], v13, s[4:7], s72 offen sc1
 s_add_u32 s72, s72, 40960
 v_cvt_pk_bf16_f32 v166, v147, v151
 v_cvt_pk_bf16_f32 v167, v155, v159
 buffer_store_dwordx2 v[166:167], v13, s[4:7], s72 offen sc1
 s_add_u32 s72, s72, 40960
 s_cmp_lt_u32 s70, 640
 s_cbranch_scc1 L_cv_4
 s_setpc_b64 s[76:77]
L_conv1:
 s_mov_b32 s8, s38
 s_and_b32 s9, s39, 0xffff
 s_mov_b32 s10, 2621440
 s_mov_b32 s11, 0x00020000
 s_mov_b32 s12, s40
 s_and_b32 s13, s41, 0xffff
 s_mov_b32 s14, 1280
 s_mov_b32 s15, 0x00020000
 v_lshlrev_b32 v130, 4, v0
 v_add_u32 v7, s71, v130
 v_mov_b32 v8, 0
 v_mov_b32 v9, 0
 v_mov_b32 v10, 0
 v_mov_b32 v11, 0
 s_mov_b32 exec_hi, 0
 ds_write_b128 v7, v[8:11] offset:0
 s_mov_b32 exec_lo, 3
 ds_write_b128 v7, v[8:11] offset:4608
 ds_write_b128 v7, v[8:11] offset:8768
 s_mov_b64 exec, -1
 v_and_b32 v8, 15, v0
 v_lshrrev_b32 v9, 5, v0
 v_sub_u32 v10, v8, v9
 v_lshlrev_b32 v10, 5, v10
 v_and_b32 v11, 16, v0
 v_add_u32 v10, v10, v11
 s_add_u32 s3, s71, 64
 v_add_u32 v14, s3, v10
 v_lshlrev_b32 v10, 5, v9
 v_lshl_add_u32 v10, v8, 1, v10
 v_sub_u32 v10, v10, v11
 v_and_b32 v11, 1, v0
 v_cmp_eq_u32 vcc, 1, v11
 v_mov_b32 v12, 8784
 v_mov_b32 v11, 4626
 s_nop 0
 v_cndmask_b32 v11, v12, v11, vcc
 v_add3_u32 v16, v10, v11, s71
 v_add_u32 v17, 512, v16
 v_add_u32 v18, 1024, v16
 v_add_u32 v19, 1536, v16
 v_add_u32 v20, 2048, v16
 v_add_u32 v21, 2560, v16
 v_add_u32 v22, 3072, v16
 v_add_u32 v23, 3584, v16
 v_lshlrev_b32 v10, 5, v8
 v_lshl_add_u32 v10, v9, 4, v10
 v_and_b32 v11, 16, v0
 v_lshrrev_b32 v11, 1, v11
 v_xor_b32 v11, 8, v11
 s_add_u32 s3, s71, 512
 v_add3_u32 v15, v10, v11, s3
 v_and_b32 v10, 1, v0
 v_lshlrev_b32 v10, 4, v10
 v_lshrrev_b32 v11, 4, v0
 v_lshl_add_u32 v10, v11, 2, v10
 s_mov_b32 s3, 40960
 v_mul_lo_u32 v13, v10, s3
 v_lshrrev_b32 v11, 1, v8
 v_lshl_add_u32 v13, v11, 3, v13
 s_waitcnt vmcnt(0)
L_cv_5:
 s_waitcnt vmcnt(4)
 ds_write_b128 v7, v[240:243] offset:512
 ds_write_b128 v7, v[96:99] offset:4640
 ds_write_b128 v7, v[112:115] offset:8800
 ds_write_b128 v7, v[244:247] offset:1536
 ds_write_b128 v7, v[100:103] offset:5664
 ds_write_b128 v7, v[116:119] offset:9824
 ds_write_b128 v7, v[248:251] offset:2560
 ds_write_b128 v7, v[104:107] offset:6688
 ds_write_b128 v7, v[120:123] offset:10848
 ds_write_b128 v7, v[252:255] offset:3584
 ds_write_b128 v7, v[108:111] offset:7712
 ds_write_b128 v7, v[124:127] offset:11872
 v_lshlrev_b32 v8, 16, v96
 v_lshlrev_b32 v12, 16, v128
 s_mov_b64 exec, 1
 ds_write_b32 v7, v8 offset:8796
 s_mov_b64 exec, -1
 s_lshl_b32 s72, s70, 6
 s_add_u32 s72, s72, 235667456
 s_add_u32 s70, s70, s69
 s_waitcnt lgkmcnt(0)
 s_lshl_b32 s73, s70, 12
 s_add_u32 s74, s73, 2
 buffer_load_dwordx4 v[96:99], v130, s[8:11], s73 offen offset:0
 buffer_load_dwordx4 v[100:103], v130, s[8:11], s73 offen offset:1024
 buffer_load_dwordx4 v[104:107], v130, s[8:11], s73 offen offset:2048
 buffer_load_dwordx4 v[108:111], v130, s[8:11], s73 offen offset:3072
 buffer_load_dwordx4 v[112:115], v130, s[8:11], s74 offen offset:0
 buffer_load_dwordx4 v[116:119], v130, s[8:11], s74 offen offset:1024
 buffer_load_dwordx4 v[120:123], v130, s[8:11], s74 offen offset:2048
 buffer_load_dwordx4 v[124:127], v130, s[8:11], s74 offen offset:3072
 s_lshl_b32 s3, s70, 1
 buffer_load_ushort v128, off, s[12:15], s3
 s_lshl_b32 s3, s70, 12
 s_add_u32 s3, s3, 231735296
 buffer_load_dwordx4 v[240:243], v130, s[4:7], s3 offen offset:0 sc1
 buffer_load_dwordx4 v[244:247], v130, s[4:7], s3 offen offset:1024 sc1
 buffer_load_dwordx4 v[248:251], v130, s[4:7], s3 offen offset:2048 sc1
 buffer_load_dwordx4 v[252:255], v130, s[4:7], s3 offen offset:3072 sc1
 ds_read_b128 v[32:35], v14 offset:448
 ds_read2_b32 v[64:65], v16 offset0:0 offset1:1
 ds_read2_b32 v[66:67], v16 offset0:2 offset1:3
 ds_read_b128 v[36:39], v14 offset:960
 ds_read2_b32 v[68:69], v17 offset0:0 offset1:1
 ds_read2_b32 v[70:71], v17 offset0:2 offset1:3
 ds_read_b128 v[40:43], v14 offset:1472
 ds_read2_b32 v[72:73], v18 offset0:0 offset1:1
 ds_read2_b32 v[74:75], v18 offset0:2 offset1:3
 ds_read_b128 v[44:47], v14 offset:1984
 ds_read2_b32 v[76:77], v19 offset0:0 offset1:1
 ds_read2_b32 v[78:79], v19 offset0:2 offset1:3
 ds_read_b128 v[48:51], v14 offset:2496
 ds_read2_b32 v[80:81], v20 offset0:0 offset1:1
 ds_read2_b32 v[82:83], v20 offset0:2 offset1:3
 ds_read_b128 v[52:55], v14 offset:3008
 ds_read2_b32 v[84:85], v21 offset0:0 offset1:1
 ds_read2_b32 v[86:87], v21 offset0:2 offset1:3
 ds_read_b128 v[56:59], v14 offset:3520
 ds_read2_b32 v[88:89], v22 offset0:0 offset1:1
 ds_read2_b32 v[90:91], v22 offset0:2 offset1:3
 ds_read_b128 v[60:63], v14 offset:4032
 ds_read2_b32 v[92:93], v23 offset0:0 offset1:1
 ds_read2_b32 v[94:95], v23 offset0:2 offset1:3
 s_waitcnt lgkmcnt(0)
 v_mfma_f32_16x16x32_bf16 v[144:147], v[64:67], v[48:51], 0
 ds_read_b128 v[176:179], v14 offset:384
 v_mfma_f32_16x16x32_bf16 v[148:151], v[64:67], v[52:55], 0
 ds_read2_b32 v[208:209], v16 offset0:16 offset1:17
 v_mfma_f32_16x16x32_bf16 v[152:155], v[64:67], v[56:59], 0
 ds_read2_b32 v[210:211], v16 offset0:18 offset1:19
 v_mfma_f32_16x16x32_bf16 v[156:159], v[64:67], v[60:63], 0
 ds_read_b128 v[180:183], v14 offset:896
 v_mfma_f32_16x16x32_bf16 v[144:147], v[68:71], v[44:47], v[144:147]
 ds_read2_b32 v[212:213], v17 offset0:16 offset1:17
 v_mfma_f32_16x16x32_bf16 v[148:151], v[68:71], v[48:51], v[148:151]
 ds_read2_b32 v[214:215], v17 offset0:18 offset1:19
 v_mfma_f32_16x16x32_bf16 v[152:155], v[68:71], v[52:55], v[152:155]
 ds_read_b128 v[184:187], v14 offset:1408
 v_mfma_f32_16x16x32_bf16 v[156:159], v[68:71], v[56:59], v[156:159]
 ds_read2_b32 v[216:217], v18 offset0:16 offset1:17
 v_mfma_f32_16x16x32_bf16 v[144:147], v[72:75], v[40:43], v[144:147]
 ds_read2_b32 v[218:219], v18 offset0:18 offset1:19
 v_mfma_f32_16x16x32_bf16 v[148:151], v[72:75], v[44:47], v[148:151]
 ds_read_b128 v[188:191], v14 offset:1920
 v_mfma_f32_16x16x32_bf16 v[152:155], v[72:75], v[48:51], v[152:155]
 ds_read2_b32 v[220:221], v19 offset0:16 offset1:17
 v_mfma_f32_16x16x32_bf16 v[156:159], v[72:75], v[52:55], v[156:159]
 ds_read2_b32 v[222:223], v19 offset0:18 offset1:19
 v_mfma_f32_16x16x32_bf16 v[144:147], v[76:79], v[36:39], v[144:147]
 ds_read_b128 v[192:195], v14 offset:2432
 v_mfma_f32_16x16x32_bf16 v[148:151], v[76:79], v[40:43], v[148:151]
 ds_read2_b32 v[224:225], v20 offset0:16 offset1:17
 v_mfma_f32_16x16x32_bf16 v[152:155], v[76:79], v[44:47], v[152:155]
 ds_read2_b32 v[226:227], v20 offset0:18 offset1:19
 v_mfma_f32_16x16x32_bf16 v[156:159], v[76:79], v[48:51], v[156:159]
 ds_read_b128 v[196:199], v14 offset:2944
 v_mfma_f32_16x16x32_bf16 v[144:147], v[80:83], v[32:35], v[144:147]
 ds_read2_b32 v[228:229], v21 offset0:16 offset1:17
 v_mfma_f32_16x16x32_bf16 v[148:151], v[80:83], v[36:39], v[148:151]
 ds_read2_b32 v[230:231], v21 offset0:18 offset1:19
 v_mfma_f32_16x16x32_bf16 v[152:155], v[80:83], v[40:43], v[152:155]
 ds_read_b128 v[200:203], v14 offset:3456
 v_mfma_f32_16x16x32_bf16 v[156:159], v[80:83], v[44:47], v[156:159]
 ds_read2_b32 v[232:233], v22 offset0:16 offset1:17
 v_mfma_f32_16x16x32_bf16 v[148:151], v[84:87], v[32:35], v[148:151]
 ds_read2_b32 v[234:235], v22 offset0:18 offset1:19
 v_mfma_f32_16x16x32_bf16 v[152:155], v[84:87], v[36:39], v[152:155]
 ds_read_b128 v[204:207], v14 offset:3968
 v_mfma_f32_16x16x32_bf16 v[156:159], v[84:87], v[40:43], v[156:159]
 ds_read2_b32 v[236:237], v23 offset0:16 offset1:17
 v_mfma_f32_16x16x32_bf16 v[152:155], v[88:91], v[32:35], v[152:155]
 ds_read2_b32 v[238:239], v23 offset0:18 offset1:19
 v_mfma_f32_16x16x32_bf16 v[156:159], v[88:91], v[36:39], v[156:159]
 v_mfma_f32_16x16x32_bf16 v[156:159], v[92:95], v[32:35], v[156:159]
 s_waitcnt lgkmcnt(0)
 v_mfma_f32_16x16x32_bf16 v[144:147], v[208:211], v[192:195], v[144:147]
 ds_read_b128 v[32:35], v14 offset:320
 v_mfma_f32_16x16x32_bf16 v[148:151], v[208:211], v[196:199], v[148:151]
 ds_read2_b32 v[64:65], v16 offset0:32 offset1:33
 v_mfma_f32_16x16x32_bf16 v[152:155], v[208:211], v[200:203], v[152:155]
 ds_read2_b32 v[66:67], v16 offset0:34 offset1:35
 v_mfma_f32_16x16x32_bf16 v[156:159], v[208:211], v[204:207], v[156:159]
 ds_read_b128 v[36:39], v14 offset:832
 v_mfma_f32_16x16x32_bf16 v[144:147], v[212:215], v[188:191], v[144:147]
 ds_read2_b32 v[68:69], v17 offset0:32 offset1:33
 v_mfma_f32_16x16x32_bf16 v[148:151], v[212:215], v[192:195], v[148:151]
 ds_read2_b32 v[70:71], v17 offset0:34 offset1:35
 v_mfma_f32_16x16x32_bf16 v[152:155], v[212:215], v[196:199], v[152:155]
 ds_read_b128 v[40:43], v14 offset:1344
 v_mfma_f32_16x16x32_bf16 v[156:159], v[212:215], v[200:203], v[156:159]
 ds_read2_b32 v[72:73], v18 offset0:32 offset1:33
 v_mfma_f32_16x16x32_bf16 v[144:147], v[216:219], v[184:187], v[144:147]
 ds_read2_b32 v[74:75], v18 offset0:34 offset1:35
 v_mfma_f32_16x16x32_bf16 v[148:151], v[216:219], v[188:191], v[148:151]
 ds_read_b128 v[44:47], v14 offset:1856
 v_mfma_f32_16x16x32_bf16 v[152:155], v[216:219], v[192:195], v[152:155]
 ds_read2_b32 v[76:77], v19 offset0:32 offset1:33
 v_mfma_f32_16x16x32_bf16 v[156:159], v[216:219], v[196:199], v[156:159]
 ds_read2_b32 v[78:79], v19 offset0:34 offset1:35
 v_mfma_f32_16x16x32_bf16 v[144:147], v[220:223], v[180:183], v[144:147]
 ds_read_b128 v[48:51], v14 offset:2368
 v_mfma_f32_16x16x32_bf16 v[148:151], v[220:223], v[184:187], v[148:151]
 ds_read2_b32 v[80:81], v20 offset0:32 offset1:33
 v_mfma_f32_16x16x32_bf16 v[152:155], v[220:223], v[188:191], v[152:155]
 ds_read2_b32 v[82:83], v20 offset0:34 offset1:35
 v_mfma_f32_16x16x32_bf16 v[156:159], v[220:223], v[192:195], v[156:159]
 ds_read_b128 v[52:55], v14 offset:2880
 v_mfma_f32_16x16x32_bf16 v[144:147], v[224:227], v[176:179], v[144:147]
 ds_read2_b32 v[84:85], v21 offset0:32 offset1:33
 v_mfma_f32_16x16x32_bf16 v[148:151], v[224:227], v[180:183], v[148:151]
 ds_read2_b32 v[86:87], v21 offset0:34 offset1:35
 v_mfma_f32_16x16x32_bf16 v[152:155], v[224:227], v[184:187], v[152:155]
 ds_read_b128 v[56:59], v14 offset:3392
 v_mfma_f32_16x16x32_bf16 v[156:159], v[224:227], v[188:191], v[156:159]
 ds_read2_b32 v[88:89], v22 offset0:32 offset1:33
 v_mfma_f32_16x16x32_bf16 v[148:151], v[228:231], v[176:179], v[148:151]
 ds_read2_b32 v[90:91], v22 offset0:34 offset1:35
 v_mfma_f32_16x16x32_bf16 v[152:155], v[228:231], v[180:183], v[152:155]
 ds_read_b128 v[60:63], v14 offset:3904
 v_mfma_f32_16x16x32_bf16 v[156:159], v[228:231], v[184:187], v[156:159]
 ds_read2_b32 v[92:93], v23 offset0:32 offset1:33
 v_mfma_f32_16x16x32_bf16 v[152:155], v[232:235], v[176:179], v[152:155]
 ds_read2_b32 v[94:95], v23 offset0:34 offset1:35
 v_mfma_f32_16x16x32_bf16 v[156:159], v[232:235], v[180:183], v[156:159]
 v_mfma_f32_16x16x32_bf16 v[156:159], v[236:239], v[176:179], v[156:159]
 s_waitcnt lgkmcnt(0)
 v_mfma_f32_16x16x32_bf16 v[144:147], v[64:67], v[48:51], v[144:147]
 ds_read_b128 v[176:179], v14 offset:256
 v_mfma_f32_16x16x32_bf16 v[148:151], v[64:67], v[52:55], v[148:151]
 ds_read2_b32 v[208:209], v16 offset0:48 offset1:49
 v_mfma_f32_16x16x32_bf16 v[152:155], v[64:67], v[56:59], v[152:155]
 ds_read2_b32 v[210:211], v16 offset0:50 offset1:51
 v_mfma_f32_16x16x32_bf16 v[156:159], v[64:67], v[60:63], v[156:159]
 ds_read_b128 v[180:183], v14 offset:768
 v_mfma_f32_16x16x32_bf16 v[144:147], v[68:71], v[44:47], v[144:147]
 ds_read2_b32 v[212:213], v17 offset0:48 offset1:49
 v_mfma_f32_16x16x32_bf16 v[148:151], v[68:71], v[48:51], v[148:151]
 ds_read2_b32 v[214:215], v17 offset0:50 offset1:51
 v_mfma_f32_16x16x32_bf16 v[152:155], v[68:71], v[52:55], v[152:155]
 ds_read_b128 v[184:187], v14 offset:1280
 v_mfma_f32_16x16x32_bf16 v[156:159], v[68:71], v[56:59], v[156:159]
 ds_read2_b32 v[216:217], v18 offset0:48 offset1:49
 v_mfma_f32_16x16x32_bf16 v[144:147], v[72:75], v[40:43], v[144:147]
 ds_read2_b32 v[218:219], v18 offset0:50 offset1:51
 v_mfma_f32_16x16x32_bf16 v[148:151], v[72:75], v[44:47], v[148:151]
 ds_read_b128 v[188:191], v14 offset:1792
 v_mfma_f32_16x16x32_bf16 v[152:155], v[72:75], v[48:51], v[152:155]
 ds_read2_b32 v[220:221], v19 offset0:48 offset1:49
 v_mfma_f32_16x16x32_bf16 v[156:159], v[72:75], v[52:55], v[156:159]
 ds_read2_b32 v[222:223], v19 offset0:50 offset1:51
 v_mfma_f32_16x16x32_bf16 v[144:147], v[76:79], v[36:39], v[144:147]
 ds_read_b128 v[192:195], v14 offset:2304
 v_mfma_f32_16x16x32_bf16 v[148:151], v[76:79], v[40:43], v[148:151]
 ds_read2_b32 v[224:225], v20 offset0:48 offset1:49
 v_mfma_f32_16x16x32_bf16 v[152:155], v[76:79], v[44:47], v[152:155]
 ds_read2_b32 v[226:227], v20 offset0:50 offset1:51
 v_mfma_f32_16x16x32_bf16 v[156:159], v[76:79], v[48:51], v[156:159]
 ds_read_b128 v[196:199], v14 offset:2816
 v_mfma_f32_16x16x32_bf16 v[144:147], v[80:83], v[32:35], v[144:147]
 ds_read2_b32 v[228:229], v21 offset0:48 offset1:49
 v_mfma_f32_16x16x32_bf16 v[148:151], v[80:83], v[36:39], v[148:151]
 ds_read2_b32 v[230:231], v21 offset0:50 offset1:51
 v_mfma_f32_16x16x32_bf16 v[152:155], v[80:83], v[40:43], v[152:155]
 ds_read_b128 v[200:203], v14 offset:3328
 v_mfma_f32_16x16x32_bf16 v[156:159], v[80:83], v[44:47], v[156:159]
 ds_read2_b32 v[232:233], v22 offset0:48 offset1:49
 v_mfma_f32_16x16x32_bf16 v[148:151], v[84:87], v[32:35], v[148:151]
 ds_read2_b32 v[234:235], v22 offset0:50 offset1:51
 v_mfma_f32_16x16x32_bf16 v[152:155], v[84:87], v[36:39], v[152:155]
 ds_read_b128 v[204:207], v14 offset:3840
 v_mfma_f32_16x16x32_bf16 v[156:159], v[84:87], v[40:43], v[156:159]
 ds_read2_b32 v[236:237], v23 offset0:48 offset1:49
 v_mfma_f32_16x16x32_bf16 v[152:155], v[88:91], v[32:35], v[152:155]
 ds_read2_b32 v[238:239], v23 offset0:50 offset1:51
 v_mfma_f32_16x16x32_bf16 v[156:159], v[88:91], v[36:39], v[156:159]
 v_mfma_f32_16x16x32_bf16 v[156:159], v[92:95], v[32:35], v[156:159]
 s_waitcnt lgkmcnt(0)
 v_mfma_f32_16x16x32_bf16 v[144:147], v[208:211], v[192:195], v[144:147]
 ds_read_b128 v[32:35], v14 offset:192
 v_mfma_f32_16x16x32_bf16 v[148:151], v[208:211], v[196:199], v[148:151]
 ds_read2_b32 v[64:65], v16 offset0:64 offset1:65
 v_mfma_f32_16x16x32_bf16 v[152:155], v[208:211], v[200:203], v[152:155]
 ds_read2_b32 v[66:67], v16 offset0:66 offset1:67
 v_mfma_f32_16x16x32_bf16 v[156:159], v[208:211], v[204:207], v[156:159]
 ds_read_b128 v[36:39], v14 offset:704
 v_mfma_f32_16x16x32_bf16 v[144:147], v[212:215], v[188:191], v[144:147]
 ds_read2_b32 v[68:69], v17 offset0:64 offset1:65
 v_mfma_f32_16x16x32_bf16 v[148:151], v[212:215], v[192:195], v[148:151]
 ds_read2_b32 v[70:71], v17 offset0:66 offset1:67
 v_mfma_f32_16x16x32_bf16 v[152:155], v[212:215], v[196:199], v[152:155]
 ds_read_b128 v[40:43], v14 offset:1216
 v_mfma_f32_16x16x32_bf16 v[156:159], v[212:215], v[200:203], v[156:159]
 ds_read2_b32 v[72:73], v18 offset0:64 offset1:65
 v_mfma_f32_16x16x32_bf16 v[144:147], v[216:219], v[184:187], v[144:147]
 ds_read2_b32 v[74:75], v18 offset0:66 offset1:67
 v_mfma_f32_16x16x32_bf16 v[148:151], v[216:219], v[188:191], v[148:151]
 ds_read_b128 v[44:47], v14 offset:1728
 v_mfma_f32_16x16x32_bf16 v[152:155], v[216:219], v[192:195], v[152:155]
 ds_read2_b32 v[76:77], v19 offset0:64 offset1:65
 v_mfma_f32_16x16x32_bf16 v[156:159], v[216:219], v[196:199], v[156:159]
 ds_read2_b32 v[78:79], v19 offset0:66 offset1:67
 v_mfma_f32_16x16x32_bf16 v[144:147], v[220:223], v[180:183], v[144:147]
 ds_read_b128 v[48:51], v14 offset:2240
 v_mfma_f32_16x16x32_bf16 v[148:151], v[220:223], v[184:187], v[148:151]
 ds_read2_b32 v[80:81], v20 offset0:64 offset1:65
 v_mfma_f32_16x16x32_bf16 v[152:155], v[220:223], v[188:191], v[152:155]
 ds_read2_b32 v[82:83], v20 offset0:66 offset1:67
 v_mfma_f32_16x16x32_bf16 v[156:159], v[220:223], v[192:195], v[156:159]
 ds_read_b128 v[52:55], v14 offset:2752
 v_mfma_f32_16x16x32_bf16 v[144:147], v[224:227], v[176:179], v[144:147]
 ds_read2_b32 v[84:85], v21 offset0:64 offset1:65
 v_mfma_f32_16x16x32_bf16 v[148:151], v[224:227], v[180:183], v[148:151]
 ds_read2_b32 v[86:87], v21 offset0:66 offset1:67
 v_mfma_f32_16x16x32_bf16 v[152:155], v[224:227], v[184:187], v[152:155]
 ds_read_b128 v[56:59], v14 offset:3264
 v_mfma_f32_16x16x32_bf16 v[156:159], v[224:227], v[188:191], v[156:159]
 ds_read2_b32 v[88:89], v22 offset0:64 offset1:65
 v_mfma_f32_16x16x32_bf16 v[148:151], v[228:231], v[176:179], v[148:151]
 ds_read2_b32 v[90:91], v22 offset0:66 offset1:67
 v_mfma_f32_16x16x32_bf16 v[152:155], v[228:231], v[180:183], v[152:155]
 ds_read_b128 v[60:63], v14 offset:3776
 v_mfma_f32_16x16x32_bf16 v[156:159], v[228:231], v[184:187], v[156:159]
 ds_read2_b32 v[92:93], v23 offset0:64 offset1:65
 v_mfma_f32_16x16x32_bf16 v[152:155], v[232:235], v[176:179], v[152:155]
 ds_read2_b32 v[94:95], v23 offset0:66 offset1:67
 v_mfma_f32_16x16x32_bf16 v[156:159], v[232:235], v[180:183], v[156:159]
 v_mfma_f32_16x16x32_bf16 v[156:159], v[236:239], v[176:179], v[156:159]
 s_waitcnt lgkmcnt(0)
 v_mfma_f32_16x16x32_bf16 v[144:147], v[64:67], v[48:51], v[144:147]
 ds_read_b128 v[176:179], v14 offset:128
 v_mfma_f32_16x16x32_bf16 v[148:151], v[64:67], v[52:55], v[148:151]
 ds_read2_b32 v[208:209], v16 offset0:80 offset1:81
 v_mfma_f32_16x16x32_bf16 v[152:155], v[64:67], v[56:59], v[152:155]
 ds_read2_b32 v[210:211], v16 offset0:82 offset1:83
 v_mfma_f32_16x16x32_bf16 v[156:159], v[64:67], v[60:63], v[156:159]
 ds_read_b128 v[180:183], v14 offset:640
 v_mfma_f32_16x16x32_bf16 v[144:147], v[68:71], v[44:47], v[144:147]
 ds_read2_b32 v[212:213], v17 offset0:80 offset1:81
 v_mfma_f32_16x16x32_bf16 v[148:151], v[68:71], v[48:51], v[148:151]
 ds_read2_b32 v[214:215], v17 offset0:82 offset1:83
 v_mfma_f32_16x16x32_bf16 v[152:155], v[68:71], v[52:55], v[152:155]
 ds_read_b128 v[184:187], v14 offset:1152
 v_mfma_f32_16x16x32_bf16 v[156:159], v[68:71], v[56:59], v[156:159]
 ds_read2_b32 v[216:217], v18 offset0:80 offset1:81
 v_mfma_f32_16x16x32_bf16 v[144:147], v[72:75], v[40:43], v[144:147]
 ds_read2_b32 v[218:219], v18 offset0:82 offset1:83
 v_mfma_f32_16x16x32_bf16 v[148:151], v[72:75], v[44:47], v[148:151]
 ds_read_b128 v[188:191], v14 offset:1664
 v_mfma_f32_16x16x32_bf16 v[152:155], v[72:75], v[48:51], v[152:155]
 ds_read2_b32 v[220:221], v19 offset0:80 offset1:81
 v_mfma_f32_16x16x32_bf16 v[156:159], v[72:75], v[52:55], v[156:159]
 ds_read2_b32 v[222:223], v19 offset0:82 offset1:83
 v_mfma_f32_16x16x32_bf16 v[144:147], v[76:79], v[36:39], v[144:147]
 ds_read_b128 v[192:195], v14 offset:2176
 v_mfma_f32_16x16x32_bf16 v[148:151], v[76:79], v[40:43], v[148:151]
 ds_read2_b32 v[224:225], v20 offset0:80 offset1:81
 v_mfma_f32_16x16x32_bf16 v[152:155], v[76:79], v[44:47], v[152:155]
 ds_read2_b32 v[226:227], v20 offset0:82 offset1:83
 v_mfma_f32_16x16x32_bf16 v[156:159], v[76:79], v[48:51], v[156:159]
 ds_read_b128 v[196:199], v14 offset:2688
 v_mfma_f32_16x16x32_bf16 v[144:147], v[80:83], v[32:35], v[144:147]
 ds_read2_b32 v[228:229], v21 offset0:80 offset1:81
 v_mfma_f32_16x16x32_bf16 v[148:151], v[80:83], v[36:39], v[148:151]
 ds_read2_b32 v[230:231], v21 offset0:82 offset1:83
 v_mfma_f32_16x16x32_bf16 v[152:155], v[80:83], v[40:43], v[152:155]
 ds_read_b128 v[200:203], v14 offset:3200
 v_mfma_f32_16x16x32_bf16 v[156:159], v[80:83], v[44:47], v[156:159]
 ds_read2_b32 v[232:233], v22 offset0:80 offset1:81
 v_mfma_f32_16x16x32_bf16 v[148:151], v[84:87], v[32:35], v[148:151]
 ds_read2_b32 v[234:235], v22 offset0:82 offset1:83
 v_mfma_f32_16x16x32_bf16 v[152:155], v[84:87], v[36:39], v[152:155]
 ds_read_b128 v[204:207], v14 offset:3712
 v_mfma_f32_16x16x32_bf16 v[156:159], v[84:87], v[40:43], v[156:159]
 ds_read2_b32 v[236:237], v23 offset0:80 offset1:81
 v_mfma_f32_16x16x32_bf16 v[152:155], v[88:91], v[32:35], v[152:155]
 ds_read2_b32 v[238:239], v23 offset0:82 offset1:83
 v_mfma_f32_16x16x32_bf16 v[156:159], v[88:91], v[36:39], v[156:159]
 v_mfma_f32_16x16x32_bf16 v[156:159], v[92:95], v[32:35], v[156:159]
 s_waitcnt lgkmcnt(0)
 v_mfma_f32_16x16x32_bf16 v[144:147], v[208:211], v[192:195], v[144:147]
 ds_read_b128 v[32:35], v14 offset:64
 v_mfma_f32_16x16x32_bf16 v[148:151], v[208:211], v[196:199], v[148:151]
 ds_read2_b32 v[64:65], v16 offset0:96 offset1:97
 v_mfma_f32_16x16x32_bf16 v[152:155], v[208:211], v[200:203], v[152:155]
 ds_read2_b32 v[66:67], v16 offset0:98 offset1:99
 v_mfma_f32_16x16x32_bf16 v[156:159], v[208:211], v[204:207], v[156:159]
 ds_read_b128 v[36:39], v14 offset:576
 v_mfma_f32_16x16x32_bf16 v[144:147], v[212:215], v[188:191], v[144:147]
 ds_read2_b32 v[68:69], v17 offset0:96 offset1:97
 v_mfma_f32_16x16x32_bf16 v[148:151], v[212:215], v[192:195], v[148:151]
 ds_read2_b32 v[70:71], v17 offset0:98 offset1:99
 v_mfma_f32_16x16x32_bf16 v[152:155], v[212:215], v[196:199], v[152:155]
 ds_read_b128 v[40:43], v14 offset:1088
 v_mfma_f32_16x16x32_bf16 v[156:159], v[212:215], v[200:203], v[156:159]
 ds_read2_b32 v[72:73], v18 offset0:96 offset1:97
 v_mfma_f32_16x16x32_bf16 v[144:147], v[216:219], v[184:187], v[144:147]
 ds_read2_b32 v[74:75], v18 offset0:98 offset1:99
 v_mfma_f32_16x16x32_bf16 v[148:151], v[216:219], v[188:191], v[148:151]
 ds_read_b128 v[44:47], v14 offset:1600
 v_mfma_f32_16x16x32_bf16 v[152:155], v[216:219], v[192:195], v[152:155]
 ds_read2_b32 v[76:77], v19 offset0:96 offset1:97
 v_mfma_f32_16x16x32_bf16 v[156:159], v[216:219], v[196:199], v[156:159]
 ds_read2_b32 v[78:79], v19 offset0:98 offset1:99
 v_mfma_f32_16x16x32_bf16 v[144:147], v[220:223], v[180:183], v[144:147]
 ds_read_b128 v[48:51], v14 offset:2112
 v_mfma_f32_16x16x32_bf16 v[148:151], v[220:223], v[184:187], v[148:151]
 ds_read2_b32 v[80:81], v20 offset0:96 offset1:97
 v_mfma_f32_16x16x32_bf16 v[152:155], v[220:223], v[188:191], v[152:155]
 ds_read2_b32 v[82:83], v20 offset0:98 offset1:99
 v_mfma_f32_16x16x32_bf16 v[156:159], v[220:223], v[192:195], v[156:159]
 ds_read_b128 v[52:55], v14 offset:2624
 v_mfma_f32_16x16x32_bf16 v[144:147], v[224:227], v[176:179], v[144:147]
 ds_read2_b32 v[84:85], v21 offset0:96 offset1:97
 v_mfma_f32_16x16x32_bf16 v[148:151], v[224:227], v[180:183], v[148:151]
 ds_read2_b32 v[86:87], v21 offset0:98 offset1:99
 v_mfma_f32_16x16x32_bf16 v[152:155], v[224:227], v[184:187], v[152:155]
 ds_read_b128 v[56:59], v14 offset:3136
 v_mfma_f32_16x16x32_bf16 v[156:159], v[224:227], v[188:191], v[156:159]
 ds_read2_b32 v[88:89], v22 offset0:96 offset1:97
 v_mfma_f32_16x16x32_bf16 v[148:151], v[228:231], v[176:179], v[148:151]
 ds_read2_b32 v[90:91], v22 offset0:98 offset1:99
 v_mfma_f32_16x16x32_bf16 v[152:155], v[228:231], v[180:183], v[152:155]
 ds_read_b128 v[60:63], v14 offset:3648
 v_mfma_f32_16x16x32_bf16 v[156:159], v[228:231], v[184:187], v[156:159]
 ds_read2_b32 v[92:93], v23 offset0:96 offset1:97
 v_mfma_f32_16x16x32_bf16 v[152:155], v[232:235], v[176:179], v[152:155]
 ds_read2_b32 v[94:95], v23 offset0:98 offset1:99
 v_mfma_f32_16x16x32_bf16 v[156:159], v[232:235], v[180:183], v[156:159]
 v_mfma_f32_16x16x32_bf16 v[156:159], v[236:239], v[176:179], v[156:159]
 s_waitcnt lgkmcnt(0)
 v_mfma_f32_16x16x32_bf16 v[144:147], v[64:67], v[48:51], v[144:147]
 ds_read_b128 v[176:179], v14 offset:0
 v_mfma_f32_16x16x32_bf16 v[148:151], v[64:67], v[52:55], v[148:151]
 ds_read2_b32 v[208:209], v16 offset0:112 offset1:113
 v_mfma_f32_16x16x32_bf16 v[152:155], v[64:67], v[56:59], v[152:155]
 ds_read2_b32 v[210:211], v16 offset0:114 offset1:115
 v_mfma_f32_16x16x32_bf16 v[156:159], v[64:67], v[60:63], v[156:159]
 ds_read_b128 v[180:183], v14 offset:512
 v_mfma_f32_16x16x32_bf16 v[144:147], v[68:71], v[44:47], v[144:147]
 ds_read2_b32 v[212:213], v17 offset0:112 offset1:113
 v_mfma_f32_16x16x32_bf16 v[148:151], v[68:71], v[48:51], v[148:151]
 ds_read2_b32 v[214:215], v17 offset0:114 offset1:115
 v_mfma_f32_16x16x32_bf16 v[152:155], v[68:71], v[52:55], v[152:155]
 ds_read_b128 v[184:187], v14 offset:1024
 v_mfma_f32_16x16x32_bf16 v[156:159], v[68:71], v[56:59], v[156:159]
 ds_read2_b32 v[216:217], v18 offset0:112 offset1:113
 v_mfma_f32_16x16x32_bf16 v[144:147], v[72:75], v[40:43], v[144:147]
 ds_read2_b32 v[218:219], v18 offset0:114 offset1:115
 v_mfma_f32_16x16x32_bf16 v[148:151], v[72:75], v[44:47], v[148:151]
 ds_read_b128 v[188:191], v14 offset:1536
 v_mfma_f32_16x16x32_bf16 v[152:155], v[72:75], v[48:51], v[152:155]
 ds_read2_b32 v[220:221], v19 offset0:112 offset1:113
 v_mfma_f32_16x16x32_bf16 v[156:159], v[72:75], v[52:55], v[156:159]
 ds_read2_b32 v[222:223], v19 offset0:114 offset1:115
 v_mfma_f32_16x16x32_bf16 v[144:147], v[76:79], v[36:39], v[144:147]
 ds_read_b128 v[192:195], v14 offset:2048
 v_mfma_f32_16x16x32_bf16 v[148:151], v[76:79], v[40:43], v[148:151]
 ds_read2_b32 v[224:225], v20 offset0:112 offset1:113
 v_mfma_f32_16x16x32_bf16 v[152:155], v[76:79], v[44:47], v[152:155]
 ds_read2_b32 v[226:227], v20 offset0:114 offset1:115
 v_mfma_f32_16x16x32_bf16 v[156:159], v[76:79], v[48:51], v[156:159]
 ds_read_b128 v[196:199], v14 offset:2560
 v_mfma_f32_16x16x32_bf16 v[144:147], v[80:83], v[32:35], v[144:147]
 ds_read2_b32 v[228:229], v21 offset0:112 offset1:113
 v_mfma_f32_16x16x32_bf16 v[148:151], v[80:83], v[36:39], v[148:151]
 ds_read2_b32 v[230:231], v21 offset0:114 offset1:115
 v_mfma_f32_16x16x32_bf16 v[152:155], v[80:83], v[40:43], v[152:155]
 ds_read_b128 v[200:203], v14 offset:3072
 v_mfma_f32_16x16x32_bf16 v[156:159], v[80:83], v[44:47], v[156:159]
 ds_read2_b32 v[232:233], v22 offset0:112 offset1:113
 v_mfma_f32_16x16x32_bf16 v[148:151], v[84:87], v[32:35], v[148:151]
 ds_read2_b32 v[234:235], v22 offset0:114 offset1:115
 v_mfma_f32_16x16x32_bf16 v[152:155], v[84:87], v[36:39], v[152:155]
 ds_read_b128 v[204:207], v14 offset:3584
 v_mfma_f32_16x16x32_bf16 v[156:159], v[84:87], v[40:43], v[156:159]
 ds_read2_b32 v[236:237], v23 offset0:112 offset1:113
 v_mfma_f32_16x16x32_bf16 v[152:155], v[88:91], v[32:35], v[152:155]
 ds_read2_b32 v[238:239], v23 offset0:114 offset1:115
 v_mfma_f32_16x16x32_bf16 v[156:159], v[88:91], v[36:39], v[156:159]
 v_mfma_f32_16x16x32_bf16 v[156:159], v[92:95], v[32:35], v[156:159]
 s_waitcnt lgkmcnt(0)
 v_mfma_f32_16x16x32_bf16 v[144:147], v[208:211], v[192:195], v[144:147]
 ds_read_b64 v[32:33], v15 offset:2048
 v_mfma_f32_16x16x32_bf16 v[148:151], v[208:211], v[196:199], v[148:151]
 ds_read_b64 v[34:35], v15 offset:2560
 v_mfma_f32_16x16x32_bf16 v[152:155], v[208:211], v[200:203], v[152:155]
 ds_read_b64 v[36:37], v15 offset:3072
 v_mfma_f32_16x16x32_bf16 v[156:159], v[208:211], v[204:207], v[156:159]
 ds_read_b64 v[38:39], v15 offset:3584
 v_mfma_f32_16x16x32_bf16 v[144:147], v[212:215], v[188:191], v[144:147]
 v_mfma_f32_16x16x32_bf16 v[148:151], v[212:215], v[192:195], v[148:151]
 v_mfma_f32_16x16x32_bf16 v[152:155], v[212:215], v[196:199], v[152:155]
 v_mfma_f32_16x16x32_bf16 v[156:159], v[212:215], v[200:203], v[156:159]
 v_mfma_f32_16x16x32_bf16 v[144:147], v[216:219], v[184:187], v[144:147]
 v_mfma_f32_16x16x32_bf16 v[148:151], v[216:219], v[188:191], v[148:151]
 v_mfma_f32_16x16x32_bf16 v[152:155], v[216:219], v[192:195], v[152:155]
 v_mfma_f32_16x16x32_bf16 v[156:159], v[216:219], v[196:199], v[156:159]
 v_mfma_f32_16x16x32_bf16 v[144:147], v[220:223], v[180:183], v[144:147]
 v_mfma_f32_16x16x32_bf16 v[148:151], v[220:223], v[184:187], v[148:151]
 v_mfma_f32_16x16x32_bf16 v[152:155], v[220:223], v[188:191], v[152:155]
 v_mfma_f32_16x16x32_bf16 v[156:159], v[220:223], v[192:195], v[156:159]
 v_mfma_f32_16x16x32_bf16 v[144:147], v[224:227], v[176:179], v[144:147]
 v_mfma_f32_16x16x32_bf16 v[148:151], v[224:227], v[180:183], v[148:151]
 v_mfma_f32_16x16x32_bf16 v[152:155], v[224:227], v[184:187], v[152:155]
 v_mfma_f32_16x16x32_bf16 v[156:159], v[224:227], v[188:191], v[156:159]
 v_mfma_f32_16x16x32_bf16 v[148:151], v[228:231], v[176:179], v[148:151]
 v_mfma_f32_16x16x32_bf16 v[152:155], v[228:231], v[180:183], v[152:155]
 v_mfma_f32_16x16x32_bf16 v[156:159], v[228:231], v[184:187], v[156:159]
 v_mfma_f32_16x16x32_bf16 v[152:155], v[232:235], v[176:179], v[152:155]
 v_mfma_f32_16x16x32_bf16 v[156:159], v[232:235], v[180:183], v[156:159]
 v_mfma_f32_16x16x32_bf16 v[156:159], v[236:239], v[176:179], v[156:159]
 s_waitcnt lgkmcnt(0)
 v_and_b32 v64, 0xffff0000, v33
 v_lshlrev_b32 v65, 16, v33
 v_and_b32 v66, 0xffff0000, v32
 v_lshlrev_b32 v67, 16, v32
 v_mul_f32 v64, v64, v12
 v_mul_f32 v65, v65, v12
 v_mul_f32 v66, v66, v12
 v_mul_f32 v67, v67, v12
 v_and_b32 v68, 0xffff0000, v35
 v_lshlrev_b32 v69, 16, v35
 v_and_b32 v70, 0xffff0000, v34
 v_lshlrev_b32 v71, 16, v34
 v_mul_f32 v68, v68, v12
 v_mul_f32 v69, v69, v12
 v_mul_f32 v70, v70, v12
 v_mul_f32 v71, v71, v12
 v_and_b32 v72, 0xffff0000, v37
 v_lshlrev_b32 v73, 16, v37
 v_and_b32 v74, 0xffff0000, v36
 v_lshlrev_b32 v75, 16, v36
 v_mul_f32 v72, v72, v12
 v_mul_f32 v73, v73, v12
 v_mul_f32 v74, v74, v12
 v_mul_f32 v75, v75, v12
 v_and_b32 v76, 0xffff0000, v39
 v_lshlrev_b32 v77, 16, v39
 v_and_b32 v78, 0xffff0000, v38
 v_lshlrev_b32 v79, 16, v38
 v_mul_f32 v76, v76, v12
 v_mul_f32 v77, v77, v12
 v_mul_f32 v78, v78, v12
 v_mul_f32 v79, v79, v12
 v_cvt_pk_bf16_f32 v8, v64, v65
 v_lshlrev_b32 v64, 16, v8
 v_and_b32 v65, 0xffff0000, v8
 v_cvt_pk_bf16_f32 v8, v66, v67
 v_lshlrev_b32 v66, 16, v8
 v_and_b32 v67, 0xffff0000, v8
 v_cvt_pk_bf16_f32 v8, v68, v69
 v_lshlrev_b32 v68, 16, v8
 v_and_b32 v69, 0xffff0000, v8
 v_cvt_pk_bf16_f32 v8, v70, v71
 v_lshlrev_b32 v70, 16, v8
 v_and_b32 v71, 0xffff0000, v8
 v_cvt_pk_bf16_f32 v8, v72, v73
 v_lshlrev_b32 v72, 16, v8
 v_and_b32 v73, 0xffff0000, v8
 v_cvt_pk_bf16_f32 v8, v74, v75
 v_lshlrev_b32 v74, 16, v8
 v_and_b32 v75, 0xffff0000, v8
 v_cvt_pk_bf16_f32 v8, v76, v77
 v_lshlrev_b32 v76, 16, v8
 v_and_b32 v77, 0xffff0000, v8
 v_cvt_pk_bf16_f32 v8, v78, v79
 v_lshlrev_b32 v78, 16, v8
 v_and_b32 v79, 0xffff0000, v8
 v_cvt_pk_bf16_f32 v8, v144, v145
 v_lshlrev_b32 v144, 16, v8
 v_and_b32 v145, 0xffff0000, v8
 v_cvt_pk_bf16_f32 v8, v146, v147
 v_lshlrev_b32 v146, 16, v8
 v_and_b32 v147, 0xffff0000, v8
 v_cvt_pk_bf16_f32 v8, v148, v149
 v_lshlrev_b32 v148, 16, v8
 v_and_b32 v149, 0xffff0000, v8
 v_cvt_pk_bf16_f32 v8, v150, v151
 v_lshlrev_b32 v150, 16, v8
 v_and_b32 v151, 0xffff0000, v8
 v_cvt_pk_bf16_f32 v8, v152, v153
 v_lshlrev_b32 v152, 16, v8
 v_and_b32 v153, 0xffff0000, v8
 v_cvt_pk_bf16_f32 v8, v154, v155
 v_lshlrev_b32 v154, 16, v8
 v_and_b32 v155, 0xffff0000, v8
 v_cvt_pk_bf16_f32 v8, v156, v157
 v_lshlrev_b32 v156, 16, v8
 v_and_b32 v157, 0xffff0000, v8
 v_cvt_pk_bf16_f32 v8, v158, v159
 v_lshlrev_b32 v158, 16, v8
 v_and_b32 v159, 0xffff0000, v8
 v_pk_add_f32 v[144:145], v[144:145], v[64:65]
 v_pk_add_f32 v[146:147], v[146:147], v[66:67]
 v_pk_add_f32 v[148:149], v[148:149], v[68:69]
 v_pk_add_f32 v[150:151], v[150:151], v[70:71]
 v_pk_add_f32 v[152:153], v[152:153], v[72:73]
 v_pk_add_f32 v[154:155], v[154:155], v[74:75]
 v_pk_add_f32 v[156:157], v[156:157], v[76:77]
 v_pk_add_f32 v[158:159], v[158:159], v[78:79]
 v_cvt_pk_bf16_f32 v160, v144, v148
 v_cvt_pk_bf16_f32 v161, v152, v156
 buffer_store_dwordx2 v[160:161], v13, s[4:7], s72 offen sc1
 s_add_u32 s72, s72, 40960
 v_cvt_pk_bf16_f32 v162, v145, v149
 v_cvt_pk_bf16_f32 v163, v153, v157
 buffer_store_dwordx2 v[162:163], v13, s[4:7], s72 offen sc1
 s_add_u32 s72, s72, 40960
 v_cvt_pk_bf16_f32 v164, v146, v150
 v_cvt_pk_bf16_f32 v165, v154, v158
 buffer_store_dwordx2 v[164:165], v13, s[4:7], s72 offen sc1
 s_add_u32 s72, s72, 40960
 v_cvt_pk_bf16_f32 v166, v147, v151
 v_cvt_pk_bf16_f32 v167, v155, v159
 buffer_store_dwordx2 v[166:167], v13, s[4:7], s72 offen sc1
 s_add_u32 s72, s72, 40960
 s_cmp_lt_u32 s70, 640
 s_cbranch_scc1 L_cv_5
 s_setpc_b64 s[76:77]
L_helper:
 s_lshl_b32 s60, s82, 2
 s_add_u32 s60, s60, s50
 s_mov_b32 s72, s60
 s_mov_b32 s8, s16
 s_and_b32 s9, s17, 0xffff
 s_mov_b32 s10, 2621440
 s_mov_b32 s11, 0x00020000
 v_lshlrev_b32 v1, 4, v0
 v_lshlrev_b32 v2, 3, v0
 v_cmp_lt_u32 vcc, 31, v0
 v_mov_b32 v3, 268435456
 s_nop 1
 v_cndmask_b32 v7, v2, v3, vcc
 s_mov_b32 s63, 0x3acccccd
 s_mov_b32 s68, 0x3727c5ac
 s_add_u32 s3, s72, 0
 s_mul_i32 s3, s3, 1280
 buffer_load_dwordx2 v[48:49], v2, s[8:11], s3 offen offset:0
 buffer_load_dwordx2 v[50:51], v2, s[8:11], s3 offen offset:512
 buffer_load_dwordx2 v[52:53], v7, s[8:11], s3 offen offset:1024
 v_mov_b32 v12, 0
 v_mov_b32 v13, 0
 v_mov_b32 v14, 0
 v_mov_b32 v15, 0
 s_lshl_b32 s73, s60, 10
 s_add_u32 s73, s73, 0
L_cl_6:
 s_cmp_ge_u32 s73, 225280
 s_cbranch_scc1 L_cle_7
 buffer_store_dwordx4 v[12:15], v1, s[4:7], s73 offen sc1
 s_add_u32 s73, s73, 393216
 s_branch L_cl_6
L_cle_7:
 s_nop 1
 s_waitcnt vmcnt(0)
L_ln_8:
 v_lshlrev_b32 v12, 16, v48
 v_and_b32 v13, 0xffff0000, v48
 v_lshlrev_b32 v14, 16, v49
 v_and_b32 v15, 0xffff0000, v49
 v_lshlrev_b32 v16, 16, v50
 v_and_b32 v17, 0xffff0000, v50
 v_lshlrev_b32 v18, 16, v51
 v_and_b32 v19, 0xffff0000, v51
 v_lshlrev_b32 v20, 16, v52
 v_and_b32 v21, 0xffff0000, v52
 v_lshlrev_b32 v22, 16, v53
 v_and_b32 v23, 0xffff0000, v53
 s_and_b32 s3, s72, 15
 v_lshrrev_b32 v4, 3, v0
 v_lshlrev_b32 v4, 2, v4
 v_and_b32 v9, 3, v0
 v_add_u32 v4, v4, v9
 v_xor_b32 v4, s3, v4
 v_lshlrev_b32 v4, 4, v4
 v_and_b32 v9, 4, v0
 v_lshl_add_u32 v4, v9, 1, v4
 v_cndmask_b32 v8, v4, v3, vcc
 v_readfirstlane_b32 s3, v12
 s_nop 1
 v_subrev_f32 v36, s3, v12
 v_subrev_f32 v37, s3, v13
 v_subrev_f32 v38, s3, v14
 v_subrev_f32 v39, s3, v15
 v_subrev_f32 v40, s3, v16
 v_subrev_f32 v41, s3, v17
 v_subrev_f32 v42, s3, v18
 v_subrev_f32 v43, s3, v19
 v_mov_b32 v44, 0
 v_mov_b32 v45, 0
 v_mov_b32 v46, 0
 v_mov_b32 v47, 0
 s_mov_b32 exec_hi, 0
 v_subrev_f32 v44, s3, v20
 v_subrev_f32 v45, s3, v21
 v_subrev_f32 v46, s3, v22
 v_subrev_f32 v47, s3, v23
 s_mov_b32 exec_hi, -1
 v_pk_mul_f32 v[10:11], v[36:37], v[36:37]
 v_pk_fma_f32 v[10:11], v[38:39], v[38:39], v[10:11]
 v_pk_fma_f32 v[10:11], v[40:41], v[40:41], v[10:11]
 v_pk_fma_f32 v[10:11], v[42:43], v[42:43], v[10:11]
 v_pk_fma_f32 v[10:11], v[44:45], v[44:45], v[10:11]
 v_pk_fma_f32 v[10:11], v[46:47], v[46:47], v[10:11]
 v_pk_add_f32 v[36:37], v[36:37], v[38:39]
 v_pk_add_f32 v[36:37], v[36:37], v[40:41]
 v_pk_add_f32 v[36:37], v[36:37], v[42:43]
 v_pk_add_f32 v[36:37], v[36:37], v[44:45]
 v_pk_add_f32 v[36:37], v[36:37], v[46:47]
 v_add_f32 v11, v10, v11
 v_add_f32 v10, v36, v37
 s_nop 0
 v_add_f32_dpp v11, v11, v11 quad_perm:[1,0,3,2] row_mask:0xf bank_mask:0xf
 v_add_f32_dpp v10, v10, v10 quad_perm:[1,0,3,2] row_mask:0xf bank_mask:0xf
 s_nop 0
 v_add_f32_dpp v11, v11, v11 quad_perm:[2,3,0,1] row_mask:0xf bank_mask:0xf
 v_add_f32_dpp v10, v10, v10 quad_perm:[2,3,0,1] row_mask:0xf bank_mask:0xf
 s_nop 0
 v_add_f32_dpp v11, v11, v11 row_half_mirror row_mask:0xf bank_mask:0xf
 v_add_f32_dpp v10, v10, v10 row_half_mirror row_mask:0xf bank_mask:0xf
 s_nop 0
 v_add_f32_dpp v11, v11, v11 row_mirror row_mask:0xf bank_mask:0xf
 v_add_f32_dpp v10, v10, v10 row_mirror row_mask:0xf bank_mask:0xf
 v_mov_b32 v37, v11
 v_mov_b32 v36, v10
 s_nop 0
 v_permlane16_swap_b32 v11, v37
 v_permlane16_swap_b32 v10, v36
 v_pk_add_f32 v[10:11], v[10:11], v[36:37]
 v_mov_b32 v37, v11
 v_mov_b32 v36, v10
 s_nop 0
 v_permlane32_swap_b32 v11, v37
 v_permlane32_swap_b32 v10, v36
 v_pk_add_f32 v[10:11], v[10:11], v[36:37]
 v_mul_f32 v10, s63, v10
 v_mul_f32 v11, s63, v11
 v_fma_f32 v11, -v10, v10, v11
 v_max_f32 v11, 0, v11
 v_add_f32 v10, s3, v10
 v_cvt_pk_bf16_f32 v9, v10, v11
 v_lshlrev_b32 v10, 16, v9
 v_and_b32 v11, 0xffff0000, v9
 v_add_f32 v11, s68, v11
 v_cvt_pk_bf16_f32 v11, v11, v11
 v_and_b32 v11, 0xffff0000, v11
 v_sqrt_f32 v11, v11
 s_nop 0
 v_pk_add_f32 v[36:37], v[12:13], v[10:11] op_sel_hi:[1,0] neg_lo:[0,1] neg_hi:[0,1]
 v_pk_add_f32 v[38:39], v[14:15], v[10:11] op_sel_hi:[1,0] neg_lo:[0,1] neg_hi:[0,1]
 v_pk_add_f32 v[40:41], v[16:17], v[10:11] op_sel_hi:[1,0] neg_lo:[0,1] neg_hi:[0,1]
 v_pk_add_f32 v[42:43], v[18:19], v[10:11] op_sel_hi:[1,0] neg_lo:[0,1] neg_hi:[0,1]
 v_pk_add_f32 v[44:45], v[20:21], v[10:11] op_sel_hi:[1,0] neg_lo:[0,1] neg_hi:[0,1]
 v_pk_add_f32 v[46:47], v[22:23], v[10:11] op_sel_hi:[1,0] neg_lo:[0,1] neg_hi:[0,1]
 v_cvt_pk_bf16_f32 v11, v11, v11
 v_and_b32 v11, 0xffff0000, v11
 v_rcp_f32 v11, v11
 v_cvt_pk_bf16_f32 v9, v36, v37
 v_lshlrev_b32 v36, 16, v9
 v_and_b32 v37, 0xffff0000, v9
 v_cvt_pk_bf16_f32 v9, v38, v39
 v_lshlrev_b32 v38, 16, v9
 v_and_b32 v39, 0xffff0000, v9
 v_cvt_pk_bf16_f32 v9, v40, v41
 v_lshlrev_b32 v40, 16, v9
 v_and_b32 v41, 0xffff0000, v9
 v_cvt_pk_bf16_f32 v9, v42, v43
 v_lshlrev_b32 v42, 16, v9
 v_and_b32 v43, 0xffff0000, v9
 v_cvt_pk_bf16_f32 v9, v44, v45
 v_lshlrev_b32 v44, 16, v9
 v_and_b32 v45, 0xffff0000, v9
 v_cvt_pk_bf16_f32 v9, v46, v47
 v_lshlrev_b32 v46, 16, v9
 v_and_b32 v47, 0xffff0000, v9
 v_pk_mul_f32 v[36:37], v[36:37], v[10:11] op_sel:[0,1] op_sel_hi:[1,1]
 v_pk_mul_f32 v[38:39], v[38:39], v[10:11] op_sel:[0,1] op_sel_hi:[1,1]
 v_pk_mul_f32 v[40:41], v[40:41], v[10:11] op_sel:[0,1] op_sel_hi:[1,1]
 v_pk_mul_f32 v[42:43], v[42:43], v[10:11] op_sel:[0,1] op_sel_hi:[1,1]
 v_pk_mul_f32 v[44:45], v[44:45], v[10:11] op_sel:[0,1] op_sel_hi:[1,1]
 v_pk_mul_f32 v[46:47], v[46:47], v[10:11] op_sel:[0,1] op_sel_hi:[1,1]
 v_cvt_pk_bf16_f32 v24, v36, v37
 v_cvt_pk_bf16_f32 v25, v38, v39
 v_cvt_pk_bf16_f32 v26, v40, v41
 v_cvt_pk_bf16_f32 v27, v42, v43
 v_cvt_pk_bf16_f32 v28, v44, v45
 v_cvt_pk_bf16_f32 v29, v46, v47
 s_mul_i32 s3, s72, 1280
 s_add_u32 s3, s3, 226492416
 buffer_store_dwordx2 v[24:25], v4, s[4:7], s3 offen offset:0 sc1
 buffer_store_dwordx2 v[26:27], v4, s[4:7], s3 offen offset:512 sc1
 buffer_store_dwordx2 v[28:29], v8, s[4:7], s3 offen offset:1024 sc1
 s_waitcnt vmcnt(0)
 s_barrier
 s_cmp_lg_u32 s50, 3
 s_cbranch_scc1 L_ar_9
 s_mov_b32 s96, s44
 s_and_b32 s97, s45, 0xffff
 s_mov_b32 s98, 256
 s_mov_b32 s99, 0x00020000
 v_mov_b32 v1, 1
 s_mov_b64 exec, 1
 buffer_atomic_add v1, off, s[96:99], 0 offset:4 sc0
 s_waitcnt vmcnt(0)
 v_cmp_eq_u32 vcc, 95, v1
 s_cbranch_vccz L_aw_10
 buffer_store_dword v1, off, s[96:99], 0 offset:132 sc1
L_aw_10:
 s_mov_b64 exec, -1
L_ar_9:
 s_cmp_lt_u32 s82, 72
 s_cbranch_scc1 L_np_11
 s_sub_u32 s60, s60, 288
 v_lshlrev_b32 v1, 4, v0
 v_mov_b32 v12, 0
 v_mov_b32 v13, 0
 v_mov_b32 v14, 0
 v_mov_b32 v15, 0
 s_lshl_b32 s73, s60, 10
 s_add_u32 s73, s73, 225280
L_cl_12:
 s_cmp_ge_u32 s73, 880640
 s_cbranch_scc1 L_cle_13
 buffer_store_dwordx4 v[12:15], v1, s[4:7], s73 offen sc1
 s_add_u32 s73, s73, 98304
 s_branch L_cl_12
L_cle_13:
 s_nop 1
 v_mov_b32 v12, -1
 v_mov_b32 v13, -1
 v_mov_b32 v14, -1
 v_mov_b32 v15, -1
 s_lshl_b32 s73, s60, 10
 s_add_u32 s73, s73, 917504
L_cl_14:
 s_cmp_ge_u32 s73, 3145728
 s_cbranch_scc1 L_cle_15
 buffer_store_dwordx4 v[12:15], v1, s[4:7], s73 offen sc1
 s_add_u32 s73, s73, 98304
 s_branch L_cl_14
L_cle_15:
 s_nop 1
 s_waitcnt vmcnt(28)
 s_waitcnt vmcnt(0)
 s_barrier
 s_cmp_lg_u32 s50, 3
 s_cbranch_scc1 L_ar_16
 s_mov_b32 s96, s44
 s_and_b32 s97, s45, 0xffff
 s_mov_b32 s98, 256
 s_mov_b32 s99, 0x00020000
 v_mov_b32 v1, 1
 s_mov_b64 exec, 1
 buffer_atomic_add v1, off, s[96:99], 0 offset:84 sc0
 s_waitcnt vmcnt(0)
 v_cmp_eq_u32 vcc, 23, v1
 s_cbranch_vccz L_aw_17
 buffer_store_dword v1, off, s[96:99], 0 offset:212 sc1
L_aw_17:
 s_mov_b64 exec, -1
L_ar_16:
 s_add_u32 s60, s60, 288
 s_cmp_lt_u32 s82, 80
 s_cbranch_scc1 L_np_11
 s_add_u32 s72, s60, 64
 s_mov_b32 s8, s16
 s_and_b32 s9, s17, 0xffff
 s_mov_b32 s10, 2621440
 s_mov_b32 s11, 0x00020000
 v_lshlrev_b32 v1, 4, v0
 v_lshlrev_b32 v2, 3, v0
 v_cmp_lt_u32 vcc, 31, v0
 v_mov_b32 v3, 268435456
 s_nop 1
 v_cndmask_b32 v7, v2, v3, vcc
 s_mov_b32 s63, 0x3acccccd
 s_mov_b32 s68, 0x3727c5ac
 s_add_u32 s3, s72, 0
 s_mul_i32 s3, s3, 1280
 buffer_load_dwordx2 v[48:49], v2, s[8:11], s3 offen offset:0
 buffer_load_dwordx2 v[50:51], v2, s[8:11], s3 offen offset:512
 buffer_load_dwordx2 v[52:53], v7, s[8:11], s3 offen offset:1024
 s_waitcnt vmcnt(0)
L_ln_18:
 v_lshlrev_b32 v12, 16, v48
 v_and_b32 v13, 0xffff0000, v48
 v_lshlrev_b32 v14, 16, v49
 v_and_b32 v15, 0xffff0000, v49
 v_lshlrev_b32 v16, 16, v50
 v_and_b32 v17, 0xffff0000, v50
 v_lshlrev_b32 v18, 16, v51
 v_and_b32 v19, 0xffff0000, v51
 v_lshlrev_b32 v20, 16, v52
 v_and_b32 v21, 0xffff0000, v52
 v_lshlrev_b32 v22, 16, v53
 v_and_b32 v23, 0xffff0000, v53
 s_add_u32 s3, s72, 64
 s_mul_i32 s3, s3, 1280
 buffer_load_dwordx2 v[48:49], v2, s[8:11], s3 offen offset:0
 buffer_load_dwordx2 v[50:51], v2, s[8:11], s3 offen offset:512
 buffer_load_dwordx2 v[52:53], v7, s[8:11], s3 offen offset:1024
 s_and_b32 s3, s72, 15
 v_lshrrev_b32 v4, 3, v0
 v_lshlrev_b32 v4, 2, v4
 v_and_b32 v9, 3, v0
 v_add_u32 v4, v4, v9
 v_xor_b32 v4, s3, v4
 v_lshlrev_b32 v4, 4, v4
 v_and_b32 v9, 4, v0
 v_lshl_add_u32 v4, v9, 1, v4
 v_cndmask_b32 v8, v4, v3, vcc
 v_readfirstlane_b32 s3, v12
 s_nop 1
 v_subrev_f32 v36, s3, v12
 v_subrev_f32 v37, s3, v13
 v_subrev_f32 v38, s3, v14
 v_subrev_f32 v39, s3, v15
 v_subrev_f32 v40, s3, v16
 v_subrev_f32 v41, s3, v17
 v_subrev_f32 v42, s3, v18
 v_subrev_f32 v43, s3, v19
 v_mov_b32 v44, 0
 v_mov_b32 v45, 0
 v_mov_b32 v46, 0
 v_mov_b32 v47, 0
 s_mov_b32 exec_hi, 0
 v_subrev_f32 v44, s3, v20
 v_subrev_f32 v45, s3, v21
 v_subrev_f32 v46, s3, v22
 v_subrev_f32 v47, s3, v23
 s_mov_b32 exec_hi, -1
 v_pk_mul_f32 v[10:11], v[36:37], v[36:37]
 v_pk_fma_f32 v[10:11], v[38:39], v[38:39], v[10:11]
 v_pk_fma_f32 v[10:11], v[40:41], v[40:41], v[10:11]
 v_pk_fma_f32 v[10:11], v[42:43], v[42:43], v[10:11]
 v_pk_fma_f32 v[10:11], v[44:45], v[44:45], v[10:11]
 v_pk_fma_f32 v[10:11], v[46:47], v[46:47], v[10:11]
 v_pk_add_f32 v[36:37], v[36:37], v[38:39]
 v_pk_add_f32 v[36:37], v[36:37], v[40:41]
 v_pk_add_f32 v[36:37], v[36:37], v[42:43]
 v_pk_add_f32 v[36:37], v[36:37], v[44:45]
 v_pk_add_f32 v[36:37], v[36:37], v[46:47]
 v_add_f32 v11, v10, v11
 v_add_f32 v10, v36, v37
 s_nop 0
 v_add_f32_dpp v11, v11, v11 quad_perm:[1,0,3,2] row_mask:0xf bank_mask:0xf
 v_add_f32_dpp v10, v10, v10 quad_perm:[1,0,3,2] row_mask:0xf bank_mask:0xf
 s_nop 0
 v_add_f32_dpp v11, v11, v11 quad_perm:[2,3,0,1] row_mask:0xf bank_mask:0xf
 v_add_f32_dpp v10, v10, v10 quad_perm:[2,3,0,1] row_mask:0xf bank_mask:0xf
 s_nop 0
 v_add_f32_dpp v11, v11, v11 row_half_mirror row_mask:0xf bank_mask:0xf
 v_add_f32_dpp v10, v10, v10 row_half_mirror row_mask:0xf bank_mask:0xf
 s_nop 0
 v_add_f32_dpp v11, v11, v11 row_mirror row_mask:0xf bank_mask:0xf
 v_add_f32_dpp v10, v10, v10 row_mirror row_mask:0xf bank_mask:0xf
 v_mov_b32 v37, v11
 v_mov_b32 v36, v10
 s_nop 0
 v_permlane16_swap_b32 v11, v37
 v_permlane16_swap_b32 v10, v36
 v_pk_add_f32 v[10:11], v[10:11], v[36:37]
 v_mov_b32 v37, v11
 v_mov_b32 v36, v10
 s_nop 0
 v_permlane32_swap_b32 v11, v37
 v_permlane32_swap_b32 v10, v36
 v_pk_add_f32 v[10:11], v[10:11], v[36:37]
 v_mul_f32 v10, s63, v10
 v_mul_f32 v11, s63, v11
 v_fma_f32 v11, -v10, v10, v11
 v_max_f32 v11, 0, v11
 v_add_f32 v10, s3, v10
 v_cvt_pk_bf16_f32 v9, v10, v11
 v_lshlrev_b32 v10, 16, v9
 v_and_b32 v11, 0xffff0000, v9
 v_add_f32 v11, s68, v11
 v_cvt_pk_bf16_f32 v11, v11, v11
 v_and_b32 v11, 0xffff0000, v11
 v_sqrt_f32 v11, v11
 s_nop 0
 v_pk_add_f32 v[36:37], v[12:13], v[10:11] op_sel_hi:[1,0] neg_lo:[0,1] neg_hi:[0,1]
 v_pk_add_f32 v[38:39], v[14:15], v[10:11] op_sel_hi:[1,0] neg_lo:[0,1] neg_hi:[0,1]
 v_pk_add_f32 v[40:41], v[16:17], v[10:11] op_sel_hi:[1,0] neg_lo:[0,1] neg_hi:[0,1]
 v_pk_add_f32 v[42:43], v[18:19], v[10:11] op_sel_hi:[1,0] neg_lo:[0,1] neg_hi:[0,1]
 v_pk_add_f32 v[44:45], v[20:21], v[10:11] op_sel_hi:[1,0] neg_lo:[0,1] neg_hi:[0,1]
 v_pk_add_f32 v[46:47], v[22:23], v[10:11] op_sel_hi:[1,0] neg_lo:[0,1] neg_hi:[0,1]
 v_cvt_pk_bf16_f32 v11, v11, v11
 v_and_b32 v11, 0xffff0000, v11
 v_rcp_f32 v11, v11
 v_cvt_pk_bf16_f32 v9, v36, v37
 v_lshlrev_b32 v36, 16, v9
 v_and_b32 v37, 0xffff0000, v9
 v_cvt_pk_bf16_f32 v9, v38, v39
 v_lshlrev_b32 v38, 16, v9
 v_and_b32 v39, 0xffff0000, v9
 v_cvt_pk_bf16_f32 v9, v40, v41
 v_lshlrev_b32 v40, 16, v9
 v_and_b32 v41, 0xffff0000, v9
 v_cvt_pk_bf16_f32 v9, v42, v43
 v_lshlrev_b32 v42, 16, v9
 v_and_b32 v43, 0xffff0000, v9
 v_cvt_pk_bf16_f32 v9, v44, v45
 v_lshlrev_b32 v44, 16, v9
 v_and_b32 v45, 0xffff0000, v9
 v_cvt_pk_bf16_f32 v9, v46, v47
 v_lshlrev_b32 v46, 16, v9
 v_and_b32 v47, 0xffff0000, v9
 v_pk_mul_f32 v[36:37], v[36:37], v[10:11] op_sel:[0,1] op_sel_hi:[1,1]
 v_pk_mul_f32 v[38:39], v[38:39], v[10:11] op_sel:[0,1] op_sel_hi:[1,1]
 v_pk_mul_f32 v[40:41], v[40:41], v[10:11] op_sel:[0,1] op_sel_hi:[1,1]
 v_pk_mul_f32 v[42:43], v[42:43], v[10:11] op_sel:[0,1] op_sel_hi:[1,1]
 v_pk_mul_f32 v[44:45], v[44:45], v[10:11] op_sel:[0,1] op_sel_hi:[1,1]
 v_pk_mul_f32 v[46:47], v[46:47], v[10:11] op_sel:[0,1] op_sel_hi:[1,1]
 v_cvt_pk_bf16_f32 v24, v36, v37
 v_cvt_pk_bf16_f32 v25, v38, v39
 v_cvt_pk_bf16_f32 v26, v40, v41
 v_cvt_pk_bf16_f32 v27, v42, v43
 v_cvt_pk_bf16_f32 v28, v44, v45
 v_cvt_pk_bf16_f32 v29, v46, v47
 s_mul_i32 s3, s72, 1280
 s_add_u32 s3, s3, 226492416
 buffer_store_dwordx2 v[24:25], v4, s[4:7], s3 offen offset:0 sc1
 buffer_store_dwordx2 v[26:27], v4, s[4:7], s3 offen offset:512 sc1
 buffer_store_dwordx2 v[28:29], v8, s[4:7], s3 offen offset:1024 sc1
 s_add_u32 s72, s72, 64
 s_waitcnt vmcnt(3)
 s_cmp_lt_u32 s72, 1024
 s_cbranch_scc1 L_ln_18
 s_waitcnt vmcnt(0)
 s_barrier
 s_cmp_lg_u32 s50, 3
 s_cbranch_scc1 L_ar_19
 s_mov_b32 s96, s44
 s_and_b32 s97, s45, 0xffff
 s_mov_b32 s98, 256
 s_mov_b32 s99, 0x00020000
 v_mov_b32 v1, 1
 s_mov_b64 exec, 1
 buffer_atomic_add v1, off, s[96:99], 0 offset:72 sc0
 s_waitcnt vmcnt(0)
 v_cmp_eq_u32 vcc, 15, v1
 s_cbranch_vccz L_aw_20
 buffer_store_dword v1, off, s[96:99], 0 offset:200 sc1
L_aw_20:
 s_mov_b64 exec, -1
L_ar_19:
L_help_ln2:
 s_cmp_lg_u32 s50, 0
 s_cbranch_scc1 L_ww_21
 s_mov_b32 s96, s44
 s_and_b32 s97, s45, 0xffff
 s_mov_b32 s98, 256
 s_mov_b32 s99, 0x00020000
 v_mov_b32 v1, 212
 s_mov_b32 s51, 0
 s_mov_b64 exec, 1
L_wb_22:
 buffer_load_dword v2, v1, s[96:99], 0 offen sc1
 s_waitcnt vmcnt(0)
 v_cmp_eq_u32 vcc, 0, v2
 s_cbranch_vccz L_wbd_23
 s_sleep 2
 s_add_u32 s51, s51, 1
 s_cmp_lt_u32 s51, 131072
 s_cbranch_scc1 L_wb_22
 s_branch L_bail
L_wbd_23:
 s_mov_b64 exec, -1
L_ww_21:
 s_barrier
 s_branch L_help_done
L_np_11:
 s_sub_u32 s60, s60, 128
 s_cmp_eq_u32 s83, 1
 s_cbranch_scc1 L_k2_24
 s_add_u32 s3, s60, 288
 s_add_u32 s60, s60, 128
 s_cmp_eq_u32 s83, 0
 s_cselect_b32 s60, s3, s60
L_k2_24:
 s_mov_b32 s8, s32
 s_and_b32 s9, s33, 0xffff
 s_mov_b32 s10, 2621440
 s_mov_b32 s11, 0x00020000
 s_mov_b32 s12, s34
 s_and_b32 s13, s35, 0xffff
 s_mov_b32 s14, 2621440
 s_mov_b32 s15, 0x00020000
 s_mul_i32 s73, s60, 6554
 s_lshr_b32 s73, s73, 16
 s_mul_i32 s3, s73, 10
 s_sub_u32 s74, s60, s3
 s_mul_i32 s69, s73, 81920
 s_lshl_b32 s3, s74, 7
 s_add_u32 s69, s69, s3
 v_lshrrev_b32 v90, 3, v0
 s_mov_b32 s3, 10240
 v_mul_lo_u32 v91, v90, s3
 v_and_b32 v92, 7, v0
 v_lshl_add_u32 v91, v92, 4, v91
 v_add_u32 v91, s69, v91
 v_subrev_u32 v93, 3840, v91
 v_cmp_gt_i32 vcc, 0, v93
 s_nop 1
 v_cndmask_b32 v93, v93, v3, vcc
 buffer_load_dwordx4 v[100:103], v93, s[8:11], 0 offen offset:0
 buffer_load_dwordx4 v[104:107], v93, s[8:11], 0 offen offset:1280
 buffer_load_dwordx4 v[108:111], v93, s[8:11], 0 offen offset:2560
 s_mov_b32 s3, 0
 buffer_load_dwordx4 v[112:115], v91, s[8:11], s3 offen
 buffer_load_dwordx4 v[144:147], v91, s[12:15], s3 offen
 s_mov_b32 s3, 1280
 buffer_load_dwordx4 v[116:119], v91, s[8:11], s3 offen
 buffer_load_dwordx4 v[148:151], v91, s[12:15], s3 offen
 s_mov_b32 s3, 2560
 buffer_load_dwordx4 v[120:123], v91, s[8:11], s3 offen
 buffer_load_dwordx4 v[152:155], v91, s[12:15], s3 offen
 s_mov_b32 s3, 3840
 buffer_load_dwordx4 v[124:127], v91, s[8:11], s3 offen
 buffer_load_dwordx4 v[156:159], v91, s[12:15], s3 offen
 s_mov_b32 s3, 5120
 buffer_load_dwordx4 v[128:131], v91, s[8:11], s3 offen
 buffer_load_dwordx4 v[160:163], v91, s[12:15], s3 offen
 s_mov_b32 s3, 6400
 buffer_load_dwordx4 v[132:135], v91, s[8:11], s3 offen
 buffer_load_dwordx4 v[164:167], v91, s[12:15], s3 offen
 s_mov_b32 s3, 7680
 buffer_load_dwordx4 v[136:139], v91, s[8:11], s3 offen
 buffer_load_dwordx4 v[168:171], v91, s[12:15], s3 offen
 s_mov_b32 s3, 8960
 buffer_load_dwordx4 v[140:143], v91, s[8:11], s3 offen
 buffer_load_dwordx4 v[172:175], v91, s[12:15], s3 offen
 s_mov_b32 s8, s36
 s_and_b32 s9, s37, 0xffff
 s_mov_b32 s10, 5120
 s_mov_b32 s11, 0x00020000
 v_lshlrev_b32 v93, 6, v92
 s_lshl_b32 s3, s74, 9
 buffer_load_dwordx4 v[176:179], v93, s[8:11], s3 offen offset:0
 buffer_load_dwordx4 v[180:183], v93, s[8:11], s3 offen offset:16
 buffer_load_dwordx4 v[184:187], v93, s[8:11], s3 offen offset:32
 buffer_load_dwordx4 v[188:191], v93, s[8:11], s3 offen offset:48
 v_lshlrev_b32 v94, 15, v92
 v_lshl_add_u32 v94, v90, 4, v94
 s_lshl_b32 s70, s74, 18
 s_lshl_b32 s3, s73, 7
 s_add_u32 s70, s70, s3
 s_add_u32 s70, s70, 231735296
 s_waitcnt vmcnt(0)
 v_lshlrev_b32 v12, 16, v100
 v_and_b32 v13, 0xffff0000, v100
 v_lshlrev_b32 v14, 16, v104
 v_and_b32 v15, 0xffff0000, v104
 v_lshlrev_b32 v16, 16, v108
 v_and_b32 v17, 0xffff0000, v108
 v_lshlrev_b32 v18, 16, v112
 v_and_b32 v19, 0xffff0000, v112
 v_lshlrev_b32 v20, 16, v116
 v_and_b32 v21, 0xffff0000, v116
 v_lshlrev_b32 v22, 16, v120
 v_and_b32 v23, 0xffff0000, v120
 v_lshlrev_b32 v24, 16, v124
 v_and_b32 v25, 0xffff0000, v124
 v_lshlrev_b32 v26, 16, v128
 v_and_b32 v27, 0xffff0000, v128
 v_lshlrev_b32 v28, 16, v132
 v_and_b32 v29, 0xffff0000, v132
 v_lshlrev_b32 v30, 16, v136
 v_and_b32 v31, 0xffff0000, v136
 v_lshlrev_b32 v32, 16, v140
 v_and_b32 v33, 0xffff0000, v140
 v_lshlrev_b32 v68, 16, v176
 v_lshlrev_b32 v69, 16, v178
 v_and_b32 v70, 0xffff0000, v176
 v_and_b32 v71, 0xffff0000, v178
 v_lshlrev_b32 v72, 16, v177
 v_lshlrev_b32 v73, 16, v179
 v_and_b32 v74, 0xffff0000, v177
 v_and_b32 v75, 0xffff0000, v179
 v_pk_mul_f32 v[36:37], v[12:13], v[74:75]
 v_pk_mul_f32 v[38:39], v[14:15], v[74:75]
 v_pk_mul_f32 v[40:41], v[16:17], v[74:75]
 v_pk_mul_f32 v[42:43], v[18:19], v[74:75]
 v_pk_mul_f32 v[44:45], v[20:21], v[74:75]
 v_pk_mul_f32 v[46:47], v[22:23], v[74:75]
 v_pk_mul_f32 v[48:49], v[24:25], v[74:75]
 v_pk_mul_f32 v[50:51], v[26:27], v[74:75]
 v_cvt_pk_bf16_f32 v84, v36, v37
 v_lshlrev_b32 v36, 16, v84
 v_and_b32 v37, 0xffff0000, v84
 v_cvt_pk_bf16_f32 v84, v38, v39
 v_lshlrev_b32 v38, 16, v84
 v_and_b32 v39, 0xffff0000, v84
 v_cvt_pk_bf16_f32 v84, v40, v41
 v_lshlrev_b32 v40, 16, v84
 v_and_b32 v41, 0xffff0000, v84
 v_cvt_pk_bf16_f32 v84, v42, v43
 v_lshlrev_b32 v42, 16, v84
 v_and_b32 v43, 0xffff0000, v84
 v_cvt_pk_bf16_f32 v84, v44, v45
 v_lshlrev_b32 v44, 16, v84
 v_and_b32 v45, 0xffff0000, v84
 v_cvt_pk_bf16_f32 v84, v46, v47
 v_lshlrev_b32 v46, 16, v84
 v_and_b32 v47, 0xffff0000, v84
 v_cvt_pk_bf16_f32 v84, v48, v49
 v_lshlrev_b32 v48, 16, v84
 v_and_b32 v49, 0xffff0000, v84
 v_cvt_pk_bf16_f32 v84, v50, v51
 v_lshlrev_b32 v50, 16, v84
 v_and_b32 v51, 0xffff0000, v84
 v_pk_mul_f32 v[52:53], v[14:15], v[72:73]
 v_pk_mul_f32 v[54:55], v[16:17], v[72:73]
 v_pk_mul_f32 v[56:57], v[18:19], v[72:73]
 v_pk_mul_f32 v[58:59], v[20:21], v[72:73]
 v_pk_mul_f32 v[60:61], v[22:23], v[72:73]
 v_pk_mul_f32 v[62:63], v[24:25], v[72:73]
 v_pk_mul_f32 v[64:65], v[26:27], v[72:73]
 v_pk_mul_f32 v[66:67], v[28:29], v[72:73]
 v_cvt_pk_bf16_f32 v84, v52, v53
 v_lshlrev_b32 v52, 16, v84
 v_and_b32 v53, 0xffff0000, v84
 v_cvt_pk_bf16_f32 v84, v54, v55
 v_lshlrev_b32 v54, 16, v84
 v_and_b32 v55, 0xffff0000, v84
 v_cvt_pk_bf16_f32 v84, v56, v57
 v_lshlrev_b32 v56, 16, v84
 v_and_b32 v57, 0xffff0000, v84
 v_cvt_pk_bf16_f32 v84, v58, v59
 v_lshlrev_b32 v58, 16, v84
 v_and_b32 v59, 0xffff0000, v84
 v_cvt_pk_bf16_f32 v84, v60, v61
 v_lshlrev_b32 v60, 16, v84
 v_and_b32 v61, 0xffff0000, v84
 v_cvt_pk_bf16_f32 v84, v62, v63
 v_lshlrev_b32 v62, 16, v84
 v_and_b32 v63, 0xffff0000, v84
 v_cvt_pk_bf16_f32 v84, v64, v65
 v_lshlrev_b32 v64, 16, v84
 v_and_b32 v65, 0xffff0000, v84
 v_cvt_pk_bf16_f32 v84, v66, v67
 v_lshlrev_b32 v66, 16, v84
 v_and_b32 v67, 0xffff0000, v84
 v_pk_add_f32 v[36:37], v[36:37], v[52:53]
 v_pk_add_f32 v[38:39], v[38:39], v[54:55]
 v_pk_add_f32 v[40:41], v[40:41], v[56:57]
 v_pk_add_f32 v[42:43], v[42:43], v[58:59]
 v_pk_add_f32 v[44:45], v[44:45], v[60:61]
 v_pk_add_f32 v[46:47], v[46:47], v[62:63]
 v_pk_add_f32 v[48:49], v[48:49], v[64:65]
 v_pk_add_f32 v[50:51], v[50:51], v[66:67]
 v_cvt_pk_bf16_f32 v84, v36, v37
 v_lshlrev_b32 v36, 16, v84
 v_and_b32 v37, 0xffff0000, v84
 v_cvt_pk_bf16_f32 v84, v38, v39
 v_lshlrev_b32 v38, 16, v84
 v_and_b32 v39, 0xffff0000, v84
 v_cvt_pk_bf16_f32 v84, v40, v41
 v_lshlrev_b32 v40, 16, v84
 v_and_b32 v41, 0xffff0000, v84
 v_cvt_pk_bf16_f32 v84, v42, v43
 v_lshlrev_b32 v42, 16, v84
 v_and_b32 v43, 0xffff0000, v84
 v_cvt_pk_bf16_f32 v84, v44, v45
 v_lshlrev_b32 v44, 16, v84
 v_and_b32 v45, 0xffff0000, v84
 v_cvt_pk_bf16_f32 v84, v46, v47
 v_lshlrev_b32 v46, 16, v84
 v_and_b32 v47, 0xffff0000, v84
 v_cvt_pk_bf16_f32 v84, v48, v49
 v_lshlrev_b32 v48, 16, v84
 v_and_b32 v49, 0xffff0000, v84
 v_cvt_pk_bf16_f32 v84, v50, v51
 v_lshlrev_b32 v50, 16, v84
 v_and_b32 v51, 0xffff0000, v84
 v_pk_mul_f32 v[52:53], v[16:17], v[70:71]
 v_pk_mul_f32 v[54:55], v[18:19], v[70:71]
 v_pk_mul_f32 v[56:57], v[20:21], v[70:71]
 v_pk_mul_f32 v[58:59], v[22:23], v[70:71]
 v_pk_mul_f32 v[60:61], v[24:25], v[70:71]
 v_pk_mul_f32 v[62:63], v[26:27], v[70:71]
 v_pk_mul_f32 v[64:65], v[28:29], v[70:71]
 v_pk_mul_f32 v[66:67], v[30:31], v[70:71]
 v_cvt_pk_bf16_f32 v84, v52, v53
 v_lshlrev_b32 v52, 16, v84
 v_and_b32 v53, 0xffff0000, v84
 v_cvt_pk_bf16_f32 v84, v54, v55
 v_lshlrev_b32 v54, 16, v84
 v_and_b32 v55, 0xffff0000, v84
 v_cvt_pk_bf16_f32 v84, v56, v57
 v_lshlrev_b32 v56, 16, v84
 v_and_b32 v57, 0xffff0000, v84
 v_cvt_pk_bf16_f32 v84, v58, v59
 v_lshlrev_b32 v58, 16, v84
 v_and_b32 v59, 0xffff0000, v84
 v_cvt_pk_bf16_f32 v84, v60, v61
 v_lshlrev_b32 v60, 16, v84
 v_and_b32 v61, 0xffff0000, v84
 v_cvt_pk_bf16_f32 v84, v62, v63
 v_lshlrev_b32 v62, 16, v84
 v_and_b32 v63, 0xffff0000, v84
 v_cvt_pk_bf16_f32 v84, v64, v65
 v_lshlrev_b32 v64, 16, v84
 v_and_b32 v65, 0xffff0000, v84
 v_cvt_pk_bf16_f32 v84, v66, v67
 v_lshlrev_b32 v66, 16, v84
 v_and_b32 v67, 0xffff0000, v84
 v_pk_add_f32 v[36:37], v[36:37], v[52:53]
 v_pk_add_f32 v[38:39], v[38:39], v[54:55]
 v_pk_add_f32 v[40:41], v[40:41], v[56:57]
 v_pk_add_f32 v[42:43], v[42:43], v[58:59]
 v_pk_add_f32 v[44:45], v[44:45], v[60:61]
 v_pk_add_f32 v[46:47], v[46:47], v[62:63]
 v_pk_add_f32 v[48:49], v[48:49], v[64:65]
 v_pk_add_f32 v[50:51], v[50:51], v[66:67]
 v_cvt_pk_bf16_f32 v84, v36, v37
 v_lshlrev_b32 v36, 16, v84
 v_and_b32 v37, 0xffff0000, v84
 v_cvt_pk_bf16_f32 v84, v38, v39
 v_lshlrev_b32 v38, 16, v84
 v_and_b32 v39, 0xffff0000, v84
 v_cvt_pk_bf16_f32 v84, v40, v41
 v_lshlrev_b32 v40, 16, v84
 v_and_b32 v41, 0xffff0000, v84
 v_cvt_pk_bf16_f32 v84, v42, v43
 v_lshlrev_b32 v42, 16, v84
 v_and_b32 v43, 0xffff0000, v84
 v_cvt_pk_bf16_f32 v84, v44, v45
 v_lshlrev_b32 v44, 16, v84
 v_and_b32 v45, 0xffff0000, v84
 v_cvt_pk_bf16_f32 v84, v46, v47
 v_lshlrev_b32 v46, 16, v84
 v_and_b32 v47, 0xffff0000, v84
 v_cvt_pk_bf16_f32 v84, v48, v49
 v_lshlrev_b32 v48, 16, v84
 v_and_b32 v49, 0xffff0000, v84
 v_cvt_pk_bf16_f32 v84, v50, v51
 v_lshlrev_b32 v50, 16, v84
 v_and_b32 v51, 0xffff0000, v84
 v_pk_mul_f32 v[52:53], v[18:19], v[68:69]
 v_pk_mul_f32 v[54:55], v[20:21], v[68:69]
 v_pk_mul_f32 v[56:57], v[22:23], v[68:69]
 v_pk_mul_f32 v[58:59], v[24:25], v[68:69]
 v_pk_mul_f32 v[60:61], v[26:27], v[68:69]
 v_pk_mul_f32 v[62:63], v[28:29], v[68:69]
 v_pk_mul_f32 v[64:65], v[30:31], v[68:69]
 v_pk_mul_f32 v[66:67], v[32:33], v[68:69]
 v_cvt_pk_bf16_f32 v84, v52, v53
 v_lshlrev_b32 v52, 16, v84
 v_and_b32 v53, 0xffff0000, v84
 v_cvt_pk_bf16_f32 v84, v54, v55
 v_lshlrev_b32 v54, 16, v84
 v_and_b32 v55, 0xffff0000, v84
 v_cvt_pk_bf16_f32 v84, v56, v57
 v_lshlrev_b32 v56, 16, v84
 v_and_b32 v57, 0xffff0000, v84
 v_cvt_pk_bf16_f32 v84, v58, v59
 v_lshlrev_b32 v58, 16, v84
 v_and_b32 v59, 0xffff0000, v84
 v_cvt_pk_bf16_f32 v84, v60, v61
 v_lshlrev_b32 v60, 16, v84
 v_and_b32 v61, 0xffff0000, v84
 v_cvt_pk_bf16_f32 v84, v62, v63
 v_lshlrev_b32 v62, 16, v84
 v_and_b32 v63, 0xffff0000, v84
 v_cvt_pk_bf16_f32 v84, v64, v65
 v_lshlrev_b32 v64, 16, v84
 v_and_b32 v65, 0xffff0000, v84
 v_cvt_pk_bf16_f32 v84, v66, v67
 v_lshlrev_b32 v66, 16, v84
 v_and_b32 v67, 0xffff0000, v84
 v_pk_add_f32 v[36:37], v[36:37], v[52:53]
 v_pk_add_f32 v[38:39], v[38:39], v[54:55]
 v_pk_add_f32 v[40:41], v[40:41], v[56:57]
 v_pk_add_f32 v[42:43], v[42:43], v[58:59]
 v_pk_add_f32 v[44:45], v[44:45], v[60:61]
 v_pk_add_f32 v[46:47], v[46:47], v[62:63]
 v_pk_add_f32 v[48:49], v[48:49], v[64:65]
 v_pk_add_f32 v[50:51], v[50:51], v[66:67]
 v_cvt_pk_bf16_f32 v84, v36, v37
 v_lshlrev_b32 v36, 16, v84
 v_and_b32 v37, 0xffff0000, v84
 v_cvt_pk_bf16_f32 v84, v38, v39
 v_lshlrev_b32 v38, 16, v84
 v_and_b32 v39, 0xffff0000, v84
 v_cvt_pk_bf16_f32 v84, v40, v41
 v_lshlrev_b32 v40, 16, v84
 v_and_b32 v41, 0xffff0000, v84
 v_cvt_pk_bf16_f32 v84, v42, v43
 v_lshlrev_b32 v42, 16, v84
 v_and_b32 v43, 0xffff0000, v84
 v_cvt_pk_bf16_f32 v84, v44, v45
 v_lshlrev_b32 v44, 16, v84
 v_and_b32 v45, 0xffff0000, v84
 v_cvt_pk_bf16_f32 v84, v46, v47
 v_lshlrev_b32 v46, 16, v84
 v_and_b32 v47, 0xffff0000, v84
 v_cvt_pk_bf16_f32 v84, v48, v49
 v_lshlrev_b32 v48, 16, v84
 v_and_b32 v49, 0xffff0000, v84
 v_cvt_pk_bf16_f32 v84, v50, v51
 v_lshlrev_b32 v50, 16, v84
 v_and_b32 v51, 0xffff0000, v84
 v_lshlrev_b32 v12, 16, v144
 v_and_b32 v13, 0xffff0000, v144
 v_lshlrev_b32 v14, 16, v148
 v_and_b32 v15, 0xffff0000, v148
 v_lshlrev_b32 v16, 16, v152
 v_and_b32 v17, 0xffff0000, v152
 v_lshlrev_b32 v18, 16, v156
 v_and_b32 v19, 0xffff0000, v156
 v_lshlrev_b32 v20, 16, v160
 v_and_b32 v21, 0xffff0000, v160
 v_lshlrev_b32 v22, 16, v164
 v_and_b32 v23, 0xffff0000, v164
 v_lshlrev_b32 v24, 16, v168
 v_and_b32 v25, 0xffff0000, v168
 v_lshlrev_b32 v26, 16, v172
 v_and_b32 v27, 0xffff0000, v172
 v_pk_mul_f32 v[36:37], v[36:37], v[12:13]
 v_pk_mul_f32 v[38:39], v[38:39], v[14:15]
 v_pk_mul_f32 v[40:41], v[40:41], v[16:17]
 v_pk_mul_f32 v[42:43], v[42:43], v[18:19]
 v_pk_mul_f32 v[44:45], v[44:45], v[20:21]
 v_pk_mul_f32 v[46:47], v[46:47], v[22:23]
 v_pk_mul_f32 v[48:49], v[48:49], v[24:25]
 v_pk_mul_f32 v[50:51], v[50:51], v[26:27]
 v_cvt_pk_bf16_f32 v76, v50, v48
 v_cvt_pk_bf16_f32 v77, v46, v44
 v_cvt_pk_bf16_f32 v78, v42, v40
 v_cvt_pk_bf16_f32 v79, v38, v36
 s_add_u32 s3, s70, 0
 buffer_store_dwordx4 v[76:79], v94, s[4:7], s3 offen sc1
 v_cvt_pk_bf16_f32 v80, v51, v49
 v_cvt_pk_bf16_f32 v81, v47, v45
 v_cvt_pk_bf16_f32 v82, v43, v41
 v_cvt_pk_bf16_f32 v83, v39, v37
 s_add_u32 s3, s70, 4096
 buffer_store_dwordx4 v[80:83], v94, s[4:7], s3 offen sc1
 v_lshlrev_b32 v12, 16, v101
 v_and_b32 v13, 0xffff0000, v101
 v_lshlrev_b32 v14, 16, v105
 v_and_b32 v15, 0xffff0000, v105
 v_lshlrev_b32 v16, 16, v109
 v_and_b32 v17, 0xffff0000, v109
 v_lshlrev_b32 v18, 16, v113
 v_and_b32 v19, 0xffff0000, v113
 v_lshlrev_b32 v20, 16, v117
 v_and_b32 v21, 0xffff0000, v117
 v_lshlrev_b32 v22, 16, v121
 v_and_b32 v23, 0xffff0000, v121
 v_lshlrev_b32 v24, 16, v125
 v_and_b32 v25, 0xffff0000, v125
 v_lshlrev_b32 v26, 16, v129
 v_and_b32 v27, 0xffff0000, v129
 v_lshlrev_b32 v28, 16, v133
 v_and_b32 v29, 0xffff0000, v133
 v_lshlrev_b32 v30, 16, v137
 v_and_b32 v31, 0xffff0000, v137
 v_lshlrev_b32 v32, 16, v141
 v_and_b32 v33, 0xffff0000, v141
 v_lshlrev_b32 v68, 16, v180
 v_lshlrev_b32 v69, 16, v182
 v_and_b32 v70, 0xffff0000, v180
 v_and_b32 v71, 0xffff0000, v182
 v_lshlrev_b32 v72, 16, v181
 v_lshlrev_b32 v73, 16, v183
 v_and_b32 v74, 0xffff0000, v181
 v_and_b32 v75, 0xffff0000, v183
 v_pk_mul_f32 v[36:37], v[12:13], v[74:75]
 v_pk_mul_f32 v[38:39], v[14:15], v[74:75]
 v_pk_mul_f32 v[40:41], v[16:17], v[74:75]
 v_pk_mul_f32 v[42:43], v[18:19], v[74:75]
 v_pk_mul_f32 v[44:45], v[20:21], v[74:75]
 v_pk_mul_f32 v[46:47], v[22:23], v[74:75]
 v_pk_mul_f32 v[48:49], v[24:25], v[74:75]
 v_pk_mul_f32 v[50:51], v[26:27], v[74:75]
 v_cvt_pk_bf16_f32 v84, v36, v37
 v_lshlrev_b32 v36, 16, v84
 v_and_b32 v37, 0xffff0000, v84
 v_cvt_pk_bf16_f32 v84, v38, v39
 v_lshlrev_b32 v38, 16, v84
 v_and_b32 v39, 0xffff0000, v84
 v_cvt_pk_bf16_f32 v84, v40, v41
 v_lshlrev_b32 v40, 16, v84
 v_and_b32 v41, 0xffff0000, v84
 v_cvt_pk_bf16_f32 v84, v42, v43
 v_lshlrev_b32 v42, 16, v84
 v_and_b32 v43, 0xffff0000, v84
 v_cvt_pk_bf16_f32 v84, v44, v45
 v_lshlrev_b32 v44, 16, v84
 v_and_b32 v45, 0xffff0000, v84
 v_cvt_pk_bf16_f32 v84, v46, v47
 v_lshlrev_b32 v46, 16, v84
 v_and_b32 v47, 0xffff0000, v84
 v_cvt_pk_bf16_f32 v84, v48, v49
 v_lshlrev_b32 v48, 16, v84
 v_and_b32 v49, 0xffff0000, v84
 v_cvt_pk_bf16_f32 v84, v50, v51
 v_lshlrev_b32 v50, 16, v84
 v_and_b32 v51, 0xffff0000, v84
 v_pk_mul_f32 v[52:53], v[14:15], v[72:73]
 v_pk_mul_f32 v[54:55], v[16:17], v[72:73]
 v_pk_mul_f32 v[56:57], v[18:19], v[72:73]
 v_pk_mul_f32 v[58:59], v[20:21], v[72:73]
 v_pk_mul_f32 v[60:61], v[22:23], v[72:73]
 v_pk_mul_f32 v[62:63], v[24:25], v[72:73]
 v_pk_mul_f32 v[64:65], v[26:27], v[72:73]
 v_pk_mul_f32 v[66:67], v[28:29], v[72:73]
 v_cvt_pk_bf16_f32 v84, v52, v53
 v_lshlrev_b32 v52, 16, v84
 v_and_b32 v53, 0xffff0000, v84
 v_cvt_pk_bf16_f32 v84, v54, v55
 v_lshlrev_b32 v54, 16, v84
 v_and_b32 v55, 0xffff0000, v84
 v_cvt_pk_bf16_f32 v84, v56, v57
 v_lshlrev_b32 v56, 16, v84
 v_and_b32 v57, 0xffff0000, v84
 v_cvt_pk_bf16_f32 v84, v58, v59
 v_lshlrev_b32 v58, 16, v84
 v_and_b32 v59, 0xffff0000, v84
 v_cvt_pk_bf16_f32 v84, v60, v61
 v_lshlrev_b32 v60, 16, v84
 v_and_b32 v61, 0xffff0000, v84
 v_cvt_pk_bf16_f32 v84, v62, v63
 v_lshlrev_b32 v62, 16, v84
 v_and_b32 v63, 0xffff0000, v84
 v_cvt_pk_bf16_f32 v84, v64, v65
 v_lshlrev_b32 v64, 16, v84
 v_and_b32 v65, 0xffff0000, v84
 v_cvt_pk_bf16_f32 v84, v66, v67
 v_lshlrev_b32 v66, 16, v84
 v_and_b32 v67, 0xffff0000, v84
 v_pk_add_f32 v[36:37], v[36:37], v[52:53]
 v_pk_add_f32 v[38:39], v[38:39], v[54:55]
 v_pk_add_f32 v[40:41], v[40:41], v[56:57]
 v_pk_add_f32 v[42:43], v[42:43], v[58:59]
 v_pk_add_f32 v[44:45], v[44:45], v[60:61]
 v_pk_add_f32 v[46:47], v[46:47], v[62:63]
 v_pk_add_f32 v[48:49], v[48:49], v[64:65]
 v_pk_add_f32 v[50:51], v[50:51], v[66:67]
 v_cvt_pk_bf16_f32 v84, v36, v37
 v_lshlrev_b32 v36, 16, v84
 v_and_b32 v37, 0xffff0000, v84
 v_cvt_pk_bf16_f32 v84, v38, v39
 v_lshlrev_b32 v38, 16, v84
 v_and_b32 v39, 0xffff0000, v84
 v_cvt_pk_bf16_f32 v84, v40, v41
 v_lshlrev_b32 v40, 16, v84
 v_and_b32 v41, 0xffff0000, v84
 v_cvt_pk_bf16_f32 v84, v42, v43
 v_lshlrev_b32 v42, 16, v84
 v_and_b32 v43, 0xffff0000, v84
 v_cvt_pk_bf16_f32 v84, v44, v45
 v_lshlrev_b32 v44, 16, v84
 v_and_b32 v45, 0xffff0000, v84
 v_cvt_pk_bf16_f32 v84, v46, v47
 v_lshlrev_b32 v46, 16, v84
 v_and_b32 v47, 0xffff0000, v84
 v_cvt_pk_bf16_f32 v84, v48, v49
 v_lshlrev_b32 v48, 16, v84
 v_and_b32 v49, 0xffff0000, v84
 v_cvt_pk_bf16_f32 v84, v50, v51
 v_lshlrev_b32 v50, 16, v84
 v_and_b32 v51, 0xffff0000, v84
 v_pk_mul_f32 v[52:53], v[16:17], v[70:71]
 v_pk_mul_f32 v[54:55], v[18:19], v[70:71]
 v_pk_mul_f32 v[56:57], v[20:21], v[70:71]
 v_pk_mul_f32 v[58:59], v[22:23], v[70:71]
 v_pk_mul_f32 v[60:61], v[24:25], v[70:71]
 v_pk_mul_f32 v[62:63], v[26:27], v[70:71]
 v_pk_mul_f32 v[64:65], v[28:29], v[70:71]
 v_pk_mul_f32 v[66:67], v[30:31], v[70:71]
 v_cvt_pk_bf16_f32 v84, v52, v53
 v_lshlrev_b32 v52, 16, v84
 v_and_b32 v53, 0xffff0000, v84
 v_cvt_pk_bf16_f32 v84, v54, v55
 v_lshlrev_b32 v54, 16, v84
 v_and_b32 v55, 0xffff0000, v84
 v_cvt_pk_bf16_f32 v84, v56, v57
 v_lshlrev_b32 v56, 16, v84
 v_and_b32 v57, 0xffff0000, v84
 v_cvt_pk_bf16_f32 v84, v58, v59
 v_lshlrev_b32 v58, 16, v84
 v_and_b32 v59, 0xffff0000, v84
 v_cvt_pk_bf16_f32 v84, v60, v61
 v_lshlrev_b32 v60, 16, v84
 v_and_b32 v61, 0xffff0000, v84
 v_cvt_pk_bf16_f32 v84, v62, v63
 v_lshlrev_b32 v62, 16, v84
 v_and_b32 v63, 0xffff0000, v84
 v_cvt_pk_bf16_f32 v84, v64, v65
 v_lshlrev_b32 v64, 16, v84
 v_and_b32 v65, 0xffff0000, v84
 v_cvt_pk_bf16_f32 v84, v66, v67
 v_lshlrev_b32 v66, 16, v84
 v_and_b32 v67, 0xffff0000, v84
 v_pk_add_f32 v[36:37], v[36:37], v[52:53]
 v_pk_add_f32 v[38:39], v[38:39], v[54:55]
 v_pk_add_f32 v[40:41], v[40:41], v[56:57]
 v_pk_add_f32 v[42:43], v[42:43], v[58:59]
 v_pk_add_f32 v[44:45], v[44:45], v[60:61]
 v_pk_add_f32 v[46:47], v[46:47], v[62:63]
 v_pk_add_f32 v[48:49], v[48:49], v[64:65]
 v_pk_add_f32 v[50:51], v[50:51], v[66:67]
 v_cvt_pk_bf16_f32 v84, v36, v37
 v_lshlrev_b32 v36, 16, v84
 v_and_b32 v37, 0xffff0000, v84
 v_cvt_pk_bf16_f32 v84, v38, v39
 v_lshlrev_b32 v38, 16, v84
 v_and_b32 v39, 0xffff0000, v84
 v_cvt_pk_bf16_f32 v84, v40, v41
 v_lshlrev_b32 v40, 16, v84
 v_and_b32 v41, 0xffff0000, v84
 v_cvt_pk_bf16_f32 v84, v42, v43
 v_lshlrev_b32 v42, 16, v84
 v_and_b32 v43, 0xffff0000, v84
 v_cvt_pk_bf16_f32 v84, v44, v45
 v_lshlrev_b32 v44, 16, v84
 v_and_b32 v45, 0xffff0000, v84
 v_cvt_pk_bf16_f32 v84, v46, v47
 v_lshlrev_b32 v46, 16, v84
 v_and_b32 v47, 0xffff0000, v84
 v_cvt_pk_bf16_f32 v84, v48, v49
 v_lshlrev_b32 v48, 16, v84
 v_and_b32 v49, 0xffff0000, v84
 v_cvt_pk_bf16_f32 v84, v50, v51
 v_lshlrev_b32 v50, 16, v84
 v_and_b32 v51, 0xffff0000, v84
 v_pk_mul_f32 v[52:53], v[18:19], v[68:69]
 v_pk_mul_f32 v[54:55], v[20:21], v[68:69]
 v_pk_mul_f32 v[56:57], v[22:23], v[68:69]
 v_pk_mul_f32 v[58:59], v[24:25], v[68:69]
 v_pk_mul_f32 v[60:61], v[26:27], v[68:69]
 v_pk_mul_f32 v[62:63], v[28:29], v[68:69]
 v_pk_mul_f32 v[64:65], v[30:31], v[68:69]
 v_pk_mul_f32 v[66:67], v[32:33], v[68:69]
 v_cvt_pk_bf16_f32 v84, v52, v53
 v_lshlrev_b32 v52, 16, v84
 v_and_b32 v53, 0xffff0000, v84
 v_cvt_pk_bf16_f32 v84, v54, v55
 v_lshlrev_b32 v54, 16, v84
 v_and_b32 v55, 0xffff0000, v84
 v_cvt_pk_bf16_f32 v84, v56, v57
 v_lshlrev_b32 v56, 16, v84
 v_and_b32 v57, 0xffff0000, v84
 v_cvt_pk_bf16_f32 v84, v58, v59
 v_lshlrev_b32 v58, 16, v84
 v_and_b32 v59, 0xffff0000, v84
 v_cvt_pk_bf16_f32 v84, v60, v61
 v_lshlrev_b32 v60, 16, v84
 v_and_b32 v61, 0xffff0000, v84
 v_cvt_pk_bf16_f32 v84, v62, v63
 v_lshlrev_b32 v62, 16, v84
 v_and_b32 v63, 0xffff0000, v84
 v_cvt_pk_bf16_f32 v84, v64, v65
 v_lshlrev_b32 v64, 16, v84
 v_and_b32 v65, 0xffff0000, v84
 v_cvt_pk_bf16_f32 v84, v66, v67
 v_lshlrev_b32 v66, 16, v84
 v_and_b32 v67, 0xffff0000, v84
 v_pk_add_f32 v[36:37], v[36:37], v[52:53]
 v_pk_add_f32 v[38:39], v[38:39], v[54:55]
 v_pk_add_f32 v[40:41], v[40:41], v[56:57]
 v_pk_add_f32 v[42:43], v[42:43], v[58:59]
 v_pk_add_f32 v[44:45], v[44:45], v[60:61]
 v_pk_add_f32 v[46:47], v[46:47], v[62:63]
 v_pk_add_f32 v[48:49], v[48:49], v[64:65]
 v_pk_add_f32 v[50:51], v[50:51], v[66:67]
 v_cvt_pk_bf16_f32 v84, v36, v37
 v_lshlrev_b32 v36, 16, v84
 v_and_b32 v37, 0xffff0000, v84
 v_cvt_pk_bf16_f32 v84, v38, v39
 v_lshlrev_b32 v38, 16, v84
 v_and_b32 v39, 0xffff0000, v84
 v_cvt_pk_bf16_f32 v84, v40, v41
 v_lshlrev_b32 v40, 16, v84
 v_and_b32 v41, 0xffff0000, v84
 v_cvt_pk_bf16_f32 v84, v42, v43
 v_lshlrev_b32 v42, 16, v84
 v_and_b32 v43, 0xffff0000, v84
 v_cvt_pk_bf16_f32 v84, v44, v45
 v_lshlrev_b32 v44, 16, v84
 v_and_b32 v45, 0xffff0000, v84
 v_cvt_pk_bf16_f32 v84, v46, v47
 v_lshlrev_b32 v46, 16, v84
 v_and_b32 v47, 0xffff0000, v84
 v_cvt_pk_bf16_f32 v84, v48, v49
 v_lshlrev_b32 v48, 16, v84
 v_and_b32 v49, 0xffff0000, v84
 v_cvt_pk_bf16_f32 v84, v50, v51
 v_lshlrev_b32 v50, 16, v84
 v_and_b32 v51, 0xffff0000, v84
 v_lshlrev_b32 v12, 16, v145
 v_and_b32 v13, 0xffff0000, v145
 v_lshlrev_b32 v14, 16, v149
 v_and_b32 v15, 0xffff0000, v149
 v_lshlrev_b32 v16, 16, v153
 v_and_b32 v17, 0xffff0000, v153
 v_lshlrev_b32 v18, 16, v157
 v_and_b32 v19, 0xffff0000, v157
 v_lshlrev_b32 v20, 16, v161
 v_and_b32 v21, 0xffff0000, v161
 v_lshlrev_b32 v22, 16, v165
 v_and_b32 v23, 0xffff0000, v165
 v_lshlrev_b32 v24, 16, v169
 v_and_b32 v25, 0xffff0000, v169
 v_lshlrev_b32 v26, 16, v173
 v_and_b32 v27, 0xffff0000, v173
 v_pk_mul_f32 v[36:37], v[36:37], v[12:13]
 v_pk_mul_f32 v[38:39], v[38:39], v[14:15]
 v_pk_mul_f32 v[40:41], v[40:41], v[16:17]
 v_pk_mul_f32 v[42:43], v[42:43], v[18:19]
 v_pk_mul_f32 v[44:45], v[44:45], v[20:21]
 v_pk_mul_f32 v[46:47], v[46:47], v[22:23]
 v_pk_mul_f32 v[48:49], v[48:49], v[24:25]
 v_pk_mul_f32 v[50:51], v[50:51], v[26:27]
 v_cvt_pk_bf16_f32 v76, v50, v48
 v_cvt_pk_bf16_f32 v77, v46, v44
 v_cvt_pk_bf16_f32 v78, v42, v40
 v_cvt_pk_bf16_f32 v79, v38, v36
 s_add_u32 s3, s70, 8192
 buffer_store_dwordx4 v[76:79], v94, s[4:7], s3 offen sc1
 v_cvt_pk_bf16_f32 v80, v51, v49
 v_cvt_pk_bf16_f32 v81, v47, v45
 v_cvt_pk_bf16_f32 v82, v43, v41
 v_cvt_pk_bf16_f32 v83, v39, v37
 s_add_u32 s3, s70, 12288
 buffer_store_dwordx4 v[80:83], v94, s[4:7], s3 offen sc1
 v_lshlrev_b32 v12, 16, v102
 v_and_b32 v13, 0xffff0000, v102
 v_lshlrev_b32 v14, 16, v106
 v_and_b32 v15, 0xffff0000, v106
 v_lshlrev_b32 v16, 16, v110
 v_and_b32 v17, 0xffff0000, v110
 v_lshlrev_b32 v18, 16, v114
 v_and_b32 v19, 0xffff0000, v114
 v_lshlrev_b32 v20, 16, v118
 v_and_b32 v21, 0xffff0000, v118
 v_lshlrev_b32 v22, 16, v122
 v_and_b32 v23, 0xffff0000, v122
 v_lshlrev_b32 v24, 16, v126
 v_and_b32 v25, 0xffff0000, v126
 v_lshlrev_b32 v26, 16, v130
 v_and_b32 v27, 0xffff0000, v130
 v_lshlrev_b32 v28, 16, v134
 v_and_b32 v29, 0xffff0000, v134
 v_lshlrev_b32 v30, 16, v138
 v_and_b32 v31, 0xffff0000, v138
 v_lshlrev_b32 v32, 16, v142
 v_and_b32 v33, 0xffff0000, v142
 v_lshlrev_b32 v68, 16, v184
 v_lshlrev_b32 v69, 16, v186
 v_and_b32 v70, 0xffff0000, v184
 v_and_b32 v71, 0xffff0000, v186
 v_lshlrev_b32 v72, 16, v185
 v_lshlrev_b32 v73, 16, v187
 v_and_b32 v74, 0xffff0000, v185
 v_and_b32 v75, 0xffff0000, v187
 v_pk_mul_f32 v[36:37], v[12:13], v[74:75]
 v_pk_mul_f32 v[38:39], v[14:15], v[74:75]
 v_pk_mul_f32 v[40:41], v[16:17], v[74:75]
 v_pk_mul_f32 v[42:43], v[18:19], v[74:75]
 v_pk_mul_f32 v[44:45], v[20:21], v[74:75]
 v_pk_mul_f32 v[46:47], v[22:23], v[74:75]
 v_pk_mul_f32 v[48:49], v[24:25], v[74:75]
 v_pk_mul_f32 v[50:51], v[26:27], v[74:75]
 v_cvt_pk_bf16_f32 v84, v36, v37
 v_lshlrev_b32 v36, 16, v84
 v_and_b32 v37, 0xffff0000, v84
 v_cvt_pk_bf16_f32 v84, v38, v39
 v_lshlrev_b32 v38, 16, v84
 v_and_b32 v39, 0xffff0000, v84
 v_cvt_pk_bf16_f32 v84, v40, v41
 v_lshlrev_b32 v40, 16, v84
 v_and_b32 v41, 0xffff0000, v84
 v_cvt_pk_bf16_f32 v84, v42, v43
 v_lshlrev_b32 v42, 16, v84
 v_and_b32 v43, 0xffff0000, v84
 v_cvt_pk_bf16_f32 v84, v44, v45
 v_lshlrev_b32 v44, 16, v84
 v_and_b32 v45, 0xffff0000, v84
 v_cvt_pk_bf16_f32 v84, v46, v47
 v_lshlrev_b32 v46, 16, v84
 v_and_b32 v47, 0xffff0000, v84
 v_cvt_pk_bf16_f32 v84, v48, v49
 v_lshlrev_b32 v48, 16, v84
 v_and_b32 v49, 0xffff0000, v84
 v_cvt_pk_bf16_f32 v84, v50, v51
 v_lshlrev_b32 v50, 16, v84
 v_and_b32 v51, 0xffff0000, v84
 v_pk_mul_f32 v[52:53], v[14:15], v[72:73]
 v_pk_mul_f32 v[54:55], v[16:17], v[72:73]
 v_pk_mul_f32 v[56:57], v[18:19], v[72:73]
 v_pk_mul_f32 v[58:59], v[20:21], v[72:73]
 v_pk_mul_f32 v[60:61], v[22:23], v[72:73]
 v_pk_mul_f32 v[62:63], v[24:25], v[72:73]
 v_pk_mul_f32 v[64:65], v[26:27], v[72:73]
 v_pk_mul_f32 v[66:67], v[28:29], v[72:73]
 v_cvt_pk_bf16_f32 v84, v52, v53
 v_lshlrev_b32 v52, 16, v84
 v_and_b32 v53, 0xffff0000, v84
 v_cvt_pk_bf16_f32 v84, v54, v55
 v_lshlrev_b32 v54, 16, v84
 v_and_b32 v55, 0xffff0000, v84
 v_cvt_pk_bf16_f32 v84, v56, v57
 v_lshlrev_b32 v56, 16, v84
 v_and_b32 v57, 0xffff0000, v84
 v_cvt_pk_bf16_f32 v84, v58, v59
 v_lshlrev_b32 v58, 16, v84
 v_and_b32 v59, 0xffff0000, v84
 v_cvt_pk_bf16_f32 v84, v60, v61
 v_lshlrev_b32 v60, 16, v84
 v_and_b32 v61, 0xffff0000, v84
 v_cvt_pk_bf16_f32 v84, v62, v63
 v_lshlrev_b32 v62, 16, v84
 v_and_b32 v63, 0xffff0000, v84
 v_cvt_pk_bf16_f32 v84, v64, v65
 v_lshlrev_b32 v64, 16, v84
 v_and_b32 v65, 0xffff0000, v84
 v_cvt_pk_bf16_f32 v84, v66, v67
 v_lshlrev_b32 v66, 16, v84
 v_and_b32 v67, 0xffff0000, v84
 v_pk_add_f32 v[36:37], v[36:37], v[52:53]
 v_pk_add_f32 v[38:39], v[38:39], v[54:55]
 v_pk_add_f32 v[40:41], v[40:41], v[56:57]
 v_pk_add_f32 v[42:43], v[42:43], v[58:59]
 v_pk_add_f32 v[44:45], v[44:45], v[60:61]
 v_pk_add_f32 v[46:47], v[46:47], v[62:63]
 v_pk_add_f32 v[48:49], v[48:49], v[64:65]
 v_pk_add_f32 v[50:51], v[50:51], v[66:67]
 v_cvt_pk_bf16_f32 v84, v36, v37
 v_lshlrev_b32 v36, 16, v84
 v_and_b32 v37, 0xffff0000, v84
 v_cvt_pk_bf16_f32 v84, v38, v39
 v_lshlrev_b32 v38, 16, v84
 v_and_b32 v39, 0xffff0000, v84
 v_cvt_pk_bf16_f32 v84, v40, v41
 v_lshlrev_b32 v40, 16, v84
 v_and_b32 v41, 0xffff0000, v84
 v_cvt_pk_bf16_f32 v84, v42, v43
 v_lshlrev_b32 v42, 16, v84
 v_and_b32 v43, 0xffff0000, v84
 v_cvt_pk_bf16_f32 v84, v44, v45
 v_lshlrev_b32 v44, 16, v84
 v_and_b32 v45, 0xffff0000, v84
 v_cvt_pk_bf16_f32 v84, v46, v47
 v_lshlrev_b32 v46, 16, v84
 v_and_b32 v47, 0xffff0000, v84
 v_cvt_pk_bf16_f32 v84, v48, v49
 v_lshlrev_b32 v48, 16, v84
 v_and_b32 v49, 0xffff0000, v84
 v_cvt_pk_bf16_f32 v84, v50, v51
 v_lshlrev_b32 v50, 16, v84
 v_and_b32 v51, 0xffff0000, v84
 v_pk_mul_f32 v[52:53], v[16:17], v[70:71]
 v_pk_mul_f32 v[54:55], v[18:19], v[70:71]
 v_pk_mul_f32 v[56:57], v[20:21], v[70:71]
 v_pk_mul_f32 v[58:59], v[22:23], v[70:71]
 v_pk_mul_f32 v[60:61], v[24:25], v[70:71]
 v_pk_mul_f32 v[62:63], v[26:27], v[70:71]
 v_pk_mul_f32 v[64:65], v[28:29], v[70:71]
 v_pk_mul_f32 v[66:67], v[30:31], v[70:71]
 v_cvt_pk_bf16_f32 v84, v52, v53
 v_lshlrev_b32 v52, 16, v84
 v_and_b32 v53, 0xffff0000, v84
 v_cvt_pk_bf16_f32 v84, v54, v55
 v_lshlrev_b32 v54, 16, v84
 v_and_b32 v55, 0xffff0000, v84
 v_cvt_pk_bf16_f32 v84, v56, v57
 v_lshlrev_b32 v56, 16, v84
 v_and_b32 v57, 0xffff0000, v84
 v_cvt_pk_bf16_f32 v84, v58, v59
 v_lshlrev_b32 v58, 16, v84
 v_and_b32 v59, 0xffff0000, v84
 v_cvt_pk_bf16_f32 v84, v60, v61
 v_lshlrev_b32 v60, 16, v84
 v_and_b32 v61, 0xffff0000, v84
 v_cvt_pk_bf16_f32 v84, v62, v63
 v_lshlrev_b32 v62, 16, v84
 v_and_b32 v63, 0xffff0000, v84
 v_cvt_pk_bf16_f32 v84, v64, v65
 v_lshlrev_b32 v64, 16, v84
 v_and_b32 v65, 0xffff0000, v84
 v_cvt_pk_bf16_f32 v84, v66, v67
 v_lshlrev_b32 v66, 16, v84
 v_and_b32 v67, 0xffff0000, v84
 v_pk_add_f32 v[36:37], v[36:37], v[52:53]
 v_pk_add_f32 v[38:39], v[38:39], v[54:55]
 v_pk_add_f32 v[40:41], v[40:41], v[56:57]
 v_pk_add_f32 v[42:43], v[42:43], v[58:59]
 v_pk_add_f32 v[44:45], v[44:45], v[60:61]
 v_pk_add_f32 v[46:47], v[46:47], v[62:63]
 v_pk_add_f32 v[48:49], v[48:49], v[64:65]
 v_pk_add_f32 v[50:51], v[50:51], v[66:67]
 v_cvt_pk_bf16_f32 v84, v36, v37
 v_lshlrev_b32 v36, 16, v84
 v_and_b32 v37, 0xffff0000, v84
 v_cvt_pk_bf16_f32 v84, v38, v39
 v_lshlrev_b32 v38, 16, v84
 v_and_b32 v39, 0xffff0000, v84
 v_cvt_pk_bf16_f32 v84, v40, v41
 v_lshlrev_b32 v40, 16, v84
 v_and_b32 v41, 0xffff0000, v84
 v_cvt_pk_bf16_f32 v84, v42, v43
 v_lshlrev_b32 v42, 16, v84
 v_and_b32 v43, 0xffff0000, v84
 v_cvt_pk_bf16_f32 v84, v44, v45
 v_lshlrev_b32 v44, 16, v84
 v_and_b32 v45, 0xffff0000, v84
 v_cvt_pk_bf16_f32 v84, v46, v47
 v_lshlrev_b32 v46, 16, v84
 v_and_b32 v47, 0xffff0000, v84
 v_cvt_pk_bf16_f32 v84, v48, v49
 v_lshlrev_b32 v48, 16, v84
 v_and_b32 v49, 0xffff0000, v84
 v_cvt_pk_bf16_f32 v84, v50, v51
 v_lshlrev_b32 v50, 16, v84
 v_and_b32 v51, 0xffff0000, v84
 v_pk_mul_f32 v[52:53], v[18:19], v[68:69]
 v_pk_mul_f32 v[54:55], v[20:21], v[68:69]
 v_pk_mul_f32 v[56:57], v[22:23], v[68:69]
 v_pk_mul_f32 v[58:59], v[24:25], v[68:69]
 v_pk_mul_f32 v[60:61], v[26:27], v[68:69]
 v_pk_mul_f32 v[62:63], v[28:29], v[68:69]
 v_pk_mul_f32 v[64:65], v[30:31], v[68:69]
 v_pk_mul_f32 v[66:67], v[32:33], v[68:69]
 v_cvt_pk_bf16_f32 v84, v52, v53
 v_lshlrev_b32 v52, 16, v84
 v_and_b32 v53, 0xffff0000, v84
 v_cvt_pk_bf16_f32 v84, v54, v55
 v_lshlrev_b32 v54, 16, v84
 v_and_b32 v55, 0xffff0000, v84
 v_cvt_pk_bf16_f32 v84, v56, v57
 v_lshlrev_b32 v56, 16, v84
 v_and_b32 v57, 0xffff0000, v84
 v_cvt_pk_bf16_f32 v84, v58, v59
 v_lshlrev_b32 v58, 16, v84
 v_and_b32 v59, 0xffff0000, v84
 v_cvt_pk_bf16_f32 v84, v60, v61
 v_lshlrev_b32 v60, 16, v84
 v_and_b32 v61, 0xffff0000, v84
 v_cvt_pk_bf16_f32 v84, v62, v63
 v_lshlrev_b32 v62, 16, v84
 v_and_b32 v63, 0xffff0000, v84
 v_cvt_pk_bf16_f32 v84, v64, v65
 v_lshlrev_b32 v64, 16, v84
 v_and_b32 v65, 0xffff0000, v84
 v_cvt_pk_bf16_f32 v84, v66, v67
 v_lshlrev_b32 v66, 16, v84
 v_and_b32 v67, 0xffff0000, v84
 v_pk_add_f32 v[36:37], v[36:37], v[52:53]
 v_pk_add_f32 v[38:39], v[38:39], v[54:55]
 v_pk_add_f32 v[40:41], v[40:41], v[56:57]
 v_pk_add_f32 v[42:43], v[42:43], v[58:59]
 v_pk_add_f32 v[44:45], v[44:45], v[60:61]
 v_pk_add_f32 v[46:47], v[46:47], v[62:63]
 v_pk_add_f32 v[48:49], v[48:49], v[64:65]
 v_pk_add_f32 v[50:51], v[50:51], v[66:67]
 v_cvt_pk_bf16_f32 v84, v36, v37
 v_lshlrev_b32 v36, 16, v84
 v_and_b32 v37, 0xffff0000, v84
 v_cvt_pk_bf16_f32 v84, v38, v39
 v_lshlrev_b32 v38, 16, v84
 v_and_b32 v39, 0xffff0000, v84
 v_cvt_pk_bf16_f32 v84, v40, v41
 v_lshlrev_b32 v40, 16, v84
 v_and_b32 v41, 0xffff0000, v84
 v_cvt_pk_bf16_f32 v84, v42, v43
 v_lshlrev_b32 v42, 16, v84
 v_and_b32 v43, 0xffff0000, v84
 v_cvt_pk_bf16_f32 v84, v44, v45
 v_lshlrev_b32 v44, 16, v84
 v_and_b32 v45, 0xffff0000, v84
 v_cvt_pk_bf16_f32 v84, v46, v47
 v_lshlrev_b32 v46, 16, v84
 v_and_b32 v47, 0xffff0000, v84
 v_cvt_pk_bf16_f32 v84, v48, v49
 v_lshlrev_b32 v48, 16, v84
 v_and_b32 v49, 0xffff0000, v84
 v_cvt_pk_bf16_f32 v84, v50, v51
 v_lshlrev_b32 v50, 16, v84
 v_and_b32 v51, 0xffff0000, v84
 v_lshlrev_b32 v12, 16, v146
 v_and_b32 v13, 0xffff0000, v146
 v_lshlrev_b32 v14, 16, v150
 v_and_b32 v15, 0xffff0000, v150
 v_lshlrev_b32 v16, 16, v154
 v_and_b32 v17, 0xffff0000, v154
 v_lshlrev_b32 v18, 16, v158
 v_and_b32 v19, 0xffff0000, v158
 v_lshlrev_b32 v20, 16, v162
 v_and_b32 v21, 0xffff0000, v162
 v_lshlrev_b32 v22, 16, v166
 v_and_b32 v23, 0xffff0000, v166
 v_lshlrev_b32 v24, 16, v170
 v_and_b32 v25, 0xffff0000, v170
 v_lshlrev_b32 v26, 16, v174
 v_and_b32 v27, 0xffff0000, v174
 v_pk_mul_f32 v[36:37], v[36:37], v[12:13]
 v_pk_mul_f32 v[38:39], v[38:39], v[14:15]
 v_pk_mul_f32 v[40:41], v[40:41], v[16:17]
 v_pk_mul_f32 v[42:43], v[42:43], v[18:19]
 v_pk_mul_f32 v[44:45], v[44:45], v[20:21]
 v_pk_mul_f32 v[46:47], v[46:47], v[22:23]
 v_pk_mul_f32 v[48:49], v[48:49], v[24:25]
 v_pk_mul_f32 v[50:51], v[50:51], v[26:27]
 v_cvt_pk_bf16_f32 v76, v50, v48
 v_cvt_pk_bf16_f32 v77, v46, v44
 v_cvt_pk_bf16_f32 v78, v42, v40
 v_cvt_pk_bf16_f32 v79, v38, v36
 s_add_u32 s3, s70, 16384
 buffer_store_dwordx4 v[76:79], v94, s[4:7], s3 offen sc1
 v_cvt_pk_bf16_f32 v80, v51, v49
 v_cvt_pk_bf16_f32 v81, v47, v45
 v_cvt_pk_bf16_f32 v82, v43, v41
 v_cvt_pk_bf16_f32 v83, v39, v37
 s_add_u32 s3, s70, 20480
 buffer_store_dwordx4 v[80:83], v94, s[4:7], s3 offen sc1
 v_lshlrev_b32 v12, 16, v103
 v_and_b32 v13, 0xffff0000, v103
 v_lshlrev_b32 v14, 16, v107
 v_and_b32 v15, 0xffff0000, v107
 v_lshlrev_b32 v16, 16, v111
 v_and_b32 v17, 0xffff0000, v111
 v_lshlrev_b32 v18, 16, v115
 v_and_b32 v19, 0xffff0000, v115
 v_lshlrev_b32 v20, 16, v119
 v_and_b32 v21, 0xffff0000, v119
 v_lshlrev_b32 v22, 16, v123
 v_and_b32 v23, 0xffff0000, v123
 v_lshlrev_b32 v24, 16, v127
 v_and_b32 v25, 0xffff0000, v127
 v_lshlrev_b32 v26, 16, v131
 v_and_b32 v27, 0xffff0000, v131
 v_lshlrev_b32 v28, 16, v135
 v_and_b32 v29, 0xffff0000, v135
 v_lshlrev_b32 v30, 16, v139
 v_and_b32 v31, 0xffff0000, v139
 v_lshlrev_b32 v32, 16, v143
 v_and_b32 v33, 0xffff0000, v143
 v_lshlrev_b32 v68, 16, v188
 v_lshlrev_b32 v69, 16, v190
 v_and_b32 v70, 0xffff0000, v188
 v_and_b32 v71, 0xffff0000, v190
 v_lshlrev_b32 v72, 16, v189
 v_lshlrev_b32 v73, 16, v191
 v_and_b32 v74, 0xffff0000, v189
 v_and_b32 v75, 0xffff0000, v191
 v_pk_mul_f32 v[36:37], v[12:13], v[74:75]
 v_pk_mul_f32 v[38:39], v[14:15], v[74:75]
 v_pk_mul_f32 v[40:41], v[16:17], v[74:75]
 v_pk_mul_f32 v[42:43], v[18:19], v[74:75]
 v_pk_mul_f32 v[44:45], v[20:21], v[74:75]
 v_pk_mul_f32 v[46:47], v[22:23], v[74:75]
 v_pk_mul_f32 v[48:49], v[24:25], v[74:75]
 v_pk_mul_f32 v[50:51], v[26:27], v[74:75]
 v_cvt_pk_bf16_f32 v84, v36, v37
 v_lshlrev_b32 v36, 16, v84
 v_and_b32 v37, 0xffff0000, v84
 v_cvt_pk_bf16_f32 v84, v38, v39
 v_lshlrev_b32 v38, 16, v84
 v_and_b32 v39, 0xffff0000, v84
 v_cvt_pk_bf16_f32 v84, v40, v41
 v_lshlrev_b32 v40, 16, v84
 v_and_b32 v41, 0xffff0000, v84
 v_cvt_pk_bf16_f32 v84, v42, v43
 v_lshlrev_b32 v42, 16, v84
 v_and_b32 v43, 0xffff0000, v84
 v_cvt_pk_bf16_f32 v84, v44, v45
 v_lshlrev_b32 v44, 16, v84
 v_and_b32 v45, 0xffff0000, v84
 v_cvt_pk_bf16_f32 v84, v46, v47
 v_lshlrev_b32 v46, 16, v84
 v_and_b32 v47, 0xffff0000, v84
 v_cvt_pk_bf16_f32 v84, v48, v49
 v_lshlrev_b32 v48, 16, v84
 v_and_b32 v49, 0xffff0000, v84
 v_cvt_pk_bf16_f32 v84, v50, v51
 v_lshlrev_b32 v50, 16, v84
 v_and_b32 v51, 0xffff0000, v84
 v_pk_mul_f32 v[52:53], v[14:15], v[72:73]
 v_pk_mul_f32 v[54:55], v[16:17], v[72:73]
 v_pk_mul_f32 v[56:57], v[18:19], v[72:73]
 v_pk_mul_f32 v[58:59], v[20:21], v[72:73]
 v_pk_mul_f32 v[60:61], v[22:23], v[72:73]
 v_pk_mul_f32 v[62:63], v[24:25], v[72:73]
 v_pk_mul_f32 v[64:65], v[26:27], v[72:73]
 v_pk_mul_f32 v[66:67], v[28:29], v[72:73]
 v_cvt_pk_bf16_f32 v84, v52, v53
 v_lshlrev_b32 v52, 16, v84
 v_and_b32 v53, 0xffff0000, v84
 v_cvt_pk_bf16_f32 v84, v54, v55
 v_lshlrev_b32 v54, 16, v84
 v_and_b32 v55, 0xffff0000, v84
 v_cvt_pk_bf16_f32 v84, v56, v57
 v_lshlrev_b32 v56, 16, v84
 v_and_b32 v57, 0xffff0000, v84
 v_cvt_pk_bf16_f32 v84, v58, v59
 v_lshlrev_b32 v58, 16, v84
 v_and_b32 v59, 0xffff0000, v84
 v_cvt_pk_bf16_f32 v84, v60, v61
 v_lshlrev_b32 v60, 16, v84
 v_and_b32 v61, 0xffff0000, v84
 v_cvt_pk_bf16_f32 v84, v62, v63
 v_lshlrev_b32 v62, 16, v84
 v_and_b32 v63, 0xffff0000, v84
 v_cvt_pk_bf16_f32 v84, v64, v65
 v_lshlrev_b32 v64, 16, v84
 v_and_b32 v65, 0xffff0000, v84
 v_cvt_pk_bf16_f32 v84, v66, v67
 v_lshlrev_b32 v66, 16, v84
 v_and_b32 v67, 0xffff0000, v84
 v_pk_add_f32 v[36:37], v[36:37], v[52:53]
 v_pk_add_f32 v[38:39], v[38:39], v[54:55]
 v_pk_add_f32 v[40:41], v[40:41], v[56:57]
 v_pk_add_f32 v[42:43], v[42:43], v[58:59]
 v_pk_add_f32 v[44:45], v[44:45], v[60:61]
 v_pk_add_f32 v[46:47], v[46:47], v[62:63]
 v_pk_add_f32 v[48:49], v[48:49], v[64:65]
 v_pk_add_f32 v[50:51], v[50:51], v[66:67]
 v_cvt_pk_bf16_f32 v84, v36, v37
 v_lshlrev_b32 v36, 16, v84
 v_and_b32 v37, 0xffff0000, v84
 v_cvt_pk_bf16_f32 v84, v38, v39
 v_lshlrev_b32 v38, 16, v84
 v_and_b32 v39, 0xffff0000, v84
 v_cvt_pk_bf16_f32 v84, v40, v41
 v_lshlrev_b32 v40, 16, v84
 v_and_b32 v41, 0xffff0000, v84
 v_cvt_pk_bf16_f32 v84, v42, v43
 v_lshlrev_b32 v42, 16, v84
 v_and_b32 v43, 0xffff0000, v84
 v_cvt_pk_bf16_f32 v84, v44, v45
 v_lshlrev_b32 v44, 16, v84
 v_and_b32 v45, 0xffff0000, v84
 v_cvt_pk_bf16_f32 v84, v46, v47
 v_lshlrev_b32 v46, 16, v84
 v_and_b32 v47, 0xffff0000, v84
 v_cvt_pk_bf16_f32 v84, v48, v49
 v_lshlrev_b32 v48, 16, v84
 v_and_b32 v49, 0xffff0000, v84
 v_cvt_pk_bf16_f32 v84, v50, v51
 v_lshlrev_b32 v50, 16, v84
 v_and_b32 v51, 0xffff0000, v84
 v_pk_mul_f32 v[52:53], v[16:17], v[70:71]
 v_pk_mul_f32 v[54:55], v[18:19], v[70:71]
 v_pk_mul_f32 v[56:57], v[20:21], v[70:71]
 v_pk_mul_f32 v[58:59], v[22:23], v[70:71]
 v_pk_mul_f32 v[60:61], v[24:25], v[70:71]
 v_pk_mul_f32 v[62:63], v[26:27], v[70:71]
 v_pk_mul_f32 v[64:65], v[28:29], v[70:71]
 v_pk_mul_f32 v[66:67], v[30:31], v[70:71]
 v_cvt_pk_bf16_f32 v84, v52, v53
 v_lshlrev_b32 v52, 16, v84
 v_and_b32 v53, 0xffff0000, v84
 v_cvt_pk_bf16_f32 v84, v54, v55
 v_lshlrev_b32 v54, 16, v84
 v_and_b32 v55, 0xffff0000, v84
 v_cvt_pk_bf16_f32 v84, v56, v57
 v_lshlrev_b32 v56, 16, v84
 v_and_b32 v57, 0xffff0000, v84
 v_cvt_pk_bf16_f32 v84, v58, v59
 v_lshlrev_b32 v58, 16, v84
 v_and_b32 v59, 0xffff0000, v84
 v_cvt_pk_bf16_f32 v84, v60, v61
 v_lshlrev_b32 v60, 16, v84
 v_and_b32 v61, 0xffff0000, v84
 v_cvt_pk_bf16_f32 v84, v62, v63
 v_lshlrev_b32 v62, 16, v84
 v_and_b32 v63, 0xffff0000, v84
 v_cvt_pk_bf16_f32 v84, v64, v65
 v_lshlrev_b32 v64, 16, v84
 v_and_b32 v65, 0xffff0000, v84
 v_cvt_pk_bf16_f32 v84, v66, v67
 v_lshlrev_b32 v66, 16, v84
 v_and_b32 v67, 0xffff0000, v84
 v_pk_add_f32 v[36:37], v[36:37], v[52:53]
 v_pk_add_f32 v[38:39], v[38:39], v[54:55]
 v_pk_add_f32 v[40:41], v[40:41], v[56:57]
 v_pk_add_f32 v[42:43], v[42:43], v[58:59]
 v_pk_add_f32 v[44:45], v[44:45], v[60:61]
 v_pk_add_f32 v[46:47], v[46:47], v[62:63]
 v_pk_add_f32 v[48:49], v[48:49], v[64:65]
 v_pk_add_f32 v[50:51], v[50:51], v[66:67]
 v_cvt_pk_bf16_f32 v84, v36, v37
 v_lshlrev_b32 v36, 16, v84
 v_and_b32 v37, 0xffff0000, v84
 v_cvt_pk_bf16_f32 v84, v38, v39
 v_lshlrev_b32 v38, 16, v84
 v_and_b32 v39, 0xffff0000, v84
 v_cvt_pk_bf16_f32 v84, v40, v41
 v_lshlrev_b32 v40, 16, v84
 v_and_b32 v41, 0xffff0000, v84
 v_cvt_pk_bf16_f32 v84, v42, v43
 v_lshlrev_b32 v42, 16, v84
 v_and_b32 v43, 0xffff0000, v84
 v_cvt_pk_bf16_f32 v84, v44, v45
 v_lshlrev_b32 v44, 16, v84
 v_and_b32 v45, 0xffff0000, v84
 v_cvt_pk_bf16_f32 v84, v46, v47
 v_lshlrev_b32 v46, 16, v84
 v_and_b32 v47, 0xffff0000, v84
 v_cvt_pk_bf16_f32 v84, v48, v49
 v_lshlrev_b32 v48, 16, v84
 v_and_b32 v49, 0xffff0000, v84
 v_cvt_pk_bf16_f32 v84, v50, v51
 v_lshlrev_b32 v50, 16, v84
 v_and_b32 v51, 0xffff0000, v84
 v_pk_mul_f32 v[52:53], v[18:19], v[68:69]
 v_pk_mul_f32 v[54:55], v[20:21], v[68:69]
 v_pk_mul_f32 v[56:57], v[22:23], v[68:69]
 v_pk_mul_f32 v[58:59], v[24:25], v[68:69]
 v_pk_mul_f32 v[60:61], v[26:27], v[68:69]
 v_pk_mul_f32 v[62:63], v[28:29], v[68:69]
 v_pk_mul_f32 v[64:65], v[30:31], v[68:69]
 v_pk_mul_f32 v[66:67], v[32:33], v[68:69]
 v_cvt_pk_bf16_f32 v84, v52, v53
 v_lshlrev_b32 v52, 16, v84
 v_and_b32 v53, 0xffff0000, v84
 v_cvt_pk_bf16_f32 v84, v54, v55
 v_lshlrev_b32 v54, 16, v84
 v_and_b32 v55, 0xffff0000, v84
 v_cvt_pk_bf16_f32 v84, v56, v57
 v_lshlrev_b32 v56, 16, v84
 v_and_b32 v57, 0xffff0000, v84
 v_cvt_pk_bf16_f32 v84, v58, v59
 v_lshlrev_b32 v58, 16, v84
 v_and_b32 v59, 0xffff0000, v84
 v_cvt_pk_bf16_f32 v84, v60, v61
 v_lshlrev_b32 v60, 16, v84
 v_and_b32 v61, 0xffff0000, v84
 v_cvt_pk_bf16_f32 v84, v62, v63
 v_lshlrev_b32 v62, 16, v84
 v_and_b32 v63, 0xffff0000, v84
 v_cvt_pk_bf16_f32 v84, v64, v65
 v_lshlrev_b32 v64, 16, v84
 v_and_b32 v65, 0xffff0000, v84
 v_cvt_pk_bf16_f32 v84, v66, v67
 v_lshlrev_b32 v66, 16, v84
 v_and_b32 v67, 0xffff0000, v84
 v_pk_add_f32 v[36:37], v[36:37], v[52:53]
 v_pk_add_f32 v[38:39], v[38:39], v[54:55]
 v_pk_add_f32 v[40:41], v[40:41], v[56:57]
 v_pk_add_f32 v[42:43], v[42:43], v[58:59]
 v_pk_add_f32 v[44:45], v[44:45], v[60:61]
 v_pk_add_f32 v[46:47], v[46:47], v[62:63]
 v_pk_add_f32 v[48:49], v[48:49], v[64:65]
 v_pk_add_f32 v[50:51], v[50:51], v[66:67]
 v_cvt_pk_bf16_f32 v84, v36, v37
 v_lshlrev_b32 v36, 16, v84
 v_and_b32 v37, 0xffff0000, v84
 v_cvt_pk_bf16_f32 v84, v38, v39
 v_lshlrev_b32 v38, 16, v84
 v_and_b32 v39, 0xffff0000, v84
 v_cvt_pk_bf16_f32 v84, v40, v41
 v_lshlrev_b32 v40, 16, v84
 v_and_b32 v41, 0xffff0000, v84
 v_cvt_pk_bf16_f32 v84, v42, v43
 v_lshlrev_b32 v42, 16, v84
 v_and_b32 v43, 0xffff0000, v84
 v_cvt_pk_bf16_f32 v84, v44, v45
 v_lshlrev_b32 v44, 16, v84
 v_and_b32 v45, 0xffff0000, v84
 v_cvt_pk_bf16_f32 v84, v46, v47
 v_lshlrev_b32 v46, 16, v84
 v_and_b32 v47, 0xffff0000, v84
 v_cvt_pk_bf16_f32 v84, v48, v49
 v_lshlrev_b32 v48, 16, v84
 v_and_b32 v49, 0xffff0000, v84
 v_cvt_pk_bf16_f32 v84, v50, v51
 v_lshlrev_b32 v50, 16, v84
 v_and_b32 v51, 0xffff0000, v84
 v_lshlrev_b32 v12, 16, v147
 v_and_b32 v13, 0xffff0000, v147
 v_lshlrev_b32 v14, 16, v151
 v_and_b32 v15, 0xffff0000, v151
 v_lshlrev_b32 v16, 16, v155
 v_and_b32 v17, 0xffff0000, v155
 v_lshlrev_b32 v18, 16, v159
 v_and_b32 v19, 0xffff0000, v159
 v_lshlrev_b32 v20, 16, v163
 v_and_b32 v21, 0xffff0000, v163
 v_lshlrev_b32 v22, 16, v167
 v_and_b32 v23, 0xffff0000, v167
 v_lshlrev_b32 v24, 16, v171
 v_and_b32 v25, 0xffff0000, v171
 v_lshlrev_b32 v26, 16, v175
 v_and_b32 v27, 0xffff0000, v175
 v_pk_mul_f32 v[36:37], v[36:37], v[12:13]
 v_pk_mul_f32 v[38:39], v[38:39], v[14:15]
 v_pk_mul_f32 v[40:41], v[40:41], v[16:17]
 v_pk_mul_f32 v[42:43], v[42:43], v[18:19]
 v_pk_mul_f32 v[44:45], v[44:45], v[20:21]
 v_pk_mul_f32 v[46:47], v[46:47], v[22:23]
 v_pk_mul_f32 v[48:49], v[48:49], v[24:25]
 v_pk_mul_f32 v[50:51], v[50:51], v[26:27]
 v_cvt_pk_bf16_f32 v76, v50, v48
 v_cvt_pk_bf16_f32 v77, v46, v44
 v_cvt_pk_bf16_f32 v78, v42, v40
 v_cvt_pk_bf16_f32 v79, v38, v36
 s_add_u32 s3, s70, 24576
 buffer_store_dwordx4 v[76:79], v94, s[4:7], s3 offen sc1
 v_cvt_pk_bf16_f32 v80, v51, v49
 v_cvt_pk_bf16_f32 v81, v47, v45
 v_cvt_pk_bf16_f32 v82, v43, v41
 v_cvt_pk_bf16_f32 v83, v39, v37
 s_add_u32 s3, s70, 28672
 buffer_store_dwordx4 v[80:83], v94, s[4:7], s3 offen sc1
 s_cmp_eq_u32 s83, 1
 s_cbranch_scc1 L_k3_25
 s_waitcnt vmcnt(0)
 s_barrier
 s_cmp_lg_u32 s50, 3
 s_cbranch_scc1 L_ar_26
 s_mov_b32 s96, s44
 s_and_b32 s97, s45, 0xffff
 s_mov_b32 s98, 256
 s_mov_b32 s99, 0x00020000
 v_mov_b32 v1, 1
 s_mov_b64 exec, 1
 buffer_atomic_add v1, off, s[96:99], 0 offset:80 sc0
 s_waitcnt vmcnt(0)
 v_cmp_eq_u32 vcc, 39, v1
 s_cbranch_vccz L_aw_27
 buffer_store_dword v1, off, s[96:99], 0 offset:208 sc1
L_aw_27:
 s_mov_b64 exec, -1
L_ar_26:
 s_branch L_help_conv
L_k3_25:
 s_waitcnt vmcnt(0)
 s_barrier
 s_cmp_lg_u32 s50, 3
 s_cbranch_scc1 L_ar_28
 s_mov_b32 s96, s44
 s_and_b32 s97, s45, 0xffff
 s_mov_b32 s98, 256
 s_mov_b32 s99, 0x00020000
 v_mov_b32 v1, 1
 s_mov_b64 exec, 1
 buffer_atomic_add v1, off, s[96:99], 0 offset:68 sc0
 s_waitcnt vmcnt(0)
 v_cmp_eq_u32 vcc, 39, v1
 s_cbranch_vccz L_aw_29
 buffer_store_dword v1, off, s[96:99], 0 offset:196 sc1
L_aw_29:
 s_mov_b64 exec, -1
L_ar_28:
 s_mov_b32 s8, s26
 s_and_b32 s9, s27, 0xffff
 s_mov_b32 s10, 5242880
 s_mov_b32 s11, 0x00020000
 s_mul_i32 s57, s50, 40960
 s_and_b32 s55, s53, 3
 s_add_u32 s64, s55, 0
 s_sub_u32 s3, s64, 4
 s_cmp_ge_u32 s64, 4
 s_cselect_b32 s64, s3, s64
 s_add_u32 s65, s55, 1
 s_sub_u32 s3, s65, 4
 s_cmp_ge_u32 s65, 4
 s_cselect_b32 s65, s3, s65
 s_add_u32 s66, s55, 2
 s_sub_u32 s3, s66, 4
 s_cmp_ge_u32 s66, 4
 s_cselect_b32 s66, s3, s66
 s_add_u32 s67, s55, 3
 s_sub_u32 s3, s67, 4
 s_cmp_ge_u32 s67, 4
 s_cselect_b32 s67, s3, s67
 s_mul_i32 s55, s52, 655360
 s_lshl_b32 s3, s53, 8
 s_add_u32 s55, s55, s3
 v_lshrrev_b32 v4, 4, v0
 s_mov_b32 s3, 1280
 v_mul_lo_u32 v4, v4, s3
 v_lshrrev_b32 v3, 3, v0
 v_and_b32 v3, 6, v3
 v_xor_b32 v3, v3, v0
 v_and_b32 v3, 15, v3
 v_lshl_add_u32 v4, v3, 4, v4
 v_xor_b32 v5, 128, v4
 s_lshl_b32 s57, s50, 13
 s_mul_i32 s3, s50, 40960
 s_add_u32 s55, s55, s3
 s_mul_i32 s51, s64, 163840
 s_add_u32 s51, s51, s55
 s_add_u32 m0, s57, 0
 s_nop 0
 buffer_load_dwordx4 v4, s[8:11], s51 offen lds
 s_add_u32 s51, s51, 5120
 s_add_u32 m0, s57, 1024
 s_nop 0
 buffer_load_dwordx4 v5, s[8:11], s51 offen lds
 s_add_u32 s51, s51, 5120
 s_add_u32 m0, s57, 2048
 s_nop 0
 buffer_load_dwordx4 v4, s[8:11], s51 offen lds
 s_add_u32 s51, s51, 5120
 s_add_u32 m0, s57, 3072
 s_nop 0
 buffer_load_dwordx4 v5, s[8:11], s51 offen lds
 s_add_u32 s51, s51, 5120
 s_add_u32 m0, s57, 4096
 s_nop 0
 buffer_load_dwordx4 v4, s[8:11], s51 offen lds
 s_add_u32 s51, s51, 5120
 s_add_u32 m0, s57, 5120
 s_nop 0
 buffer_load_dwordx4 v5, s[8:11], s51 offen lds
 s_add_u32 s51, s51, 5120
 s_add_u32 m0, s57, 6144
 s_nop 0
 buffer_load_dwordx4 v4, s[8:11], s51 offen lds
 s_add_u32 s51, s51, 5120
 s_add_u32 m0, s57, 7168
 s_nop 0
 buffer_load_dwordx4 v5, s[8:11], s51 offen lds
 s_add_u32 s51, s51, 5120
 s_mul_i32 s51, s65, 163840
 s_add_u32 s51, s51, s55
 s_add_u32 m0, s57, 32768
 s_nop 0
 buffer_load_dwordx4 v4, s[8:11], s51 offen lds
 s_add_u32 s51, s51, 5120
 s_add_u32 m0, s57, 33792
 s_nop 0
 buffer_load_dwordx4 v5, s[8:11], s51 offen lds
 s_add_u32 s51, s51, 5120
 s_add_u32 m0, s57, 34816
 s_nop 0
 buffer_load_dwordx4 v4, s[8:11], s51 offen lds
 s_add_u32 s51, s51, 5120
 s_add_u32 m0, s57, 35840
 s_nop 0
 buffer_load_dwordx4 v5, s[8:11], s51 offen lds
 s_add_u32 s51, s51, 5120
 s_add_u32 m0, s57, 36864
 s_nop 0
 buffer_load_dwordx4 v4, s[8:11], s51 offen lds
 s_add_u32 s51, s51, 5120
 s_add_u32 m0, s57, 37888
 s_nop 0
 buffer_load_dwordx4 v5, s[8:11], s51 offen lds
 s_add_u32 s51, s51, 5120
 s_add_u32 m0, s57, 38912
 s_nop 0
 buffer_load_dwordx4 v4, s[8:11], s51 offen lds
 s_add_u32 s51, s51, 5120
 s_add_u32 m0, s57, 39936
 s_nop 0
 buffer_load_dwordx4 v5, s[8:11], s51 offen lds
 s_add_u32 s51, s51, 5120
 s_mul_i32 s51, s66, 163840
 s_add_u32 s51, s51, s55
 s_add_u32 m0, s57, 65536
 s_nop 0
 buffer_load_dwordx4 v4, s[8:11], s51 offen lds
 s_add_u32 s51, s51, 5120
 s_add_u32 m0, s57, 66560
 s_nop 0
 buffer_load_dwordx4 v5, s[8:11], s51 offen lds
 s_add_u32 s51, s51, 5120
 s_add_u32 m0, s57, 67584
 s_nop 0
 buffer_load_dwordx4 v4, s[8:11], s51 offen lds
 s_add_u32 s51, s51, 5120
 s_add_u32 m0, s57, 68608
 s_nop 0
 buffer_load_dwordx4 v5, s[8:11], s51 offen lds
 s_add_u32 s51, s51, 5120
 s_add_u32 m0, s57, 69632
 s_nop 0
 buffer_load_dwordx4 v4, s[8:11], s51 offen lds
 s_add_u32 s51, s51, 5120
 s_add_u32 m0, s57, 70656
 s_nop 0
 buffer_load_dwordx4 v5, s[8:11], s51 offen lds
 s_add_u32 s51, s51, 5120
 s_add_u32 m0, s57, 71680
 s_nop 0
 buffer_load_dwordx4 v4, s[8:11], s51 offen lds
 s_add_u32 s51, s51, 5120
 s_add_u32 m0, s57, 72704
 s_nop 0
 buffer_load_dwordx4 v5, s[8:11], s51 offen lds
 s_add_u32 s51, s51, 5120
 s_mul_i32 s51, s67, 163840
 s_add_u32 s51, s51, s55
 s_add_u32 m0, s57, 98304
 s_nop 0
 buffer_load_dwordx4 v4, s[8:11], s51 offen lds
 s_add_u32 s51, s51, 5120
 s_add_u32 m0, s57, 99328
 s_nop 0
 buffer_load_dwordx4 v5, s[8:11], s51 offen lds
 s_add_u32 s51, s51, 5120
 s_add_u32 m0, s57, 100352
 s_nop 0
 buffer_load_dwordx4 v4, s[8:11], s51 offen lds
 s_add_u32 s51, s51, 5120
 s_add_u32 m0, s57, 101376
 s_nop 0
 buffer_load_dwordx4 v5, s[8:11], s51 offen lds
 s_add_u32 s51, s51, 5120
 s_add_u32 m0, s57, 102400
 s_nop 0
 buffer_load_dwordx4 v4, s[8:11], s51 offen lds
 s_add_u32 s51, s51, 5120
 s_add_u32 m0, s57, 103424
 s_nop 0
 buffer_load_dwordx4 v5, s[8:11], s51 offen lds
 s_add_u32 s51, s51, 5120
 s_add_u32 m0, s57, 104448
 s_nop 0
 buffer_load_dwordx4 v4, s[8:11], s51 offen lds
 s_add_u32 s51, s51, 5120
 s_add_u32 m0, s57, 105472
 s_nop 0
 buffer_load_dwordx4 v5, s[8:11], s51 offen lds
 s_add_u32 s51, s51, 5120
 v_lshrrev_b32 v2, 3, v0
 v_and_b32 v2, 4, v2
 v_bfe_u32 v3, v0, 2, 2
 v_or_b32 v2, v2, v3
 v_bfe_u32 v3, v0, 4, 1
 v_xor_b32 v3, v3, v2
 s_lshl_b32 s3, s50, 1
 v_xor_b32 v3, s3, v3
 v_lshlrev_b32 v2, 8, v2
 v_lshl_add_u32 v2, v3, 5, v2
 v_and_b32 v3, 3, v0
 v_lshl_add_u32 v2, v3, 3, v2
 s_waitcnt vmcnt(24)
 s_barrier
 ds_read_b64_tr_b16 a[0:1], v2 offset:0
 ds_read_b64_tr_b16 a[2:3], v2 offset:4096
 ds_read_b64_tr_b16 a[4:5], v2 offset:2048
 ds_read_b64_tr_b16 a[6:7], v2 offset:6144
 ds_read_b64_tr_b16 a[8:9], v2 offset:8192
 ds_read_b64_tr_b16 a[10:11], v2 offset:12288
 ds_read_b64_tr_b16 a[12:13], v2 offset:10240
 ds_read_b64_tr_b16 a[14:15], v2 offset:14336
 ds_read_b64_tr_b16 a[16:17], v2 offset:16384
 ds_read_b64_tr_b16 a[18:19], v2 offset:20480
 ds_read_b64_tr_b16 a[20:21], v2 offset:18432
 ds_read_b64_tr_b16 a[22:23], v2 offset:22528
 ds_read_b64_tr_b16 a[24:25], v2 offset:24576
 ds_read_b64_tr_b16 a[26:27], v2 offset:28672
 ds_read_b64_tr_b16 a[28:29], v2 offset:26624
 ds_read_b64_tr_b16 a[30:31], v2 offset:30720
 v_add_u32 v2, 0x8000, v2
 s_waitcnt vmcnt(16)
 s_barrier
 ds_read_b64_tr_b16 a[32:33], v2 offset:0
 ds_read_b64_tr_b16 a[34:35], v2 offset:4096
 ds_read_b64_tr_b16 a[36:37], v2 offset:2048
 ds_read_b64_tr_b16 a[38:39], v2 offset:6144
 ds_read_b64_tr_b16 a[40:41], v2 offset:8192
 ds_read_b64_tr_b16 a[42:43], v2 offset:12288
 ds_read_b64_tr_b16 a[44:45], v2 offset:10240
 ds_read_b64_tr_b16 a[46:47], v2 offset:14336
 ds_read_b64_tr_b16 a[48:49], v2 offset:16384
 ds_read_b64_tr_b16 a[50:51], v2 offset:20480
 ds_read_b64_tr_b16 a[52:53], v2 offset:18432
 ds_read_b64_tr_b16 a[54:55], v2 offset:22528
 ds_read_b64_tr_b16 a[56:57], v2 offset:24576
 ds_read_b64_tr_b16 a[58:59], v2 offset:28672
 ds_read_b64_tr_b16 a[60:61], v2 offset:26624
 ds_read_b64_tr_b16 a[62:63], v2 offset:30720
 v_add_u32 v2, 0x8000, v2
 s_waitcnt vmcnt(8)
 s_barrier
 ds_read_b64_tr_b16 a[64:65], v2 offset:0
 ds_read_b64_tr_b16 a[66:67], v2 offset:4096
 ds_read_b64_tr_b16 a[68:69], v2 offset:2048
 ds_read_b64_tr_b16 a[70:71], v2 offset:6144
 ds_read_b64_tr_b16 a[72:73], v2 offset:8192
 ds_read_b64_tr_b16 a[74:75], v2 offset:12288
 ds_read_b64_tr_b16 a[76:77], v2 offset:10240
 ds_read_b64_tr_b16 a[78:79], v2 offset:14336
 ds_read_b64_tr_b16 a[80:81], v2 offset:16384
 ds_read_b64_tr_b16 a[82:83], v2 offset:20480
 ds_read_b64_tr_b16 a[84:85], v2 offset:18432
 ds_read_b64_tr_b16 a[86:87], v2 offset:22528
 ds_read_b64_tr_b16 a[88:89], v2 offset:24576
 ds_read_b64_tr_b16 a[90:91], v2 offset:28672
 ds_read_b64_tr_b16 a[92:93], v2 offset:26624
 ds_read_b64_tr_b16 a[94:95], v2 offset:30720
 v_add_u32 v2, 0x8000, v2
 s_waitcnt vmcnt(0)
 s_barrier
 ds_read_b64_tr_b16 a[96:97], v2 offset:0
 ds_read_b64_tr_b16 a[98:99], v2 offset:4096
 ds_read_b64_tr_b16 a[100:101], v2 offset:2048
 ds_read_b64_tr_b16 a[102:103], v2 offset:6144
 ds_read_b64_tr_b16 a[104:105], v2 offset:8192
 ds_read_b64_tr_b16 a[106:107], v2 offset:12288
 ds_read_b64_tr_b16 a[108:109], v2 offset:10240
 ds_read_b64_tr_b16 a[110:111], v2 offset:14336
 ds_read_b64_tr_b16 a[112:113], v2 offset:16384
 ds_read_b64_tr_b16 a[114:115], v2 offset:20480
 ds_read_b64_tr_b16 a[116:117], v2 offset:18432
 ds_read_b64_tr_b16 a[118:119], v2 offset:22528
 ds_read_b64_tr_b16 a[120:121], v2 offset:24576
 ds_read_b64_tr_b16 a[122:123], v2 offset:28672
 ds_read_b64_tr_b16 a[124:125], v2 offset:26624
 ds_read_b64_tr_b16 a[126:127], v2 offset:30720
 v_add_u32 v2, 0x8000, v2
 s_waitcnt lgkmcnt(0)
 s_barrier
L_help_conv:
 s_cmp_ge_u32 s82, 72
 s_cbranch_scc1 L_help_ln2
 s_cmp_ge_u32 s82, 64
 s_cbranch_scc1 L_help_done
 s_lshl_b32 s70, s82, 2
 s_add_u32 s70, s70, s50
 s_add_u32 s70, s70, 384
 s_mul_i32 s71, s50, 13312
 s_mov_b32 s69, 640
 s_mov_b32 s8, s38
 s_and_b32 s9, s39, 0xffff
 s_mov_b32 s10, 2621440
 s_mov_b32 s11, 0x00020000
 s_mov_b32 s12, s40
 s_and_b32 s13, s41, 0xffff
 s_mov_b32 s14, 1280
 s_mov_b32 s15, 0x00020000
 v_lshlrev_b32 v130, 4, v0
 s_lshl_b32 s73, s70, 12
 s_add_u32 s74, s73, 2
 buffer_load_dwordx4 v[96:99], v130, s[8:11], s73 offen offset:0
 buffer_load_dwordx4 v[100:103], v130, s[8:11], s73 offen offset:1024
 buffer_load_dwordx4 v[112:115], v130, s[8:11], s74 offen offset:0
 buffer_load_dwordx4 v[116:119], v130, s[8:11], s74 offen offset:1024
 s_lshl_b32 s3, s70, 1
 buffer_load_ushort v128, off, s[12:15], s3
 s_getpc_b64 s[76:77]
L_ca_30:
 s_add_u32 s76, s76, L_conv0-L_ca_30
 s_addc_u32 s77, s77, -1
 s_swappc_b64 s[76:77], s[76:77]
 s_waitcnt vmcnt(0)
 s_barrier
 s_cmp_lg_u32 s50, 3
 s_cbranch_scc1 L_ar_31
 s_mov_b32 s96, s44
 s_and_b32 s97, s45, 0xffff
 s_mov_b32 s98, 256
 s_mov_b32 s99, 0x00020000
 v_mov_b32 v1, 1
 s_mov_b64 exec, 1
 buffer_atomic_add v1, off, s[96:99], 0 offset:8 sc0
 s_waitcnt vmcnt(0)
 v_cmp_eq_u32 vcc, 159, v1
 s_cbranch_vccz L_aw_32
 buffer_store_dword v1, off, s[96:99], 0 offset:136 sc1
L_aw_32:
 s_mov_b64 exec, -1
L_ar_31:
L_help_done:
 s_cmp_lg_u32 s50, 0
 s_cbranch_scc1 L_ww_33
 s_mov_b32 s96, s44
 s_and_b32 s97, s45, 0xffff
 s_mov_b32 s98, 256
 s_mov_b32 s99, 0x00020000
 v_mov_b32 v1, 132
 s_mov_b32 s51, 0
 s_mov_b64 exec, 1
L_wb_34:
 buffer_load_dword v2, v1, s[96:99], 0 offen sc1
 s_waitcnt vmcnt(0)
 v_cmp_eq_u32 vcc, 0, v2
 s_cbranch_vccz L_wbd_35
 s_sleep 2
 s_add_u32 s51, s51, 1
 s_cmp_lt_u32 s51, 131072
 s_cbranch_scc1 L_wb_34
 s_branch L_bail
L_wbd_35:
 s_mov_b64 exec, -1
L_ww_33:
 s_barrier
 s_cmp_eq_u32 s83, 0
 s_cbranch_scc1 L_t4
 s_cmp_eq_u32 s83, 1
 s_cbranch_scc1 L_wo
 s_branch L_att
L_qkvq:
 s_mul_i32 s57, s50, 40960
 s_mul_i32 s62, s52, 3
 s_add_u32 s62, s62, s53
 s_mul_i32 s3, s62, 13108
 s_lshr_b32 s3, s3, 16
 s_mul_i32 s3, s3, 5
 s_sub_u32 s55, s62, s3
 s_add_u32 s64, s55, 0
 s_sub_u32 s3, s64, 5
 s_cmp_ge_u32 s64, 5
 s_cselect_b32 s64, s3, s64
 s_add_u32 s65, s55, 1
 s_sub_u32 s3, s65, 5
 s_cmp_ge_u32 s65, 5
 s_cselect_b32 s65, s3, s65
 s_add_u32 s66, s55, 2
 s_sub_u32 s3, s66, 5
 s_cmp_ge_u32 s66, 5
 s_cselect_b32 s66, s3, s66
 s_add_u32 s67, s55, 3
 s_sub_u32 s3, s67, 5
 s_cmp_ge_u32 s67, 5
 s_cselect_b32 s67, s3, s67
 s_add_u32 s68, s55, 4
 s_sub_u32 s3, s68, 5
 s_cmp_ge_u32 s68, 5
 s_cselect_b32 s68, s3, s68
 s_lshl_b32 s55, s52, 8
 v_lshrrev_b32 v4, 4, v0
 s_mov_b32 s3, 8192
 v_mul_lo_u32 v4, v4, s3
 v_lshrrev_b32 v3, 3, v0
 v_and_b32 v3, 6, v3
 v_xor_b32 v3, v3, v0
 v_and_b32 v3, 15, v3
 v_lshl_add_u32 v4, v3, 4, v4
 v_xor_b32 v5, 128, v4
 s_lshl_b32 s57, s50, 13
 s_mul_i32 s3, s50, 262144
 s_add_u32 s55, s55, s3
 s_mul_i32 s51, s64, 1048576
 s_add_u32 s51, s51, s55
 s_add_u32 m0, s57, 0
 s_nop 0
 buffer_load_dwordx4 v4, s[8:11], s51 offen lds
 s_add_u32 s51, s51, 32768
 s_add_u32 m0, s57, 1024
 s_nop 0
 buffer_load_dwordx4 v5, s[8:11], s51 offen lds
 s_add_u32 s51, s51, 32768
 s_add_u32 m0, s57, 2048
 s_nop 0
 buffer_load_dwordx4 v4, s[8:11], s51 offen lds
 s_add_u32 s51, s51, 32768
 s_add_u32 m0, s57, 3072
 s_nop 0
 buffer_load_dwordx4 v5, s[8:11], s51 offen lds
 s_add_u32 s51, s51, 32768
 s_add_u32 m0, s57, 4096
 s_nop 0
 buffer_load_dwordx4 v4, s[8:11], s51 offen lds
 s_add_u32 s51, s51, 32768
 s_add_u32 m0, s57, 5120
 s_nop 0
 buffer_load_dwordx4 v5, s[8:11], s51 offen lds
 s_add_u32 s51, s51, 32768
 s_add_u32 m0, s57, 6144
 s_nop 0
 buffer_load_dwordx4 v4, s[8:11], s51 offen lds
 s_add_u32 s51, s51, 32768
 s_add_u32 m0, s57, 7168
 s_nop 0
 buffer_load_dwordx4 v5, s[8:11], s51 offen lds
 s_add_u32 s51, s51, 32768
 s_mul_i32 s51, s65, 1048576
 s_add_u32 s51, s51, s55
 s_add_u32 m0, s57, 32768
 s_nop 0
 buffer_load_dwordx4 v4, s[8:11], s51 offen lds
 s_add_u32 s51, s51, 32768
 s_add_u32 m0, s57, 33792
 s_nop 0
 buffer_load_dwordx4 v5, s[8:11], s51 offen lds
 s_add_u32 s51, s51, 32768
 s_add_u32 m0, s57, 34816
 s_nop 0
 buffer_load_dwordx4 v4, s[8:11], s51 offen lds
 s_add_u32 s51, s51, 32768
 s_add_u32 m0, s57, 35840
 s_nop 0
 buffer_load_dwordx4 v5, s[8:11], s51 offen lds
 s_add_u32 s51, s51, 32768
 s_add_u32 m0, s57, 36864
 s_nop 0
 buffer_load_dwordx4 v4, s[8:11], s51 offen lds
 s_add_u32 s51, s51, 32768
 s_add_u32 m0, s57, 37888
 s_nop 0
 buffer_load_dwordx4 v5, s[8:11], s51 offen lds
 s_add_u32 s51, s51, 32768
 s_add_u32 m0, s57, 38912
 s_nop 0
 buffer_load_dwordx4 v4, s[8:11], s51 offen lds
 s_add_u32 s51, s51, 32768
 s_add_u32 m0, s57, 39936
 s_nop 0
 buffer_load_dwordx4 v5, s[8:11], s51 offen lds
 s_add_u32 s51, s51, 32768
 s_mul_i32 s51, s66, 1048576
 s_add_u32 s51, s51, s55
 s_add_u32 m0, s57, 65536
 s_nop 0
 buffer_load_dwordx4 v4, s[8:11], s51 offen lds
 s_add_u32 s51, s51, 32768
 s_add_u32 m0, s57, 66560
 s_nop 0
 buffer_load_dwordx4 v5, s[8:11], s51 offen lds
 s_add_u32 s51, s51, 32768
 s_add_u32 m0, s57, 67584
 s_nop 0
 buffer_load_dwordx4 v4, s[8:11], s51 offen lds
 s_add_u32 s51, s51, 32768
 s_add_u32 m0, s57, 68608
 s_nop 0
 buffer_load_dwordx4 v5, s[8:11], s51 offen lds
 s_add_u32 s51, s51, 32768
 s_add_u32 m0, s57, 69632
 s_nop 0
 buffer_load_dwordx4 v4, s[8:11], s51 offen lds
 s_add_u32 s51, s51, 32768
 s_add_u32 m0, s57, 70656
 s_nop 0
 buffer_load_dwordx4 v5, s[8:11], s51 offen lds
 s_add_u32 s51, s51, 32768
 s_add_u32 m0, s57, 71680
 s_nop 0
 buffer_load_dwordx4 v4, s[8:11], s51 offen lds
 s_add_u32 s51, s51, 32768
 s_add_u32 m0, s57, 72704
 s_nop 0
 buffer_load_dwordx4 v5, s[8:11], s51 offen lds
 s_add_u32 s51, s51, 32768
 s_mul_i32 s51, s67, 1048576
 s_add_u32 s51, s51, s55
 s_add_u32 m0, s57, 98304
 s_nop 0
 buffer_load_dwordx4 v4, s[8:11], s51 offen lds
 s_add_u32 s51, s51, 32768
 s_add_u32 m0, s57, 99328
 s_nop 0
 buffer_load_dwordx4 v5, s[8:11], s51 offen lds
 s_add_u32 s51, s51, 32768
 s_add_u32 m0, s57, 100352
 s_nop 0
 buffer_load_dwordx4 v4, s[8:11], s51 offen lds
 s_add_u32 s51, s51, 32768
 s_add_u32 m0, s57, 101376
 s_nop 0
 buffer_load_dwordx4 v5, s[8:11], s51 offen lds
 s_add_u32 s51, s51, 32768
 s_add_u32 m0, s57, 102400
 s_nop 0
 buffer_load_dwordx4 v4, s[8:11], s51 offen lds
 s_add_u32 s51, s51, 32768
 s_add_u32 m0, s57, 103424
 s_nop 0
 buffer_load_dwordx4 v5, s[8:11], s51 offen lds
 s_add_u32 s51, s51, 32768
 s_add_u32 m0, s57, 104448
 s_nop 0
 buffer_load_dwordx4 v4, s[8:11], s51 offen lds
 s_add_u32 s51, s51, 32768
 s_add_u32 m0, s57, 105472
 s_nop 0
 buffer_load_dwordx4 v5, s[8:11], s51 offen lds
 s_add_u32 s51, s51, 32768
 s_mul_i32 s51, s68, 1048576
 s_add_u32 s51, s51, s55
 s_add_u32 m0, s57, 131072
 s_nop 0
 buffer_load_dwordx4 v4, s[8:11], s51 offen lds
 s_add_u32 s51, s51, 32768
 s_add_u32 m0, s57, 132096
 s_nop 0
 buffer_load_dwordx4 v5, s[8:11], s51 offen lds
 s_add_u32 s51, s51, 32768
 s_add_u32 m0, s57, 133120
 s_nop 0
 buffer_load_dwordx4 v4, s[8:11], s51 offen lds
 s_add_u32 s51, s51, 32768
 s_add_u32 m0, s57, 134144
 s_nop 0
 buffer_load_dwordx4 v5, s[8:11], s51 offen lds
 s_add_u32 s51, s51, 32768
 s_add_u32 m0, s57, 135168
 s_nop 0
 buffer_load_dwordx4 v4, s[8:11], s51 offen lds
 s_add_u32 s51, s51, 32768
 s_add_u32 m0, s57, 136192
 s_nop 0
 buffer_load_dwordx4 v5, s[8:11], s51 offen lds
 s_add_u32 s51, s51, 32768
 s_add_u32 m0, s57, 137216
 s_nop 0
 buffer_load_dwordx4 v4, s[8:11], s51 offen lds
 s_add_u32 s51, s51, 32768
 s_add_u32 m0, s57, 138240
 s_nop 0
 buffer_load_dwordx4 v5, s[8:11], s51 offen lds
 s_add_u32 s51, s51, 32768
 s_mov_b32 s96, s44
 s_and_b32 s97, s45, 0xffff
 s_mov_b32 s98, 256
 s_mov_b32 s99, 0x00020000
 buffer_load_dword v30, off, s[96:99], 0 offset:132 sc1
 v_lshrrev_b32 v2, 3, v0
 v_and_b32 v2, 4, v2
 v_bfe_u32 v3, v0, 2, 2
 v_or_b32 v2, v2, v3
 v_bfe_u32 v3, v0, 4, 1
 v_xor_b32 v3, v3, v2
 s_lshl_b32 s3, s50, 1
 v_xor_b32 v3, s3, v3
 v_lshlrev_b32 v2, 8, v2
 v_lshl_add_u32 v2, v3, 5, v2
 v_and_b32 v3, 3, v0
 v_lshl_add_u32 v2, v3, 3, v2
 s_waitcnt vmcnt(32)
 s_barrier
 ds_read_b64_tr_b16 a[0:1], v2 offset:0
 ds_read_b64_tr_b16 a[2:3], v2 offset:4096
 ds_read_b64_tr_b16 a[4:5], v2 offset:2048
 ds_read_b64_tr_b16 a[6:7], v2 offset:6144
 ds_read_b64_tr_b16 a[8:9], v2 offset:8192
 ds_read_b64_tr_b16 a[10:11], v2 offset:12288
 ds_read_b64_tr_b16 a[12:13], v2 offset:10240
 ds_read_b64_tr_b16 a[14:15], v2 offset:14336
 ds_read_b64_tr_b16 a[16:17], v2 offset:16384
 ds_read_b64_tr_b16 a[18:19], v2 offset:20480
 ds_read_b64_tr_b16 a[20:21], v2 offset:18432
 ds_read_b64_tr_b16 a[22:23], v2 offset:22528
 ds_read_b64_tr_b16 a[24:25], v2 offset:24576
 ds_read_b64_tr_b16 a[26:27], v2 offset:28672
 ds_read_b64_tr_b16 a[28:29], v2 offset:26624
 ds_read_b64_tr_b16 a[30:31], v2 offset:30720
 v_add_u32 v2, 0x8000, v2
 s_waitcnt vmcnt(24)
 s_barrier
 ds_read_b64_tr_b16 a[32:33], v2 offset:0
 ds_read_b64_tr_b16 a[34:35], v2 offset:4096
 ds_read_b64_tr_b16 a[36:37], v2 offset:2048
 ds_read_b64_tr_b16 a[38:39], v2 offset:6144
 ds_read_b64_tr_b16 a[40:41], v2 offset:8192
 ds_read_b64_tr_b16 a[42:43], v2 offset:12288
 ds_read_b64_tr_b16 a[44:45], v2 offset:10240
 ds_read_b64_tr_b16 a[46:47], v2 offset:14336
 ds_read_b64_tr_b16 a[48:49], v2 offset:16384
 ds_read_b64_tr_b16 a[50:51], v2 offset:20480
 ds_read_b64_tr_b16 a[52:53], v2 offset:18432
 ds_read_b64_tr_b16 a[54:55], v2 offset:22528
 ds_read_b64_tr_b16 a[56:57], v2 offset:24576
 ds_read_b64_tr_b16 a[58:59], v2 offset:28672
 ds_read_b64_tr_b16 a[60:61], v2 offset:26624
 ds_read_b64_tr_b16 a[62:63], v2 offset:30720
 v_add_u32 v2, 0x8000, v2
 s_waitcnt vmcnt(16)
 s_barrier
 ds_read_b64_tr_b16 a[64:65], v2 offset:0
 ds_read_b64_tr_b16 a[66:67], v2 offset:4096
 ds_read_b64_tr_b16 a[68:69], v2 offset:2048
 ds_read_b64_tr_b16 a[70:71], v2 offset:6144
 ds_read_b64_tr_b16 a[72:73], v2 offset:8192
 ds_read_b64_tr_b16 a[74:75], v2 offset:12288
 ds_read_b64_tr_b16 a[76:77], v2 offset:10240
 ds_read_b64_tr_b16 a[78:79], v2 offset:14336
 ds_read_b64_tr_b16 a[80:81], v2 offset:16384
 ds_read_b64_tr_b16 a[82:83], v2 offset:20480
 ds_read_b64_tr_b16 a[84:85], v2 offset:18432
 ds_read_b64_tr_b16 a[86:87], v2 offset:22528
 ds_read_b64_tr_b16 a[88:89], v2 offset:24576
 ds_read_b64_tr_b16 a[90:91], v2 offset:28672
 ds_read_b64_tr_b16 a[92:93], v2 offset:26624
 ds_read_b64_tr_b16 a[94:95], v2 offset:30720
 v_add_u32 v2, 0x8000, v2
 s_waitcnt vmcnt(8)
 s_barrier
 ds_read_b64_tr_b16 a[96:97], v2 offset:0
 ds_read_b64_tr_b16 a[98:99], v2 offset:4096
 ds_read_b64_tr_b16 a[100:101], v2 offset:2048
 ds_read_b64_tr_b16 a[102:103], v2 offset:6144
 ds_read_b64_tr_b16 a[104:105], v2 offset:8192
 ds_read_b64_tr_b16 a[106:107], v2 offset:12288
 ds_read_b64_tr_b16 a[108:109], v2 offset:10240
 ds_read_b64_tr_b16 a[110:111], v2 offset:14336
 ds_read_b64_tr_b16 a[112:113], v2 offset:16384
 ds_read_b64_tr_b16 a[114:115], v2 offset:20480
 ds_read_b64_tr_b16 a[116:117], v2 offset:18432
 ds_read_b64_tr_b16 a[118:119], v2 offset:22528
 ds_read_b64_tr_b16 a[120:121], v2 offset:24576
 ds_read_b64_tr_b16 a[122:123], v2 offset:28672
 ds_read_b64_tr_b16 a[124:125], v2 offset:26624
 ds_read_b64_tr_b16 a[126:127], v2 offset:30720
 v_add_u32 v2, 0x8000, v2
 s_waitcnt vmcnt(0)
 s_barrier
 ds_read_b64_tr_b16 a[128:129], v2 offset:0
 ds_read_b64_tr_b16 a[130:131], v2 offset:4096
 ds_read_b64_tr_b16 a[132:133], v2 offset:2048
 ds_read_b64_tr_b16 a[134:135], v2 offset:6144
 ds_read_b64_tr_b16 a[136:137], v2 offset:8192
 ds_read_b64_tr_b16 a[138:139], v2 offset:12288
 ds_read_b64_tr_b16 a[140:141], v2 offset:10240
 ds_read_b64_tr_b16 a[142:143], v2 offset:14336
 ds_read_b64_tr_b16 a[144:145], v2 offset:16384
 ds_read_b64_tr_b16 a[146:147], v2 offset:20480
 ds_read_b64_tr_b16 a[148:149], v2 offset:18432
 ds_read_b64_tr_b16 a[150:151], v2 offset:22528
 ds_read_b64_tr_b16 a[152:153], v2 offset:24576
 ds_read_b64_tr_b16 a[154:155], v2 offset:28672
 ds_read_b64_tr_b16 a[156:157], v2 offset:26624
 ds_read_b64_tr_b16 a[158:159], v2 offset:30720
 v_add_u32 v2, 0x8000, v2
 s_waitcnt lgkmcnt(0)
 s_barrier
 v_cmp_eq_u32 vcc, 0, v30
 s_cbranch_vccz L_qa_36
 s_mov_b32 s96, s44
 s_and_b32 s97, s45, 0xffff
 s_mov_b32 s98, 256
 s_mov_b32 s99, 0x00020000
 v_mov_b32 v1, 132
 s_mov_b32 s51, 0
 s_mov_b64 exec, 1
L_wb_37:
 buffer_load_dword v2, v1, s[96:99], 0 offen sc1
 s_waitcnt vmcnt(0)
 v_cmp_eq_u32 vcc, 0, v2
 s_cbranch_vccz L_wbd_38
 s_sleep 2
 s_add_u32 s51, s51, 1
 s_cmp_lt_u32 s51, 131072
 s_cbranch_scc1 L_wb_37
 s_branch L_bail
L_wbd_38:
 s_mov_b64 exec, -1
L_qa_36:
 s_lshl_b32 s64, s64, 8
 s_lshl_b32 s65, s65, 8
 s_lshl_b32 s66, s66, 8
 s_lshl_b32 s67, s67, 8
 s_lshl_b32 s68, s68, 8
 s_cmp_eq_u32 s53, 0
 s_cselect_b32 s78, 2, 3
 s_mov_b32 s79, 0
 v_lshrrev_b32 v1, 4, v0
 s_mov_b32 s3, 1280
 v_mul_lo_u32 v1, v1, s3
 v_and_b32 v3, 15, v0
 v_lshl_add_u32 v1, v3, 4, v1
 v_add_u32 v6, 5120, v1
 v_mov_b32 v24, v6
 v_and_b32 v2, 31, v0
 v_lshlrev_b32 v2, 8, v2
 v_lshrrev_b32 v4, 5, v0
 v_xor_b32 v4, v4, v3
 v_xor_b32 v8, 0, v4
 v_lshl_add_u32 v8, v8, 4, v2
 v_add_u32 v16, 40960, v8
 v_xor_b32 v9, 2, v4
 v_lshl_add_u32 v9, v9, 4, v2
 v_add_u32 v17, 40960, v9
 v_xor_b32 v10, 4, v4
 v_lshl_add_u32 v10, v10, 4, v2
 v_add_u32 v18, 40960, v10
 v_xor_b32 v11, 6, v4
 v_lshl_add_u32 v11, v11, 4, v2
 v_add_u32 v19, 40960, v11
 v_xor_b32 v12, 8, v4
 v_lshl_add_u32 v12, v12, 4, v2
 v_add_u32 v20, 40960, v12
 v_xor_b32 v13, 10, v4
 v_lshl_add_u32 v13, v13, 4, v2
 v_add_u32 v21, 40960, v13
 v_xor_b32 v14, 12, v4
 v_lshl_add_u32 v14, v14, 4, v2
 v_add_u32 v22, 40960, v14
 v_xor_b32 v15, 14, v4
 v_lshl_add_u32 v15, v15, 4, v2
 v_add_u32 v23, 40960, v15
 v_lshrrev_b32 v4, 5, v0
 v_lshlrev_b32 v4, 8, v4
 v_lshl_add_u32 v4, v3, 4, v4
 v_and_b32 v2, 16, v0
 v_lshl_add_u32 v4, v2, 8, v4
 s_lshl_b32 s3, s50, 10
 v_add_u32 v4, s3, v4
 v_mul_u32_u24 v5, 24576, v0
 v_mov_b32 v7, 163776
 v_mul_u32_u24 v30, 16384, v0
 s_lshl_b32 s75, s62, 2
 s_add_u32 s75, s75, s50
 s_and_b32 s100, s52, 1
 s_lshl_b32 s100, s100, 13
 s_lshl_b32 s58, s52, 14
 s_add_u32 s58, s58, s100
 s_add_u32 s58, s58, 8388608
 s_cmp_eq_u32 s53, 0
 s_cselect_b32 s82, 8192, 0
 s_lshl_b32 s59, s52, 8
 s_add_u32 s59, s59, 8192
 s_lshl_b32 s56, s50, 11
 s_mov_b32 s54, 0
 s_mov_b32 s61, 0
 s_mov_b32 s70, s75
 s_mul_i32 s55, s54, 40960
 s_mul_i32 s3, s50, 10240
 s_add_u32 s55, s55, s3
 s_add_u32 s55, s55, 226492416
 s_add_u32 m0, s56, 0
 s_add_u32 s3, s55, s64
 buffer_load_dwordx4 v1, s[4:7], s3 offen sc1 lds
 s_add_u32 m0, s56, 1024
 s_add_u32 s3, s55, s64
 buffer_load_dwordx4 v24, s[4:7], s3 offen sc1 lds
 s_add_u32 m0, s56, 8192
 s_add_u32 s3, s55, s65
 buffer_load_dwordx4 v1, s[4:7], s3 offen sc1 lds
 s_add_u32 m0, s56, 9216
 s_add_u32 s3, s55, s65
 buffer_load_dwordx4 v24, s[4:7], s3 offen sc1 lds
 s_add_u32 m0, s56, 16384
 s_add_u32 s3, s55, s66
 buffer_load_dwordx4 v1, s[4:7], s3 offen sc1 lds
 s_add_u32 m0, s56, 17408
 s_add_u32 s3, s55, s66
 buffer_load_dwordx4 v24, s[4:7], s3 offen sc1 lds
 s_add_u32 m0, s56, 24576
 s_add_u32 s3, s55, s67
 buffer_load_dwordx4 v1, s[4:7], s3 offen sc1 lds
 s_add_u32 m0, s56, 25600
 s_add_u32 s3, s55, s67
 buffer_load_dwordx4 v24, s[4:7], s3 offen sc1 lds
 s_add_u32 m0, s56, 32768
 s_add_u32 s3, s55, s68
 buffer_load_dwordx4 v1, s[4:7], s3 offen sc1 lds
 s_add_u32 m0, s56, 33792
 s_add_u32 s3, s55, s68
 buffer_load_dwordx4 v24, s[4:7], s3 offen sc1 lds
 s_waitcnt vmcnt(0)
L_qkvq_pre:
 s_barrier
 s_mov_b32 s60, s54
 s_add_u32 s54, s54, 1
 s_mul_i32 s55, s54, 40960
 s_mul_i32 s3, s50, 10240
 s_add_u32 s55, s55, s3
 s_add_u32 s55, s55, 226492416
 ds_read_b128 v[32:35], v8 offset:0
 ds_read_b128 v[36:39], v9 offset:0
 ds_read_b128 v[40:43], v10 offset:0
 ds_read_b128 v[44:47], v11 offset:0
 s_waitcnt lgkmcnt(3)
 v_mfma_f32_32x32x16_bf16 v[64:79], a[0:3], v[32:35], 0
 ds_read_b128 v[48:51], v12 offset:0
 s_add_u32 m0, s56, 40960
 s_add_u32 s3, s55, s64
 buffer_load_dwordx4 v1, s[4:7], s3 offen sc1 lds
 s_waitcnt lgkmcnt(3)
 v_mfma_f32_32x32x16_bf16 v[64:79], a[4:7], v[36:39], v[64:79]
 ds_read_b128 v[52:55], v13 offset:0
 s_waitcnt lgkmcnt(3)
 v_mfma_f32_32x32x16_bf16 v[64:79], a[8:11], v[40:43], v[64:79]
 ds_read_b128 v[56:59], v14 offset:0
 s_waitcnt lgkmcnt(3)
 v_mfma_f32_32x32x16_bf16 v[64:79], a[12:15], v[44:47], v[64:79]
 ds_read_b128 v[60:63], v15 offset:0
 s_add_u32 m0, s56, 41984
 s_add_u32 s3, s55, s64
 buffer_load_dwordx4 v24, s[4:7], s3 offen sc1 lds
 s_waitcnt lgkmcnt(3)
 v_mfma_f32_32x32x16_bf16 v[64:79], a[16:19], v[48:51], v[64:79]
 ds_read_b128 v[32:35], v8 offset:8192
 s_waitcnt lgkmcnt(3)
 v_mfma_f32_32x32x16_bf16 v[64:79], a[20:23], v[52:55], v[64:79]
 ds_read_b128 v[36:39], v9 offset:8192
 s_waitcnt lgkmcnt(3)
 v_mfma_f32_32x32x16_bf16 v[64:79], a[24:27], v[56:59], v[64:79]
 ds_read_b128 v[40:43], v10 offset:8192
 s_add_u32 m0, s56, 49152
 s_add_u32 s3, s55, s65
 buffer_load_dwordx4 v1, s[4:7], s3 offen sc1 lds
 s_waitcnt lgkmcnt(3)
 v_mfma_f32_32x32x16_bf16 v[64:79], a[28:31], v[60:63], v[64:79]
 ds_read_b128 v[44:47], v11 offset:8192
 s_waitcnt lgkmcnt(3)
 v_mfma_f32_32x32x16_bf16 v[64:79], a[32:35], v[32:35], v[64:79]
 ds_read_b128 v[48:51], v12 offset:8192
 s_waitcnt lgkmcnt(3)
 v_mfma_f32_32x32x16_bf16 v[64:79], a[36:39], v[36:39], v[64:79]
 ds_read_b128 v[52:55], v13 offset:8192
 s_add_u32 m0, s56, 50176
 s_add_u32 s3, s55, s65
 buffer_load_dwordx4 v24, s[4:7], s3 offen sc1 lds
 s_waitcnt lgkmcnt(3)
 v_mfma_f32_32x32x16_bf16 v[64:79], a[40:43], v[40:43], v[64:79]
 ds_read_b128 v[56:59], v14 offset:8192
 s_waitcnt lgkmcnt(3)
 v_mfma_f32_32x32x16_bf16 v[64:79], a[44:47], v[44:47], v[64:79]
 ds_read_b128 v[60:63], v15 offset:8192
 s_waitcnt lgkmcnt(3)
 v_mfma_f32_32x32x16_bf16 v[64:79], a[48:51], v[48:51], v[64:79]
 ds_read_b128 v[32:35], v8 offset:16384
 s_add_u32 m0, s56, 57344
 s_add_u32 s3, s55, s66
 buffer_load_dwordx4 v1, s[4:7], s3 offen sc1 lds
 s_waitcnt lgkmcnt(3)
 v_mfma_f32_32x32x16_bf16 v[64:79], a[52:55], v[52:55], v[64:79]
 ds_read_b128 v[36:39], v9 offset:16384
 s_waitcnt lgkmcnt(3)
 v_mfma_f32_32x32x16_bf16 v[64:79], a[56:59], v[56:59], v[64:79]
 ds_read_b128 v[40:43], v10 offset:16384
 s_waitcnt lgkmcnt(3)
 v_mfma_f32_32x32x16_bf16 v[64:79], a[60:63], v[60:63], v[64:79]
 ds_read_b128 v[44:47], v11 offset:16384
 s_add_u32 m0, s56, 58368
 s_add_u32 s3, s55, s66
 buffer_load_dwordx4 v24, s[4:7], s3 offen sc1 lds
 s_waitcnt lgkmcnt(3)
 v_mfma_f32_32x32x16_bf16 v[64:79], a[64:67], v[32:35], v[64:79]
 ds_read_b128 v[48:51], v12 offset:16384
 s_waitcnt lgkmcnt(3)
 v_mfma_f32_32x32x16_bf16 v[64:79], a[68:71], v[36:39], v[64:79]
 ds_read_b128 v[52:55], v13 offset:16384
 s_waitcnt lgkmcnt(3)
 v_mfma_f32_32x32x16_bf16 v[64:79], a[72:75], v[40:43], v[64:79]
 ds_read_b128 v[56:59], v14 offset:16384
 s_add_u32 m0, s56, 65536
 s_add_u32 s3, s55, s67
 buffer_load_dwordx4 v1, s[4:7], s3 offen sc1 lds
 s_waitcnt lgkmcnt(3)
 v_mfma_f32_32x32x16_bf16 v[64:79], a[76:79], v[44:47], v[64:79]
 ds_read_b128 v[60:63], v15 offset:16384
 s_waitcnt vmcnt(7)
 s_cmp_eq_u32 s61, 0
 s_cbranch_scc1 L_pf_39
 s_lshl_b32 s3, s61, 2
 s_add_u32 s3, s3, s59
 s_sub_u32 s3, s3, 4
 v_mov_b32 v3, 1
 s_mov_b64 exec, s[78:79]
 buffer_atomic_add v3, v30, s[4:7], s3 offen
 s_mov_b64 exec, -1
 s_mov_b32 s61, 0
L_pf_39:
 s_waitcnt lgkmcnt(3)
 v_mfma_f32_32x32x16_bf16 v[64:79], a[80:83], v[48:51], v[64:79]
 ds_read_b128 v[32:35], v8 offset:24576
 s_waitcnt lgkmcnt(3)
 v_mfma_f32_32x32x16_bf16 v[64:79], a[84:87], v[52:55], v[64:79]
 ds_read_b128 v[36:39], v9 offset:24576
 s_add_u32 m0, s56, 66560
 s_add_u32 s3, s55, s67
 buffer_load_dwordx4 v24, s[4:7], s3 offen sc1 lds
 s_waitcnt lgkmcnt(3)
 v_mfma_f32_32x32x16_bf16 v[64:79], a[88:91], v[56:59], v[64:79]
 ds_read_b128 v[40:43], v10 offset:24576
 s_waitcnt lgkmcnt(3)
 v_mfma_f32_32x32x16_bf16 v[64:79], a[92:95], v[60:63], v[64:79]
 ds_read_b128 v[44:47], v11 offset:24576
 s_waitcnt lgkmcnt(3)
 v_mfma_f32_32x32x16_bf16 v[64:79], a[96:99], v[32:35], v[64:79]
 ds_read_b128 v[48:51], v12 offset:24576
 s_add_u32 m0, s56, 73728
 s_add_u32 s3, s55, s68
 buffer_load_dwordx4 v1, s[4:7], s3 offen sc1 lds
 s_waitcnt lgkmcnt(3)
 v_mfma_f32_32x32x16_bf16 v[64:79], a[100:103], v[36:39], v[64:79]
 ds_read_b128 v[52:55], v13 offset:24576
 s_waitcnt lgkmcnt(3)
 v_mfma_f32_32x32x16_bf16 v[64:79], a[104:107], v[40:43], v[64:79]
 ds_read_b128 v[56:59], v14 offset:24576
 s_waitcnt lgkmcnt(3)
 v_mfma_f32_32x32x16_bf16 v[64:79], a[108:111], v[44:47], v[64:79]
 ds_read_b128 v[60:63], v15 offset:24576
 s_add_u32 m0, s56, 74752
 s_add_u32 s3, s55, s68
 buffer_load_dwordx4 v24, s[4:7], s3 offen sc1 lds
 s_waitcnt lgkmcnt(3)
 v_mfma_f32_32x32x16_bf16 v[64:79], a[112:115], v[48:51], v[64:79]
 ds_read_b128 v[32:35], v8 offset:32768
 s_waitcnt lgkmcnt(3)
 v_mfma_f32_32x32x16_bf16 v[64:79], a[116:119], v[52:55], v[64:79]
 ds_read_b128 v[36:39], v9 offset:32768
 s_waitcnt lgkmcnt(3)
 v_mfma_f32_32x32x16_bf16 v[64:79], a[120:123], v[56:59], v[64:79]
 ds_read_b128 v[40:43], v10 offset:32768
 s_waitcnt lgkmcnt(3)
 v_mfma_f32_32x32x16_bf16 v[64:79], a[124:127], v[60:63], v[64:79]
 ds_read_b128 v[44:47], v11 offset:32768
 s_waitcnt lgkmcnt(3)
 v_mfma_f32_32x32x16_bf16 v[64:79], a[128:131], v[32:35], v[64:79]
 ds_read_b128 v[48:51], v12 offset:32768
 s_waitcnt lgkmcnt(3)
 v_mfma_f32_32x32x16_bf16 v[64:79], a[132:135], v[36:39], v[64:79]
 ds_read_b128 v[52:55], v13 offset:32768
 s_waitcnt lgkmcnt(3)
 v_mfma_f32_32x32x16_bf16 v[64:79], a[136:139], v[40:43], v[64:79]
 ds_read_b128 v[56:59], v14 offset:32768
 s_waitcnt lgkmcnt(3)
 v_mfma_f32_32x32x16_bf16 v[64:79], a[140:143], v[44:47], v[64:79]
 ds_read_b128 v[60:63], v15 offset:32768
 s_waitcnt lgkmcnt(3)
 v_mfma_f32_32x32x16_bf16 v[64:79], a[144:147], v[48:51], v[64:79]
 s_waitcnt lgkmcnt(2)
 v_mfma_f32_32x32x16_bf16 v[64:79], a[148:151], v[52:55], v[64:79]
 s_waitcnt lgkmcnt(1)
 v_mfma_f32_32x32x16_bf16 v[64:79], a[152:155], v[56:59], v[64:79]
 s_waitcnt lgkmcnt(0)
 v_mfma_f32_32x32x16_bf16 v[64:79], a[156:159], v[60:63], v[64:79]
 s_lshl_b32 s3, s60, 19
 s_add_u32 s3, s3, s58
 s_xor_b32 s3, s3, s82
 s_nop 8
 v_cvt_pk_bf16_f32 v80, v64, v65
 v_cvt_pk_bf16_f32 v81, v66, v67
 v_cvt_pk_bf16_f32 v82, v72, v73
 v_cvt_pk_bf16_f32 v83, v74, v75
 buffer_store_dwordx4 v[80:83], v4, s[4:7], s3 offen offset:0 sc1
 v_cvt_pk_bf16_f32 v84, v68, v69
 v_cvt_pk_bf16_f32 v85, v70, v71
 v_cvt_pk_bf16_f32 v86, v76, v77
 v_cvt_pk_bf16_f32 v87, v78, v79
 buffer_store_dwordx4 v[84:87], v4, s[4:7], s3 offen offset:512 sc1
 s_mov_b32 s61, s54
 s_cmp_lg_u32 s54, 1
 s_cbranch_scc1 L_f1_40
 s_waitcnt vmcnt(0)
 s_cmp_eq_u32 s61, 0
 s_cbranch_scc1 L_pf_41
 s_lshl_b32 s3, s61, 2
 s_add_u32 s3, s3, s59
 s_sub_u32 s3, s3, 4
 v_mov_b32 v3, 1
 s_mov_b64 exec, s[78:79]
 buffer_atomic_add v3, v30, s[4:7], s3 offen
 s_mov_b64 exec, -1
 s_mov_b32 s61, 0
L_pf_41:
 s_mov_b32 s8, s38
 s_and_b32 s9, s39, 0xffff
 s_mov_b32 s10, 2621440
 s_mov_b32 s11, 0x00020000
 s_mov_b32 s12, s40
 s_and_b32 s13, s41, 0xffff
 s_mov_b32 s14, 1280
 s_mov_b32 s15, 0x00020000
 v_lshlrev_b32 v130, 4, v0
 s_lshl_b32 s73, s70, 12
 s_add_u32 s74, s73, 2
 buffer_load_dwordx4 v[96:99], v130, s[8:11], s73 offen offset:0
 buffer_load_dwordx4 v[100:103], v130, s[8:11], s73 offen offset:1024
 buffer_load_dwordx4 v[112:115], v130, s[8:11], s74 offen offset:0
 buffer_load_dwordx4 v[116:119], v130, s[8:11], s74 offen offset:1024
 s_lshl_b32 s3, s70, 1
 buffer_load_ushort v128, off, s[12:15], s3
 s_branch L_f2_42
L_f1_40:
 s_waitcnt vmcnt(2)
L_f2_42:
 s_barrier
 s_mov_b32 s60, s54
 s_add_u32 s54, s54, 1
 s_mul_i32 s55, s54, 40960
 s_mul_i32 s3, s50, 10240
 s_add_u32 s55, s55, s3
 s_add_u32 s55, s55, 226492416
 ds_read_b128 v[32:35], v16 offset:0
 ds_read_b128 v[36:39], v17 offset:0
 ds_read_b128 v[40:43], v18 offset:0
 ds_read_b128 v[44:47], v19 offset:0
 s_waitcnt lgkmcnt(3)
 v_mfma_f32_32x32x16_bf16 v[64:79], a[0:3], v[32:35], 0
 ds_read_b128 v[48:51], v20 offset:0
 s_add_u32 m0, s56, 0
 s_add_u32 s3, s55, s64
 buffer_load_dwordx4 v1, s[4:7], s3 offen sc1 lds
 s_waitcnt lgkmcnt(3)
 v_mfma_f32_32x32x16_bf16 v[64:79], a[4:7], v[36:39], v[64:79]
 ds_read_b128 v[52:55], v21 offset:0
 s_waitcnt lgkmcnt(3)
 v_mfma_f32_32x32x16_bf16 v[64:79], a[8:11], v[40:43], v[64:79]
 ds_read_b128 v[56:59], v22 offset:0
 s_waitcnt lgkmcnt(3)
 v_mfma_f32_32x32x16_bf16 v[64:79], a[12:15], v[44:47], v[64:79]
 ds_read_b128 v[60:63], v23 offset:0
 s_add_u32 m0, s56, 1024
 s_add_u32 s3, s55, s64
 buffer_load_dwordx4 v24, s[4:7], s3 offen sc1 lds
 s_waitcnt lgkmcnt(3)
 v_mfma_f32_32x32x16_bf16 v[64:79], a[16:19], v[48:51], v[64:79]
 ds_read_b128 v[32:35], v16 offset:8192
 s_waitcnt lgkmcnt(3)
 v_mfma_f32_32x32x16_bf16 v[64:79], a[20:23], v[52:55], v[64:79]
 ds_read_b128 v[36:39], v17 offset:8192
 s_waitcnt lgkmcnt(3)
 v_mfma_f32_32x32x16_bf16 v[64:79], a[24:27], v[56:59], v[64:79]
 ds_read_b128 v[40:43], v18 offset:8192
 s_add_u32 m0, s56, 8192
 s_add_u32 s3, s55, s65
 buffer_load_dwordx4 v1, s[4:7], s3 offen sc1 lds
 s_waitcnt lgkmcnt(3)
 v_mfma_f32_32x32x16_bf16 v[64:79], a[28:31], v[60:63], v[64:79]
 ds_read_b128 v[44:47], v19 offset:8192
 s_waitcnt lgkmcnt(3)
 v_mfma_f32_32x32x16_bf16 v[64:79], a[32:35], v[32:35], v[64:79]
 ds_read_b128 v[48:51], v20 offset:8192
 s_waitcnt lgkmcnt(3)
 v_mfma_f32_32x32x16_bf16 v[64:79], a[36:39], v[36:39], v[64:79]
 ds_read_b128 v[52:55], v21 offset:8192
 s_add_u32 m0, s56, 9216
 s_add_u32 s3, s55, s65
 buffer_load_dwordx4 v24, s[4:7], s3 offen sc1 lds
 s_waitcnt lgkmcnt(3)
 v_mfma_f32_32x32x16_bf16 v[64:79], a[40:43], v[40:43], v[64:79]
 ds_read_b128 v[56:59], v22 offset:8192
 s_waitcnt lgkmcnt(3)
 v_mfma_f32_32x32x16_bf16 v[64:79], a[44:47], v[44:47], v[64:79]
 ds_read_b128 v[60:63], v23 offset:8192
 s_waitcnt lgkmcnt(3)
 v_mfma_f32_32x32x16_bf16 v[64:79], a[48:51], v[48:51], v[64:79]
 ds_read_b128 v[32:35], v16 offset:16384
 s_add_u32 m0, s56, 16384
 s_add_u32 s3, s55, s66
 buffer_load_dwordx4 v1, s[4:7], s3 offen sc1 lds
 s_waitcnt lgkmcnt(3)
 v_mfma_f32_32x32x16_bf16 v[64:79], a[52:55], v[52:55], v[64:79]
 ds_read_b128 v[36:39], v17 offset:16384
 s_waitcnt lgkmcnt(3)
 v_mfma_f32_32x32x16_bf16 v[64:79], a[56:59], v[56:59], v[64:79]
 ds_read_b128 v[40:43], v18 offset:16384
 s_waitcnt lgkmcnt(3)
 v_mfma_f32_32x32x16_bf16 v[64:79], a[60:63], v[60:63], v[64:79]
 ds_read_b128 v[44:47], v19 offset:16384
 s_add_u32 m0, s56, 17408
 s_add_u32 s3, s55, s66
 buffer_load_dwordx4 v24, s[4:7], s3 offen sc1 lds
 s_waitcnt lgkmcnt(3)
 v_mfma_f32_32x32x16_bf16 v[64:79], a[64:67], v[32:35], v[64:79]
 ds_read_b128 v[48:51], v20 offset:16384
 s_waitcnt lgkmcnt(3)
 v_mfma_f32_32x32x16_bf16 v[64:79], a[68:71], v[36:39], v[64:79]
 ds_read_b128 v[52:55], v21 offset:16384
 s_waitcnt lgkmcnt(3)
 v_mfma_f32_32x32x16_bf16 v[64:79], a[72:75], v[40:43], v[64:79]
 ds_read_b128 v[56:59], v22 offset:16384
 s_add_u32 m0, s56, 24576
 s_add_u32 s3, s55, s67
 buffer_load_dwordx4 v1, s[4:7], s3 offen sc1 lds
 s_waitcnt lgkmcnt(3)
 v_mfma_f32_32x32x16_bf16 v[64:79], a[76:79], v[44:47], v[64:79]
 ds_read_b128 v[60:63], v23 offset:16384
 s_waitcnt vmcnt(7)
 s_cmp_eq_u32 s61, 0
 s_cbranch_scc1 L_pf_43
 s_lshl_b32 s3, s61, 2
 s_add_u32 s3, s3, s59
 s_sub_u32 s3, s3, 4
 v_mov_b32 v3, 1
 s_mov_b64 exec, s[78:79]
 buffer_atomic_add v3, v30, s[4:7], s3 offen
 s_mov_b64 exec, -1
 s_mov_b32 s61, 0
L_pf_43:
 s_waitcnt lgkmcnt(3)
 v_mfma_f32_32x32x16_bf16 v[64:79], a[80:83], v[48:51], v[64:79]
 ds_read_b128 v[32:35], v16 offset:24576
 s_waitcnt lgkmcnt(3)
 v_mfma_f32_32x32x16_bf16 v[64:79], a[84:87], v[52:55], v[64:79]
 ds_read_b128 v[36:39], v17 offset:24576
 s_add_u32 m0, s56, 25600
 s_add_u32 s3, s55, s67
 buffer_load_dwordx4 v24, s[4:7], s3 offen sc1 lds
 s_waitcnt lgkmcnt(3)
 v_mfma_f32_32x32x16_bf16 v[64:79], a[88:91], v[56:59], v[64:79]
 ds_read_b128 v[40:43], v18 offset:24576
 s_waitcnt lgkmcnt(3)
 v_mfma_f32_32x32x16_bf16 v[64:79], a[92:95], v[60:63], v[64:79]
 ds_read_b128 v[44:47], v19 offset:24576
 s_waitcnt lgkmcnt(3)
 v_mfma_f32_32x32x16_bf16 v[64:79], a[96:99], v[32:35], v[64:79]
 ds_read_b128 v[48:51], v20 offset:24576
 s_add_u32 m0, s56, 32768
 s_add_u32 s3, s55, s68
 buffer_load_dwordx4 v1, s[4:7], s3 offen sc1 lds
 s_waitcnt lgkmcnt(3)
 v_mfma_f32_32x32x16_bf16 v[64:79], a[100:103], v[36:39], v[64:79]
 ds_read_b128 v[52:55], v21 offset:24576
 s_waitcnt lgkmcnt(3)
 v_mfma_f32_32x32x16_bf16 v[64:79], a[104:107], v[40:43], v[64:79]
 ds_read_b128 v[56:59], v22 offset:24576
 s_waitcnt lgkmcnt(3)
 v_mfma_f32_32x32x16_bf16 v[64:79], a[108:111], v[44:47], v[64:79]
 ds_read_b128 v[60:63], v23 offset:24576
 s_add_u32 m0, s56, 33792
 s_add_u32 s3, s55, s68
 buffer_load_dwordx4 v24, s[4:7], s3 offen sc1 lds
 s_waitcnt lgkmcnt(3)
 v_mfma_f32_32x32x16_bf16 v[64:79], a[112:115], v[48:51], v[64:79]
 ds_read_b128 v[32:35], v16 offset:32768
 s_waitcnt lgkmcnt(3)
 v_mfma_f32_32x32x16_bf16 v[64:79], a[116:119], v[52:55], v[64:79]
 ds_read_b128 v[36:39], v17 offset:32768
 s_waitcnt lgkmcnt(3)
 v_mfma_f32_32x32x16_bf16 v[64:79], a[120:123], v[56:59], v[64:79]
 ds_read_b128 v[40:43], v18 offset:32768
 s_waitcnt lgkmcnt(3)
 v_mfma_f32_32x32x16_bf16 v[64:79], a[124:127], v[60:63], v[64:79]
 ds_read_b128 v[44:47], v19 offset:32768
 s_waitcnt lgkmcnt(3)
 v_mfma_f32_32x32x16_bf16 v[64:79], a[128:131], v[32:35], v[64:79]
 ds_read_b128 v[48:51], v20 offset:32768
 s_waitcnt lgkmcnt(3)
 v_mfma_f32_32x32x16_bf16 v[64:79], a[132:135], v[36:39], v[64:79]
 ds_read_b128 v[52:55], v21 offset:32768
 s_waitcnt lgkmcnt(3)
 v_mfma_f32_32x32x16_bf16 v[64:79], a[136:139], v[40:43], v[64:79]
 ds_read_b128 v[56:59], v22 offset:32768
 s_waitcnt lgkmcnt(3)
 v_mfma_f32_32x32x16_bf16 v[64:79], a[140:143], v[44:47], v[64:79]
 ds_read_b128 v[60:63], v23 offset:32768
 s_waitcnt lgkmcnt(3)
 v_mfma_f32_32x32x16_bf16 v[64:79], a[144:147], v[48:51], v[64:79]
 s_waitcnt lgkmcnt(2)
 v_mfma_f32_32x32x16_bf16 v[64:79], a[148:151], v[52:55], v[64:79]
 s_waitcnt lgkmcnt(1)
 v_mfma_f32_32x32x16_bf16 v[64:79], a[152:155], v[56:59], v[64:79]
 s_waitcnt lgkmcnt(0)
 v_mfma_f32_32x32x16_bf16 v[64:79], a[156:159], v[60:63], v[64:79]
 s_lshl_b32 s3, s60, 19
 s_add_u32 s3, s3, s58
 s_xor_b32 s3, s3, s82
 s_nop 8
 v_cvt_pk_bf16_f32 v88, v64, v65
 v_cvt_pk_bf16_f32 v89, v66, v67
 v_cvt_pk_bf16_f32 v90, v72, v73
 v_cvt_pk_bf16_f32 v91, v74, v75
 buffer_store_dwordx4 v[88:91], v4, s[4:7], s3 offen offset:0 sc1
 v_cvt_pk_bf16_f32 v92, v68, v69
 v_cvt_pk_bf16_f32 v93, v70, v71
 v_cvt_pk_bf16_f32 v94, v76, v77
 v_cvt_pk_bf16_f32 v95, v78, v79
 buffer_store_dwordx4 v[92:95], v4, s[4:7], s3 offen offset:512 sc1
 s_mov_b32 s61, s54
 s_waitcnt vmcnt(2)
 s_cmp_lg_u32 s54, 4
 s_cbranch_scc1 L_cv_44
 s_waitcnt vmcnt(0)
 s_cmp_eq_u32 s61, 0
 s_cbranch_scc1 L_pf_45
 s_lshl_b32 s3, s61, 2
 s_add_u32 s3, s3, s59
 s_sub_u32 s3, s3, 4
 v_mov_b32 v3, 1
 s_mov_b64 exec, s[78:79]
 buffer_atomic_add v3, v30, s[4:7], s3 offen
 s_mov_b64 exec, -1
 s_mov_b32 s61, 0
L_pf_45:
 s_mul_i32 s71, s50, 13312
 s_add_u32 s71, s71, 81920
 s_mov_b32 s70, s75
 s_mov_b32 s69, 640
 s_getpc_b64 s[76:77]
L_ca_46:
 s_add_u32 s76, s76, L_conv0-L_ca_46
 s_addc_u32 s77, s77, -1
 s_swappc_b64 s[76:77], s[76:77]
 s_waitcnt vmcnt(0)
 s_barrier
 s_cmp_lg_u32 s50, 3
 s_cbranch_scc1 L_ar_47
 s_mov_b32 s96, s44
 s_and_b32 s97, s45, 0xffff
 s_mov_b32 s98, 256
 s_mov_b32 s99, 0x00020000
 v_mov_b32 v1, 1
 s_mov_b64 exec, 1
 buffer_atomic_add v1, off, s[96:99], 0 offset:8 sc0
 s_waitcnt vmcnt(0)
 v_cmp_eq_u32 vcc, 159, v1
 s_cbranch_vccz L_aw_48
 buffer_store_dword v1, off, s[96:99], 0 offset:136 sc1
L_aw_48:
 s_mov_b64 exec, -1
L_ar_47:
 v_lshrrev_b32 v1, 4, v0
 s_mov_b32 s3, 1280
 v_mul_lo_u32 v1, v1, s3
 v_and_b32 v3, 15, v0
 v_lshl_add_u32 v1, v3, 4, v1
 v_add_u32 v6, 5120, v1
 v_mov_b32 v24, v6
 v_and_b32 v2, 31, v0
 v_lshlrev_b32 v2, 8, v2
 v_lshrrev_b32 v4, 5, v0
 v_xor_b32 v4, v4, v3
 v_xor_b32 v8, 0, v4
 v_lshl_add_u32 v8, v8, 4, v2
 v_add_u32 v16, 40960, v8
 v_xor_b32 v9, 2, v4
 v_lshl_add_u32 v9, v9, 4, v2
 v_add_u32 v17, 40960, v9
 v_xor_b32 v10, 4, v4
 v_lshl_add_u32 v10, v10, 4, v2
 v_add_u32 v18, 40960, v10
 v_xor_b32 v11, 6, v4
 v_lshl_add_u32 v11, v11, 4, v2
 v_add_u32 v19, 40960, v11
 v_xor_b32 v12, 8, v4
 v_lshl_add_u32 v12, v12, 4, v2
 v_add_u32 v20, 40960, v12
 v_xor_b32 v13, 10, v4
 v_lshl_add_u32 v13, v13, 4, v2
 v_add_u32 v21, 40960, v13
 v_xor_b32 v14, 12, v4
 v_lshl_add_u32 v14, v14, 4, v2
 v_add_u32 v22, 40960, v14
 v_xor_b32 v15, 14, v4
 v_lshl_add_u32 v15, v15, 4, v2
 v_add_u32 v23, 40960, v15
 v_lshrrev_b32 v4, 5, v0
 v_lshlrev_b32 v4, 8, v4
 v_lshl_add_u32 v4, v3, 4, v4
 v_and_b32 v2, 16, v0
 v_lshl_add_u32 v4, v2, 8, v4
 s_lshl_b32 s3, s50, 10
 v_add_u32 v4, s3, v4
 v_mul_u32_u24 v5, 24576, v0
 v_mov_b32 v7, 163776
 v_mul_u32_u24 v30, 16384, v0
L_cv_44:
 s_cmp_lg_u32 s54, 10
 s_cbranch_scc1 L_cb_49
 s_cmp_lg_u32 s50, 0
 s_cbranch_scc1 L_ww_50
 s_mov_b32 s96, s44
 s_and_b32 s97, s45, 0xffff
 s_mov_b32 s98, 256
 s_mov_b32 s99, 0x00020000
 v_mov_b32 v25, 200
 s_mov_b32 s51, 0
 s_mov_b64 exec, 1
L_wb_51:
 buffer_load_dword v26, v25, s[96:99], 0 offen sc1
 s_waitcnt vmcnt(0)
 v_cmp_eq_u32 vcc, 0, v26
 s_cbranch_vccz L_wbd_52
 s_sleep 2
 s_add_u32 s51, s51, 1
 s_cmp_lt_u32 s51, 131072
 s_cbranch_scc1 L_wb_51
 s_branch L_bail
L_wbd_52:
 s_mov_b64 exec, -1
L_ww_50:
 s_barrier
L_cb_49:
 s_cmp_lt_u32 s54, 16
 s_cbranch_scc1 L_qkvq_pre
 s_waitcnt vmcnt(0)
 s_cmp_eq_u32 s61, 0
 s_cbranch_scc1 L_pf_54
 s_lshl_b32 s3, s61, 2
 s_add_u32 s3, s3, s59
 s_sub_u32 s3, s3, 4
 v_mov_b32 v3, 1
 s_mov_b64 exec, s[78:79]
 buffer_atomic_add v3, v30, s[4:7], s3 offen
 s_mov_b64 exec, -1
 s_mov_b32 s61, 0
L_pf_54:
 s_lshl_b32 s62, s62, 8
 s_add_u32 s62, s62, 126976
 s_add_u32 s63, s59, 8128
L_qkvq_block:
 s_lshl_b32 s55, s54, 2
 s_add_u32 s55, s55, s62
 s_sub_u32 s55, s55, 64
 s_cmp_lg_u32 s50, 0
 s_cselect_b32 s3, 268435456, s55
 v_mov_b32 v6, 8
 s_mov_b64 exec, 15
 v_mov_b32 v6, 0
 buffer_atomic_add v6, v5, s[4:7], s3 offen sc0
 s_mov_b64 exec, -1
 s_waitcnt vmcnt(0)
 s_cmp_eq_u32 s61, 0
 s_cbranch_scc1 L_pf_57
 s_lshl_b32 s3, s61, 2
 s_add_u32 s3, s3, s59
 s_sub_u32 s3, s3, 4
 v_mov_b32 v3, 1
 s_mov_b64 exec, s[78:79]
 buffer_atomic_add v3, v30, s[4:7], s3 offen
 s_mov_b64 exec, -1
 s_mov_b32 s61, 0
L_pf_57:
 s_cmp_lg_u32 s50, 0
 s_cbranch_scc1 L_w_55
 v_cmp_gt_u32 vcc, 8, v6
 s_cbranch_vccz L_w_55
 s_mov_b32 s51, 0
 s_mov_b64 exec, 15
 v_mov_b32 v28, 0
 buffer_atomic_add v28, v5, s[4:7], s55 offen sc0
 s_sleep 5
L_wc_58:
 v_mov_b32 v29, 0
 buffer_atomic_add v29, v5, s[4:7], s55 offen sc0
 s_waitcnt vmcnt(1)
 v_cmp_gt_u32 vcc, 8, v28
 s_cbranch_vccz L_wcd_59
 v_mov_b32 v28, 0
 buffer_atomic_add v28, v5, s[4:7], s55 offen sc0
 s_waitcnt vmcnt(1)
 v_cmp_gt_u32 vcc, 8, v29
 s_cbranch_vccz L_wcd_59
 s_add_u32 s51, s51, 1
 s_cmp_lt_u32 s51, 131072
 s_cbranch_scc1 L_wc_58
 s_branch L_bail
L_wcd_59:
 s_mov_b64 exec, -1
L_w_55:
 s_barrier
 s_branch L_qkvq_loop
L_qkvq_fast:
 s_cmp_lg_u32 s54, 32
 s_cbranch_scc1 L_c2_61
 s_cmp_lg_u32 s50, 0
 s_cbranch_scc1 L_ww_62
 s_mov_b32 s96, s44
 s_and_b32 s97, s45, 0xffff
 s_mov_b32 s98, 256
 s_mov_b32 s99, 0x00020000
 v_mov_b32 v25, 140
 s_mov_b32 s51, 0
 s_mov_b64 exec, 1
L_wb_63:
 buffer_load_dword v26, v25, s[96:99], 0 offen sc1
 s_waitcnt vmcnt(0)
 v_cmp_eq_u32 vcc, 0, v26
 s_cbranch_vccz L_wbd_64
 s_sleep 2
 s_add_u32 s51, s51, 1
 s_cmp_lt_u32 s51, 131072
 s_cbranch_scc1 L_wb_63
 s_branch L_bail
L_wbd_64:
 s_mov_b64 exec, -1
L_ww_62:
 s_barrier
L_c2_61:
 s_sub_u32 s60, s54, 16
 s_lshl_b32 s70, s54, 2
 s_add_u32 s70, s70, s62
 s_sub_u32 s70, s70, 60
 s_cmp_lg_u32 s50, 0
 s_cselect_b32 s70, 268435456, s70
 s_min_u32 s51, s54, 63
 s_mul_i32 s55, s51, 40960
 s_mul_i32 s3, s50, 10240
 s_add_u32 s55, s55, s3
 s_add_u32 s55, s55, 226492416
 ds_read_b128 v[32:35], v16 offset:0
 ds_read_b128 v[36:39], v17 offset:0
 ds_read_b128 v[40:43], v18 offset:0
 ds_read_b128 v[44:47], v19 offset:0
 s_waitcnt lgkmcnt(3)
 v_mfma_f32_32x32x16_bf16 v[64:79], a[0:3], v[32:35], 0
 ds_read_b128 v[48:51], v20 offset:0
 s_add_u32 m0, s56, 0
 s_add_u32 s3, s55, s64
 buffer_load_dwordx4 v1, s[4:7], s3 offen sc1 lds
 s_waitcnt lgkmcnt(3)
 v_mfma_f32_32x32x16_bf16 v[64:79], a[4:7], v[36:39], v[64:79]
 ds_read_b128 v[52:55], v21 offset:0
 s_waitcnt lgkmcnt(3)
 v_mfma_f32_32x32x16_bf16 v[64:79], a[8:11], v[40:43], v[64:79]
 ds_read_b128 v[56:59], v22 offset:0
 s_waitcnt lgkmcnt(3)
 v_mfma_f32_32x32x16_bf16 v[64:79], a[12:15], v[44:47], v[64:79]
 ds_read_b128 v[60:63], v23 offset:0
 s_add_u32 m0, s56, 1024
 s_add_u32 s3, s55, s64
 buffer_load_dwordx4 v24, s[4:7], s3 offen sc1 lds
 s_waitcnt lgkmcnt(3)
 v_mfma_f32_32x32x16_bf16 v[64:79], a[16:19], v[48:51], v[64:79]
 ds_read_b128 v[32:35], v16 offset:8192
 s_waitcnt lgkmcnt(3)
 v_mfma_f32_32x32x16_bf16 v[64:79], a[20:23], v[52:55], v[64:79]
 ds_read_b128 v[36:39], v17 offset:8192
 s_waitcnt lgkmcnt(3)
 v_mfma_f32_32x32x16_bf16 v[64:79], a[24:27], v[56:59], v[64:79]
 ds_read_b128 v[40:43], v18 offset:8192
 s_add_u32 m0, s56, 8192
 s_add_u32 s3, s55, s65
 buffer_load_dwordx4 v1, s[4:7], s3 offen sc1 lds
 s_waitcnt lgkmcnt(3)
 v_mfma_f32_32x32x16_bf16 v[64:79], a[28:31], v[60:63], v[64:79]
 ds_read_b128 v[44:47], v19 offset:8192
 s_waitcnt lgkmcnt(3)
 v_mfma_f32_32x32x16_bf16 v[64:79], a[32:35], v[32:35], v[64:79]
 ds_read_b128 v[48:51], v20 offset:8192
 s_waitcnt lgkmcnt(3)
 v_mfma_f32_32x32x16_bf16 v[64:79], a[36:39], v[36:39], v[64:79]
 ds_read_b128 v[52:55], v21 offset:8192
 s_add_u32 m0, s56, 9216
 s_add_u32 s3, s55, s65
 buffer_load_dwordx4 v24, s[4:7], s3 offen sc1 lds
 s_waitcnt lgkmcnt(3)
 v_mfma_f32_32x32x16_bf16 v[64:79], a[40:43], v[40:43], v[64:79]
 ds_read_b128 v[56:59], v22 offset:8192
 s_waitcnt lgkmcnt(3)
 v_mfma_f32_32x32x16_bf16 v[64:79], a[44:47], v[44:47], v[64:79]
 ds_read_b128 v[60:63], v23 offset:8192
 s_waitcnt lgkmcnt(3)
 v_mfma_f32_32x32x16_bf16 v[64:79], a[48:51], v[48:51], v[64:79]
 ds_read_b128 v[32:35], v16 offset:16384
 s_add_u32 m0, s56, 16384
 s_add_u32 s3, s55, s66
 buffer_load_dwordx4 v1, s[4:7], s3 offen sc1 lds
 s_waitcnt lgkmcnt(3)
 v_mfma_f32_32x32x16_bf16 v[64:79], a[52:55], v[52:55], v[64:79]
 ds_read_b128 v[36:39], v17 offset:16384
 s_waitcnt lgkmcnt(3)
 v_mfma_f32_32x32x16_bf16 v[64:79], a[56:59], v[56:59], v[64:79]
 ds_read_b128 v[40:43], v18 offset:16384
 s_waitcnt lgkmcnt(3)
 v_mfma_f32_32x32x16_bf16 v[64:79], a[60:63], v[60:63], v[64:79]
 ds_read_b128 v[44:47], v19 offset:16384
 s_add_u32 m0, s56, 17408
 s_add_u32 s3, s55, s66
 buffer_load_dwordx4 v24, s[4:7], s3 offen sc1 lds
 s_waitcnt lgkmcnt(3)
 v_mfma_f32_32x32x16_bf16 v[64:79], a[64:67], v[32:35], v[64:79]
 ds_read_b128 v[48:51], v20 offset:16384
 s_waitcnt lgkmcnt(3)
 v_mfma_f32_32x32x16_bf16 v[64:79], a[68:71], v[36:39], v[64:79]
 ds_read_b128 v[52:55], v21 offset:16384
 s_waitcnt lgkmcnt(3)
 v_mfma_f32_32x32x16_bf16 v[64:79], a[72:75], v[40:43], v[64:79]
 ds_read_b128 v[56:59], v22 offset:16384
 s_add_u32 m0, s56, 24576
 s_add_u32 s3, s55, s67
 buffer_load_dwordx4 v1, s[4:7], s3 offen sc1 lds
 s_waitcnt lgkmcnt(3)
 v_mfma_f32_32x32x16_bf16 v[64:79], a[76:79], v[44:47], v[64:79]
 ds_read_b128 v[60:63], v23 offset:16384
 s_waitcnt lgkmcnt(3)
 v_mfma_f32_32x32x16_bf16 v[64:79], a[80:83], v[48:51], v[64:79]
 ds_read_b128 v[32:35], v16 offset:24576
 s_waitcnt lgkmcnt(3)
 v_mfma_f32_32x32x16_bf16 v[64:79], a[84:87], v[52:55], v[64:79]
 ds_read_b128 v[36:39], v17 offset:24576
 s_add_u32 m0, s56, 25600
 s_add_u32 s3, s55, s67
 buffer_load_dwordx4 v24, s[4:7], s3 offen sc1 lds
 s_waitcnt lgkmcnt(3)
 v_mfma_f32_32x32x16_bf16 v[64:79], a[88:91], v[56:59], v[64:79]
 ds_read_b128 v[40:43], v18 offset:24576
 s_waitcnt lgkmcnt(3)
 v_mfma_f32_32x32x16_bf16 v[64:79], a[92:95], v[60:63], v[64:79]
 ds_read_b128 v[44:47], v19 offset:24576
 s_waitcnt lgkmcnt(3)
 v_mfma_f32_32x32x16_bf16 v[64:79], a[96:99], v[32:35], v[64:79]
 ds_read_b128 v[48:51], v20 offset:24576
 s_add_u32 m0, s56, 32768
 s_add_u32 s3, s55, s68
 buffer_load_dwordx4 v1, s[4:7], s3 offen sc1 lds
 s_waitcnt lgkmcnt(3)
 v_mfma_f32_32x32x16_bf16 v[64:79], a[100:103], v[36:39], v[64:79]
 ds_read_b128 v[52:55], v21 offset:24576
 s_waitcnt lgkmcnt(3)
 v_mfma_f32_32x32x16_bf16 v[64:79], a[104:107], v[40:43], v[64:79]
 ds_read_b128 v[56:59], v22 offset:24576
 s_waitcnt lgkmcnt(3)
 v_mfma_f32_32x32x16_bf16 v[64:79], a[108:111], v[44:47], v[64:79]
 ds_read_b128 v[60:63], v23 offset:24576
 s_add_u32 m0, s56, 33792
 s_add_u32 s3, s55, s68
 buffer_load_dwordx4 v24, s[4:7], s3 offen sc1 lds
 s_waitcnt lgkmcnt(3)
 v_mfma_f32_32x32x16_bf16 v[64:79], a[112:115], v[48:51], v[64:79]
 ds_read_b128 v[32:35], v16 offset:32768
 s_waitcnt lgkmcnt(3)
 v_mfma_f32_32x32x16_bf16 v[64:79], a[116:119], v[52:55], v[64:79]
 ds_read_b128 v[36:39], v17 offset:32768
 v_mov_b32 v6, 8
 s_mov_b64 exec, 15
 v_mov_b32 v6, 0
 buffer_atomic_add v6, v5, s[4:7], s70 offen sc0
 s_mov_b64 exec, -1
 s_waitcnt lgkmcnt(3)
 v_mfma_f32_32x32x16_bf16 v[64:79], a[120:123], v[56:59], v[64:79]
 ds_read_b128 v[40:43], v18 offset:32768
 s_waitcnt lgkmcnt(3)
 v_mfma_f32_32x32x16_bf16 v[64:79], a[124:127], v[60:63], v[64:79]
 ds_read_b128 v[44:47], v19 offset:32768
 s_waitcnt lgkmcnt(3)
 v_mfma_f32_32x32x16_bf16 v[64:79], a[128:131], v[32:35], v[64:79]
 ds_read_b128 v[48:51], v20 offset:32768
 s_waitcnt lgkmcnt(3)
 v_mfma_f32_32x32x16_bf16 v[64:79], a[132:135], v[36:39], v[64:79]
 ds_read_b128 v[52:55], v21 offset:32768
 s_waitcnt lgkmcnt(3)
 v_mfma_f32_32x32x16_bf16 v[64:79], a[136:139], v[40:43], v[64:79]
 ds_read_b128 v[56:59], v22 offset:32768
 s_waitcnt lgkmcnt(3)
 v_mfma_f32_32x32x16_bf16 v[64:79], a[140:143], v[44:47], v[64:79]
 ds_read_b128 v[60:63], v23 offset:32768
 s_waitcnt lgkmcnt(3)
 v_mfma_f32_32x32x16_bf16 v[64:79], a[144:147], v[48:51], v[64:79]
 s_waitcnt lgkmcnt(2)
 v_mfma_f32_32x32x16_bf16 v[64:79], a[148:151], v[52:55], v[64:79]
 s_waitcnt lgkmcnt(1)
 v_mfma_f32_32x32x16_bf16 v[64:79], a[152:155], v[56:59], v[64:79]
 s_waitcnt lgkmcnt(0)
 v_mfma_f32_32x32x16_bf16 v[64:79], a[156:159], v[60:63], v[64:79]
 s_lshl_b32 s3, s60, 19
 s_add_u32 s3, s3, s58
 s_xor_b32 s3, s3, s82
 s_add_u32 s3, s3, 33554432
 s_nop 8
 v_cvt_pk_bf16_f32 v88, v64, v65
 v_cvt_pk_bf16_f32 v89, v66, v67
 v_cvt_pk_bf16_f32 v90, v72, v73
 v_cvt_pk_bf16_f32 v91, v74, v75
 buffer_store_dwordx4 v[88:91], v4, s[4:7], s3 offen offset:0 sc1
 v_cvt_pk_bf16_f32 v92, v68, v69
 v_cvt_pk_bf16_f32 v93, v70, v71
 v_cvt_pk_bf16_f32 v94, v76, v77
 v_cvt_pk_bf16_f32 v95, v78, v79
 buffer_store_dwordx4 v[92:95], v4, s[4:7], s3 offen offset:512 sc1
 s_branch L_qkvq_mid
L_qkvq_loop:
 s_cmp_lg_u32 s54, 32
 s_cbranch_scc1 L_c2_65
 s_cmp_lg_u32 s50, 0
 s_cbranch_scc1 L_ww_66
 s_mov_b32 s96, s44
 s_and_b32 s97, s45, 0xffff
 s_mov_b32 s98, 256
 s_mov_b32 s99, 0x00020000
 v_mov_b32 v25, 140
 s_mov_b32 s51, 0
 s_mov_b64 exec, 1
L_wb_67:
 buffer_load_dword v26, v25, s[96:99], 0 offen sc1
 s_waitcnt vmcnt(0)
 v_cmp_eq_u32 vcc, 0, v26
 s_cbranch_vccz L_wbd_68
 s_sleep 2
 s_add_u32 s51, s51, 1
 s_cmp_lt_u32 s51, 131072
 s_cbranch_scc1 L_wb_67
 s_branch L_bail
L_wbd_68:
 s_mov_b64 exec, -1
L_ww_66:
 s_barrier
L_c2_65:
 s_sub_u32 s60, s54, 16
 s_mul_i32 s55, s60, 40960
 s_mul_i32 s3, s50, 10240
 s_add_u32 s55, s55, s3
 s_add_u32 s55, s55, 229113856
 s_add_u32 m0, s56, 40960
 s_add_u32 s3, s55, s64
 buffer_load_dwordx4 v1, s[4:7], s3 offen sc1 lds
 s_add_u32 m0, s56, 41984
 s_add_u32 s3, s55, s64
 buffer_load_dwordx4 v24, s[4:7], s3 offen sc1 lds
 s_add_u32 m0, s56, 49152
 s_add_u32 s3, s55, s65
 buffer_load_dwordx4 v1, s[4:7], s3 offen sc1 lds
 s_add_u32 m0, s56, 50176
 s_add_u32 s3, s55, s65
 buffer_load_dwordx4 v24, s[4:7], s3 offen sc1 lds
 s_add_u32 m0, s56, 57344
 s_add_u32 s3, s55, s66
 buffer_load_dwordx4 v1, s[4:7], s3 offen sc1 lds
 s_add_u32 m0, s56, 58368
 s_add_u32 s3, s55, s66
 buffer_load_dwordx4 v24, s[4:7], s3 offen sc1 lds
 s_add_u32 m0, s56, 65536
 s_add_u32 s3, s55, s67
 buffer_load_dwordx4 v1, s[4:7], s3 offen sc1 lds
 s_add_u32 m0, s56, 66560
 s_add_u32 s3, s55, s67
 buffer_load_dwordx4 v24, s[4:7], s3 offen sc1 lds
 s_add_u32 m0, s56, 73728
 s_add_u32 s3, s55, s68
 buffer_load_dwordx4 v1, s[4:7], s3 offen sc1 lds
 s_add_u32 m0, s56, 74752
 s_add_u32 s3, s55, s68
 buffer_load_dwordx4 v24, s[4:7], s3 offen sc1 lds
 s_lshl_b32 s70, s54, 2
 s_add_u32 s70, s70, s62
 s_sub_u32 s70, s70, 60
 s_cmp_lg_u32 s50, 0
 s_cselect_b32 s70, 268435456, s70
 s_min_u32 s51, s54, 63
 s_mul_i32 s55, s51, 40960
 s_mul_i32 s3, s50, 10240
 s_add_u32 s55, s55, s3
 s_add_u32 s55, s55, 226492416
 s_waitcnt vmcnt(8)
 s_barrier
 ds_read_b128 v[32:35], v16 offset:0
 ds_read_b128 v[36:39], v17 offset:0
 ds_read_b128 v[40:43], v18 offset:0
 ds_read_b128 v[44:47], v19 offset:0
 s_waitcnt lgkmcnt(3)
 v_mfma_f32_32x32x16_bf16 v[64:79], a[0:3], v[32:35], 0
 ds_read_b128 v[48:51], v20 offset:0
 s_add_u32 m0, s56, 0
 s_add_u32 s3, s55, s64
 buffer_load_dwordx4 v1, s[4:7], s3 offen sc1 lds
 s_waitcnt lgkmcnt(3)
 v_mfma_f32_32x32x16_bf16 v[64:79], a[4:7], v[36:39], v[64:79]
 ds_read_b128 v[52:55], v21 offset:0
 s_waitcnt lgkmcnt(3)
 v_mfma_f32_32x32x16_bf16 v[64:79], a[8:11], v[40:43], v[64:79]
 ds_read_b128 v[56:59], v22 offset:0
 s_waitcnt lgkmcnt(3)
 v_mfma_f32_32x32x16_bf16 v[64:79], a[12:15], v[44:47], v[64:79]
 ds_read_b128 v[60:63], v23 offset:0
 s_add_u32 m0, s56, 1024
 s_add_u32 s3, s55, s64
 buffer_load_dwordx4 v24, s[4:7], s3 offen sc1 lds
 s_waitcnt lgkmcnt(3)
 v_mfma_f32_32x32x16_bf16 v[64:79], a[16:19], v[48:51], v[64:79]
 s_waitcnt vmcnt(8)
 s_barrier
 ds_read_b128 v[32:35], v16 offset:8192
 s_waitcnt lgkmcnt(3)
 v_mfma_f32_32x32x16_bf16 v[64:79], a[20:23], v[52:55], v[64:79]
 ds_read_b128 v[36:39], v17 offset:8192
 s_waitcnt lgkmcnt(3)
 v_mfma_f32_32x32x16_bf16 v[64:79], a[24:27], v[56:59], v[64:79]
 ds_read_b128 v[40:43], v18 offset:8192
 s_add_u32 m0, s56, 8192
 s_add_u32 s3, s55, s65
 buffer_load_dwordx4 v1, s[4:7], s3 offen sc1 lds
 s_waitcnt lgkmcnt(3)
 v_mfma_f32_32x32x16_bf16 v[64:79], a[28:31], v[60:63], v[64:79]
 ds_read_b128 v[44:47], v19 offset:8192
 s_waitcnt lgkmcnt(3)
 v_mfma_f32_32x32x16_bf16 v[64:79], a[32:35], v[32:35], v[64:79]
 ds_read_b128 v[48:51], v20 offset:8192
 s_waitcnt lgkmcnt(3)
 v_mfma_f32_32x32x16_bf16 v[64:79], a[36:39], v[36:39], v[64:79]
 ds_read_b128 v[52:55], v21 offset:8192
 s_add_u32 m0, s56, 9216
 s_add_u32 s3, s55, s65
 buffer_load_dwordx4 v24, s[4:7], s3 offen sc1 lds
 s_waitcnt lgkmcnt(3)
 v_mfma_f32_32x32x16_bf16 v[64:79], a[40:43], v[40:43], v[64:79]
 ds_read_b128 v[56:59], v22 offset:8192
 s_waitcnt lgkmcnt(3)
 v_mfma_f32_32x32x16_bf16 v[64:79], a[44:47], v[44:47], v[64:79]
 ds_read_b128 v[60:63], v23 offset:8192
 s_waitcnt lgkmcnt(3)
 v_mfma_f32_32x32x16_bf16 v[64:79], a[48:51], v[48:51], v[64:79]
 s_waitcnt vmcnt(8)
 s_barrier
 ds_read_b128 v[32:35], v16 offset:16384
 s_add_u32 m0, s56, 16384
 s_add_u32 s3, s55, s66
 buffer_load_dwordx4 v1, s[4:7], s3 offen sc1 lds
 s_waitcnt lgkmcnt(3)
 v_mfma_f32_32x32x16_bf16 v[64:79], a[52:55], v[52:55], v[64:79]
 ds_read_b128 v[36:39], v17 offset:16384
 s_waitcnt lgkmcnt(3)
 v_mfma_f32_32x32x16_bf16 v[64:79], a[56:59], v[56:59], v[64:79]
 ds_read_b128 v[40:43], v18 offset:16384
 s_waitcnt lgkmcnt(3)
 v_mfma_f32_32x32x16_bf16 v[64:79], a[60:63], v[60:63], v[64:79]
 ds_read_b128 v[44:47], v19 offset:16384
 s_add_u32 m0, s56, 17408
 s_add_u32 s3, s55, s66
 buffer_load_dwordx4 v24, s[4:7], s3 offen sc1 lds
 s_waitcnt lgkmcnt(3)
 v_mfma_f32_32x32x16_bf16 v[64:79], a[64:67], v[32:35], v[64:79]
 ds_read_b128 v[48:51], v20 offset:16384
 s_waitcnt lgkmcnt(3)
 v_mfma_f32_32x32x16_bf16 v[64:79], a[68:71], v[36:39], v[64:79]
 ds_read_b128 v[52:55], v21 offset:16384
 s_waitcnt lgkmcnt(3)
 v_mfma_f32_32x32x16_bf16 v[64:79], a[72:75], v[40:43], v[64:79]
 ds_read_b128 v[56:59], v22 offset:16384
 s_add_u32 m0, s56, 24576
 s_add_u32 s3, s55, s67
 buffer_load_dwordx4 v1, s[4:7], s3 offen sc1 lds
 s_waitcnt lgkmcnt(3)
 v_mfma_f32_32x32x16_bf16 v[64:79], a[76:79], v[44:47], v[64:79]
 ds_read_b128 v[60:63], v23 offset:16384
 s_waitcnt lgkmcnt(3)
 v_mfma_f32_32x32x16_bf16 v[64:79], a[80:83], v[48:51], v[64:79]
 s_waitcnt vmcnt(9)
 s_barrier
 ds_read_b128 v[32:35], v16 offset:24576
 s_waitcnt lgkmcnt(3)
 v_mfma_f32_32x32x16_bf16 v[64:79], a[84:87], v[52:55], v[64:79]
 ds_read_b128 v[36:39], v17 offset:24576
 s_add_u32 m0, s56, 25600
 s_add_u32 s3, s55, s67
 buffer_load_dwordx4 v24, s[4:7], s3 offen sc1 lds
 s_waitcnt lgkmcnt(3)
 v_mfma_f32_32x32x16_bf16 v[64:79], a[88:91], v[56:59], v[64:79]
 ds_read_b128 v[40:43], v18 offset:24576
 s_waitcnt lgkmcnt(3)
 v_mfma_f32_32x32x16_bf16 v[64:79], a[92:95], v[60:63], v[64:79]
 ds_read_b128 v[44:47], v19 offset:24576
 s_waitcnt lgkmcnt(3)
 v_mfma_f32_32x32x16_bf16 v[64:79], a[96:99], v[32:35], v[64:79]
 ds_read_b128 v[48:51], v20 offset:24576
 s_add_u32 m0, s56, 32768
 s_add_u32 s3, s55, s68
 buffer_load_dwordx4 v1, s[4:7], s3 offen sc1 lds
 s_waitcnt lgkmcnt(3)
 v_mfma_f32_32x32x16_bf16 v[64:79], a[100:103], v[36:39], v[64:79]
 ds_read_b128 v[52:55], v21 offset:24576
 s_waitcnt lgkmcnt(3)
 v_mfma_f32_32x32x16_bf16 v[64:79], a[104:107], v[40:43], v[64:79]
 ds_read_b128 v[56:59], v22 offset:24576
 s_waitcnt lgkmcnt(3)
 v_mfma_f32_32x32x16_bf16 v[64:79], a[108:111], v[44:47], v[64:79]
 ds_read_b128 v[60:63], v23 offset:24576
 s_add_u32 m0, s56, 33792
 s_add_u32 s3, s55, s68
 buffer_load_dwordx4 v24, s[4:7], s3 offen sc1 lds
 s_waitcnt lgkmcnt(3)
 v_mfma_f32_32x32x16_bf16 v[64:79], a[112:115], v[48:51], v[64:79]
 s_waitcnt vmcnt(10)
 s_barrier
 ds_read_b128 v[32:35], v16 offset:32768
 s_waitcnt lgkmcnt(3)
 v_mfma_f32_32x32x16_bf16 v[64:79], a[116:119], v[52:55], v[64:79]
 ds_read_b128 v[36:39], v17 offset:32768
 v_mov_b32 v6, 8
 s_mov_b64 exec, 15
 v_mov_b32 v6, 0
 buffer_atomic_add v6, v5, s[4:7], s70 offen sc0
 s_mov_b64 exec, -1
 s_waitcnt lgkmcnt(3)
 v_mfma_f32_32x32x16_bf16 v[64:79], a[120:123], v[56:59], v[64:79]
 ds_read_b128 v[40:43], v18 offset:32768
 s_waitcnt lgkmcnt(3)
 v_mfma_f32_32x32x16_bf16 v[64:79], a[124:127], v[60:63], v[64:79]
 ds_read_b128 v[44:47], v19 offset:32768
 s_waitcnt lgkmcnt(3)
 v_mfma_f32_32x32x16_bf16 v[64:79], a[128:131], v[32:35], v[64:79]
 ds_read_b128 v[48:51], v20 offset:32768
 s_waitcnt lgkmcnt(3)
 v_mfma_f32_32x32x16_bf16 v[64:79], a[132:135], v[36:39], v[64:79]
 ds_read_b128 v[52:55], v21 offset:32768
 s_waitcnt lgkmcnt(3)
 v_mfma_f32_32x32x16_bf16 v[64:79], a[136:139], v[40:43], v[64:79]
 ds_read_b128 v[56:59], v22 offset:32768
 s_waitcnt lgkmcnt(3)
 v_mfma_f32_32x32x16_bf16 v[64:79], a[140:143], v[44:47], v[64:79]
 ds_read_b128 v[60:63], v23 offset:32768
 s_waitcnt lgkmcnt(3)
 v_mfma_f32_32x32x16_bf16 v[64:79], a[144:147], v[48:51], v[64:79]
 s_waitcnt lgkmcnt(2)
 v_mfma_f32_32x32x16_bf16 v[64:79], a[148:151], v[52:55], v[64:79]
 s_waitcnt lgkmcnt(1)
 v_mfma_f32_32x32x16_bf16 v[64:79], a[152:155], v[56:59], v[64:79]
 s_waitcnt lgkmcnt(0)
 v_mfma_f32_32x32x16_bf16 v[64:79], a[156:159], v[60:63], v[64:79]
 s_lshl_b32 s3, s60, 19
 s_add_u32 s3, s3, s58
 s_xor_b32 s3, s3, s82
 s_add_u32 s3, s3, 33554432
 s_nop 8
 v_cvt_pk_bf16_f32 v88, v64, v65
 v_cvt_pk_bf16_f32 v89, v66, v67
 v_cvt_pk_bf16_f32 v90, v72, v73
 v_cvt_pk_bf16_f32 v91, v74, v75
 buffer_store_dwordx4 v[88:91], v4, s[4:7], s3 offen offset:0 sc1
 v_cvt_pk_bf16_f32 v92, v68, v69
 v_cvt_pk_bf16_f32 v93, v70, v71
 v_cvt_pk_bf16_f32 v94, v76, v77
 v_cvt_pk_bf16_f32 v95, v78, v79
 buffer_store_dwordx4 v[92:95], v4, s[4:7], s3 offen offset:512 sc1
L_qkvq_mid:
 s_cmp_ge_u32 s54, 64
 s_cbranch_scc1 L_n0_60
 s_waitcnt vmcnt(2)
 s_cmp_lg_u32 s50, 0
 s_cbranch_scc1 L_w_69
 v_cmp_gt_u32 vcc, 8, v6
 s_nop 1
 v_mov_b32 v3, vcc_lo
 ds_write_b32 v7, v3
 s_waitcnt lgkmcnt(0)
L_w_69:
 s_barrier
 ds_read_b32 v3, v7
 s_waitcnt lgkmcnt(0)
 v_readfirstlane_b32 s3, v3
 s_mov_b32 s69, s3
 s_add_u32 s51, s60, 1
 s_mov_b32 s60, s54
 s_mul_i32 s55, s51, 40960
 s_mul_i32 s3, s50, 10240
 s_add_u32 s55, s55, s3
 s_add_u32 s55, s55, 229113856
 s_cmp_eq_u32 s69, 0
 s_cselect_b32 s55, s55, 268435456
 ds_read_b128 v[32:35], v8 offset:0
 ds_read_b128 v[36:39], v9 offset:0
 ds_read_b128 v[40:43], v10 offset:0
 ds_read_b128 v[44:47], v11 offset:0
 s_waitcnt lgkmcnt(3)
 v_mfma_f32_32x32x16_bf16 v[64:79], a[0:3], v[32:35], 0
 ds_read_b128 v[48:51], v12 offset:0
 s_add_u32 m0, s56, 40960
 s_add_u32 s3, s55, s64
 buffer_load_dwordx4 v1, s[4:7], s3 offen sc1 lds
 s_waitcnt lgkmcnt(3)
 v_mfma_f32_32x32x16_bf16 v[64:79], a[4:7], v[36:39], v[64:79]
 ds_read_b128 v[52:55], v13 offset:0
 s_waitcnt lgkmcnt(3)
 v_mfma_f32_32x32x16_bf16 v[64:79], a[8:11], v[40:43], v[64:79]
 ds_read_b128 v[56:59], v14 offset:0
 s_waitcnt lgkmcnt(3)
 v_mfma_f32_32x32x16_bf16 v[64:79], a[12:15], v[44:47], v[64:79]
 ds_read_b128 v[60:63], v15 offset:0
 s_add_u32 m0, s56, 41984
 s_add_u32 s3, s55, s64
 buffer_load_dwordx4 v24, s[4:7], s3 offen sc1 lds
 s_waitcnt lgkmcnt(3)
 v_mfma_f32_32x32x16_bf16 v[64:79], a[16:19], v[48:51], v[64:79]
 ds_read_b128 v[32:35], v8 offset:8192
 s_waitcnt lgkmcnt(3)
 v_mfma_f32_32x32x16_bf16 v[64:79], a[20:23], v[52:55], v[64:79]
 ds_read_b128 v[36:39], v9 offset:8192
 s_waitcnt lgkmcnt(3)
 v_mfma_f32_32x32x16_bf16 v[64:79], a[24:27], v[56:59], v[64:79]
 ds_read_b128 v[40:43], v10 offset:8192
 s_add_u32 m0, s56, 49152
 s_add_u32 s3, s55, s65
 buffer_load_dwordx4 v1, s[4:7], s3 offen sc1 lds
 s_waitcnt lgkmcnt(3)
 v_mfma_f32_32x32x16_bf16 v[64:79], a[28:31], v[60:63], v[64:79]
 ds_read_b128 v[44:47], v11 offset:8192
 s_waitcnt lgkmcnt(3)
 v_mfma_f32_32x32x16_bf16 v[64:79], a[32:35], v[32:35], v[64:79]
 ds_read_b128 v[48:51], v12 offset:8192
 s_waitcnt lgkmcnt(3)
 v_mfma_f32_32x32x16_bf16 v[64:79], a[36:39], v[36:39], v[64:79]
 ds_read_b128 v[52:55], v13 offset:8192
 s_add_u32 m0, s56, 50176
 s_add_u32 s3, s55, s65
 buffer_load_dwordx4 v24, s[4:7], s3 offen sc1 lds
 s_waitcnt lgkmcnt(3)
 v_mfma_f32_32x32x16_bf16 v[64:79], a[40:43], v[40:43], v[64:79]
 ds_read_b128 v[56:59], v14 offset:8192
 s_waitcnt lgkmcnt(3)
 v_mfma_f32_32x32x16_bf16 v[64:79], a[44:47], v[44:47], v[64:79]
 ds_read_b128 v[60:63], v15 offset:8192
 s_waitcnt lgkmcnt(3)
 v_mfma_f32_32x32x16_bf16 v[64:79], a[48:51], v[48:51], v[64:79]
 ds_read_b128 v[32:35], v8 offset:16384
 s_add_u32 m0, s56, 57344
 s_add_u32 s3, s55, s66
 buffer_load_dwordx4 v1, s[4:7], s3 offen sc1 lds
 s_waitcnt lgkmcnt(3)
 v_mfma_f32_32x32x16_bf16 v[64:79], a[52:55], v[52:55], v[64:79]
 ds_read_b128 v[36:39], v9 offset:16384
 s_waitcnt lgkmcnt(3)
 v_mfma_f32_32x32x16_bf16 v[64:79], a[56:59], v[56:59], v[64:79]
 ds_read_b128 v[40:43], v10 offset:16384
 s_waitcnt lgkmcnt(3)
 v_mfma_f32_32x32x16_bf16 v[64:79], a[60:63], v[60:63], v[64:79]
 ds_read_b128 v[44:47], v11 offset:16384
 s_add_u32 m0, s56, 58368
 s_add_u32 s3, s55, s66
 buffer_load_dwordx4 v24, s[4:7], s3 offen sc1 lds
 s_waitcnt lgkmcnt(3)
 v_mfma_f32_32x32x16_bf16 v[64:79], a[64:67], v[32:35], v[64:79]
 ds_read_b128 v[48:51], v12 offset:16384
 s_waitcnt lgkmcnt(3)
 v_mfma_f32_32x32x16_bf16 v[64:79], a[68:71], v[36:39], v[64:79]
 ds_read_b128 v[52:55], v13 offset:16384
 s_waitcnt vmcnt(6)
 s_lshl_b32 s3, s54, 2
 s_add_u32 s3, s3, s63
 v_mov_b32 v3, 1
 s_mov_b64 exec, s[78:79]
 buffer_atomic_add v3, v30, s[4:7], s3 offen
 s_mov_b64 exec, -1
 s_cmp_eq_u32 s61, 0
 s_cbranch_scc1 L_pf_70
 s_lshl_b32 s3, s61, 2
 s_add_u32 s3, s3, s59
 s_sub_u32 s3, s3, 4
 v_mov_b32 v3, 1
 s_mov_b64 exec, s[78:79]
 buffer_atomic_add v3, v30, s[4:7], s3 offen
 s_mov_b64 exec, -1
 s_mov_b32 s61, 0
L_pf_70:
 s_waitcnt lgkmcnt(3)
 v_mfma_f32_32x32x16_bf16 v[64:79], a[72:75], v[40:43], v[64:79]
 ds_read_b128 v[56:59], v14 offset:16384
 s_add_u32 m0, s56, 65536
 s_add_u32 s3, s55, s67
 buffer_load_dwordx4 v1, s[4:7], s3 offen sc1 lds
 s_waitcnt lgkmcnt(3)
 v_mfma_f32_32x32x16_bf16 v[64:79], a[76:79], v[44:47], v[64:79]
 ds_read_b128 v[60:63], v15 offset:16384
 s_waitcnt lgkmcnt(3)
 v_mfma_f32_32x32x16_bf16 v[64:79], a[80:83], v[48:51], v[64:79]
 ds_read_b128 v[32:35], v8 offset:24576
 s_waitcnt lgkmcnt(3)
 v_mfma_f32_32x32x16_bf16 v[64:79], a[84:87], v[52:55], v[64:79]
 ds_read_b128 v[36:39], v9 offset:24576
 s_add_u32 m0, s56, 66560
 s_add_u32 s3, s55, s67
 buffer_load_dwordx4 v24, s[4:7], s3 offen sc1 lds
 s_waitcnt lgkmcnt(3)
 v_mfma_f32_32x32x16_bf16 v[64:79], a[88:91], v[56:59], v[64:79]
 ds_read_b128 v[40:43], v10 offset:24576
 s_waitcnt lgkmcnt(3)
 v_mfma_f32_32x32x16_bf16 v[64:79], a[92:95], v[60:63], v[64:79]
 ds_read_b128 v[44:47], v11 offset:24576
 s_waitcnt lgkmcnt(3)
 v_mfma_f32_32x32x16_bf16 v[64:79], a[96:99], v[32:35], v[64:79]
 ds_read_b128 v[48:51], v12 offset:24576
 s_add_u32 m0, s56, 73728
 s_add_u32 s3, s55, s68
 buffer_load_dwordx4 v1, s[4:7], s3 offen sc1 lds
 s_waitcnt lgkmcnt(3)
 v_mfma_f32_32x32x16_bf16 v[64:79], a[100:103], v[36:39], v[64:79]
 ds_read_b128 v[52:55], v13 offset:24576
 s_waitcnt lgkmcnt(3)
 v_mfma_f32_32x32x16_bf16 v[64:79], a[104:107], v[40:43], v[64:79]
 ds_read_b128 v[56:59], v14 offset:24576
 s_waitcnt lgkmcnt(3)
 v_mfma_f32_32x32x16_bf16 v[64:79], a[108:111], v[44:47], v[64:79]
 ds_read_b128 v[60:63], v15 offset:24576
 s_add_u32 m0, s56, 74752
 s_add_u32 s3, s55, s68
 buffer_load_dwordx4 v24, s[4:7], s3 offen sc1 lds
 v_mov_b32 v6, 8
 s_mov_b64 exec, 15
 v_mov_b32 v6, 0
 buffer_atomic_add v6, v5, s[4:7], s70 offen sc0
 s_mov_b64 exec, -1
 s_waitcnt lgkmcnt(3)
 v_mfma_f32_32x32x16_bf16 v[64:79], a[112:115], v[48:51], v[64:79]
 ds_read_b128 v[32:35], v8 offset:32768
 s_waitcnt lgkmcnt(3)
 v_mfma_f32_32x32x16_bf16 v[64:79], a[116:119], v[52:55], v[64:79]
 ds_read_b128 v[36:39], v9 offset:32768
 s_waitcnt lgkmcnt(3)
 v_mfma_f32_32x32x16_bf16 v[64:79], a[120:123], v[56:59], v[64:79]
 ds_read_b128 v[40:43], v10 offset:32768
 s_waitcnt lgkmcnt(3)
 v_mfma_f32_32x32x16_bf16 v[64:79], a[124:127], v[60:63], v[64:79]
 ds_read_b128 v[44:47], v11 offset:32768
 s_waitcnt lgkmcnt(3)
 v_mfma_f32_32x32x16_bf16 v[64:79], a[128:131], v[32:35], v[64:79]
 ds_read_b128 v[48:51], v12 offset:32768
 s_waitcnt lgkmcnt(3)
 v_mfma_f32_32x32x16_bf16 v[64:79], a[132:135], v[36:39], v[64:79]
 ds_read_b128 v[52:55], v13 offset:32768
 s_waitcnt lgkmcnt(3)
 v_mfma_f32_32x32x16_bf16 v[64:79], a[136:139], v[40:43], v[64:79]
 ds_read_b128 v[56:59], v14 offset:32768
 s_waitcnt lgkmcnt(3)
 v_mfma_f32_32x32x16_bf16 v[64:79], a[140:143], v[44:47], v[64:79]
 ds_read_b128 v[60:63], v15 offset:32768
 s_waitcnt lgkmcnt(3)
 v_mfma_f32_32x32x16_bf16 v[64:79], a[144:147], v[48:51], v[64:79]
 s_waitcnt lgkmcnt(2)
 v_mfma_f32_32x32x16_bf16 v[64:79], a[148:151], v[52:55], v[64:79]
 s_waitcnt lgkmcnt(1)
 v_mfma_f32_32x32x16_bf16 v[64:79], a[152:155], v[56:59], v[64:79]
 s_waitcnt lgkmcnt(0)
 v_mfma_f32_32x32x16_bf16 v[64:79], a[156:159], v[60:63], v[64:79]
 s_lshl_b32 s3, s60, 19
 s_add_u32 s3, s3, s58
 s_xor_b32 s3, s3, s82
 s_nop 8
 v_cvt_pk_bf16_f32 v80, v64, v65
 v_cvt_pk_bf16_f32 v81, v66, v67
 v_cvt_pk_bf16_f32 v82, v72, v73
 v_cvt_pk_bf16_f32 v83, v74, v75
 buffer_store_dwordx4 v[80:83], v4, s[4:7], s3 offen offset:0 sc1
 v_cvt_pk_bf16_f32 v84, v68, v69
 v_cvt_pk_bf16_f32 v85, v70, v71
 v_cvt_pk_bf16_f32 v86, v76, v77
 v_cvt_pk_bf16_f32 v87, v78, v79
 buffer_store_dwordx4 v[84:87], v4, s[4:7], s3 offen offset:512 sc1
 s_add_u32 s54, s54, 1
 s_mov_b32 s61, s54
 s_waitcnt vmcnt(2)
 s_cmp_lg_u32 s50, 0
 s_cbranch_scc1 L_w_71
 v_cmp_gt_u32 vcc, 8, v6
 s_nop 1
 v_mov_b32 v3, vcc_lo
 ds_write_b32 v7, v3
 s_waitcnt lgkmcnt(0)
L_w_71:
 s_barrier
 ds_read_b32 v3, v7
 s_waitcnt lgkmcnt(0)
 v_readfirstlane_b32 s3, v3
 s_cmp_eq_u32 s69, 0
 s_cbranch_scc1 L_qkvq_fast
 s_cmp_eq_u32 s3, 0
 s_cbranch_scc1 L_qkvq_loop
 s_branch L_qkvq_block
L_n0_60:
 s_waitcnt vmcnt(0)
 s_lshl_b32 s3, s54, 2
 s_add_u32 s3, s3, s63
 v_mov_b32 v3, 1
 s_mov_b64 exec, s[78:79]
 buffer_atomic_add v3, v30, s[4:7], s3 offen
 s_mov_b64 exec, -1
 s_add_u32 s54, s54, 1
 s_cmp_lt_u32 s54, 80
 s_cbranch_scc1 L_qkvq_block
 s_endpgm
L_qkvv:
 s_mul_i32 s57, s50, 40960
 s_mul_i32 s62, s52, 3
 s_add_u32 s62, s62, s53
 s_mul_i32 s3, s62, 13108
 s_lshr_b32 s3, s3, 16
 s_mul_i32 s3, s3, 5
 s_sub_u32 s55, s62, s3
 s_add_u32 s64, s55, 0
 s_sub_u32 s3, s64, 5
 s_cmp_ge_u32 s64, 5
 s_cselect_b32 s64, s3, s64
 s_add_u32 s65, s55, 1
 s_sub_u32 s3, s65, 5
 s_cmp_ge_u32 s65, 5
 s_cselect_b32 s65, s3, s65
 s_add_u32 s66, s55, 2
 s_sub_u32 s3, s66, 5
 s_cmp_ge_u32 s66, 5
 s_cselect_b32 s66, s3, s66
 s_add_u32 s67, s55, 3
 s_sub_u32 s3, s67, 5
 s_cmp_ge_u32 s67, 5
 s_cselect_b32 s67, s3, s67
 s_add_u32 s68, s55, 4
 s_sub_u32 s3, s68, 5
 s_cmp_ge_u32 s68, 5
 s_cselect_b32 s68, s3, s68
 s_lshl_b32 s55, s52, 8
 v_lshrrev_b32 v4, 4, v0
 s_mov_b32 s3, 8192
 v_mul_lo_u32 v4, v4, s3
 v_lshrrev_b32 v3, 3, v0
 v_and_b32 v3, 6, v3
 v_xor_b32 v3, v3, v0
 v_and_b32 v3, 15, v3
 v_lshl_add_u32 v4, v3, 4, v4
 v_xor_b32 v5, 128, v4
 s_lshl_b32 s57, s50, 13
 s_mul_i32 s3, s50, 262144
 s_add_u32 s55, s55, s3
 s_mul_i32 s51, s64, 1048576
 s_add_u32 s51, s51, s55
 s_add_u32 m0, s57, 0
 s_nop 0
 buffer_load_dwordx4 v4, s[8:11], s51 offen lds
 s_add_u32 s51, s51, 32768
 s_add_u32 m0, s57, 1024
 s_nop 0
 buffer_load_dwordx4 v5, s[8:11], s51 offen lds
 s_add_u32 s51, s51, 32768
 s_add_u32 m0, s57, 2048
 s_nop 0
 buffer_load_dwordx4 v4, s[8:11], s51 offen lds
 s_add_u32 s51, s51, 32768
 s_add_u32 m0, s57, 3072
 s_nop 0
 buffer_load_dwordx4 v5, s[8:11], s51 offen lds
 s_add_u32 s51, s51, 32768
 s_add_u32 m0, s57, 4096
 s_nop 0
 buffer_load_dwordx4 v4, s[8:11], s51 offen lds
 s_add_u32 s51, s51, 32768
 s_add_u32 m0, s57, 5120
 s_nop 0
 buffer_load_dwordx4 v5, s[8:11], s51 offen lds
 s_add_u32 s51, s51, 32768
 s_add_u32 m0, s57, 6144
 s_nop 0
 buffer_load_dwordx4 v4, s[8:11], s51 offen lds
 s_add_u32 s51, s51, 32768
 s_add_u32 m0, s57, 7168
 s_nop 0
 buffer_load_dwordx4 v5, s[8:11], s51 offen lds
 s_add_u32 s51, s51, 32768
 s_mul_i32 s51, s65, 1048576
 s_add_u32 s51, s51, s55
 s_add_u32 m0, s57, 32768
 s_nop 0
 buffer_load_dwordx4 v4, s[8:11], s51 offen lds
 s_add_u32 s51, s51, 32768
 s_add_u32 m0, s57, 33792
 s_nop 0
 buffer_load_dwordx4 v5, s[8:11], s51 offen lds
 s_add_u32 s51, s51, 32768
 s_add_u32 m0, s57, 34816
 s_nop 0
 buffer_load_dwordx4 v4, s[8:11], s51 offen lds
 s_add_u32 s51, s51, 32768
 s_add_u32 m0, s57, 35840
 s_nop 0
 buffer_load_dwordx4 v5, s[8:11], s51 offen lds
 s_add_u32 s51, s51, 32768
 s_add_u32 m0, s57, 36864
 s_nop 0
 buffer_load_dwordx4 v4, s[8:11], s51 offen lds
 s_add_u32 s51, s51, 32768
 s_add_u32 m0, s57, 37888
 s_nop 0
 buffer_load_dwordx4 v5, s[8:11], s51 offen lds
 s_add_u32 s51, s51, 32768
 s_add_u32 m0, s57, 38912
 s_nop 0
 buffer_load_dwordx4 v4, s[8:11], s51 offen lds
 s_add_u32 s51, s51, 32768
 s_add_u32 m0, s57, 39936
 s_nop 0
 buffer_load_dwordx4 v5, s[8:11], s51 offen lds
 s_add_u32 s51, s51, 32768
 s_mul_i32 s51, s66, 1048576
 s_add_u32 s51, s51, s55
 s_add_u32 m0, s57, 65536
 s_nop 0
 buffer_load_dwordx4 v4, s[8:11], s51 offen lds
 s_add_u32 s51, s51, 32768
 s_add_u32 m0, s57, 66560
 s_nop 0
 buffer_load_dwordx4 v5, s[8:11], s51 offen lds
 s_add_u32 s51, s51, 32768
 s_add_u32 m0, s57, 67584
 s_nop 0
 buffer_load_dwordx4 v4, s[8:11], s51 offen lds
 s_add_u32 s51, s51, 32768
 s_add_u32 m0, s57, 68608
 s_nop 0
 buffer_load_dwordx4 v5, s[8:11], s51 offen lds
 s_add_u32 s51, s51, 32768
 s_add_u32 m0, s57, 69632
 s_nop 0
 buffer_load_dwordx4 v4, s[8:11], s51 offen lds
 s_add_u32 s51, s51, 32768
 s_add_u32 m0, s57, 70656
 s_nop 0
 buffer_load_dwordx4 v5, s[8:11], s51 offen lds
 s_add_u32 s51, s51, 32768
 s_add_u32 m0, s57, 71680
 s_nop 0
 buffer_load_dwordx4 v4, s[8:11], s51 offen lds
 s_add_u32 s51, s51, 32768
 s_add_u32 m0, s57, 72704
 s_nop 0
 buffer_load_dwordx4 v5, s[8:11], s51 offen lds
 s_add_u32 s51, s51, 32768
 s_mul_i32 s51, s67, 1048576
 s_add_u32 s51, s51, s55
 s_add_u32 m0, s57, 98304
 s_nop 0
 buffer_load_dwordx4 v4, s[8:11], s51 offen lds
 s_add_u32 s51, s51, 32768
 s_add_u32 m0, s57, 99328
 s_nop 0
 buffer_load_dwordx4 v5, s[8:11], s51 offen lds
 s_add_u32 s51, s51, 32768
 s_add_u32 m0, s57, 100352
 s_nop 0
 buffer_load_dwordx4 v4, s[8:11], s51 offen lds
 s_add_u32 s51, s51, 32768
 s_add_u32 m0, s57, 101376
 s_nop 0
 buffer_load_dwordx4 v5, s[8:11], s51 offen lds
 s_add_u32 s51, s51, 32768
 s_add_u32 m0, s57, 102400
 s_nop 0
 buffer_load_dwordx4 v4, s[8:11], s51 offen lds
 s_add_u32 s51, s51, 32768
 s_add_u32 m0, s57, 103424
 s_nop 0
 buffer_load_dwordx4 v5, s[8:11], s51 offen lds
 s_add_u32 s51, s51, 32768
 s_add_u32 m0, s57, 104448
 s_nop 0
 buffer_load_dwordx4 v4, s[8:11], s51 offen lds
 s_add_u32 s51, s51, 32768
 s_add_u32 m0, s57, 105472
 s_nop 0
 buffer_load_dwordx4 v5, s[8:11], s51 offen lds
 s_add_u32 s51, s51, 32768
 s_mul_i32 s51, s68, 1048576
 s_add_u32 s51, s51, s55
 s_add_u32 m0, s57, 131072
 s_nop 0
 buffer_load_dwordx4 v4, s[8:11], s51 offen lds
 s_add_u32 s51, s51, 32768
 s_add_u32 m0, s57, 132096
 s_nop 0
 buffer_load_dwordx4 v5, s[8:11], s51 offen lds
 s_add_u32 s51, s51, 32768
 s_add_u32 m0, s57, 133120
 s_nop 0
 buffer_load_dwordx4 v4, s[8:11], s51 offen lds
 s_add_u32 s51, s51, 32768
 s_add_u32 m0, s57, 134144
 s_nop 0
 buffer_load_dwordx4 v5, s[8:11], s51 offen lds
 s_add_u32 s51, s51, 32768
 s_add_u32 m0, s57, 135168
 s_nop 0
 buffer_load_dwordx4 v4, s[8:11], s51 offen lds
 s_add_u32 s51, s51, 32768
 s_add_u32 m0, s57, 136192
 s_nop 0
 buffer_load_dwordx4 v5, s[8:11], s51 offen lds
 s_add_u32 s51, s51, 32768
 s_add_u32 m0, s57, 137216
 s_nop 0
 buffer_load_dwordx4 v4, s[8:11], s51 offen lds
 s_add_u32 s51, s51, 32768
 s_add_u32 m0, s57, 138240
 s_nop 0
 buffer_load_dwordx4 v5, s[8:11], s51 offen lds
 s_add_u32 s51, s51, 32768
 s_mov_b32 s96, s44
 s_and_b32 s97, s45, 0xffff
 s_mov_b32 s98, 256
 s_mov_b32 s99, 0x00020000
 buffer_load_dword v30, off, s[96:99], 0 offset:132 sc1
 v_lshrrev_b32 v2, 3, v0
 v_and_b32 v2, 4, v2
 v_bfe_u32 v3, v0, 2, 2
 v_or_b32 v2, v2, v3
 v_bfe_u32 v3, v0, 4, 1
 v_xor_b32 v3, v3, v2
 s_lshl_b32 s3, s50, 1
 v_xor_b32 v3, s3, v3
 v_lshlrev_b32 v2, 8, v2
 v_lshl_add_u32 v2, v3, 5, v2
 v_and_b32 v3, 3, v0
 v_lshl_add_u32 v2, v3, 3, v2
 s_waitcnt vmcnt(32)
 s_barrier
 ds_read_b64_tr_b16 a[0:1], v2 offset:0
 ds_read_b64_tr_b16 a[2:3], v2 offset:4096
 ds_read_b64_tr_b16 a[4:5], v2 offset:2048
 ds_read_b64_tr_b16 a[6:7], v2 offset:6144
 ds_read_b64_tr_b16 a[8:9], v2 offset:8192
 ds_read_b64_tr_b16 a[10:11], v2 offset:12288
 ds_read_b64_tr_b16 a[12:13], v2 offset:10240
 ds_read_b64_tr_b16 a[14:15], v2 offset:14336
 ds_read_b64_tr_b16 a[16:17], v2 offset:16384
 ds_read_b64_tr_b16 a[18:19], v2 offset:20480
 ds_read_b64_tr_b16 a[20:21], v2 offset:18432
 ds_read_b64_tr_b16 a[22:23], v2 offset:22528
 ds_read_b64_tr_b16 a[24:25], v2 offset:24576
 ds_read_b64_tr_b16 a[26:27], v2 offset:28672
 ds_read_b64_tr_b16 a[28:29], v2 offset:26624
 ds_read_b64_tr_b16 a[30:31], v2 offset:30720
 v_add_u32 v2, 0x8000, v2
 s_waitcnt vmcnt(24)
 s_barrier
 ds_read_b64_tr_b16 a[32:33], v2 offset:0
 ds_read_b64_tr_b16 a[34:35], v2 offset:4096
 ds_read_b64_tr_b16 a[36:37], v2 offset:2048
 ds_read_b64_tr_b16 a[38:39], v2 offset:6144
 ds_read_b64_tr_b16 a[40:41], v2 offset:8192
 ds_read_b64_tr_b16 a[42:43], v2 offset:12288
 ds_read_b64_tr_b16 a[44:45], v2 offset:10240
 ds_read_b64_tr_b16 a[46:47], v2 offset:14336
 ds_read_b64_tr_b16 a[48:49], v2 offset:16384
 ds_read_b64_tr_b16 a[50:51], v2 offset:20480
 ds_read_b64_tr_b16 a[52:53], v2 offset:18432
 ds_read_b64_tr_b16 a[54:55], v2 offset:22528
 ds_read_b64_tr_b16 a[56:57], v2 offset:24576
 ds_read_b64_tr_b16 a[58:59], v2 offset:28672
 ds_read_b64_tr_b16 a[60:61], v2 offset:26624
 ds_read_b64_tr_b16 a[62:63], v2 offset:30720
 v_add_u32 v2, 0x8000, v2
 s_waitcnt vmcnt(16)
 s_barrier
 ds_read_b64_tr_b16 a[64:65], v2 offset:0
 ds_read_b64_tr_b16 a[66:67], v2 offset:4096
 ds_read_b64_tr_b16 a[68:69], v2 offset:2048
 ds_read_b64_tr_b16 a[70:71], v2 offset:6144
 ds_read_b64_tr_b16 a[72:73], v2 offset:8192
 ds_read_b64_tr_b16 a[74:75], v2 offset:12288
 ds_read_b64_tr_b16 a[76:77], v2 offset:10240
 ds_read_b64_tr_b16 a[78:79], v2 offset:14336
 ds_read_b64_tr_b16 a[80:81], v2 offset:16384
 ds_read_b64_tr_b16 a[82:83], v2 offset:20480
 ds_read_b64_tr_b16 a[84:85], v2 offset:18432
 ds_read_b64_tr_b16 a[86:87], v2 offset:22528
 ds_read_b64_tr_b16 a[88:89], v2 offset:24576
 ds_read_b64_tr_b16 a[90:91], v2 offset:28672
 ds_read_b64_tr_b16 a[92:93], v2 offset:26624
 ds_read_b64_tr_b16 a[94:95], v2 offset:30720
 v_add_u32 v2, 0x8000, v2
 s_waitcnt vmcnt(8)
 s_barrier
 ds_read_b64_tr_b16 a[96:97], v2 offset:0
 ds_read_b64_tr_b16 a[98:99], v2 offset:4096
 ds_read_b64_tr_b16 a[100:101], v2 offset:2048
 ds_read_b64_tr_b16 a[102:103], v2 offset:6144
 ds_read_b64_tr_b16 a[104:105], v2 offset:8192
 ds_read_b64_tr_b16 a[106:107], v2 offset:12288
 ds_read_b64_tr_b16 a[108:109], v2 offset:10240
 ds_read_b64_tr_b16 a[110:111], v2 offset:14336
 ds_read_b64_tr_b16 a[112:113], v2 offset:16384
 ds_read_b64_tr_b16 a[114:115], v2 offset:20480
 ds_read_b64_tr_b16 a[116:117], v2 offset:18432
 ds_read_b64_tr_b16 a[118:119], v2 offset:22528
 ds_read_b64_tr_b16 a[120:121], v2 offset:24576
 ds_read_b64_tr_b16 a[122:123], v2 offset:28672
 ds_read_b64_tr_b16 a[124:125], v2 offset:26624
 ds_read_b64_tr_b16 a[126:127], v2 offset:30720
 v_add_u32 v2, 0x8000, v2
 s_waitcnt vmcnt(0)
 s_barrier
 ds_read_b64_tr_b16 a[128:129], v2 offset:0
 ds_read_b64_tr_b16 a[130:131], v2 offset:4096
 ds_read_b64_tr_b16 a[132:133], v2 offset:2048
 ds_read_b64_tr_b16 a[134:135], v2 offset:6144
 ds_read_b64_tr_b16 a[136:137], v2 offset:8192
 ds_read_b64_tr_b16 a[138:139], v2 offset:12288
 ds_read_b64_tr_b16 a[140:141], v2 offset:10240
 ds_read_b64_tr_b16 a[142:143], v2 offset:14336
 ds_read_b64_tr_b16 a[144:145], v2 offset:16384
 ds_read_b64_tr_b16 a[146:147], v2 offset:20480
 ds_read_b64_tr_b16 a[148:149], v2 offset:18432
 ds_read_b64_tr_b16 a[150:151], v2 offset:22528
 ds_read_b64_tr_b16 a[152:153], v2 offset:24576
 ds_read_b64_tr_b16 a[154:155], v2 offset:28672
 ds_read_b64_tr_b16 a[156:157], v2 offset:26624
 ds_read_b64_tr_b16 a[158:159], v2 offset:30720
 v_add_u32 v2, 0x8000, v2
 s_waitcnt lgkmcnt(0)
 s_barrier
 v_cmp_eq_u32 vcc, 0, v30
 s_cbranch_vccz L_qa_72
 s_mov_b32 s96, s44
 s_and_b32 s97, s45, 0xffff
 s_mov_b32 s98, 256
 s_mov_b32 s99, 0x00020000
 v_mov_b32 v1, 132
 s_mov_b32 s51, 0
 s_mov_b64 exec, 1
L_wb_73:
 buffer_load_dword v2, v1, s[96:99], 0 offen sc1
 s_waitcnt vmcnt(0)
 v_cmp_eq_u32 vcc, 0, v2
 s_cbranch_vccz L_wbd_74
 s_sleep 2
 s_add_u32 s51, s51, 1
 s_cmp_lt_u32 s51, 131072
 s_cbranch_scc1 L_wb_73
 s_branch L_bail
L_wbd_74:
 s_mov_b64 exec, -1
L_qa_72:
 s_lshl_b32 s64, s64, 8
 s_lshl_b32 s65, s65, 8
 s_lshl_b32 s66, s66, 8
 s_lshl_b32 s67, s67, 8
 s_lshl_b32 s68, s68, 8
 s_cmp_eq_u32 s53, 0
 s_cselect_b32 s78, 2, 3
 s_mov_b32 s79, 0
 v_lshrrev_b32 v1, 4, v0
 s_mov_b32 s3, 1280
 v_mul_lo_u32 v1, v1, s3
 v_and_b32 v3, 15, v0
 v_lshl_add_u32 v1, v3, 4, v1
 v_add_u32 v6, 5120, v1
 v_mov_b32 v24, v6
 v_and_b32 v2, 31, v0
 v_lshlrev_b32 v2, 8, v2
 v_lshrrev_b32 v4, 5, v0
 v_xor_b32 v4, v4, v3
 v_xor_b32 v8, 0, v4
 v_lshl_add_u32 v8, v8, 4, v2
 v_add_u32 v16, 40960, v8
 v_xor_b32 v9, 2, v4
 v_lshl_add_u32 v9, v9, 4, v2
 v_add_u32 v17, 40960, v9
 v_xor_b32 v10, 4, v4
 v_lshl_add_u32 v10, v10, 4, v2
 v_add_u32 v18, 40960, v10
 v_xor_b32 v11, 6, v4
 v_lshl_add_u32 v11, v11, 4, v2
 v_add_u32 v19, 40960, v11
 v_xor_b32 v12, 8, v4
 v_lshl_add_u32 v12, v12, 4, v2
 v_add_u32 v20, 40960, v12
 v_xor_b32 v13, 10, v4
 v_lshl_add_u32 v13, v13, 4, v2
 v_add_u32 v21, 40960, v13
 v_xor_b32 v14, 12, v4
 v_lshl_add_u32 v14, v14, 4, v2
 v_add_u32 v22, 40960, v14
 v_xor_b32 v15, 14, v4
 v_lshl_add_u32 v15, v15, 4, v2
 v_add_u32 v23, 40960, v15
 v_lshrrev_b32 v4, 5, v0
 v_lshlrev_b32 v4, 8, v4
 v_lshl_add_u32 v4, v3, 4, v4
 v_and_b32 v2, 16, v0
 v_lshl_add_u32 v4, v2, 6, v4
 s_lshl_b32 s3, s50, 11
 v_add_u32 v4, s3, v4
 v_mul_u32_u24 v5, 24576, v0
 v_mov_b32 v7, 163776
 v_mul_u32_u24 v30, 16384, v0
 s_lshl_b32 s75, s62, 2
 s_add_u32 s75, s75, s50
 s_and_b32 s100, s52, 1
 s_lshl_b32 s100, s100, 13
 s_lshl_b32 s58, s52, 14
 s_add_u32 s58, s58, s100
 s_add_u32 s58, s58, 75497472
 s_cmp_eq_u32 s53, 0
 s_cselect_b32 s82, 8192, 0
 s_lshl_b32 s59, s52, 8
 s_add_u32 s59, s59, 8192
 s_lshl_b32 s56, s50, 11
 s_mov_b32 s54, 0
 s_mov_b32 s61, 0
 s_mov_b32 s70, s75
 s_mul_i32 s55, s54, 40960
 s_mul_i32 s3, s50, 10240
 s_add_u32 s55, s55, s3
 s_add_u32 s55, s55, 226492416
 s_add_u32 m0, s56, 0
 s_add_u32 s3, s55, s64
 buffer_load_dwordx4 v1, s[4:7], s3 offen sc1 lds
 s_add_u32 m0, s56, 1024
 s_add_u32 s3, s55, s64
 buffer_load_dwordx4 v24, s[4:7], s3 offen sc1 lds
 s_add_u32 m0, s56, 8192
 s_add_u32 s3, s55, s65
 buffer_load_dwordx4 v1, s[4:7], s3 offen sc1 lds
 s_add_u32 m0, s56, 9216
 s_add_u32 s3, s55, s65
 buffer_load_dwordx4 v24, s[4:7], s3 offen sc1 lds
 s_add_u32 m0, s56, 16384
 s_add_u32 s3, s55, s66
 buffer_load_dwordx4 v1, s[4:7], s3 offen sc1 lds
 s_add_u32 m0, s56, 17408
 s_add_u32 s3, s55, s66
 buffer_load_dwordx4 v24, s[4:7], s3 offen sc1 lds
 s_add_u32 m0, s56, 24576
 s_add_u32 s3, s55, s67
 buffer_load_dwordx4 v1, s[4:7], s3 offen sc1 lds
 s_add_u32 m0, s56, 25600
 s_add_u32 s3, s55, s67
 buffer_load_dwordx4 v24, s[4:7], s3 offen sc1 lds
 s_add_u32 m0, s56, 32768
 s_add_u32 s3, s55, s68
 buffer_load_dwordx4 v1, s[4:7], s3 offen sc1 lds
 s_add_u32 m0, s56, 33792
 s_add_u32 s3, s55, s68
 buffer_load_dwordx4 v24, s[4:7], s3 offen sc1 lds
 s_waitcnt vmcnt(0)
L_qkvv_pre:
 s_barrier
 s_mov_b32 s60, s54
 s_add_u32 s54, s54, 1
 s_mul_i32 s55, s54, 40960
 s_mul_i32 s3, s50, 10240
 s_add_u32 s55, s55, s3
 s_add_u32 s55, s55, 226492416
 ds_read_b128 v[32:35], v8 offset:0
 ds_read_b128 v[36:39], v9 offset:0
 ds_read_b128 v[40:43], v10 offset:0
 ds_read_b128 v[44:47], v11 offset:0
 s_waitcnt lgkmcnt(3)
 v_mfma_f32_32x32x16_bf16 v[64:79], v[32:35], a[0:3], 0
 ds_read_b128 v[48:51], v12 offset:0
 s_add_u32 m0, s56, 40960
 s_add_u32 s3, s55, s64
 buffer_load_dwordx4 v1, s[4:7], s3 offen sc1 lds
 s_waitcnt lgkmcnt(3)
 v_mfma_f32_32x32x16_bf16 v[64:79], v[36:39], a[4:7], v[64:79]
 ds_read_b128 v[52:55], v13 offset:0
 s_waitcnt lgkmcnt(3)
 v_mfma_f32_32x32x16_bf16 v[64:79], v[40:43], a[8:11], v[64:79]
 ds_read_b128 v[56:59], v14 offset:0
 s_waitcnt lgkmcnt(3)
 v_mfma_f32_32x32x16_bf16 v[64:79], v[44:47], a[12:15], v[64:79]
 ds_read_b128 v[60:63], v15 offset:0
 s_add_u32 m0, s56, 41984
 s_add_u32 s3, s55, s64
 buffer_load_dwordx4 v24, s[4:7], s3 offen sc1 lds
 s_waitcnt lgkmcnt(3)
 v_mfma_f32_32x32x16_bf16 v[64:79], v[48:51], a[16:19], v[64:79]
 ds_read_b128 v[32:35], v8 offset:8192
 s_waitcnt lgkmcnt(3)
 v_mfma_f32_32x32x16_bf16 v[64:79], v[52:55], a[20:23], v[64:79]
 ds_read_b128 v[36:39], v9 offset:8192
 s_waitcnt lgkmcnt(3)
 v_mfma_f32_32x32x16_bf16 v[64:79], v[56:59], a[24:27], v[64:79]
 ds_read_b128 v[40:43], v10 offset:8192
 s_add_u32 m0, s56, 49152
 s_add_u32 s3, s55, s65
 buffer_load_dwordx4 v1, s[4:7], s3 offen sc1 lds
 s_waitcnt lgkmcnt(3)
 v_mfma_f32_32x32x16_bf16 v[64:79], v[60:63], a[28:31], v[64:79]
 ds_read_b128 v[44:47], v11 offset:8192
 s_waitcnt lgkmcnt(3)
 v_mfma_f32_32x32x16_bf16 v[64:79], v[32:35], a[32:35], v[64:79]
 ds_read_b128 v[48:51], v12 offset:8192
 s_waitcnt lgkmcnt(3)
 v_mfma_f32_32x32x16_bf16 v[64:79], v[36:39], a[36:39], v[64:79]
 ds_read_b128 v[52:55], v13 offset:8192
 s_add_u32 m0, s56, 50176
 s_add_u32 s3, s55, s65
 buffer_load_dwordx4 v24, s[4:7], s3 offen sc1 lds
 s_waitcnt lgkmcnt(3)
 v_mfma_f32_32x32x16_bf16 v[64:79], v[40:43], a[40:43], v[64:79]
 ds_read_b128 v[56:59], v14 offset:8192
 s_waitcnt lgkmcnt(3)
 v_mfma_f32_32x32x16_bf16 v[64:79], v[44:47], a[44:47], v[64:79]
 ds_read_b128 v[60:63], v15 offset:8192
 s_waitcnt lgkmcnt(3)
 v_mfma_f32_32x32x16_bf16 v[64:79], v[48:51], a[48:51], v[64:79]
 ds_read_b128 v[32:35], v8 offset:16384
 s_add_u32 m0, s56, 57344
 s_add_u32 s3, s55, s66
 buffer_load_dwordx4 v1, s[4:7], s3 offen sc1 lds
 s_waitcnt lgkmcnt(3)
 v_mfma_f32_32x32x16_bf16 v[64:79], v[52:55], a[52:55], v[64:79]
 ds_read_b128 v[36:39], v9 offset:16384
 s_waitcnt lgkmcnt(3)
 v_mfma_f32_32x32x16_bf16 v[64:79], v[56:59], a[56:59], v[64:79]
 ds_read_b128 v[40:43], v10 offset:16384
 s_waitcnt lgkmcnt(3)
 v_mfma_f32_32x32x16_bf16 v[64:79], v[60:63], a[60:63], v[64:79]
 ds_read_b128 v[44:47], v11 offset:16384
 s_add_u32 m0, s56, 58368
 s_add_u32 s3, s55, s66
 buffer_load_dwordx4 v24, s[4:7], s3 offen sc1 lds
 s_waitcnt lgkmcnt(3)
 v_mfma_f32_32x32x16_bf16 v[64:79], v[32:35], a[64:67], v[64:79]
 ds_read_b128 v[48:51], v12 offset:16384
 s_waitcnt lgkmcnt(3)
 v_mfma_f32_32x32x16_bf16 v[64:79], v[36:39], a[68:71], v[64:79]
 ds_read_b128 v[52:55], v13 offset:16384
 s_waitcnt lgkmcnt(3)
 v_mfma_f32_32x32x16_bf16 v[64:79], v[40:43], a[72:75], v[64:79]
 ds_read_b128 v[56:59], v14 offset:16384
 s_add_u32 m0, s56, 65536
 s_add_u32 s3, s55, s67
 buffer_load_dwordx4 v1, s[4:7], s3 offen sc1 lds
 s_waitcnt lgkmcnt(3)
 v_mfma_f32_32x32x16_bf16 v[64:79], v[44:47], a[76:79], v[64:79]
 ds_read_b128 v[60:63], v15 offset:16384
 s_waitcnt vmcnt(7)
 s_cmp_eq_u32 s61, 0
 s_cbranch_scc1 L_pf_75
 s_lshl_b32 s3, s61, 2
 s_add_u32 s3, s3, s59
 s_sub_u32 s3, s3, 4
 v_mov_b32 v3, 1
 s_mov_b64 exec, s[78:79]
 buffer_atomic_add v3, v30, s[4:7], s3 offen
 s_mov_b64 exec, -1
 s_mov_b32 s61, 0
L_pf_75:
 s_waitcnt lgkmcnt(3)
 v_mfma_f32_32x32x16_bf16 v[64:79], v[48:51], a[80:83], v[64:79]
 ds_read_b128 v[32:35], v8 offset:24576
 s_waitcnt lgkmcnt(3)
 v_mfma_f32_32x32x16_bf16 v[64:79], v[52:55], a[84:87], v[64:79]
 ds_read_b128 v[36:39], v9 offset:24576
 s_add_u32 m0, s56, 66560
 s_add_u32 s3, s55, s67
 buffer_load_dwordx4 v24, s[4:7], s3 offen sc1 lds
 s_waitcnt lgkmcnt(3)
 v_mfma_f32_32x32x16_bf16 v[64:79], v[56:59], a[88:91], v[64:79]
 ds_read_b128 v[40:43], v10 offset:24576
 s_waitcnt lgkmcnt(3)
 v_mfma_f32_32x32x16_bf16 v[64:79], v[60:63], a[92:95], v[64:79]
 ds_read_b128 v[44:47], v11 offset:24576
 s_waitcnt lgkmcnt(3)
 v_mfma_f32_32x32x16_bf16 v[64:79], v[32:35], a[96:99], v[64:79]
 ds_read_b128 v[48:51], v12 offset:24576
 s_add_u32 m0, s56, 73728
 s_add_u32 s3, s55, s68
 buffer_load_dwordx4 v1, s[4:7], s3 offen sc1 lds
 s_waitcnt lgkmcnt(3)
 v_mfma_f32_32x32x16_bf16 v[64:79], v[36:39], a[100:103], v[64:79]
 ds_read_b128 v[52:55], v13 offset:24576
 s_waitcnt lgkmcnt(3)
 v_mfma_f32_32x32x16_bf16 v[64:79], v[40:43], a[104:107], v[64:79]
 ds_read_b128 v[56:59], v14 offset:24576
 s_waitcnt lgkmcnt(3)
 v_mfma_f32_32x32x16_bf16 v[64:79], v[44:47], a[108:111], v[64:79]
 ds_read_b128 v[60:63], v15 offset:24576
 s_add_u32 m0, s56, 74752
 s_add_u32 s3, s55, s68
 buffer_load_dwordx4 v24, s[4:7], s3 offen sc1 lds
 s_waitcnt lgkmcnt(3)
 v_mfma_f32_32x32x16_bf16 v[64:79], v[48:51], a[112:115], v[64:79]
 ds_read_b128 v[32:35], v8 offset:32768
 s_waitcnt lgkmcnt(3)
 v_mfma_f32_32x32x16_bf16 v[64:79], v[52:55], a[116:119], v[64:79]
 ds_read_b128 v[36:39], v9 offset:32768
 s_waitcnt lgkmcnt(3)
 v_mfma_f32_32x32x16_bf16 v[64:79], v[56:59], a[120:123], v[64:79]
 ds_read_b128 v[40:43], v10 offset:32768
 s_waitcnt lgkmcnt(3)
 v_mfma_f32_32x32x16_bf16 v[64:79], v[60:63], a[124:127], v[64:79]
 ds_read_b128 v[44:47], v11 offset:32768
 s_waitcnt lgkmcnt(3)
 v_mfma_f32_32x32x16_bf16 v[64:79], v[32:35], a[128:131], v[64:79]
 ds_read_b128 v[48:51], v12 offset:32768
 s_waitcnt lgkmcnt(3)
 v_mfma_f32_32x32x16_bf16 v[64:79], v[36:39], a[132:135], v[64:79]
 ds_read_b128 v[52:55], v13 offset:32768
 s_waitcnt lgkmcnt(3)
 v_mfma_f32_32x32x16_bf16 v[64:79], v[40:43], a[136:139], v[64:79]
 ds_read_b128 v[56:59], v14 offset:32768
 s_waitcnt lgkmcnt(3)
 v_mfma_f32_32x32x16_bf16 v[64:79], v[44:47], a[140:143], v[64:79]
 ds_read_b128 v[60:63], v15 offset:32768
 s_waitcnt lgkmcnt(3)
 v_mfma_f32_32x32x16_bf16 v[64:79], v[48:51], a[144:147], v[64:79]
 s_waitcnt lgkmcnt(2)
 v_mfma_f32_32x32x16_bf16 v[64:79], v[52:55], a[148:151], v[64:79]
 s_waitcnt lgkmcnt(1)
 v_mfma_f32_32x32x16_bf16 v[64:79], v[56:59], a[152:155], v[64:79]
 s_waitcnt lgkmcnt(0)
 v_mfma_f32_32x32x16_bf16 v[64:79], v[60:63], a[156:159], v[64:79]
 s_lshl_b32 s3, s60, 19
 s_add_u32 s3, s3, s58
 s_xor_b32 s3, s3, s82
 s_nop 8
 v_cvt_pk_bf16_f32 v80, v64, v65
 v_cvt_pk_bf16_f32 v81, v66, v67
 v_cvt_pk_bf16_f32 v82, v72, v73
 v_cvt_pk_bf16_f32 v83, v74, v75
 buffer_store_dwordx4 v[80:83], v4, s[4:7], s3 offen offset:0 sc1
 v_cvt_pk_bf16_f32 v84, v68, v69
 v_cvt_pk_bf16_f32 v85, v70, v71
 v_cvt_pk_bf16_f32 v86, v76, v77
 v_cvt_pk_bf16_f32 v87, v78, v79
 buffer_store_dwordx4 v[84:87], v4, s[4:7], s3 offen offset:512 sc1
 s_mov_b32 s61, s54
 s_cmp_lg_u32 s54, 1
 s_cbranch_scc1 L_f1_76
 s_waitcnt vmcnt(0)
 s_cmp_eq_u32 s61, 0
 s_cbranch_scc1 L_pf_77
 s_lshl_b32 s3, s61, 2
 s_add_u32 s3, s3, s59
 s_sub_u32 s3, s3, 4
 v_mov_b32 v3, 1
 s_mov_b64 exec, s[78:79]
 buffer_atomic_add v3, v30, s[4:7], s3 offen
 s_mov_b64 exec, -1
 s_mov_b32 s61, 0
L_pf_77:
 s_mov_b32 s8, s38
 s_and_b32 s9, s39, 0xffff
 s_mov_b32 s10, 2621440
 s_mov_b32 s11, 0x00020000
 s_mov_b32 s12, s40
 s_and_b32 s13, s41, 0xffff
 s_mov_b32 s14, 1280
 s_mov_b32 s15, 0x00020000
 v_lshlrev_b32 v130, 4, v0
 s_lshl_b32 s73, s70, 12
 s_add_u32 s74, s73, 2
 buffer_load_dwordx4 v[96:99], v130, s[8:11], s73 offen offset:0
 buffer_load_dwordx4 v[100:103], v130, s[8:11], s73 offen offset:1024
 buffer_load_dwordx4 v[112:115], v130, s[8:11], s74 offen offset:0
 buffer_load_dwordx4 v[116:119], v130, s[8:11], s74 offen offset:1024
 s_lshl_b32 s3, s70, 1
 buffer_load_ushort v128, off, s[12:15], s3
 s_branch L_f2_78
L_f1_76:
 s_waitcnt vmcnt(2)
L_f2_78:
 s_barrier
 s_mov_b32 s60, s54
 s_add_u32 s54, s54, 1
 s_mul_i32 s55, s54, 40960
 s_mul_i32 s3, s50, 10240
 s_add_u32 s55, s55, s3
 s_add_u32 s55, s55, 226492416
 ds_read_b128 v[32:35], v16 offset:0
 ds_read_b128 v[36:39], v17 offset:0
 ds_read_b128 v[40:43], v18 offset:0
 ds_read_b128 v[44:47], v19 offset:0
 s_waitcnt lgkmcnt(3)
 v_mfma_f32_32x32x16_bf16 v[64:79], v[32:35], a[0:3], 0
 ds_read_b128 v[48:51], v20 offset:0
 s_add_u32 m0, s56, 0
 s_add_u32 s3, s55, s64
 buffer_load_dwordx4 v1, s[4:7], s3 offen sc1 lds
 s_waitcnt lgkmcnt(3)
 v_mfma_f32_32x32x16_bf16 v[64:79], v[36:39], a[4:7], v[64:79]
 ds_read_b128 v[52:55], v21 offset:0
 s_waitcnt lgkmcnt(3)
 v_mfma_f32_32x32x16_bf16 v[64:79], v[40:43], a[8:11], v[64:79]
 ds_read_b128 v[56:59], v22 offset:0
 s_waitcnt lgkmcnt(3)
 v_mfma_f32_32x32x16_bf16 v[64:79], v[44:47], a[12:15], v[64:79]
 ds_read_b128 v[60:63], v23 offset:0
 s_add_u32 m0, s56, 1024
 s_add_u32 s3, s55, s64
 buffer_load_dwordx4 v24, s[4:7], s3 offen sc1 lds
 s_waitcnt lgkmcnt(3)
 v_mfma_f32_32x32x16_bf16 v[64:79], v[48:51], a[16:19], v[64:79]
 ds_read_b128 v[32:35], v16 offset:8192
 s_waitcnt lgkmcnt(3)
 v_mfma_f32_32x32x16_bf16 v[64:79], v[52:55], a[20:23], v[64:79]
 ds_read_b128 v[36:39], v17 offset:8192
 s_waitcnt lgkmcnt(3)
 v_mfma_f32_32x32x16_bf16 v[64:79], v[56:59], a[24:27], v[64:79]
 ds_read_b128 v[40:43], v18 offset:8192
 s_add_u32 m0, s56, 8192
 s_add_u32 s3, s55, s65
 buffer_load_dwordx4 v1, s[4:7], s3 offen sc1 lds
 s_waitcnt lgkmcnt(3)
 v_mfma_f32_32x32x16_bf16 v[64:79], v[60:63], a[28:31], v[64:79]
 ds_read_b128 v[44:47], v19 offset:8192
 s_waitcnt lgkmcnt(3)
 v_mfma_f32_32x32x16_bf16 v[64:79], v[32:35], a[32:35], v[64:79]
 ds_read_b128 v[48:51], v20 offset:8192
 s_waitcnt lgkmcnt(3)
 v_mfma_f32_32x32x16_bf16 v[64:79], v[36:39], a[36:39], v[64:79]
 ds_read_b128 v[52:55], v21 offset:8192
 s_add_u32 m0, s56, 9216
 s_add_u32 s3, s55, s65
 buffer_load_dwordx4 v24, s[4:7], s3 offen sc1 lds
 s_waitcnt lgkmcnt(3)
 v_mfma_f32_32x32x16_bf16 v[64:79], v[40:43], a[40:43], v[64:79]
 ds_read_b128 v[56:59], v22 offset:8192
 s_waitcnt lgkmcnt(3)
 v_mfma_f32_32x32x16_bf16 v[64:79], v[44:47], a[44:47], v[64:79]
 ds_read_b128 v[60:63], v23 offset:8192
 s_waitcnt lgkmcnt(3)
 v_mfma_f32_32x32x16_bf16 v[64:79], v[48:51], a[48:51], v[64:79]
 ds_read_b128 v[32:35], v16 offset:16384
 s_add_u32 m0, s56, 16384
 s_add_u32 s3, s55, s66
 buffer_load_dwordx4 v1, s[4:7], s3 offen sc1 lds
 s_waitcnt lgkmcnt(3)
 v_mfma_f32_32x32x16_bf16 v[64:79], v[52:55], a[52:55], v[64:79]
 ds_read_b128 v[36:39], v17 offset:16384
 s_waitcnt lgkmcnt(3)
 v_mfma_f32_32x32x16_bf16 v[64:79], v[56:59], a[56:59], v[64:79]
 ds_read_b128 v[40:43], v18 offset:16384
 s_waitcnt lgkmcnt(3)
 v_mfma_f32_32x32x16_bf16 v[64:79], v[60:63], a[60:63], v[64:79]
 ds_read_b128 v[44:47], v19 offset:16384
 s_add_u32 m0, s56, 17408
 s_add_u32 s3, s55, s66
 buffer_load_dwordx4 v24, s[4:7], s3 offen sc1 lds
 s_waitcnt lgkmcnt(3)
 v_mfma_f32_32x32x16_bf16 v[64:79], v[32:35], a[64:67], v[64:79]
 ds_read_b128 v[48:51], v20 offset:16384
 s_waitcnt lgkmcnt(3)
 v_mfma_f32_32x32x16_bf16 v[64:79], v[36:39], a[68:71], v[64:79]
 ds_read_b128 v[52:55], v21 offset:16384
 s_waitcnt lgkmcnt(3)
 v_mfma_f32_32x32x16_bf16 v[64:79], v[40:43], a[72:75], v[64:79]
 ds_read_b128 v[56:59], v22 offset:16384
 s_add_u32 m0, s56, 24576
 s_add_u32 s3, s55, s67
 buffer_load_dwordx4 v1, s[4:7], s3 offen sc1 lds
 s_waitcnt lgkmcnt(3)
 v_mfma_f32_32x32x16_bf16 v[64:79], v[44:47], a[76:79], v[64:79]
 ds_read_b128 v[60:63], v23 offset:16384
 s_waitcnt vmcnt(7)
 s_cmp_eq_u32 s61, 0
 s_cbranch_scc1 L_pf_79
 s_lshl_b32 s3, s61, 2
 s_add_u32 s3, s3, s59
 s_sub_u32 s3, s3, 4
 v_mov_b32 v3, 1
 s_mov_b64 exec, s[78:79]
 buffer_atomic_add v3, v30, s[4:7], s3 offen
 s_mov_b64 exec, -1
 s_mov_b32 s61, 0
L_pf_79:
 s_waitcnt lgkmcnt(3)
 v_mfma_f32_32x32x16_bf16 v[64:79], v[48:51], a[80:83], v[64:79]
 ds_read_b128 v[32:35], v16 offset:24576
 s_waitcnt lgkmcnt(3)
 v_mfma_f32_32x32x16_bf16 v[64:79], v[52:55], a[84:87], v[64:79]
 ds_read_b128 v[36:39], v17 offset:24576
 s_add_u32 m0, s56, 25600
 s_add_u32 s3, s55, s67
 buffer_load_dwordx4 v24, s[4:7], s3 offen sc1 lds
 s_waitcnt lgkmcnt(3)
 v_mfma_f32_32x32x16_bf16 v[64:79], v[56:59], a[88:91], v[64:79]
 ds_read_b128 v[40:43], v18 offset:24576
 s_waitcnt lgkmcnt(3)
 v_mfma_f32_32x32x16_bf16 v[64:79], v[60:63], a[92:95], v[64:79]
 ds_read_b128 v[44:47], v19 offset:24576
 s_waitcnt lgkmcnt(3)
 v_mfma_f32_32x32x16_bf16 v[64:79], v[32:35], a[96:99], v[64:79]
 ds_read_b128 v[48:51], v20 offset:24576
 s_add_u32 m0, s56, 32768
 s_add_u32 s3, s55, s68
 buffer_load_dwordx4 v1, s[4:7], s3 offen sc1 lds
 s_waitcnt lgkmcnt(3)
 v_mfma_f32_32x32x16_bf16 v[64:79], v[36:39], a[100:103], v[64:79]
 ds_read_b128 v[52:55], v21 offset:24576
 s_waitcnt lgkmcnt(3)
 v_mfma_f32_32x32x16_bf16 v[64:79], v[40:43], a[104:107], v[64:79]
 ds_read_b128 v[56:59], v22 offset:24576
 s_waitcnt lgkmcnt(3)
 v_mfma_f32_32x32x16_bf16 v[64:79], v[44:47], a[108:111], v[64:79]
 ds_read_b128 v[60:63], v23 offset:24576
 s_add_u32 m0, s56, 33792
 s_add_u32 s3, s55, s68
 buffer_load_dwordx4 v24, s[4:7], s3 offen sc1 lds
 s_waitcnt lgkmcnt(3)
 v_mfma_f32_32x32x16_bf16 v[64:79], v[48:51], a[112:115], v[64:79]
 ds_read_b128 v[32:35], v16 offset:32768
 s_waitcnt lgkmcnt(3)
 v_mfma_f32_32x32x16_bf16 v[64:79], v[52:55], a[116:119], v[64:79]
 ds_read_b128 v[36:39], v17 offset:32768
 s_waitcnt lgkmcnt(3)
 v_mfma_f32_32x32x16_bf16 v[64:79], v[56:59], a[120:123], v[64:79]
 ds_read_b128 v[40:43], v18 offset:32768
 s_waitcnt lgkmcnt(3)
 v_mfma_f32_32x32x16_bf16 v[64:79], v[60:63], a[124:127], v[64:79]
 ds_read_b128 v[44:47], v19 offset:32768
 s_waitcnt lgkmcnt(3)
 v_mfma_f32_32x32x16_bf16 v[64:79], v[32:35], a[128:131], v[64:79]
 ds_read_b128 v[48:51], v20 offset:32768
 s_waitcnt lgkmcnt(3)
 v_mfma_f32_32x32x16_bf16 v[64:79], v[36:39], a[132:135], v[64:79]
 ds_read_b128 v[52:55], v21 offset:32768
 s_waitcnt lgkmcnt(3)
 v_mfma_f32_32x32x16_bf16 v[64:79], v[40:43], a[136:139], v[64:79]
 ds_read_b128 v[56:59], v22 offset:32768
 s_waitcnt lgkmcnt(3)
 v_mfma_f32_32x32x16_bf16 v[64:79], v[44:47], a[140:143], v[64:79]
 ds_read_b128 v[60:63], v23 offset:32768
 s_waitcnt lgkmcnt(3)
 v_mfma_f32_32x32x16_bf16 v[64:79], v[48:51], a[144:147], v[64:79]
 s_waitcnt lgkmcnt(2)
 v_mfma_f32_32x32x16_bf16 v[64:79], v[52:55], a[148:151], v[64:79]
 s_waitcnt lgkmcnt(1)
 v_mfma_f32_32x32x16_bf16 v[64:79], v[56:59], a[152:155], v[64:79]
 s_waitcnt lgkmcnt(0)
 v_mfma_f32_32x32x16_bf16 v[64:79], v[60:63], a[156:159], v[64:79]
 s_lshl_b32 s3, s60, 19
 s_add_u32 s3, s3, s58
 s_xor_b32 s3, s3, s82
 s_nop 8
 v_cvt_pk_bf16_f32 v88, v64, v65
 v_cvt_pk_bf16_f32 v89, v66, v67
 v_cvt_pk_bf16_f32 v90, v72, v73
 v_cvt_pk_bf16_f32 v91, v74, v75
 buffer_store_dwordx4 v[88:91], v4, s[4:7], s3 offen offset:0 sc1
 v_cvt_pk_bf16_f32 v92, v68, v69
 v_cvt_pk_bf16_f32 v93, v70, v71
 v_cvt_pk_bf16_f32 v94, v76, v77
 v_cvt_pk_bf16_f32 v95, v78, v79
 buffer_store_dwordx4 v[92:95], v4, s[4:7], s3 offen offset:512 sc1
 s_mov_b32 s61, s54
 s_waitcnt vmcnt(2)
 s_cmp_lg_u32 s54, 4
 s_cbranch_scc1 L_cv_80
 s_waitcnt vmcnt(0)
 s_cmp_eq_u32 s61, 0
 s_cbranch_scc1 L_pf_81
 s_lshl_b32 s3, s61, 2
 s_add_u32 s3, s3, s59
 s_sub_u32 s3, s3, 4
 v_mov_b32 v3, 1
 s_mov_b64 exec, s[78:79]
 buffer_atomic_add v3, v30, s[4:7], s3 offen
 s_mov_b64 exec, -1
 s_mov_b32 s61, 0
L_pf_81:
 s_mul_i32 s71, s50, 13312
 s_add_u32 s71, s71, 81920
 s_mov_b32 s70, s75
 s_mov_b32 s69, 640
 s_getpc_b64 s[76:77]
L_ca_82:
 s_add_u32 s76, s76, L_conv0-L_ca_82
 s_addc_u32 s77, s77, -1
 s_swappc_b64 s[76:77], s[76:77]
 s_waitcnt vmcnt(0)
 s_barrier
 s_cmp_lg_u32 s50, 3
 s_cbranch_scc1 L_ar_83
 s_mov_b32 s96, s44
 s_and_b32 s97, s45, 0xffff
 s_mov_b32 s98, 256
 s_mov_b32 s99, 0x00020000
 v_mov_b32 v1, 1
 s_mov_b64 exec, 1
 buffer_atomic_add v1, off, s[96:99], 0 offset:8 sc0
 s_waitcnt vmcnt(0)
 v_cmp_eq_u32 vcc, 159, v1
 s_cbranch_vccz L_aw_84
 buffer_store_dword v1, off, s[96:99], 0 offset:136 sc1
L_aw_84:
 s_mov_b64 exec, -1
L_ar_83:
 v_lshrrev_b32 v1, 4, v0
 s_mov_b32 s3, 1280
 v_mul_lo_u32 v1, v1, s3
 v_and_b32 v3, 15, v0
 v_lshl_add_u32 v1, v3, 4, v1
 v_add_u32 v6, 5120, v1
 v_mov_b32 v24, v6
 v_and_b32 v2, 31, v0
 v_lshlrev_b32 v2, 8, v2
 v_lshrrev_b32 v4, 5, v0
 v_xor_b32 v4, v4, v3
 v_xor_b32 v8, 0, v4
 v_lshl_add_u32 v8, v8, 4, v2
 v_add_u32 v16, 40960, v8
 v_xor_b32 v9, 2, v4
 v_lshl_add_u32 v9, v9, 4, v2
 v_add_u32 v17, 40960, v9
 v_xor_b32 v10, 4, v4
 v_lshl_add_u32 v10, v10, 4, v2
 v_add_u32 v18, 40960, v10
 v_xor_b32 v11, 6, v4
 v_lshl_add_u32 v11, v11, 4, v2
 v_add_u32 v19, 40960, v11
 v_xor_b32 v12, 8, v4
 v_lshl_add_u32 v12, v12, 4, v2
 v_add_u32 v20, 40960, v12
 v_xor_b32 v13, 10, v4
 v_lshl_add_u32 v13, v13, 4, v2
 v_add_u32 v21, 40960, v13
 v_xor_b32 v14, 12, v4
 v_lshl_add_u32 v14, v14, 4, v2
 v_add_u32 v22, 40960, v14
 v_xor_b32 v15, 14, v4
 v_lshl_add_u32 v15, v15, 4, v2
 v_add_u32 v23, 40960, v15
 v_lshrrev_b32 v4, 5, v0
 v_lshlrev_b32 v4, 8, v4
 v_lshl_add_u32 v4, v3, 4, v4
 v_and_b32 v2, 16, v0
 v_lshl_add_u32 v4, v2, 6, v4
 s_lshl_b32 s3, s50, 11
 v_add_u32 v4, s3, v4
 v_mul_u32_u24 v5, 24576, v0
 v_mov_b32 v7, 163776
 v_mul_u32_u24 v30, 16384, v0
L_cv_80:
 s_cmp_lg_u32 s54, 10
 s_cbranch_scc1 L_cb_85
 s_cmp_lg_u32 s50, 0
 s_cbranch_scc1 L_ww_86
 s_mov_b32 s96, s44
 s_and_b32 s97, s45, 0xffff
 s_mov_b32 s98, 256
 s_mov_b32 s99, 0x00020000
 v_mov_b32 v25, 200
 s_mov_b32 s51, 0
 s_mov_b64 exec, 1
L_wb_87:
 buffer_load_dword v26, v25, s[96:99], 0 offen sc1
 s_waitcnt vmcnt(0)
 v_cmp_eq_u32 vcc, 0, v26
 s_cbranch_vccz L_wbd_88
 s_sleep 2
 s_add_u32 s51, s51, 1
 s_cmp_lt_u32 s51, 131072
 s_cbranch_scc1 L_wb_87
 s_branch L_bail
L_wbd_88:
 s_mov_b64 exec, -1
L_ww_86:
 s_barrier
L_cb_85:
 s_cmp_lt_u32 s54, 16
 s_cbranch_scc1 L_qkvv_pre
 s_waitcnt vmcnt(0)
 s_cmp_eq_u32 s61, 0
 s_cbranch_scc1 L_pf_90
 s_lshl_b32 s3, s61, 2
 s_add_u32 s3, s3, s59
 s_sub_u32 s3, s3, 4
 v_mov_b32 v3, 1
 s_mov_b64 exec, s[78:79]
 buffer_atomic_add v3, v30, s[4:7], s3 offen
 s_mov_b64 exec, -1
 s_mov_b32 s61, 0
L_pf_90:
 s_lshl_b32 s62, s62, 8
 s_add_u32 s62, s62, 126976
 s_add_u32 s63, s59, 8128
L_qkvv_block:
 s_lshl_b32 s55, s54, 2
 s_add_u32 s55, s55, s62
 s_sub_u32 s55, s55, 64
 s_cmp_lg_u32 s50, 0
 s_cselect_b32 s3, 268435456, s55
 v_mov_b32 v6, 8
 s_mov_b64 exec, 15
 v_mov_b32 v6, 0
 buffer_atomic_add v6, v5, s[4:7], s3 offen sc0
 s_mov_b64 exec, -1
 s_waitcnt vmcnt(0)
 s_cmp_eq_u32 s61, 0
 s_cbranch_scc1 L_pf_93
 s_lshl_b32 s3, s61, 2
 s_add_u32 s3, s3, s59
 s_sub_u32 s3, s3, 4
 v_mov_b32 v3, 1
 s_mov_b64 exec, s[78:79]
 buffer_atomic_add v3, v30, s[4:7], s3 offen
 s_mov_b64 exec, -1
 s_mov_b32 s61, 0
L_pf_93:
 s_cmp_lg_u32 s50, 0
 s_cbranch_scc1 L_w_91
 v_cmp_gt_u32 vcc, 8, v6
 s_cbranch_vccz L_w_91
 s_mov_b32 s51, 0
 s_mov_b64 exec, 15
 v_mov_b32 v28, 0
 buffer_atomic_add v28, v5, s[4:7], s55 offen sc0
 s_sleep 5
L_wc_94:
 v_mov_b32 v29, 0
 buffer_atomic_add v29, v5, s[4:7], s55 offen sc0
 s_waitcnt vmcnt(1)
 v_cmp_gt_u32 vcc, 8, v28
 s_cbranch_vccz L_wcd_95
 v_mov_b32 v28, 0
 buffer_atomic_add v28, v5, s[4:7], s55 offen sc0
 s_waitcnt vmcnt(1)
 v_cmp_gt_u32 vcc, 8, v29
 s_cbranch_vccz L_wcd_95
 s_add_u32 s51, s51, 1
 s_cmp_lt_u32 s51, 131072
 s_cbranch_scc1 L_wc_94
 s_branch L_bail
L_wcd_95:
 s_mov_b64 exec, -1
L_w_91:
 s_barrier
 s_branch L_qkvv_loop
L_qkvv_fast:
 s_cmp_lg_u32 s54, 32
 s_cbranch_scc1 L_c2_97
 s_cmp_lg_u32 s50, 0
 s_cbranch_scc1 L_ww_98
 s_mov_b32 s96, s44
 s_and_b32 s97, s45, 0xffff
 s_mov_b32 s98, 256
 s_mov_b32 s99, 0x00020000
 v_mov_b32 v25, 140
 s_mov_b32 s51, 0
 s_mov_b64 exec, 1
L_wb_99:
 buffer_load_dword v26, v25, s[96:99], 0 offen sc1
 s_waitcnt vmcnt(0)
 v_cmp_eq_u32 vcc, 0, v26
 s_cbranch_vccz L_wbd_100
 s_sleep 2
 s_add_u32 s51, s51, 1
 s_cmp_lt_u32 s51, 131072
 s_cbranch_scc1 L_wb_99
 s_branch L_bail
L_wbd_100:
 s_mov_b64 exec, -1
L_ww_98:
 s_barrier
L_c2_97:
 s_sub_u32 s60, s54, 16
 s_lshl_b32 s70, s54, 2
 s_add_u32 s70, s70, s62
 s_sub_u32 s70, s70, 60
 s_cmp_lg_u32 s50, 0
 s_cselect_b32 s70, 268435456, s70
 s_min_u32 s51, s54, 63
 s_mul_i32 s55, s51, 40960
 s_mul_i32 s3, s50, 10240
 s_add_u32 s55, s55, s3
 s_add_u32 s55, s55, 226492416
 ds_read_b128 v[32:35], v16 offset:0
 ds_read_b128 v[36:39], v17 offset:0
 ds_read_b128 v[40:43], v18 offset:0
 ds_read_b128 v[44:47], v19 offset:0
 s_waitcnt lgkmcnt(3)
 v_mfma_f32_32x32x16_bf16 v[64:79], v[32:35], a[0:3], 0
 ds_read_b128 v[48:51], v20 offset:0
 s_add_u32 m0, s56, 0
 s_add_u32 s3, s55, s64
 buffer_load_dwordx4 v1, s[4:7], s3 offen sc1 lds
 s_waitcnt lgkmcnt(3)
 v_mfma_f32_32x32x16_bf16 v[64:79], v[36:39], a[4:7], v[64:79]
 ds_read_b128 v[52:55], v21 offset:0
 s_waitcnt lgkmcnt(3)
 v_mfma_f32_32x32x16_bf16 v[64:79], v[40:43], a[8:11], v[64:79]
 ds_read_b128 v[56:59], v22 offset:0
 s_waitcnt lgkmcnt(3)
 v_mfma_f32_32x32x16_bf16 v[64:79], v[44:47], a[12:15], v[64:79]
 ds_read_b128 v[60:63], v23 offset:0
 s_add_u32 m0, s56, 1024
 s_add_u32 s3, s55, s64
 buffer_load_dwordx4 v24, s[4:7], s3 offen sc1 lds
 s_waitcnt lgkmcnt(3)
 v_mfma_f32_32x32x16_bf16 v[64:79], v[48:51], a[16:19], v[64:79]
 ds_read_b128 v[32:35], v16 offset:8192
 s_waitcnt lgkmcnt(3)
 v_mfma_f32_32x32x16_bf16 v[64:79], v[52:55], a[20:23], v[64:79]
 ds_read_b128 v[36:39], v17 offset:8192
 s_waitcnt lgkmcnt(3)
 v_mfma_f32_32x32x16_bf16 v[64:79], v[56:59], a[24:27], v[64:79]
 ds_read_b128 v[40:43], v18 offset:8192
 s_add_u32 m0, s56, 8192
 s_add_u32 s3, s55, s65
 buffer_load_dwordx4 v1, s[4:7], s3 offen sc1 lds
 s_waitcnt lgkmcnt(3)
 v_mfma_f32_32x32x16_bf16 v[64:79], v[60:63], a[28:31], v[64:79]
 ds_read_b128 v[44:47], v19 offset:8192
 s_waitcnt lgkmcnt(3)
 v_mfma_f32_32x32x16_bf16 v[64:79], v[32:35], a[32:35], v[64:79]
 ds_read_b128 v[48:51], v20 offset:8192
 s_waitcnt lgkmcnt(3)
 v_mfma_f32_32x32x16_bf16 v[64:79], v[36:39], a[36:39], v[64:79]
 ds_read_b128 v[52:55], v21 offset:8192
 s_add_u32 m0, s56, 9216
 s_add_u32 s3, s55, s65
 buffer_load_dwordx4 v24, s[4:7], s3 offen sc1 lds
 s_waitcnt lgkmcnt(3)
 v_mfma_f32_32x32x16_bf16 v[64:79], v[40:43], a[40:43], v[64:79]
 ds_read_b128 v[56:59], v22 offset:8192
 s_waitcnt lgkmcnt(3)
 v_mfma_f32_32x32x16_bf16 v[64:79], v[44:47], a[44:47], v[64:79]
 ds_read_b128 v[60:63], v23 offset:8192
 s_waitcnt lgkmcnt(3)
 v_mfma_f32_32x32x16_bf16 v[64:79], v[48:51], a[48:51], v[64:79]
 ds_read_b128 v[32:35], v16 offset:16384
 s_add_u32 m0, s56, 16384
 s_add_u32 s3, s55, s66
 buffer_load_dwordx4 v1, s[4:7], s3 offen sc1 lds
 s_waitcnt lgkmcnt(3)
 v_mfma_f32_32x32x16_bf16 v[64:79], v[52:55], a[52:55], v[64:79]
 ds_read_b128 v[36:39], v17 offset:16384
 s_waitcnt lgkmcnt(3)
 v_mfma_f32_32x32x16_bf16 v[64:79], v[56:59], a[56:59], v[64:79]
 ds_read_b128 v[40:43], v18 offset:16384
 s_waitcnt lgkmcnt(3)
 v_mfma_f32_32x32x16_bf16 v[64:79], v[60:63], a[60:63], v[64:79]
 ds_read_b128 v[44:47], v19 offset:16384
 s_add_u32 m0, s56, 17408
 s_add_u32 s3, s55, s66
 buffer_load_dwordx4 v24, s[4:7], s3 offen sc1 lds
 s_waitcnt lgkmcnt(3)
 v_mfma_f32_32x32x16_bf16 v[64:79], v[32:35], a[64:67], v[64:79]
 ds_read_b128 v[48:51], v20 offset:16384
 s_waitcnt lgkmcnt(3)
 v_mfma_f32_32x32x16_bf16 v[64:79], v[36:39], a[68:71], v[64:79]
 ds_read_b128 v[52:55], v21 offset:16384
 s_waitcnt lgkmcnt(3)
 v_mfma_f32_32x32x16_bf16 v[64:79], v[40:43], a[72:75], v[64:79]
 ds_read_b128 v[56:59], v22 offset:16384
 s_add_u32 m0, s56, 24576
 s_add_u32 s3, s55, s67
 buffer_load_dwordx4 v1, s[4:7], s3 offen sc1 lds
 s_waitcnt lgkmcnt(3)
 v_mfma_f32_32x32x16_bf16 v[64:79], v[44:47], a[76:79], v[64:79]
 ds_read_b128 v[60:63], v23 offset:16384
 s_waitcnt lgkmcnt(3)
 v_mfma_f32_32x32x16_bf16 v[64:79], v[48:51], a[80:83], v[64:79]
 ds_read_b128 v[32:35], v16 offset:24576
 s_waitcnt lgkmcnt(3)
 v_mfma_f32_32x32x16_bf16 v[64:79], v[52:55], a[84:87], v[64:79]
 ds_read_b128 v[36:39], v17 offset:24576
 s_add_u32 m0, s56, 25600
 s_add_u32 s3, s55, s67
 buffer_load_dwordx4 v24, s[4:7], s3 offen sc1 lds
 s_waitcnt lgkmcnt(3)
 v_mfma_f32_32x32x16_bf16 v[64:79], v[56:59], a[88:91], v[64:79]
 ds_read_b128 v[40:43], v18 offset:24576
 s_waitcnt lgkmcnt(3)
 v_mfma_f32_32x32x16_bf16 v[64:79], v[60:63], a[92:95], v[64:79]
 ds_read_b128 v[44:47], v19 offset:24576
 s_waitcnt lgkmcnt(3)
 v_mfma_f32_32x32x16_bf16 v[64:79], v[32:35], a[96:99], v[64:79]
 ds_read_b128 v[48:51], v20 offset:24576
 s_add_u32 m0, s56, 32768
 s_add_u32 s3, s55, s68
 buffer_load_dwordx4 v1, s[4:7], s3 offen sc1 lds
 s_waitcnt lgkmcnt(3)
 v_mfma_f32_32x32x16_bf16 v[64:79], v[36:39], a[100:103], v[64:79]
 ds_read_b128 v[52:55], v21 offset:24576
 s_waitcnt lgkmcnt(3)
 v_mfma_f32_32x32x16_bf16 v[64:79], v[40:43], a[104:107], v[64:79]
 ds_read_b128 v[56:59], v22 offset:24576
 s_waitcnt lgkmcnt(3)
 v_mfma_f32_32x32x16_bf16 v[64:79], v[44:47], a[108:111], v[64:79]
 ds_read_b128 v[60:63], v23 offset:24576
 s_add_u32 m0, s56, 33792
 s_add_u32 s3, s55, s68
 buffer_load_dwordx4 v24, s[4:7], s3 offen sc1 lds
 s_waitcnt lgkmcnt(3)
 v_mfma_f32_32x32x16_bf16 v[64:79], v[48:51], a[112:115], v[64:79]
 ds_read_b128 v[32:35], v16 offset:32768
 s_waitcnt lgkmcnt(3)
 v_mfma_f32_32x32x16_bf16 v[64:79], v[52:55], a[116:119], v[64:79]
 ds_read_b128 v[36:39], v17 offset:32768
 v_mov_b32 v6, 8
 s_mov_b64 exec, 15
 v_mov_b32 v6, 0
 buffer_atomic_add v6, v5, s[4:7], s70 offen sc0
 s_mov_b64 exec, -1
 s_waitcnt lgkmcnt(3)
 v_mfma_f32_32x32x16_bf16 v[64:79], v[56:59], a[120:123], v[64:79]
 ds_read_b128 v[40:43], v18 offset:32768
 s_waitcnt lgkmcnt(3)
 v_mfma_f32_32x32x16_bf16 v[64:79], v[60:63], a[124:127], v[64:79]
 ds_read_b128 v[44:47], v19 offset:32768
 s_waitcnt lgkmcnt(3)
 v_mfma_f32_32x32x16_bf16 v[64:79], v[32:35], a[128:131], v[64:79]
 ds_read_b128 v[48:51], v20 offset:32768
 s_waitcnt lgkmcnt(3)
 v_mfma_f32_32x32x16_bf16 v[64:79], v[36:39], a[132:135], v[64:79]
 ds_read_b128 v[52:55], v21 offset:32768
 s_waitcnt lgkmcnt(3)
 v_mfma_f32_32x32x16_bf16 v[64:79], v[40:43], a[136:139], v[64:79]
 ds_read_b128 v[56:59], v22 offset:32768
 s_waitcnt lgkmcnt(3)
 v_mfma_f32_32x32x16_bf16 v[64:79], v[44:47], a[140:143], v[64:79]
 ds_read_b128 v[60:63], v23 offset:32768
 s_waitcnt lgkmcnt(3)
 v_mfma_f32_32x32x16_bf16 v[64:79], v[48:51], a[144:147], v[64:79]
 s_waitcnt lgkmcnt(2)
 v_mfma_f32_32x32x16_bf16 v[64:79], v[52:55], a[148:151], v[64:79]
 s_waitcnt lgkmcnt(1)
 v_mfma_f32_32x32x16_bf16 v[64:79], v[56:59], a[152:155], v[64:79]
 s_waitcnt lgkmcnt(0)
 v_mfma_f32_32x32x16_bf16 v[64:79], v[60:63], a[156:159], v[64:79]
 s_lshl_b32 s3, s60, 19
 s_add_u32 s3, s3, s58
 s_xor_b32 s3, s3, s82
 s_add_u32 s3, s3, 33554432
 s_nop 8
 v_cvt_pk_bf16_f32 v88, v64, v65
 v_cvt_pk_bf16_f32 v89, v66, v67
 v_cvt_pk_bf16_f32 v90, v72, v73
 v_cvt_pk_bf16_f32 v91, v74, v75
 buffer_store_dwordx4 v[88:91], v4, s[4:7], s3 offen offset:0 sc1
 v_cvt_pk_bf16_f32 v92, v68, v69
 v_cvt_pk_bf16_f32 v93, v70, v71
 v_cvt_pk_bf16_f32 v94, v76, v77
 v_cvt_pk_bf16_f32 v95, v78, v79
 buffer_store_dwordx4 v[92:95], v4, s[4:7], s3 offen offset:512 sc1
 s_branch L_qkvv_mid
L_qkvv_loop:
 s_cmp_lg_u32 s54, 32
 s_cbranch_scc1 L_c2_101
 s_cmp_lg_u32 s50, 0
 s_cbranch_scc1 L_ww_102
 s_mov_b32 s96, s44
 s_and_b32 s97, s45, 0xffff
 s_mov_b32 s98, 256
 s_mov_b32 s99, 0x00020000
 v_mov_b32 v25, 140
 s_mov_b32 s51, 0
 s_mov_b64 exec, 1
L_wb_103:
 buffer_load_dword v26, v25, s[96:99], 0 offen sc1
 s_waitcnt vmcnt(0)
 v_cmp_eq_u32 vcc, 0, v26
 s_cbranch_vccz L_wbd_104
 s_sleep 2
 s_add_u32 s51, s51, 1
 s_cmp_lt_u32 s51, 131072
 s_cbranch_scc1 L_wb_103
 s_branch L_bail
L_wbd_104:
 s_mov_b64 exec, -1
L_ww_102:
 s_barrier
L_c2_101:
 s_sub_u32 s60, s54, 16
 s_mul_i32 s55, s60, 40960
 s_mul_i32 s3, s50, 10240
 s_add_u32 s55, s55, s3
 s_add_u32 s55, s55, 229113856
 s_add_u32 m0, s56, 40960
 s_add_u32 s3, s55, s64
 buffer_load_dwordx4 v1, s[4:7], s3 offen sc1 lds
 s_add_u32 m0, s56, 41984
 s_add_u32 s3, s55, s64
 buffer_load_dwordx4 v24, s[4:7], s3 offen sc1 lds
 s_add_u32 m0, s56, 49152
 s_add_u32 s3, s55, s65
 buffer_load_dwordx4 v1, s[4:7], s3 offen sc1 lds
 s_add_u32 m0, s56, 50176
 s_add_u32 s3, s55, s65
 buffer_load_dwordx4 v24, s[4:7], s3 offen sc1 lds
 s_add_u32 m0, s56, 57344
 s_add_u32 s3, s55, s66
 buffer_load_dwordx4 v1, s[4:7], s3 offen sc1 lds
 s_add_u32 m0, s56, 58368
 s_add_u32 s3, s55, s66
 buffer_load_dwordx4 v24, s[4:7], s3 offen sc1 lds
 s_add_u32 m0, s56, 65536
 s_add_u32 s3, s55, s67
 buffer_load_dwordx4 v1, s[4:7], s3 offen sc1 lds
 s_add_u32 m0, s56, 66560
 s_add_u32 s3, s55, s67
 buffer_load_dwordx4 v24, s[4:7], s3 offen sc1 lds
 s_add_u32 m0, s56, 73728
 s_add_u32 s3, s55, s68
 buffer_load_dwordx4 v1, s[4:7], s3 offen sc1 lds
 s_add_u32 m0, s56, 74752
 s_add_u32 s3, s55, s68
 buffer_load_dwordx4 v24, s[4:7], s3 offen sc1 lds
 s_lshl_b32 s70, s54, 2
 s_add_u32 s70, s70, s62
 s_sub_u32 s70, s70, 60
 s_cmp_lg_u32 s50, 0
 s_cselect_b32 s70, 268435456, s70
 s_min_u32 s51, s54, 63
 s_mul_i32 s55, s51, 40960
 s_mul_i32 s3, s50, 10240
 s_add_u32 s55, s55, s3
 s_add_u32 s55, s55, 226492416
 s_waitcnt vmcnt(8)
 s_barrier
 ds_read_b128 v[32:35], v16 offset:0
 ds_read_b128 v[36:39], v17 offset:0
 ds_read_b128 v[40:43], v18 offset:0
 ds_read_b128 v[44:47], v19 offset:0
 s_waitcnt lgkmcnt(3)
 v_mfma_f32_32x32x16_bf16 v[64:79], v[32:35], a[0:3], 0
 ds_read_b128 v[48:51], v20 offset:0
 s_add_u32 m0, s56, 0
 s_add_u32 s3, s55, s64
 buffer_load_dwordx4 v1, s[4:7], s3 offen sc1 lds
 s_waitcnt lgkmcnt(3)
 v_mfma_f32_32x32x16_bf16 v[64:79], v[36:39], a[4:7], v[64:79]
 ds_read_b128 v[52:55], v21 offset:0
 s_waitcnt lgkmcnt(3)
 v_mfma_f32_32x32x16_bf16 v[64:79], v[40:43], a[8:11], v[64:79]
 ds_read_b128 v[56:59], v22 offset:0
 s_waitcnt lgkmcnt(3)
 v_mfma_f32_32x32x16_bf16 v[64:79], v[44:47], a[12:15], v[64:79]
 ds_read_b128 v[60:63], v23 offset:0
 s_add_u32 m0, s56, 1024
 s_add_u32 s3, s55, s64
 buffer_load_dwordx4 v24, s[4:7], s3 offen sc1 lds
 s_waitcnt lgkmcnt(3)
 v_mfma_f32_32x32x16_bf16 v[64:79], v[48:51], a[16:19], v[64:79]
 s_waitcnt vmcnt(8)
 s_barrier
 ds_read_b128 v[32:35], v16 offset:8192
 s_waitcnt lgkmcnt(3)
 v_mfma_f32_32x32x16_bf16 v[64:79], v[52:55], a[20:23], v[64:79]
 ds_read_b128 v[36:39], v17 offset:8192
 s_waitcnt lgkmcnt(3)
 v_mfma_f32_32x32x16_bf16 v[64:79], v[56:59], a[24:27], v[64:79]
 ds_read_b128 v[40:43], v18 offset:8192
 s_add_u32 m0, s56, 8192
 s_add_u32 s3, s55, s65
 buffer_load_dwordx4 v1, s[4:7], s3 offen sc1 lds
 s_waitcnt lgkmcnt(3)
 v_mfma_f32_32x32x16_bf16 v[64:79], v[60:63], a[28:31], v[64:79]
 ds_read_b128 v[44:47], v19 offset:8192
 s_waitcnt lgkmcnt(3)
 v_mfma_f32_32x32x16_bf16 v[64:79], v[32:35], a[32:35], v[64:79]
 ds_read_b128 v[48:51], v20 offset:8192
 s_waitcnt lgkmcnt(3)
 v_mfma_f32_32x32x16_bf16 v[64:79], v[36:39], a[36:39], v[64:79]
 ds_read_b128 v[52:55], v21 offset:8192
 s_add_u32 m0, s56, 9216
 s_add_u32 s3, s55, s65
 buffer_load_dwordx4 v24, s[4:7], s3 offen sc1 lds
 s_waitcnt lgkmcnt(3)
 v_mfma_f32_32x32x16_bf16 v[64:79], v[40:43], a[40:43], v[64:79]
 ds_read_b128 v[56:59], v22 offset:8192
 s_waitcnt lgkmcnt(3)
 v_mfma_f32_32x32x16_bf16 v[64:79], v[44:47], a[44:47], v[64:79]
 ds_read_b128 v[60:63], v23 offset:8192
 s_waitcnt lgkmcnt(3)
 v_mfma_f32_32x32x16_bf16 v[64:79], v[48:51], a[48:51], v[64:79]
 s_waitcnt vmcnt(8)
 s_barrier
 ds_read_b128 v[32:35], v16 offset:16384
 s_add_u32 m0, s56, 16384
 s_add_u32 s3, s55, s66
 buffer_load_dwordx4 v1, s[4:7], s3 offen sc1 lds
 s_waitcnt lgkmcnt(3)
 v_mfma_f32_32x32x16_bf16 v[64:79], v[52:55], a[52:55], v[64:79]
 ds_read_b128 v[36:39], v17 offset:16384
 s_waitcnt lgkmcnt(3)
 v_mfma_f32_32x32x16_bf16 v[64:79], v[56:59], a[56:59], v[64:79]
 ds_read_b128 v[40:43], v18 offset:16384
 s_waitcnt lgkmcnt(3)
 v_mfma_f32_32x32x16_bf16 v[64:79], v[60:63], a[60:63], v[64:79]
 ds_read_b128 v[44:47], v19 offset:16384
 s_add_u32 m0, s56, 17408
 s_add_u32 s3, s55, s66
 buffer_load_dwordx4 v24, s[4:7], s3 offen sc1 lds
 s_waitcnt lgkmcnt(3)
 v_mfma_f32_32x32x16_bf16 v[64:79], v[32:35], a[64:67], v[64:79]
 ds_read_b128 v[48:51], v20 offset:16384
 s_waitcnt lgkmcnt(3)
 v_mfma_f32_32x32x16_bf16 v[64:79], v[36:39], a[68:71], v[64:79]
 ds_read_b128 v[52:55], v21 offset:16384
 s_waitcnt lgkmcnt(3)
 v_mfma_f32_32x32x16_bf16 v[64:79], v[40:43], a[72:75], v[64:79]
 ds_read_b128 v[56:59], v22 offset:16384
 s_add_u32 m0, s56, 24576
 s_add_u32 s3, s55, s67
 buffer_load_dwordx4 v1, s[4:7], s3 offen sc1 lds
 s_waitcnt lgkmcnt(3)
 v_mfma_f32_32x32x16_bf16 v[64:79], v[44:47], a[76:79], v[64:79]
 ds_read_b128 v[60:63], v23 offset:16384
 s_waitcnt lgkmcnt(3)
 v_mfma_f32_32x32x16_bf16 v[64:79], v[48:51], a[80:83], v[64:79]
 s_waitcnt vmcnt(9)
 s_barrier
 ds_read_b128 v[32:35], v16 offset:24576
 s_waitcnt lgkmcnt(3)
 v_mfma_f32_32x32x16_bf16 v[64:79], v[52:55], a[84:87], v[64:79]
 ds_read_b128 v[36:39], v17 offset:24576
 s_add_u32 m0, s56, 25600
 s_add_u32 s3, s55, s67
 buffer_load_dwordx4 v24, s[4:7], s3 offen sc1 lds
 s_waitcnt lgkmcnt(3)
 v_mfma_f32_32x32x16_bf16 v[64:79], v[56:59], a[88:91], v[64:79]
 ds_read_b128 v[40:43], v18 offset:24576
 s_waitcnt lgkmcnt(3)
 v_mfma_f32_32x32x16_bf16 v[64:79], v[60:63], a[92:95], v[64:79]
 ds_read_b128 v[44:47], v19 offset:24576
 s_waitcnt lgkmcnt(3)
 v_mfma_f32_32x32x16_bf16 v[64:79], v[32:35], a[96:99], v[64:79]
 ds_read_b128 v[48:51], v20 offset:24576
 s_add_u32 m0, s56, 32768
 s_add_u32 s3, s55, s68
 buffer_load_dwordx4 v1, s[4:7], s3 offen sc1 lds
 s_waitcnt lgkmcnt(3)
 v_mfma_f32_32x32x16_bf16 v[64:79], v[36:39], a[100:103], v[64:79]
 ds_read_b128 v[52:55], v21 offset:24576
 s_waitcnt lgkmcnt(3)
 v_mfma_f32_32x32x16_bf16 v[64:79], v[40:43], a[104:107], v[64:79]
 ds_read_b128 v[56:59], v22 offset:24576
 s_waitcnt lgkmcnt(3)
 v_mfma_f32_32x32x16_bf16 v[64:79], v[44:47], a[108:111], v[64:79]
 ds_read_b128 v[60:63], v23 offset:24576
 s_add_u32 m0, s56, 33792
 s_add_u32 s3, s55, s68
 buffer_load_dwordx4 v24, s[4:7], s3 offen sc1 lds
 s_waitcnt lgkmcnt(3)
 v_mfma_f32_32x32x16_bf16 v[64:79], v[48:51], a[112:115], v[64:79]
 s_waitcnt vmcnt(10)
 s_barrier
 ds_read_b128 v[32:35], v16 offset:32768
 s_waitcnt lgkmcnt(3)
 v_mfma_f32_32x32x16_bf16 v[64:79], v[52:55], a[116:119], v[64:79]
 ds_read_b128 v[36:39], v17 offset:32768
 v_mov_b32 v6, 8
 s_mov_b64 exec, 15
 v_mov_b32 v6, 0
 buffer_atomic_add v6, v5, s[4:7], s70 offen sc0
 s_mov_b64 exec, -1
 s_waitcnt lgkmcnt(3)
 v_mfma_f32_32x32x16_bf16 v[64:79], v[56:59], a[120:123], v[64:79]
 ds_read_b128 v[40:43], v18 offset:32768
 s_waitcnt lgkmcnt(3)
 v_mfma_f32_32x32x16_bf16 v[64:79], v[60:63], a[124:127], v[64:79]
 ds_read_b128 v[44:47], v19 offset:32768
 s_waitcnt lgkmcnt(3)
 v_mfma_f32_32x32x16_bf16 v[64:79], v[32:35], a[128:131], v[64:79]
 ds_read_b128 v[48:51], v20 offset:32768
 s_waitcnt lgkmcnt(3)
 v_mfma_f32_32x32x16_bf16 v[64:79], v[36:39], a[132:135], v[64:79]
 ds_read_b128 v[52:55], v21 offset:32768
 s_waitcnt lgkmcnt(3)
 v_mfma_f32_32x32x16_bf16 v[64:79], v[40:43], a[136:139], v[64:79]
 ds_read_b128 v[56:59], v22 offset:32768
 s_waitcnt lgkmcnt(3)
 v_mfma_f32_32x32x16_bf16 v[64:79], v[44:47], a[140:143], v[64:79]
 ds_read_b128 v[60:63], v23 offset:32768
 s_waitcnt lgkmcnt(3)
 v_mfma_f32_32x32x16_bf16 v[64:79], v[48:51], a[144:147], v[64:79]
 s_waitcnt lgkmcnt(2)
 v_mfma_f32_32x32x16_bf16 v[64:79], v[52:55], a[148:151], v[64:79]
 s_waitcnt lgkmcnt(1)
 v_mfma_f32_32x32x16_bf16 v[64:79], v[56:59], a[152:155], v[64:79]
 s_waitcnt lgkmcnt(0)
 v_mfma_f32_32x32x16_bf16 v[64:79], v[60:63], a[156:159], v[64:79]
 s_lshl_b32 s3, s60, 19
 s_add_u32 s3, s3, s58
 s_xor_b32 s3, s3, s82
 s_add_u32 s3, s3, 33554432
 s_nop 8
 v_cvt_pk_bf16_f32 v88, v64, v65
 v_cvt_pk_bf16_f32 v89, v66, v67
 v_cvt_pk_bf16_f32 v90, v72, v73
 v_cvt_pk_bf16_f32 v91, v74, v75
 buffer_store_dwordx4 v[88:91], v4, s[4:7], s3 offen offset:0 sc1
 v_cvt_pk_bf16_f32 v92, v68, v69
 v_cvt_pk_bf16_f32 v93, v70, v71
 v_cvt_pk_bf16_f32 v94, v76, v77
 v_cvt_pk_bf16_f32 v95, v78, v79
 buffer_store_dwordx4 v[92:95], v4, s[4:7], s3 offen offset:512 sc1
L_qkvv_mid:
 s_cmp_ge_u32 s54, 64
 s_cbranch_scc1 L_n0_96
 s_waitcnt vmcnt(2)
 s_cmp_lg_u32 s50, 0
 s_cbranch_scc1 L_w_105
 v_cmp_gt_u32 vcc, 8, v6
 s_nop 1
 v_mov_b32 v3, vcc_lo
 ds_write_b32 v7, v3
 s_waitcnt lgkmcnt(0)
L_w_105:
 s_barrier
 ds_read_b32 v3, v7
 s_waitcnt lgkmcnt(0)
 v_readfirstlane_b32 s3, v3
 s_mov_b32 s69, s3
 s_add_u32 s51, s60, 1
 s_mov_b32 s60, s54
 s_mul_i32 s55, s51, 40960
 s_mul_i32 s3, s50, 10240
 s_add_u32 s55, s55, s3
 s_add_u32 s55, s55, 229113856
 s_cmp_eq_u32 s69, 0
 s_cselect_b32 s55, s55, 268435456
 ds_read_b128 v[32:35], v8 offset:0
 ds_read_b128 v[36:39], v9 offset:0
 ds_read_b128 v[40:43], v10 offset:0
 ds_read_b128 v[44:47], v11 offset:0
 s_waitcnt lgkmcnt(3)
 v_mfma_f32_32x32x16_bf16 v[64:79], v[32:35], a[0:3], 0
 ds_read_b128 v[48:51], v12 offset:0
 s_add_u32 m0, s56, 40960
 s_add_u32 s3, s55, s64
 buffer_load_dwordx4 v1, s[4:7], s3 offen sc1 lds
 s_waitcnt lgkmcnt(3)
 v_mfma_f32_32x32x16_bf16 v[64:79], v[36:39], a[4:7], v[64:79]
 ds_read_b128 v[52:55], v13 offset:0
 s_waitcnt lgkmcnt(3)
 v_mfma_f32_32x32x16_bf16 v[64:79], v[40:43], a[8:11], v[64:79]
 ds_read_b128 v[56:59], v14 offset:0
 s_waitcnt lgkmcnt(3)
 v_mfma_f32_32x32x16_bf16 v[64:79], v[44:47], a[12:15], v[64:79]
 ds_read_b128 v[60:63], v15 offset:0
 s_add_u32 m0, s56, 41984
 s_add_u32 s3, s55, s64
 buffer_load_dwordx4 v24, s[4:7], s3 offen sc1 lds
 s_waitcnt lgkmcnt(3)
 v_mfma_f32_32x32x16_bf16 v[64:79], v[48:51], a[16:19], v[64:79]
 ds_read_b128 v[32:35], v8 offset:8192
 s_waitcnt lgkmcnt(3)
 v_mfma_f32_32x32x16_bf16 v[64:79], v[52:55], a[20:23], v[64:79]
 ds_read_b128 v[36:39], v9 offset:8192
 s_waitcnt lgkmcnt(3)
 v_mfma_f32_32x32x16_bf16 v[64:79], v[56:59], a[24:27], v[64:79]
 ds_read_b128 v[40:43], v10 offset:8192
 s_add_u32 m0, s56, 49152
 s_add_u32 s3, s55, s65
 buffer_load_dwordx4 v1, s[4:7], s3 offen sc1 lds
 s_waitcnt lgkmcnt(3)
 v_mfma_f32_32x32x16_bf16 v[64:79], v[60:63], a[28:31], v[64:79]
 ds_read_b128 v[44:47], v11 offset:8192
 s_waitcnt lgkmcnt(3)
 v_mfma_f32_32x32x16_bf16 v[64:79], v[32:35], a[32:35], v[64:79]
 ds_read_b128 v[48:51], v12 offset:8192
 s_waitcnt lgkmcnt(3)
 v_mfma_f32_32x32x16_bf16 v[64:79], v[36:39], a[36:39], v[64:79]
 ds_read_b128 v[52:55], v13 offset:8192
 s_add_u32 m0, s56, 50176
 s_add_u32 s3, s55, s65
 buffer_load_dwordx4 v24, s[4:7], s3 offen sc1 lds
 s_waitcnt lgkmcnt(3)
 v_mfma_f32_32x32x16_bf16 v[64:79], v[40:43], a[40:43], v[64:79]
 ds_read_b128 v[56:59], v14 offset:8192
 s_waitcnt lgkmcnt(3)
 v_mfma_f32_32x32x16_bf16 v[64:79], v[44:47], a[44:47], v[64:79]
 ds_read_b128 v[60:63], v15 offset:8192
 s_waitcnt lgkmcnt(3)
 v_mfma_f32_32x32x16_bf16 v[64:79], v[48:51], a[48:51], v[64:79]
 ds_read_b128 v[32:35], v8 offset:16384
 s_add_u32 m0, s56, 57344
 s_add_u32 s3, s55, s66
 buffer_load_dwordx4 v1, s[4:7], s3 offen sc1 lds
 s_waitcnt lgkmcnt(3)
 v_mfma_f32_32x32x16_bf16 v[64:79], v[52:55], a[52:55], v[64:79]
 ds_read_b128 v[36:39], v9 offset:16384
 s_waitcnt lgkmcnt(3)
 v_mfma_f32_32x32x16_bf16 v[64:79], v[56:59], a[56:59], v[64:79]
 ds_read_b128 v[40:43], v10 offset:16384
 s_waitcnt lgkmcnt(3)
 v_mfma_f32_32x32x16_bf16 v[64:79], v[60:63], a[60:63], v[64:79]
 ds_read_b128 v[44:47], v11 offset:16384
 s_add_u32 m0, s56, 58368
 s_add_u32 s3, s55, s66
 buffer_load_dwordx4 v24, s[4:7], s3 offen sc1 lds
 s_waitcnt lgkmcnt(3)
 v_mfma_f32_32x32x16_bf16 v[64:79], v[32:35], a[64:67], v[64:79]
 ds_read_b128 v[48:51], v12 offset:16384
 s_waitcnt lgkmcnt(3)
 v_mfma_f32_32x32x16_bf16 v[64:79], v[36:39], a[68:71], v[64:79]
 ds_read_b128 v[52:55], v13 offset:16384
 s_waitcnt vmcnt(6)
 s_lshl_b32 s3, s54, 2
 s_add_u32 s3, s3, s63
 v_mov_b32 v3, 1
 s_mov_b64 exec, s[78:79]
 buffer_atomic_add v3, v30, s[4:7], s3 offen
 s_mov_b64 exec, -1
 s_cmp_eq_u32 s61, 0
 s_cbranch_scc1 L_pf_106
 s_lshl_b32 s3, s61, 2
 s_add_u32 s3, s3, s59
 s_sub_u32 s3, s3, 4
 v_mov_b32 v3, 1
 s_mov_b64 exec, s[78:79]
 buffer_atomic_add v3, v30, s[4:7], s3 offen
 s_mov_b64 exec, -1
 s_mov_b32 s61, 0
L_pf_106:
 s_waitcnt lgkmcnt(3)
 v_mfma_f32_32x32x16_bf16 v[64:79], v[40:43], a[72:75], v[64:79]
 ds_read_b128 v[56:59], v14 offset:16384
 s_add_u32 m0, s56, 65536
 s_add_u32 s3, s55, s67
 buffer_load_dwordx4 v1, s[4:7], s3 offen sc1 lds
 s_waitcnt lgkmcnt(3)
 v_mfma_f32_32x32x16_bf16 v[64:79], v[44:47], a[76:79], v[64:79]
 ds_read_b128 v[60:63], v15 offset:16384
 s_waitcnt lgkmcnt(3)
 v_mfma_f32_32x32x16_bf16 v[64:79], v[48:51], a[80:83], v[64:79]
 ds_read_b128 v[32:35], v8 offset:24576
 s_waitcnt lgkmcnt(3)
 v_mfma_f32_32x32x16_bf16 v[64:79], v[52:55], a[84:87], v[64:79]
 ds_read_b128 v[36:39], v9 offset:24576
 s_add_u32 m0, s56, 66560
 s_add_u32 s3, s55, s67
 buffer_load_dwordx4 v24, s[4:7], s3 offen sc1 lds
 s_waitcnt lgkmcnt(3)
 v_mfma_f32_32x32x16_bf16 v[64:79], v[56:59], a[88:91], v[64:79]
 ds_read_b128 v[40:43], v10 offset:24576
 s_waitcnt lgkmcnt(3)
 v_mfma_f32_32x32x16_bf16 v[64:79], v[60:63], a[92:95], v[64:79]
 ds_read_b128 v[44:47], v11 offset:24576
 s_waitcnt lgkmcnt(3)
 v_mfma_f32_32x32x16_bf16 v[64:79], v[32:35], a[96:99], v[64:79]
 ds_read_b128 v[48:51], v12 offset:24576
 s_add_u32 m0, s56, 73728
 s_add_u32 s3, s55, s68
 buffer_load_dwordx4 v1, s[4:7], s3 offen sc1 lds
 s_waitcnt lgkmcnt(3)
 v_mfma_f32_32x32x16_bf16 v[64:79], v[36:39], a[100:103], v[64:79]
 ds_read_b128 v[52:55], v13 offset:24576
 s_waitcnt lgkmcnt(3)
 v_mfma_f32_32x32x16_bf16 v[64:79], v[40:43], a[104:107], v[64:79]
 ds_read_b128 v[56:59], v14 offset:24576
 s_waitcnt lgkmcnt(3)
 v_mfma_f32_32x32x16_bf16 v[64:79], v[44:47], a[108:111], v[64:79]
 ds_read_b128 v[60:63], v15 offset:24576
 s_add_u32 m0, s56, 74752
 s_add_u32 s3, s55, s68
 buffer_load_dwordx4 v24, s[4:7], s3 offen sc1 lds
 v_mov_b32 v6, 8
 s_mov_b64 exec, 15
 v_mov_b32 v6, 0
 buffer_atomic_add v6, v5, s[4:7], s70 offen sc0
 s_mov_b64 exec, -1
 s_waitcnt lgkmcnt(3)
 v_mfma_f32_32x32x16_bf16 v[64:79], v[48:51], a[112:115], v[64:79]
 ds_read_b128 v[32:35], v8 offset:32768
 s_waitcnt lgkmcnt(3)
 v_mfma_f32_32x32x16_bf16 v[64:79], v[52:55], a[116:119], v[64:79]
 ds_read_b128 v[36:39], v9 offset:32768
 s_waitcnt lgkmcnt(3)
 v_mfma_f32_32x32x16_bf16 v[64:79], v[56:59], a[120:123], v[64:79]
 ds_read_b128 v[40:43], v10 offset:32768
 s_waitcnt lgkmcnt(3)
 v_mfma_f32_32x32x16_bf16 v[64:79], v[60:63], a[124:127], v[64:79]
 ds_read_b128 v[44:47], v11 offset:32768
 s_waitcnt lgkmcnt(3)
 v_mfma_f32_32x32x16_bf16 v[64:79], v[32:35], a[128:131], v[64:79]
 ds_read_b128 v[48:51], v12 offset:32768
 s_waitcnt lgkmcnt(3)
 v_mfma_f32_32x32x16_bf16 v[64:79], v[36:39], a[132:135], v[64:79]
 ds_read_b128 v[52:55], v13 offset:32768
 s_waitcnt lgkmcnt(3)
 v_mfma_f32_32x32x16_bf16 v[64:79], v[40:43], a[136:139], v[64:79]
 ds_read_b128 v[56:59], v14 offset:32768
 s_waitcnt lgkmcnt(3)
 v_mfma_f32_32x32x16_bf16 v[64:79], v[44:47], a[140:143], v[64:79]
 ds_read_b128 v[60:63], v15 offset:32768
 s_waitcnt lgkmcnt(3)
 v_mfma_f32_32x32x16_bf16 v[64:79], v[48:51], a[144:147], v[64:79]
 s_waitcnt lgkmcnt(2)
 v_mfma_f32_32x32x16_bf16 v[64:79], v[52:55], a[148:151], v[64:79]
 s_waitcnt lgkmcnt(1)
 v_mfma_f32_32x32x16_bf16 v[64:79], v[56:59], a[152:155], v[64:79]
 s_waitcnt lgkmcnt(0)
 v_mfma_f32_32x32x16_bf16 v[64:79], v[60:63], a[156:159], v[64:79]
 s_lshl_b32 s3, s60, 19
 s_add_u32 s3, s3, s58
 s_xor_b32 s3, s3, s82
 s_nop 8
 v_cvt_pk_bf16_f32 v80, v64, v65
 v_cvt_pk_bf16_f32 v81, v66, v67
 v_cvt_pk_bf16_f32 v82, v72, v73
 v_cvt_pk_bf16_f32 v83, v74, v75
 buffer_store_dwordx4 v[80:83], v4, s[4:7], s3 offen offset:0 sc1
 v_cvt_pk_bf16_f32 v84, v68, v69
 v_cvt_pk_bf16_f32 v85, v70, v71
 v_cvt_pk_bf16_f32 v86, v76, v77
 v_cvt_pk_bf16_f32 v87, v78, v79
 buffer_store_dwordx4 v[84:87], v4, s[4:7], s3 offen offset:512 sc1
 s_add_u32 s54, s54, 1
 s_mov_b32 s61, s54
 s_waitcnt vmcnt(2)
 s_cmp_lg_u32 s50, 0
 s_cbranch_scc1 L_w_107
 v_cmp_gt_u32 vcc, 8, v6
 s_nop 1
 v_mov_b32 v3, vcc_lo
 ds_write_b32 v7, v3
 s_waitcnt lgkmcnt(0)
L_w_107:
 s_barrier
 ds_read_b32 v3, v7
 s_waitcnt lgkmcnt(0)
 v_readfirstlane_b32 s3, v3
 s_cmp_eq_u32 s69, 0
 s_cbranch_scc1 L_qkvv_fast
 s_cmp_eq_u32 s3, 0
 s_cbranch_scc1 L_qkvv_loop
 s_branch L_qkvv_block
L_n0_96:
 s_waitcnt vmcnt(0)
 s_lshl_b32 s3, s54, 2
 s_add_u32 s3, s3, s63
 v_mov_b32 v3, 1
 s_mov_b64 exec, s[78:79]
 buffer_atomic_add v3, v30, s[4:7], s3 offen
 s_mov_b64 exec, -1
 s_add_u32 s54, s54, 1
 s_cmp_lt_u32 s54, 80
 s_cbranch_scc1 L_qkvv_block
 s_endpgm
L_att:
 s_mul_i32 s3, s50, 24
 s_add_u32 s3, s3, s82
 s_sub_u32 s3, s3, 72
 s_cmp_lt_u32 s3, 64
 s_cbranch_scc1 L_att_go
 s_mov_b32 s60, s3
 s_mul_i32 s71, s50, 13312
 s_mov_b32 s70, s60
 s_mov_b32 s69, 96
 s_mov_b32 s96, s44
 s_and_b32 s97, s45, 0xffff
 s_mov_b32 s98, 256
 s_mov_b32 s99, 0x00020000
 v_mov_b32 v1, 196
 s_mov_b32 s51, 0
 s_mov_b64 exec, 1
L_wb_108:
 buffer_load_dword v2, v1, s[96:99], 0 offen sc1
 s_waitcnt vmcnt(0)
 v_cmp_eq_u32 vcc, 0, v2
 s_cbranch_vccz L_wbd_109
 s_sleep 2
 s_add_u32 s51, s51, 1
 s_cmp_lt_u32 s51, 131072
 s_cbranch_scc1 L_wb_108
 s_branch L_bail
L_wbd_109:
 s_mov_b64 exec, -1
 s_mov_b32 s96, s44
 s_and_b32 s97, s45, 0xffff
 s_mov_b32 s98, 256
 s_mov_b32 s99, 0x00020000
 v_mov_b32 v1, 208
 s_mov_b32 s51, 0
 s_mov_b64 exec, 1
L_wb_110:
 buffer_load_dword v2, v1, s[96:99], 0 offen sc1
 s_waitcnt vmcnt(0)
 v_cmp_eq_u32 vcc, 0, v2
 s_cbranch_vccz L_wbd_111
 s_sleep 2
 s_add_u32 s51, s51, 1
 s_cmp_lt_u32 s51, 131072
 s_cbranch_scc1 L_wb_110
 s_branch L_bail
L_wbd_111:
 s_mov_b64 exec, -1
 s_mov_b32 s8, s38
 s_and_b32 s9, s39, 0xffff
 s_mov_b32 s10, 2621440
 s_mov_b32 s11, 0x00020000
 s_mov_b32 s12, s40
 s_and_b32 s13, s41, 0xffff
 s_mov_b32 s14, 1280
 s_mov_b32 s15, 0x00020000
 v_lshlrev_b32 v130, 4, v0
 s_lshl_b32 s73, s70, 12
 s_add_u32 s74, s73, 2
 buffer_load_dwordx4 v[96:99], v130, s[8:11], s73 offen offset:0
 buffer_load_dwordx4 v[100:103], v130, s[8:11], s73 offen offset:1024
 buffer_load_dwordx4 v[104:107], v130, s[8:11], s73 offen offset:2048
 buffer_load_dwordx4 v[108:111], v130, s[8:11], s73 offen offset:3072
 buffer_load_dwordx4 v[112:115], v130, s[8:11], s74 offen offset:0
 buffer_load_dwordx4 v[116:119], v130, s[8:11], s74 offen offset:1024
 buffer_load_dwordx4 v[120:123], v130, s[8:11], s74 offen offset:2048
 buffer_load_dwordx4 v[124:127], v130, s[8:11], s74 offen offset:3072
 s_lshl_b32 s3, s70, 1
 buffer_load_ushort v128, off, s[12:15], s3
 s_lshl_b32 s3, s70, 12
 s_add_u32 s3, s3, 231735296
 buffer_load_dwordx4 v[240:243], v130, s[4:7], s3 offen offset:0 sc1
 buffer_load_dwordx4 v[244:247], v130, s[4:7], s3 offen offset:1024 sc1
 buffer_load_dwordx4 v[248:251], v130, s[4:7], s3 offen offset:2048 sc1
 buffer_load_dwordx4 v[252:255], v130, s[4:7], s3 offen offset:3072 sc1
 s_getpc_b64 s[76:77]
L_ca_112:
 s_add_u32 s76, s76, L_conv1-L_ca_112
 s_addc_u32 s77, s77, -1
 s_swappc_b64 s[76:77], s[76:77]
 s_waitcnt vmcnt(0)
 s_mov_b32 s96, s44
 s_and_b32 s97, s45, 0xffff
 s_mov_b32 s98, 256
 s_mov_b32 s99, 0x00020000
 v_mov_b32 v1, 1
 s_mov_b64 exec, 1
 buffer_atomic_add v1, off, s[96:99], 0 offset:76 sc0
 s_waitcnt vmcnt(0)
 v_cmp_eq_u32 vcc, 95, v1
 s_cbranch_vccz L_aw_113
 buffer_store_dword v1, off, s[96:99], 0 offset:204 sc1
L_aw_113:
 s_mov_b64 exec, -1
 s_endpgm
L_att_go:
 s_and_b32 s53, s3, 1
 s_lshr_b32 s52, s3, 1
 v_lshlrev_b32 v1, 4, v0
 v_add_u32 v2, 4096, v1
 v_mov_b32 v5, 0
 v_lshlrev_b32 v30, 3, v0
 v_and_b32 v6, 0x1e0, v30
 v_and_b32 v3, 16, v1
 v_add_u32 v6, v6, v3
 s_lshl_b32 s3, s53, 5
 s_add_u32 s3, s3, s52
 s_lshl_b32 s61, s3, 8
 s_add_u32 s61, s61, 24576
 s_lshl_b32 s66, s3, 7
 s_add_u32 s66, s66, 0
 s_lshl_b32 s57, s53, 11
 s_add_u32 s57, s57, s52
 s_and_b32 s100, s57, 1
 s_lshl_b32 s100, s100, 13
 s_lshl_b32 s57, s57, 14
 s_add_u32 s57, s57, s100
 s_add_u32 s57, s57, 8388608
 s_mul_i32 s58, s53, 1048576
 s_lshl_b32 s3, s52, 12
 s_add_u32 s58, s58, s3
 s_add_u32 s58, s58, 1048576
 s_add_u32 s59, s57, 67108864
 s_lshl_b32 s60, s53, 8
 s_add_u32 s60, s60, 40960
 s_lshr_b32 s3, s52, 2
 s_mul_i32 s3, s3, 2560
 v_lshl_add_u32 v31, v0, 9, s3
 v_mov_b32 v208, -1
 v_mov_b32 v209, -1
 v_mov_b32 v210, -1
 v_mov_b32 v211, -1
 v_lshrrev_b32 v3, 4, v0
 v_lshlrev_b32 v7, 9, v3
 v_and_b32 v4, 15, v0
 v_lshl_add_u32 v7, v4, 4, v7
 v_mov_b32 v88, 0xff61b1e6
 v_lshlrev_b32 v3, 2, v3
 v_add_u32 v89, 0, v3
 v_cmp_gt_u32 vcc, v89, v4
 s_nop 1
 v_cndmask_b32 v12, 0, v88, vcc
 v_add_u32 v89, 1, v3
 v_cmp_gt_u32 vcc, v89, v4
 s_nop 1
 v_cndmask_b32 v13, 0, v88, vcc
 v_add_u32 v89, 2, v3
 v_cmp_gt_u32 vcc, v89, v4
 s_nop 1
 v_cndmask_b32 v14, 0, v88, vcc
 v_add_u32 v89, 3, v3
 v_cmp_gt_u32 vcc, v89, v4
 s_nop 1
 v_cndmask_b32 v15, 0, v88, vcc
 v_mov_b32 v152, 0
 v_mov_b32 v153, 0
 v_mov_b32 v154, 0
 v_mov_b32 v155, 0
 v_mov_b32 v156, 0
 v_mov_b32 v157, 0
 v_mov_b32 v158, 0
 v_mov_b32 v159, 0
 v_mov_b32 v160, 0
 v_mov_b32 v161, 0
 v_mov_b32 v162, 0
 v_mov_b32 v163, 0
 v_mov_b32 v164, 0
 v_mov_b32 v165, 0
 v_mov_b32 v166, 0
 v_mov_b32 v167, 0
 v_mov_b32 v168, 0
 v_mov_b32 v169, 0
 v_mov_b32 v170, 0
 v_mov_b32 v171, 0
 v_mov_b32 v172, 0
 v_mov_b32 v173, 0
 v_mov_b32 v174, 0
 v_mov_b32 v175, 0
 s_mov_b32 s62, 0x3db504f3
 s_mov_b32 s63, 0x3fb8aa3b
 s_mov_b32 s54, 0
 s_mov_b32 s51, 0
 s_mov_b64 exec, 1
L_wc_114:
 v_mov_b32 v3, 0
 buffer_atomic_add v3, v5, s[4:7], s61 offen sc0
 s_waitcnt vmcnt(0)
 v_cmp_gt_u32 vcc, 12, v3
 s_cbranch_vccz L_wcd_115
 s_sleep 16
 s_add_u32 s51, s51, 1
 s_cmp_lt_u32 s51, 131072
 s_cbranch_scc1 L_wc_114
 s_branch L_bail
L_wcd_115:
 s_mov_b64 exec, -1
 s_lshl_b32 s56, s54, 19
 s_add_u32 s56, s56, s57
 s_cmp_lt_u32 s54, 64
 s_cselect_b32 s56, s56, 268435456
 s_xor_b32 s3, s56, 8192
 buffer_load_dwordx4 a[0:3], v1, s[4:7], s3 offen offset:0 sc1 nt
 buffer_load_dwordx4 a[4:7], v1, s[4:7], s3 offen offset:1024 sc1 nt
 buffer_load_dwordx4 a[8:11], v1, s[4:7], s3 offen offset:2048 sc1 nt
 buffer_load_dwordx4 a[12:15], v1, s[4:7], s3 offen offset:3072 sc1 nt
 buffer_load_dwordx4 a[16:19], v2, s[4:7], s3 offen offset:0 sc1 nt
 buffer_load_dwordx4 a[20:23], v2, s[4:7], s3 offen offset:1024 sc1 nt
 buffer_load_dwordx4 a[24:27], v2, s[4:7], s3 offen offset:2048 sc1 nt
 buffer_load_dwordx4 a[28:31], v2, s[4:7], s3 offen offset:3072 sc1 nt
 s_mov_b32 s3, s56
 buffer_load_dwordx4 a[32:35], v1, s[4:7], s3 offen offset:0 sc1 nt
 buffer_load_dwordx4 a[36:39], v1, s[4:7], s3 offen offset:1024 sc1 nt
 buffer_load_dwordx4 a[40:43], v1, s[4:7], s3 offen offset:2048 sc1 nt
 buffer_load_dwordx4 a[44:47], v1, s[4:7], s3 offen offset:3072 sc1 nt
 buffer_load_dwordx4 a[48:51], v2, s[4:7], s3 offen offset:0 sc1 nt
 buffer_load_dwordx4 a[52:55], v2, s[4:7], s3 offen offset:1024 sc1 nt
 buffer_load_dwordx4 a[56:59], v2, s[4:7], s3 offen offset:2048 sc1 nt
 buffer_load_dwordx4 a[60:63], v2, s[4:7], s3 offen offset:3072 sc1 nt
 s_add_u32 s3, s56, 67108864
 buffer_load_dwordx4 a[64:67], v1, s[4:7], s3 offen offset:0 sc1 nt
 buffer_load_dwordx4 a[68:71], v1, s[4:7], s3 offen offset:1024 sc1 nt
 buffer_load_dwordx4 a[72:75], v1, s[4:7], s3 offen offset:2048 sc1 nt
 buffer_load_dwordx4 a[76:79], v1, s[4:7], s3 offen offset:3072 sc1 nt
 buffer_load_dwordx4 a[80:83], v2, s[4:7], s3 offen offset:0 sc1 nt
 buffer_load_dwordx4 a[84:87], v2, s[4:7], s3 offen offset:1024 sc1 nt
 buffer_load_dwordx4 a[88:91], v2, s[4:7], s3 offen offset:2048 sc1 nt
 buffer_load_dwordx4 a[92:95], v2, s[4:7], s3 offen offset:3072 sc1 nt
L_att_loop:
 s_and_b32 s3, s54, 7
 s_lshl_b32 s65, s3, 17
 s_add_u32 s65, s65, s58
 buffer_load_dwordx4 v[32:35], v6, s[4:7], s65 offen offset:0 sc1
 buffer_load_dwordx4 v[36:39], v6, s[4:7], s65 offen offset:512 sc1
 buffer_load_dwordx4 v[40:43], v6, s[4:7], s65 offen offset:1024 sc1
 buffer_load_dwordx4 v[44:47], v6, s[4:7], s65 offen offset:1536 sc1
 buffer_load_dwordx2 v[48:49], v30, s[4:7], s65 offen offset:2048 sc1
 buffer_load_dwordx2 v[50:51], v30, s[4:7], s65 offen offset:2560 sc1
 buffer_load_dwordx2 v[52:53], v30, s[4:7], s65 offen offset:3072 sc1
 buffer_load_dwordx2 v[54:55], v30, s[4:7], s65 offen offset:3584 sc1
 s_lshl_b32 s55, s54, 19
 s_add_u32 s55, s55, s59
 s_xor_b32 s55, s55, 8192
 s_waitcnt vmcnt(16)
 v_mfma_f32_16x16x32_bf16 v[68:71], a[32:35], a[0:3], v[12:15]
 v_mfma_f32_16x16x32_bf16 v[68:71], a[36:39], a[4:7], v[68:71]
 v_mfma_f32_16x16x32_bf16 v[68:71], a[40:43], a[8:11], v[68:71]
 v_mfma_f32_16x16x32_bf16 v[68:71], a[44:47], a[12:15], v[68:71]
 v_mfma_f32_16x16x32_bf16 v[80:83], a[32:35], a[16:19], 0
 v_mfma_f32_16x16x32_bf16 v[80:83], a[36:39], a[20:23], v[80:83]
 v_mfma_f32_16x16x32_bf16 v[80:83], a[40:43], a[24:27], v[80:83]
 v_mfma_f32_16x16x32_bf16 v[80:83], a[44:47], a[28:31], v[80:83]
 v_mfma_f32_16x16x32_bf16 v[84:87], a[48:51], a[16:19], v[12:15]
 v_mfma_f32_16x16x32_bf16 v[84:87], a[52:55], a[20:23], v[84:87]
 v_mfma_f32_16x16x32_bf16 v[84:87], a[56:59], a[24:27], v[84:87]
 v_mfma_f32_16x16x32_bf16 v[84:87], a[60:63], a[28:31], v[84:87]
 s_nop 7
 v_cvt_pk_bf16_f32 v3, v68, v69
 v_lshlrev_b32 v68, 16, v3
 v_and_b32 v69, 0xffff0000, v3
 v_cvt_pk_bf16_f32 v3, v70, v71
 v_lshlrev_b32 v70, 16, v3
 v_and_b32 v71, 0xffff0000, v3
 v_cvt_pk_bf16_f32 v3, v80, v81
 v_lshlrev_b32 v80, 16, v3
 v_and_b32 v81, 0xffff0000, v3
 v_cvt_pk_bf16_f32 v3, v82, v83
 v_lshlrev_b32 v82, 16, v3
 v_and_b32 v83, 0xffff0000, v3
 v_cvt_pk_bf16_f32 v3, v84, v85
 v_lshlrev_b32 v84, 16, v3
 v_and_b32 v85, 0xffff0000, v3
 v_cvt_pk_bf16_f32 v3, v86, v87
 v_lshlrev_b32 v86, 16, v3
 v_and_b32 v87, 0xffff0000, v3
 v_mul_f32 v68, s62, v68
 v_mul_f32 v69, s62, v69
 v_mul_f32 v70, s62, v70
 v_mul_f32 v71, s62, v71
 v_mul_f32 v80, s62, v80
 v_mul_f32 v81, s62, v81
 v_mul_f32 v82, s62, v82
 v_mul_f32 v83, s62, v83
 v_mul_f32 v84, s62, v84
 v_mul_f32 v85, s62, v85
 v_mul_f32 v86, s62, v86
 v_mul_f32 v87, s62, v87
 v_cvt_pk_bf16_f32 v3, v68, v69
 v_lshlrev_b32 v68, 16, v3
 v_and_b32 v69, 0xffff0000, v3
 v_cvt_pk_bf16_f32 v3, v70, v71
 v_lshlrev_b32 v70, 16, v3
 v_and_b32 v71, 0xffff0000, v3
 v_cvt_pk_bf16_f32 v3, v80, v81
 v_lshlrev_b32 v80, 16, v3
 v_and_b32 v81, 0xffff0000, v3
 v_cvt_pk_bf16_f32 v3, v82, v83
 v_lshlrev_b32 v82, 16, v3
 v_and_b32 v83, 0xffff0000, v3
 v_cvt_pk_bf16_f32 v3, v84, v85
 v_lshlrev_b32 v84, 16, v3
 v_and_b32 v85, 0xffff0000, v3
 v_cvt_pk_bf16_f32 v3, v86, v87
 v_lshlrev_b32 v86, 16, v3
 v_and_b32 v87, 0xffff0000, v3
 v_max3_f32 v16, v68, v69, v70
 v_max_f32 v16, v16, v71
 v_max3_f32 v17, v80, v81, v82
 v_max3_f32 v17, v17, v83, v84
 v_max3_f32 v17, v17, v85, v86
 v_max_f32 v17, v17, v87
 v_mov_b32 v22, v16
 v_mov_b32 v23, v17
 s_nop 0
 v_permlane16_swap_b32 v16, v22
 v_permlane16_swap_b32 v17, v23
 v_max_f32 v16, v16, v22
 v_max_f32 v17, v17, v23
 v_mov_b32 v22, v16
 v_mov_b32 v23, v17
 s_nop 0
 v_permlane32_swap_b32 v16, v22
 v_permlane32_swap_b32 v17, v23
 v_max_f32 v16, v16, v22
 v_max_f32 v17, v17, v23
 v_mul_f32 v22, s63, v16
 v_fma_f32 v68, v68, s63, -v22
 v_fma_f32 v69, v69, s63, -v22
 v_fma_f32 v70, v70, s63, -v22
 v_fma_f32 v71, v71, s63, -v22
 v_mul_f32 v23, s63, v17
 v_fma_f32 v80, v80, s63, -v23
 v_fma_f32 v81, v81, s63, -v23
 v_fma_f32 v82, v82, s63, -v23
 v_fma_f32 v83, v83, s63, -v23
 v_fma_f32 v84, v84, s63, -v23
 v_fma_f32 v85, v85, s63, -v23
 v_fma_f32 v86, v86, s63, -v23
 v_fma_f32 v87, v87, s63, -v23
 v_exp_f32 v68, v68
 v_exp_f32 v69, v69
 v_exp_f32 v70, v70
 v_exp_f32 v71, v71
 v_exp_f32 v80, v80
 v_exp_f32 v81, v81
 v_exp_f32 v82, v82
 v_exp_f32 v83, v83
 v_exp_f32 v84, v84
 v_exp_f32 v85, v85
 v_exp_f32 v86, v86
 v_exp_f32 v87, v87
 v_add_f32 v18, v68, v69
 v_add_f32 v18, v18, v70
 v_add_f32 v18, v18, v71
 v_add_f32 v19, v80, v81
 v_add_f32 v19, v19, v82
 v_add_f32 v19, v19, v83
 v_add_f32 v19, v19, v84
 v_add_f32 v19, v19, v85
 v_add_f32 v19, v19, v86
 v_add_f32 v19, v19, v87
 s_mov_b32 s51, 0
 s_waitcnt vmcnt(4)
 v_max_u32 v3, v32, v34
 v_max3_u32 v3, v3, v36, v38
 v_max3_u32 v3, v3, v40, v42
 v_max3_u32 v3, v3, v44, v46
 v_cmp_eq_u32 vcc, -1, v3
 s_cbranch_vccz L_pkd_117
L_pk_116:
 s_sleep 2
 buffer_load_dwordx4 v[32:35], v6, s[4:7], s65 offen offset:0 sc1
 buffer_load_dwordx4 v[36:39], v6, s[4:7], s65 offen offset:512 sc1
 buffer_load_dwordx4 v[40:43], v6, s[4:7], s65 offen offset:1024 sc1
 buffer_load_dwordx4 v[44:47], v6, s[4:7], s65 offen offset:1536 sc1
 s_waitcnt vmcnt(0)
 v_max_u32 v3, v32, v34
 v_max3_u32 v3, v3, v36, v38
 v_max3_u32 v3, v3, v40, v42
 v_max3_u32 v3, v3, v44, v46
 v_cmp_eq_u32 vcc, -1, v3
 s_cbranch_vccz L_pke_118
 s_add_u32 s51, s51, 1
 s_cmp_lt_u32 s51, 131072
 s_cbranch_scc1 L_pk_116
 s_branch L_bail
L_pke_118:
 s_mov_b32 s51, 1
L_pkd_117:
 v_mfma_f32_16x16x32_bf16 v[64:67], v[32:35], a[0:3], 0
 v_mfma_f32_16x16x32_bf16 v[64:67], v[36:39], a[4:7], v[64:67]
 v_mfma_f32_16x16x32_bf16 v[64:67], v[40:43], a[8:11], v[64:67]
 v_mfma_f32_16x16x32_bf16 v[64:67], v[44:47], a[12:15], v[64:67]
 v_mfma_f32_16x16x32_bf16 v[76:79], v[32:35], a[16:19], 0
 v_mfma_f32_16x16x32_bf16 v[76:79], v[36:39], a[20:23], v[76:79]
 v_mfma_f32_16x16x32_bf16 v[76:79], v[40:43], a[24:27], v[76:79]
 v_mfma_f32_16x16x32_bf16 v[76:79], v[44:47], a[28:31], v[76:79]
 v_mov_b32 v29, 0
 s_nop 6
 v_cvt_pk_bf16_f32 v3, v64, v65
 v_lshlrev_b32 v64, 16, v3
 v_and_b32 v65, 0xffff0000, v3
 v_cvt_pk_bf16_f32 v3, v76, v77
 v_lshlrev_b32 v76, 16, v3
 v_and_b32 v77, 0xffff0000, v3
 v_mul_f32 v64, s62, v64
 v_mul_f32 v65, s62, v65
 v_mul_f32 v76, s62, v76
 v_mul_f32 v77, s62, v77
 v_cvt_pk_bf16_f32 v3, v64, v65
 v_lshlrev_b32 v64, 16, v3
 v_and_b32 v65, 0xffff0000, v3
 v_cvt_pk_bf16_f32 v3, v76, v77
 v_lshlrev_b32 v76, 16, v3
 v_and_b32 v77, 0xffff0000, v3
 s_cmp_eq_u32 s51, 0
 s_cbranch_scc1 L_nv_119
 buffer_load_dwordx2 v[48:49], v30, s[4:7], s65 offen offset:2048 sc1
 buffer_load_dwordx2 v[50:51], v30, s[4:7], s65 offen offset:2560 sc1
 buffer_load_dwordx2 v[52:53], v30, s[4:7], s65 offen offset:3072 sc1
 buffer_load_dwordx2 v[54:55], v30, s[4:7], s65 offen offset:3584 sc1
L_nv_119:
 s_mov_b64 exec, 1
 buffer_atomic_add v29, off, s[4:7], s61 offset:4 sc0
 s_mov_b64 exec, -1
 v_max3_f32 v20, v64, v65, v16
 v_max3_f32 v21, v76, v77, v17
 v_mov_b32 v22, v20
 v_mov_b32 v23, v21
 s_nop 0
 v_permlane16_swap_b32 v20, v22
 v_permlane16_swap_b32 v21, v23
 v_max_f32 v20, v20, v22
 v_max_f32 v21, v21, v23
 v_mov_b32 v22, v20
 v_mov_b32 v23, v21
 s_nop 0
 v_permlane32_swap_b32 v20, v22
 v_permlane32_swap_b32 v21, v23
 v_max_f32 v20, v20, v22
 v_max_f32 v21, v21, v23
 v_mul_f32 v20, s63, v20
 v_fma_f32 v24, v16, s63, -v20
 v_fma_f32 v64, v64, s63, -v20
 v_fma_f32 v65, v65, s63, -v20
 v_mul_f32 v21, s63, v21
 v_fma_f32 v26, v17, s63, -v21
 v_fma_f32 v76, v76, s63, -v21
 v_fma_f32 v77, v77, s63, -v21
 v_exp_f32 v24, v24
 v_exp_f32 v64, v64
 v_exp_f32 v65, v65
 v_exp_f32 v26, v26
 v_exp_f32 v76, v76
 v_exp_f32 v77, v77
 s_nop 0
 v_fma_f32 v18, v18, v24, v64
 v_add_f32 v18, v18, v65
 v_fma_f32 v19, v19, v26, v76
 v_add_f32 v19, v19, v77
 v_mov_b32 v22, v18
 v_mov_b32 v23, v19
 s_nop 0
 v_permlane16_swap_b32 v18, v22
 v_permlane16_swap_b32 v19, v23
 v_add_f32 v18, v18, v22
 v_add_f32 v19, v19, v23
 v_mov_b32 v22, v18
 v_mov_b32 v23, v19
 s_nop 0
 v_permlane32_swap_b32 v18, v22
 v_permlane32_swap_b32 v19, v23
 v_add_f32 v18, v18, v22
 v_add_f32 v19, v19, v23
 v_rcp_f32 v18, v18
 v_rcp_f32 v19, v19
 v_mul_f32 v24, v24, v18
 v_mul_f32 v26, v26, v19
 v_pk_mul_f32 v[68:69], v[68:69], v[24:25] op_sel_hi:[1,0]
 v_cvt_pk_bf16_f32 v168, v68, v69
 v_pk_mul_f32 v[70:71], v[70:71], v[24:25] op_sel_hi:[1,0]
 v_cvt_pk_bf16_f32 v169, v70, v71
 v_mul_f32 v64, v64, v18
 v_mul_f32 v65, v65, v18
 v_cvt_pk_bf16_f32 v152, v64, v65
 v_cvt_pk_bf16_f32 v155, v64, v65
 v_mfma_f32_16x16x32_bf16 v[88:91], a[64:67], v[168:171], 0
 v_pk_mul_f32 v[80:81], v[80:81], v[26:27] op_sel_hi:[1,0]
 v_cvt_pk_bf16_f32 v172, v80, v81
 v_mfma_f32_16x16x32_bf16 v[92:95], a[68:71], v[168:171], 0
 v_pk_mul_f32 v[82:83], v[82:83], v[26:27] op_sel_hi:[1,0]
 v_cvt_pk_bf16_f32 v173, v82, v83
 v_mfma_f32_16x16x32_bf16 v[96:99], a[72:75], v[168:171], 0
 v_pk_mul_f32 v[84:85], v[84:85], v[26:27] op_sel_hi:[1,0]
 v_cvt_pk_bf16_f32 v174, v84, v85
 v_mfma_f32_16x16x32_bf16 v[100:103], a[76:79], v[168:171], 0
 v_pk_mul_f32 v[86:87], v[86:87], v[26:27] op_sel_hi:[1,0]
 v_cvt_pk_bf16_f32 v175, v86, v87
 v_mfma_f32_16x16x32_bf16 v[104:107], a[80:83], v[168:171], 0
 v_mul_f32 v76, v76, v19
 v_mul_f32 v77, v77, v19
 v_mfma_f32_16x16x32_bf16 v[108:111], a[84:87], v[168:171], 0
 v_cvt_pk_bf16_f32 v160, v76, v77
 v_cvt_pk_bf16_f32 v163, v76, v77
 v_mfma_f32_16x16x32_bf16 v[112:115], a[88:91], v[168:171], 0
 v_mfma_f32_16x16x32_bf16 v[116:119], a[92:95], v[168:171], 0
 v_mfma_f32_16x16x32_bf16 v[120:123], a[64:67], v[172:175], 0
 v_mfma_f32_16x16x32_bf16 v[124:127], a[68:71], v[172:175], 0
 v_mfma_f32_16x16x32_bf16 v[128:131], a[72:75], v[172:175], 0
 v_mfma_f32_16x16x32_bf16 v[132:135], a[76:79], v[172:175], 0
 v_mfma_f32_16x16x32_bf16 v[136:139], a[80:83], v[172:175], 0
 v_mfma_f32_16x16x32_bf16 v[140:143], a[84:87], v[172:175], 0
 v_mfma_f32_16x16x32_bf16 v[144:147], a[88:91], v[172:175], 0
 v_mfma_f32_16x16x32_bf16 v[148:151], a[92:95], v[172:175], 0
 s_waitcnt vmcnt(1)
L_pv_120:
 v_max_u32 v3, v48, v50
 v_max3_u32 v3, v3, v52, v54
 v_cmp_eq_u32 vcc, -1, v3
 s_cbranch_vccz L_pvd_121
 buffer_load_dwordx2 v[48:49], v30, s[4:7], s65 offen offset:2048 sc1
 buffer_load_dwordx2 v[50:51], v30, s[4:7], s65 offen offset:2560 sc1
 buffer_load_dwordx2 v[52:53], v30, s[4:7], s65 offen offset:3072 sc1
 buffer_load_dwordx2 v[54:55], v30, s[4:7], s65 offen offset:3584 sc1
 s_waitcnt vmcnt(0)
 s_add_u32 s51, s51, 1
 s_cmp_lt_u32 s51, 131072
 s_cbranch_scc1 L_pv_120
 s_branch L_bail
L_pvd_121:
 v_mfma_f32_16x16x16_bf16 v[88:91], v[48:49], v[152:153], v[88:91]
 v_mfma_f32_16x16x16_bf16 v[92:95], v[48:49], v[154:155], v[92:95]
 v_mfma_f32_16x16x16_bf16 v[96:99], v[50:51], v[152:153], v[96:99]
 v_mfma_f32_16x16x16_bf16 v[100:103], v[50:51], v[154:155], v[100:103]
 v_mfma_f32_16x16x16_bf16 v[104:107], v[52:53], v[152:153], v[104:107]
 v_mfma_f32_16x16x16_bf16 v[108:111], v[52:53], v[154:155], v[108:111]
 v_mfma_f32_16x16x16_bf16 v[112:115], v[54:55], v[152:153], v[112:115]
 v_mfma_f32_16x16x16_bf16 v[116:119], v[54:55], v[154:155], v[116:119]
 v_mfma_f32_16x16x16_bf16 v[120:123], v[48:49], v[160:161], v[120:123]
 v_mfma_f32_16x16x16_bf16 v[124:127], v[48:49], v[162:163], v[124:127]
 v_cvt_pk_bf16_f32 v176, v88, v89
 v_cvt_pk_bf16_f32 v177, v90, v91
 v_mfma_f32_16x16x16_bf16 v[128:131], v[50:51], v[160:161], v[128:131]
 v_cvt_pk_bf16_f32 v178, v92, v93
 v_cvt_pk_bf16_f32 v179, v94, v95
 v_mfma_f32_16x16x16_bf16 v[132:135], v[50:51], v[162:163], v[132:135]
 s_add_u32 s3, s55, 0
 buffer_store_dwordx4 v[176:179], v7, s[4:7], s3 offen offset:0 sc1
 v_cvt_pk_bf16_f32 v180, v96, v97
 v_mfma_f32_16x16x16_bf16 v[136:139], v[52:53], v[160:161], v[136:139]
 v_cvt_pk_bf16_f32 v181, v98, v99
 v_cvt_pk_bf16_f32 v182, v100, v101
 v_mfma_f32_16x16x16_bf16 v[140:143], v[52:53], v[162:163], v[140:143]
 v_cvt_pk_bf16_f32 v183, v102, v103
 s_add_u32 s3, s55, 2048
 buffer_store_dwordx4 v[180:183], v7, s[4:7], s3 offen offset:0 sc1
 v_mfma_f32_16x16x16_bf16 v[144:147], v[54:55], v[160:161], v[144:147]
 v_cvt_pk_bf16_f32 v184, v104, v105
 v_cvt_pk_bf16_f32 v185, v106, v107
 v_mfma_f32_16x16x16_bf16 v[148:151], v[54:55], v[162:163], v[148:151]
 v_cvt_pk_bf16_f32 v186, v108, v109
 v_cvt_pk_bf16_f32 v187, v110, v111
 s_add_u32 s3, s55, 4096
 buffer_store_dwordx4 v[184:187], v7, s[4:7], s3 offen offset:0 sc1
 v_cvt_pk_bf16_f32 v188, v112, v113
 v_cvt_pk_bf16_f32 v189, v114, v115
 v_cvt_pk_bf16_f32 v190, v116, v117
 v_cvt_pk_bf16_f32 v191, v118, v119
 s_add_u32 s3, s55, 6144
 buffer_store_dwordx4 v[188:191], v7, s[4:7], s3 offen offset:0 sc1
 v_cvt_pk_bf16_f32 v192, v120, v121
 v_cvt_pk_bf16_f32 v193, v122, v123
 v_cvt_pk_bf16_f32 v194, v124, v125
 v_cvt_pk_bf16_f32 v195, v126, v127
 s_add_u32 s3, s55, 0
 buffer_store_dwordx4 v[192:195], v7, s[4:7], s3 offen offset:256 sc1
 v_cvt_pk_bf16_f32 v196, v128, v129
 v_cvt_pk_bf16_f32 v197, v130, v131
 v_cvt_pk_bf16_f32 v198, v132, v133
 v_cvt_pk_bf16_f32 v199, v134, v135
 s_add_u32 s3, s55, 2048
 buffer_store_dwordx4 v[196:199], v7, s[4:7], s3 offen offset:256 sc1
 v_cvt_pk_bf16_f32 v200, v136, v137
 v_cvt_pk_bf16_f32 v201, v138, v139
 v_cvt_pk_bf16_f32 v202, v140, v141
 v_cvt_pk_bf16_f32 v203, v142, v143
 s_add_u32 s3, s55, 4096
 buffer_store_dwordx4 v[200:203], v7, s[4:7], s3 offen offset:256 sc1
 v_cvt_pk_bf16_f32 v204, v144, v145
 v_cvt_pk_bf16_f32 v205, v146, v147
 v_cvt_pk_bf16_f32 v206, v148, v149
 v_cvt_pk_bf16_f32 v207, v150, v151
 s_add_u32 s3, s55, 6144
 buffer_store_dwordx4 v[204:207], v7, s[4:7], s3 offen offset:256 sc1
 buffer_store_dwordx4 v[208:211], v1, s[4:7], s65 offen offset:0 sc1
 buffer_store_dwordx4 v[208:211], v1, s[4:7], s65 offen offset:1024 sc1
 buffer_store_dwordx4 v[208:211], v1, s[4:7], s65 offen offset:2048 sc1
 buffer_store_dwordx4 v[208:211], v1, s[4:7], s65 offen offset:3072 sc1
 s_add_u32 s54, s54, 1
 s_add_u32 s61, s61, 4
 s_cmp_lt_u32 s54, 64
 s_cselect_b32 s64, 12, 0
 s_waitcnt vmcnt(12)
 v_readfirstlane_b32 s3, v29
 s_nop 3
 s_cmp_ge_u32 s3, s64
 s_cbranch_scc1 L_aj_122
 s_waitcnt vmcnt(4)
 v_mov_b32 v3, 1
 s_mov_b64 exec, 31
 buffer_atomic_add v3, v31, s[4:7], s60 offen
 s_mov_b64 exec, -1
 s_waitcnt vmcnt(1)
 v_mov_b32 v3, 1
 s_mov_b64 exec, 1
 buffer_atomic_add v3, v5, s[4:7], s66 offen
 s_mov_b64 exec, -1
 s_mov_b32 s51, 0
 s_mov_b64 exec, 1
L_wc_124:
 v_mov_b32 v3, 0
 buffer_atomic_add v3, v5, s[4:7], s61 offen sc0
 s_waitcnt vmcnt(0)
 v_cmp_gt_u32 vcc, s64, v3
 s_cbranch_vccz L_wcd_125
 s_sleep 4
 s_add_u32 s51, s51, 1
 s_cmp_lt_u32 s51, 131072
 s_cbranch_scc1 L_wc_124
 s_branch L_bail
L_wcd_125:
 s_mov_b64 exec, -1
 s_lshl_b32 s56, s54, 19
 s_add_u32 s56, s56, s57
 s_cmp_lt_u32 s54, 64
 s_cselect_b32 s56, s56, 268435456
 s_xor_b32 s3, s56, 8192
 buffer_load_dwordx4 a[0:3], v1, s[4:7], s3 offen offset:0 sc1 nt
 buffer_load_dwordx4 a[4:7], v1, s[4:7], s3 offen offset:1024 sc1 nt
 buffer_load_dwordx4 a[8:11], v1, s[4:7], s3 offen offset:2048 sc1 nt
 buffer_load_dwordx4 a[12:15], v1, s[4:7], s3 offen offset:3072 sc1 nt
 buffer_load_dwordx4 a[16:19], v2, s[4:7], s3 offen offset:0 sc1 nt
 buffer_load_dwordx4 a[20:23], v2, s[4:7], s3 offen offset:1024 sc1 nt
 buffer_load_dwordx4 a[24:27], v2, s[4:7], s3 offen offset:2048 sc1 nt
 buffer_load_dwordx4 a[28:31], v2, s[4:7], s3 offen offset:3072 sc1 nt
 s_mov_b32 s3, s56
 buffer_load_dwordx4 a[32:35], v1, s[4:7], s3 offen offset:0 sc1 nt
 buffer_load_dwordx4 a[36:39], v1, s[4:7], s3 offen offset:1024 sc1 nt
 buffer_load_dwordx4 a[40:43], v1, s[4:7], s3 offen offset:2048 sc1 nt
 buffer_load_dwordx4 a[44:47], v1, s[4:7], s3 offen offset:3072 sc1 nt
 buffer_load_dwordx4 a[48:51], v2, s[4:7], s3 offen offset:0 sc1 nt
 buffer_load_dwordx4 a[52:55], v2, s[4:7], s3 offen offset:1024 sc1 nt
 buffer_load_dwordx4 a[56:59], v2, s[4:7], s3 offen offset:2048 sc1 nt
 buffer_load_dwordx4 a[60:63], v2, s[4:7], s3 offen offset:3072 sc1 nt
 s_add_u32 s3, s56, 67108864
 buffer_load_dwordx4 a[64:67], v1, s[4:7], s3 offen offset:0 sc1 nt
 buffer_load_dwordx4 a[68:71], v1, s[4:7], s3 offen offset:1024 sc1 nt
 buffer_load_dwordx4 a[72:75], v1, s[4:7], s3 offen offset:2048 sc1 nt
 buffer_load_dwordx4 a[76:79], v1, s[4:7], s3 offen offset:3072 sc1 nt
 buffer_load_dwordx4 a[80:83], v2, s[4:7], s3 offen offset:0 sc1 nt
 buffer_load_dwordx4 a[84:87], v2, s[4:7], s3 offen offset:1024 sc1 nt
 buffer_load_dwordx4 a[88:91], v2, s[4:7], s3 offen offset:2048 sc1 nt
 buffer_load_dwordx4 a[92:95], v2, s[4:7], s3 offen offset:3072 sc1 nt
 s_branch L_ak_123
L_aj_122:
 s_lshl_b32 s56, s54, 19
 s_add_u32 s56, s56, s57
 s_cmp_lt_u32 s54, 64
 s_cselect_b32 s56, s56, 268435456
 s_xor_b32 s3, s56, 8192
 buffer_load_dwordx4 a[0:3], v1, s[4:7], s3 offen offset:0 sc1 nt
 buffer_load_dwordx4 a[4:7], v1, s[4:7], s3 offen offset:1024 sc1 nt
 buffer_load_dwordx4 a[8:11], v1, s[4:7], s3 offen offset:2048 sc1 nt
 buffer_load_dwordx4 a[12:15], v1, s[4:7], s3 offen offset:3072 sc1 nt
 buffer_load_dwordx4 a[16:19], v2, s[4:7], s3 offen offset:0 sc1 nt
 buffer_load_dwordx4 a[20:23], v2, s[4:7], s3 offen offset:1024 sc1 nt
 buffer_load_dwordx4 a[24:27], v2, s[4:7], s3 offen offset:2048 sc1 nt
 buffer_load_dwordx4 a[28:31], v2, s[4:7], s3 offen offset:3072 sc1 nt
 s_mov_b32 s3, s56
 buffer_load_dwordx4 a[32:35], v1, s[4:7], s3 offen offset:0 sc1 nt
 buffer_load_dwordx4 a[36:39], v1, s[4:7], s3 offen offset:1024 sc1 nt
 buffer_load_dwordx4 a[40:43], v1, s[4:7], s3 offen offset:2048 sc1 nt
 buffer_load_dwordx4 a[44:47], v1, s[4:7], s3 offen offset:3072 sc1 nt
 buffer_load_dwordx4 a[48:51], v2, s[4:7], s3 offen offset:0 sc1 nt
 buffer_load_dwordx4 a[52:55], v2, s[4:7], s3 offen offset:1024 sc1 nt
 buffer_load_dwordx4 a[56:59], v2, s[4:7], s3 offen offset:2048 sc1 nt
 buffer_load_dwordx4 a[60:63], v2, s[4:7], s3 offen offset:3072 sc1 nt
 s_add_u32 s3, s56, 67108864
 buffer_load_dwordx4 a[64:67], v1, s[4:7], s3 offen offset:0 sc1 nt
 buffer_load_dwordx4 a[68:71], v1, s[4:7], s3 offen offset:1024 sc1 nt
 buffer_load_dwordx4 a[72:75], v1, s[4:7], s3 offen offset:2048 sc1 nt
 buffer_load_dwordx4 a[76:79], v1, s[4:7], s3 offen offset:3072 sc1 nt
 buffer_load_dwordx4 a[80:83], v2, s[4:7], s3 offen offset:0 sc1 nt
 buffer_load_dwordx4 a[84:87], v2, s[4:7], s3 offen offset:1024 sc1 nt
 buffer_load_dwordx4 a[88:91], v2, s[4:7], s3 offen offset:2048 sc1 nt
 buffer_load_dwordx4 a[92:95], v2, s[4:7], s3 offen offset:3072 sc1 nt
 s_waitcnt vmcnt(28)
 v_mov_b32 v3, 1
 s_mov_b64 exec, 31
 buffer_atomic_add v3, v31, s[4:7], s60 offen
 s_mov_b64 exec, -1
 s_waitcnt vmcnt(25)
 v_mov_b32 v3, 1
 s_mov_b64 exec, 1
 buffer_atomic_add v3, v5, s[4:7], s66 offen
 s_mov_b64 exec, -1
L_ak_123:
 s_add_u32 s60, s60, 4
 s_cmp_lt_u32 s54, 64
 s_cbranch_scc1 L_att_loop
 s_endpgm
L_wo:
 s_and_b32 s100, s64, 1
 s_lshl_b32 s100, s100, 13
 s_lshl_b32 s64, s64, 14
 s_add_u32 s64, s64, s100
 s_xor_b32 s64, s64, 8192
 s_and_b32 s100, s65, 1
 s_lshl_b32 s100, s100, 13
 s_lshl_b32 s65, s65, 14
 s_add_u32 s65, s65, s100
 s_xor_b32 s65, s65, 8192
 s_and_b32 s100, s66, 1
 s_lshl_b32 s100, s100, 13
 s_lshl_b32 s66, s66, 14
 s_add_u32 s66, s66, s100
 s_xor_b32 s66, s66, 8192
 s_and_b32 s100, s67, 1
 s_lshl_b32 s100, s100, 13
 s_lshl_b32 s67, s67, 14
 s_add_u32 s67, s67, s100
 s_xor_b32 s67, s67, 8192
 v_lshlrev_b32 v7, 4, v0
 v_lshrrev_b32 v4, 5, v0
 s_mov_b32 s3, 10240
 v_mul_lo_u32 v4, v4, s3
 v_and_b32 v3, 31, v0
 v_lshl_add_u32 v4, v3, 2, v4
 s_lshl_b32 s3, s53, 9
 s_lshl_b32 s55, s50, 7
 s_add_u32 s3, s3, s55
 v_add_u32 v4, s3, v4
 s_mul_i32 s58, s52, 81920
 s_add_u32 s58, s58, 142606336
 v_lshlrev_b32 v8, 9, v0
 s_mul_i32 s3, s52, 5
 s_add_u32 s3, s3, s53
 s_and_b32 s55, s3, 3
 s_mul_i32 s55, s55, 16384
 v_add_u32 v8, s55, v8
 s_lshl_b32 s3, s3, 9
 s_add_u32 s3, s3, 40960
 v_mul_u32_u24 v5, 224, v0
 v_add_u32 v5, s3, v5
 v_mov_b32 v6, 0
 v_mov_b32 v10, 163776
 s_lshl_b32 s56, s50, 11
 s_mov_b32 s54, 0
 s_mov_b32 s61, -1
L_wo_loop:
 s_cmp_lt_u32 s54, 64
 s_cselect_b32 s3, 4, 0
 v_writelane_b32 v6, s3, 0
 s_cmp_ge_u32 s54, 8
 s_cselect_b32 s3, 4, 0
 v_writelane_b32 v6, s3, 1
 s_lshl_b32 s55, s54, 2
 s_cmp_lg_u32 s50, 0
 s_cselect_b32 s3, 268435456, s55
 v_mov_b32 v9, 0
 s_mov_b64 exec, 3
 buffer_atomic_add v9, v5, s[4:7], s3 offen sc0
 s_mov_b64 exec, -1
 s_waitcnt vmcnt(1)
 s_barrier
 s_cmp_lg_u32 s50, 1
 s_cbranch_scc1 L_sg_126
 s_cmp_ge_u32 s61, 64
 s_cbranch_scc1 L_sg_126
 s_lshl_b32 s3, s61, 2
 s_add_u32 s3, s3, 61696
 v_mov_b32 v3, 1
 s_mov_b32 exec_hi, 0
 buffer_atomic_add v3, v8, s[4:7], s3 offen
 s_mov_b64 exec, -1
L_sg_126:
 s_cmp_ge_u32 s54, 72
 s_cbranch_scc1 L_bail
 s_cmp_lg_u32 s50, 0
 s_cbranch_scc1 L_w_127
 s_waitcnt vmcnt(0)
 v_cmp_gt_u32 vcc, v6, v9
 s_cbranch_vccz L_w_127
 s_mov_b32 s51, 0
 s_mov_b64 exec, 3
 v_mov_b32 v12, 0
 buffer_atomic_add v12, v5, s[4:7], s55 offen sc0
 s_sleep 5
L_wc_128:
 v_mov_b32 v13, 0
 buffer_atomic_add v13, v5, s[4:7], s55 offen sc0
 s_waitcnt vmcnt(1)
 v_cmp_gt_u32 vcc, v6, v12
 s_cbranch_vccz L_wcd_129
 v_mov_b32 v12, 0
 buffer_atomic_add v12, v5, s[4:7], s55 offen sc0
 s_waitcnt vmcnt(1)
 v_cmp_gt_u32 vcc, v6, v13
 s_cbranch_vccz L_wcd_129
 s_add_u32 s51, s51, 1
 s_cmp_lt_u32 s51, 131072
 s_cbranch_scc1 L_wc_128
 s_branch L_bail
L_wcd_129:
 s_mov_b64 exec, -1
L_w_127:
 s_barrier
 s_sub_u32 s61, s54, 8
 s_cmp_ge_u32 s54, 64
 s_cbranch_scc1 L_tail_130
 s_lshl_b32 s3, s52, 16
 s_add_u32 s3, s3, s56
 s_add_u32 s3, s3, 75497472
 s_lshl_b32 s55, s54, 19
 s_add_u32 s55, s55, s3
 s_cmp_lt_u32 s54, 64
 s_cselect_b32 s55, s55, 268435456
 s_add_u32 m0, s56, 0
 s_add_u32 s3, s55, s64
 buffer_load_dwordx4 v7, s[4:7], s3 offen offset:0 sc1 lds
 s_add_u32 m0, s56, 0
 s_add_u32 s3, s55, s64
 buffer_load_dwordx4 v7, s[4:7], s3 offen offset:1024 sc1 lds
 s_add_u32 m0, s56, 8192
 s_add_u32 s3, s55, s65
 buffer_load_dwordx4 v7, s[4:7], s3 offen offset:0 sc1 lds
 s_add_u32 m0, s56, 8192
 s_add_u32 s3, s55, s65
 buffer_load_dwordx4 v7, s[4:7], s3 offen offset:1024 sc1 lds
 s_add_u32 m0, s56, 16384
 s_add_u32 s3, s55, s66
 buffer_load_dwordx4 v7, s[4:7], s3 offen offset:0 sc1 lds
 s_add_u32 m0, s56, 16384
 s_add_u32 s3, s55, s66
 buffer_load_dwordx4 v7, s[4:7], s3 offen offset:1024 sc1 lds
 s_add_u32 m0, s56, 24576
 s_add_u32 s3, s55, s67
 buffer_load_dwordx4 v7, s[4:7], s3 offen offset:0 sc1 lds
 s_add_u32 m0, s56, 24576
 s_add_u32 s3, s55, s67
 buffer_load_dwordx4 v7, s[4:7], s3 offen offset:1024 sc1 lds
 s_mov_b32 s60, s54
 s_lshl_b32 s3, s52, 16
 s_add_u32 s3, s3, s56
 s_add_u32 s3, s3, 109051904
 s_lshl_b32 s55, s61, 19
 s_add_u32 s55, s55, s3
 s_cmp_lt_u32 s61, 64
 s_cselect_b32 s55, s55, 268435456
 s_waitcnt vmcnt(6)
 s_barrier
 ds_read_b128 v[32:35], v7 offset:0
 ds_read_b128 v[36:39], v7 offset:1024
 ds_read_b128 v[40:43], v7 offset:2048
 ds_read_b128 v[44:47], v7 offset:3072
 s_waitcnt lgkmcnt(3)
 v_mfma_f32_32x32x16_bf16 v[64:79], v[32:35], a[0:3], 0
 ds_read_b128 v[48:51], v7 offset:4096
 s_add_u32 m0, s56, 32768
 s_add_u32 s3, s55, s64
 buffer_load_dwordx4 v7, s[4:7], s3 offen offset:0 sc1 lds
 s_waitcnt lgkmcnt(3)
 v_mfma_f32_32x32x16_bf16 v[64:79], v[36:39], a[4:7], v[64:79]
 ds_read_b128 v[52:55], v7 offset:5120
 s_waitcnt lgkmcnt(3)
 v_mfma_f32_32x32x16_bf16 v[64:79], v[40:43], a[8:11], v[64:79]
 ds_read_b128 v[56:59], v7 offset:6144
 s_waitcnt lgkmcnt(3)
 v_mfma_f32_32x32x16_bf16 v[64:79], v[44:47], a[12:15], v[64:79]
 ds_read_b128 v[60:63], v7 offset:7168
 s_add_u32 m0, s56, 32768
 s_add_u32 s3, s55, s64
 buffer_load_dwordx4 v7, s[4:7], s3 offen offset:1024 sc1 lds
 s_waitcnt lgkmcnt(3)
 v_mfma_f32_32x32x16_bf16 v[64:79], v[48:51], a[16:19], v[64:79]
 s_waitcnt vmcnt(6)
 s_barrier
 ds_read_b128 v[32:35], v7 offset:8192
 s_waitcnt lgkmcnt(3)
 v_mfma_f32_32x32x16_bf16 v[64:79], v[52:55], a[20:23], v[64:79]
 ds_read_b128 v[36:39], v7 offset:9216
 s_waitcnt lgkmcnt(3)
 v_mfma_f32_32x32x16_bf16 v[64:79], v[56:59], a[24:27], v[64:79]
 ds_read_b128 v[40:43], v7 offset:10240
 s_add_u32 m0, s56, 40960
 s_add_u32 s3, s55, s65
 buffer_load_dwordx4 v7, s[4:7], s3 offen offset:0 sc1 lds
 s_waitcnt lgkmcnt(3)
 v_mfma_f32_32x32x16_bf16 v[64:79], v[60:63], a[28:31], v[64:79]
 ds_read_b128 v[44:47], v7 offset:11264
 s_waitcnt lgkmcnt(3)
 v_mfma_f32_32x32x16_bf16 v[64:79], v[32:35], a[32:35], v[64:79]
 ds_read_b128 v[48:51], v7 offset:12288
 s_waitcnt lgkmcnt(3)
 v_mfma_f32_32x32x16_bf16 v[64:79], v[36:39], a[36:39], v[64:79]
 ds_read_b128 v[52:55], v7 offset:13312
 s_add_u32 m0, s56, 40960
 s_add_u32 s3, s55, s65
 buffer_load_dwordx4 v7, s[4:7], s3 offen offset:1024 sc1 lds
 s_waitcnt lgkmcnt(3)
 v_mfma_f32_32x32x16_bf16 v[64:79], v[40:43], a[40:43], v[64:79]
 ds_read_b128 v[56:59], v7 offset:14336
 s_waitcnt lgkmcnt(3)
 v_mfma_f32_32x32x16_bf16 v[64:79], v[44:47], a[44:47], v[64:79]
 ds_read_b128 v[60:63], v7 offset:15360
 s_waitcnt lgkmcnt(3)
 v_mfma_f32_32x32x16_bf16 v[64:79], v[48:51], a[48:51], v[64:79]
 s_waitcnt vmcnt(6)
 s_barrier
 ds_read_b128 v[32:35], v7 offset:16384
 s_add_u32 m0, s56, 49152
 s_add_u32 s3, s55, s66
 buffer_load_dwordx4 v7, s[4:7], s3 offen offset:0 sc1 lds
 s_waitcnt lgkmcnt(3)
 v_mfma_f32_32x32x16_bf16 v[64:79], v[52:55], a[52:55], v[64:79]
 ds_read_b128 v[36:39], v7 offset:17408
 s_waitcnt lgkmcnt(3)
 v_mfma_f32_32x32x16_bf16 v[64:79], v[56:59], a[56:59], v[64:79]
 ds_read_b128 v[40:43], v7 offset:18432
 s_waitcnt lgkmcnt(3)
 v_mfma_f32_32x32x16_bf16 v[64:79], v[60:63], a[60:63], v[64:79]
 ds_read_b128 v[44:47], v7 offset:19456
 s_add_u32 m0, s56, 49152
 s_add_u32 s3, s55, s66
 buffer_load_dwordx4 v7, s[4:7], s3 offen offset:1024 sc1 lds
 s_waitcnt lgkmcnt(3)
 v_mfma_f32_32x32x16_bf16 v[64:79], v[32:35], a[64:67], v[64:79]
 ds_read_b128 v[48:51], v7 offset:20480
 s_waitcnt lgkmcnt(3)
 v_mfma_f32_32x32x16_bf16 v[64:79], v[36:39], a[68:71], v[64:79]
 ds_read_b128 v[52:55], v7 offset:21504
 s_waitcnt lgkmcnt(3)
 v_mfma_f32_32x32x16_bf16 v[64:79], v[40:43], a[72:75], v[64:79]
 ds_read_b128 v[56:59], v7 offset:22528
 s_add_u32 m0, s56, 57344
 s_add_u32 s3, s55, s67
 buffer_load_dwordx4 v7, s[4:7], s3 offen offset:0 sc1 lds
 s_waitcnt lgkmcnt(3)
 v_mfma_f32_32x32x16_bf16 v[64:79], v[44:47], a[76:79], v[64:79]
 ds_read_b128 v[60:63], v7 offset:23552
 s_waitcnt lgkmcnt(3)
 v_mfma_f32_32x32x16_bf16 v[64:79], v[48:51], a[80:83], v[64:79]
 s_waitcnt vmcnt(7)
 s_barrier
 ds_read_b128 v[32:35], v7 offset:24576
 s_waitcnt lgkmcnt(3)
 v_mfma_f32_32x32x16_bf16 v[64:79], v[52:55], a[84:87], v[64:79]
 ds_read_b128 v[36:39], v7 offset:25600
 s_add_u32 m0, s56, 57344
 s_add_u32 s3, s55, s67
 buffer_load_dwordx4 v7, s[4:7], s3 offen offset:1024 sc1 lds
 s_waitcnt lgkmcnt(3)
 v_mfma_f32_32x32x16_bf16 v[64:79], v[56:59], a[88:91], v[64:79]
 ds_read_b128 v[40:43], v7 offset:26624
 s_waitcnt lgkmcnt(3)
 v_mfma_f32_32x32x16_bf16 v[64:79], v[60:63], a[92:95], v[64:79]
 ds_read_b128 v[44:47], v7 offset:27648
 s_waitcnt lgkmcnt(3)
 v_mfma_f32_32x32x16_bf16 v[64:79], v[32:35], a[96:99], v[64:79]
 ds_read_b128 v[48:51], v7 offset:28672
 s_waitcnt lgkmcnt(3)
 v_mfma_f32_32x32x16_bf16 v[64:79], v[36:39], a[100:103], v[64:79]
 ds_read_b128 v[52:55], v7 offset:29696
 s_waitcnt lgkmcnt(3)
 v_mfma_f32_32x32x16_bf16 v[64:79], v[40:43], a[104:107], v[64:79]
 ds_read_b128 v[56:59], v7 offset:30720
 s_waitcnt lgkmcnt(3)
 v_mfma_f32_32x32x16_bf16 v[64:79], v[44:47], a[108:111], v[64:79]
 ds_read_b128 v[60:63], v7 offset:31744
 s_waitcnt lgkmcnt(3)
 v_mfma_f32_32x32x16_bf16 v[64:79], v[48:51], a[112:115], v[64:79]
 s_waitcnt lgkmcnt(2)
 v_mfma_f32_32x32x16_bf16 v[64:79], v[52:55], a[116:119], v[64:79]
 s_waitcnt lgkmcnt(1)
 v_mfma_f32_32x32x16_bf16 v[64:79], v[56:59], a[120:123], v[64:79]
 s_waitcnt lgkmcnt(0)
 v_mfma_f32_32x32x16_bf16 v[64:79], v[60:63], a[124:127], v[64:79]
 s_mul_i32 s55, s60, 655360
 s_add_u32 s55, s55, s58
 s_cmp_lt_u32 s60, 64
 s_cselect_b32 s55, s55, 268435456
 s_nop 7
 s_add_u32 s3, s55, 0
 buffer_store_dword v64, v4, s[4:7], s3 offen sc1
 s_add_u32 s3, s55, 2560
 buffer_store_dword v65, v4, s[4:7], s3 offen sc1
 s_add_u32 s3, s55, 5120
 buffer_store_dword v66, v4, s[4:7], s3 offen sc1
 s_add_u32 s3, s55, 7680
 buffer_store_dword v67, v4, s[4:7], s3 offen sc1
 s_add_u32 s3, s55, 20480
 buffer_store_dword v68, v4, s[4:7], s3 offen sc1
 s_add_u32 s3, s55, 23040
 buffer_store_dword v69, v4, s[4:7], s3 offen sc1
 s_add_u32 s3, s55, 25600
 buffer_store_dword v70, v4, s[4:7], s3 offen sc1
 s_add_u32 s3, s55, 28160
 buffer_store_dword v71, v4, s[4:7], s3 offen sc1
 s_add_u32 s3, s55, 40960
 buffer_store_dword v72, v4, s[4:7], s3 offen sc1
 s_add_u32 s3, s55, 43520
 buffer_store_dword v73, v4, s[4:7], s3 offen sc1
 s_add_u32 s3, s55, 46080
 buffer_store_dword v74, v4, s[4:7], s3 offen sc1
 s_add_u32 s3, s55, 48640
 buffer_store_dword v75, v4, s[4:7], s3 offen sc1
 s_add_u32 s3, s55, 61440
 buffer_store_dword v76, v4, s[4:7], s3 offen sc1
 s_add_u32 s3, s55, 64000
 buffer_store_dword v77, v4, s[4:7], s3 offen sc1
 s_add_u32 s3, s55, 66560
 buffer_store_dword v78, v4, s[4:7], s3 offen sc1
 s_add_u32 s3, s55, 69120
 buffer_store_dword v79, v4, s[4:7], s3 offen sc1
L_wo_mid:
 s_add_u32 s62, s54, 1
 s_cmp_lt_u32 s62, 64
 s_cselect_b32 s3, 4, 0
 v_writelane_b32 v6, s3, 0
 s_cmp_ge_u32 s62, 8
 s_cselect_b32 s3, 4, 0
 v_writelane_b32 v6, s3, 1
 s_lshl_b32 s55, s62, 2
 s_cmp_lg_u32 s50, 0
 s_cselect_b32 s3, 268435456, s55
 v_mov_b32 v9, 0
 s_mov_b64 exec, 3
 buffer_atomic_add v9, v5, s[4:7], s3 offen sc0
 s_mov_b64 exec, -1
 s_waitcnt vmcnt(17)
 s_barrier
 s_mov_b32 s60, s61
 ds_read_b128 v[32:35], v7 offset:32768
 ds_read_b128 v[36:39], v7 offset:33792
 ds_read_b128 v[40:43], v7 offset:34816
 ds_read_b128 v[44:47], v7 offset:35840
 s_waitcnt lgkmcnt(3)
 v_mfma_f32_32x32x16_bf16 v[80:95], v[32:35], a[0:3], 0
 ds_read_b128 v[48:51], v7 offset:36864
 s_waitcnt lgkmcnt(3)
 v_mfma_f32_32x32x16_bf16 v[80:95], v[36:39], a[4:7], v[80:95]
 ds_read_b128 v[52:55], v7 offset:37888
 s_waitcnt lgkmcnt(3)
 v_mfma_f32_32x32x16_bf16 v[80:95], v[40:43], a[8:11], v[80:95]
 ds_read_b128 v[56:59], v7 offset:38912
 s_waitcnt lgkmcnt(3)
 v_mfma_f32_32x32x16_bf16 v[80:95], v[44:47], a[12:15], v[80:95]
 ds_read_b128 v[60:63], v7 offset:39936
 s_waitcnt lgkmcnt(3)
 v_mfma_f32_32x32x16_bf16 v[80:95], v[48:51], a[16:19], v[80:95]
 ds_read_b128 v[32:35], v7 offset:40960
 s_waitcnt lgkmcnt(3)
 v_mfma_f32_32x32x16_bf16 v[80:95], v[52:55], a[20:23], v[80:95]
 ds_read_b128 v[36:39], v7 offset:41984
 s_waitcnt lgkmcnt(3)
 v_mfma_f32_32x32x16_bf16 v[80:95], v[56:59], a[24:27], v[80:95]
 ds_read_b128 v[40:43], v7 offset:43008
 s_waitcnt lgkmcnt(3)
 v_mfma_f32_32x32x16_bf16 v[80:95], v[60:63], a[28:31], v[80:95]
 ds_read_b128 v[44:47], v7 offset:44032
 s_waitcnt lgkmcnt(3)
 v_mfma_f32_32x32x16_bf16 v[80:95], v[32:35], a[32:35], v[80:95]
 ds_read_b128 v[48:51], v7 offset:45056
 s_waitcnt lgkmcnt(3)
 v_mfma_f32_32x32x16_bf16 v[80:95], v[36:39], a[36:39], v[80:95]
 ds_read_b128 v[52:55], v7 offset:46080
 s_waitcnt lgkmcnt(3)
 v_mfma_f32_32x32x16_bf16 v[80:95], v[40:43], a[40:43], v[80:95]
 ds_read_b128 v[56:59], v7 offset:47104
 s_waitcnt lgkmcnt(3)
 v_mfma_f32_32x32x16_bf16 v[80:95], v[44:47], a[44:47], v[80:95]
 ds_read_b128 v[60:63], v7 offset:48128
 s_waitcnt lgkmcnt(3)
 v_mfma_f32_32x32x16_bf16 v[80:95], v[48:51], a[48:51], v[80:95]
 ds_read_b128 v[32:35], v7 offset:49152
 s_waitcnt lgkmcnt(3)
 v_mfma_f32_32x32x16_bf16 v[80:95], v[52:55], a[52:55], v[80:95]
 ds_read_b128 v[36:39], v7 offset:50176
 s_waitcnt lgkmcnt(3)
 v_mfma_f32_32x32x16_bf16 v[80:95], v[56:59], a[56:59], v[80:95]
 ds_read_b128 v[40:43], v7 offset:51200
 s_waitcnt lgkmcnt(3)
 v_mfma_f32_32x32x16_bf16 v[80:95], v[60:63], a[60:63], v[80:95]
 ds_read_b128 v[44:47], v7 offset:52224
 s_waitcnt vmcnt(0)
 s_cmp_lg_u32 s50, 0
 s_cbranch_scc1 L_hs_132
 v_cmp_gt_u32 vcc, v6, v9
 s_nop 1
 v_mov_b32 v3, vcc_lo
 ds_write_b32 v10, v3
 s_waitcnt lgkmcnt(0)
L_hs_132:
 s_barrier
 ds_read_b32 v9, v10
 s_cmp_lg_u32 s50, 1
 s_cbranch_scc1 L_sg_133
 s_cmp_ge_u32 s54, 64
 s_cbranch_scc1 L_sg_133
 s_lshl_b32 s3, s54, 2
 s_add_u32 s3, s3, 61440
 v_mov_b32 v3, 1
 s_mov_b32 exec_hi, 0
 buffer_atomic_add v3, v8, s[4:7], s3 offen
 s_mov_b64 exec, -1
L_sg_133:
 s_waitcnt lgkmcnt(0)
 v_readfirstlane_b32 s3, v9
 s_nop 3
 s_cmp_eq_u32 s3, 0
 s_cselect_b32 s62, s62, 64
 s_lshl_b32 s3, s52, 16
 s_add_u32 s3, s3, s56
 s_add_u32 s3, s3, 75497472
 s_lshl_b32 s55, s62, 19
 s_add_u32 s55, s55, s3
 s_cmp_lt_u32 s62, 64
 s_cselect_b32 s55, s55, 268435456
 s_waitcnt lgkmcnt(3)
 v_mfma_f32_32x32x16_bf16 v[80:95], v[32:35], a[64:67], v[80:95]
 ds_read_b128 v[48:51], v7 offset:53248
 s_add_u32 m0, s56, 0
 s_add_u32 s3, s55, s64
 buffer_load_dwordx4 v7, s[4:7], s3 offen offset:0 sc1 lds
 s_waitcnt lgkmcnt(3)
 v_mfma_f32_32x32x16_bf16 v[80:95], v[36:39], a[68:71], v[80:95]
 ds_read_b128 v[52:55], v7 offset:54272
 s_waitcnt lgkmcnt(3)
 v_mfma_f32_32x32x16_bf16 v[80:95], v[40:43], a[72:75], v[80:95]
 ds_read_b128 v[56:59], v7 offset:55296
 s_add_u32 m0, s56, 0
 s_add_u32 s3, s55, s64
 buffer_load_dwordx4 v7, s[4:7], s3 offen offset:1024 sc1 lds
 s_waitcnt lgkmcnt(3)
 v_mfma_f32_32x32x16_bf16 v[80:95], v[44:47], a[76:79], v[80:95]
 ds_read_b128 v[60:63], v7 offset:56320
 s_waitcnt lgkmcnt(3)
 v_mfma_f32_32x32x16_bf16 v[80:95], v[48:51], a[80:83], v[80:95]
 ds_read_b128 v[32:35], v7 offset:57344
 s_add_u32 m0, s56, 8192
 s_add_u32 s3, s55, s65
 buffer_load_dwordx4 v7, s[4:7], s3 offen offset:0 sc1 lds
 s_waitcnt lgkmcnt(3)
 v_mfma_f32_32x32x16_bf16 v[80:95], v[52:55], a[84:87], v[80:95]
 ds_read_b128 v[36:39], v7 offset:58368
 s_waitcnt lgkmcnt(3)
 v_mfma_f32_32x32x16_bf16 v[80:95], v[56:59], a[88:91], v[80:95]
 ds_read_b128 v[40:43], v7 offset:59392
 s_add_u32 m0, s56, 8192
 s_add_u32 s3, s55, s65
 buffer_load_dwordx4 v7, s[4:7], s3 offen offset:1024 sc1 lds
 s_waitcnt lgkmcnt(3)
 v_mfma_f32_32x32x16_bf16 v[80:95], v[60:63], a[92:95], v[80:95]
 ds_read_b128 v[44:47], v7 offset:60416
 s_waitcnt lgkmcnt(3)
 v_mfma_f32_32x32x16_bf16 v[80:95], v[32:35], a[96:99], v[80:95]
 ds_read_b128 v[48:51], v7 offset:61440
 s_add_u32 m0, s56, 16384
 s_add_u32 s3, s55, s66
 buffer_load_dwordx4 v7, s[4:7], s3 offen offset:0 sc1 lds
 s_waitcnt lgkmcnt(3)
 v_mfma_f32_32x32x16_bf16 v[80:95], v[36:39], a[100:103], v[80:95]
 ds_read_b128 v[52:55], v7 offset:62464
 s_waitcnt lgkmcnt(3)
 v_mfma_f32_32x32x16_bf16 v[80:95], v[40:43], a[104:107], v[80:95]
 ds_read_b128 v[56:59], v7 offset:63488
 s_add_u32 m0, s56, 16384
 s_add_u32 s3, s55, s66
 buffer_load_dwordx4 v7, s[4:7], s3 offen offset:1024 sc1 lds
 s_waitcnt lgkmcnt(3)
 v_mfma_f32_32x32x16_bf16 v[80:95], v[44:47], a[108:111], v[80:95]
 ds_read_b128 v[60:63], v7 offset:64512
 s_waitcnt lgkmcnt(3)
 v_mfma_f32_32x32x16_bf16 v[80:95], v[48:51], a[112:115], v[80:95]
 s_add_u32 m0, s56, 24576
 s_add_u32 s3, s55, s67
 buffer_load_dwordx4 v7, s[4:7], s3 offen offset:0 sc1 lds
 s_waitcnt lgkmcnt(2)
 v_mfma_f32_32x32x16_bf16 v[80:95], v[52:55], a[116:119], v[80:95]
 s_waitcnt lgkmcnt(1)
 v_mfma_f32_32x32x16_bf16 v[80:95], v[56:59], a[120:123], v[80:95]
 s_add_u32 m0, s56, 24576
 s_add_u32 s3, s55, s67
 buffer_load_dwordx4 v7, s[4:7], s3 offen offset:1024 sc1 lds
 s_waitcnt lgkmcnt(0)
 v_mfma_f32_32x32x16_bf16 v[80:95], v[60:63], a[124:127], v[80:95]
 s_mul_i32 s55, s60, 655360
 s_add_u32 s55, s55, s58
 s_add_u32 s55, s55, 41943040
 s_cmp_lt_u32 s60, 64
 s_cselect_b32 s55, s55, 268435456
 s_nop 7
 s_add_u32 s3, s55, 0
 buffer_store_dword v80, v4, s[4:7], s3 offen sc1
 s_add_u32 s3, s55, 2560
 buffer_store_dword v81, v4, s[4:7], s3 offen sc1
 s_add_u32 s3, s55, 5120
 buffer_store_dword v82, v4, s[4:7], s3 offen sc1
 s_add_u32 s3, s55, 7680
 buffer_store_dword v83, v4, s[4:7], s3 offen sc1
 s_add_u32 s3, s55, 20480
 buffer_store_dword v84, v4, s[4:7], s3 offen sc1
 s_add_u32 s3, s55, 23040
 buffer_store_dword v85, v4, s[4:7], s3 offen sc1
 s_add_u32 s3, s55, 25600
 buffer_store_dword v86, v4, s[4:7], s3 offen sc1
 s_add_u32 s3, s55, 28160
 buffer_store_dword v87, v4, s[4:7], s3 offen sc1
 s_add_u32 s3, s55, 40960
 buffer_store_dword v88, v4, s[4:7], s3 offen sc1
 s_add_u32 s3, s55, 43520
 buffer_store_dword v89, v4, s[4:7], s3 offen sc1
 s_add_u32 s3, s55, 46080
 buffer_store_dword v90, v4, s[4:7], s3 offen sc1
 s_add_u32 s3, s55, 48640
 buffer_store_dword v91, v4, s[4:7], s3 offen sc1
 s_add_u32 s3, s55, 61440
 buffer_store_dword v92, v4, s[4:7], s3 offen sc1
 s_add_u32 s3, s55, 64000
 buffer_store_dword v93, v4, s[4:7], s3 offen sc1
 s_add_u32 s3, s55, 66560
 buffer_store_dword v94, v4, s[4:7], s3 offen sc1
 s_add_u32 s3, s55, 69120
 buffer_store_dword v95, v4, s[4:7], s3 offen sc1
 s_cmp_ge_u32 s62, 64
 s_cbranch_scc1 L_e_131
 s_mov_b32 s54, s62
 s_mov_b32 s63, s61
 s_sub_u32 s61, s54, 8
 s_mov_b32 s60, s54
 s_waitcnt vmcnt(16)
 s_barrier
 s_lshl_b32 s3, s52, 16
 s_add_u32 s3, s3, s56
 s_add_u32 s3, s3, 109051904
 s_lshl_b32 s55, s61, 19
 s_add_u32 s55, s55, s3
 s_cmp_lt_u32 s61, 64
 s_cselect_b32 s55, s55, 268435456
 ds_read_b128 v[32:35], v7 offset:0
 ds_read_b128 v[36:39], v7 offset:1024
 ds_read_b128 v[40:43], v7 offset:2048
 ds_read_b128 v[44:47], v7 offset:3072
 s_waitcnt lgkmcnt(3)
 v_mfma_f32_32x32x16_bf16 v[64:79], v[32:35], a[0:3], 0
 ds_read_b128 v[48:51], v7 offset:4096
 s_add_u32 m0, s56, 32768
 s_add_u32 s3, s55, s64
 buffer_load_dwordx4 v7, s[4:7], s3 offen offset:0 sc1 lds
 s_waitcnt lgkmcnt(3)
 v_mfma_f32_32x32x16_bf16 v[64:79], v[36:39], a[4:7], v[64:79]
 ds_read_b128 v[52:55], v7 offset:5120
 s_waitcnt lgkmcnt(3)
 v_mfma_f32_32x32x16_bf16 v[64:79], v[40:43], a[8:11], v[64:79]
 ds_read_b128 v[56:59], v7 offset:6144
 s_waitcnt lgkmcnt(3)
 v_mfma_f32_32x32x16_bf16 v[64:79], v[44:47], a[12:15], v[64:79]
 ds_read_b128 v[60:63], v7 offset:7168
 s_add_u32 m0, s56, 32768
 s_add_u32 s3, s55, s64
 buffer_load_dwordx4 v7, s[4:7], s3 offen offset:1024 sc1 lds
 s_waitcnt lgkmcnt(3)
 v_mfma_f32_32x32x16_bf16 v[64:79], v[48:51], a[16:19], v[64:79]
 ds_read_b128 v[32:35], v7 offset:8192
 s_waitcnt lgkmcnt(3)
 v_mfma_f32_32x32x16_bf16 v[64:79], v[52:55], a[20:23], v[64:79]
 ds_read_b128 v[36:39], v7 offset:9216
 s_waitcnt lgkmcnt(3)
 v_mfma_f32_32x32x16_bf16 v[64:79], v[56:59], a[24:27], v[64:79]
 ds_read_b128 v[40:43], v7 offset:10240
 s_add_u32 m0, s56, 40960
 s_add_u32 s3, s55, s65
 buffer_load_dwordx4 v7, s[4:7], s3 offen offset:0 sc1 lds
 s_waitcnt lgkmcnt(3)
 v_mfma_f32_32x32x16_bf16 v[64:79], v[60:63], a[28:31], v[64:79]
 ds_read_b128 v[44:47], v7 offset:11264
 s_waitcnt lgkmcnt(3)
 v_mfma_f32_32x32x16_bf16 v[64:79], v[32:35], a[32:35], v[64:79]
 ds_read_b128 v[48:51], v7 offset:12288
 s_waitcnt lgkmcnt(3)
 v_mfma_f32_32x32x16_bf16 v[64:79], v[36:39], a[36:39], v[64:79]
 ds_read_b128 v[52:55], v7 offset:13312
 s_add_u32 m0, s56, 40960
 s_add_u32 s3, s55, s65
 buffer_load_dwordx4 v7, s[4:7], s3 offen offset:1024 sc1 lds
 s_waitcnt lgkmcnt(3)
 v_mfma_f32_32x32x16_bf16 v[64:79], v[40:43], a[40:43], v[64:79]
 ds_read_b128 v[56:59], v7 offset:14336
 s_waitcnt lgkmcnt(3)
 v_mfma_f32_32x32x16_bf16 v[64:79], v[44:47], a[44:47], v[64:79]
 ds_read_b128 v[60:63], v7 offset:15360
 s_waitcnt lgkmcnt(3)
 v_mfma_f32_32x32x16_bf16 v[64:79], v[48:51], a[48:51], v[64:79]
 ds_read_b128 v[32:35], v7 offset:16384
 s_add_u32 m0, s56, 49152
 s_add_u32 s3, s55, s66
 buffer_load_dwordx4 v7, s[4:7], s3 offen offset:0 sc1 lds
 s_waitcnt lgkmcnt(3)
 v_mfma_f32_32x32x16_bf16 v[64:79], v[52:55], a[52:55], v[64:79]
 ds_read_b128 v[36:39], v7 offset:17408
 s_waitcnt lgkmcnt(3)
 v_mfma_f32_32x32x16_bf16 v[64:79], v[56:59], a[56:59], v[64:79]
 ds_read_b128 v[40:43], v7 offset:18432
 s_waitcnt lgkmcnt(3)
 v_mfma_f32_32x32x16_bf16 v[64:79], v[60:63], a[60:63], v[64:79]
 ds_read_b128 v[44:47], v7 offset:19456
 s_add_u32 m0, s56, 49152
 s_add_u32 s3, s55, s66
 buffer_load_dwordx4 v7, s[4:7], s3 offen offset:1024 sc1 lds
 s_waitcnt vmcnt(6)
 s_barrier
 s_cmp_lg_u32 s50, 1
 s_cbranch_scc1 L_sg_134
 s_cmp_ge_u32 s63, 64
 s_cbranch_scc1 L_sg_134
 s_lshl_b32 s3, s63, 2
 s_add_u32 s3, s3, 61696
 v_mov_b32 v3, 1
 s_mov_b32 exec_hi, 0
 buffer_atomic_add v3, v8, s[4:7], s3 offen
 s_mov_b64 exec, -1
L_sg_134:
 s_waitcnt lgkmcnt(3)
 v_mfma_f32_32x32x16_bf16 v[64:79], v[32:35], a[64:67], v[64:79]
 ds_read_b128 v[48:51], v7 offset:20480
 s_waitcnt lgkmcnt(3)
 v_mfma_f32_32x32x16_bf16 v[64:79], v[36:39], a[68:71], v[64:79]
 ds_read_b128 v[52:55], v7 offset:21504
 s_waitcnt lgkmcnt(3)
 v_mfma_f32_32x32x16_bf16 v[64:79], v[40:43], a[72:75], v[64:79]
 ds_read_b128 v[56:59], v7 offset:22528
 s_add_u32 m0, s56, 57344
 s_add_u32 s3, s55, s67
 buffer_load_dwordx4 v7, s[4:7], s3 offen offset:0 sc1 lds
 s_waitcnt lgkmcnt(3)
 v_mfma_f32_32x32x16_bf16 v[64:79], v[44:47], a[76:79], v[64:79]
 ds_read_b128 v[60:63], v7 offset:23552
 s_waitcnt lgkmcnt(3)
 v_mfma_f32_32x32x16_bf16 v[64:79], v[48:51], a[80:83], v[64:79]
 ds_read_b128 v[32:35], v7 offset:24576
 s_waitcnt lgkmcnt(3)
 v_mfma_f32_32x32x16_bf16 v[64:79], v[52:55], a[84:87], v[64:79]
 ds_read_b128 v[36:39], v7 offset:25600
 s_add_u32 m0, s56, 57344
 s_add_u32 s3, s55, s67
 buffer_load_dwordx4 v7, s[4:7], s3 offen offset:1024 sc1 lds
 s_waitcnt lgkmcnt(3)
 v_mfma_f32_32x32x16_bf16 v[64:79], v[56:59], a[88:91], v[64:79]
 ds_read_b128 v[40:43], v7 offset:26624
 s_waitcnt lgkmcnt(3)
 v_mfma_f32_32x32x16_bf16 v[64:79], v[60:63], a[92:95], v[64:79]
 ds_read_b128 v[44:47], v7 offset:27648
 s_waitcnt lgkmcnt(3)
 v_mfma_f32_32x32x16_bf16 v[64:79], v[32:35], a[96:99], v[64:79]
 ds_read_b128 v[48:51], v7 offset:28672
 s_waitcnt lgkmcnt(3)
 v_mfma_f32_32x32x16_bf16 v[64:79], v[36:39], a[100:103], v[64:79]
 ds_read_b128 v[52:55], v7 offset:29696
 s_waitcnt lgkmcnt(3)
 v_mfma_f32_32x32x16_bf16 v[64:79], v[40:43], a[104:107], v[64:79]
 ds_read_b128 v[56:59], v7 offset:30720
 s_waitcnt lgkmcnt(3)
 v_mfma_f32_32x32x16_bf16 v[64:79], v[44:47], a[108:111], v[64:79]
 ds_read_b128 v[60:63], v7 offset:31744
 s_waitcnt lgkmcnt(3)
 v_mfma_f32_32x32x16_bf16 v[64:79], v[48:51], a[112:115], v[64:79]
 s_waitcnt lgkmcnt(2)
 v_mfma_f32_32x32x16_bf16 v[64:79], v[52:55], a[116:119], v[64:79]
 s_waitcnt lgkmcnt(1)
 v_mfma_f32_32x32x16_bf16 v[64:79], v[56:59], a[120:123], v[64:79]
 s_waitcnt lgkmcnt(0)
 v_mfma_f32_32x32x16_bf16 v[64:79], v[60:63], a[124:127], v[64:79]
 s_mul_i32 s55, s60, 655360
 s_add_u32 s55, s55, s58
 s_cmp_lt_u32 s60, 64
 s_cselect_b32 s55, s55, 268435456
 s_nop 7
 s_add_u32 s3, s55, 0
 buffer_store_dword v64, v4, s[4:7], s3 offen sc1
 s_add_u32 s3, s55, 2560
 buffer_store_dword v65, v4, s[4:7], s3 offen sc1
 s_add_u32 s3, s55, 5120
 buffer_store_dword v66, v4, s[4:7], s3 offen sc1
 s_add_u32 s3, s55, 7680
 buffer_store_dword v67, v4, s[4:7], s3 offen sc1
 s_add_u32 s3, s55, 20480
 buffer_store_dword v68, v4, s[4:7], s3 offen sc1
 s_add_u32 s3, s55, 23040
 buffer_store_dword v69, v4, s[4:7], s3 offen sc1
 s_add_u32 s3, s55, 25600
 buffer_store_dword v70, v4, s[4:7], s3 offen sc1
 s_add_u32 s3, s55, 28160
 buffer_store_dword v71, v4, s[4:7], s3 offen sc1
 s_add_u32 s3, s55, 40960
 buffer_store_dword v72, v4, s[4:7], s3 offen sc1
 s_add_u32 s3, s55, 43520
 buffer_store_dword v73, v4, s[4:7], s3 offen sc1
 s_add_u32 s3, s55, 46080
 buffer_store_dword v74, v4, s[4:7], s3 offen sc1
 s_add_u32 s3, s55, 48640
 buffer_store_dword v75, v4, s[4:7], s3 offen sc1
 s_add_u32 s3, s55, 61440
 buffer_store_dword v76, v4, s[4:7], s3 offen sc1
 s_add_u32 s3, s55, 64000
 buffer_store_dword v77, v4, s[4:7], s3 offen sc1
 s_add_u32 s3, s55, 66560
 buffer_store_dword v78, v4, s[4:7], s3 offen sc1
 s_add_u32 s3, s55, 69120
 buffer_store_dword v79, v4, s[4:7], s3 offen sc1
 s_branch L_wo_mid
L_tail_130:
 s_lshl_b32 s3, s52, 16
 s_add_u32 s3, s3, s56
 s_add_u32 s3, s3, 109051904
 s_lshl_b32 s55, s61, 19
 s_add_u32 s55, s55, s3
 s_cmp_lt_u32 s61, 64
 s_cselect_b32 s55, s55, 268435456
 s_add_u32 m0, s56, 32768
 s_add_u32 s3, s55, s64
 buffer_load_dwordx4 v7, s[4:7], s3 offen offset:0 sc1 lds
 s_add_u32 m0, s56, 32768
 s_add_u32 s3, s55, s64
 buffer_load_dwordx4 v7, s[4:7], s3 offen offset:1024 sc1 lds
 s_add_u32 m0, s56, 40960
 s_add_u32 s3, s55, s65
 buffer_load_dwordx4 v7, s[4:7], s3 offen offset:0 sc1 lds
 s_add_u32 m0, s56, 40960
 s_add_u32 s3, s55, s65
 buffer_load_dwordx4 v7, s[4:7], s3 offen offset:1024 sc1 lds
 s_add_u32 m0, s56, 49152
 s_add_u32 s3, s55, s66
 buffer_load_dwordx4 v7, s[4:7], s3 offen offset:0 sc1 lds
 s_add_u32 m0, s56, 49152
 s_add_u32 s3, s55, s66
 buffer_load_dwordx4 v7, s[4:7], s3 offen offset:1024 sc1 lds
 s_add_u32 m0, s56, 57344
 s_add_u32 s3, s55, s67
 buffer_load_dwordx4 v7, s[4:7], s3 offen offset:0 sc1 lds
 s_add_u32 m0, s56, 57344
 s_add_u32 s3, s55, s67
 buffer_load_dwordx4 v7, s[4:7], s3 offen offset:1024 sc1 lds
 s_mov_b32 s60, s61
 s_waitcnt vmcnt(6)
 s_barrier
 ds_read_b128 v[32:35], v7 offset:32768
 ds_read_b128 v[36:39], v7 offset:33792
 ds_read_b128 v[40:43], v7 offset:34816
 ds_read_b128 v[44:47], v7 offset:35840
 s_waitcnt lgkmcnt(3)
 v_mfma_f32_32x32x16_bf16 v[80:95], v[32:35], a[0:3], 0
 ds_read_b128 v[48:51], v7 offset:36864
 s_waitcnt lgkmcnt(3)
 v_mfma_f32_32x32x16_bf16 v[80:95], v[36:39], a[4:7], v[80:95]
 ds_read_b128 v[52:55], v7 offset:37888
 s_waitcnt lgkmcnt(3)
 v_mfma_f32_32x32x16_bf16 v[80:95], v[40:43], a[8:11], v[80:95]
 ds_read_b128 v[56:59], v7 offset:38912
 s_waitcnt lgkmcnt(3)
 v_mfma_f32_32x32x16_bf16 v[80:95], v[44:47], a[12:15], v[80:95]
 ds_read_b128 v[60:63], v7 offset:39936
 s_waitcnt lgkmcnt(3)
 v_mfma_f32_32x32x16_bf16 v[80:95], v[48:51], a[16:19], v[80:95]
 s_waitcnt vmcnt(4)
 s_barrier
 ds_read_b128 v[32:35], v7 offset:40960
 s_waitcnt lgkmcnt(3)
 v_mfma_f32_32x32x16_bf16 v[80:95], v[52:55], a[20:23], v[80:95]
 ds_read_b128 v[36:39], v7 offset:41984
 s_waitcnt lgkmcnt(3)
 v_mfma_f32_32x32x16_bf16 v[80:95], v[56:59], a[24:27], v[80:95]
 ds_read_b128 v[40:43], v7 offset:43008
 s_waitcnt lgkmcnt(3)
 v_mfma_f32_32x32x16_bf16 v[80:95], v[60:63], a[28:31], v[80:95]
 ds_read_b128 v[44:47], v7 offset:44032
 s_waitcnt lgkmcnt(3)
 v_mfma_f32_32x32x16_bf16 v[80:95], v[32:35], a[32:35], v[80:95]
 ds_read_b128 v[48:51], v7 offset:45056
 s_waitcnt lgkmcnt(3)
 v_mfma_f32_32x32x16_bf16 v[80:95], v[36:39], a[36:39], v[80:95]
 ds_read_b128 v[52:55], v7 offset:46080
 s_waitcnt lgkmcnt(3)
 v_mfma_f32_32x32x16_bf16 v[80:95], v[40:43], a[40:43], v[80:95]
 ds_read_b128 v[56:59], v7 offset:47104
 s_waitcnt lgkmcnt(3)
 v_mfma_f32_32x32x16_bf16 v[80:95], v[44:47], a[44:47], v[80:95]
 ds_read_b128 v[60:63], v7 offset:48128
 s_waitcnt lgkmcnt(3)
 v_mfma_f32_32x32x16_bf16 v[80:95], v[48:51], a[48:51], v[80:95]
 s_waitcnt vmcnt(2)
 s_barrier
 ds_read_b128 v[32:35], v7 offset:49152
 s_waitcnt lgkmcnt(3)
 v_mfma_f32_32x32x16_bf16 v[80:95], v[52:55], a[52:55], v[80:95]
 ds_read_b128 v[36:39], v7 offset:50176
 s_waitcnt lgkmcnt(3)
 v_mfma_f32_32x32x16_bf16 v[80:95], v[56:59], a[56:59], v[80:95]
 ds_read_b128 v[40:43], v7 offset:51200
 s_waitcnt lgkmcnt(3)
 v_mfma_f32_32x32x16_bf16 v[80:95], v[60:63], a[60:63], v[80:95]
 ds_read_b128 v[44:47], v7 offset:52224
 s_waitcnt lgkmcnt(3)
 v_mfma_f32_32x32x16_bf16 v[80:95], v[32:35], a[64:67], v[80:95]
 ds_read_b128 v[48:51], v7 offset:53248
 s_waitcnt lgkmcnt(3)
 v_mfma_f32_32x32x16_bf16 v[80:95], v[36:39], a[68:71], v[80:95]
 ds_read_b128 v[52:55], v7 offset:54272
 s_waitcnt lgkmcnt(3)
 v_mfma_f32_32x32x16_bf16 v[80:95], v[40:43], a[72:75], v[80:95]
 ds_read_b128 v[56:59], v7 offset:55296
 s_waitcnt lgkmcnt(3)
 v_mfma_f32_32x32x16_bf16 v[80:95], v[44:47], a[76:79], v[80:95]
 ds_read_b128 v[60:63], v7 offset:56320
 s_waitcnt lgkmcnt(3)
 v_mfma_f32_32x32x16_bf16 v[80:95], v[48:51], a[80:83], v[80:95]
 s_waitcnt vmcnt(0)
 s_barrier
 ds_read_b128 v[32:35], v7 offset:57344
 s_waitcnt lgkmcnt(3)
 v_mfma_f32_32x32x16_bf16 v[80:95], v[52:55], a[84:87], v[80:95]
 ds_read_b128 v[36:39], v7 offset:58368
 s_waitcnt lgkmcnt(3)
 v_mfma_f32_32x32x16_bf16 v[80:95], v[56:59], a[88:91], v[80:95]
 ds_read_b128 v[40:43], v7 offset:59392
 s_waitcnt lgkmcnt(3)
 v_mfma_f32_32x32x16_bf16 v[80:95], v[60:63], a[92:95], v[80:95]
 ds_read_b128 v[44:47], v7 offset:60416
 s_waitcnt lgkmcnt(3)
 v_mfma_f32_32x32x16_bf16 v[80:95], v[32:35], a[96:99], v[80:95]
 ds_read_b128 v[48:51], v7 offset:61440
 s_waitcnt lgkmcnt(3)
 v_mfma_f32_32x32x16_bf16 v[80:95], v[36:39], a[100:103], v[80:95]
 ds_read_b128 v[52:55], v7 offset:62464
 s_waitcnt lgkmcnt(3)
 v_mfma_f32_32x32x16_bf16 v[80:95], v[40:43], a[104:107], v[80:95]
 ds_read_b128 v[56:59], v7 offset:63488
 s_waitcnt lgkmcnt(3)
 v_mfma_f32_32x32x16_bf16 v[80:95], v[44:47], a[108:111], v[80:95]
 ds_read_b128 v[60:63], v7 offset:64512
 s_waitcnt lgkmcnt(3)
 v_mfma_f32_32x32x16_bf16 v[80:95], v[48:51], a[112:115], v[80:95]
 s_waitcnt lgkmcnt(2)
 v_mfma_f32_32x32x16_bf16 v[80:95], v[52:55], a[116:119], v[80:95]
 s_waitcnt lgkmcnt(1)
 v_mfma_f32_32x32x16_bf16 v[80:95], v[56:59], a[120:123], v[80:95]
 s_waitcnt lgkmcnt(0)
 v_mfma_f32_32x32x16_bf16 v[80:95], v[60:63], a[124:127], v[80:95]
 s_mul_i32 s55, s60, 655360
 s_add_u32 s55, s55, s58
 s_add_u32 s55, s55, 41943040
 s_cmp_lt_u32 s60, 64
 s_cselect_b32 s55, s55, 268435456
 s_nop 7
 s_add_u32 s3, s55, 0
 buffer_store_dword v80, v4, s[4:7], s3 offen sc1
 s_add_u32 s3, s55, 2560
 buffer_store_dword v81, v4, s[4:7], s3 offen sc1
 s_add_u32 s3, s55, 5120
 buffer_store_dword v82, v4, s[4:7], s3 offen sc1
 s_add_u32 s3, s55, 7680
 buffer_store_dword v83, v4, s[4:7], s3 offen sc1
 s_add_u32 s3, s55, 20480
 buffer_store_dword v84, v4, s[4:7], s3 offen sc1
 s_add_u32 s3, s55, 23040
 buffer_store_dword v85, v4, s[4:7], s3 offen sc1
 s_add_u32 s3, s55, 25600
 buffer_store_dword v86, v4, s[4:7], s3 offen sc1
 s_add_u32 s3, s55, 28160
 buffer_store_dword v87, v4, s[4:7], s3 offen sc1
 s_add_u32 s3, s55, 40960
 buffer_store_dword v88, v4, s[4:7], s3 offen sc1
 s_add_u32 s3, s55, 43520
 buffer_store_dword v89, v4, s[4:7], s3 offen sc1
 s_add_u32 s3, s55, 46080
 buffer_store_dword v90, v4, s[4:7], s3 offen sc1
 s_add_u32 s3, s55, 48640
 buffer_store_dword v91, v4, s[4:7], s3 offen sc1
 s_add_u32 s3, s55, 61440
 buffer_store_dword v92, v4, s[4:7], s3 offen sc1
 s_add_u32 s3, s55, 64000
 buffer_store_dword v93, v4, s[4:7], s3 offen sc1
 s_add_u32 s3, s55, 66560
 buffer_store_dword v94, v4, s[4:7], s3 offen sc1
 s_add_u32 s3, s55, 69120
 buffer_store_dword v95, v4, s[4:7], s3 offen sc1
L_e_131:
 s_add_u32 s54, s54, 1
 s_branch L_wo_loop
L_t4:
 s_lshr_b32 s53, s50, 1
 s_and_b32 s54, s50, 1
 v_lshlrev_b32 v1, 4, v0
 v_mov_b32 v72, 0
 s_lshl_b32 s3, s50, 2
 s_add_u32 s3, s3, 163776
 v_mov_b32 v73, s3
 ds_write_b32 v73, v72
 s_cmp_lg_u32 s50, 0
 s_cbranch_scc1 L_ww_135
 s_mov_b32 s96, s44
 s_and_b32 s97, s45, 0xffff
 s_mov_b32 s98, 256
 s_mov_b32 s99, 0x00020000
 v_mov_b32 v12, 136
 s_mov_b32 s51, 0
 s_mov_b64 exec, 1
L_wb_136:
 buffer_load_dword v13, v12, s[96:99], 0 offen sc1
 s_waitcnt vmcnt(0)
 v_cmp_eq_u32 vcc, 0, v13
 s_cbranch_vccz L_wbd_137
 s_sleep 2
 s_add_u32 s51, s51, 1
 s_cmp_lt_u32 s51, 131072
 s_cbranch_scc1 L_wb_136
 s_branch L_bail
L_wbd_137:
 s_mov_b64 exec, -1
L_ww_135:
 s_barrier
 s_mul_i32 s55, s52, 40960
 s_mul_i32 s56, s50, 10240
 s_add_u32 s55, s55, s56
 s_add_u32 s55, s55, 234356736
 s_add_u32 m0, s56, 0
 s_add_u32 s3, s55, 0
 buffer_load_dwordx4 v1, s[4:7], s3 offen offset:0 sc1 lds
 buffer_load_dwordx4 v1, s[4:7], s3 offen offset:1024 sc1 lds
 s_add_u32 m0, s56, 2048
 s_add_u32 s3, s55, 2048
 buffer_load_dwordx4 v1, s[4:7], s3 offen offset:0 sc1 lds
 buffer_load_dwordx4 v1, s[4:7], s3 offen offset:1024 sc1 lds
 s_add_u32 m0, s56, 4096
 s_add_u32 s3, s55, 4096
 buffer_load_dwordx4 v1, s[4:7], s3 offen offset:0 sc1 lds
 buffer_load_dwordx4 v1, s[4:7], s3 offen offset:1024 sc1 lds
 s_add_u32 m0, s56, 6144
 s_add_u32 s3, s55, 6144
 buffer_load_dwordx4 v1, s[4:7], s3 offen offset:0 sc1 lds
 buffer_load_dwordx4 v1, s[4:7], s3 offen offset:1024 sc1 lds
 s_add_u32 m0, s56, 8192
 s_add_u32 s3, s55, 8192
 buffer_load_dwordx4 v1, s[4:7], s3 offen offset:0 sc1 lds
 buffer_load_dwordx4 v1, s[4:7], s3 offen offset:1024 sc1 lds
 s_waitcnt vmcnt(0) lgkmcnt(0)
 s_barrier
 s_cmp_eq_u32 s53, 0
 s_cbranch_scc1 L_e0_138
 s_lshl_b32 s60, s52, 1
 s_and_b32 s3, s50, 1
 s_add_u32 s60, s60, s3
 s_mul_i32 s71, s3, 13312
 s_add_u32 s71, s71, 131072
 s_add_u32 s72, s60, 1024
 s_mov_b32 s8, s16
 s_and_b32 s9, s17, 0xffff
 s_mov_b32 s10, 2621440
 s_mov_b32 s11, 0x00020000
 v_lshlrev_b32 v1, 4, v0
 v_lshlrev_b32 v2, 3, v0
 v_cmp_lt_u32 vcc, 31, v0
 v_mov_b32 v3, 268435456
 s_nop 1
 v_cndmask_b32 v7, v2, v3, vcc
 s_mov_b32 s63, 0x3acccccd
 s_mov_b32 s68, 0x3727c5ac
 s_add_u32 s3, s72, 0
 s_mul_i32 s3, s3, 1280
 buffer_load_dwordx2 v[48:49], v2, s[8:11], s3 offen offset:0
 buffer_load_dwordx2 v[50:51], v2, s[8:11], s3 offen offset:512
 buffer_load_dwordx2 v[52:53], v7, s[8:11], s3 offen offset:1024
 s_waitcnt vmcnt(0)
L_ln_139:
 v_lshlrev_b32 v12, 16, v48
 v_and_b32 v13, 0xffff0000, v48
 v_lshlrev_b32 v14, 16, v49
 v_and_b32 v15, 0xffff0000, v49
 v_lshlrev_b32 v16, 16, v50
 v_and_b32 v17, 0xffff0000, v50
 v_lshlrev_b32 v18, 16, v51
 v_and_b32 v19, 0xffff0000, v51
 v_lshlrev_b32 v20, 16, v52
 v_and_b32 v21, 0xffff0000, v52
 v_lshlrev_b32 v22, 16, v53
 v_and_b32 v23, 0xffff0000, v53
 s_add_u32 s3, s72, 64
 s_mul_i32 s3, s3, 1280
 buffer_load_dwordx2 v[48:49], v2, s[8:11], s3 offen offset:0
 buffer_load_dwordx2 v[50:51], v2, s[8:11], s3 offen offset:512
 buffer_load_dwordx2 v[52:53], v7, s[8:11], s3 offen offset:1024
 s_and_b32 s3, s72, 15
 v_lshrrev_b32 v4, 3, v0
 v_lshlrev_b32 v4, 2, v4
 v_and_b32 v9, 3, v0
 v_add_u32 v4, v4, v9
 v_xor_b32 v4, s3, v4
 v_lshlrev_b32 v4, 4, v4
 v_and_b32 v9, 4, v0
 v_lshl_add_u32 v4, v9, 1, v4
 v_cndmask_b32 v8, v4, v3, vcc
 v_readfirstlane_b32 s3, v12
 s_nop 1
 v_subrev_f32 v36, s3, v12
 v_subrev_f32 v37, s3, v13
 v_subrev_f32 v38, s3, v14
 v_subrev_f32 v39, s3, v15
 v_subrev_f32 v40, s3, v16
 v_subrev_f32 v41, s3, v17
 v_subrev_f32 v42, s3, v18
 v_subrev_f32 v43, s3, v19
 v_mov_b32 v44, 0
 v_mov_b32 v45, 0
 v_mov_b32 v46, 0
 v_mov_b32 v47, 0
 s_mov_b32 exec_hi, 0
 v_subrev_f32 v44, s3, v20
 v_subrev_f32 v45, s3, v21
 v_subrev_f32 v46, s3, v22
 v_subrev_f32 v47, s3, v23
 s_mov_b32 exec_hi, -1
 v_pk_mul_f32 v[10:11], v[36:37], v[36:37]
 v_pk_fma_f32 v[10:11], v[38:39], v[38:39], v[10:11]
 v_pk_fma_f32 v[10:11], v[40:41], v[40:41], v[10:11]
 v_pk_fma_f32 v[10:11], v[42:43], v[42:43], v[10:11]
 v_pk_fma_f32 v[10:11], v[44:45], v[44:45], v[10:11]
 v_pk_fma_f32 v[10:11], v[46:47], v[46:47], v[10:11]
 v_pk_add_f32 v[36:37], v[36:37], v[38:39]
 v_pk_add_f32 v[36:37], v[36:37], v[40:41]
 v_pk_add_f32 v[36:37], v[36:37], v[42:43]
 v_pk_add_f32 v[36:37], v[36:37], v[44:45]
 v_pk_add_f32 v[36:37], v[36:37], v[46:47]
 v_add_f32 v11, v10, v11
 v_add_f32 v10, v36, v37
 s_nop 0
 v_add_f32_dpp v11, v11, v11 quad_perm:[1,0,3,2] row_mask:0xf bank_mask:0xf
 v_add_f32_dpp v10, v10, v10 quad_perm:[1,0,3,2] row_mask:0xf bank_mask:0xf
 s_nop 0
 v_add_f32_dpp v11, v11, v11 quad_perm:[2,3,0,1] row_mask:0xf bank_mask:0xf
 v_add_f32_dpp v10, v10, v10 quad_perm:[2,3,0,1] row_mask:0xf bank_mask:0xf
 s_nop 0
 v_add_f32_dpp v11, v11, v11 row_half_mirror row_mask:0xf bank_mask:0xf
 v_add_f32_dpp v10, v10, v10 row_half_mirror row_mask:0xf bank_mask:0xf
 s_nop 0
 v_add_f32_dpp v11, v11, v11 row_mirror row_mask:0xf bank_mask:0xf
 v_add_f32_dpp v10, v10, v10 row_mirror row_mask:0xf bank_mask:0xf
 v_mov_b32 v37, v11
 v_mov_b32 v36, v10
 s_nop 0
 v_permlane16_swap_b32 v11, v37
 v_permlane16_swap_b32 v10, v36
 v_pk_add_f32 v[10:11], v[10:11], v[36:37]
 v_mov_b32 v37, v11
 v_mov_b32 v36, v10
 s_nop 0
 v_permlane32_swap_b32 v11, v37
 v_permlane32_swap_b32 v10, v36
 v_pk_add_f32 v[10:11], v[10:11], v[36:37]
 v_mul_f32 v10, s63, v10
 v_mul_f32 v11, s63, v11
 v_fma_f32 v11, -v10, v10, v11
 v_max_f32 v11, 0, v11
 v_add_f32 v10, s3, v10
 v_cvt_pk_bf16_f32 v9, v10, v11
 v_lshlrev_b32 v10, 16, v9
 v_and_b32 v11, 0xffff0000, v9
 v_add_f32 v11, s68, v11
 v_cvt_pk_bf16_f32 v11, v11, v11
 v_and_b32 v11, 0xffff0000, v11
 v_sqrt_f32 v11, v11
 s_nop 0
 v_pk_add_f32 v[36:37], v[12:13], v[10:11] op_sel_hi:[1,0] neg_lo:[0,1] neg_hi:[0,1]
 v_pk_add_f32 v[38:39], v[14:15], v[10:11] op_sel_hi:[1,0] neg_lo:[0,1] neg_hi:[0,1]
 v_pk_add_f32 v[40:41], v[16:17], v[10:11] op_sel_hi:[1,0] neg_lo:[0,1] neg_hi:[0,1]
 v_pk_add_f32 v[42:43], v[18:19], v[10:11] op_sel_hi:[1,0] neg_lo:[0,1] neg_hi:[0,1]
 v_pk_add_f32 v[44:45], v[20:21], v[10:11] op_sel_hi:[1,0] neg_lo:[0,1] neg_hi:[0,1]
 v_pk_add_f32 v[46:47], v[22:23], v[10:11] op_sel_hi:[1,0] neg_lo:[0,1] neg_hi:[0,1]
 v_cvt_pk_bf16_f32 v11, v11, v11
 v_and_b32 v11, 0xffff0000, v11
 v_rcp_f32 v11, v11
 v_cvt_pk_bf16_f32 v9, v36, v37
 v_lshlrev_b32 v36, 16, v9
 v_and_b32 v37, 0xffff0000, v9
 v_cvt_pk_bf16_f32 v9, v38, v39
 v_lshlrev_b32 v38, 16, v9
 v_and_b32 v39, 0xffff0000, v9
 v_cvt_pk_bf16_f32 v9, v40, v41
 v_lshlrev_b32 v40, 16, v9
 v_and_b32 v41, 0xffff0000, v9
 v_cvt_pk_bf16_f32 v9, v42, v43
 v_lshlrev_b32 v42, 16, v9
 v_and_b32 v43, 0xffff0000, v9
 v_cvt_pk_bf16_f32 v9, v44, v45
 v_lshlrev_b32 v44, 16, v9
 v_and_b32 v45, 0xffff0000, v9
 v_cvt_pk_bf16_f32 v9, v46, v47
 v_lshlrev_b32 v46, 16, v9
 v_and_b32 v47, 0xffff0000, v9
 v_pk_mul_f32 v[36:37], v[36:37], v[10:11] op_sel:[0,1] op_sel_hi:[1,1]
 v_pk_mul_f32 v[38:39], v[38:39], v[10:11] op_sel:[0,1] op_sel_hi:[1,1]
 v_pk_mul_f32 v[40:41], v[40:41], v[10:11] op_sel:[0,1] op_sel_hi:[1,1]
 v_pk_mul_f32 v[42:43], v[42:43], v[10:11] op_sel:[0,1] op_sel_hi:[1,1]
 v_pk_mul_f32 v[44:45], v[44:45], v[10:11] op_sel:[0,1] op_sel_hi:[1,1]
 v_pk_mul_f32 v[46:47], v[46:47], v[10:11] op_sel:[0,1] op_sel_hi:[1,1]
 v_cvt_pk_bf16_f32 v24, v36, v37
 v_cvt_pk_bf16_f32 v25, v38, v39
 v_cvt_pk_bf16_f32 v26, v40, v41
 v_cvt_pk_bf16_f32 v27, v42, v43
 v_cvt_pk_bf16_f32 v28, v44, v45
 v_cvt_pk_bf16_f32 v29, v46, v47
 s_mul_i32 s3, s72, 1280
 s_add_u32 s3, s3, 226492416
 buffer_store_dwordx2 v[24:25], v4, s[4:7], s3 offen offset:0 sc1
 buffer_store_dwordx2 v[26:27], v4, s[4:7], s3 offen offset:512 sc1
 buffer_store_dwordx2 v[28:29], v8, s[4:7], s3 offen offset:1024 sc1
 s_add_u32 s72, s72, 64
 s_waitcnt vmcnt(3)
 s_cmp_lt_u32 s72, 2048
 s_cbranch_scc1 L_ln_139
 s_waitcnt vmcnt(0)
 s_mov_b32 s96, s44
 s_and_b32 s97, s45, 0xffff
 s_mov_b32 s98, 256
 s_mov_b32 s99, 0x00020000
 v_mov_b32 v1, 1
 s_mov_b64 exec, 1
 buffer_atomic_add v1, off, s[96:99], 0 offset:12 sc0
 s_waitcnt vmcnt(0)
 v_cmp_eq_u32 vcc, 63, v1
 s_cbranch_vccz L_aw_140
 buffer_store_dword v1, off, s[96:99], 0 offset:140 sc1
L_aw_140:
 s_mov_b64 exec, -1
 s_mov_b32 s70, s60
 s_mov_b32 s69, 96
 s_mov_b32 s96, s44
 s_and_b32 s97, s45, 0xffff
 s_mov_b32 s98, 256
 s_mov_b32 s99, 0x00020000
 v_mov_b32 v1, 196
 s_mov_b32 s51, 0
 s_mov_b64 exec, 1
L_wb_141:
 buffer_load_dword v2, v1, s[96:99], 0 offen sc1
 s_waitcnt vmcnt(0)
 v_cmp_eq_u32 vcc, 0, v2
 s_cbranch_vccz L_wbd_142
 s_sleep 2
 s_add_u32 s51, s51, 1
 s_cmp_lt_u32 s51, 131072
 s_cbranch_scc1 L_wb_141
 s_branch L_bail
L_wbd_142:
 s_mov_b64 exec, -1
 s_mov_b32 s96, s44
 s_and_b32 s97, s45, 0xffff
 s_mov_b32 s98, 256
 s_mov_b32 s99, 0x00020000
 v_mov_b32 v1, 208
 s_mov_b32 s51, 0
 s_mov_b64 exec, 1
L_wb_143:
 buffer_load_dword v2, v1, s[96:99], 0 offen sc1
 s_waitcnt vmcnt(0)
 v_cmp_eq_u32 vcc, 0, v2
 s_cbranch_vccz L_wbd_144
 s_sleep 2
 s_add_u32 s51, s51, 1
 s_cmp_lt_u32 s51, 131072
 s_cbranch_scc1 L_wb_143
 s_branch L_bail
L_wbd_144:
 s_mov_b64 exec, -1
 s_mov_b32 s8, s38
 s_and_b32 s9, s39, 0xffff
 s_mov_b32 s10, 2621440
 s_mov_b32 s11, 0x00020000
 s_mov_b32 s12, s40
 s_and_b32 s13, s41, 0xffff
 s_mov_b32 s14, 1280
 s_mov_b32 s15, 0x00020000
 v_lshlrev_b32 v130, 4, v0
 s_lshl_b32 s73, s70, 12
 s_add_u32 s74, s73, 2
 buffer_load_dwordx4 v[96:99], v130, s[8:11], s73 offen offset:0
 buffer_load_dwordx4 v[100:103], v130, s[8:11], s73 offen offset:1024
 buffer_load_dwordx4 v[104:107], v130, s[8:11], s73 offen offset:2048
 buffer_load_dwordx4 v[108:111], v130, s[8:11], s73 offen offset:3072
 buffer_load_dwordx4 v[112:115], v130, s[8:11], s74 offen offset:0
 buffer_load_dwordx4 v[116:119], v130, s[8:11], s74 offen offset:1024
 buffer_load_dwordx4 v[120:123], v130, s[8:11], s74 offen offset:2048
 buffer_load_dwordx4 v[124:127], v130, s[8:11], s74 offen offset:3072
 s_lshl_b32 s3, s70, 1
 buffer_load_ushort v128, off, s[12:15], s3
 s_lshl_b32 s3, s70, 12
 s_add_u32 s3, s3, 231735296
 buffer_load_dwordx4 v[240:243], v130, s[4:7], s3 offen offset:0 sc1
 buffer_load_dwordx4 v[244:247], v130, s[4:7], s3 offen offset:1024 sc1
 buffer_load_dwordx4 v[248:251], v130, s[4:7], s3 offen offset:2048 sc1
 buffer_load_dwordx4 v[252:255], v130, s[4:7], s3 offen offset:3072 sc1
 s_getpc_b64 s[76:77]
L_ca_145:
 s_add_u32 s76, s76, L_conv1-L_ca_145
 s_addc_u32 s77, s77, -1
 s_swappc_b64 s[76:77], s[76:77]
 s_waitcnt vmcnt(0)
 s_mov_b32 s96, s44
 s_and_b32 s97, s45, 0xffff
 s_mov_b32 s98, 256
 s_mov_b32 s99, 0x00020000
 v_mov_b32 v1, 1
 s_mov_b64 exec, 1
 buffer_atomic_add v1, off, s[96:99], 0 offset:76 sc0
 s_waitcnt vmcnt(0)
 v_cmp_eq_u32 vcc, 95, v1
 s_cbranch_vccz L_aw_146
 buffer_store_dword v1, off, s[96:99], 0 offset:204 sc1
L_aw_146:
 s_mov_b64 exec, -1
 s_mov_b32 s96, s44
 s_and_b32 s97, s45, 0xffff
 s_mov_b32 s98, 256
 s_mov_b32 s99, 0x00020000
 v_mov_b32 v1, 204
 s_mov_b32 s51, 0
 s_mov_b64 exec, 1
L_wb_147:
 buffer_load_dword v2, v1, s[96:99], 0 offen sc1
 s_waitcnt vmcnt(0)
 v_cmp_eq_u32 vcc, 0, v2
 s_cbranch_vccz L_wbd_148
 s_sleep 2
 s_add_u32 s51, s51, 1
 s_cmp_lt_u32 s51, 131072
 s_cbranch_scc1 L_wb_147
 s_branch L_bail
L_wbd_148:
 s_mov_b64 exec, -1
 v_lshlrev_b32 v1, 4, v0
 s_mul_i32 s55, s52, 40960
 s_mul_i32 s56, s54, 20480
 s_add_u32 s55, s55, s56
 s_add_u32 s55, s55, 235667456
 s_add_u32 m0, s56, 40960
 s_add_u32 s3, s55, 0
 buffer_load_dwordx4 v1, s[4:7], s3 offen offset:0 sc1 lds
 buffer_load_dwordx4 v1, s[4:7], s3 offen offset:1024 sc1 lds
 s_add_u32 m0, s56, 43008
 s_add_u32 s3, s55, 2048
 buffer_load_dwordx4 v1, s[4:7], s3 offen offset:0 sc1 lds
 buffer_load_dwordx4 v1, s[4:7], s3 offen offset:1024 sc1 lds
 s_add_u32 m0, s56, 45056
 s_add_u32 s3, s55, 4096
 buffer_load_dwordx4 v1, s[4:7], s3 offen offset:0 sc1 lds
 buffer_load_dwordx4 v1, s[4:7], s3 offen offset:1024 sc1 lds
 s_add_u32 m0, s56, 47104
 s_add_u32 s3, s55, 6144
 buffer_load_dwordx4 v1, s[4:7], s3 offen offset:0 sc1 lds
 buffer_load_dwordx4 v1, s[4:7], s3 offen offset:1024 sc1 lds
 s_add_u32 m0, s56, 49152
 s_add_u32 s3, s55, 8192
 buffer_load_dwordx4 v1, s[4:7], s3 offen offset:0 sc1 lds
 buffer_load_dwordx4 v1, s[4:7], s3 offen offset:1024 sc1 lds
 s_add_u32 m0, s56, 51200
 s_add_u32 s3, s55, 10240
 buffer_load_dwordx4 v1, s[4:7], s3 offen offset:0 sc1 lds
 buffer_load_dwordx4 v1, s[4:7], s3 offen offset:1024 sc1 lds
 s_add_u32 m0, s56, 53248
 s_add_u32 s3, s55, 12288
 buffer_load_dwordx4 v1, s[4:7], s3 offen offset:0 sc1 lds
 buffer_load_dwordx4 v1, s[4:7], s3 offen offset:1024 sc1 lds
 s_add_u32 m0, s56, 55296
 s_add_u32 s3, s55, 14336
 buffer_load_dwordx4 v1, s[4:7], s3 offen offset:0 sc1 lds
 buffer_load_dwordx4 v1, s[4:7], s3 offen offset:1024 sc1 lds
 s_add_u32 m0, s56, 57344
 s_add_u32 s3, s55, 16384
 buffer_load_dwordx4 v1, s[4:7], s3 offen offset:0 sc1 lds
 buffer_load_dwordx4 v1, s[4:7], s3 offen offset:1024 sc1 lds
 s_add_u32 m0, s56, 59392
 s_add_u32 s3, s55, 18432
 buffer_load_dwordx4 v1, s[4:7], s3 offen offset:0 sc1 lds
 buffer_load_dwordx4 v1, s[4:7], s3 offen offset:1024 sc1 lds
 s_waitcnt vmcnt(0) lgkmcnt(0)
 s_lshl_b32 s3, s50, 2
 s_add_u32 s3, s3, 163776
 v_mov_b32 v73, s3
 v_mov_b32 v72, 1
 ds_write_b32 v73, v72
L_e0_138:
 s_lshl_b32 s3, s54, 2
 s_add_u32 s3, s3, 163776
 v_mov_b32 v73, s3
 s_mov_b32 s8, s16
 s_and_b32 s9, s17, 0xffff
 s_mov_b32 s10, 2621440
 s_mov_b32 s11, 0x00020000
 s_mov_b32 s12, s42
 s_and_b32 s13, s43, 0xffff
 s_mov_b32 s14, 2621440
 s_mov_b32 s15, 0x00020000
 v_lshlrev_b32 v1, 4, v0
 v_lshlrev_b32 v2, 3, v0
 v_cmp_lt_u32 vcc, 31, v0
 v_mov_b32 v3, 268435456
 s_nop 1
 v_cndmask_b32 v6, v1, v3, vcc
 v_cndmask_b32 v7, v2, v3, vcc
 s_and_b32 s3, s52, 15
 v_lshrrev_b32 v4, 3, v0
 v_lshlrev_b32 v4, 2, v4
 v_and_b32 v10, 3, v0
 v_add_u32 v4, v4, v10
 v_xor_b32 v4, s3, v4
 v_lshlrev_b32 v4, 4, v4
 v_and_b32 v10, 4, v0
 v_lshl_add_u32 v4, v10, 1, v4
 v_cndmask_b32 v8, v4, v3, vcc
 s_lshl_b32 s3, s52, 9
 s_lshl_b32 s55, s53, 8
 s_add_u32 s3, s3, s55
 s_add_u32 s3, s3, 61440
 v_mul_u32_u24 v5, 16384, v0
 v_add_u32 v5, s3, v5
 s_sub_u32 s3, s3, 4
 v_writelane_b32 v5, s3, 4
 v_lshlrev_b32 v68, 8, v0
 s_mov_b32 s57, 0x3acccccd
 s_mov_b32 s58, 0x3727c5ac
L_t4_loop:
 s_lshl_b32 s60, s54, 5
 s_add_u32 s60, s60, s52
 s_mul_i32 s60, s60, 1280
 s_cmp_eq_u32 s53, 0
 s_cselect_b32 s3, s60, 268435456
 buffer_load_dwordx2 v[48:49], v2, s[8:11], s3 offen offset:0
 buffer_load_dwordx2 v[50:51], v2, s[8:11], s3 offen offset:512
 buffer_load_dwordx2 v[52:53], v7, s[8:11], s3 offen offset:1024
 s_and_b32 s3, s54, 62
 s_cmp_lg_u32 s3, 32
 s_cbranch_scc1 L_yhd_150
 v_mov_b32 v3, 163784
 s_mov_b32 s51, 0
L_yh_149:
 ds_read_b64 v[24:25], v3
 s_waitcnt lgkmcnt(0)
 v_and_b32 v24, v24, v25
 v_cmp_eq_u32 vcc, 0, v24
 s_cbranch_vccz L_yhd_150
 s_sleep 8
 s_add_u32 s51, s51, 1
 s_cmp_lt_u32 s51, 131072
 s_cbranch_scc1 L_yh_149
 s_branch L_bail
L_yhd_150:
 s_and_b32 s3, s54, 7
 s_lshl_b32 s3, s3, 3
 s_bfe_u32 s55, s54, 0x20003
 s_lshl_b32 s55, s55, 1
 s_add_u32 s3, s3, s55
 s_lshr_b32 s55, s54, 5
 s_mul_i32 s55, s55, 40960
 s_add_u32 s3, s3, s55
 v_lshlrev_b32 v72, 8, v0
 v_add_u32 v72, s3, v72
 ds_read_u16 v24, v72 offset:0
 ds_read_u16 v25, v72 offset:64
 ds_read_u16 v26, v72 offset:128
 ds_read_u16 v27, v72 offset:192
 ds_read_u16 v28, v72 offset:16384
 ds_read_u16 v29, v72 offset:16448
 ds_read_u16 v30, v72 offset:16512
 ds_read_u16 v31, v72 offset:16576
 v_mov_b32 v32, 0
 v_mov_b32 v33, 0
 v_mov_b32 v34, 0
 v_mov_b32 v35, 0
 s_mov_b32 exec_hi, 0
 ds_read_u16 v32, v72 offset:32768
 ds_read_u16 v33, v72 offset:32832
 ds_read_u16 v34, v72 offset:32896
 ds_read_u16 v35, v72 offset:32960
 s_mov_b32 exec_hi, -1
 s_waitcnt vmcnt(0) lgkmcnt(0)
 v_lshlrev_b32 v24, 16, v24
 v_lshlrev_b32 v25, 16, v25
 v_lshlrev_b32 v26, 16, v26
 v_lshlrev_b32 v27, 16, v27
 v_lshlrev_b32 v28, 16, v28
 v_lshlrev_b32 v29, 16, v29
 v_lshlrev_b32 v30, 16, v30
 v_lshlrev_b32 v31, 16, v31
 v_lshlrev_b32 v32, 16, v32
 v_lshlrev_b32 v33, 16, v33
 v_lshlrev_b32 v34, 16, v34
 v_lshlrev_b32 v35, 16, v35
 v_lshlrev_b32 v12, 16, v48
 v_and_b32 v13, 0xffff0000, v48
 v_lshlrev_b32 v14, 16, v49
 v_and_b32 v15, 0xffff0000, v49
 v_lshlrev_b32 v16, 16, v50
 v_and_b32 v17, 0xffff0000, v50
 v_lshlrev_b32 v18, 16, v51
 v_and_b32 v19, 0xffff0000, v51
 v_lshlrev_b32 v20, 16, v52
 v_and_b32 v21, 0xffff0000, v52
 v_lshlrev_b32 v22, 16, v53
 v_and_b32 v23, 0xffff0000, v53
 s_lshl_b32 s55, s54, 2
 s_mov_b32 s51, 0
 s_mov_b64 exec, 31
L_tw_151:
 v_mov_b32 v3, 0
 buffer_atomic_add v3, v5, s[4:7], s55 offen sc0
 s_waitcnt vmcnt(0)
 v_cmp_gt_u32 vcc, 10, v3
 s_and_b32 s3, vcc_lo, 15
 s_cbranch_scc0 L_twd_152
 s_bitcmp0_b32 vcc_lo, 4
 s_cbranch_scc1 L_twf_153
 s_cmp_eq_u32 s54, 0
 s_cbranch_scc1 L_twf_153
 s_sleep 24
L_twf_153:
 s_sleep 8
 s_add_u32 s51, s51, 1
 s_cmp_lt_u32 s51, 131072
 s_cbranch_scc1 L_tw_151
 s_branch L_bail
L_twd_152:
 s_mov_b64 exec, -1
 s_lshl_b32 s55, s53, 6
 s_add_u32 s55, s55, s54
 s_mul_i32 s55, s55, 655360
 s_mul_i32 s3, s52, 2560
 s_add_u32 s55, s55, s3
 s_add_u32 s55, s55, 142606336
 buffer_load_dwordx4 v[80:83], v1, s[4:7], s55 offen offset:0 sc1 nt
 buffer_load_dwordx4 v[84:87], v1, s[4:7], s55 offen offset:1024 sc1 nt
 buffer_load_dwordx4 v[88:91], v6, s[4:7], s55 offen offset:2048 sc1 nt
 s_add_u32 s55, s55, 81920
 buffer_load_dwordx4 v[92:95], v1, s[4:7], s55 offen offset:0 sc1 nt
 buffer_load_dwordx4 v[96:99], v1, s[4:7], s55 offen offset:1024 sc1 nt
 buffer_load_dwordx4 v[100:103], v6, s[4:7], s55 offen offset:2048 sc1 nt
 s_add_u32 s55, s55, 81920
 buffer_load_dwordx4 v[104:107], v1, s[4:7], s55 offen offset:0 sc1 nt
 buffer_load_dwordx4 v[108:111], v1, s[4:7], s55 offen offset:1024 sc1 nt
 buffer_load_dwordx4 v[112:115], v6, s[4:7], s55 offen offset:2048 sc1 nt
 s_add_u32 s55, s55, 81920
 buffer_load_dwordx4 v[116:119], v1, s[4:7], s55 offen offset:0 sc1 nt
 buffer_load_dwordx4 v[120:123], v1, s[4:7], s55 offen offset:1024 sc1 nt
 buffer_load_dwordx4 v[124:127], v6, s[4:7], s55 offen offset:2048 sc1 nt
 s_add_u32 s55, s55, 81920
 buffer_load_dwordx4 v[128:131], v1, s[4:7], s55 offen offset:0 sc1 nt
 buffer_load_dwordx4 v[132:135], v1, s[4:7], s55 offen offset:1024 sc1 nt
 buffer_load_dwordx4 v[136:139], v6, s[4:7], s55 offen offset:2048 sc1 nt
 s_add_u32 s55, s55, 81920
 buffer_load_dwordx4 v[140:143], v1, s[4:7], s55 offen offset:0 sc1 nt
 buffer_load_dwordx4 v[144:147], v1, s[4:7], s55 offen offset:1024 sc1 nt
 buffer_load_dwordx4 v[148:151], v6, s[4:7], s55 offen offset:2048 sc1 nt
 s_add_u32 s55, s55, 81920
 buffer_load_dwordx4 v[152:155], v1, s[4:7], s55 offen offset:0 sc1 nt
 buffer_load_dwordx4 v[156:159], v1, s[4:7], s55 offen offset:1024 sc1 nt
 buffer_load_dwordx4 v[160:163], v6, s[4:7], s55 offen offset:2048 sc1 nt
 s_add_u32 s55, s55, 81920
 buffer_load_dwordx4 v[164:167], v1, s[4:7], s55 offen offset:0 sc1 nt
 buffer_load_dwordx4 v[168:171], v1, s[4:7], s55 offen offset:1024 sc1 nt
 buffer_load_dwordx4 v[172:175], v6, s[4:7], s55 offen offset:2048 sc1 nt
 s_add_u32 s55, s55, 81920
 s_and_b32 s56, s54, 31
 s_mul_i32 s56, s56, 1536
 s_add_u32 s56, s56, 81920
 v_add_u32 v3, s56, v2
 s_cmp_eq_u32 s53, 0
 s_cbranch_scc1 L_l0_154
 ds_read_b64 v[48:49], v3 offset:0
 ds_read_b64 v[50:51], v3 offset:512
 ds_read_b64 v[52:53], v3 offset:1024
 s_waitcnt lgkmcnt(0)
 v_lshlrev_b32 v12, 16, v48
 v_and_b32 v13, 0xffff0000, v48
 v_lshlrev_b32 v14, 16, v49
 v_and_b32 v15, 0xffff0000, v49
 v_lshlrev_b32 v16, 16, v50
 v_and_b32 v17, 0xffff0000, v50
 v_lshlrev_b32 v18, 16, v51
 v_and_b32 v19, 0xffff0000, v51
 v_lshlrev_b32 v20, 16, v52
 v_and_b32 v21, 0xffff0000, v52
 v_lshlrev_b32 v22, 16, v53
 v_and_b32 v23, 0xffff0000, v53
 s_add_u32 s3, s54, 1
 v_mov_b32 v10, s3
 ds_write_b32 v73, v10
L_l0_154:
 s_waitcnt vmcnt(18)
 v_pk_add_f32 v[80:81], v[80:81], v[92:93]
 v_pk_add_f32 v[82:83], v[82:83], v[94:95]
 v_pk_add_f32 v[84:85], v[84:85], v[96:97]
 v_pk_add_f32 v[86:87], v[86:87], v[98:99]
 v_pk_add_f32 v[88:89], v[88:89], v[100:101]
 v_pk_add_f32 v[90:91], v[90:91], v[102:103]
 s_waitcnt vmcnt(15)
 v_pk_add_f32 v[80:81], v[80:81], v[104:105]
 v_pk_add_f32 v[82:83], v[82:83], v[106:107]
 v_pk_add_f32 v[84:85], v[84:85], v[108:109]
 v_pk_add_f32 v[86:87], v[86:87], v[110:111]
 v_pk_add_f32 v[88:89], v[88:89], v[112:113]
 v_pk_add_f32 v[90:91], v[90:91], v[114:115]
 s_waitcnt vmcnt(12)
 v_pk_add_f32 v[80:81], v[80:81], v[116:117]
 v_pk_add_f32 v[82:83], v[82:83], v[118:119]
 v_pk_add_f32 v[84:85], v[84:85], v[120:121]
 v_pk_add_f32 v[86:87], v[86:87], v[122:123]
 v_pk_add_f32 v[88:89], v[88:89], v[124:125]
 v_pk_add_f32 v[90:91], v[90:91], v[126:127]
 s_waitcnt vmcnt(9)
 v_pk_add_f32 v[80:81], v[80:81], v[128:129]
 v_pk_add_f32 v[82:83], v[82:83], v[130:131]
 v_pk_add_f32 v[84:85], v[84:85], v[132:133]
 v_pk_add_f32 v[86:87], v[86:87], v[134:135]
 v_pk_add_f32 v[88:89], v[88:89], v[136:137]
 v_pk_add_f32 v[90:91], v[90:91], v[138:139]
 s_waitcnt vmcnt(6)
 v_pk_add_f32 v[80:81], v[80:81], v[140:141]
 v_pk_add_f32 v[82:83], v[82:83], v[142:143]
 v_pk_add_f32 v[84:85], v[84:85], v[144:145]
 v_pk_add_f32 v[86:87], v[86:87], v[146:147]
 v_pk_add_f32 v[88:89], v[88:89], v[148:149]
 v_pk_add_f32 v[90:91], v[90:91], v[150:151]
 s_waitcnt vmcnt(3)
 v_pk_add_f32 v[80:81], v[80:81], v[152:153]
 v_pk_add_f32 v[82:83], v[82:83], v[154:155]
 v_pk_add_f32 v[84:85], v[84:85], v[156:157]
 v_pk_add_f32 v[86:87], v[86:87], v[158:159]
 v_pk_add_f32 v[88:89], v[88:89], v[160:161]
 v_pk_add_f32 v[90:91], v[90:91], v[162:163]
 s_waitcnt vmcnt(0)
 v_pk_add_f32 v[80:81], v[80:81], v[164:165]
 v_pk_add_f32 v[82:83], v[82:83], v[166:167]
 v_pk_add_f32 v[84:85], v[84:85], v[168:169]
 v_pk_add_f32 v[86:87], v[86:87], v[170:171]
 v_pk_add_f32 v[88:89], v[88:89], v[172:173]
 v_pk_add_f32 v[90:91], v[90:91], v[174:175]
 v_cvt_pk_bf16_f32 v9, v80, v81
 v_lshlrev_b32 v80, 16, v9
 v_and_b32 v81, 0xffff0000, v9
 v_cvt_pk_bf16_f32 v9, v82, v83
 v_lshlrev_b32 v82, 16, v9
 v_and_b32 v83, 0xffff0000, v9
 v_cvt_pk_bf16_f32 v9, v84, v85
 v_lshlrev_b32 v84, 16, v9
 v_and_b32 v85, 0xffff0000, v9
 v_cvt_pk_bf16_f32 v9, v86, v87
 v_lshlrev_b32 v86, 16, v9
 v_and_b32 v87, 0xffff0000, v9
 v_cvt_pk_bf16_f32 v9, v88, v89
 v_lshlrev_b32 v88, 16, v9
 v_and_b32 v89, 0xffff0000, v9
 v_cvt_pk_bf16_f32 v9, v90, v91
 v_lshlrev_b32 v90, 16, v9
 v_and_b32 v91, 0xffff0000, v9
 v_pk_add_f32 v[12:13], v[12:13], v[80:81]
 v_pk_add_f32 v[14:15], v[14:15], v[82:83]
 v_pk_add_f32 v[16:17], v[16:17], v[84:85]
 v_pk_add_f32 v[18:19], v[18:19], v[86:87]
 v_pk_add_f32 v[20:21], v[20:21], v[88:89]
 v_pk_add_f32 v[22:23], v[22:23], v[90:91]
 v_cvt_pk_bf16_f32 v9, v12, v13
 v_lshlrev_b32 v12, 16, v9
 v_and_b32 v13, 0xffff0000, v9
 v_cvt_pk_bf16_f32 v9, v14, v15
 v_lshlrev_b32 v14, 16, v9
 v_and_b32 v15, 0xffff0000, v9
 v_cvt_pk_bf16_f32 v9, v16, v17
 v_lshlrev_b32 v16, 16, v9
 v_and_b32 v17, 0xffff0000, v9
 v_cvt_pk_bf16_f32 v9, v18, v19
 v_lshlrev_b32 v18, 16, v9
 v_and_b32 v19, 0xffff0000, v9
 v_cvt_pk_bf16_f32 v9, v20, v21
 v_lshlrev_b32 v20, 16, v9
 v_and_b32 v21, 0xffff0000, v9
 v_cvt_pk_bf16_f32 v9, v22, v23
 v_lshlrev_b32 v22, 16, v9
 v_and_b32 v23, 0xffff0000, v9
 v_readfirstlane_b32 s3, v12
 s_nop 1
 v_subrev_f32 v36, s3, v12
 v_subrev_f32 v37, s3, v13
 v_subrev_f32 v38, s3, v14
 v_subrev_f32 v39, s3, v15
 v_subrev_f32 v40, s3, v16
 v_subrev_f32 v41, s3, v17
 v_subrev_f32 v42, s3, v18
 v_subrev_f32 v43, s3, v19
 v_mov_b32 v44, 0
 v_mov_b32 v45, 0
 v_mov_b32 v46, 0
 v_mov_b32 v47, 0
 s_mov_b32 exec_hi, 0
 v_subrev_f32 v44, s3, v20
 v_subrev_f32 v45, s3, v21
 v_subrev_f32 v46, s3, v22
 v_subrev_f32 v47, s3, v23
 s_mov_b32 exec_hi, -1
 v_pk_mul_f32 v[10:11], v[36:37], v[36:37]
 v_pk_fma_f32 v[10:11], v[38:39], v[38:39], v[10:11]
 v_pk_fma_f32 v[10:11], v[40:41], v[40:41], v[10:11]
 v_pk_fma_f32 v[10:11], v[42:43], v[42:43], v[10:11]
 v_pk_fma_f32 v[10:11], v[44:45], v[44:45], v[10:11]
 v_pk_fma_f32 v[10:11], v[46:47], v[46:47], v[10:11]
 v_pk_add_f32 v[36:37], v[36:37], v[38:39]
 v_pk_add_f32 v[36:37], v[36:37], v[40:41]
 v_pk_add_f32 v[36:37], v[36:37], v[42:43]
 v_pk_add_f32 v[36:37], v[36:37], v[44:45]
 v_pk_add_f32 v[36:37], v[36:37], v[46:47]
 v_add_f32 v11, v10, v11
 v_add_f32 v10, v36, v37
 s_nop 0
 v_add_f32_dpp v11, v11, v11 quad_perm:[1,0,3,2] row_mask:0xf bank_mask:0xf
 v_add_f32_dpp v10, v10, v10 quad_perm:[1,0,3,2] row_mask:0xf bank_mask:0xf
 s_nop 0
 v_add_f32_dpp v11, v11, v11 quad_perm:[2,3,0,1] row_mask:0xf bank_mask:0xf
 v_add_f32_dpp v10, v10, v10 quad_perm:[2,3,0,1] row_mask:0xf bank_mask:0xf
 s_nop 0
 v_add_f32_dpp v11, v11, v11 row_half_mirror row_mask:0xf bank_mask:0xf
 v_add_f32_dpp v10, v10, v10 row_half_mirror row_mask:0xf bank_mask:0xf
 s_nop 0
 v_add_f32_dpp v11, v11, v11 row_mirror row_mask:0xf bank_mask:0xf
 v_add_f32_dpp v10, v10, v10 row_mirror row_mask:0xf bank_mask:0xf
 v_mov_b32 v37, v11
 v_mov_b32 v36, v10
 s_nop 0
 v_permlane16_swap_b32 v11, v37
 v_permlane16_swap_b32 v10, v36
 v_pk_add_f32 v[10:11], v[10:11], v[36:37]
 v_mov_b32 v37, v11
 v_mov_b32 v36, v10
 s_nop 0
 v_permlane32_swap_b32 v11, v37
 v_permlane32_swap_b32 v10, v36
 v_pk_add_f32 v[10:11], v[10:11], v[36:37]
 v_mul_f32 v10, s57, v10
 v_mul_f32 v11, s57, v11
 v_fma_f32 v11, -v10, v10, v11
 v_max_f32 v11, 0, v11
 v_add_f32 v10, s3, v10
 v_cvt_pk_bf16_f32 v9, v10, v11
 v_lshlrev_b32 v10, 16, v9
 v_and_b32 v11, 0xffff0000, v9
 v_add_f32 v11, s58, v11
 v_cvt_pk_bf16_f32 v11, v11, v11
 v_and_b32 v11, 0xffff0000, v11
 v_sqrt_f32 v11, v11
 s_nop 0
 v_pk_add_f32 v[36:37], v[12:13], v[10:11] op_sel_hi:[1,0] neg_lo:[0,1] neg_hi:[0,1]
 v_pk_add_f32 v[38:39], v[14:15], v[10:11] op_sel_hi:[1,0] neg_lo:[0,1] neg_hi:[0,1]
 v_pk_add_f32 v[40:41], v[16:17], v[10:11] op_sel_hi:[1,0] neg_lo:[0,1] neg_hi:[0,1]
 v_pk_add_f32 v[42:43], v[18:19], v[10:11] op_sel_hi:[1,0] neg_lo:[0,1] neg_hi:[0,1]
 v_pk_add_f32 v[44:45], v[20:21], v[10:11] op_sel_hi:[1,0] neg_lo:[0,1] neg_hi:[0,1]
 v_pk_add_f32 v[46:47], v[22:23], v[10:11] op_sel_hi:[1,0] neg_lo:[0,1] neg_hi:[0,1]
 v_cvt_pk_bf16_f32 v11, v11, v11
 v_and_b32 v11, 0xffff0000, v11
 v_rcp_f32 v11, v11
 v_cvt_pk_bf16_f32 v9, v36, v37
 v_lshlrev_b32 v36, 16, v9
 v_and_b32 v37, 0xffff0000, v9
 v_cvt_pk_bf16_f32 v9, v38, v39
 v_lshlrev_b32 v38, 16, v9
 v_and_b32 v39, 0xffff0000, v9
 v_cvt_pk_bf16_f32 v9, v40, v41
 v_lshlrev_b32 v40, 16, v9
 v_and_b32 v41, 0xffff0000, v9
 v_cvt_pk_bf16_f32 v9, v42, v43
 v_lshlrev_b32 v42, 16, v9
 v_and_b32 v43, 0xffff0000, v9
 v_cvt_pk_bf16_f32 v9, v44, v45
 v_lshlrev_b32 v44, 16, v9
 v_and_b32 v45, 0xffff0000, v9
 v_cvt_pk_bf16_f32 v9, v46, v47
 v_lshlrev_b32 v46, 16, v9
 v_and_b32 v47, 0xffff0000, v9
 v_pk_mul_f32 v[36:37], v[36:37], v[10:11] op_sel:[0,1] op_sel_hi:[1,1]
 v_pk_mul_f32 v[38:39], v[38:39], v[10:11] op_sel:[0,1] op_sel_hi:[1,1]
 v_pk_mul_f32 v[40:41], v[40:41], v[10:11] op_sel:[0,1] op_sel_hi:[1,1]
 v_pk_mul_f32 v[42:43], v[42:43], v[10:11] op_sel:[0,1] op_sel_hi:[1,1]
 v_pk_mul_f32 v[44:45], v[44:45], v[10:11] op_sel:[0,1] op_sel_hi:[1,1]
 v_pk_mul_f32 v[46:47], v[46:47], v[10:11] op_sel:[0,1] op_sel_hi:[1,1]
 v_cvt_pk_bf16_f32 v9, v36, v37
 v_lshlrev_b32 v36, 16, v9
 v_and_b32 v37, 0xffff0000, v9
 v_cvt_pk_bf16_f32 v9, v38, v39
 v_lshlrev_b32 v38, 16, v9
 v_and_b32 v39, 0xffff0000, v9
 v_cvt_pk_bf16_f32 v9, v40, v41
 v_lshlrev_b32 v40, 16, v9
 v_and_b32 v41, 0xffff0000, v9
 v_cvt_pk_bf16_f32 v9, v42, v43
 v_lshlrev_b32 v42, 16, v9
 v_and_b32 v43, 0xffff0000, v9
 v_cvt_pk_bf16_f32 v9, v44, v45
 v_lshlrev_b32 v44, 16, v9
 v_and_b32 v45, 0xffff0000, v9
 v_cvt_pk_bf16_f32 v9, v46, v47
 v_lshlrev_b32 v46, 16, v9
 v_and_b32 v47, 0xffff0000, v9
 v_pk_mul_f32 v[36:37], v[36:37], v[24:25]
 v_pk_mul_f32 v[38:39], v[38:39], v[26:27]
 v_pk_mul_f32 v[40:41], v[40:41], v[28:29]
 v_pk_mul_f32 v[42:43], v[42:43], v[30:31]
 v_pk_mul_f32 v[44:45], v[44:45], v[32:33]
 v_pk_mul_f32 v[46:47], v[46:47], v[34:35]
 v_cvt_pk_bf16_f32 v9, v36, v37
 v_lshlrev_b32 v36, 16, v9
 v_and_b32 v37, 0xffff0000, v9
 v_cvt_pk_bf16_f32 v9, v38, v39
 v_lshlrev_b32 v38, 16, v9
 v_and_b32 v39, 0xffff0000, v9
 v_cvt_pk_bf16_f32 v9, v40, v41
 v_lshlrev_b32 v40, 16, v9
 v_and_b32 v41, 0xffff0000, v9
 v_cvt_pk_bf16_f32 v9, v42, v43
 v_lshlrev_b32 v42, 16, v9
 v_and_b32 v43, 0xffff0000, v9
 v_cvt_pk_bf16_f32 v9, v44, v45
 v_lshlrev_b32 v44, 16, v9
 v_and_b32 v45, 0xffff0000, v9
 v_cvt_pk_bf16_f32 v9, v46, v47
 v_lshlrev_b32 v46, 16, v9
 v_and_b32 v47, 0xffff0000, v9
 v_pk_add_f32 v[12:13], v[12:13], v[36:37]
 v_pk_add_f32 v[14:15], v[14:15], v[38:39]
 v_pk_add_f32 v[16:17], v[16:17], v[40:41]
 v_pk_add_f32 v[18:19], v[18:19], v[42:43]
 v_pk_add_f32 v[20:21], v[20:21], v[44:45]
 v_pk_add_f32 v[22:23], v[22:23], v[46:47]
 v_cvt_pk_bf16_f32 v60, v12, v13
 v_cvt_pk_bf16_f32 v61, v14, v15
 v_cvt_pk_bf16_f32 v62, v16, v17
 v_cvt_pk_bf16_f32 v63, v18, v19
 v_cvt_pk_bf16_f32 v64, v20, v21
 v_cvt_pk_bf16_f32 v65, v22, v23
 s_cmp_lg_u32 s53, 0
 s_cbranch_scc1 L_l1_155
 s_cmp_lt_u32 s54, 32
 s_cbranch_scc1 L_rgd_158
 s_sub_u32 s55, s54, 31
 s_mov_b32 s51, 0
L_rg_157:
 ds_read_b32 v10, v73
 s_waitcnt lgkmcnt(0)
 v_cmp_gt_u32 vcc, s55, v10
 s_cbranch_vccz L_rgd_158
 s_sleep 8
 s_add_u32 s51, s51, 1
 s_cmp_lt_u32 s51, 131072
 s_cbranch_scc1 L_rg_157
 s_branch L_bail
L_rgd_158:
 ds_write_b64 v3, v[60:61] offset:0
 ds_write_b64 v3, v[62:63] offset:512
 ds_write_b64 v3, v[64:65] offset:1024
 v_lshlrev_b32 v12, 16, v60
 v_and_b32 v13, 0xffff0000, v60
 v_lshlrev_b32 v14, 16, v61
 v_and_b32 v15, 0xffff0000, v61
 v_lshlrev_b32 v16, 16, v62
 v_and_b32 v17, 0xffff0000, v62
 v_lshlrev_b32 v18, 16, v63
 v_and_b32 v19, 0xffff0000, v63
 v_lshlrev_b32 v20, 16, v64
 v_and_b32 v21, 0xffff0000, v64
 v_lshlrev_b32 v22, 16, v65
 v_and_b32 v23, 0xffff0000, v65
 s_nop 0
 v_readfirstlane_b32 s3, v12
 s_nop 1
 v_subrev_f32 v36, s3, v12
 v_subrev_f32 v37, s3, v13
 v_subrev_f32 v38, s3, v14
 v_subrev_f32 v39, s3, v15
 v_subrev_f32 v40, s3, v16
 v_subrev_f32 v41, s3, v17
 v_subrev_f32 v42, s3, v18
 v_subrev_f32 v43, s3, v19
 v_mov_b32 v44, 0
 v_mov_b32 v45, 0
 v_mov_b32 v46, 0
 v_mov_b32 v47, 0
 s_mov_b32 exec_hi, 0
 v_subrev_f32 v44, s3, v20
 v_subrev_f32 v45, s3, v21
 v_subrev_f32 v46, s3, v22
 v_subrev_f32 v47, s3, v23
 s_mov_b32 exec_hi, -1
 v_pk_mul_f32 v[10:11], v[36:37], v[36:37]
 v_pk_fma_f32 v[10:11], v[38:39], v[38:39], v[10:11]
 v_pk_fma_f32 v[10:11], v[40:41], v[40:41], v[10:11]
 v_pk_fma_f32 v[10:11], v[42:43], v[42:43], v[10:11]
 v_pk_fma_f32 v[10:11], v[44:45], v[44:45], v[10:11]
 v_pk_fma_f32 v[10:11], v[46:47], v[46:47], v[10:11]
 v_pk_add_f32 v[36:37], v[36:37], v[38:39]
 v_pk_add_f32 v[36:37], v[36:37], v[40:41]
 v_pk_add_f32 v[36:37], v[36:37], v[42:43]
 v_pk_add_f32 v[36:37], v[36:37], v[44:45]
 v_pk_add_f32 v[36:37], v[36:37], v[46:47]
 v_add_f32 v11, v10, v11
 v_add_f32 v10, v36, v37
 s_nop 0
 v_add_f32_dpp v11, v11, v11 quad_perm:[1,0,3,2] row_mask:0xf bank_mask:0xf
 v_add_f32_dpp v10, v10, v10 quad_perm:[1,0,3,2] row_mask:0xf bank_mask:0xf
 s_nop 0
 v_add_f32_dpp v11, v11, v11 quad_perm:[2,3,0,1] row_mask:0xf bank_mask:0xf
 v_add_f32_dpp v10, v10, v10 quad_perm:[2,3,0,1] row_mask:0xf bank_mask:0xf
 s_nop 0
 v_add_f32_dpp v11, v11, v11 row_half_mirror row_mask:0xf bank_mask:0xf
 v_add_f32_dpp v10, v10, v10 row_half_mirror row_mask:0xf bank_mask:0xf
 s_nop 0
 v_add_f32_dpp v11, v11, v11 row_mirror row_mask:0xf bank_mask:0xf
 v_add_f32_dpp v10, v10, v10 row_mirror row_mask:0xf bank_mask:0xf
 v_mov_b32 v37, v11
 v_mov_b32 v36, v10
 s_nop 0
 v_permlane16_swap_b32 v11, v37
 v_permlane16_swap_b32 v10, v36
 v_pk_add_f32 v[10:11], v[10:11], v[36:37]
 v_mov_b32 v37, v11
 v_mov_b32 v36, v10
 s_nop 0
 v_permlane32_swap_b32 v11, v37
 v_permlane32_swap_b32 v10, v36
 v_pk_add_f32 v[10:11], v[10:11], v[36:37]
 v_mul_f32 v10, s57, v10
 v_mul_f32 v11, s57, v11
 v_fma_f32 v11, -v10, v10, v11
 v_max_f32 v11, 0, v11
 v_add_f32 v10, s3, v10
 v_cvt_pk_bf16_f32 v9, v10, v11
 v_lshlrev_b32 v10, 16, v9
 v_and_b32 v11, 0xffff0000, v9
 v_add_f32 v11, s58, v11
 v_cvt_pk_bf16_f32 v11, v11, v11
 v_and_b32 v11, 0xffff0000, v11
 v_sqrt_f32 v11, v11
 s_nop 0
 v_pk_add_f32 v[36:37], v[12:13], v[10:11] op_sel_hi:[1,0] neg_lo:[0,1] neg_hi:[0,1]
 v_pk_add_f32 v[38:39], v[14:15], v[10:11] op_sel_hi:[1,0] neg_lo:[0,1] neg_hi:[0,1]
 v_pk_add_f32 v[40:41], v[16:17], v[10:11] op_sel_hi:[1,0] neg_lo:[0,1] neg_hi:[0,1]
 v_pk_add_f32 v[42:43], v[18:19], v[10:11] op_sel_hi:[1,0] neg_lo:[0,1] neg_hi:[0,1]
 v_pk_add_f32 v[44:45], v[20:21], v[10:11] op_sel_hi:[1,0] neg_lo:[0,1] neg_hi:[0,1]
 v_pk_add_f32 v[46:47], v[22:23], v[10:11] op_sel_hi:[1,0] neg_lo:[0,1] neg_hi:[0,1]
 v_cvt_pk_bf16_f32 v11, v11, v11
 v_and_b32 v11, 0xffff0000, v11
 v_rcp_f32 v11, v11
 v_cvt_pk_bf16_f32 v9, v36, v37
 v_lshlrev_b32 v36, 16, v9
 v_and_b32 v37, 0xffff0000, v9
 v_cvt_pk_bf16_f32 v9, v38, v39
 v_lshlrev_b32 v38, 16, v9
 v_and_b32 v39, 0xffff0000, v9
 v_cvt_pk_bf16_f32 v9, v40, v41
 v_lshlrev_b32 v40, 16, v9
 v_and_b32 v41, 0xffff0000, v9
 v_cvt_pk_bf16_f32 v9, v42, v43
 v_lshlrev_b32 v42, 16, v9
 v_and_b32 v43, 0xffff0000, v9
 v_cvt_pk_bf16_f32 v9, v44, v45
 v_lshlrev_b32 v44, 16, v9
 v_and_b32 v45, 0xffff0000, v9
 v_cvt_pk_bf16_f32 v9, v46, v47
 v_lshlrev_b32 v46, 16, v9
 v_and_b32 v47, 0xffff0000, v9
 v_pk_mul_f32 v[36:37], v[36:37], v[10:11] op_sel:[0,1] op_sel_hi:[1,1]
 v_pk_mul_f32 v[38:39], v[38:39], v[10:11] op_sel:[0,1] op_sel_hi:[1,1]
 v_pk_mul_f32 v[40:41], v[40:41], v[10:11] op_sel:[0,1] op_sel_hi:[1,1]
 v_pk_mul_f32 v[42:43], v[42:43], v[10:11] op_sel:[0,1] op_sel_hi:[1,1]
 v_pk_mul_f32 v[44:45], v[44:45], v[10:11] op_sel:[0,1] op_sel_hi:[1,1]
 v_pk_mul_f32 v[46:47], v[46:47], v[10:11] op_sel:[0,1] op_sel_hi:[1,1]
 v_cvt_pk_bf16_f32 v48, v36, v37
 v_cvt_pk_bf16_f32 v49, v38, v39
 v_cvt_pk_bf16_f32 v50, v40, v41
 v_cvt_pk_bf16_f32 v51, v42, v43
 v_cvt_pk_bf16_f32 v52, v44, v45
 v_cvt_pk_bf16_f32 v53, v46, v47
 s_add_u32 s3, s60, 229113856
 buffer_store_dwordx2 v[48:49], v4, s[4:7], s3 offen offset:0 sc1
 buffer_store_dwordx2 v[50:51], v4, s[4:7], s3 offen offset:512 sc1
 buffer_store_dwordx2 v[52:53], v8, s[4:7], s3 offen offset:1024 sc1
 s_waitcnt vmcnt(0) lgkmcnt(0)
 s_and_b32 s55, s52, 3
 s_mul_i32 s55, s55, 24576
 s_lshl_b32 s3, s54, 2
 s_add_u32 s3, s3, s55
 s_add_u32 s3, s3, 126976
 v_mov_b32 v3, 1
 s_mov_b64 exec, -1
 buffer_atomic_add v3, v68, s[4:7], s3 offen
 s_mov_b64 exec, -1
 s_add_u32 s3, s3, 16384
 v_mov_b32 v3, 1
 s_mov_b32 exec_hi, 0
 buffer_atomic_add v3, v68, s[4:7], s3 offen
 s_mov_b64 exec, -1
 s_branch L_le_156
L_l1_155:
 buffer_store_dwordx2 v[60:61], v2, s[12:15], s60 offen offset:0 nt
 buffer_store_dwordx2 v[62:63], v2, s[12:15], s60 offen offset:512 nt
 buffer_store_dwordx2 v[64:65], v7, s[12:15], s60 offen offset:1024 nt
 s_waitcnt vmcnt(0)
L_le_156:
 s_add_u32 s54, s54, 2
 s_cmp_lt_u32 s54, 64
 s_cbranch_scc1 L_t4_loop
 s_cmp_lg_u32 s50, 3
 s_cbranch_scc1 L_bail
 s_endpgm
L_bail:
 s_endpgm
L_ch:
 s_mov_b32 s52, s49
 s_lshl_b32 s14, s53, 5
 s_add_u32 s14, s14, s52
 s_lshl_b32 s63, s14, 16
 s_lshl_b32 s3, s50, 14
 s_add_u32 s63, s63, s3
 s_add_u32 s63, s63, 3145728
 s_mul_i32 s60, s14, 10240
 s_lshl_b32 s3, s50, 11
 s_add_u32 s60, s60, s3
 s_add_u32 s60, s60, 225280
 s_lshl_b32 s12, s14, 8
 s_add_u32 s12, s12, 8192
 s_lshl_b32 s13, s14, 7
 s_add_u32 s13, s13, 0
 s_mul_i32 s62, s53, 1048576
 s_lshl_b32 s3, s52, 12
 s_add_u32 s62, s62, s3
 s_add_u32 s62, s62, 1048576
 s_and_b32 s3, s52, 1
 s_lshl_b32 s3, s3, 13
 s_lshl_b32 s61, s52, 14
 s_add_u32 s61, s61, s3
 s_mul_i32 s3, s53, 33554432
 s_add_u32 s61, s61, s3
 s_add_u32 s61, s61, 8388608
 s_mov_b32 s56, 0x3e0293ee
 s_mov_b32 s54, 0
 s_mov_b32 s55, 1
 s_mov_b32 s68, 0x33333333
 s_mov_b32 s69, 0x33333333
 s_mov_b32 s70, 0xcccccccc
 s_mov_b32 s71, 0xcccccccc
 s_mov_b32 s72, 0x11111111
 s_mov_b32 s73, 0x11111111
 s_mov_b32 s74, 0x44444444
 s_mov_b32 s75, 0x44444444
 s_mov_b32 s76, 0x22222222
 s_mov_b32 s77, 0x22222222
 s_mov_b32 s78, 0x88888888
 s_mov_b32 s79, 0x88888888
 s_mov_b32 s82, 0xf0f0f0f0
 s_mov_b32 s83, 0xf0f0f0f0
 s_cmp_eq_u32 s50, 1
 s_cbranch_scc1 L_ch1
 s_cmp_eq_u32 s50, 2
 s_cbranch_scc1 L_ch2
 s_cmp_eq_u32 s50, 3
 s_cbranch_scc1 L_ch3
L_ch0:
 v_lshrrev_b32 v8, 4, v0
 s_mov_b32 s3, 1280
 v_mul_lo_u32 v8, v8, s3
 v_lshrrev_b32 v7, 3, v0
 v_and_b32 v7, 6, v7
 v_xor_b32 v7, v7, v0
 v_and_b32 v7, 15, v7
 v_lshl_add_u32 v8, v7, 4, v8
 v_xor_b32 v9, 128, v8
 v_lshrrev_b32 v10, 4, v0
 s_mov_b32 s3, 8192
 v_mul_lo_u32 v10, v10, s3
 v_lshrrev_b32 v7, 3, v0
 v_and_b32 v7, 6, v7
 v_xor_b32 v7, v7, v0
 v_and_b32 v7, 15, v7
 v_lshl_add_u32 v10, v7, 4, v10
 v_xor_b32 v11, 128, v10
 s_mov_b32 s8, s26
 s_and_b32 s9, s27, 0xffff
 s_mov_b32 s10, 5242880
 s_mul_i32 s14, s52, 163840
 s_add_u32 s14, s14, 0
 s_mov_b32 m0, 0
 s_nop 0
 buffer_load_dwordx4 v8, s[8:11], s14 offen lds
 s_add_u32 s14, s14, 5120
 s_mov_b32 m0, 1024
 s_nop 0
 buffer_load_dwordx4 v8, s[8:11], s14 offen lds
 s_add_u32 s14, s14, 5120
 s_mov_b32 m0, 2048
 s_nop 0
 buffer_load_dwordx4 v8, s[8:11], s14 offen lds
 s_add_u32 s14, s14, 5120
 s_mov_b32 m0, 3072
 s_nop 0
 buffer_load_dwordx4 v8, s[8:11], s14 offen lds
 s_add_u32 s14, s14, 5120
 s_mov_b32 m0, 4096
 s_nop 0
 buffer_load_dwordx4 v9, s[8:11], s14 offen lds
 s_add_u32 s14, s14, 5120
 s_mov_b32 m0, 5120
 s_nop 0
 buffer_load_dwordx4 v9, s[8:11], s14 offen lds
 s_add_u32 s14, s14, 5120
 s_mov_b32 m0, 6144
 s_nop 0
 buffer_load_dwordx4 v9, s[8:11], s14 offen lds
 s_add_u32 s14, s14, 5120
 s_mov_b32 m0, 7168
 s_nop 0
 buffer_load_dwordx4 v9, s[8:11], s14 offen lds
 s_mul_i32 s14, s52, 163840
 s_add_u32 s14, s14, 256
 s_mov_b32 m0, 32768
 s_nop 0
 buffer_load_dwordx4 v8, s[8:11], s14 offen lds
 s_add_u32 s14, s14, 5120
 s_mov_b32 m0, 33792
 s_nop 0
 buffer_load_dwordx4 v8, s[8:11], s14 offen lds
 s_add_u32 s14, s14, 5120
 s_mov_b32 m0, 34816
 s_nop 0
 buffer_load_dwordx4 v8, s[8:11], s14 offen lds
 s_add_u32 s14, s14, 5120
 s_mov_b32 m0, 35840
 s_nop 0
 buffer_load_dwordx4 v8, s[8:11], s14 offen lds
 s_add_u32 s14, s14, 5120
 s_mov_b32 m0, 36864
 s_nop 0
 buffer_load_dwordx4 v9, s[8:11], s14 offen lds
 s_add_u32 s14, s14, 5120
 s_mov_b32 m0, 37888
 s_nop 0
 buffer_load_dwordx4 v9, s[8:11], s14 offen lds
 s_add_u32 s14, s14, 5120
 s_mov_b32 m0, 38912
 s_nop 0
 buffer_load_dwordx4 v9, s[8:11], s14 offen lds
 s_add_u32 s14, s14, 5120
 s_mov_b32 m0, 39936
 s_nop 0
 buffer_load_dwordx4 v9, s[8:11], s14 offen lds
 s_mul_i32 s14, s52, 163840
 s_add_u32 s14, s14, 512
 s_mov_b32 m0, 65536
 s_nop 0
 buffer_load_dwordx4 v8, s[8:11], s14 offen lds
 s_add_u32 s14, s14, 5120
 s_mov_b32 m0, 66560
 s_nop 0
 buffer_load_dwordx4 v8, s[8:11], s14 offen lds
 s_add_u32 s14, s14, 5120
 s_mov_b32 m0, 67584
 s_nop 0
 buffer_load_dwordx4 v8, s[8:11], s14 offen lds
 s_add_u32 s14, s14, 5120
 s_mov_b32 m0, 68608
 s_nop 0
 buffer_load_dwordx4 v8, s[8:11], s14 offen lds
 s_add_u32 s14, s14, 5120
 s_mov_b32 m0, 69632
 s_nop 0
 buffer_load_dwordx4 v9, s[8:11], s14 offen lds
 s_add_u32 s14, s14, 5120
 s_mov_b32 m0, 70656
 s_nop 0
 buffer_load_dwordx4 v9, s[8:11], s14 offen lds
 s_add_u32 s14, s14, 5120
 s_mov_b32 m0, 71680
 s_nop 0
 buffer_load_dwordx4 v9, s[8:11], s14 offen lds
 s_add_u32 s14, s14, 5120
 s_mov_b32 m0, 72704
 s_nop 0
 buffer_load_dwordx4 v9, s[8:11], s14 offen lds
 s_mul_i32 s14, s52, 163840
 s_add_u32 s14, s14, 768
 s_mov_b32 m0, 98304
 s_nop 0
 buffer_load_dwordx4 v8, s[8:11], s14 offen lds
 s_add_u32 s14, s14, 5120
 s_mov_b32 m0, 99328
 s_nop 0
 buffer_load_dwordx4 v8, s[8:11], s14 offen lds
 s_add_u32 s14, s14, 5120
 s_mov_b32 m0, 100352
 s_nop 0
 buffer_load_dwordx4 v8, s[8:11], s14 offen lds
 s_add_u32 s14, s14, 5120
 s_mov_b32 m0, 101376
 s_nop 0
 buffer_load_dwordx4 v8, s[8:11], s14 offen lds
 s_add_u32 s14, s14, 5120
 s_mov_b32 m0, 102400
 s_nop 0
 buffer_load_dwordx4 v9, s[8:11], s14 offen lds
 s_add_u32 s14, s14, 5120
 s_mov_b32 m0, 103424
 s_nop 0
 buffer_load_dwordx4 v9, s[8:11], s14 offen lds
 s_add_u32 s14, s14, 5120
 s_mov_b32 m0, 104448
 s_nop 0
 buffer_load_dwordx4 v9, s[8:11], s14 offen lds
 s_add_u32 s14, s14, 5120
 s_mov_b32 m0, 105472
 s_nop 0
 buffer_load_dwordx4 v9, s[8:11], s14 offen lds
 s_mul_i32 s14, s52, 163840
 s_add_u32 s14, s14, 1024
 s_mov_b32 m0, 131072
 s_nop 0
 buffer_load_dwordx4 v8, s[8:11], s14 offen lds
 s_add_u32 s14, s14, 5120
 s_mov_b32 m0, 132096
 s_nop 0
 buffer_load_dwordx4 v8, s[8:11], s14 offen lds
 s_add_u32 s14, s14, 5120
 s_mov_b32 m0, 133120
 s_nop 0
 buffer_load_dwordx4 v8, s[8:11], s14 offen lds
 s_add_u32 s14, s14, 5120
 s_mov_b32 m0, 134144
 s_nop 0
 buffer_load_dwordx4 v8, s[8:11], s14 offen lds
 s_add_u32 s14, s14, 5120
 s_mov_b32 m0, 135168
 s_nop 0
 buffer_load_dwordx4 v9, s[8:11], s14 offen lds
 s_add_u32 s14, s14, 5120
 s_mov_b32 m0, 136192
 s_nop 0
 buffer_load_dwordx4 v9, s[8:11], s14 offen lds
 s_add_u32 s14, s14, 5120
 s_mov_b32 m0, 137216
 s_nop 0
 buffer_load_dwordx4 v9, s[8:11], s14 offen lds
 s_add_u32 s14, s14, 5120
 s_mov_b32 m0, 138240
 s_nop 0
 buffer_load_dwordx4 v9, s[8:11], s14 offen lds
 v_lshrrev_b32 v20, 4, v0
 v_bfe_u32 v21, v0, 2, 1
 v_bfe_u32 v22, v0, 3, 1
 v_and_b32 v23, 1, v20
 v_lshrrev_b32 v24, 1, v20
 v_and_b32 v25, 3, v0
 v_lshlrev_b32 v25, 3, v25
 v_lshl_add_u32 v26, v22, 1, v23
 v_lshl_add_u32 v27, v21, 2, v26
 v_lshl_add_u32 v26, v24, 2, v26
 v_lshl_add_u32 v26, v21, 4, v26
 v_xor_b32 v27, 0, v27
 v_lshl_add_u32 v27, v27, 5, v25
 v_lshl_add_u32 v12, v26, 8, v27
 v_lshl_add_u32 v26, v24, 2, v21
 v_lshl_add_u32 v26, v23, 4, v26
 v_lshl_add_u32 v27, v23, 2, v21
 v_lshl_add_u32 v27, v22, 1, v27
 v_lshl_add_u32 v27, v27, 5, v25
 v_lshl_add_u32 v14, v26, 8, v27
 v_lshlrev_b32 v1, 4, v0
 v_add_u32 v2, 65536, v1
 v_add_u32 v3, 114688, v1
 s_waitcnt vmcnt(32)
 s_barrier
 v_xor_b32 v16, 0, v14
 v_add_u32 v16, 0, v16
 v_xor_b32 v17, 64, v16
 ds_read_b64_tr_b16 a[0:1], v16 offset:0
 ds_read_b64_tr_b16 a[2:3], v17 offset:512
 ds_read_b64_tr_b16 a[4:5], v16 offset:2048
 ds_read_b64_tr_b16 a[6:7], v17 offset:2560
 v_xor_b32 v16, 0, v14
 v_add_u32 v16, 0, v16
 v_xor_b32 v17, 64, v16
 ds_read_b64_tr_b16 a[8:9], v16 offset:8192
 ds_read_b64_tr_b16 a[10:11], v17 offset:8704
 ds_read_b64_tr_b16 a[12:13], v16 offset:10240
 ds_read_b64_tr_b16 a[14:15], v17 offset:10752
 v_xor_b32 v16, 0, v14
 v_add_u32 v16, 0, v16
 v_xor_b32 v17, 64, v16
 ds_read_b64_tr_b16 a[16:17], v16 offset:16384
 ds_read_b64_tr_b16 a[18:19], v17 offset:16896
 ds_read_b64_tr_b16 a[20:21], v16 offset:18432
 ds_read_b64_tr_b16 a[22:23], v17 offset:18944
 v_xor_b32 v16, 0, v14
 v_add_u32 v16, 0, v16
 v_xor_b32 v17, 64, v16
 ds_read_b64_tr_b16 a[24:25], v16 offset:24576
 ds_read_b64_tr_b16 a[26:27], v17 offset:25088
 ds_read_b64_tr_b16 a[28:29], v16 offset:26624
 ds_read_b64_tr_b16 a[30:31], v17 offset:27136
 v_xor_b32 v16, 32, v14
 v_add_u32 v16, 0, v16
 v_xor_b32 v17, 64, v16
 ds_read_b64_tr_b16 a[32:33], v16 offset:0
 ds_read_b64_tr_b16 a[34:35], v17 offset:512
 ds_read_b64_tr_b16 a[36:37], v16 offset:2048
 ds_read_b64_tr_b16 a[38:39], v17 offset:2560
 v_xor_b32 v16, 32, v14
 v_add_u32 v16, 0, v16
 v_xor_b32 v17, 64, v16
 ds_read_b64_tr_b16 a[40:41], v16 offset:8192
 ds_read_b64_tr_b16 a[42:43], v17 offset:8704
 ds_read_b64_tr_b16 a[44:45], v16 offset:10240
 ds_read_b64_tr_b16 a[46:47], v17 offset:10752
 v_xor_b32 v16, 32, v14
 v_add_u32 v16, 0, v16
 v_xor_b32 v17, 64, v16
 ds_read_b64_tr_b16 a[48:49], v16 offset:16384
 ds_read_b64_tr_b16 a[50:51], v17 offset:16896
 ds_read_b64_tr_b16 a[52:53], v16 offset:18432
 ds_read_b64_tr_b16 a[54:55], v17 offset:18944
 v_xor_b32 v16, 32, v14
 v_add_u32 v16, 0, v16
 v_xor_b32 v17, 64, v16
 ds_read_b64_tr_b16 a[56:57], v16 offset:24576
 ds_read_b64_tr_b16 a[58:59], v17 offset:25088
 ds_read_b64_tr_b16 a[60:61], v16 offset:26624
 ds_read_b64_tr_b16 a[62:63], v17 offset:27136
 v_xor_b32 v16, 128, v14
 v_add_u32 v16, 0, v16
 v_xor_b32 v17, 64, v16
 ds_read_b64_tr_b16 a[64:65], v16 offset:0
 ds_read_b64_tr_b16 a[66:67], v17 offset:512
 ds_read_b64_tr_b16 a[68:69], v16 offset:2048
 ds_read_b64_tr_b16 a[70:71], v17 offset:2560
 v_xor_b32 v16, 128, v14
 v_add_u32 v16, 0, v16
 v_xor_b32 v17, 64, v16
 ds_read_b64_tr_b16 a[72:73], v16 offset:8192
 ds_read_b64_tr_b16 a[74:75], v17 offset:8704
 ds_read_b64_tr_b16 a[76:77], v16 offset:10240
 ds_read_b64_tr_b16 a[78:79], v17 offset:10752
 v_xor_b32 v16, 128, v14
 v_add_u32 v16, 0, v16
 v_xor_b32 v17, 64, v16
 ds_read_b64_tr_b16 a[80:81], v16 offset:16384
 ds_read_b64_tr_b16 a[82:83], v17 offset:16896
 ds_read_b64_tr_b16 a[84:85], v16 offset:18432
 ds_read_b64_tr_b16 a[86:87], v17 offset:18944
 v_xor_b32 v16, 128, v14
 v_add_u32 v16, 0, v16
 v_xor_b32 v17, 64, v16
 ds_read_b64_tr_b16 a[88:89], v16 offset:24576
 ds_read_b64_tr_b16 a[90:91], v17 offset:25088
 ds_read_b64_tr_b16 a[92:93], v16 offset:26624
 ds_read_b64_tr_b16 a[94:95], v17 offset:27136
 v_xor_b32 v16, 160, v14
 v_add_u32 v16, 0, v16
 v_xor_b32 v17, 64, v16
 ds_read_b64_tr_b16 a[96:97], v16 offset:0
 ds_read_b64_tr_b16 a[98:99], v17 offset:512
 ds_read_b64_tr_b16 a[100:101], v16 offset:2048
 ds_read_b64_tr_b16 a[102:103], v17 offset:2560
 v_xor_b32 v16, 160, v14
 v_add_u32 v16, 0, v16
 v_xor_b32 v17, 64, v16
 ds_read_b64_tr_b16 a[104:105], v16 offset:8192
 ds_read_b64_tr_b16 a[106:107], v17 offset:8704
 ds_read_b64_tr_b16 a[108:109], v16 offset:10240
 ds_read_b64_tr_b16 a[110:111], v17 offset:10752
 v_xor_b32 v16, 160, v14
 v_add_u32 v16, 0, v16
 v_xor_b32 v17, 64, v16
 ds_read_b64_tr_b16 a[112:113], v16 offset:16384
 ds_read_b64_tr_b16 a[114:115], v17 offset:16896
 ds_read_b64_tr_b16 a[116:117], v16 offset:18432
 ds_read_b64_tr_b16 a[118:119], v17 offset:18944
 v_xor_b32 v16, 160, v14
 v_add_u32 v16, 0, v16
 v_xor_b32 v17, 64, v16
 ds_read_b64_tr_b16 a[120:121], v16 offset:24576
 ds_read_b64_tr_b16 a[122:123], v17 offset:25088
 ds_read_b64_tr_b16 a[124:125], v16 offset:26624
 ds_read_b64_tr_b16 a[126:127], v17 offset:27136
 s_waitcnt lgkmcnt(0)
 s_barrier
 s_mov_b32 s8, s24
 s_and_b32 s9, s25, 0xffff
 s_mov_b32 s10, 5242880
 s_lshl_b32 s14, s52, 8
 s_add_u32 s14, s14, 0
 s_mov_b32 m0, 0
 s_nop 0
 buffer_load_dwordx4 v10, s[8:11], s14 offen lds
 s_add_u32 s14, s14, 32768
 s_mov_b32 m0, 1024
 s_nop 0
 buffer_load_dwordx4 v10, s[8:11], s14 offen lds
 s_add_u32 s14, s14, 32768
 s_mov_b32 m0, 2048
 s_nop 0
 buffer_load_dwordx4 v10, s[8:11], s14 offen lds
 s_add_u32 s14, s14, 32768
 s_mov_b32 m0, 3072
 s_nop 0
 buffer_load_dwordx4 v10, s[8:11], s14 offen lds
 s_add_u32 s14, s14, 32768
 s_mov_b32 m0, 4096
 s_nop 0
 buffer_load_dwordx4 v11, s[8:11], s14 offen lds
 s_add_u32 s14, s14, 32768
 s_mov_b32 m0, 5120
 s_nop 0
 buffer_load_dwordx4 v11, s[8:11], s14 offen lds
 s_add_u32 s14, s14, 32768
 s_mov_b32 m0, 6144
 s_nop 0
 buffer_load_dwordx4 v11, s[8:11], s14 offen lds
 s_add_u32 s14, s14, 32768
 s_mov_b32 m0, 7168
 s_nop 0
 buffer_load_dwordx4 v11, s[8:11], s14 offen lds
 s_waitcnt vmcnt(32)
 s_barrier
 s_waitcnt lgkmcnt(0)
 s_barrier
 s_lshl_b32 s14, s52, 8
 s_add_u32 s14, s14, 1048576
 s_mov_b32 m0, 32768
 s_nop 0
 buffer_load_dwordx4 v10, s[8:11], s14 offen lds
 s_add_u32 s14, s14, 32768
 s_mov_b32 m0, 33792
 s_nop 0
 buffer_load_dwordx4 v10, s[8:11], s14 offen lds
 s_add_u32 s14, s14, 32768
 s_mov_b32 m0, 34816
 s_nop 0
 buffer_load_dwordx4 v10, s[8:11], s14 offen lds
 s_add_u32 s14, s14, 32768
 s_mov_b32 m0, 35840
 s_nop 0
 buffer_load_dwordx4 v10, s[8:11], s14 offen lds
 s_add_u32 s14, s14, 32768
 s_mov_b32 m0, 36864
 s_nop 0
 buffer_load_dwordx4 v11, s[8:11], s14 offen lds
 s_add_u32 s14, s14, 32768
 s_mov_b32 m0, 37888
 s_nop 0
 buffer_load_dwordx4 v11, s[8:11], s14 offen lds
 s_add_u32 s14, s14, 32768
 s_mov_b32 m0, 38912
 s_nop 0
 buffer_load_dwordx4 v11, s[8:11], s14 offen lds
 s_add_u32 s14, s14, 32768
 s_mov_b32 m0, 39936
 s_nop 0
 buffer_load_dwordx4 v11, s[8:11], s14 offen lds
 s_waitcnt vmcnt(32)
 s_barrier
 s_waitcnt lgkmcnt(0)
 s_barrier
 s_lshl_b32 s14, s52, 8
 s_add_u32 s14, s14, 2097152
 s_mov_b32 m0, 65536
 s_nop 0
 buffer_load_dwordx4 v10, s[8:11], s14 offen lds
 s_add_u32 s14, s14, 32768
 s_mov_b32 m0, 66560
 s_nop 0
 buffer_load_dwordx4 v10, s[8:11], s14 offen lds
 s_add_u32 s14, s14, 32768
 s_mov_b32 m0, 67584
 s_nop 0
 buffer_load_dwordx4 v10, s[8:11], s14 offen lds
 s_add_u32 s14, s14, 32768
 s_mov_b32 m0, 68608
 s_nop 0
 buffer_load_dwordx4 v10, s[8:11], s14 offen lds
 s_add_u32 s14, s14, 32768
 s_mov_b32 m0, 69632
 s_nop 0
 buffer_load_dwordx4 v11, s[8:11], s14 offen lds
 s_add_u32 s14, s14, 32768
 s_mov_b32 m0, 70656
 s_nop 0
 buffer_load_dwordx4 v11, s[8:11], s14 offen lds
 s_add_u32 s14, s14, 32768
 s_mov_b32 m0, 71680
 s_nop 0
 buffer_load_dwordx4 v11, s[8:11], s14 offen lds
 s_add_u32 s14, s14, 32768
 s_mov_b32 m0, 72704
 s_nop 0
 buffer_load_dwordx4 v11, s[8:11], s14 offen lds
 s_waitcnt vmcnt(32)
 s_barrier
 s_waitcnt lgkmcnt(0)
 s_barrier
 s_lshl_b32 s14, s52, 8
 s_add_u32 s14, s14, 3145728
 s_mov_b32 m0, 98304
 s_nop 0
 buffer_load_dwordx4 v10, s[8:11], s14 offen lds
 s_add_u32 s14, s14, 32768
 s_mov_b32 m0, 99328
 s_nop 0
 buffer_load_dwordx4 v10, s[8:11], s14 offen lds
 s_add_u32 s14, s14, 32768
 s_mov_b32 m0, 100352
 s_nop 0
 buffer_load_dwordx4 v10, s[8:11], s14 offen lds
 s_add_u32 s14, s14, 32768
 s_mov_b32 m0, 101376
 s_nop 0
 buffer_load_dwordx4 v10, s[8:11], s14 offen lds
 s_add_u32 s14, s14, 32768
 s_mov_b32 m0, 102400
 s_nop 0
 buffer_load_dwordx4 v11, s[8:11], s14 offen lds
 s_add_u32 s14, s14, 32768
 s_mov_b32 m0, 103424
 s_nop 0
 buffer_load_dwordx4 v11, s[8:11], s14 offen lds
 s_add_u32 s14, s14, 32768
 s_mov_b32 m0, 104448
 s_nop 0
 buffer_load_dwordx4 v11, s[8:11], s14 offen lds
 s_add_u32 s14, s14, 32768
 s_mov_b32 m0, 105472
 s_nop 0
 buffer_load_dwordx4 v11, s[8:11], s14 offen lds
 s_waitcnt vmcnt(32)
 s_barrier
 v_xor_b32 v16, 0, v14
 v_add_u32 v16, 131072, v16
 v_xor_b32 v17, 64, v16
 ds_read_b64_tr_b16 a[128:129], v16 offset:0
 ds_read_b64_tr_b16 a[130:131], v17 offset:512
 ds_read_b64_tr_b16 a[132:133], v16 offset:2048
 ds_read_b64_tr_b16 a[134:135], v17 offset:2560
 v_xor_b32 v16, 0, v14
 v_add_u32 v16, 131072, v16
 v_xor_b32 v17, 64, v16
 ds_read_b64_tr_b16 a[136:137], v16 offset:8192
 ds_read_b64_tr_b16 a[138:139], v17 offset:8704
 ds_read_b64_tr_b16 a[140:141], v16 offset:10240
 ds_read_b64_tr_b16 a[142:143], v17 offset:10752
 v_xor_b32 v16, 0, v14
 v_add_u32 v16, 131072, v16
 v_xor_b32 v17, 64, v16
 ds_read_b64_tr_b16 a[144:145], v16 offset:16384
 ds_read_b64_tr_b16 a[146:147], v17 offset:16896
 ds_read_b64_tr_b16 a[148:149], v16 offset:18432
 ds_read_b64_tr_b16 a[150:151], v17 offset:18944
 v_xor_b32 v16, 0, v14
 v_add_u32 v16, 131072, v16
 v_xor_b32 v17, 64, v16
 ds_read_b64_tr_b16 a[152:153], v16 offset:24576
 ds_read_b64_tr_b16 a[154:155], v17 offset:25088
 ds_read_b64_tr_b16 a[156:157], v16 offset:26624
 ds_read_b64_tr_b16 a[158:159], v17 offset:27136
 s_waitcnt lgkmcnt(0)
 s_barrier
 s_lshl_b32 s14, s52, 8
 s_add_u32 s14, s14, 4194304
 s_mov_b32 m0, 131072
 s_nop 0
 buffer_load_dwordx4 v10, s[8:11], s14 offen lds
 s_add_u32 s14, s14, 32768
 s_mov_b32 m0, 132096
 s_nop 0
 buffer_load_dwordx4 v10, s[8:11], s14 offen lds
 s_add_u32 s14, s14, 32768
 s_mov_b32 m0, 133120
 s_nop 0
 buffer_load_dwordx4 v10, s[8:11], s14 offen lds
 s_add_u32 s14, s14, 32768
 s_mov_b32 m0, 134144
 s_nop 0
 buffer_load_dwordx4 v10, s[8:11], s14 offen lds
 s_add_u32 s14, s14, 32768
 s_mov_b32 m0, 135168
 s_nop 0
 buffer_load_dwordx4 v11, s[8:11], s14 offen lds
 s_add_u32 s14, s14, 32768
 s_mov_b32 m0, 136192
 s_nop 0
 buffer_load_dwordx4 v11, s[8:11], s14 offen lds
 s_add_u32 s14, s14, 32768
 s_mov_b32 m0, 137216
 s_nop 0
 buffer_load_dwordx4 v11, s[8:11], s14 offen lds
 s_add_u32 s14, s14, 32768
 s_mov_b32 m0, 138240
 s_nop 0
 buffer_load_dwordx4 v11, s[8:11], s14 offen lds
 s_waitcnt vmcnt(32)
 s_barrier
 v_xor_b32 v16, 0, v12
 v_add_u32 v16, 0, v16
 ds_read_b64_tr_b16 a[160:161], v16 offset:0
 ds_read_b64_tr_b16 a[162:163], v16 offset:8192
 ds_read_b64_tr_b16 a[164:165], v16 offset:2048
 ds_read_b64_tr_b16 a[166:167], v16 offset:10240
 v_xor_b32 v16, 32, v12
 v_add_u32 v16, 0, v16
 ds_read_b64_tr_b16 a[168:169], v16 offset:0
 ds_read_b64_tr_b16 a[170:171], v16 offset:8192
 ds_read_b64_tr_b16 a[172:173], v16 offset:2048
 ds_read_b64_tr_b16 a[174:175], v16 offset:10240
 v_xor_b32 v16, 0, v12
 v_add_u32 v16, 0, v16
 ds_read_b64_tr_b16 a[176:177], v16 offset:16384
 ds_read_b64_tr_b16 a[178:179], v16 offset:24576
 ds_read_b64_tr_b16 a[180:181], v16 offset:18432
 ds_read_b64_tr_b16 a[182:183], v16 offset:26624
 v_xor_b32 v16, 32, v12
 v_add_u32 v16, 0, v16
 ds_read_b64_tr_b16 a[184:185], v16 offset:16384
 ds_read_b64_tr_b16 a[186:187], v16 offset:24576
 ds_read_b64_tr_b16 a[188:189], v16 offset:18432
 ds_read_b64_tr_b16 a[190:191], v16 offset:26624
 s_waitcnt lgkmcnt(0)
 s_barrier
 s_mov_b32 s8, s22
 s_and_b32 s9, s23, 0xffff
 s_mov_b32 s10, 5242880
 s_lshl_b32 s14, s52, 8
 s_add_u32 s14, s14, 0
 s_mov_b32 m0, 0
 s_nop 0
 buffer_load_dwordx4 v10, s[8:11], s14 offen lds
 s_add_u32 s14, s14, 32768
 s_mov_b32 m0, 1024
 s_nop 0
 buffer_load_dwordx4 v10, s[8:11], s14 offen lds
 s_add_u32 s14, s14, 32768
 s_mov_b32 m0, 2048
 s_nop 0
 buffer_load_dwordx4 v10, s[8:11], s14 offen lds
 s_add_u32 s14, s14, 32768
 s_mov_b32 m0, 3072
 s_nop 0
 buffer_load_dwordx4 v10, s[8:11], s14 offen lds
 s_add_u32 s14, s14, 32768
 s_mov_b32 m0, 4096
 s_nop 0
 buffer_load_dwordx4 v11, s[8:11], s14 offen lds
 s_add_u32 s14, s14, 32768
 s_mov_b32 m0, 5120
 s_nop 0
 buffer_load_dwordx4 v11, s[8:11], s14 offen lds
 s_add_u32 s14, s14, 32768
 s_mov_b32 m0, 6144
 s_nop 0
 buffer_load_dwordx4 v11, s[8:11], s14 offen lds
 s_add_u32 s14, s14, 32768
 s_mov_b32 m0, 7168
 s_nop 0
 buffer_load_dwordx4 v11, s[8:11], s14 offen lds
 s_waitcnt vmcnt(32)
 s_barrier
 v_xor_b32 v16, 0, v12
 v_add_u32 v16, 32768, v16
 ds_read_b64_tr_b16 a[192:193], v16 offset:0
 ds_read_b64_tr_b16 a[194:195], v16 offset:8192
 ds_read_b64_tr_b16 a[196:197], v16 offset:2048
 ds_read_b64_tr_b16 a[198:199], v16 offset:10240
 v_xor_b32 v16, 32, v12
 v_add_u32 v16, 32768, v16
 ds_read_b64_tr_b16 a[200:201], v16 offset:0
 ds_read_b64_tr_b16 a[202:203], v16 offset:8192
 ds_read_b64_tr_b16 a[204:205], v16 offset:2048
 ds_read_b64_tr_b16 a[206:207], v16 offset:10240
 v_xor_b32 v16, 0, v12
 v_add_u32 v16, 32768, v16
 ds_read_b64_tr_b16 a[208:209], v16 offset:16384
 ds_read_b64_tr_b16 a[210:211], v16 offset:24576
 ds_read_b64_tr_b16 a[212:213], v16 offset:18432
 ds_read_b64_tr_b16 a[214:215], v16 offset:26624
 v_xor_b32 v16, 32, v12
 v_add_u32 v16, 32768, v16
 ds_read_b64_tr_b16 a[216:217], v16 offset:16384
 ds_read_b64_tr_b16 a[218:219], v16 offset:24576
 ds_read_b64_tr_b16 a[220:221], v16 offset:18432
 ds_read_b64_tr_b16 a[222:223], v16 offset:26624
 s_waitcnt lgkmcnt(0)
 s_barrier
 s_lshl_b32 s14, s52, 8
 s_add_u32 s14, s14, 1048576
 s_mov_b32 m0, 32768
 s_nop 0
 buffer_load_dwordx4 v10, s[8:11], s14 offen lds
 s_add_u32 s14, s14, 32768
 s_mov_b32 m0, 33792
 s_nop 0
 buffer_load_dwordx4 v10, s[8:11], s14 offen lds
 s_add_u32 s14, s14, 32768
 s_mov_b32 m0, 34816
 s_nop 0
 buffer_load_dwordx4 v10, s[8:11], s14 offen lds
 s_add_u32 s14, s14, 32768
 s_mov_b32 m0, 35840
 s_nop 0
 buffer_load_dwordx4 v10, s[8:11], s14 offen lds
 s_add_u32 s14, s14, 32768
 s_mov_b32 m0, 36864
 s_nop 0
 buffer_load_dwordx4 v11, s[8:11], s14 offen lds
 s_add_u32 s14, s14, 32768
 s_mov_b32 m0, 37888
 s_nop 0
 buffer_load_dwordx4 v11, s[8:11], s14 offen lds
 s_add_u32 s14, s14, 32768
 s_mov_b32 m0, 38912
 s_nop 0
 buffer_load_dwordx4 v11, s[8:11], s14 offen lds
 s_add_u32 s14, s14, 32768
 s_mov_b32 m0, 39936
 s_nop 0
 buffer_load_dwordx4 v11, s[8:11], s14 offen lds
 s_waitcnt vmcnt(32)
 s_barrier
 v_xor_b32 v16, 0, v12
 v_add_u32 v16, 65536, v16
 ds_read_b64_tr_b16 a[224:225], v16 offset:0
 ds_read_b64_tr_b16 a[226:227], v16 offset:8192
 ds_read_b64_tr_b16 a[228:229], v16 offset:2048
 ds_read_b64_tr_b16 a[230:231], v16 offset:10240
 v_xor_b32 v16, 32, v12
 v_add_u32 v16, 65536, v16
 ds_read_b64_tr_b16 a[232:233], v16 offset:0
 ds_read_b64_tr_b16 a[234:235], v16 offset:8192
 ds_read_b64_tr_b16 a[236:237], v16 offset:2048
 ds_read_b64_tr_b16 a[238:239], v16 offset:10240
 v_xor_b32 v16, 0, v12
 v_add_u32 v16, 65536, v16
 ds_read_b64_tr_b16 a[240:241], v16 offset:16384
 ds_read_b64_tr_b16 a[242:243], v16 offset:24576
 ds_read_b64_tr_b16 a[244:245], v16 offset:18432
 ds_read_b64_tr_b16 a[246:247], v16 offset:26624
 v_xor_b32 v16, 32, v12
 v_add_u32 v16, 65536, v16
 ds_read_b64_tr_b16 a[248:249], v16 offset:16384
 ds_read_b64_tr_b16 a[250:251], v16 offset:24576
 ds_read_b64_tr_b16 a[252:253], v16 offset:18432
 ds_read_b64_tr_b16 a[254:255], v16 offset:26624
 s_waitcnt lgkmcnt(0)
 s_barrier
 s_lshl_b32 s14, s52, 8
 s_add_u32 s14, s14, 2097152
 s_mov_b32 m0, 65536
 s_nop 0
 buffer_load_dwordx4 v10, s[8:11], s14 offen lds
 s_add_u32 s14, s14, 32768
 s_mov_b32 m0, 66560
 s_nop 0
 buffer_load_dwordx4 v10, s[8:11], s14 offen lds
 s_add_u32 s14, s14, 32768
 s_mov_b32 m0, 67584
 s_nop 0
 buffer_load_dwordx4 v10, s[8:11], s14 offen lds
 s_add_u32 s14, s14, 32768
 s_mov_b32 m0, 68608
 s_nop 0
 buffer_load_dwordx4 v10, s[8:11], s14 offen lds
 s_add_u32 s14, s14, 32768
 s_mov_b32 m0, 69632
 s_nop 0
 buffer_load_dwordx4 v11, s[8:11], s14 offen lds
 s_add_u32 s14, s14, 32768
 s_mov_b32 m0, 70656
 s_nop 0
 buffer_load_dwordx4 v11, s[8:11], s14 offen lds
 s_add_u32 s14, s14, 32768
 s_mov_b32 m0, 71680
 s_nop 0
 buffer_load_dwordx4 v11, s[8:11], s14 offen lds
 s_add_u32 s14, s14, 32768
 s_mov_b32 m0, 72704
 s_nop 0
 buffer_load_dwordx4 v11, s[8:11], s14 offen lds
 s_waitcnt vmcnt(32)
 s_barrier
 v_xor_b32 v16, 0, v12
 v_add_u32 v16, 98304, v16
 ds_read_b64_tr_b16 v[64:65], v16 offset:0
 ds_read_b64_tr_b16 v[66:67], v16 offset:8192
 ds_read_b64_tr_b16 v[68:69], v16 offset:2048
 ds_read_b64_tr_b16 v[70:71], v16 offset:10240
 v_xor_b32 v16, 32, v12
 v_add_u32 v16, 98304, v16
 ds_read_b64_tr_b16 v[72:73], v16 offset:0
 ds_read_b64_tr_b16 v[74:75], v16 offset:8192
 ds_read_b64_tr_b16 v[76:77], v16 offset:2048
 ds_read_b64_tr_b16 v[78:79], v16 offset:10240
 v_xor_b32 v16, 0, v12
 v_add_u32 v16, 98304, v16
 ds_read_b64_tr_b16 v[80:81], v16 offset:16384
 ds_read_b64_tr_b16 v[82:83], v16 offset:24576
 ds_read_b64_tr_b16 v[84:85], v16 offset:18432
 ds_read_b64_tr_b16 v[86:87], v16 offset:26624
 v_xor_b32 v16, 32, v12
 v_add_u32 v16, 98304, v16
 ds_read_b64_tr_b16 v[88:89], v16 offset:16384
 ds_read_b64_tr_b16 v[90:91], v16 offset:24576
 ds_read_b64_tr_b16 v[92:93], v16 offset:18432
 ds_read_b64_tr_b16 v[94:95], v16 offset:26624
 s_waitcnt lgkmcnt(0)
 s_barrier
 s_lshl_b32 s14, s52, 8
 s_add_u32 s14, s14, 3145728
 s_mov_b32 m0, 98304
 s_nop 0
 buffer_load_dwordx4 v10, s[8:11], s14 offen lds
 s_add_u32 s14, s14, 32768
 s_mov_b32 m0, 99328
 s_nop 0
 buffer_load_dwordx4 v10, s[8:11], s14 offen lds
 s_add_u32 s14, s14, 32768
 s_mov_b32 m0, 100352
 s_nop 0
 buffer_load_dwordx4 v10, s[8:11], s14 offen lds
 s_add_u32 s14, s14, 32768
 s_mov_b32 m0, 101376
 s_nop 0
 buffer_load_dwordx4 v10, s[8:11], s14 offen lds
 s_add_u32 s14, s14, 32768
 s_mov_b32 m0, 102400
 s_nop 0
 buffer_load_dwordx4 v11, s[8:11], s14 offen lds
 s_add_u32 s14, s14, 32768
 s_mov_b32 m0, 103424
 s_nop 0
 buffer_load_dwordx4 v11, s[8:11], s14 offen lds
 s_add_u32 s14, s14, 32768
 s_mov_b32 m0, 104448
 s_nop 0
 buffer_load_dwordx4 v11, s[8:11], s14 offen lds
 s_add_u32 s14, s14, 32768
 s_mov_b32 m0, 105472
 s_nop 0
 buffer_load_dwordx4 v11, s[8:11], s14 offen lds
 s_waitcnt vmcnt(32)
 s_barrier
 v_xor_b32 v16, 0, v12
 v_add_u32 v16, 131072, v16
 ds_read_b64_tr_b16 v[96:97], v16 offset:0
 ds_read_b64_tr_b16 v[98:99], v16 offset:8192
 ds_read_b64_tr_b16 v[100:101], v16 offset:2048
 ds_read_b64_tr_b16 v[102:103], v16 offset:10240
 v_xor_b32 v16, 32, v12
 v_add_u32 v16, 131072, v16
 ds_read_b64_tr_b16 v[104:105], v16 offset:0
 ds_read_b64_tr_b16 v[106:107], v16 offset:8192
 ds_read_b64_tr_b16 v[108:109], v16 offset:2048
 ds_read_b64_tr_b16 v[110:111], v16 offset:10240
 v_xor_b32 v16, 0, v12
 v_add_u32 v16, 131072, v16
 ds_read_b64_tr_b16 v[112:113], v16 offset:16384
 ds_read_b64_tr_b16 v[114:115], v16 offset:24576
 ds_read_b64_tr_b16 v[116:117], v16 offset:18432
 ds_read_b64_tr_b16 v[118:119], v16 offset:26624
 v_xor_b32 v16, 32, v12
 v_add_u32 v16, 131072, v16
 ds_read_b64_tr_b16 v[120:121], v16 offset:16384
 ds_read_b64_tr_b16 v[122:123], v16 offset:24576
 ds_read_b64_tr_b16 v[124:125], v16 offset:18432
 ds_read_b64_tr_b16 v[126:127], v16 offset:26624
 s_waitcnt lgkmcnt(0)
 s_barrier
 s_lshl_b32 s14, s52, 8
 s_add_u32 s14, s14, 4194304
 s_mov_b32 m0, 131072
 s_nop 0
 buffer_load_dwordx4 v10, s[8:11], s14 offen lds
 s_add_u32 s14, s14, 32768
 s_mov_b32 m0, 132096
 s_nop 0
 buffer_load_dwordx4 v10, s[8:11], s14 offen lds
 s_add_u32 s14, s14, 32768
 s_mov_b32 m0, 133120
 s_nop 0
 buffer_load_dwordx4 v10, s[8:11], s14 offen lds
 s_add_u32 s14, s14, 32768
 s_mov_b32 m0, 134144
 s_nop 0
 buffer_load_dwordx4 v10, s[8:11], s14 offen lds
 s_add_u32 s14, s14, 32768
 s_mov_b32 m0, 135168
 s_nop 0
 buffer_load_dwordx4 v11, s[8:11], s14 offen lds
 s_add_u32 s14, s14, 32768
 s_mov_b32 m0, 136192
 s_nop 0
 buffer_load_dwordx4 v11, s[8:11], s14 offen lds
 s_add_u32 s14, s14, 32768
 s_mov_b32 m0, 137216
 s_nop 0
 buffer_load_dwordx4 v11, s[8:11], s14 offen lds
 s_add_u32 s14, s14, 32768
 s_mov_b32 m0, 138240
 s_nop 0
 buffer_load_dwordx4 v11, s[8:11], s14 offen lds
 s_waitcnt vmcnt(32)
 s_barrier
 v_xor_b32 v16, 0, v12
 v_add_u32 v16, 0, v16
 ds_read_b64_tr_b16 v[32:33], v16 offset:0
 ds_read_b64_tr_b16 v[34:35], v16 offset:8192
 ds_read_b64_tr_b16 v[36:37], v16 offset:2048
 ds_read_b64_tr_b16 v[38:39], v16 offset:10240
 s_add_u32 s3, s63, 0
 s_waitcnt lgkmcnt(2)
 buffer_store_dwordx4 v[32:35], v1, s[4:7], s3 offen offset:0
 s_waitcnt lgkmcnt(0)
 buffer_store_dwordx4 v[36:39], v1, s[4:7], s3 offen offset:1024
 v_xor_b32 v16, 32, v12
 v_add_u32 v16, 0, v16
 ds_read_b64_tr_b16 v[40:41], v16 offset:0
 ds_read_b64_tr_b16 v[42:43], v16 offset:8192
 ds_read_b64_tr_b16 v[44:45], v16 offset:2048
 ds_read_b64_tr_b16 v[46:47], v16 offset:10240
 s_add_u32 s3, s63, 2048
 s_waitcnt lgkmcnt(2)
 buffer_store_dwordx4 v[40:43], v1, s[4:7], s3 offen offset:0
 s_waitcnt lgkmcnt(0)
 buffer_store_dwordx4 v[44:47], v1, s[4:7], s3 offen offset:1024
 v_xor_b32 v16, 0, v12
 v_add_u32 v16, 0, v16
 ds_read_b64_tr_b16 v[48:49], v16 offset:16384
 ds_read_b64_tr_b16 v[50:51], v16 offset:24576
 ds_read_b64_tr_b16 v[52:53], v16 offset:18432
 ds_read_b64_tr_b16 v[54:55], v16 offset:26624
 s_add_u32 s3, s63, 4096
 s_waitcnt lgkmcnt(2)
 buffer_store_dwordx4 v[48:51], v1, s[4:7], s3 offen offset:0
 s_waitcnt lgkmcnt(0)
 buffer_store_dwordx4 v[52:55], v1, s[4:7], s3 offen offset:1024
 v_xor_b32 v16, 32, v12
 v_add_u32 v16, 0, v16
 ds_read_b64_tr_b16 v[56:57], v16 offset:16384
 ds_read_b64_tr_b16 v[58:59], v16 offset:24576
 ds_read_b64_tr_b16 v[60:61], v16 offset:18432
 ds_read_b64_tr_b16 v[62:63], v16 offset:26624
 s_add_u32 s3, s63, 6144
 s_waitcnt lgkmcnt(2)
 buffer_store_dwordx4 v[56:59], v1, s[4:7], s3 offen offset:0
 s_waitcnt lgkmcnt(0)
 buffer_store_dwordx4 v[60:63], v1, s[4:7], s3 offen offset:1024
 s_waitcnt lgkmcnt(0)
 s_barrier
 s_mov_b32 s8, s20
 s_and_b32 s9, s21, 0xffff
 s_mov_b32 s10, 5242880
 s_lshl_b32 s14, s52, 8
 s_add_u32 s14, s14, 0
 s_mov_b32 m0, 0
 s_nop 0
 buffer_load_dwordx4 v10, s[8:11], s14 offen lds
 s_add_u32 s14, s14, 32768
 s_mov_b32 m0, 1024
 s_nop 0
 buffer_load_dwordx4 v10, s[8:11], s14 offen lds
 s_add_u32 s14, s14, 32768
 s_mov_b32 m0, 2048
 s_nop 0
 buffer_load_dwordx4 v10, s[8:11], s14 offen lds
 s_add_u32 s14, s14, 32768
 s_mov_b32 m0, 3072
 s_nop 0
 buffer_load_dwordx4 v10, s[8:11], s14 offen lds
 s_add_u32 s14, s14, 32768
 s_mov_b32 m0, 4096
 s_nop 0
 buffer_load_dwordx4 v11, s[8:11], s14 offen lds
 s_add_u32 s14, s14, 32768
 s_mov_b32 m0, 5120
 s_nop 0
 buffer_load_dwordx4 v11, s[8:11], s14 offen lds
 s_add_u32 s14, s14, 32768
 s_mov_b32 m0, 6144
 s_nop 0
 buffer_load_dwordx4 v11, s[8:11], s14 offen lds
 s_add_u32 s14, s14, 32768
 s_mov_b32 m0, 7168
 s_nop 0
 buffer_load_dwordx4 v11, s[8:11], s14 offen lds
 s_waitcnt vmcnt(40)
 s_barrier
 v_xor_b32 v16, 0, v12
 v_add_u32 v16, 32768, v16
 ds_read_b64_tr_b16 v[128:129], v16 offset:0
 ds_read_b64_tr_b16 v[130:131], v16 offset:8192
 ds_read_b64_tr_b16 v[132:133], v16 offset:2048
 ds_read_b64_tr_b16 v[134:135], v16 offset:10240
 v_xor_b32 v16, 32, v12
 v_add_u32 v16, 32768, v16
 ds_read_b64_tr_b16 v[136:137], v16 offset:0
 ds_read_b64_tr_b16 v[138:139], v16 offset:8192
 ds_read_b64_tr_b16 v[140:141], v16 offset:2048
 ds_read_b64_tr_b16 v[142:143], v16 offset:10240
 v_xor_b32 v16, 0, v12
 v_add_u32 v16, 32768, v16
 ds_read_b64_tr_b16 v[144:145], v16 offset:16384
 ds_read_b64_tr_b16 v[146:147], v16 offset:24576
 ds_read_b64_tr_b16 v[148:149], v16 offset:18432
 ds_read_b64_tr_b16 v[150:151], v16 offset:26624
 v_xor_b32 v16, 32, v12
 v_add_u32 v16, 32768, v16
 ds_read_b64_tr_b16 v[152:153], v16 offset:16384
 ds_read_b64_tr_b16 v[154:155], v16 offset:24576
 ds_read_b64_tr_b16 v[156:157], v16 offset:18432
 ds_read_b64_tr_b16 v[158:159], v16 offset:26624
 s_waitcnt lgkmcnt(0)
 s_barrier
 s_lshl_b32 s14, s52, 8
 s_add_u32 s14, s14, 1048576
 s_mov_b32 m0, 32768
 s_nop 0
 buffer_load_dwordx4 v10, s[8:11], s14 offen lds
 s_add_u32 s14, s14, 32768
 s_mov_b32 m0, 33792
 s_nop 0
 buffer_load_dwordx4 v10, s[8:11], s14 offen lds
 s_add_u32 s14, s14, 32768
 s_mov_b32 m0, 34816
 s_nop 0
 buffer_load_dwordx4 v10, s[8:11], s14 offen lds
 s_add_u32 s14, s14, 32768
 s_mov_b32 m0, 35840
 s_nop 0
 buffer_load_dwordx4 v10, s[8:11], s14 offen lds
 s_add_u32 s14, s14, 32768
 s_mov_b32 m0, 36864
 s_nop 0
 buffer_load_dwordx4 v11, s[8:11], s14 offen lds
 s_add_u32 s14, s14, 32768
 s_mov_b32 m0, 37888
 s_nop 0
 buffer_load_dwordx4 v11, s[8:11], s14 offen lds
 s_add_u32 s14, s14, 32768
 s_mov_b32 m0, 38912
 s_nop 0
 buffer_load_dwordx4 v11, s[8:11], s14 offen lds
 s_add_u32 s14, s14, 32768
 s_mov_b32 m0, 39936
 s_nop 0
 buffer_load_dwordx4 v11, s[8:11], s14 offen lds
 s_waitcnt vmcnt(40)
 s_barrier
 v_xor_b32 v16, 0, v12
 v_add_u32 v16, 65536, v16
 ds_read_b64_tr_b16 v[160:161], v16 offset:0
 ds_read_b64_tr_b16 v[162:163], v16 offset:8192
 ds_read_b64_tr_b16 v[164:165], v16 offset:2048
 ds_read_b64_tr_b16 v[166:167], v16 offset:10240
 v_xor_b32 v16, 32, v12
 v_add_u32 v16, 65536, v16
 ds_read_b64_tr_b16 v[168:169], v16 offset:0
 ds_read_b64_tr_b16 v[170:171], v16 offset:8192
 ds_read_b64_tr_b16 v[172:173], v16 offset:2048
 ds_read_b64_tr_b16 v[174:175], v16 offset:10240
 v_xor_b32 v16, 0, v12
 v_add_u32 v16, 65536, v16
 ds_read_b64_tr_b16 v[176:177], v16 offset:16384
 ds_read_b64_tr_b16 v[178:179], v16 offset:24576
 ds_read_b64_tr_b16 v[180:181], v16 offset:18432
 ds_read_b64_tr_b16 v[182:183], v16 offset:26624
 v_xor_b32 v16, 32, v12
 v_add_u32 v16, 65536, v16
 ds_read_b64_tr_b16 v[184:185], v16 offset:16384
 ds_read_b64_tr_b16 v[186:187], v16 offset:24576
 ds_read_b64_tr_b16 v[188:189], v16 offset:18432
 ds_read_b64_tr_b16 v[190:191], v16 offset:26624
 s_waitcnt lgkmcnt(0)
 s_barrier
 s_lshl_b32 s14, s52, 8
 s_add_u32 s14, s14, 2097152
 s_mov_b32 m0, 65536
 s_nop 0
 buffer_load_dwordx4 v10, s[8:11], s14 offen lds
 s_add_u32 s14, s14, 32768
 s_mov_b32 m0, 66560
 s_nop 0
 buffer_load_dwordx4 v10, s[8:11], s14 offen lds
 s_add_u32 s14, s14, 32768
 s_mov_b32 m0, 67584
 s_nop 0
 buffer_load_dwordx4 v10, s[8:11], s14 offen lds
 s_add_u32 s14, s14, 32768
 s_mov_b32 m0, 68608
 s_nop 0
 buffer_load_dwordx4 v10, s[8:11], s14 offen lds
 s_add_u32 s14, s14, 32768
 s_mov_b32 m0, 69632
 s_nop 0
 buffer_load_dwordx4 v11, s[8:11], s14 offen lds
 s_add_u32 s14, s14, 32768
 s_mov_b32 m0, 70656
 s_nop 0
 buffer_load_dwordx4 v11, s[8:11], s14 offen lds
 s_add_u32 s14, s14, 32768
 s_mov_b32 m0, 71680
 s_nop 0
 buffer_load_dwordx4 v11, s[8:11], s14 offen lds
 s_add_u32 s14, s14, 32768
 s_mov_b32 m0, 72704
 s_nop 0
 buffer_load_dwordx4 v11, s[8:11], s14 offen lds
 s_waitcnt vmcnt(40)
 s_barrier
 v_xor_b32 v16, 0, v12
 v_add_u32 v16, 98304, v16
 ds_read_b64_tr_b16 v[192:193], v16 offset:0
 ds_read_b64_tr_b16 v[194:195], v16 offset:8192
 ds_read_b64_tr_b16 v[196:197], v16 offset:2048
 ds_read_b64_tr_b16 v[198:199], v16 offset:10240
 v_xor_b32 v16, 32, v12
 v_add_u32 v16, 98304, v16
 ds_read_b64_tr_b16 v[32:33], v16 offset:0
 ds_read_b64_tr_b16 v[34:35], v16 offset:8192
 ds_read_b64_tr_b16 v[36:37], v16 offset:2048
 ds_read_b64_tr_b16 v[38:39], v16 offset:10240
 s_add_u32 s3, s63, 8192
 s_waitcnt lgkmcnt(2)
 buffer_store_dwordx4 v[32:35], v1, s[4:7], s3 offen offset:0
 s_waitcnt lgkmcnt(0)
 buffer_store_dwordx4 v[36:39], v1, s[4:7], s3 offen offset:1024
 v_xor_b32 v16, 0, v12
 v_add_u32 v16, 98304, v16
 ds_read_b64_tr_b16 v[200:201], v16 offset:16384
 ds_read_b64_tr_b16 v[202:203], v16 offset:24576
 ds_read_b64_tr_b16 v[204:205], v16 offset:18432
 ds_read_b64_tr_b16 v[206:207], v16 offset:26624
 v_xor_b32 v16, 32, v12
 v_add_u32 v16, 98304, v16
 ds_read_b64_tr_b16 v[208:209], v16 offset:16384
 ds_read_b64_tr_b16 v[210:211], v16 offset:24576
 ds_read_b64_tr_b16 v[212:213], v16 offset:18432
 ds_read_b64_tr_b16 v[214:215], v16 offset:26624
 s_waitcnt lgkmcnt(0)
 s_barrier
 s_lshl_b32 s14, s52, 8
 s_add_u32 s14, s14, 3145728
 s_mov_b32 m0, 98304
 s_nop 0
 buffer_load_dwordx4 v10, s[8:11], s14 offen lds
 s_add_u32 s14, s14, 32768
 s_mov_b32 m0, 99328
 s_nop 0
 buffer_load_dwordx4 v10, s[8:11], s14 offen lds
 s_add_u32 s14, s14, 32768
 s_mov_b32 m0, 100352
 s_nop 0
 buffer_load_dwordx4 v10, s[8:11], s14 offen lds
 s_add_u32 s14, s14, 32768
 s_mov_b32 m0, 101376
 s_nop 0
 buffer_load_dwordx4 v10, s[8:11], s14 offen lds
 s_add_u32 s14, s14, 32768
 s_mov_b32 m0, 102400
 s_nop 0
 buffer_load_dwordx4 v11, s[8:11], s14 offen lds
 s_add_u32 s14, s14, 32768
 s_mov_b32 m0, 103424
 s_nop 0
 buffer_load_dwordx4 v11, s[8:11], s14 offen lds
 s_add_u32 s14, s14, 32768
 s_mov_b32 m0, 104448
 s_nop 0
 buffer_load_dwordx4 v11, s[8:11], s14 offen lds
 s_add_u32 s14, s14, 32768
 s_mov_b32 m0, 105472
 s_nop 0
 buffer_load_dwordx4 v11, s[8:11], s14 offen lds
 s_waitcnt vmcnt(42)
 s_barrier
 v_xor_b32 v16, 0, v12
 v_add_u32 v16, 131072, v16
 ds_read_b64_tr_b16 v[216:217], v16 offset:0
 ds_read_b64_tr_b16 v[218:219], v16 offset:8192
 ds_read_b64_tr_b16 v[220:221], v16 offset:2048
 ds_read_b64_tr_b16 v[222:223], v16 offset:10240
 v_xor_b32 v16, 32, v12
 v_add_u32 v16, 131072, v16
 ds_read_b64_tr_b16 v[224:225], v16 offset:0
 ds_read_b64_tr_b16 v[226:227], v16 offset:8192
 ds_read_b64_tr_b16 v[228:229], v16 offset:2048
 ds_read_b64_tr_b16 v[230:231], v16 offset:10240
 v_xor_b32 v16, 0, v12
 v_add_u32 v16, 131072, v16
 ds_read_b64_tr_b16 v[232:233], v16 offset:16384
 ds_read_b64_tr_b16 v[234:235], v16 offset:24576
 ds_read_b64_tr_b16 v[236:237], v16 offset:18432
 ds_read_b64_tr_b16 v[238:239], v16 offset:26624
 v_xor_b32 v16, 32, v12
 v_add_u32 v16, 131072, v16
 ds_read_b64_tr_b16 v[40:41], v16 offset:16384
 ds_read_b64_tr_b16 v[42:43], v16 offset:24576
 ds_read_b64_tr_b16 v[44:45], v16 offset:18432
 ds_read_b64_tr_b16 v[46:47], v16 offset:26624
 s_add_u32 s3, s63, 10240
 s_waitcnt lgkmcnt(2)
 buffer_store_dwordx4 v[40:43], v1, s[4:7], s3 offen offset:0
 s_waitcnt lgkmcnt(0)
 buffer_store_dwordx4 v[44:47], v1, s[4:7], s3 offen offset:1024
 s_waitcnt lgkmcnt(0)
 s_barrier
 s_lshl_b32 s14, s52, 8
 s_add_u32 s14, s14, 4194304
 s_mov_b32 m0, 131072
 s_nop 0
 buffer_load_dwordx4 v10, s[8:11], s14 offen lds
 s_add_u32 s14, s14, 32768
 s_mov_b32 m0, 132096
 s_nop 0
 buffer_load_dwordx4 v10, s[8:11], s14 offen lds
 s_add_u32 s14, s14, 32768
 s_mov_b32 m0, 133120
 s_nop 0
 buffer_load_dwordx4 v10, s[8:11], s14 offen lds
 s_add_u32 s14, s14, 32768
 s_mov_b32 m0, 134144
 s_nop 0
 buffer_load_dwordx4 v10, s[8:11], s14 offen lds
 s_add_u32 s14, s14, 32768
 s_mov_b32 m0, 135168
 s_nop 0
 buffer_load_dwordx4 v11, s[8:11], s14 offen lds
 s_add_u32 s14, s14, 32768
 s_mov_b32 m0, 136192
 s_nop 0
 buffer_load_dwordx4 v11, s[8:11], s14 offen lds
 s_add_u32 s14, s14, 32768
 s_mov_b32 m0, 137216
 s_nop 0
 buffer_load_dwordx4 v11, s[8:11], s14 offen lds
 s_add_u32 s14, s14, 32768
 s_mov_b32 m0, 138240
 s_nop 0
 buffer_load_dwordx4 v11, s[8:11], s14 offen lds
 s_waitcnt vmcnt(36)
 s_barrier
 v_xor_b32 v16, 0, v12
 v_add_u32 v16, 0, v16
 ds_read_b64_tr_b16 v[240:241], v16 offset:0
 ds_read_b64_tr_b16 v[242:243], v16 offset:8192
 ds_read_b64_tr_b16 v[244:245], v16 offset:2048
 ds_read_b64_tr_b16 v[246:247], v16 offset:10240
 v_xor_b32 v16, 32, v12
 v_add_u32 v16, 0, v16
 ds_read_b64_tr_b16 v[248:249], v16 offset:0
 ds_read_b64_tr_b16 v[250:251], v16 offset:8192
 ds_read_b64_tr_b16 v[252:253], v16 offset:2048
 ds_read_b64_tr_b16 v[254:255], v16 offset:10240
 v_xor_b32 v16, 0, v12
 v_add_u32 v16, 0, v16
 ds_read_b64_tr_b16 v[32:33], v16 offset:16384
 ds_read_b64_tr_b16 v[34:35], v16 offset:24576
 ds_read_b64_tr_b16 v[36:37], v16 offset:18432
 ds_read_b64_tr_b16 v[38:39], v16 offset:26624
 v_xor_b32 v16, 32, v12
 v_add_u32 v16, 0, v16
 ds_read_b64_tr_b16 v[40:41], v16 offset:16384
 ds_read_b64_tr_b16 v[42:43], v16 offset:24576
 ds_read_b64_tr_b16 v[44:45], v16 offset:18432
 ds_read_b64_tr_b16 v[46:47], v16 offset:26624
 s_waitcnt lgkmcnt(0)
 s_barrier
 ds_write_b128 v1, v[224:227] offset:16384
 ds_write_b128 v1, v[228:231] offset:17408
 ds_write_b128 v1, v[216:219] offset:18432
 ds_write_b128 v1, v[220:223] offset:19456
 s_waitcnt lgkmcnt(0)
 v_mov_b32 v224, v32
 v_mov_b32 v225, v33
 v_mov_b32 v226, v34
 v_mov_b32 v227, v35
 v_mov_b32 v228, v36
 v_mov_b32 v229, v37
 v_mov_b32 v230, v38
 v_mov_b32 v231, v39
 v_mov_b32 v216, v40
 v_mov_b32 v217, v41
 v_mov_b32 v218, v42
 v_mov_b32 v219, v43
 v_mov_b32 v220, v44
 v_mov_b32 v221, v45
 v_mov_b32 v222, v46
 v_mov_b32 v223, v47
 s_waitcnt vmcnt(28)
 s_barrier
 v_xor_b32 v16, 0, v12
 v_add_u32 v16, 32768, v16
 ds_read_b64_tr_b16 v[32:33], v16 offset:0
 ds_read_b64_tr_b16 v[34:35], v16 offset:8192
 ds_read_b64_tr_b16 v[36:37], v16 offset:2048
 ds_read_b64_tr_b16 v[38:39], v16 offset:10240
 v_xor_b32 v16, 32, v12
 v_add_u32 v16, 32768, v16
 ds_read_b64_tr_b16 v[40:41], v16 offset:0
 ds_read_b64_tr_b16 v[42:43], v16 offset:8192
 ds_read_b64_tr_b16 v[44:45], v16 offset:2048
 ds_read_b64_tr_b16 v[46:47], v16 offset:10240
 v_xor_b32 v16, 0, v12
 v_add_u32 v16, 32768, v16
 ds_read_b64_tr_b16 v[48:49], v16 offset:16384
 ds_read_b64_tr_b16 v[50:51], v16 offset:24576
 ds_read_b64_tr_b16 v[52:53], v16 offset:18432
 ds_read_b64_tr_b16 v[54:55], v16 offset:26624
 v_xor_b32 v16, 32, v12
 v_add_u32 v16, 32768, v16
 ds_read_b64_tr_b16 v[56:57], v16 offset:16384
 ds_read_b64_tr_b16 v[58:59], v16 offset:24576
 ds_read_b64_tr_b16 v[60:61], v16 offset:18432
 ds_read_b64_tr_b16 v[62:63], v16 offset:26624
 s_waitcnt lgkmcnt(0)
 s_barrier
 ds_write_b128 v1, v[200:203] offset:32768
 ds_write_b128 v1, v[204:207] offset:33792
 ds_write_b128 v1, v[192:195] offset:34816
 ds_write_b128 v1, v[196:199] offset:35840
 ds_write_b128 v1, v[184:187] offset:36864
 ds_write_b128 v1, v[188:191] offset:37888
 ds_write_b128 v1, v[176:179] offset:38912
 ds_write_b128 v1, v[180:183] offset:39936
 s_waitcnt lgkmcnt(0)
 v_mov_b32 v200, v32
 v_mov_b32 v201, v33
 v_mov_b32 v202, v34
 v_mov_b32 v203, v35
 v_mov_b32 v204, v36
 v_mov_b32 v205, v37
 v_mov_b32 v206, v38
 v_mov_b32 v207, v39
 v_mov_b32 v192, v40
 v_mov_b32 v193, v41
 v_mov_b32 v194, v42
 v_mov_b32 v195, v43
 v_mov_b32 v196, v44
 v_mov_b32 v197, v45
 v_mov_b32 v198, v46
 v_mov_b32 v199, v47
 v_mov_b32 v184, v48
 v_mov_b32 v185, v49
 v_mov_b32 v186, v50
 v_mov_b32 v187, v51
 v_mov_b32 v188, v52
 v_mov_b32 v189, v53
 v_mov_b32 v190, v54
 v_mov_b32 v191, v55
 v_mov_b32 v176, v56
 v_mov_b32 v177, v57
 v_mov_b32 v178, v58
 v_mov_b32 v179, v59
 v_mov_b32 v180, v60
 v_mov_b32 v181, v61
 v_mov_b32 v182, v62
 v_mov_b32 v183, v63
 s_waitcnt vmcnt(20)
 s_barrier
 v_xor_b32 v16, 0, v12
 v_add_u32 v16, 65536, v16
 ds_read_b64_tr_b16 v[32:33], v16 offset:0
 ds_read_b64_tr_b16 v[34:35], v16 offset:8192
 ds_read_b64_tr_b16 v[36:37], v16 offset:2048
 ds_read_b64_tr_b16 v[38:39], v16 offset:10240
 v_xor_b32 v16, 32, v12
 v_add_u32 v16, 65536, v16
 ds_read_b64_tr_b16 v[40:41], v16 offset:0
 ds_read_b64_tr_b16 v[42:43], v16 offset:8192
 ds_read_b64_tr_b16 v[44:45], v16 offset:2048
 ds_read_b64_tr_b16 v[46:47], v16 offset:10240
 v_xor_b32 v16, 0, v12
 v_add_u32 v16, 65536, v16
 ds_read_b64_tr_b16 v[48:49], v16 offset:16384
 ds_read_b64_tr_b16 v[50:51], v16 offset:24576
 ds_read_b64_tr_b16 v[52:53], v16 offset:18432
 ds_read_b64_tr_b16 v[54:55], v16 offset:26624
 v_xor_b32 v16, 32, v12
 v_add_u32 v16, 65536, v16
 ds_read_b64_tr_b16 v[56:57], v16 offset:16384
 ds_read_b64_tr_b16 v[58:59], v16 offset:24576
 ds_read_b64_tr_b16 v[60:61], v16 offset:18432
 ds_read_b64_tr_b16 v[62:63], v16 offset:26624
 s_waitcnt lgkmcnt(0)
 s_barrier
 ds_write_b128 v2, v[160:163] offset:0
 ds_write_b128 v2, v[164:167] offset:1024
 ds_write_b128 v2, v[144:147] offset:2048
 ds_write_b128 v2, v[148:151] offset:3072
 ds_write_b128 v2, v[136:139] offset:4096
 ds_write_b128 v2, v[140:143] offset:5120
 ds_write_b128 v2, v[128:131] offset:6144
 ds_write_b128 v2, v[132:135] offset:7168
 s_waitcnt lgkmcnt(0)
 v_mov_b32 v160, v32
 v_mov_b32 v161, v33
 v_mov_b32 v162, v34
 v_mov_b32 v163, v35
 v_mov_b32 v164, v36
 v_mov_b32 v165, v37
 v_mov_b32 v166, v38
 v_mov_b32 v167, v39
 v_mov_b32 v144, v40
 v_mov_b32 v145, v41
 v_mov_b32 v146, v42
 v_mov_b32 v147, v43
 v_mov_b32 v148, v44
 v_mov_b32 v149, v45
 v_mov_b32 v150, v46
 v_mov_b32 v151, v47
 v_mov_b32 v136, v48
 v_mov_b32 v137, v49
 v_mov_b32 v138, v50
 v_mov_b32 v139, v51
 v_mov_b32 v140, v52
 v_mov_b32 v141, v53
 v_mov_b32 v142, v54
 v_mov_b32 v143, v55
 v_mov_b32 v128, v56
 v_mov_b32 v129, v57
 v_mov_b32 v130, v58
 v_mov_b32 v131, v59
 v_mov_b32 v132, v60
 v_mov_b32 v133, v61
 v_mov_b32 v134, v62
 v_mov_b32 v135, v63
 s_waitcnt vmcnt(10)
 s_barrier
 v_xor_b32 v16, 0, v12
 v_add_u32 v16, 98304, v16
 ds_read_b64_tr_b16 v[32:33], v16 offset:0
 ds_read_b64_tr_b16 v[34:35], v16 offset:8192
 ds_read_b64_tr_b16 v[36:37], v16 offset:2048
 ds_read_b64_tr_b16 v[38:39], v16 offset:10240
 v_xor_b32 v16, 32, v12
 v_add_u32 v16, 98304, v16
 ds_read_b64_tr_b16 v[40:41], v16 offset:0
 ds_read_b64_tr_b16 v[42:43], v16 offset:8192
 ds_read_b64_tr_b16 v[44:45], v16 offset:2048
 ds_read_b64_tr_b16 v[46:47], v16 offset:10240
 v_xor_b32 v16, 0, v12
 v_add_u32 v16, 98304, v16
 ds_read_b64_tr_b16 v[48:49], v16 offset:16384
 ds_read_b64_tr_b16 v[50:51], v16 offset:24576
 ds_read_b64_tr_b16 v[52:53], v16 offset:18432
 ds_read_b64_tr_b16 v[54:55], v16 offset:26624
 v_xor_b32 v16, 32, v12
 v_add_u32 v16, 98304, v16
 ds_read_b64_tr_b16 v[56:57], v16 offset:16384
 ds_read_b64_tr_b16 v[58:59], v16 offset:24576
 ds_read_b64_tr_b16 v[60:61], v16 offset:18432
 ds_read_b64_tr_b16 v[62:63], v16 offset:26624
 s_waitcnt lgkmcnt(0)
 s_barrier
 ds_write_b128 v2, a[144:147] offset:32768
 ds_write_b128 v2, a[148:151] offset:33792
 ds_write_b128 v2, a[136:139] offset:34816
 ds_write_b128 v2, a[140:143] offset:35840
 ds_write_b128 v2, a[96:99] offset:36864
 ds_write_b128 v2, a[100:103] offset:37888
 ds_write_b128 v2, a[88:91] offset:38912
 ds_write_b128 v2, a[92:95] offset:39936
 s_waitcnt lgkmcnt(0)
 v_accvgpr_write_b32 a144, v32
 v_accvgpr_write_b32 a145, v33
 v_accvgpr_write_b32 a146, v34
 v_accvgpr_write_b32 a147, v35
 v_accvgpr_write_b32 a148, v36
 v_accvgpr_write_b32 a149, v37
 v_accvgpr_write_b32 a150, v38
 v_accvgpr_write_b32 a151, v39
 v_accvgpr_write_b32 a136, v40
 v_accvgpr_write_b32 a137, v41
 v_accvgpr_write_b32 a138, v42
 v_accvgpr_write_b32 a139, v43
 v_accvgpr_write_b32 a140, v44
 v_accvgpr_write_b32 a141, v45
 v_accvgpr_write_b32 a142, v46
 v_accvgpr_write_b32 a143, v47
 v_accvgpr_write_b32 a96, v48
 v_accvgpr_write_b32 a97, v49
 v_accvgpr_write_b32 a98, v50
 v_accvgpr_write_b32 a99, v51
 v_accvgpr_write_b32 a100, v52
 v_accvgpr_write_b32 a101, v53
 v_accvgpr_write_b32 a102, v54
 v_accvgpr_write_b32 a103, v55
 v_accvgpr_write_b32 a88, v56
 v_accvgpr_write_b32 a89, v57
 v_accvgpr_write_b32 a90, v58
 v_accvgpr_write_b32 a91, v59
 v_accvgpr_write_b32 a92, v60
 v_accvgpr_write_b32 a93, v61
 v_accvgpr_write_b32 a94, v62
 v_accvgpr_write_b32 a95, v63
 s_waitcnt vmcnt(0)
 s_barrier
 v_xor_b32 v16, 0, v12
 v_add_u32 v16, 131072, v16
 ds_read_b64_tr_b16 v[32:33], v16 offset:0
 ds_read_b64_tr_b16 v[34:35], v16 offset:8192
 ds_read_b64_tr_b16 v[36:37], v16 offset:2048
 ds_read_b64_tr_b16 v[38:39], v16 offset:10240
 v_xor_b32 v16, 32, v12
 v_add_u32 v16, 131072, v16
 ds_read_b64_tr_b16 v[40:41], v16 offset:0
 ds_read_b64_tr_b16 v[42:43], v16 offset:8192
 ds_read_b64_tr_b16 v[44:45], v16 offset:2048
 ds_read_b64_tr_b16 v[46:47], v16 offset:10240
 v_xor_b32 v16, 0, v12
 v_add_u32 v16, 131072, v16
 ds_read_b64_tr_b16 v[48:49], v16 offset:16384
 ds_read_b64_tr_b16 v[50:51], v16 offset:24576
 ds_read_b64_tr_b16 v[52:53], v16 offset:18432
 ds_read_b64_tr_b16 v[54:55], v16 offset:26624
 v_xor_b32 v16, 32, v12
 v_add_u32 v16, 131072, v16
 ds_read_b64_tr_b16 v[56:57], v16 offset:16384
 ds_read_b64_tr_b16 v[58:59], v16 offset:24576
 ds_read_b64_tr_b16 v[60:61], v16 offset:18432
 ds_read_b64_tr_b16 v[62:63], v16 offset:26624
 s_waitcnt lgkmcnt(0)
 s_barrier
 ds_write_b128 v3, a[80:83] offset:16384
 ds_write_b128 v3, a[84:87] offset:17408
 ds_write_b128 v3, a[64:67] offset:18432
 ds_write_b128 v3, a[68:71] offset:19456
 ds_write_b128 v3, a[40:43] offset:20480
 ds_write_b128 v3, a[44:47] offset:21504
 ds_write_b128 v3, a[24:27] offset:22528
 ds_write_b128 v3, a[28:31] offset:23552
 s_waitcnt lgkmcnt(0)
 v_accvgpr_write_b32 a80, v32
 v_accvgpr_write_b32 a81, v33
 v_accvgpr_write_b32 a82, v34
 v_accvgpr_write_b32 a83, v35
 v_accvgpr_write_b32 a84, v36
 v_accvgpr_write_b32 a85, v37
 v_accvgpr_write_b32 a86, v38
 v_accvgpr_write_b32 a87, v39
 v_accvgpr_write_b32 a64, v40
 v_accvgpr_write_b32 a65, v41
 v_accvgpr_write_b32 a66, v42
 v_accvgpr_write_b32 a67, v43
 v_accvgpr_write_b32 a68, v44
 v_accvgpr_write_b32 a69, v45
 v_accvgpr_write_b32 a70, v46
 v_accvgpr_write_b32 a71, v47
 v_accvgpr_write_b32 a40, v48
 v_accvgpr_write_b32 a41, v49
 v_accvgpr_write_b32 a42, v50
 v_accvgpr_write_b32 a43, v51
 v_accvgpr_write_b32 a44, v52
 v_accvgpr_write_b32 a45, v53
 v_accvgpr_write_b32 a46, v54
 v_accvgpr_write_b32 a47, v55
 v_accvgpr_write_b32 a24, v56
 v_accvgpr_write_b32 a25, v57
 v_accvgpr_write_b32 a26, v58
 v_accvgpr_write_b32 a27, v59
 v_accvgpr_write_b32 a28, v60
 v_accvgpr_write_b32 a29, v61
 v_accvgpr_write_b32 a30, v62
 v_accvgpr_write_b32 a31, v63
 v_lshlrev_b32 v5, 3, v0
 v_and_b32 v4, 15, v0
 v_lshlrev_b32 v4, 5, v4
 v_lshrrev_b32 v7, 4, v0
 v_lshl_add_u32 v4, v7, 3, v4
 v_add_u32 v4, 10240, v4
 v_and_b32 v6, 0x1e0, v5
 v_and_b32 v7, 1, v0
 v_lshl_add_u32 v6, v7, 4, v6
 v_and_b32 v7, 2, v0
 v_lshl_add_u32 v6, v7, 2, v6
 s_lshl_b32 s59, s53, 16
 s_add_u32 s59, s59, 917504
 s_mul_i32 s15, s53, 327680
 s_add_u32 s15, s15, 225280
 s_lshl_b32 s3, s52, 8
 s_add_u32 s15, s15, s3
 s_add_u32 s64, s15, 0
 s_add_u32 s65, s15, 81920
 s_add_u32 s66, s15, 163840
 s_add_u32 s67, s15, 245760
 s_lshr_b32 s14, s52, 2
 s_and_b32 s15, s52, 3
 s_mov_b32 s16, 0
 s_mov_b32 s84, 0x00ff00ff
 s_mov_b32 s85, 0
 s_lshl_b32 s57, s14, 10
 s_lshl_b32 s3, s15, 6
 s_add_u32 s57, s57, s3
 s_lshl_b32 s3, s16, 8
 s_add_u32 s57, s57, s3
 s_add_u32 s57, s57, s59
 s_add_u32 s59, s59, 0
 s_lshl_b32 s14, s14, 7
 s_mul_i32 s15, s15, 2560
 s_add_u32 s14, s14, s15
 s_lshl_b32 s3, s16, 3
 s_add_u32 s14, s14, s3
 s_mov_b32 s8, s18
 s_and_b32 s9, s19, 0xffff
 s_mov_b32 s10, 10240
 s_mov_b32 s11, 0x00020000
 v_bfe_u32 v40, v0, 4, 1
 v_mul_u32_u24 v40, 1280, v40
 v_and_b32 v41, 7, v0
 v_lshl_add_u32 v40, v41, 1, v40
 buffer_load_ushort v44, v40, s[8:11], s14 offen offset:0
 buffer_load_ushort v45, v40, s[8:11], s14 offen offset:32
 buffer_load_ushort v46, v40, s[8:11], s14 offen offset:64
 buffer_load_ushort v47, v40, s[8:11], s14 offen offset:96
 v_lshrrev_b32 v42, 7, v1
 v_mul_u32_u24 v42, 10240, v42
 v_and_b32 v7, 112, v1
 v_add_u32 v42, v42, v7
 v_and_b32 v43, 32, v1
 v_and_b32 v7, 64, v1
 v_lshl_add_u32 v43, v7, 2, v43
 v_bfe_u32 v7, v1, 8, 1
 v_lshl_add_u32 v43, v7, 4, v43
 v_and_b32 v7, 8, v5
 v_add_u32 v43, v43, v7
 s_waitcnt vmcnt(2)
 v_lshl_or_b32 v44, v45, 16, v44
 s_waitcnt vmcnt(0)
 v_lshl_or_b32 v45, v47, 16, v46
 s_waitcnt vmcnt(0) lgkmcnt(0)
 s_mov_b32 s96, s44
 s_and_b32 s97, s45, 0xffff
 s_mov_b32 s98, 256
 s_mov_b32 s99, 0x00020000
 v_mov_b32 v8, 132
 s_mov_b32 s51, 0
 s_mov_b64 exec, 1
L_wb_159:
 buffer_load_dword v9, v8, s[96:99], 0 offen sc1
 s_waitcnt vmcnt(0)
 v_cmp_eq_u32 vcc, 0, v9
 s_cbranch_vccz L_wbd_160
 s_sleep 2
 s_add_u32 s51, s51, 1
 s_cmp_lt_u32 s51, 131072
 s_cbranch_scc1 L_wb_159
 s_branch L_bail
L_wbd_160:
 s_mov_b64 exec, -1
 s_mov_b32 s96, s44
 s_and_b32 s97, s45, 0xffff
 s_mov_b32 s98, 256
 s_mov_b32 s99, 0x00020000
 v_mov_b32 v8, 212
 s_mov_b32 s51, 0
 s_mov_b64 exec, 1
L_wb_161:
 buffer_load_dword v9, v8, s[96:99], 0 offen sc1
 s_waitcnt vmcnt(0)
 v_cmp_eq_u32 vcc, 0, v9
 s_cbranch_vccz L_wbd_162
 s_sleep 2
 s_add_u32 s51, s51, 1
 s_cmp_lt_u32 s51, 131072
 s_cbranch_scc1 L_wb_161
 s_branch L_bail
L_wbd_162:
 s_mov_b64 exec, -1
 s_mov_b32 s96, s44
 s_and_b32 s97, s45, 0xffff
 s_mov_b32 s98, 256
 s_mov_b32 s99, 0x00020000
 v_lshlrev_b32 v8, 5, v0
 s_mov_b32 s51, 0
L_gl_163:
 buffer_load_dword v9, v8, s[96:99], 0 offen sc1
 s_waitcnt vmcnt(0)
 v_readlane_b32 s3, v9, s48
 s_mov_b32 s80, 0
 s_nop 2
 s_cmp_ge_u32 s3, 32
 s_cbranch_scc1 L_gld_164
 s_mov_b32 s80, 0
 v_readlane_b32 s3, v9, 0
 s_nop 3
 s_add_u32 s80, s80, s3
 v_readlane_b32 s3, v9, 1
 s_nop 3
 s_add_u32 s80, s80, s3
 v_readlane_b32 s3, v9, 2
 s_nop 3
 s_add_u32 s80, s80, s3
 v_readlane_b32 s3, v9, 3
 s_nop 3
 s_add_u32 s80, s80, s3
 v_readlane_b32 s3, v9, 4
 s_nop 3
 s_add_u32 s80, s80, s3
 v_readlane_b32 s3, v9, 5
 s_nop 3
 s_add_u32 s80, s80, s3
 v_readlane_b32 s3, v9, 6
 s_nop 3
 s_add_u32 s80, s80, s3
 v_readlane_b32 s3, v9, 7
 s_nop 3
 s_add_u32 s80, s80, s3
 s_cmp_ge_u32 s80, 256
 s_cbranch_scc1 L_gld_164
 s_sleep 4
 s_add_u32 s51, s51, 1
 s_cmp_lt_u32 s51, 131072
 s_cbranch_scc1 L_gl_163
 s_branch L_bail
L_gld_164:
 s_mov_b64 exec, s[84:85]
 buffer_store_dwordx2 v[44:45], v43, s[4:7], s57 offen sc1
 s_mov_b64 exec, -1
 v_and_b32 v7, 2, v0
 v_mul_u32_u24 v7, 0x5555, v7
 v_add_u32 v0, 0x4444, v7
 s_mov_b32 m0, 2048
 s_waitcnt vmcnt(0) lgkmcnt(0)
 s_barrier
 buffer_load_dwordx4 v[32:35], v1, s[4:7], s63 offen offset:0
 buffer_load_dwordx4 v[36:39], v1, s[4:7], s63 offen offset:1024
 buffer_load_dwordx4 v[40:43], v1, s[4:7], s63 offen offset:2048
 buffer_load_dwordx4 v[44:47], v1, s[4:7], s63 offen offset:3072
 s_add_u32 s3, s63, 4096
 buffer_load_dwordx4 v[48:51], v1, s[4:7], s3 offen offset:0
 buffer_load_dwordx4 v[52:55], v1, s[4:7], s3 offen offset:1024
 s_add_u32 s3, s63, 4096
 buffer_load_dwordx4 v[56:59], v1, s[4:7], s3 offen offset:2048
 buffer_load_dwordx4 v[60:63], v1, s[4:7], s3 offen offset:3072
 ds_read_b128 v[8:11], v3 offset:49152
 ds_read_b128 v[12:15], v3 offset:49152
 ds_read_b128 v[16:19], v3 offset:49152
 ds_read_b128 v[20:23], v3 offset:49152
 s_waitcnt vmcnt(0) lgkmcnt(0)
 s_cmp_lg_u32 s80, 0
 s_cbranch_scc1 L_ch0_s
.p2align 6
L_ch0_f:
 s_mov_b32 s51, 0
L_pm_165:
 buffer_load_dwordx4 v[24:27], v1, s[4:7], s59 offen offset:0 sc1
 buffer_load_dwordx4 v[28:31], v1, s[4:7], s59 offen offset:1024 sc1
 s_waitcnt vmcnt(1)
 ds_write_b128 v1, v[24:27] offset:0
 v_max_u32 v7, v24, v26
 s_waitcnt vmcnt(0)
 ds_write_b128 v1, v[28:31] offset:1024
 v_max3_u32 v7, v7, v28, v30
 v_cmp_eq_u32 vcc, -1, v7
 s_cbranch_vccnz L_rt_166
 v_smfmac_f32_16x16x64_bf16 v[16:19], v[24:27], v[32:39], v0
 ds_read_b128 v[32:35], v2 offset:6144
 ds_read_b128 v[36:39], v2 offset:7168
 v_smfmac_f32_16x16x64_bf16 v[20:23], v[24:27], v[40:47], v0
 ds_read_b128 v[40:43], v2 offset:4096
 ds_read_b128 v[44:47], v2 offset:5120
 v_smfmac_f32_16x16x64_bf16 v[16:19], v[28:31], v[48:55], v0
 v_smfmac_f32_16x16x64_bf16 v[20:23], v[28:31], v[56:63], v0
 s_waitcnt lgkmcnt(4)
 s_barrier
 s_add_u32 s3, s63, 8192
 buffer_load_dwordx4 v[56:59], v1, s[4:7], s3 offen offset:0
 buffer_load_dwordx4 v[60:63], v1, s[4:7], s3 offen offset:1024
 s_add_u32 s3, s63, 8192
 buffer_load_dwordx4 v[48:51], v1, s[4:7], s3 offen offset:2048
 buffer_load_dwordx4 v[52:55], v1, s[4:7], s3 offen offset:3072
 v_smfmac_f32_16x16x64_bf16 v[8:11], v[24:27], v[240:247], v0
 v_smfmac_f32_16x16x64_bf16 v[8:11], v[28:31], v[224:231], v0
 v_smfmac_f32_16x16x64_bf16 v[12:15], v[24:27], v[248:255], v0
 ds_read_b128 v[24:27], v1 offset:2048
 v_smfmac_f32_16x16x64_bf16 v[12:15], v[28:31], v[216:223], v0
 ds_read_b128 v[28:31], v1 offset:3072
 s_waitcnt lgkmcnt(1)
 v_smfmac_f32_16x16x64_bf16 v[16:19], v[24:27], v[32:39], v0
 ds_read_b128 v[32:35], v2 offset:2048
 ds_read_b128 v[36:39], v2 offset:3072
 v_smfmac_f32_16x16x64_bf16 v[8:11], v[24:27], v[200:207], v0
 v_smfmac_f32_16x16x64_bf16 v[12:15], v[24:27], v[192:199], v0
 v_smfmac_f32_16x16x64_bf16 v[20:23], v[24:27], v[40:47], v0
 ds_read_b128 v[40:43], v2 offset:0
 ds_read_b128 v[44:47], v2 offset:1024
 ds_read_b128 v[24:27], v1 offset:4096
 s_waitcnt lgkmcnt(5)
 v_smfmac_f32_16x16x64_bf16 v[8:11], v[28:31], v[184:191], v0
 v_smfmac_f32_16x16x64_bf16 v[12:15], v[28:31], v[176:183], v0
 s_waitcnt lgkmcnt(3)
 v_smfmac_f32_16x16x64_bf16 v[16:19], v[28:31], v[32:39], v0
 ds_read_b128 v[32:35], v1 offset:38912
 ds_read_b128 v[36:39], v1 offset:39936
 v_smfmac_f32_16x16x64_bf16 v[20:23], v[28:31], v[152:159], v0
 ds_read_b128 v[28:31], v1 offset:5120
 s_waitcnt lgkmcnt(3)
 v_smfmac_f32_16x16x64_bf16 v[8:11], v[24:27], v[160:167], v0
 v_smfmac_f32_16x16x64_bf16 v[16:19], v[24:27], v[40:47], v0
 ds_read_b128 v[40:43], v1 offset:36864
 ds_read_b128 v[44:47], v1 offset:37888
 v_smfmac_f32_16x16x64_bf16 v[12:15], v[24:27], v[144:151], v0
 v_smfmac_f32_16x16x64_bf16 v[20:23], v[24:27], v[168:175], v0
 ds_read_b128 v[24:27], v1 offset:6144
 s_waitcnt lgkmcnt(3)
 v_smfmac_f32_16x16x64_bf16 v[16:19], v[28:31], v[32:39], v0
 ds_read_b128 v[32:35], v1 offset:34816
 ds_read_b128 v[36:39], v1 offset:35840
 v_smfmac_f32_16x16x64_bf16 v[8:11], v[28:31], v[136:143], v0
 v_smfmac_f32_16x16x64_bf16 v[12:15], v[28:31], v[128:135], v0
 s_waitcnt lgkmcnt(3)
 v_smfmac_f32_16x16x64_bf16 v[20:23], v[28:31], v[40:47], v0
 ds_read_b128 v[40:43], v1 offset:32768
 ds_read_b128 v[44:47], v1 offset:33792
 ds_read_b128 v[28:31], v1 offset:7168
 s_waitcnt lgkmcnt(5)
 v_smfmac_f32_16x16x64_bf16 v[8:11], v[24:27], a[144:151], v0
 v_smfmac_f32_16x16x64_bf16 v[12:15], v[24:27], a[136:143], v0
 s_waitcnt lgkmcnt(3)
 v_smfmac_f32_16x16x64_bf16 v[16:19], v[24:27], v[32:39], v0
 ds_read_b128 v[32:35], v1 offset:18432
 ds_read_b128 v[36:39], v1 offset:19456
 s_waitcnt vmcnt(2)
 v_smfmac_f32_16x16x64_bf16 v[20:23], v[24:27], v[56:63], v0
 s_add_u32 s3, s61, 4096
 buffer_load_dwordx4 v[56:59], v1, s[4:7], s61 offen offset:0 sc1
 buffer_load_dwordx4 v[60:63], v1, s[4:7], s3 offen offset:0 sc1
 ds_read_b128 v[24:27], v1 offset:8192
 s_waitcnt lgkmcnt(3)
 v_smfmac_f32_16x16x64_bf16 v[8:11], v[28:31], a[96:103], v0
 v_smfmac_f32_16x16x64_bf16 v[16:19], v[28:31], v[40:47], v0
 ds_read_b128 v[40:43], v1 offset:16384
 ds_read_b128 v[44:47], v1 offset:17408
 v_smfmac_f32_16x16x64_bf16 v[12:15], v[28:31], a[88:95], v0
 v_smfmac_f32_16x16x64_bf16 v[20:23], v[28:31], v[208:215], v0
 ds_read_b128 v[28:31], v1 offset:9216
 s_waitcnt lgkmcnt(3)
 v_smfmac_f32_16x16x64_bf16 v[16:19], v[24:27], v[32:39], v0
 s_add_u32 s3, s61, 67108864
 buffer_load_dwordx4 v[32:35], v1, s[4:7], s3 offen offset:0 sc1
 buffer_load_dwordx4 v[36:39], v1, s[4:7], s3 offen offset:1024 sc1
 v_smfmac_f32_16x16x64_bf16 v[8:11], v[24:27], a[80:87], v0
 v_smfmac_f32_16x16x64_bf16 v[12:15], v[24:27], a[64:71], v0
 s_waitcnt lgkmcnt(1)
 v_smfmac_f32_16x16x64_bf16 v[20:23], v[24:27], v[40:47], v0
 ds_read_b128 v[40:43], v3 offset:49152
 ds_read_b128 v[44:47], v3 offset:49152
 s_waitcnt lgkmcnt(2)
 v_smfmac_f32_16x16x64_bf16 v[8:11], v[28:31], a[40:47], v0
 v_smfmac_f32_16x16x64_bf16 v[12:15], v[28:31], a[24:31], v0
 v_smfmac_f32_16x16x64_bf16 v[16:19], v[28:31], v[232:239], v0
 s_waitcnt vmcnt(4)
 v_smfmac_f32_16x16x64_bf16 v[20:23], v[28:31], v[48:55], v0
 ds_read_b128 v[52:55], v1 offset:0
 v_add_f32 v8, v8, v10
 v_add_f32 v9, v9, v11
 v_cvt_pk_bf16_f32 v8, v8, v9
 v_add_f32 v12, v12, v14
 v_add_f32 v13, v13, v15
 v_cvt_pk_bf16_f32 v12, v12, v13
 ds_write2_b32 v4, v8, v8 offset0:0 offset1:1
 ds_write2_b32 v4, v12, v12 offset0:128 offset1:129
 ds_read_b64_tr_b16 v[12:13], v5 offset:10240
 ds_read_b64_tr_b16 v[14:15], v5 offset:10752
 v_add_f32 v16, v16, v18
 v_add_f32 v17, v17, v19
 v_cvt_pk_bf16_f32 v16, v16, v17
 v_add_f32 v20, v20, v22
 v_add_f32 v21, v21, v23
 v_cvt_pk_bf16_f32 v20, v20, v21
 ds_write2_b32 v4, v16, v20 offset0:0 offset1:128
 ds_read_b64_tr_b16 v[20:21], v5 offset:10240
 ds_read_b64_tr_b16 v[22:23], v5 offset:10752
 s_waitcnt lgkmcnt(9)
 v_smfmac_f32_16x16x64_bf16 v[40:43], v[24:27], v[96:103], v0
 s_waitcnt lgkmcnt(8)
 v_smfmac_f32_16x16x64_bf16 v[44:47], v[24:27], v[104:111], v0
 ds_read_b128 v[24:27], v1 offset:1024
 v_smfmac_f32_16x16x64_bf16 v[40:43], v[28:31], v[112:119], v0
 v_smfmac_f32_16x16x64_bf16 v[44:47], v[28:31], v[120:127], v0
 ds_read_b128 v[28:31], v1 offset:2048
 s_waitcnt vmcnt(3) lgkmcnt(5)
 v_mfma_f32_16x16x32_bf16 v[8:11], v[56:59], v[12:15], 0
 s_waitcnt vmcnt(2) lgkmcnt(4)
 v_mfma_f32_16x16x32_bf16 v[16:19], v[60:63], v[12:15], 0
 s_waitcnt lgkmcnt(2)
 v_mfma_f32_16x16x32_bf16 v[48:51], v[20:23], v[12:15], 0
 v_smfmac_f32_16x16x64_bf16 v[40:43], v[52:55], a[160:167], v0
 v_smfmac_f32_16x16x64_bf16 v[44:47], v[52:55], a[168:175], v0
 ds_read_b128 v[52:55], v1 offset:3072
 s_waitcnt lgkmcnt(2)
 v_smfmac_f32_16x16x64_bf16 v[40:43], v[24:27], a[176:183], v0
 v_cndmask_b32 v8, v8, v16, s[70:71]
 v_cndmask_b32 v9, v9, v17, s[70:71]
 v_cndmask_b32 v10, v10, v18, s[70:71]
 v_cndmask_b32 v11, v11, v19, s[70:71]
 ds_write_b128 v1, v[8:11] offset:10240
 ds_write_b64 v1, v[48:49] offset:14336
 v_smfmac_f32_16x16x64_bf16 v[44:47], v[24:27], a[184:191], v0
 ds_read_b128 v[24:27], v1 offset:4096
 s_waitcnt lgkmcnt(4)
 v_smfmac_f32_16x16x64_bf16 v[40:43], v[28:31], a[192:199], v0
 v_smfmac_f32_16x16x64_bf16 v[44:47], v[28:31], a[200:207], v0
 ds_read_b128 v[28:31], v1 offset:5120
 s_waitcnt lgkmcnt(4)
 v_smfmac_f32_16x16x64_bf16 v[40:43], v[52:55], a[208:215], v0
 v_smfmac_f32_16x16x64_bf16 v[44:47], v[52:55], a[216:223], v0
 ds_read_b128 v[52:55], v1 offset:6144
 s_waitcnt lgkmcnt(2)
 v_smfmac_f32_16x16x64_bf16 v[40:43], v[24:27], a[224:231], v0
 s_barrier
 ds_read_b128 v[56:59], v1 offset:11264
 ds_read_b128 v[60:63], v1 offset:12288
 ds_read_b128 v[16:19], v1 offset:13312
 ds_read_b128 v[12:15], v1 offset:14336
 ds_read_b128 v[48:51], v1 offset:15360
 v_smfmac_f32_16x16x64_bf16 v[44:47], v[24:27], a[232:239], v0
 ds_read_b128 v[24:27], v1 offset:7168
 s_mov_b64 exec, s[68:69]
 buffer_store_dwordx4 v[20:23], v6, s[4:7], s62 offen offset:0 sc1
 s_mov_b64 exec, -1
 s_waitcnt lgkmcnt(7)
 v_smfmac_f32_16x16x64_bf16 v[40:43], v[28:31], a[240:247], v0
 v_smfmac_f32_16x16x64_bf16 v[44:47], v[28:31], a[248:255], v0
 s_waitcnt lgkmcnt(6)
 v_smfmac_f32_16x16x64_bf16 v[40:43], v[52:55], v[64:71], v0
 v_smfmac_f32_16x16x64_bf16 v[44:47], v[52:55], v[72:79], v0
 s_waitcnt lgkmcnt(0)
 v_smfmac_f32_16x16x64_bf16 v[40:43], v[24:27], v[80:87], v0
 v_smfmac_f32_16x16x64_bf16 v[44:47], v[24:27], v[88:95], v0
 v_pk_add_f32 v[8:9], v[8:9], v[56:57]
 v_pk_add_f32 v[10:11], v[10:11], v[58:59]
 v_pk_add_f32 v[60:61], v[60:61], v[16:17]
 v_pk_add_f32 v[62:63], v[62:63], v[18:19]
 v_pk_add_f32 v[12:13], v[12:13], v[14:15]
 v_pk_add_f32 v[48:49], v[48:49], v[50:51]
 v_pk_add_f32 v[8:9], v[8:9], v[60:61]
 v_pk_add_f32 v[10:11], v[10:11], v[62:63]
 v_pk_add_f32 v[48:49], v[12:13], v[48:49]
 v_max3_f32 v50, v8, v9, v10
 v_max3_f32 v50, v50, v11, v48
 v_max_f32 v50, v50, v49
 v_add_f32 v40, v40, v42
 v_add_f32 v41, v41, v43
 v_max_f32_dpp v50, v50, v50 quad_perm:[2,3,0,1] row_mask:0xf bank_mask:0xf
 v_mov_b32 v51, v50
 v_add_f32 v44, v44, v46
 v_add_f32 v45, v45, v47
 v_permlane16_swap_b32 v50, v51
 v_max_f32 v50, v50, v51
 v_mov_b32 v51, v50
 v_cvt_pk_bf16_f32 v40, v40, v41
 v_cvt_pk_bf16_f32 v41, v44, v45
 v_permlane32_swap_b32 v50, v51
 v_max_f32 v50, v50, v51
 v_mul_f32 v50, s56, v50
 v_fma_f32 v48, v48, s56, -v50
 v_fma_f32 v49, v49, s56, -v50
 v_fma_f32 v8, v8, s56, -v50
 v_fma_f32 v9, v9, s56, -v50
 v_fma_f32 v10, v10, s56, -v50
 v_fma_f32 v11, v11, s56, -v50
 v_exp_f32 v48, v48
 v_exp_f32 v49, v49
 ds_read_b128 v[56:59], v3 offset:18432
 ds_read_b128 v[60:63], v3 offset:19456
 v_exp_f32 v8, v8
 v_exp_f32 v9, v9
 ds_read_b128 v[24:27], v2 offset:36864
 ds_read_b128 v[28:31], v2 offset:37888
 v_exp_f32 v10, v10
 buffer_store_dwordx2 v[40:41], v5, s[4:7], s62 offen offset:2048 sc1
 v_exp_f32 v11, v11
 v_cvt_pk_bf16_f32 v14, v48, v49
 v_cvt_pk_bf16_f32 v12, v8, v9
 v_cvt_pk_bf16_f32 v13, v10, v11
 v_cndmask_b32 v52, 0, v14, s[68:69]
 v_cndmask_b32 v53, 0, v14, s[70:71]
 v_cndmask_b32 v22, 0, v12, s[70:71]
 v_cndmask_b32 v23, 0, v13, s[70:71]
 v_mfma_f32_16x16x16_bf16 v[44:47], v[40:41], v[52:53], 0
 v_cndmask_b32 v16, 0, v12, s[68:69]
 v_cndmask_b32 v17, 0, v13, s[68:69]
 v_mov_b32_dpp v18, v22 quad_perm:[2,3,0,1] row_mask:0xf bank_mask:0xf
 v_mov_b32_dpp v19, v23 quad_perm:[2,3,0,1] row_mask:0xf bank_mask:0xf
 v_mov_b32_dpp v20, v16 quad_perm:[2,3,0,1] row_mask:0xf bank_mask:0xf
 v_mov_b32_dpp v21, v17 quad_perm:[2,3,0,1] row_mask:0xf bank_mask:0xf
 s_waitcnt vmcnt(3)
 v_mfma_f32_16x16x32_bf16 v[44:47], v[32:35], v[16:19], v[44:47]
 v_add_f32 v54, v8, v9
 v_add_f32 v55, v48, v49
 s_waitcnt vmcnt(2)
 v_mfma_f32_16x16x32_bf16 v[44:47], v[36:39], v[20:23], v[44:47]
 v_add_f32 v54, v54, v10
 v_fma_f32 v55, v55, 0.5, v11
 v_add_f32 v54, v54, v55
 ds_read_b128 v[16:19], v3 offset:49152
 ds_read_b128 v[20:23], v3 offset:49152
 v_add_f32_dpp v54, v54, v54 quad_perm:[2,3,0,1] row_mask:0xf bank_mask:0xf
 v_mov_b32 v55, v54
 ds_read_b128 v[32:35], v3 offset:49152
 ds_read_b128 v[36:39], v3 offset:49152
 v_permlane16_swap_b32 v54, v55
 v_add_f32 v54, v54, v55
 v_mov_b32 v55, v54
 ds_read_b128 v[8:11], v3 offset:49152
 s_cmp_eq_u32 s54, 63
 v_permlane32_swap_b32 v54, v55
 v_add_f32 v54, v54, v55
 v_rcp_f32 v54, v54
 s_cbranch_scc1 L_ch0_end
 v_mul_f32 v44, v44, v54
 v_mul_f32 v45, v45, v54
 v_cvt_pk_bf16_f32 v42, v44, v45
 v_mul_f32 v46, v46, v54
 v_mul_f32 v47, v47, v54
 v_cvt_pk_bf16_f32 v43, v46, v47
 ds_write_b64 v6, v[42:43] offset:0
 v_and_b32 v40, -9, v6
 v_mov_b32_dpp v12, v42 quad_perm:[0,1,0,1] row_mask:0xf bank_mask:0xf
 v_mov_b32_dpp v14, v42 quad_perm:[2,3,2,3] row_mask:0xf bank_mask:0xf
 v_mov_b32_dpp v13, v43 quad_perm:[0,1,0,1] row_mask:0xf bank_mask:0xf
 v_mov_b32_dpp v15, v43 quad_perm:[2,3,2,3] row_mask:0xf bank_mask:0xf
 s_waitcnt lgkmcnt(5)
 s_nop 0
 v_smfmac_f32_16x16x64_bf16 v[16:19], v[12:15], a[0:7], v0
 s_waitcnt lgkmcnt(4)
 v_smfmac_f32_16x16x64_bf16 v[20:23], v[12:15], a[32:39], v0
 s_waitcnt lgkmcnt(0)
 s_barrier
 ds_read_b128 v[48:51], v40 offset:512
 ds_read_b128 v[52:55], v40 offset:1024
 ds_read_b128 v[44:47], v40 offset:1536
 v_smfmac_f32_16x16x64_bf16 v[32:35], v[12:15], v[56:63], v0
 ds_read_b128 v[56:59], v3 offset:22528
 ds_read_b128 v[60:63], v3 offset:23552
 v_smfmac_f32_16x16x64_bf16 v[36:39], v[12:15], v[24:31], v0
 ds_read_b128 v[24:27], v3 offset:20480
 ds_read_b128 v[28:31], v3 offset:21504
 v_smfmac_f32_16x16x64_bf16 v[8:11], v[12:15], a[128:135], v0
 s_waitcnt lgkmcnt(6)
 v_smfmac_f32_16x16x64_bf16 v[16:19], v[48:51], a[8:15], v0
 s_waitcnt lgkmcnt(5)
 v_smfmac_f32_16x16x64_bf16 v[16:19], v[52:55], a[16:23], v0
 s_waitcnt lgkmcnt(2)
 v_smfmac_f32_16x16x64_bf16 v[16:19], v[44:47], v[56:63], v0
 ds_read_b128 v[56:59], v3 offset:16384
 ds_read_b128 v[60:63], v3 offset:17408
 s_waitcnt lgkmcnt(2)
 v_smfmac_f32_16x16x64_bf16 v[20:23], v[48:51], v[24:31], v0
 ds_read_b128 v[24:27], v2 offset:38912
 ds_read_b128 v[28:31], v2 offset:39936
 v_smfmac_f32_16x16x64_bf16 v[20:23], v[52:55], a[48:55], v0
 v_smfmac_f32_16x16x64_bf16 v[20:23], v[44:47], a[56:63], v0
 v_cvt_pk_bf16_f32 v16, v16, v17
 v_smfmac_f32_16x16x64_bf16 v[32:35], v[48:51], a[72:79], v0
 v_cvt_pk_bf16_f32 v17, v18, v19
 s_waitcnt lgkmcnt(2)
 v_smfmac_f32_16x16x64_bf16 v[32:35], v[52:55], v[56:63], v0
 ds_read_b128 v[56:59], v2 offset:34816
 ds_read_b128 v[60:63], v2 offset:35840
 v_and_or_b32 v16, v16, -2, s55
 s_waitcnt lgkmcnt(2)
 v_smfmac_f32_16x16x64_bf16 v[32:35], v[44:47], v[24:31], v0
 ds_read_b128 v[24:27], v2 offset:32768
 ds_read_b128 v[28:31], v2 offset:33792
 v_cvt_pk_bf16_f32 v18, v20, v21
 v_smfmac_f32_16x16x64_bf16 v[36:39], v[48:51], a[104:111], v0
 v_cvt_pk_bf16_f32 v19, v22, v23
 v_smfmac_f32_16x16x64_bf16 v[36:39], v[52:55], a[112:119], v0
 v_and_or_b32 v18, v18, -2, s55
 buffer_store_dwordx4 v[16:19], v1, s[4:7], s60 offen offset:0
 v_smfmac_f32_16x16x64_bf16 v[36:39], v[44:47], a[120:127], v0
 v_cvt_pk_bf16_f32 v32, v32, v33
 s_waitcnt lgkmcnt(2)
 v_smfmac_f32_16x16x64_bf16 v[8:11], v[48:51], v[56:63], v0
 v_cvt_pk_bf16_f32 v33, v34, v35
 s_waitcnt lgkmcnt(0)
 v_smfmac_f32_16x16x64_bf16 v[8:11], v[52:55], v[24:31], v0
 v_and_or_b32 v32, v32, -2, s55
 v_smfmac_f32_16x16x64_bf16 v[8:11], v[44:47], a[152:159], v0
 v_cvt_pk_bf16_f32 v34, v36, v37
 v_cvt_pk_bf16_f32 v35, v38, v39
 v_and_or_b32 v34, v34, -2, s55
 buffer_store_dwordx4 v[32:35], v1, s[4:7], s60 offen offset:1024
 s_add_u32 s3, s60, 8192
 s_nop 2
 v_cvt_pk_bf16_f32 v8, v8, v9
 v_cvt_pk_bf16_f32 v9, v10, v11
 v_and_or_b32 v8, v8, -2, s55
 buffer_store_dwordx2 v[8:9], v1, s[4:7], s3 offen offset:0
 buffer_load_dwordx4 v[32:35], v1, s[4:7], s63 offen offset:0
 buffer_load_dwordx4 v[36:39], v1, s[4:7], s63 offen offset:1024
 s_add_u32 s54, s54, 1
 s_add_u32 s61, s61, 524288
 s_and_b32 s3, s54, 7
 s_cselect_b32 s3, 1, -7
 s_lshl_b32 s3, s3, 17
 s_add_u32 s62, s62, s3
 s_and_b32 s3, s54, 3
 s_cselect_b32 s3, 1, -3
 s_lshl_b32 s3, s3, 14
 s_add_u32 s58, s57, s3
 s_add_u32 s59, s59, s3
 v_lshrrev_b32 v56, 7, v1
 v_mul_u32_u24 v56, 10240, v56
 v_and_b32 v60, 112, v1
 v_add_u32 v56, v56, v60
 v_and_b32 v57, 32, v1
 v_and_b32 v60, 64, v1
 v_lshl_add_u32 v57, v60, 2, v57
 v_bfe_u32 v60, v1, 8, 1
 v_lshl_add_u32 v57, v60, 4, v57
 v_and_b32 v60, 8, v5
 v_add_u32 v57, v57, v60
 v_mov_b32 v60, 0x3f80
 v_mov_b32 v28, 0x3f800000
 v_cndmask_b32 v60, v60, v28, s[82:83]
 v_cndmask_b32 v28, 0, v60, s[72:73]
 v_cndmask_b32 v29, 0, v60, s[74:75]
 v_cndmask_b32 v30, 0, v60, s[76:77]
 v_cndmask_b32 v31, 0, v60, s[78:79]
 v_mov_b64 v[58:59], -1
 s_nop 15
 s_nop 15
 s_nop 15
 s_nop 1
 s_mov_b32 s51, 0
L_pp_167:
 buffer_load_dwordx4 v[8:11], v56, s[4:7], s64 offen sc1
 buffer_load_dwordx4 v[12:15], v56, s[4:7], s65 offen sc1
 buffer_load_dwordx4 v[16:19], v56, s[4:7], s66 offen sc1
 buffer_load_dwordx4 v[20:23], v56, s[4:7], s67 offen sc1
 s_waitcnt vmcnt(3)
 v_mfma_f32_16x16x32_bf16 v[24:27], v[28:31], v[8:11], 0
 v_bitop3_b32 v60, v8, v10, s55 bitop3:0x7e
 s_waitcnt vmcnt(2)
 v_mfma_f32_16x16x32_bf16 v[24:27], v[28:31], v[12:15], v[24:27]
 v_bitop3_b32 v61, v12, v14, s55 bitop3:0x7e
 s_waitcnt vmcnt(1)
 v_mfma_f32_16x16x32_bf16 v[24:27], v[28:31], v[16:19], v[24:27]
 v_bitop3_b32 v62, v16, v18, s55 bitop3:0x7e
 s_waitcnt vmcnt(0)
 v_mfma_f32_16x16x32_bf16 v[24:27], v[28:31], v[20:23], v[24:27]
 v_bitop3_b32 v63, v20, v22, s55 bitop3:0x7e
 v_or3_b32 v7, v60, v61, v62
 v_bitop3_b32 v7, v7, v63, 1 bitop3:0xa8
 v_cmp_ne_u32 vcc, 0, v7
 s_cbranch_vccnz L_rt_168
 s_nop 2
 v_add_f32_dpp v24, v24, v24 row_ror:8 row_mask:0xf bank_mask:0xf
 v_add_f32_dpp v25, v25, v25 row_ror:8 row_mask:0xf bank_mask:0xf
 v_add_f32_dpp v26, v26, v26 row_ror:8 row_mask:0xf bank_mask:0xf
 v_add_f32_dpp v27, v27, v27 row_ror:8 row_mask:0xf bank_mask:0xf
 s_mov_b64 exec, s[84:85]
 v_cvt_pk_bf16_f32 v24, v24, v25
 v_cvt_pk_bf16_f32 v25, v26, v27
 buffer_store_dwordx2 v[24:25], v57, s[4:7], s58 offen
 buffer_store_dwordx2 v[58:59], v57, s[4:7], s57 offen
 s_mov_b64 exec, -1
 s_mov_b32 s57, s58
 s_xor_b32 s55, s55, 1
 buffer_load_dwordx4 v[40:43], v1, s[4:7], s63 offen offset:2048
 buffer_load_dwordx4 v[44:47], v1, s[4:7], s63 offen offset:3072
 s_add_u32 s3, s63, 4096
 buffer_load_dwordx4 v[48:51], v1, s[4:7], s3 offen offset:0
 buffer_load_dwordx4 v[52:55], v1, s[4:7], s3 offen offset:1024
 s_add_u32 s3, s63, 4096
 buffer_load_dwordx4 v[56:59], v1, s[4:7], s3 offen offset:2048
 buffer_load_dwordx4 v[60:63], v1, s[4:7], s3 offen offset:3072
 ds_read_b128 v[8:11], v3 offset:49152
 ds_read_b128 v[12:15], v3 offset:49152
 ds_read_b128 v[16:19], v3 offset:49152
 ds_read_b128 v[20:23], v3 offset:49152
 s_waitcnt lgkmcnt(0)
 s_nop 15
 s_nop 15
 s_nop 7
 s_branch L_ch0_f
L_rt_166:
 s_waitcnt lgkmcnt(0)
 s_add_u32 s51, s51, 1
 s_cmp_lt_u32 s51, 131072
 s_cbranch_scc1 L_pm_165
 s_branch L_bail
L_rt_168:
 s_add_u32 s51, s51, 1
 s_cmp_lt_u32 s51, 131072
 s_cbranch_scc1 L_pp_167
 s_branch L_bail
.p2align 6
L_ch0_s:
 s_mov_b32 s51, 0
L_pm_169:
 buffer_load_dwordx4 v[24:27], v1, s[4:7], s59 offen offset:0 sc1
 buffer_load_dwordx4 v[28:31], v1, s[4:7], s59 offen offset:1024 sc1
 s_waitcnt vmcnt(1)
 ds_write_b128 v1, v[24:27] offset:0
 v_max_u32 v7, v24, v26
 s_waitcnt vmcnt(0)
 ds_write_b128 v1, v[28:31] offset:1024
 v_max3_u32 v7, v7, v28, v30
 v_cmp_eq_u32 vcc, -1, v7
 s_cbranch_vccnz L_rt_170
 v_smfmac_f32_16x16x64_bf16 v[16:19], v[24:27], v[32:39], v0
 ds_read_b128 v[32:35], v2 offset:6144
 ds_read_b128 v[36:39], v2 offset:7168
 v_smfmac_f32_16x16x64_bf16 v[20:23], v[24:27], v[40:47], v0
 ds_read_b128 v[40:43], v2 offset:4096
 ds_read_b128 v[44:47], v2 offset:5120
 v_smfmac_f32_16x16x64_bf16 v[16:19], v[28:31], v[48:55], v0
 v_smfmac_f32_16x16x64_bf16 v[20:23], v[28:31], v[56:63], v0
 s_waitcnt lgkmcnt(4)
 s_barrier
 s_add_u32 s3, s63, 8192
 buffer_load_dwordx4 v[56:59], v1, s[4:7], s3 offen offset:0
 buffer_load_dwordx4 v[60:63], v1, s[4:7], s3 offen offset:1024
 s_add_u32 s3, s63, 8192
 buffer_load_dwordx4 v[48:51], v1, s[4:7], s3 offen offset:2048
 buffer_load_dwordx4 v[52:55], v1, s[4:7], s3 offen offset:3072
 v_smfmac_f32_16x16x64_bf16 v[8:11], v[24:27], v[240:247], v0
 v_smfmac_f32_16x16x64_bf16 v[8:11], v[28:31], v[224:231], v0
 v_smfmac_f32_16x16x64_bf16 v[12:15], v[24:27], v[248:255], v0
 ds_read_b128 v[24:27], v1 offset:2048
 v_smfmac_f32_16x16x64_bf16 v[12:15], v[28:31], v[216:223], v0
 ds_read_b128 v[28:31], v1 offset:3072
 s_waitcnt lgkmcnt(1)
 v_smfmac_f32_16x16x64_bf16 v[16:19], v[24:27], v[32:39], v0
 ds_read_b128 v[32:35], v2 offset:2048
 ds_read_b128 v[36:39], v2 offset:3072
 v_smfmac_f32_16x16x64_bf16 v[8:11], v[24:27], v[200:207], v0
 v_smfmac_f32_16x16x64_bf16 v[12:15], v[24:27], v[192:199], v0
 v_smfmac_f32_16x16x64_bf16 v[20:23], v[24:27], v[40:47], v0
 ds_read_b128 v[40:43], v2 offset:0
 ds_read_b128 v[44:47], v2 offset:1024
 ds_read_b128 v[24:27], v1 offset:4096
 s_waitcnt lgkmcnt(5)
 v_smfmac_f32_16x16x64_bf16 v[8:11], v[28:31], v[184:191], v0
 v_smfmac_f32_16x16x64_bf16 v[12:15], v[28:31], v[176:183], v0
 s_waitcnt lgkmcnt(3)
 v_smfmac_f32_16x16x64_bf16 v[16:19], v[28:31], v[32:39], v0
 ds_read_b128 v[32:35], v1 offset:38912
 ds_read_b128 v[36:39], v1 offset:39936
 v_smfmac_f32_16x16x64_bf16 v[20:23], v[28:31], v[152:159], v0
 ds_read_b128 v[28:31], v1 offset:5120
 s_waitcnt lgkmcnt(3)
 v_smfmac_f32_16x16x64_bf16 v[8:11], v[24:27], v[160:167], v0
 v_smfmac_f32_16x16x64_bf16 v[16:19], v[24:27], v[40:47], v0
 ds_read_b128 v[40:43], v1 offset:36864
 ds_read_b128 v[44:47], v1 offset:37888
 v_smfmac_f32_16x16x64_bf16 v[12:15], v[24:27], v[144:151], v0
 v_smfmac_f32_16x16x64_bf16 v[20:23], v[24:27], v[168:175], v0
 ds_read_b128 v[24:27], v1 offset:6144
 s_waitcnt lgkmcnt(3)
 v_smfmac_f32_16x16x64_bf16 v[16:19], v[28:31], v[32:39], v0
 ds_read_b128 v[32:35], v1 offset:34816
 ds_read_b128 v[36:39], v1 offset:35840
 v_smfmac_f32_16x16x64_bf16 v[8:11], v[28:31], v[136:143], v0
 v_smfmac_f32_16x16x64_bf16 v[12:15], v[28:31], v[128:135], v0
 s_waitcnt lgkmcnt(3)
 v_smfmac_f32_16x16x64_bf16 v[20:23], v[28:31], v[40:47], v0
 ds_read_b128 v[40:43], v1 offset:32768
 ds_read_b128 v[44:47], v1 offset:33792
 ds_read_b128 v[28:31], v1 offset:7168
 s_waitcnt lgkmcnt(5)
 v_smfmac_f32_16x16x64_bf16 v[8:11], v[24:27], a[144:151], v0
 v_smfmac_f32_16x16x64_bf16 v[12:15], v[24:27], a[136:143], v0
 s_waitcnt lgkmcnt(3)
 v_smfmac_f32_16x16x64_bf16 v[16:19], v[24:27], v[32:39], v0
 ds_read_b128 v[32:35], v1 offset:18432
 ds_read_b128 v[36:39], v1 offset:19456
 s_waitcnt vmcnt(2)
 v_smfmac_f32_16x16x64_bf16 v[20:23], v[24:27], v[56:63], v0
 s_add_u32 s3, s61, 4096
 buffer_load_dwordx4 v[56:59], v1, s[4:7], s61 offen offset:0 sc1
 buffer_load_dwordx4 v[60:63], v1, s[4:7], s3 offen offset:0 sc1
 ds_read_b128 v[24:27], v1 offset:8192
 s_waitcnt lgkmcnt(3)
 v_smfmac_f32_16x16x64_bf16 v[8:11], v[28:31], a[96:103], v0
 v_smfmac_f32_16x16x64_bf16 v[16:19], v[28:31], v[40:47], v0
 ds_read_b128 v[40:43], v1 offset:16384
 ds_read_b128 v[44:47], v1 offset:17408
 v_smfmac_f32_16x16x64_bf16 v[12:15], v[28:31], a[88:95], v0
 v_smfmac_f32_16x16x64_bf16 v[20:23], v[28:31], v[208:215], v0
 ds_read_b128 v[28:31], v1 offset:9216
 s_waitcnt lgkmcnt(3)
 v_smfmac_f32_16x16x64_bf16 v[16:19], v[24:27], v[32:39], v0
 s_add_u32 s3, s61, 67108864
 buffer_load_dwordx4 v[32:35], v1, s[4:7], s3 offen offset:0 sc1
 buffer_load_dwordx4 v[36:39], v1, s[4:7], s3 offen offset:1024 sc1
 v_smfmac_f32_16x16x64_bf16 v[8:11], v[24:27], a[80:87], v0
 v_smfmac_f32_16x16x64_bf16 v[12:15], v[24:27], a[64:71], v0
 s_waitcnt lgkmcnt(1)
 v_smfmac_f32_16x16x64_bf16 v[20:23], v[24:27], v[40:47], v0
 ds_read_b128 v[40:43], v3 offset:49152
 ds_read_b128 v[44:47], v3 offset:49152
 s_waitcnt lgkmcnt(2)
 v_smfmac_f32_16x16x64_bf16 v[8:11], v[28:31], a[40:47], v0
 v_smfmac_f32_16x16x64_bf16 v[12:15], v[28:31], a[24:31], v0
 v_smfmac_f32_16x16x64_bf16 v[16:19], v[28:31], v[232:239], v0
 s_waitcnt vmcnt(4)
 v_smfmac_f32_16x16x64_bf16 v[20:23], v[28:31], v[48:55], v0
 ds_read_b128 v[52:55], v1 offset:0
 v_add_f32 v8, v8, v10
 v_add_f32 v9, v9, v11
 v_cvt_pk_bf16_f32 v8, v8, v9
 v_add_f32 v12, v12, v14
 v_add_f32 v13, v13, v15
 v_cvt_pk_bf16_f32 v12, v12, v13
 ds_write2_b32 v4, v8, v8 offset0:0 offset1:1
 ds_write2_b32 v4, v12, v12 offset0:128 offset1:129
 ds_read_b64_tr_b16 v[12:13], v5 offset:10240
 ds_read_b64_tr_b16 v[14:15], v5 offset:10752
 v_add_f32 v16, v16, v18
 v_add_f32 v17, v17, v19
 v_cvt_pk_bf16_f32 v16, v16, v17
 v_add_f32 v20, v20, v22
 v_add_f32 v21, v21, v23
 v_cvt_pk_bf16_f32 v20, v20, v21
 ds_write2_b32 v4, v16, v20 offset0:0 offset1:128
 ds_read_b64_tr_b16 v[20:21], v5 offset:10240
 ds_read_b64_tr_b16 v[22:23], v5 offset:10752
 s_waitcnt lgkmcnt(9)
 v_smfmac_f32_16x16x64_bf16 v[40:43], v[24:27], v[96:103], v0
 s_waitcnt lgkmcnt(8)
 v_smfmac_f32_16x16x64_bf16 v[44:47], v[24:27], v[104:111], v0
 ds_read_b128 v[24:27], v1 offset:1024
 v_smfmac_f32_16x16x64_bf16 v[40:43], v[28:31], v[112:119], v0
 v_smfmac_f32_16x16x64_bf16 v[44:47], v[28:31], v[120:127], v0
 ds_read_b128 v[28:31], v1 offset:2048
 s_waitcnt vmcnt(3) lgkmcnt(5)
 v_mfma_f32_16x16x32_bf16 v[8:11], v[56:59], v[12:15], 0
 s_waitcnt vmcnt(2) lgkmcnt(4)
 v_mfma_f32_16x16x32_bf16 v[16:19], v[60:63], v[12:15], 0
 s_waitcnt lgkmcnt(2)
 v_mfma_f32_16x16x32_bf16 v[48:51], v[20:23], v[12:15], 0
 v_smfmac_f32_16x16x64_bf16 v[40:43], v[52:55], a[160:167], v0
 v_smfmac_f32_16x16x64_bf16 v[44:47], v[52:55], a[168:175], v0
 ds_read_b128 v[52:55], v1 offset:3072
 s_waitcnt lgkmcnt(2)
 v_smfmac_f32_16x16x64_bf16 v[40:43], v[24:27], a[176:183], v0
 v_cndmask_b32 v8, v8, v16, s[70:71]
 v_cndmask_b32 v9, v9, v17, s[70:71]
 v_cndmask_b32 v10, v10, v18, s[70:71]
 v_cndmask_b32 v11, v11, v19, s[70:71]
 ds_write_b128 v1, v[8:11] offset:10240
 ds_write_b64 v1, v[48:49] offset:14336
 v_smfmac_f32_16x16x64_bf16 v[44:47], v[24:27], a[184:191], v0
 ds_read_b128 v[24:27], v1 offset:4096
 s_waitcnt lgkmcnt(4)
 v_smfmac_f32_16x16x64_bf16 v[40:43], v[28:31], a[192:199], v0
 v_smfmac_f32_16x16x64_bf16 v[44:47], v[28:31], a[200:207], v0
 ds_read_b128 v[28:31], v1 offset:5120
 s_waitcnt lgkmcnt(4)
 v_smfmac_f32_16x16x64_bf16 v[40:43], v[52:55], a[208:215], v0
 v_smfmac_f32_16x16x64_bf16 v[44:47], v[52:55], a[216:223], v0
 ds_read_b128 v[52:55], v1 offset:6144
 s_waitcnt lgkmcnt(2)
 v_smfmac_f32_16x16x64_bf16 v[40:43], v[24:27], a[224:231], v0
 s_barrier
 ds_read_b128 v[56:59], v1 offset:11264
 ds_read_b128 v[60:63], v1 offset:12288
 ds_read_b128 v[16:19], v1 offset:13312
 ds_read_b128 v[12:15], v1 offset:14336
 ds_read_b128 v[48:51], v1 offset:15360
 v_smfmac_f32_16x16x64_bf16 v[44:47], v[24:27], a[232:239], v0
 ds_read_b128 v[24:27], v1 offset:7168
 s_mov_b64 exec, s[68:69]
 buffer_store_dwordx4 v[20:23], v6, s[4:7], s62 offen offset:0 sc1
 s_mov_b64 exec, -1
 s_waitcnt lgkmcnt(7)
 v_smfmac_f32_16x16x64_bf16 v[40:43], v[28:31], a[240:247], v0
 v_smfmac_f32_16x16x64_bf16 v[44:47], v[28:31], a[248:255], v0
 s_waitcnt lgkmcnt(6)
 v_smfmac_f32_16x16x64_bf16 v[40:43], v[52:55], v[64:71], v0
 v_smfmac_f32_16x16x64_bf16 v[44:47], v[52:55], v[72:79], v0
 s_waitcnt lgkmcnt(0)
 v_smfmac_f32_16x16x64_bf16 v[40:43], v[24:27], v[80:87], v0
 v_smfmac_f32_16x16x64_bf16 v[44:47], v[24:27], v[88:95], v0
 v_pk_add_f32 v[8:9], v[8:9], v[56:57]
 v_pk_add_f32 v[10:11], v[10:11], v[58:59]
 v_pk_add_f32 v[60:61], v[60:61], v[16:17]
 v_pk_add_f32 v[62:63], v[62:63], v[18:19]
 v_pk_add_f32 v[12:13], v[12:13], v[14:15]
 v_pk_add_f32 v[48:49], v[48:49], v[50:51]
 v_pk_add_f32 v[8:9], v[8:9], v[60:61]
 v_pk_add_f32 v[10:11], v[10:11], v[62:63]
 v_pk_add_f32 v[48:49], v[12:13], v[48:49]
 v_max3_f32 v50, v8, v9, v10
 v_max3_f32 v50, v50, v11, v48
 v_max_f32 v50, v50, v49
 v_add_f32 v40, v40, v42
 v_add_f32 v41, v41, v43
 v_max_f32_dpp v50, v50, v50 quad_perm:[2,3,0,1] row_mask:0xf bank_mask:0xf
 v_mov_b32 v51, v50
 v_add_f32 v44, v44, v46
 v_add_f32 v45, v45, v47
 v_permlane16_swap_b32 v50, v51
 v_max_f32 v50, v50, v51
 v_mov_b32 v51, v50
 v_cvt_pk_bf16_f32 v40, v40, v41
 v_cvt_pk_bf16_f32 v41, v44, v45
 v_permlane32_swap_b32 v50, v51
 v_max_f32 v50, v50, v51
 v_mul_f32 v50, s56, v50
 v_fma_f32 v48, v48, s56, -v50
 v_fma_f32 v49, v49, s56, -v50
 v_fma_f32 v8, v8, s56, -v50
 v_fma_f32 v9, v9, s56, -v50
 v_fma_f32 v10, v10, s56, -v50
 v_fma_f32 v11, v11, s56, -v50
 v_exp_f32 v48, v48
 v_exp_f32 v49, v49
 ds_read_b128 v[56:59], v3 offset:18432
 ds_read_b128 v[60:63], v3 offset:19456
 v_exp_f32 v8, v8
 v_exp_f32 v9, v9
 ds_read_b128 v[24:27], v2 offset:36864
 ds_read_b128 v[28:31], v2 offset:37888
 v_exp_f32 v10, v10
 buffer_store_dwordx2 v[40:41], v5, s[4:7], s62 offen offset:2048 sc1
 v_exp_f32 v11, v11
 v_cvt_pk_bf16_f32 v14, v48, v49
 v_cvt_pk_bf16_f32 v12, v8, v9
 v_cvt_pk_bf16_f32 v13, v10, v11
 v_cndmask_b32 v52, 0, v14, s[68:69]
 v_cndmask_b32 v53, 0, v14, s[70:71]
 v_cndmask_b32 v22, 0, v12, s[70:71]
 v_cndmask_b32 v23, 0, v13, s[70:71]
 v_mfma_f32_16x16x16_bf16 v[44:47], v[40:41], v[52:53], 0
 v_cndmask_b32 v16, 0, v12, s[68:69]
 v_cndmask_b32 v17, 0, v13, s[68:69]
 v_mov_b32_dpp v18, v22 quad_perm:[2,3,0,1] row_mask:0xf bank_mask:0xf
 v_mov_b32_dpp v19, v23 quad_perm:[2,3,0,1] row_mask:0xf bank_mask:0xf
 v_mov_b32_dpp v20, v16 quad_perm:[2,3,0,1] row_mask:0xf bank_mask:0xf
 v_mov_b32_dpp v21, v17 quad_perm:[2,3,0,1] row_mask:0xf bank_mask:0xf
 s_waitcnt vmcnt(3)
 v_mfma_f32_16x16x32_bf16 v[44:47], v[32:35], v[16:19], v[44:47]
 v_add_f32 v54, v8, v9
 v_add_f32 v55, v48, v49
 s_waitcnt vmcnt(2)
 v_mfma_f32_16x16x32_bf16 v[44:47], v[36:39], v[20:23], v[44:47]
 v_add_f32 v54, v54, v10
 v_fma_f32 v55, v55, 0.5, v11
 v_add_f32 v54, v54, v55
 ds_read_b128 v[16:19], v3 offset:49152
 ds_read_b128 v[20:23], v3 offset:49152
 v_add_f32_dpp v54, v54, v54 quad_perm:[2,3,0,1] row_mask:0xf bank_mask:0xf
 v_mov_b32 v55, v54
 ds_read_b128 v[32:35], v3 offset:49152
 ds_read_b128 v[36:39], v3 offset:49152
 v_permlane16_swap_b32 v54, v55
 v_add_f32 v54, v54, v55
 v_mov_b32 v55, v54
 ds_read_b128 v[8:11], v3 offset:49152
 s_cmp_eq_u32 s54, 63
 v_permlane32_swap_b32 v54, v55
 v_add_f32 v54, v54, v55
 v_rcp_f32 v54, v54
 s_cbranch_scc1 L_ch0_end
 v_mul_f32 v44, v44, v54
 v_mul_f32 v45, v45, v54
 v_cvt_pk_bf16_f32 v42, v44, v45
 v_mul_f32 v46, v46, v54
 v_mul_f32 v47, v47, v54
 v_cvt_pk_bf16_f32 v43, v46, v47
 ds_write_b64 v6, v[42:43] offset:0
 v_and_b32 v40, -9, v6
 v_mov_b32_dpp v12, v42 quad_perm:[0,1,0,1] row_mask:0xf bank_mask:0xf
 v_mov_b32_dpp v14, v42 quad_perm:[2,3,2,3] row_mask:0xf bank_mask:0xf
 v_mov_b32_dpp v13, v43 quad_perm:[0,1,0,1] row_mask:0xf bank_mask:0xf
 v_mov_b32_dpp v15, v43 quad_perm:[2,3,2,3] row_mask:0xf bank_mask:0xf
 s_waitcnt lgkmcnt(5)
 s_nop 0
 v_smfmac_f32_16x16x64_bf16 v[16:19], v[12:15], a[0:7], v0
 s_waitcnt lgkmcnt(4)
 v_smfmac_f32_16x16x64_bf16 v[20:23], v[12:15], a[32:39], v0
 s_waitcnt lgkmcnt(0)
 s_barrier
 ds_read_b128 v[48:51], v40 offset:512
 ds_read_b128 v[52:55], v40 offset:1024
 ds_read_b128 v[44:47], v40 offset:1536
 v_smfmac_f32_16x16x64_bf16 v[32:35], v[12:15], v[56:63], v0
 ds_read_b128 v[56:59], v3 offset:22528
 ds_read_b128 v[60:63], v3 offset:23552
 v_smfmac_f32_16x16x64_bf16 v[36:39], v[12:15], v[24:31], v0
 ds_read_b128 v[24:27], v3 offset:20480
 ds_read_b128 v[28:31], v3 offset:21504
 v_smfmac_f32_16x16x64_bf16 v[8:11], v[12:15], a[128:135], v0
 s_waitcnt lgkmcnt(6)
 v_smfmac_f32_16x16x64_bf16 v[16:19], v[48:51], a[8:15], v0
 s_waitcnt lgkmcnt(5)
 v_smfmac_f32_16x16x64_bf16 v[16:19], v[52:55], a[16:23], v0
 s_waitcnt lgkmcnt(2)
 v_smfmac_f32_16x16x64_bf16 v[16:19], v[44:47], v[56:63], v0
 ds_read_b128 v[56:59], v3 offset:16384
 ds_read_b128 v[60:63], v3 offset:17408
 s_waitcnt lgkmcnt(2)
 v_smfmac_f32_16x16x64_bf16 v[20:23], v[48:51], v[24:31], v0
 ds_read_b128 v[24:27], v2 offset:38912
 ds_read_b128 v[28:31], v2 offset:39936
 v_smfmac_f32_16x16x64_bf16 v[20:23], v[52:55], a[48:55], v0
 v_smfmac_f32_16x16x64_bf16 v[20:23], v[44:47], a[56:63], v0
 v_cvt_pk_bf16_f32 v16, v16, v17
 v_smfmac_f32_16x16x64_bf16 v[32:35], v[48:51], a[72:79], v0
 v_cvt_pk_bf16_f32 v17, v18, v19
 s_waitcnt lgkmcnt(2)
 v_smfmac_f32_16x16x64_bf16 v[32:35], v[52:55], v[56:63], v0
 ds_read_b128 v[56:59], v2 offset:34816
 ds_read_b128 v[60:63], v2 offset:35840
 v_and_or_b32 v16, v16, -2, s55
 s_waitcnt lgkmcnt(2)
 v_smfmac_f32_16x16x64_bf16 v[32:35], v[44:47], v[24:31], v0
 ds_read_b128 v[24:27], v2 offset:32768
 ds_read_b128 v[28:31], v2 offset:33792
 v_cvt_pk_bf16_f32 v18, v20, v21
 v_smfmac_f32_16x16x64_bf16 v[36:39], v[48:51], a[104:111], v0
 v_cvt_pk_bf16_f32 v19, v22, v23
 v_smfmac_f32_16x16x64_bf16 v[36:39], v[52:55], a[112:119], v0
 v_and_or_b32 v18, v18, -2, s55
 buffer_store_dwordx4 v[16:19], v1, s[4:7], s60 offen offset:0 sc1
 v_smfmac_f32_16x16x64_bf16 v[36:39], v[44:47], a[120:127], v0
 v_cvt_pk_bf16_f32 v32, v32, v33
 s_waitcnt lgkmcnt(2)
 v_smfmac_f32_16x16x64_bf16 v[8:11], v[48:51], v[56:63], v0
 v_cvt_pk_bf16_f32 v33, v34, v35
 s_waitcnt lgkmcnt(0)
 v_smfmac_f32_16x16x64_bf16 v[8:11], v[52:55], v[24:31], v0
 v_and_or_b32 v32, v32, -2, s55
 v_smfmac_f32_16x16x64_bf16 v[8:11], v[44:47], a[152:159], v0
 v_cvt_pk_bf16_f32 v34, v36, v37
 v_cvt_pk_bf16_f32 v35, v38, v39
 v_and_or_b32 v34, v34, -2, s55
 buffer_store_dwordx4 v[32:35], v1, s[4:7], s60 offen offset:1024 sc1
 s_add_u32 s3, s60, 8192
 s_nop 2
 v_cvt_pk_bf16_f32 v8, v8, v9
 v_cvt_pk_bf16_f32 v9, v10, v11
 v_and_or_b32 v8, v8, -2, s55
 buffer_store_dwordx2 v[8:9], v1, s[4:7], s3 offen offset:0 sc1
 buffer_load_dwordx4 v[32:35], v1, s[4:7], s63 offen offset:0
 buffer_load_dwordx4 v[36:39], v1, s[4:7], s63 offen offset:1024
 s_add_u32 s54, s54, 1
 s_add_u32 s61, s61, 524288
 s_and_b32 s3, s54, 7
 s_cselect_b32 s3, 1, -7
 s_lshl_b32 s3, s3, 17
 s_add_u32 s62, s62, s3
 s_and_b32 s3, s54, 3
 s_cselect_b32 s3, 1, -3
 s_lshl_b32 s3, s3, 14
 s_add_u32 s58, s57, s3
 s_add_u32 s59, s59, s3
 v_lshrrev_b32 v56, 7, v1
 v_mul_u32_u24 v56, 10240, v56
 v_and_b32 v60, 112, v1
 v_add_u32 v56, v56, v60
 v_and_b32 v57, 32, v1
 v_and_b32 v60, 64, v1
 v_lshl_add_u32 v57, v60, 2, v57
 v_bfe_u32 v60, v1, 8, 1
 v_lshl_add_u32 v57, v60, 4, v57
 v_and_b32 v60, 8, v5
 v_add_u32 v57, v57, v60
 v_mov_b32 v60, 0x3f80
 v_mov_b32 v28, 0x3f800000
 v_cndmask_b32 v60, v60, v28, s[82:83]
 v_cndmask_b32 v28, 0, v60, s[72:73]
 v_cndmask_b32 v29, 0, v60, s[74:75]
 v_cndmask_b32 v30, 0, v60, s[76:77]
 v_cndmask_b32 v31, 0, v60, s[78:79]
 v_mov_b64 v[58:59], -1
 s_nop 15
 s_nop 15
 s_nop 15
 s_nop 1
 s_mov_b32 s51, 0
L_pp_171:
 buffer_load_dwordx4 v[8:11], v56, s[4:7], s64 offen sc1
 buffer_load_dwordx4 v[12:15], v56, s[4:7], s65 offen sc1
 buffer_load_dwordx4 v[16:19], v56, s[4:7], s66 offen sc1
 buffer_load_dwordx4 v[20:23], v56, s[4:7], s67 offen sc1
 s_waitcnt vmcnt(3)
 v_mfma_f32_16x16x32_bf16 v[24:27], v[28:31], v[8:11], 0
 v_bitop3_b32 v60, v8, v10, s55 bitop3:0x7e
 s_waitcnt vmcnt(2)
 v_mfma_f32_16x16x32_bf16 v[24:27], v[28:31], v[12:15], v[24:27]
 v_bitop3_b32 v61, v12, v14, s55 bitop3:0x7e
 s_waitcnt vmcnt(1)
 v_mfma_f32_16x16x32_bf16 v[24:27], v[28:31], v[16:19], v[24:27]
 v_bitop3_b32 v62, v16, v18, s55 bitop3:0x7e
 s_waitcnt vmcnt(0)
 v_mfma_f32_16x16x32_bf16 v[24:27], v[28:31], v[20:23], v[24:27]
 v_bitop3_b32 v63, v20, v22, s55 bitop3:0x7e
 v_or3_b32 v7, v60, v61, v62
 v_bitop3_b32 v7, v7, v63, 1 bitop3:0xa8
 v_cmp_ne_u32 vcc, 0, v7
 s_cbranch_vccnz L_rt_172
 s_nop 2
 v_add_f32_dpp v24, v24, v24 row_ror:8 row_mask:0xf bank_mask:0xf
 v_add_f32_dpp v25, v25, v25 row_ror:8 row_mask:0xf bank_mask:0xf
 v_add_f32_dpp v26, v26, v26 row_ror:8 row_mask:0xf bank_mask:0xf
 v_add_f32_dpp v27, v27, v27 row_ror:8 row_mask:0xf bank_mask:0xf
 s_mov_b64 exec, s[84:85]
 v_cvt_pk_bf16_f32 v24, v24, v25
 v_cvt_pk_bf16_f32 v25, v26, v27
 buffer_store_dwordx2 v[24:25], v57, s[4:7], s58 offen sc1
 buffer_store_dwordx2 v[58:59], v57, s[4:7], s57 offen sc1
 s_mov_b64 exec, -1
 s_mov_b32 s57, s58
 s_xor_b32 s55, s55, 1
 buffer_load_dwordx4 v[40:43], v1, s[4:7], s63 offen offset:2048
 buffer_load_dwordx4 v[44:47], v1, s[4:7], s63 offen offset:3072
 s_add_u32 s3, s63, 4096
 buffer_load_dwordx4 v[48:51], v1, s[4:7], s3 offen offset:0
 buffer_load_dwordx4 v[52:55], v1, s[4:7], s3 offen offset:1024
 s_add_u32 s3, s63, 4096
 buffer_load_dwordx4 v[56:59], v1, s[4:7], s3 offen offset:2048
 buffer_load_dwordx4 v[60:63], v1, s[4:7], s3 offen offset:3072
 ds_read_b128 v[8:11], v3 offset:49152
 ds_read_b128 v[12:15], v3 offset:49152
 ds_read_b128 v[16:19], v3 offset:49152
 ds_read_b128 v[20:23], v3 offset:49152
 s_waitcnt lgkmcnt(0)
 s_nop 15
 s_nop 15
 s_nop 7
 s_branch L_ch0_s
L_rt_170:
 s_waitcnt lgkmcnt(0)
 s_add_u32 s51, s51, 1
 s_cmp_lt_u32 s51, 131072
 s_cbranch_scc1 L_pm_169
 s_branch L_bail
L_rt_172:
 s_add_u32 s51, s51, 1
 s_cmp_lt_u32 s51, 131072
 s_cbranch_scc1 L_pp_171
 s_branch L_bail
L_ch0_end:
 s_waitcnt vmcnt(0)
 s_endpgm
L_ch1:
 v_lshrrev_b32 v8, 4, v0
 s_mov_b32 s3, 1280
 v_mul_lo_u32 v8, v8, s3
 v_lshrrev_b32 v7, 3, v0
 v_and_b32 v7, 6, v7
 v_xor_b32 v7, v7, v0
 v_and_b32 v7, 15, v7
 v_lshl_add_u32 v8, v7, 4, v8
 v_xor_b32 v9, 128, v8
 v_lshrrev_b32 v10, 4, v0
 s_mov_b32 s3, 8192
 v_mul_lo_u32 v10, v10, s3
 v_lshrrev_b32 v7, 3, v0
 v_and_b32 v7, 6, v7
 v_xor_b32 v7, v7, v0
 v_and_b32 v7, 15, v7
 v_lshl_add_u32 v10, v7, 4, v10
 v_xor_b32 v11, 128, v10
 s_mov_b32 s8, s26
 s_and_b32 s9, s27, 0xffff
 s_mov_b32 s10, 5242880
 s_mul_i32 s14, s52, 163840
 s_add_u32 s14, s14, 40960
 s_mov_b32 m0, 8192
 s_nop 0
 buffer_load_dwordx4 v8, s[8:11], s14 offen lds
 s_add_u32 s14, s14, 5120
 s_mov_b32 m0, 9216
 s_nop 0
 buffer_load_dwordx4 v8, s[8:11], s14 offen lds
 s_add_u32 s14, s14, 5120
 s_mov_b32 m0, 10240
 s_nop 0
 buffer_load_dwordx4 v8, s[8:11], s14 offen lds
 s_add_u32 s14, s14, 5120
 s_mov_b32 m0, 11264
 s_nop 0
 buffer_load_dwordx4 v8, s[8:11], s14 offen lds
 s_add_u32 s14, s14, 5120
 s_mov_b32 m0, 12288
 s_nop 0
 buffer_load_dwordx4 v9, s[8:11], s14 offen lds
 s_add_u32 s14, s14, 5120
 s_mov_b32 m0, 13312
 s_nop 0
 buffer_load_dwordx4 v9, s[8:11], s14 offen lds
 s_add_u32 s14, s14, 5120
 s_mov_b32 m0, 14336
 s_nop 0
 buffer_load_dwordx4 v9, s[8:11], s14 offen lds
 s_add_u32 s14, s14, 5120
 s_mov_b32 m0, 15360
 s_nop 0
 buffer_load_dwordx4 v9, s[8:11], s14 offen lds
 s_mul_i32 s14, s52, 163840
 s_add_u32 s14, s14, 41216
 s_mov_b32 m0, 40960
 s_nop 0
 buffer_load_dwordx4 v8, s[8:11], s14 offen lds
 s_add_u32 s14, s14, 5120
 s_mov_b32 m0, 41984
 s_nop 0
 buffer_load_dwordx4 v8, s[8:11], s14 offen lds
 s_add_u32 s14, s14, 5120
 s_mov_b32 m0, 43008
 s_nop 0
 buffer_load_dwordx4 v8, s[8:11], s14 offen lds
 s_add_u32 s14, s14, 5120
 s_mov_b32 m0, 44032
 s_nop 0
 buffer_load_dwordx4 v8, s[8:11], s14 offen lds
 s_add_u32 s14, s14, 5120
 s_mov_b32 m0, 45056
 s_nop 0
 buffer_load_dwordx4 v9, s[8:11], s14 offen lds
 s_add_u32 s14, s14, 5120
 s_mov_b32 m0, 46080
 s_nop 0
 buffer_load_dwordx4 v9, s[8:11], s14 offen lds
 s_add_u32 s14, s14, 5120
 s_mov_b32 m0, 47104
 s_nop 0
 buffer_load_dwordx4 v9, s[8:11], s14 offen lds
 s_add_u32 s14, s14, 5120
 s_mov_b32 m0, 48128
 s_nop 0
 buffer_load_dwordx4 v9, s[8:11], s14 offen lds
 s_mul_i32 s14, s52, 163840
 s_add_u32 s14, s14, 41472
 s_mov_b32 m0, 73728
 s_nop 0
 buffer_load_dwordx4 v8, s[8:11], s14 offen lds
 s_add_u32 s14, s14, 5120
 s_mov_b32 m0, 74752
 s_nop 0
 buffer_load_dwordx4 v8, s[8:11], s14 offen lds
 s_add_u32 s14, s14, 5120
 s_mov_b32 m0, 75776
 s_nop 0
 buffer_load_dwordx4 v8, s[8:11], s14 offen lds
 s_add_u32 s14, s14, 5120
 s_mov_b32 m0, 76800
 s_nop 0
 buffer_load_dwordx4 v8, s[8:11], s14 offen lds
 s_add_u32 s14, s14, 5120
 s_mov_b32 m0, 77824
 s_nop 0
 buffer_load_dwordx4 v9, s[8:11], s14 offen lds
 s_add_u32 s14, s14, 5120
 s_mov_b32 m0, 78848
 s_nop 0
 buffer_load_dwordx4 v9, s[8:11], s14 offen lds
 s_add_u32 s14, s14, 5120
 s_mov_b32 m0, 79872
 s_nop 0
 buffer_load_dwordx4 v9, s[8:11], s14 offen lds
 s_add_u32 s14, s14, 5120
 s_mov_b32 m0, 80896
 s_nop 0
 buffer_load_dwordx4 v9, s[8:11], s14 offen lds
 s_mul_i32 s14, s52, 163840
 s_add_u32 s14, s14, 41728
 s_mov_b32 m0, 106496
 s_nop 0
 buffer_load_dwordx4 v8, s[8:11], s14 offen lds
 s_add_u32 s14, s14, 5120
 s_mov_b32 m0, 107520
 s_nop 0
 buffer_load_dwordx4 v8, s[8:11], s14 offen lds
 s_add_u32 s14, s14, 5120
 s_mov_b32 m0, 108544
 s_nop 0
 buffer_load_dwordx4 v8, s[8:11], s14 offen lds
 s_add_u32 s14, s14, 5120
 s_mov_b32 m0, 109568
 s_nop 0
 buffer_load_dwordx4 v8, s[8:11], s14 offen lds
 s_add_u32 s14, s14, 5120
 s_mov_b32 m0, 110592
 s_nop 0
 buffer_load_dwordx4 v9, s[8:11], s14 offen lds
 s_add_u32 s14, s14, 5120
 s_mov_b32 m0, 111616
 s_nop 0
 buffer_load_dwordx4 v9, s[8:11], s14 offen lds
 s_add_u32 s14, s14, 5120
 s_mov_b32 m0, 112640
 s_nop 0
 buffer_load_dwordx4 v9, s[8:11], s14 offen lds
 s_add_u32 s14, s14, 5120
 s_mov_b32 m0, 113664
 s_nop 0
 buffer_load_dwordx4 v9, s[8:11], s14 offen lds
 s_mul_i32 s14, s52, 163840
 s_add_u32 s14, s14, 41984
 s_mov_b32 m0, 139264
 s_nop 0
 buffer_load_dwordx4 v8, s[8:11], s14 offen lds
 s_add_u32 s14, s14, 5120
 s_mov_b32 m0, 140288
 s_nop 0
 buffer_load_dwordx4 v8, s[8:11], s14 offen lds
 s_add_u32 s14, s14, 5120
 s_mov_b32 m0, 141312
 s_nop 0
 buffer_load_dwordx4 v8, s[8:11], s14 offen lds
 s_add_u32 s14, s14, 5120
 s_mov_b32 m0, 142336
 s_nop 0
 buffer_load_dwordx4 v8, s[8:11], s14 offen lds
 s_add_u32 s14, s14, 5120
 s_mov_b32 m0, 143360
 s_nop 0
 buffer_load_dwordx4 v9, s[8:11], s14 offen lds
 s_add_u32 s14, s14, 5120
 s_mov_b32 m0, 144384
 s_nop 0
 buffer_load_dwordx4 v9, s[8:11], s14 offen lds
 s_add_u32 s14, s14, 5120
 s_mov_b32 m0, 145408
 s_nop 0
 buffer_load_dwordx4 v9, s[8:11], s14 offen lds
 s_add_u32 s14, s14, 5120
 s_mov_b32 m0, 146432
 s_nop 0
 buffer_load_dwordx4 v9, s[8:11], s14 offen lds
 v_lshrrev_b32 v20, 4, v0
 v_bfe_u32 v21, v0, 2, 1
 v_bfe_u32 v22, v0, 3, 1
 v_and_b32 v23, 1, v20
 v_lshrrev_b32 v24, 1, v20
 v_and_b32 v25, 3, v0
 v_lshlrev_b32 v25, 3, v25
 v_lshl_add_u32 v26, v22, 1, v23
 v_lshl_add_u32 v27, v21, 2, v26
 v_lshl_add_u32 v26, v24, 2, v26
 v_lshl_add_u32 v26, v21, 4, v26
 v_xor_b32 v27, 2, v27
 v_lshl_add_u32 v27, v27, 5, v25
 v_lshl_add_u32 v12, v26, 8, v27
 v_lshl_add_u32 v26, v24, 2, v21
 v_lshl_add_u32 v26, v23, 4, v26
 v_lshl_add_u32 v27, v23, 2, v21
 v_lshl_add_u32 v27, v22, 1, v27
 v_lshl_add_u32 v27, v27, 5, v25
 v_lshl_add_u32 v14, v26, 8, v27
 v_lshlrev_b32 v1, 4, v0
 v_add_u32 v2, 65536, v1
 v_add_u32 v3, 114688, v1
 s_waitcnt vmcnt(32)
 s_barrier
 s_waitcnt lgkmcnt(0)
 s_barrier
 s_mov_b32 s8, s24
 s_and_b32 s9, s25, 0xffff
 s_mov_b32 s10, 5242880
 s_lshl_b32 s14, s52, 8
 s_add_u32 s14, s14, 262144
 s_mov_b32 m0, 8192
 s_nop 0
 buffer_load_dwordx4 v10, s[8:11], s14 offen lds
 s_add_u32 s14, s14, 32768
 s_mov_b32 m0, 9216
 s_nop 0
 buffer_load_dwordx4 v10, s[8:11], s14 offen lds
 s_add_u32 s14, s14, 32768
 s_mov_b32 m0, 10240
 s_nop 0
 buffer_load_dwordx4 v10, s[8:11], s14 offen lds
 s_add_u32 s14, s14, 32768
 s_mov_b32 m0, 11264
 s_nop 0
 buffer_load_dwordx4 v10, s[8:11], s14 offen lds
 s_add_u32 s14, s14, 32768
 s_mov_b32 m0, 12288
 s_nop 0
 buffer_load_dwordx4 v11, s[8:11], s14 offen lds
 s_add_u32 s14, s14, 32768
 s_mov_b32 m0, 13312
 s_nop 0
 buffer_load_dwordx4 v11, s[8:11], s14 offen lds
 s_add_u32 s14, s14, 32768
 s_mov_b32 m0, 14336
 s_nop 0
 buffer_load_dwordx4 v11, s[8:11], s14 offen lds
 s_add_u32 s14, s14, 32768
 s_mov_b32 m0, 15360
 s_nop 0
 buffer_load_dwordx4 v11, s[8:11], s14 offen lds
 s_waitcnt vmcnt(32)
 s_barrier
 v_xor_b32 v16, 0, v14
 v_add_u32 v16, 32768, v16
 v_xor_b32 v17, 64, v16
 ds_read_b64_tr_b16 a[0:1], v16 offset:0
 ds_read_b64_tr_b16 a[2:3], v17 offset:512
 ds_read_b64_tr_b16 a[4:5], v16 offset:2048
 ds_read_b64_tr_b16 a[6:7], v17 offset:2560
 v_xor_b32 v16, 0, v14
 v_add_u32 v16, 32768, v16
 v_xor_b32 v17, 64, v16
 ds_read_b64_tr_b16 a[8:9], v16 offset:8192
 ds_read_b64_tr_b16 a[10:11], v17 offset:8704
 ds_read_b64_tr_b16 a[12:13], v16 offset:10240
 ds_read_b64_tr_b16 a[14:15], v17 offset:10752
 v_xor_b32 v16, 0, v14
 v_add_u32 v16, 32768, v16
 v_xor_b32 v17, 64, v16
 ds_read_b64_tr_b16 a[16:17], v16 offset:16384
 ds_read_b64_tr_b16 a[18:19], v17 offset:16896
 ds_read_b64_tr_b16 a[20:21], v16 offset:18432
 ds_read_b64_tr_b16 a[22:23], v17 offset:18944
 v_xor_b32 v16, 0, v14
 v_add_u32 v16, 32768, v16
 v_xor_b32 v17, 64, v16
 ds_read_b64_tr_b16 a[24:25], v16 offset:24576
 ds_read_b64_tr_b16 a[26:27], v17 offset:25088
 ds_read_b64_tr_b16 a[28:29], v16 offset:26624
 ds_read_b64_tr_b16 a[30:31], v17 offset:27136
 v_xor_b32 v16, 32, v14
 v_add_u32 v16, 32768, v16
 v_xor_b32 v17, 64, v16
 ds_read_b64_tr_b16 a[32:33], v16 offset:0
 ds_read_b64_tr_b16 a[34:35], v17 offset:512
 ds_read_b64_tr_b16 a[36:37], v16 offset:2048
 ds_read_b64_tr_b16 a[38:39], v17 offset:2560
 v_xor_b32 v16, 32, v14
 v_add_u32 v16, 32768, v16
 v_xor_b32 v17, 64, v16
 ds_read_b64_tr_b16 a[40:41], v16 offset:8192
 ds_read_b64_tr_b16 a[42:43], v17 offset:8704
 ds_read_b64_tr_b16 a[44:45], v16 offset:10240
 ds_read_b64_tr_b16 a[46:47], v17 offset:10752
 v_xor_b32 v16, 32, v14
 v_add_u32 v16, 32768, v16
 v_xor_b32 v17, 64, v16
 ds_read_b64_tr_b16 a[48:49], v16 offset:16384
 ds_read_b64_tr_b16 a[50:51], v17 offset:16896
 ds_read_b64_tr_b16 a[52:53], v16 offset:18432
 ds_read_b64_tr_b16 a[54:55], v17 offset:18944
 v_xor_b32 v16, 32, v14
 v_add_u32 v16, 32768, v16
 v_xor_b32 v17, 64, v16
 ds_read_b64_tr_b16 a[56:57], v16 offset:24576
 ds_read_b64_tr_b16 a[58:59], v17 offset:25088
 ds_read_b64_tr_b16 a[60:61], v16 offset:26624
 ds_read_b64_tr_b16 a[62:63], v17 offset:27136
 v_xor_b32 v16, 128, v14
 v_add_u32 v16, 32768, v16
 v_xor_b32 v17, 64, v16
 ds_read_b64_tr_b16 a[64:65], v16 offset:0
 ds_read_b64_tr_b16 a[66:67], v17 offset:512
 ds_read_b64_tr_b16 a[68:69], v16 offset:2048
 ds_read_b64_tr_b16 a[70:71], v17 offset:2560
 v_xor_b32 v16, 128, v14
 v_add_u32 v16, 32768, v16
 v_xor_b32 v17, 64, v16
 ds_read_b64_tr_b16 a[72:73], v16 offset:8192
 ds_read_b64_tr_b16 a[74:75], v17 offset:8704
 ds_read_b64_tr_b16 a[76:77], v16 offset:10240
 ds_read_b64_tr_b16 a[78:79], v17 offset:10752
 v_xor_b32 v16, 128, v14
 v_add_u32 v16, 32768, v16
 v_xor_b32 v17, 64, v16
 ds_read_b64_tr_b16 a[80:81], v16 offset:16384
 ds_read_b64_tr_b16 a[82:83], v17 offset:16896
 ds_read_b64_tr_b16 a[84:85], v16 offset:18432
 ds_read_b64_tr_b16 a[86:87], v17 offset:18944
 v_xor_b32 v16, 128, v14
 v_add_u32 v16, 32768, v16
 v_xor_b32 v17, 64, v16
 ds_read_b64_tr_b16 a[88:89], v16 offset:24576
 ds_read_b64_tr_b16 a[90:91], v17 offset:25088
 ds_read_b64_tr_b16 a[92:93], v16 offset:26624
 ds_read_b64_tr_b16 a[94:95], v17 offset:27136
 v_xor_b32 v16, 160, v14
 v_add_u32 v16, 32768, v16
 v_xor_b32 v17, 64, v16
 ds_read_b64_tr_b16 a[96:97], v16 offset:0
 ds_read_b64_tr_b16 a[98:99], v17 offset:512
 ds_read_b64_tr_b16 a[100:101], v16 offset:2048
 ds_read_b64_tr_b16 a[102:103], v17 offset:2560
 v_xor_b32 v16, 160, v14
 v_add_u32 v16, 32768, v16
 v_xor_b32 v17, 64, v16
 ds_read_b64_tr_b16 a[104:105], v16 offset:8192
 ds_read_b64_tr_b16 a[106:107], v17 offset:8704
 ds_read_b64_tr_b16 a[108:109], v16 offset:10240
 ds_read_b64_tr_b16 a[110:111], v17 offset:10752
 v_xor_b32 v16, 160, v14
 v_add_u32 v16, 32768, v16
 v_xor_b32 v17, 64, v16
 ds_read_b64_tr_b16 a[112:113], v16 offset:16384
 ds_read_b64_tr_b16 a[114:115], v17 offset:16896
 ds_read_b64_tr_b16 a[116:117], v16 offset:18432
 ds_read_b64_tr_b16 a[118:119], v17 offset:18944
 v_xor_b32 v16, 160, v14
 v_add_u32 v16, 32768, v16
 v_xor_b32 v17, 64, v16
 ds_read_b64_tr_b16 a[120:121], v16 offset:24576
 ds_read_b64_tr_b16 a[122:123], v17 offset:25088
 ds_read_b64_tr_b16 a[124:125], v16 offset:26624
 ds_read_b64_tr_b16 a[126:127], v17 offset:27136
 s_waitcnt lgkmcnt(0)
 s_barrier
 s_lshl_b32 s14, s52, 8
 s_add_u32 s14, s14, 1310720
 s_mov_b32 m0, 40960
 s_nop 0
 buffer_load_dwordx4 v10, s[8:11], s14 offen lds
 s_add_u32 s14, s14, 32768
 s_mov_b32 m0, 41984
 s_nop 0
 buffer_load_dwordx4 v10, s[8:11], s14 offen lds
 s_add_u32 s14, s14, 32768
 s_mov_b32 m0, 43008
 s_nop 0
 buffer_load_dwordx4 v10, s[8:11], s14 offen lds
 s_add_u32 s14, s14, 32768
 s_mov_b32 m0, 44032
 s_nop 0
 buffer_load_dwordx4 v10, s[8:11], s14 offen lds
 s_add_u32 s14, s14, 32768
 s_mov_b32 m0, 45056
 s_nop 0
 buffer_load_dwordx4 v11, s[8:11], s14 offen lds
 s_add_u32 s14, s14, 32768
 s_mov_b32 m0, 46080
 s_nop 0
 buffer_load_dwordx4 v11, s[8:11], s14 offen lds
 s_add_u32 s14, s14, 32768
 s_mov_b32 m0, 47104
 s_nop 0
 buffer_load_dwordx4 v11, s[8:11], s14 offen lds
 s_add_u32 s14, s14, 32768
 s_mov_b32 m0, 48128
 s_nop 0
 buffer_load_dwordx4 v11, s[8:11], s14 offen lds
 s_waitcnt vmcnt(32)
 s_barrier
 s_waitcnt lgkmcnt(0)
 s_barrier
 s_lshl_b32 s14, s52, 8
 s_add_u32 s14, s14, 2359296
 s_mov_b32 m0, 73728
 s_nop 0
 buffer_load_dwordx4 v10, s[8:11], s14 offen lds
 s_add_u32 s14, s14, 32768
 s_mov_b32 m0, 74752
 s_nop 0
 buffer_load_dwordx4 v10, s[8:11], s14 offen lds
 s_add_u32 s14, s14, 32768
 s_mov_b32 m0, 75776
 s_nop 0
 buffer_load_dwordx4 v10, s[8:11], s14 offen lds
 s_add_u32 s14, s14, 32768
 s_mov_b32 m0, 76800
 s_nop 0
 buffer_load_dwordx4 v10, s[8:11], s14 offen lds
 s_add_u32 s14, s14, 32768
 s_mov_b32 m0, 77824
 s_nop 0
 buffer_load_dwordx4 v11, s[8:11], s14 offen lds
 s_add_u32 s14, s14, 32768
 s_mov_b32 m0, 78848
 s_nop 0
 buffer_load_dwordx4 v11, s[8:11], s14 offen lds
 s_add_u32 s14, s14, 32768
 s_mov_b32 m0, 79872
 s_nop 0
 buffer_load_dwordx4 v11, s[8:11], s14 offen lds
 s_add_u32 s14, s14, 32768
 s_mov_b32 m0, 80896
 s_nop 0
 buffer_load_dwordx4 v11, s[8:11], s14 offen lds
 s_waitcnt vmcnt(32)
 s_barrier
 s_waitcnt lgkmcnt(0)
 s_barrier
 s_lshl_b32 s14, s52, 8
 s_add_u32 s14, s14, 3407872
 s_mov_b32 m0, 106496
 s_nop 0
 buffer_load_dwordx4 v10, s[8:11], s14 offen lds
 s_add_u32 s14, s14, 32768
 s_mov_b32 m0, 107520
 s_nop 0
 buffer_load_dwordx4 v10, s[8:11], s14 offen lds
 s_add_u32 s14, s14, 32768
 s_mov_b32 m0, 108544
 s_nop 0
 buffer_load_dwordx4 v10, s[8:11], s14 offen lds
 s_add_u32 s14, s14, 32768
 s_mov_b32 m0, 109568
 s_nop 0
 buffer_load_dwordx4 v10, s[8:11], s14 offen lds
 s_add_u32 s14, s14, 32768
 s_mov_b32 m0, 110592
 s_nop 0
 buffer_load_dwordx4 v11, s[8:11], s14 offen lds
 s_add_u32 s14, s14, 32768
 s_mov_b32 m0, 111616
 s_nop 0
 buffer_load_dwordx4 v11, s[8:11], s14 offen lds
 s_add_u32 s14, s14, 32768
 s_mov_b32 m0, 112640
 s_nop 0
 buffer_load_dwordx4 v11, s[8:11], s14 offen lds
 s_add_u32 s14, s14, 32768
 s_mov_b32 m0, 113664
 s_nop 0
 buffer_load_dwordx4 v11, s[8:11], s14 offen lds
 s_waitcnt vmcnt(32)
 s_barrier
 v_xor_b32 v16, 32, v14
 v_add_u32 v16, 131072, v16
 v_xor_b32 v17, 64, v16
 ds_read_b64_tr_b16 a[128:129], v16 offset:0
 ds_read_b64_tr_b16 a[130:131], v17 offset:512
 ds_read_b64_tr_b16 a[132:133], v16 offset:2048
 ds_read_b64_tr_b16 a[134:135], v17 offset:2560
 v_xor_b32 v16, 32, v14
 v_add_u32 v16, 131072, v16
 v_xor_b32 v17, 64, v16
 ds_read_b64_tr_b16 a[136:137], v16 offset:8192
 ds_read_b64_tr_b16 a[138:139], v17 offset:8704
 ds_read_b64_tr_b16 a[140:141], v16 offset:10240
 ds_read_b64_tr_b16 a[142:143], v17 offset:10752
 v_xor_b32 v16, 32, v14
 v_add_u32 v16, 131072, v16
 v_xor_b32 v17, 64, v16
 ds_read_b64_tr_b16 a[144:145], v16 offset:16384
 ds_read_b64_tr_b16 a[146:147], v17 offset:16896
 ds_read_b64_tr_b16 a[148:149], v16 offset:18432
 ds_read_b64_tr_b16 a[150:151], v17 offset:18944
 v_xor_b32 v16, 32, v14
 v_add_u32 v16, 131072, v16
 v_xor_b32 v17, 64, v16
 ds_read_b64_tr_b16 a[152:153], v16 offset:24576
 ds_read_b64_tr_b16 a[154:155], v17 offset:25088
 ds_read_b64_tr_b16 a[156:157], v16 offset:26624
 ds_read_b64_tr_b16 a[158:159], v17 offset:27136
 s_waitcnt lgkmcnt(0)
 s_barrier
 s_lshl_b32 s14, s52, 8
 s_add_u32 s14, s14, 4456448
 s_mov_b32 m0, 139264
 s_nop 0
 buffer_load_dwordx4 v10, s[8:11], s14 offen lds
 s_add_u32 s14, s14, 32768
 s_mov_b32 m0, 140288
 s_nop 0
 buffer_load_dwordx4 v10, s[8:11], s14 offen lds
 s_add_u32 s14, s14, 32768
 s_mov_b32 m0, 141312
 s_nop 0
 buffer_load_dwordx4 v10, s[8:11], s14 offen lds
 s_add_u32 s14, s14, 32768
 s_mov_b32 m0, 142336
 s_nop 0
 buffer_load_dwordx4 v10, s[8:11], s14 offen lds
 s_add_u32 s14, s14, 32768
 s_mov_b32 m0, 143360
 s_nop 0
 buffer_load_dwordx4 v11, s[8:11], s14 offen lds
 s_add_u32 s14, s14, 32768
 s_mov_b32 m0, 144384
 s_nop 0
 buffer_load_dwordx4 v11, s[8:11], s14 offen lds
 s_add_u32 s14, s14, 32768
 s_mov_b32 m0, 145408
 s_nop 0
 buffer_load_dwordx4 v11, s[8:11], s14 offen lds
 s_add_u32 s14, s14, 32768
 s_mov_b32 m0, 146432
 s_nop 0
 buffer_load_dwordx4 v11, s[8:11], s14 offen lds
 s_waitcnt vmcnt(32)
 s_barrier
 v_xor_b32 v16, 0, v12
 v_add_u32 v16, 0, v16
 ds_read_b64_tr_b16 a[160:161], v16 offset:0
 ds_read_b64_tr_b16 a[162:163], v16 offset:8192
 ds_read_b64_tr_b16 a[164:165], v16 offset:2048
 ds_read_b64_tr_b16 a[166:167], v16 offset:10240
 v_xor_b32 v16, 32, v12
 v_add_u32 v16, 0, v16
 ds_read_b64_tr_b16 a[168:169], v16 offset:0
 ds_read_b64_tr_b16 a[170:171], v16 offset:8192
 ds_read_b64_tr_b16 a[172:173], v16 offset:2048
 ds_read_b64_tr_b16 a[174:175], v16 offset:10240
 v_xor_b32 v16, 0, v12
 v_add_u32 v16, 0, v16
 ds_read_b64_tr_b16 a[176:177], v16 offset:16384
 ds_read_b64_tr_b16 a[178:179], v16 offset:24576
 ds_read_b64_tr_b16 a[180:181], v16 offset:18432
 ds_read_b64_tr_b16 a[182:183], v16 offset:26624
 v_xor_b32 v16, 32, v12
 v_add_u32 v16, 0, v16
 ds_read_b64_tr_b16 a[184:185], v16 offset:16384
 ds_read_b64_tr_b16 a[186:187], v16 offset:24576
 ds_read_b64_tr_b16 a[188:189], v16 offset:18432
 ds_read_b64_tr_b16 a[190:191], v16 offset:26624
 s_waitcnt lgkmcnt(0)
 s_barrier
 s_mov_b32 s8, s22
 s_and_b32 s9, s23, 0xffff
 s_mov_b32 s10, 5242880
 s_lshl_b32 s14, s52, 8
 s_add_u32 s14, s14, 262144
 s_mov_b32 m0, 8192
 s_nop 0
 buffer_load_dwordx4 v10, s[8:11], s14 offen lds
 s_add_u32 s14, s14, 32768
 s_mov_b32 m0, 9216
 s_nop 0
 buffer_load_dwordx4 v10, s[8:11], s14 offen lds
 s_add_u32 s14, s14, 32768
 s_mov_b32 m0, 10240
 s_nop 0
 buffer_load_dwordx4 v10, s[8:11], s14 offen lds
 s_add_u32 s14, s14, 32768
 s_mov_b32 m0, 11264
 s_nop 0
 buffer_load_dwordx4 v10, s[8:11], s14 offen lds
 s_add_u32 s14, s14, 32768
 s_mov_b32 m0, 12288
 s_nop 0
 buffer_load_dwordx4 v11, s[8:11], s14 offen lds
 s_add_u32 s14, s14, 32768
 s_mov_b32 m0, 13312
 s_nop 0
 buffer_load_dwordx4 v11, s[8:11], s14 offen lds
 s_add_u32 s14, s14, 32768
 s_mov_b32 m0, 14336
 s_nop 0
 buffer_load_dwordx4 v11, s[8:11], s14 offen lds
 s_add_u32 s14, s14, 32768
 s_mov_b32 m0, 15360
 s_nop 0
 buffer_load_dwordx4 v11, s[8:11], s14 offen lds
 s_waitcnt vmcnt(32)
 s_barrier
 v_xor_b32 v16, 0, v12
 v_add_u32 v16, 32768, v16
 ds_read_b64_tr_b16 a[192:193], v16 offset:0
 ds_read_b64_tr_b16 a[194:195], v16 offset:8192
 ds_read_b64_tr_b16 a[196:197], v16 offset:2048
 ds_read_b64_tr_b16 a[198:199], v16 offset:10240
 v_xor_b32 v16, 32, v12
 v_add_u32 v16, 32768, v16
 ds_read_b64_tr_b16 a[200:201], v16 offset:0
 ds_read_b64_tr_b16 a[202:203], v16 offset:8192
 ds_read_b64_tr_b16 a[204:205], v16 offset:2048
 ds_read_b64_tr_b16 a[206:207], v16 offset:10240
 v_xor_b32 v16, 0, v12
 v_add_u32 v16, 32768, v16
 ds_read_b64_tr_b16 a[208:209], v16 offset:16384
 ds_read_b64_tr_b16 a[210:211], v16 offset:24576
 ds_read_b64_tr_b16 a[212:213], v16 offset:18432
 ds_read_b64_tr_b16 a[214:215], v16 offset:26624
 v_xor_b32 v16, 32, v12
 v_add_u32 v16, 32768, v16
 ds_read_b64_tr_b16 a[216:217], v16 offset:16384
 ds_read_b64_tr_b16 a[218:219], v16 offset:24576
 ds_read_b64_tr_b16 a[220:221], v16 offset:18432
 ds_read_b64_tr_b16 a[222:223], v16 offset:26624
 s_waitcnt lgkmcnt(0)
 s_barrier
 s_lshl_b32 s14, s52, 8
 s_add_u32 s14, s14, 1310720
 s_mov_b32 m0, 40960
 s_nop 0
 buffer_load_dwordx4 v10, s[8:11], s14 offen lds
 s_add_u32 s14, s14, 32768
 s_mov_b32 m0, 41984
 s_nop 0
 buffer_load_dwordx4 v10, s[8:11], s14 offen lds
 s_add_u32 s14, s14, 32768
 s_mov_b32 m0, 43008
 s_nop 0
 buffer_load_dwordx4 v10, s[8:11], s14 offen lds
 s_add_u32 s14, s14, 32768
 s_mov_b32 m0, 44032
 s_nop 0
 buffer_load_dwordx4 v10, s[8:11], s14 offen lds
 s_add_u32 s14, s14, 32768
 s_mov_b32 m0, 45056
 s_nop 0
 buffer_load_dwordx4 v11, s[8:11], s14 offen lds
 s_add_u32 s14, s14, 32768
 s_mov_b32 m0, 46080
 s_nop 0
 buffer_load_dwordx4 v11, s[8:11], s14 offen lds
 s_add_u32 s14, s14, 32768
 s_mov_b32 m0, 47104
 s_nop 0
 buffer_load_dwordx4 v11, s[8:11], s14 offen lds
 s_add_u32 s14, s14, 32768
 s_mov_b32 m0, 48128
 s_nop 0
 buffer_load_dwordx4 v11, s[8:11], s14 offen lds
 s_waitcnt vmcnt(32)
 s_barrier
 v_xor_b32 v16, 0, v12
 v_add_u32 v16, 65536, v16
 ds_read_b64_tr_b16 a[224:225], v16 offset:0
 ds_read_b64_tr_b16 a[226:227], v16 offset:8192
 ds_read_b64_tr_b16 a[228:229], v16 offset:2048
 ds_read_b64_tr_b16 a[230:231], v16 offset:10240
 v_xor_b32 v16, 32, v12
 v_add_u32 v16, 65536, v16
 ds_read_b64_tr_b16 a[232:233], v16 offset:0
 ds_read_b64_tr_b16 a[234:235], v16 offset:8192
 ds_read_b64_tr_b16 a[236:237], v16 offset:2048
 ds_read_b64_tr_b16 a[238:239], v16 offset:10240
 v_xor_b32 v16, 0, v12
 v_add_u32 v16, 65536, v16
 ds_read_b64_tr_b16 a[240:241], v16 offset:16384
 ds_read_b64_tr_b16 a[242:243], v16 offset:24576
 ds_read_b64_tr_b16 a[244:245], v16 offset:18432
 ds_read_b64_tr_b16 a[246:247], v16 offset:26624
 v_xor_b32 v16, 32, v12
 v_add_u32 v16, 65536, v16
 ds_read_b64_tr_b16 a[248:249], v16 offset:16384
 ds_read_b64_tr_b16 a[250:251], v16 offset:24576
 ds_read_b64_tr_b16 a[252:253], v16 offset:18432
 ds_read_b64_tr_b16 a[254:255], v16 offset:26624
 s_waitcnt lgkmcnt(0)
 s_barrier
 s_lshl_b32 s14, s52, 8
 s_add_u32 s14, s14, 2359296
 s_mov_b32 m0, 73728
 s_nop 0
 buffer_load_dwordx4 v10, s[8:11], s14 offen lds
 s_add_u32 s14, s14, 32768
 s_mov_b32 m0, 74752
 s_nop 0
 buffer_load_dwordx4 v10, s[8:11], s14 offen lds
 s_add_u32 s14, s14, 32768
 s_mov_b32 m0, 75776
 s_nop 0
 buffer_load_dwordx4 v10, s[8:11], s14 offen lds
 s_add_u32 s14, s14, 32768
 s_mov_b32 m0, 76800
 s_nop 0
 buffer_load_dwordx4 v10, s[8:11], s14 offen lds
 s_add_u32 s14, s14, 32768
 s_mov_b32 m0, 77824
 s_nop 0
 buffer_load_dwordx4 v11, s[8:11], s14 offen lds
 s_add_u32 s14, s14, 32768
 s_mov_b32 m0, 78848
 s_nop 0
 buffer_load_dwordx4 v11, s[8:11], s14 offen lds
 s_add_u32 s14, s14, 32768
 s_mov_b32 m0, 79872
 s_nop 0
 buffer_load_dwordx4 v11, s[8:11], s14 offen lds
 s_add_u32 s14, s14, 32768
 s_mov_b32 m0, 80896
 s_nop 0
 buffer_load_dwordx4 v11, s[8:11], s14 offen lds
 s_waitcnt vmcnt(32)
 s_barrier
 v_xor_b32 v16, 0, v12
 v_add_u32 v16, 98304, v16
 ds_read_b64_tr_b16 v[64:65], v16 offset:0
 ds_read_b64_tr_b16 v[66:67], v16 offset:8192
 ds_read_b64_tr_b16 v[68:69], v16 offset:2048
 ds_read_b64_tr_b16 v[70:71], v16 offset:10240
 v_xor_b32 v16, 32, v12
 v_add_u32 v16, 98304, v16
 ds_read_b64_tr_b16 v[72:73], v16 offset:0
 ds_read_b64_tr_b16 v[74:75], v16 offset:8192
 ds_read_b64_tr_b16 v[76:77], v16 offset:2048
 ds_read_b64_tr_b16 v[78:79], v16 offset:10240
 v_xor_b32 v16, 0, v12
 v_add_u32 v16, 98304, v16
 ds_read_b64_tr_b16 v[80:81], v16 offset:16384
 ds_read_b64_tr_b16 v[82:83], v16 offset:24576
 ds_read_b64_tr_b16 v[84:85], v16 offset:18432
 ds_read_b64_tr_b16 v[86:87], v16 offset:26624
 v_xor_b32 v16, 32, v12
 v_add_u32 v16, 98304, v16
 ds_read_b64_tr_b16 v[88:89], v16 offset:16384
 ds_read_b64_tr_b16 v[90:91], v16 offset:24576
 ds_read_b64_tr_b16 v[92:93], v16 offset:18432
 ds_read_b64_tr_b16 v[94:95], v16 offset:26624
 s_waitcnt lgkmcnt(0)
 s_barrier
 s_lshl_b32 s14, s52, 8
 s_add_u32 s14, s14, 3407872
 s_mov_b32 m0, 106496
 s_nop 0
 buffer_load_dwordx4 v10, s[8:11], s14 offen lds
 s_add_u32 s14, s14, 32768
 s_mov_b32 m0, 107520
 s_nop 0
 buffer_load_dwordx4 v10, s[8:11], s14 offen lds
 s_add_u32 s14, s14, 32768
 s_mov_b32 m0, 108544
 s_nop 0
 buffer_load_dwordx4 v10, s[8:11], s14 offen lds
 s_add_u32 s14, s14, 32768
 s_mov_b32 m0, 109568
 s_nop 0
 buffer_load_dwordx4 v10, s[8:11], s14 offen lds
 s_add_u32 s14, s14, 32768
 s_mov_b32 m0, 110592
 s_nop 0
 buffer_load_dwordx4 v11, s[8:11], s14 offen lds
 s_add_u32 s14, s14, 32768
 s_mov_b32 m0, 111616
 s_nop 0
 buffer_load_dwordx4 v11, s[8:11], s14 offen lds
 s_add_u32 s14, s14, 32768
 s_mov_b32 m0, 112640
 s_nop 0
 buffer_load_dwordx4 v11, s[8:11], s14 offen lds
 s_add_u32 s14, s14, 32768
 s_mov_b32 m0, 113664
 s_nop 0
 buffer_load_dwordx4 v11, s[8:11], s14 offen lds
 s_waitcnt vmcnt(32)
 s_barrier
 v_xor_b32 v16, 0, v12
 v_add_u32 v16, 131072, v16
 ds_read_b64_tr_b16 v[96:97], v16 offset:0
 ds_read_b64_tr_b16 v[98:99], v16 offset:8192
 ds_read_b64_tr_b16 v[100:101], v16 offset:2048
 ds_read_b64_tr_b16 v[102:103], v16 offset:10240
 v_xor_b32 v16, 32, v12
 v_add_u32 v16, 131072, v16
 ds_read_b64_tr_b16 v[104:105], v16 offset:0
 ds_read_b64_tr_b16 v[106:107], v16 offset:8192
 ds_read_b64_tr_b16 v[108:109], v16 offset:2048
 ds_read_b64_tr_b16 v[110:111], v16 offset:10240
 v_xor_b32 v16, 0, v12
 v_add_u32 v16, 131072, v16
 ds_read_b64_tr_b16 v[112:113], v16 offset:16384
 ds_read_b64_tr_b16 v[114:115], v16 offset:24576
 ds_read_b64_tr_b16 v[116:117], v16 offset:18432
 ds_read_b64_tr_b16 v[118:119], v16 offset:26624
 v_xor_b32 v16, 32, v12
 v_add_u32 v16, 131072, v16
 ds_read_b64_tr_b16 v[120:121], v16 offset:16384
 ds_read_b64_tr_b16 v[122:123], v16 offset:24576
 ds_read_b64_tr_b16 v[124:125], v16 offset:18432
 ds_read_b64_tr_b16 v[126:127], v16 offset:26624
 s_waitcnt lgkmcnt(0)
 s_barrier
 s_lshl_b32 s14, s52, 8
 s_add_u32 s14, s14, 4456448
 s_mov_b32 m0, 139264
 s_nop 0
 buffer_load_dwordx4 v10, s[8:11], s14 offen lds
 s_add_u32 s14, s14, 32768
 s_mov_b32 m0, 140288
 s_nop 0
 buffer_load_dwordx4 v10, s[8:11], s14 offen lds
 s_add_u32 s14, s14, 32768
 s_mov_b32 m0, 141312
 s_nop 0
 buffer_load_dwordx4 v10, s[8:11], s14 offen lds
 s_add_u32 s14, s14, 32768
 s_mov_b32 m0, 142336
 s_nop 0
 buffer_load_dwordx4 v10, s[8:11], s14 offen lds
 s_add_u32 s14, s14, 32768
 s_mov_b32 m0, 143360
 s_nop 0
 buffer_load_dwordx4 v11, s[8:11], s14 offen lds
 s_add_u32 s14, s14, 32768
 s_mov_b32 m0, 144384
 s_nop 0
 buffer_load_dwordx4 v11, s[8:11], s14 offen lds
 s_add_u32 s14, s14, 32768
 s_mov_b32 m0, 145408
 s_nop 0
 buffer_load_dwordx4 v11, s[8:11], s14 offen lds
 s_add_u32 s14, s14, 32768
 s_mov_b32 m0, 146432
 s_nop 0
 buffer_load_dwordx4 v11, s[8:11], s14 offen lds
 s_waitcnt vmcnt(32)
 s_barrier
 v_xor_b32 v16, 0, v12
 v_add_u32 v16, 0, v16
 ds_read_b64_tr_b16 v[128:129], v16 offset:0
 ds_read_b64_tr_b16 v[130:131], v16 offset:8192
 ds_read_b64_tr_b16 v[132:133], v16 offset:2048
 ds_read_b64_tr_b16 v[134:135], v16 offset:10240
 v_xor_b32 v16, 32, v12
 v_add_u32 v16, 0, v16
 ds_read_b64_tr_b16 v[136:137], v16 offset:0
 ds_read_b64_tr_b16 v[138:139], v16 offset:8192
 ds_read_b64_tr_b16 v[140:141], v16 offset:2048
 ds_read_b64_tr_b16 v[142:143], v16 offset:10240
 v_xor_b32 v16, 0, v12
 v_add_u32 v16, 0, v16
 ds_read_b64_tr_b16 v[144:145], v16 offset:16384
 ds_read_b64_tr_b16 v[146:147], v16 offset:24576
 ds_read_b64_tr_b16 v[148:149], v16 offset:18432
 ds_read_b64_tr_b16 v[150:151], v16 offset:26624
 v_xor_b32 v16, 32, v12
 v_add_u32 v16, 0, v16
 ds_read_b64_tr_b16 v[152:153], v16 offset:16384
 ds_read_b64_tr_b16 v[154:155], v16 offset:24576
 ds_read_b64_tr_b16 v[156:157], v16 offset:18432
 ds_read_b64_tr_b16 v[158:159], v16 offset:26624
 s_waitcnt lgkmcnt(0)
 s_barrier
 s_mov_b32 s8, s20
 s_and_b32 s9, s21, 0xffff
 s_mov_b32 s10, 5242880
 s_lshl_b32 s14, s52, 8
 s_add_u32 s14, s14, 262144
 s_mov_b32 m0, 8192
 s_nop 0
 buffer_load_dwordx4 v10, s[8:11], s14 offen lds
 s_add_u32 s14, s14, 32768
 s_mov_b32 m0, 9216
 s_nop 0
 buffer_load_dwordx4 v10, s[8:11], s14 offen lds
 s_add_u32 s14, s14, 32768
 s_mov_b32 m0, 10240
 s_nop 0
 buffer_load_dwordx4 v10, s[8:11], s14 offen lds
 s_add_u32 s14, s14, 32768
 s_mov_b32 m0, 11264
 s_nop 0
 buffer_load_dwordx4 v10, s[8:11], s14 offen lds
 s_add_u32 s14, s14, 32768
 s_mov_b32 m0, 12288
 s_nop 0
 buffer_load_dwordx4 v11, s[8:11], s14 offen lds
 s_add_u32 s14, s14, 32768
 s_mov_b32 m0, 13312
 s_nop 0
 buffer_load_dwordx4 v11, s[8:11], s14 offen lds
 s_add_u32 s14, s14, 32768
 s_mov_b32 m0, 14336
 s_nop 0
 buffer_load_dwordx4 v11, s[8:11], s14 offen lds
 s_add_u32 s14, s14, 32768
 s_mov_b32 m0, 15360
 s_nop 0
 buffer_load_dwordx4 v11, s[8:11], s14 offen lds
 s_waitcnt vmcnt(32)
 s_barrier
 v_xor_b32 v16, 0, v12
 v_add_u32 v16, 32768, v16
 ds_read_b64_tr_b16 v[32:33], v16 offset:0
 ds_read_b64_tr_b16 v[34:35], v16 offset:8192
 ds_read_b64_tr_b16 v[36:37], v16 offset:2048
 ds_read_b64_tr_b16 v[38:39], v16 offset:10240
 s_add_u32 s3, s63, 0
 s_waitcnt lgkmcnt(2)
 buffer_store_dwordx4 v[32:35], v1, s[4:7], s3 offen offset:0
 s_waitcnt lgkmcnt(0)
 buffer_store_dwordx4 v[36:39], v1, s[4:7], s3 offen offset:1024
 v_xor_b32 v16, 32, v12
 v_add_u32 v16, 32768, v16
 ds_read_b64_tr_b16 v[40:41], v16 offset:0
 ds_read_b64_tr_b16 v[42:43], v16 offset:8192
 ds_read_b64_tr_b16 v[44:45], v16 offset:2048
 ds_read_b64_tr_b16 v[46:47], v16 offset:10240
 s_add_u32 s3, s63, 2048
 s_waitcnt lgkmcnt(2)
 buffer_store_dwordx4 v[40:43], v1, s[4:7], s3 offen offset:0
 s_waitcnt lgkmcnt(0)
 buffer_store_dwordx4 v[44:47], v1, s[4:7], s3 offen offset:1024
 v_xor_b32 v16, 0, v12
 v_add_u32 v16, 32768, v16
 ds_read_b64_tr_b16 v[48:49], v16 offset:16384
 ds_read_b64_tr_b16 v[50:51], v16 offset:24576
 ds_read_b64_tr_b16 v[52:53], v16 offset:18432
 ds_read_b64_tr_b16 v[54:55], v16 offset:26624
 s_add_u32 s3, s63, 4096
 s_waitcnt lgkmcnt(2)
 buffer_store_dwordx4 v[48:51], v1, s[4:7], s3 offen offset:0
 s_waitcnt lgkmcnt(0)
 buffer_store_dwordx4 v[52:55], v1, s[4:7], s3 offen offset:1024
 v_xor_b32 v16, 32, v12
 v_add_u32 v16, 32768, v16
 ds_read_b64_tr_b16 v[56:57], v16 offset:16384
 ds_read_b64_tr_b16 v[58:59], v16 offset:24576
 ds_read_b64_tr_b16 v[60:61], v16 offset:18432
 ds_read_b64_tr_b16 v[62:63], v16 offset:26624
 s_add_u32 s3, s63, 6144
 s_waitcnt lgkmcnt(2)
 buffer_store_dwordx4 v[56:59], v1, s[4:7], s3 offen offset:0
 s_waitcnt lgkmcnt(0)
 buffer_store_dwordx4 v[60:63], v1, s[4:7], s3 offen offset:1024
 s_waitcnt lgkmcnt(0)
 s_barrier
 s_lshl_b32 s14, s52, 8
 s_add_u32 s14, s14, 1310720
 s_mov_b32 m0, 40960
 s_nop 0
 buffer_load_dwordx4 v10, s[8:11], s14 offen lds
 s_add_u32 s14, s14, 32768
 s_mov_b32 m0, 41984
 s_nop 0
 buffer_load_dwordx4 v10, s[8:11], s14 offen lds
 s_add_u32 s14, s14, 32768
 s_mov_b32 m0, 43008
 s_nop 0
 buffer_load_dwordx4 v10, s[8:11], s14 offen lds
 s_add_u32 s14, s14, 32768
 s_mov_b32 m0, 44032
 s_nop 0
 buffer_load_dwordx4 v10, s[8:11], s14 offen lds
 s_add_u32 s14, s14, 32768
 s_mov_b32 m0, 45056
 s_nop 0
 buffer_load_dwordx4 v11, s[8:11], s14 offen lds
 s_add_u32 s14, s14, 32768
 s_mov_b32 m0, 46080
 s_nop 0
 buffer_load_dwordx4 v11, s[8:11], s14 offen lds
 s_add_u32 s14, s14, 32768
 s_mov_b32 m0, 47104
 s_nop 0
 buffer_load_dwordx4 v11, s[8:11], s14 offen lds
 s_add_u32 s14, s14, 32768
 s_mov_b32 m0, 48128
 s_nop 0
 buffer_load_dwordx4 v11, s[8:11], s14 offen lds
 s_waitcnt vmcnt(40)
 s_barrier
 v_xor_b32 v16, 0, v12
 v_add_u32 v16, 65536, v16
 ds_read_b64_tr_b16 v[160:161], v16 offset:0
 ds_read_b64_tr_b16 v[162:163], v16 offset:8192
 ds_read_b64_tr_b16 v[164:165], v16 offset:2048
 ds_read_b64_tr_b16 v[166:167], v16 offset:10240
 v_xor_b32 v16, 32, v12
 v_add_u32 v16, 65536, v16
 ds_read_b64_tr_b16 v[168:169], v16 offset:0
 ds_read_b64_tr_b16 v[170:171], v16 offset:8192
 ds_read_b64_tr_b16 v[172:173], v16 offset:2048
 ds_read_b64_tr_b16 v[174:175], v16 offset:10240
 v_xor_b32 v16, 0, v12
 v_add_u32 v16, 65536, v16
 ds_read_b64_tr_b16 v[176:177], v16 offset:16384
 ds_read_b64_tr_b16 v[178:179], v16 offset:24576
 ds_read_b64_tr_b16 v[180:181], v16 offset:18432
 ds_read_b64_tr_b16 v[182:183], v16 offset:26624
 v_xor_b32 v16, 32, v12
 v_add_u32 v16, 65536, v16
 ds_read_b64_tr_b16 v[184:185], v16 offset:16384
 ds_read_b64_tr_b16 v[186:187], v16 offset:24576
 ds_read_b64_tr_b16 v[188:189], v16 offset:18432
 ds_read_b64_tr_b16 v[190:191], v16 offset:26624
 s_waitcnt lgkmcnt(0)
 s_barrier
 s_lshl_b32 s14, s52, 8
 s_add_u32 s14, s14, 2359296
 s_mov_b32 m0, 73728
 s_nop 0
 buffer_load_dwordx4 v10, s[8:11], s14 offen lds
 s_add_u32 s14, s14, 32768
 s_mov_b32 m0, 74752
 s_nop 0
 buffer_load_dwordx4 v10, s[8:11], s14 offen lds
 s_add_u32 s14, s14, 32768
 s_mov_b32 m0, 75776
 s_nop 0
 buffer_load_dwordx4 v10, s[8:11], s14 offen lds
 s_add_u32 s14, s14, 32768
 s_mov_b32 m0, 76800
 s_nop 0
 buffer_load_dwordx4 v10, s[8:11], s14 offen lds
 s_add_u32 s14, s14, 32768
 s_mov_b32 m0, 77824
 s_nop 0
 buffer_load_dwordx4 v11, s[8:11], s14 offen lds
 s_add_u32 s14, s14, 32768
 s_mov_b32 m0, 78848
 s_nop 0
 buffer_load_dwordx4 v11, s[8:11], s14 offen lds
 s_add_u32 s14, s14, 32768
 s_mov_b32 m0, 79872
 s_nop 0
 buffer_load_dwordx4 v11, s[8:11], s14 offen lds
 s_add_u32 s14, s14, 32768
 s_mov_b32 m0, 80896
 s_nop 0
 buffer_load_dwordx4 v11, s[8:11], s14 offen lds
 s_waitcnt vmcnt(40)
 s_barrier
 v_xor_b32 v16, 0, v12
 v_add_u32 v16, 98304, v16
 ds_read_b64_tr_b16 v[192:193], v16 offset:0
 ds_read_b64_tr_b16 v[194:195], v16 offset:8192
 ds_read_b64_tr_b16 v[196:197], v16 offset:2048
 ds_read_b64_tr_b16 v[198:199], v16 offset:10240
 v_xor_b32 v16, 32, v12
 v_add_u32 v16, 98304, v16
 ds_read_b64_tr_b16 v[32:33], v16 offset:0
 ds_read_b64_tr_b16 v[34:35], v16 offset:8192
 ds_read_b64_tr_b16 v[36:37], v16 offset:2048
 ds_read_b64_tr_b16 v[38:39], v16 offset:10240
 s_add_u32 s3, s63, 8192
 s_waitcnt lgkmcnt(2)
 buffer_store_dwordx4 v[32:35], v1, s[4:7], s3 offen offset:0
 s_waitcnt lgkmcnt(0)
 buffer_store_dwordx4 v[36:39], v1, s[4:7], s3 offen offset:1024
 v_xor_b32 v16, 0, v12
 v_add_u32 v16, 98304, v16
 ds_read_b64_tr_b16 v[200:201], v16 offset:16384
 ds_read_b64_tr_b16 v[202:203], v16 offset:24576
 ds_read_b64_tr_b16 v[204:205], v16 offset:18432
 ds_read_b64_tr_b16 v[206:207], v16 offset:26624
 v_xor_b32 v16, 32, v12
 v_add_u32 v16, 98304, v16
 ds_read_b64_tr_b16 v[208:209], v16 offset:16384
 ds_read_b64_tr_b16 v[210:211], v16 offset:24576
 ds_read_b64_tr_b16 v[212:213], v16 offset:18432
 ds_read_b64_tr_b16 v[214:215], v16 offset:26624
 s_waitcnt lgkmcnt(0)
 s_barrier
 s_lshl_b32 s14, s52, 8
 s_add_u32 s14, s14, 3407872
 s_mov_b32 m0, 106496
 s_nop 0
 buffer_load_dwordx4 v10, s[8:11], s14 offen lds
 s_add_u32 s14, s14, 32768
 s_mov_b32 m0, 107520
 s_nop 0
 buffer_load_dwordx4 v10, s[8:11], s14 offen lds
 s_add_u32 s14, s14, 32768
 s_mov_b32 m0, 108544
 s_nop 0
 buffer_load_dwordx4 v10, s[8:11], s14 offen lds
 s_add_u32 s14, s14, 32768
 s_mov_b32 m0, 109568
 s_nop 0
 buffer_load_dwordx4 v10, s[8:11], s14 offen lds
 s_add_u32 s14, s14, 32768
 s_mov_b32 m0, 110592
 s_nop 0
 buffer_load_dwordx4 v11, s[8:11], s14 offen lds
 s_add_u32 s14, s14, 32768
 s_mov_b32 m0, 111616
 s_nop 0
 buffer_load_dwordx4 v11, s[8:11], s14 offen lds
 s_add_u32 s14, s14, 32768
 s_mov_b32 m0, 112640
 s_nop 0
 buffer_load_dwordx4 v11, s[8:11], s14 offen lds
 s_add_u32 s14, s14, 32768
 s_mov_b32 m0, 113664
 s_nop 0
 buffer_load_dwordx4 v11, s[8:11], s14 offen lds
 s_waitcnt vmcnt(42)
 s_barrier
 v_xor_b32 v16, 0, v12
 v_add_u32 v16, 131072, v16
 ds_read_b64_tr_b16 v[216:217], v16 offset:0
 ds_read_b64_tr_b16 v[218:219], v16 offset:8192
 ds_read_b64_tr_b16 v[220:221], v16 offset:2048
 ds_read_b64_tr_b16 v[222:223], v16 offset:10240
 v_xor_b32 v16, 32, v12
 v_add_u32 v16, 131072, v16
 ds_read_b64_tr_b16 v[224:225], v16 offset:0
 ds_read_b64_tr_b16 v[226:227], v16 offset:8192
 ds_read_b64_tr_b16 v[228:229], v16 offset:2048
 ds_read_b64_tr_b16 v[230:231], v16 offset:10240
 v_xor_b32 v16, 0, v12
 v_add_u32 v16, 131072, v16
 ds_read_b64_tr_b16 v[232:233], v16 offset:16384
 ds_read_b64_tr_b16 v[234:235], v16 offset:24576
 ds_read_b64_tr_b16 v[236:237], v16 offset:18432
 ds_read_b64_tr_b16 v[238:239], v16 offset:26624
 v_xor_b32 v16, 32, v12
 v_add_u32 v16, 131072, v16
 ds_read_b64_tr_b16 v[40:41], v16 offset:16384
 ds_read_b64_tr_b16 v[42:43], v16 offset:24576
 ds_read_b64_tr_b16 v[44:45], v16 offset:18432
 ds_read_b64_tr_b16 v[46:47], v16 offset:26624
 s_add_u32 s3, s63, 10240
 s_waitcnt lgkmcnt(2)
 buffer_store_dwordx4 v[40:43], v1, s[4:7], s3 offen offset:0
 s_waitcnt lgkmcnt(0)
 buffer_store_dwordx4 v[44:47], v1, s[4:7], s3 offen offset:1024
 s_waitcnt lgkmcnt(0)
 s_barrier
 s_lshl_b32 s14, s52, 8
 s_add_u32 s14, s14, 4456448
 s_mov_b32 m0, 139264
 s_nop 0
 buffer_load_dwordx4 v10, s[8:11], s14 offen lds
 s_add_u32 s14, s14, 32768
 s_mov_b32 m0, 140288
 s_nop 0
 buffer_load_dwordx4 v10, s[8:11], s14 offen lds
 s_add_u32 s14, s14, 32768
 s_mov_b32 m0, 141312
 s_nop 0
 buffer_load_dwordx4 v10, s[8:11], s14 offen lds
 s_add_u32 s14, s14, 32768
 s_mov_b32 m0, 142336
 s_nop 0
 buffer_load_dwordx4 v10, s[8:11], s14 offen lds
 s_add_u32 s14, s14, 32768
 s_mov_b32 m0, 143360
 s_nop 0
 buffer_load_dwordx4 v11, s[8:11], s14 offen lds
 s_add_u32 s14, s14, 32768
 s_mov_b32 m0, 144384
 s_nop 0
 buffer_load_dwordx4 v11, s[8:11], s14 offen lds
 s_add_u32 s14, s14, 32768
 s_mov_b32 m0, 145408
 s_nop 0
 buffer_load_dwordx4 v11, s[8:11], s14 offen lds
 s_add_u32 s14, s14, 32768
 s_mov_b32 m0, 146432
 s_nop 0
 buffer_load_dwordx4 v11, s[8:11], s14 offen lds
 s_waitcnt vmcnt(44)
 s_barrier
 v_xor_b32 v16, 0, v12
 v_add_u32 v16, 0, v16
 ds_read_b64_tr_b16 v[240:241], v16 offset:0
 ds_read_b64_tr_b16 v[242:243], v16 offset:8192
 ds_read_b64_tr_b16 v[244:245], v16 offset:2048
 ds_read_b64_tr_b16 v[246:247], v16 offset:10240
 v_xor_b32 v16, 32, v12
 v_add_u32 v16, 0, v16
 ds_read_b64_tr_b16 v[248:249], v16 offset:0
 ds_read_b64_tr_b16 v[250:251], v16 offset:8192
 ds_read_b64_tr_b16 v[252:253], v16 offset:2048
 ds_read_b64_tr_b16 v[254:255], v16 offset:10240
 v_xor_b32 v16, 0, v12
 v_add_u32 v16, 0, v16
 ds_read_b64_tr_b16 v[32:33], v16 offset:16384
 ds_read_b64_tr_b16 v[34:35], v16 offset:24576
 ds_read_b64_tr_b16 v[36:37], v16 offset:18432
 ds_read_b64_tr_b16 v[38:39], v16 offset:26624
 v_xor_b32 v16, 32, v12
 v_add_u32 v16, 0, v16
 ds_read_b64_tr_b16 v[40:41], v16 offset:16384
 ds_read_b64_tr_b16 v[42:43], v16 offset:24576
 ds_read_b64_tr_b16 v[44:45], v16 offset:18432
 ds_read_b64_tr_b16 v[46:47], v16 offset:26624
 s_waitcnt lgkmcnt(0)
 s_barrier
 ds_write_b128 v1, v[224:227] offset:20480
 ds_write_b128 v1, v[228:231] offset:21504
 ds_write_b128 v1, v[216:219] offset:22528
 ds_write_b128 v1, v[220:223] offset:23552
 s_waitcnt lgkmcnt(0)
 v_mov_b32 v224, v32
 v_mov_b32 v225, v33
 v_mov_b32 v226, v34
 v_mov_b32 v227, v35
 v_mov_b32 v228, v36
 v_mov_b32 v229, v37
 v_mov_b32 v230, v38
 v_mov_b32 v231, v39
 v_mov_b32 v216, v40
 v_mov_b32 v217, v41
 v_mov_b32 v218, v42
 v_mov_b32 v219, v43
 v_mov_b32 v220, v44
 v_mov_b32 v221, v45
 v_mov_b32 v222, v46
 v_mov_b32 v223, v47
 s_waitcnt vmcnt(28)
 s_barrier
 v_xor_b32 v16, 0, v12
 v_add_u32 v16, 32768, v16
 ds_read_b64_tr_b16 v[32:33], v16 offset:0
 ds_read_b64_tr_b16 v[34:35], v16 offset:8192
 ds_read_b64_tr_b16 v[36:37], v16 offset:2048
 ds_read_b64_tr_b16 v[38:39], v16 offset:10240
 v_xor_b32 v16, 32, v12
 v_add_u32 v16, 32768, v16
 ds_read_b64_tr_b16 v[40:41], v16 offset:0
 ds_read_b64_tr_b16 v[42:43], v16 offset:8192
 ds_read_b64_tr_b16 v[44:45], v16 offset:2048
 ds_read_b64_tr_b16 v[46:47], v16 offset:10240
 v_xor_b32 v16, 0, v12
 v_add_u32 v16, 32768, v16
 ds_read_b64_tr_b16 v[48:49], v16 offset:16384
 ds_read_b64_tr_b16 v[50:51], v16 offset:24576
 ds_read_b64_tr_b16 v[52:53], v16 offset:18432
 ds_read_b64_tr_b16 v[54:55], v16 offset:26624
 v_xor_b32 v16, 32, v12
 v_add_u32 v16, 32768, v16
 ds_read_b64_tr_b16 v[56:57], v16 offset:16384
 ds_read_b64_tr_b16 v[58:59], v16 offset:24576
 ds_read_b64_tr_b16 v[60:61], v16 offset:18432
 ds_read_b64_tr_b16 v[62:63], v16 offset:26624
 s_waitcnt lgkmcnt(0)
 s_barrier
 ds_write_b128 v1, v[200:203] offset:40960
 ds_write_b128 v1, v[204:207] offset:41984
 ds_write_b128 v1, v[192:195] offset:43008
 ds_write_b128 v1, v[196:199] offset:44032
 ds_write_b128 v1, v[184:187] offset:45056
 ds_write_b128 v1, v[188:191] offset:46080
 ds_write_b128 v1, v[176:179] offset:47104
 ds_write_b128 v1, v[180:183] offset:48128
 s_waitcnt lgkmcnt(0)
 v_mov_b32 v200, v32
 v_mov_b32 v201, v33
 v_mov_b32 v202, v34
 v_mov_b32 v203, v35
 v_mov_b32 v204, v36
 v_mov_b32 v205, v37
 v_mov_b32 v206, v38
 v_mov_b32 v207, v39
 v_mov_b32 v192, v40
 v_mov_b32 v193, v41
 v_mov_b32 v194, v42
 v_mov_b32 v195, v43
 v_mov_b32 v196, v44
 v_mov_b32 v197, v45
 v_mov_b32 v198, v46
 v_mov_b32 v199, v47
 v_mov_b32 v184, v48
 v_mov_b32 v185, v49
 v_mov_b32 v186, v50
 v_mov_b32 v187, v51
 v_mov_b32 v188, v52
 v_mov_b32 v189, v53
 v_mov_b32 v190, v54
 v_mov_b32 v191, v55
 v_mov_b32 v176, v56
 v_mov_b32 v177, v57
 v_mov_b32 v178, v58
 v_mov_b32 v179, v59
 v_mov_b32 v180, v60
 v_mov_b32 v181, v61
 v_mov_b32 v182, v62
 v_mov_b32 v183, v63
 s_waitcnt vmcnt(20)
 s_barrier
 v_xor_b32 v16, 0, v12
 v_add_u32 v16, 65536, v16
 ds_read_b64_tr_b16 v[32:33], v16 offset:0
 ds_read_b64_tr_b16 v[34:35], v16 offset:8192
 ds_read_b64_tr_b16 v[36:37], v16 offset:2048
 ds_read_b64_tr_b16 v[38:39], v16 offset:10240
 v_xor_b32 v16, 32, v12
 v_add_u32 v16, 65536, v16
 ds_read_b64_tr_b16 v[40:41], v16 offset:0
 ds_read_b64_tr_b16 v[42:43], v16 offset:8192
 ds_read_b64_tr_b16 v[44:45], v16 offset:2048
 ds_read_b64_tr_b16 v[46:47], v16 offset:10240
 v_xor_b32 v16, 0, v12
 v_add_u32 v16, 65536, v16
 ds_read_b64_tr_b16 v[48:49], v16 offset:16384
 ds_read_b64_tr_b16 v[50:51], v16 offset:24576
 ds_read_b64_tr_b16 v[52:53], v16 offset:18432
 ds_read_b64_tr_b16 v[54:55], v16 offset:26624
 v_xor_b32 v16, 32, v12
 v_add_u32 v16, 65536, v16
 ds_read_b64_tr_b16 v[56:57], v16 offset:16384
 ds_read_b64_tr_b16 v[58:59], v16 offset:24576
 ds_read_b64_tr_b16 v[60:61], v16 offset:18432
 ds_read_b64_tr_b16 v[62:63], v16 offset:26624
 s_waitcnt lgkmcnt(0)
 s_barrier
 ds_write_b128 v2, v[160:163] offset:8192
 ds_write_b128 v2, v[164:167] offset:9216
 ds_write_b128 v2, v[144:147] offset:10240
 ds_write_b128 v2, v[148:151] offset:11264
 ds_write_b128 v2, v[136:139] offset:12288
 ds_write_b128 v2, v[140:143] offset:13312
 ds_write_b128 v2, v[128:131] offset:14336
 ds_write_b128 v2, v[132:135] offset:15360
 s_waitcnt lgkmcnt(0)
 v_mov_b32 v160, v32
 v_mov_b32 v161, v33
 v_mov_b32 v162, v34
 v_mov_b32 v163, v35
 v_mov_b32 v164, v36
 v_mov_b32 v165, v37
 v_mov_b32 v166, v38
 v_mov_b32 v167, v39
 v_mov_b32 v144, v40
 v_mov_b32 v145, v41
 v_mov_b32 v146, v42
 v_mov_b32 v147, v43
 v_mov_b32 v148, v44
 v_mov_b32 v149, v45
 v_mov_b32 v150, v46
 v_mov_b32 v151, v47
 v_mov_b32 v136, v48
 v_mov_b32 v137, v49
 v_mov_b32 v138, v50
 v_mov_b32 v139, v51
 v_mov_b32 v140, v52
 v_mov_b32 v141, v53
 v_mov_b32 v142, v54
 v_mov_b32 v143, v55
 v_mov_b32 v128, v56
 v_mov_b32 v129, v57
 v_mov_b32 v130, v58
 v_mov_b32 v131, v59
 v_mov_b32 v132, v60
 v_mov_b32 v133, v61
 v_mov_b32 v134, v62
 v_mov_b32 v135, v63
 s_waitcnt vmcnt(10)
 s_barrier
 v_xor_b32 v16, 0, v12
 v_add_u32 v16, 98304, v16
 ds_read_b64_tr_b16 v[32:33], v16 offset:0
 ds_read_b64_tr_b16 v[34:35], v16 offset:8192
 ds_read_b64_tr_b16 v[36:37], v16 offset:2048
 ds_read_b64_tr_b16 v[38:39], v16 offset:10240
 v_xor_b32 v16, 32, v12
 v_add_u32 v16, 98304, v16
 ds_read_b64_tr_b16 v[40:41], v16 offset:0
 ds_read_b64_tr_b16 v[42:43], v16 offset:8192
 ds_read_b64_tr_b16 v[44:45], v16 offset:2048
 ds_read_b64_tr_b16 v[46:47], v16 offset:10240
 v_xor_b32 v16, 0, v12
 v_add_u32 v16, 98304, v16
 ds_read_b64_tr_b16 v[48:49], v16 offset:16384
 ds_read_b64_tr_b16 v[50:51], v16 offset:24576
 ds_read_b64_tr_b16 v[52:53], v16 offset:18432
 ds_read_b64_tr_b16 v[54:55], v16 offset:26624
 v_xor_b32 v16, 32, v12
 v_add_u32 v16, 98304, v16
 ds_read_b64_tr_b16 v[56:57], v16 offset:16384
 ds_read_b64_tr_b16 v[58:59], v16 offset:24576
 ds_read_b64_tr_b16 v[60:61], v16 offset:18432
 ds_read_b64_tr_b16 v[62:63], v16 offset:26624
 s_waitcnt lgkmcnt(0)
 s_barrier
 ds_write_b128 v2, a[144:147] offset:40960
 ds_write_b128 v2, a[148:151] offset:41984
 ds_write_b128 v2, a[128:131] offset:43008
 ds_write_b128 v2, a[132:135] offset:44032
 ds_write_b128 v2, a[104:107] offset:45056
 ds_write_b128 v2, a[108:111] offset:46080
 ds_write_b128 v2, a[88:91] offset:47104
 ds_write_b128 v2, a[92:95] offset:48128
 s_waitcnt lgkmcnt(0)
 v_accvgpr_write_b32 a144, v32
 v_accvgpr_write_b32 a145, v33
 v_accvgpr_write_b32 a146, v34
 v_accvgpr_write_b32 a147, v35
 v_accvgpr_write_b32 a148, v36
 v_accvgpr_write_b32 a149, v37
 v_accvgpr_write_b32 a150, v38
 v_accvgpr_write_b32 a151, v39
 v_accvgpr_write_b32 a128, v40
 v_accvgpr_write_b32 a129, v41
 v_accvgpr_write_b32 a130, v42
 v_accvgpr_write_b32 a131, v43
 v_accvgpr_write_b32 a132, v44
 v_accvgpr_write_b32 a133, v45
 v_accvgpr_write_b32 a134, v46
 v_accvgpr_write_b32 a135, v47
 v_accvgpr_write_b32 a104, v48
 v_accvgpr_write_b32 a105, v49
 v_accvgpr_write_b32 a106, v50
 v_accvgpr_write_b32 a107, v51
 v_accvgpr_write_b32 a108, v52
 v_accvgpr_write_b32 a109, v53
 v_accvgpr_write_b32 a110, v54
 v_accvgpr_write_b32 a111, v55
 v_accvgpr_write_b32 a88, v56
 v_accvgpr_write_b32 a89, v57
 v_accvgpr_write_b32 a90, v58
 v_accvgpr_write_b32 a91, v59
 v_accvgpr_write_b32 a92, v60
 v_accvgpr_write_b32 a93, v61
 v_accvgpr_write_b32 a94, v62
 v_accvgpr_write_b32 a95, v63
 s_waitcnt vmcnt(0)
 s_barrier
 v_xor_b32 v16, 0, v12
 v_add_u32 v16, 131072, v16
 ds_read_b64_tr_b16 v[32:33], v16 offset:0
 ds_read_b64_tr_b16 v[34:35], v16 offset:8192
 ds_read_b64_tr_b16 v[36:37], v16 offset:2048
 ds_read_b64_tr_b16 v[38:39], v16 offset:10240
 v_xor_b32 v16, 32, v12
 v_add_u32 v16, 131072, v16
 ds_read_b64_tr_b16 v[40:41], v16 offset:0
 ds_read_b64_tr_b16 v[42:43], v16 offset:8192
 ds_read_b64_tr_b16 v[44:45], v16 offset:2048
 ds_read_b64_tr_b16 v[46:47], v16 offset:10240
 v_xor_b32 v16, 0, v12
 v_add_u32 v16, 131072, v16
 ds_read_b64_tr_b16 v[48:49], v16 offset:16384
 ds_read_b64_tr_b16 v[50:51], v16 offset:24576
 ds_read_b64_tr_b16 v[52:53], v16 offset:18432
 ds_read_b64_tr_b16 v[54:55], v16 offset:26624
 v_xor_b32 v16, 32, v12
 v_add_u32 v16, 131072, v16
 ds_read_b64_tr_b16 v[56:57], v16 offset:16384
 ds_read_b64_tr_b16 v[58:59], v16 offset:24576
 ds_read_b64_tr_b16 v[60:61], v16 offset:18432
 ds_read_b64_tr_b16 v[62:63], v16 offset:26624
 s_waitcnt lgkmcnt(0)
 s_barrier
 ds_write_b128 v3, a[80:83] offset:24576
 ds_write_b128 v3, a[84:87] offset:25600
 ds_write_b128 v3, a[72:75] offset:26624
 ds_write_b128 v3, a[76:79] offset:27648
 ds_write_b128 v3, a[32:35] offset:28672
 ds_write_b128 v3, a[36:39] offset:29696
 ds_write_b128 v3, a[24:27] offset:30720
 ds_write_b128 v3, a[28:31] offset:31744
 s_waitcnt lgkmcnt(0)
 v_accvgpr_write_b32 a80, v32
 v_accvgpr_write_b32 a81, v33
 v_accvgpr_write_b32 a82, v34
 v_accvgpr_write_b32 a83, v35
 v_accvgpr_write_b32 a84, v36
 v_accvgpr_write_b32 a85, v37
 v_accvgpr_write_b32 a86, v38
 v_accvgpr_write_b32 a87, v39
 v_accvgpr_write_b32 a72, v40
 v_accvgpr_write_b32 a73, v41
 v_accvgpr_write_b32 a74, v42
 v_accvgpr_write_b32 a75, v43
 v_accvgpr_write_b32 a76, v44
 v_accvgpr_write_b32 a77, v45
 v_accvgpr_write_b32 a78, v46
 v_accvgpr_write_b32 a79, v47
 v_accvgpr_write_b32 a32, v48
 v_accvgpr_write_b32 a33, v49
 v_accvgpr_write_b32 a34, v50
 v_accvgpr_write_b32 a35, v51
 v_accvgpr_write_b32 a36, v52
 v_accvgpr_write_b32 a37, v53
 v_accvgpr_write_b32 a38, v54
 v_accvgpr_write_b32 a39, v55
 v_accvgpr_write_b32 a24, v56
 v_accvgpr_write_b32 a25, v57
 v_accvgpr_write_b32 a26, v58
 v_accvgpr_write_b32 a27, v59
 v_accvgpr_write_b32 a28, v60
 v_accvgpr_write_b32 a29, v61
 v_accvgpr_write_b32 a30, v62
 v_accvgpr_write_b32 a31, v63
 v_lshlrev_b32 v5, 3, v0
 v_and_b32 v4, 15, v0
 v_lshlrev_b32 v4, 5, v4
 v_lshrrev_b32 v7, 4, v0
 v_lshl_add_u32 v4, v7, 3, v4
 v_add_u32 v4, 11264, v4
 v_and_b32 v6, 0x1e0, v5
 v_and_b32 v7, 1, v0
 v_lshl_add_u32 v6, v7, 4, v6
 v_and_b32 v7, 2, v0
 v_lshl_add_u32 v6, v7, 2, v6
 s_lshl_b32 s59, s53, 16
 s_add_u32 s59, s59, 917504
 s_mul_i32 s15, s53, 327680
 s_add_u32 s15, s15, 225280
 s_lshl_b32 s3, s52, 8
 s_add_u32 s15, s15, s3
 s_add_u32 s64, s15, 128
 s_add_u32 s65, s15, 82048
 s_add_u32 s66, s15, 163968
 s_add_u32 s67, s15, 245888
 s_lshr_b32 s14, s52, 2
 s_and_b32 s15, s52, 3
 s_mov_b32 s16, 2
 s_mov_b32 s84, 0x00ff00ff
 s_mov_b32 s85, 0
 s_lshl_b32 s57, s14, 10
 s_lshl_b32 s3, s15, 6
 s_add_u32 s57, s57, s3
 s_lshl_b32 s3, s16, 8
 s_add_u32 s57, s57, s3
 s_add_u32 s57, s57, s59
 s_add_u32 s59, s59, 2048
 s_lshl_b32 s14, s14, 7
 s_mul_i32 s15, s15, 2560
 s_add_u32 s14, s14, s15
 s_lshl_b32 s3, s16, 3
 s_add_u32 s14, s14, s3
 s_mov_b32 s8, s18
 s_and_b32 s9, s19, 0xffff
 s_mov_b32 s10, 10240
 s_mov_b32 s11, 0x00020000
 v_bfe_u32 v40, v0, 4, 1
 v_mul_u32_u24 v40, 1280, v40
 v_and_b32 v41, 7, v0
 v_lshl_add_u32 v40, v41, 1, v40
 buffer_load_ushort v44, v40, s[8:11], s14 offen offset:0
 buffer_load_ushort v45, v40, s[8:11], s14 offen offset:32
 buffer_load_ushort v46, v40, s[8:11], s14 offen offset:64
 buffer_load_ushort v47, v40, s[8:11], s14 offen offset:96
 v_lshrrev_b32 v42, 7, v1
 v_mul_u32_u24 v42, 10240, v42
 v_and_b32 v7, 112, v1
 v_add_u32 v42, v42, v7
 v_and_b32 v43, 32, v1
 v_and_b32 v7, 64, v1
 v_lshl_add_u32 v43, v7, 2, v43
 v_bfe_u32 v7, v1, 8, 1
 v_lshl_add_u32 v43, v7, 4, v43
 v_and_b32 v7, 8, v5
 v_add_u32 v43, v43, v7
 s_waitcnt vmcnt(2)
 v_lshl_or_b32 v44, v45, 16, v44
 s_waitcnt vmcnt(0)
 v_lshl_or_b32 v45, v47, 16, v46
 s_waitcnt vmcnt(0) lgkmcnt(0)
 s_mov_b32 s96, s44
 s_and_b32 s97, s45, 0xffff
 s_mov_b32 s98, 256
 s_mov_b32 s99, 0x00020000
 v_mov_b32 v8, 132
 s_mov_b32 s51, 0
 s_mov_b64 exec, 1
L_wb_173:
 buffer_load_dword v9, v8, s[96:99], 0 offen sc1
 s_waitcnt vmcnt(0)
 v_cmp_eq_u32 vcc, 0, v9
 s_cbranch_vccz L_wbd_174
 s_sleep 2
 s_add_u32 s51, s51, 1
 s_cmp_lt_u32 s51, 131072
 s_cbranch_scc1 L_wb_173
 s_branch L_bail
L_wbd_174:
 s_mov_b64 exec, -1
 s_mov_b32 s96, s44
 s_and_b32 s97, s45, 0xffff
 s_mov_b32 s98, 256
 s_mov_b32 s99, 0x00020000
 v_mov_b32 v8, 212
 s_mov_b32 s51, 0
 s_mov_b64 exec, 1
L_wb_175:
 buffer_load_dword v9, v8, s[96:99], 0 offen sc1
 s_waitcnt vmcnt(0)
 v_cmp_eq_u32 vcc, 0, v9
 s_cbranch_vccz L_wbd_176
 s_sleep 2
 s_add_u32 s51, s51, 1
 s_cmp_lt_u32 s51, 131072
 s_cbranch_scc1 L_wb_175
 s_branch L_bail
L_wbd_176:
 s_mov_b64 exec, -1
 s_mov_b32 s96, s44
 s_and_b32 s97, s45, 0xffff
 s_mov_b32 s98, 256
 s_mov_b32 s99, 0x00020000
 v_lshlrev_b32 v8, 5, v0
 s_mov_b32 s51, 0
L_gl_177:
 buffer_load_dword v9, v8, s[96:99], 0 offen sc1
 s_waitcnt vmcnt(0)
 v_readlane_b32 s3, v9, s48
 s_mov_b32 s80, 0
 s_nop 2
 s_cmp_ge_u32 s3, 32
 s_cbranch_scc1 L_gld_178
 s_mov_b32 s80, 0
 v_readlane_b32 s3, v9, 0
 s_nop 3
 s_add_u32 s80, s80, s3
 v_readlane_b32 s3, v9, 1
 s_nop 3
 s_add_u32 s80, s80, s3
 v_readlane_b32 s3, v9, 2
 s_nop 3
 s_add_u32 s80, s80, s3
 v_readlane_b32 s3, v9, 3
 s_nop 3
 s_add_u32 s80, s80, s3
 v_readlane_b32 s3, v9, 4
 s_nop 3
 s_add_u32 s80, s80, s3
 v_readlane_b32 s3, v9, 5
 s_nop 3
 s_add_u32 s80, s80, s3
 v_readlane_b32 s3, v9, 6
 s_nop 3
 s_add_u32 s80, s80, s3
 v_readlane_b32 s3, v9, 7
 s_nop 3
 s_add_u32 s80, s80, s3
 s_cmp_ge_u32 s80, 256
 s_cbranch_scc1 L_gld_178
 s_sleep 4
 s_add_u32 s51, s51, 1
 s_cmp_lt_u32 s51, 131072
 s_cbranch_scc1 L_gl_177
 s_branch L_bail
L_gld_178:
 s_mov_b64 exec, s[84:85]
 buffer_store_dwordx2 v[44:45], v43, s[4:7], s57 offen sc1
 s_mov_b64 exec, -1
 v_and_b32 v7, 2, v0
 v_mul_u32_u24 v7, 0x5555, v7
 v_add_u32 v0, 0x4444, v7
 s_mov_b32 m0, 2048
 s_waitcnt vmcnt(0) lgkmcnt(0)
 s_barrier
 buffer_load_dwordx4 v[32:35], v1, s[4:7], s63 offen offset:0
 buffer_load_dwordx4 v[36:39], v1, s[4:7], s63 offen offset:1024
 buffer_load_dwordx4 v[40:43], v1, s[4:7], s63 offen offset:2048
 buffer_load_dwordx4 v[44:47], v1, s[4:7], s63 offen offset:3072
 s_add_u32 s3, s63, 4096
 buffer_load_dwordx4 v[48:51], v1, s[4:7], s3 offen offset:0
 buffer_load_dwordx4 v[52:55], v1, s[4:7], s3 offen offset:1024
 s_add_u32 s3, s63, 4096
 buffer_load_dwordx4 v[56:59], v1, s[4:7], s3 offen offset:2048
 buffer_load_dwordx4 v[60:63], v1, s[4:7], s3 offen offset:3072
 ds_read_b128 v[8:11], v3 offset:49152
 ds_read_b128 v[12:15], v3 offset:49152
 ds_read_b128 v[16:19], v3 offset:49152
 ds_read_b128 v[20:23], v3 offset:49152
 s_waitcnt vmcnt(0) lgkmcnt(0)
 s_cmp_lg_u32 s80, 0
 s_cbranch_scc1 L_ch1_s
.p2align 6
L_ch1_f:
 s_mov_b32 s51, 0
L_pm_179:
 buffer_load_dwordx4 v[24:27], v1, s[4:7], s59 offen offset:0 sc1
 buffer_load_dwordx4 v[28:31], v1, s[4:7], s59 offen offset:1024 sc1
 s_waitcnt vmcnt(1)
 ds_write_b128 v1, v[24:27] offset:2048
 v_max_u32 v7, v24, v26
 s_waitcnt vmcnt(0)
 ds_write_b128 v1, v[28:31] offset:3072
 v_max3_u32 v7, v7, v28, v30
 v_cmp_eq_u32 vcc, -1, v7
 s_cbranch_vccnz L_rt_180
 v_smfmac_f32_16x16x64_bf16 v[16:19], v[24:27], v[32:39], v0
 ds_read_b128 v[32:35], v2 offset:14336
 ds_read_b128 v[36:39], v2 offset:15360
 v_smfmac_f32_16x16x64_bf16 v[20:23], v[24:27], v[40:47], v0
 ds_read_b128 v[40:43], v2 offset:12288
 ds_read_b128 v[44:47], v2 offset:13312
 v_smfmac_f32_16x16x64_bf16 v[16:19], v[28:31], v[48:55], v0
 v_smfmac_f32_16x16x64_bf16 v[20:23], v[28:31], v[56:63], v0
 s_waitcnt lgkmcnt(4)
 s_barrier
 s_add_u32 s3, s63, 8192
 buffer_load_dwordx4 v[56:59], v1, s[4:7], s3 offen offset:0
 buffer_load_dwordx4 v[60:63], v1, s[4:7], s3 offen offset:1024
 s_add_u32 s3, s63, 8192
 buffer_load_dwordx4 v[48:51], v1, s[4:7], s3 offen offset:2048
 buffer_load_dwordx4 v[52:55], v1, s[4:7], s3 offen offset:3072
 v_smfmac_f32_16x16x64_bf16 v[8:11], v[24:27], v[200:207], v0
 v_smfmac_f32_16x16x64_bf16 v[8:11], v[28:31], v[184:191], v0
 v_smfmac_f32_16x16x64_bf16 v[12:15], v[24:27], v[192:199], v0
 ds_read_b128 v[24:27], v1 offset:0
 v_smfmac_f32_16x16x64_bf16 v[12:15], v[28:31], v[176:183], v0
 ds_read_b128 v[28:31], v1 offset:1024
 s_waitcnt lgkmcnt(1)
 v_smfmac_f32_16x16x64_bf16 v[16:19], v[24:27], v[32:39], v0
 ds_read_b128 v[32:35], v2 offset:10240
 ds_read_b128 v[36:39], v2 offset:11264
 v_smfmac_f32_16x16x64_bf16 v[8:11], v[24:27], v[240:247], v0
 v_smfmac_f32_16x16x64_bf16 v[12:15], v[24:27], v[248:255], v0
 v_smfmac_f32_16x16x64_bf16 v[20:23], v[24:27], v[40:47], v0
 ds_read_b128 v[40:43], v2 offset:8192
 ds_read_b128 v[44:47], v2 offset:9216
 ds_read_b128 v[24:27], v1 offset:4096
 s_waitcnt lgkmcnt(5)
 v_smfmac_f32_16x16x64_bf16 v[8:11], v[28:31], v[224:231], v0
 v_smfmac_f32_16x16x64_bf16 v[12:15], v[28:31], v[216:223], v0
 s_waitcnt lgkmcnt(3)
 v_smfmac_f32_16x16x64_bf16 v[16:19], v[28:31], v[32:39], v0
 ds_read_b128 v[32:35], v1 offset:47104
 ds_read_b128 v[36:39], v1 offset:48128
 v_smfmac_f32_16x16x64_bf16 v[20:23], v[28:31], v[152:159], v0
 ds_read_b128 v[28:31], v1 offset:5120
 s_waitcnt lgkmcnt(3)
 v_smfmac_f32_16x16x64_bf16 v[8:11], v[24:27], v[160:167], v0
 v_smfmac_f32_16x16x64_bf16 v[16:19], v[24:27], v[40:47], v0
 ds_read_b128 v[40:43], v1 offset:45056
 ds_read_b128 v[44:47], v1 offset:46080
 v_smfmac_f32_16x16x64_bf16 v[12:15], v[24:27], v[144:151], v0
 v_smfmac_f32_16x16x64_bf16 v[20:23], v[24:27], v[168:175], v0
 ds_read_b128 v[24:27], v1 offset:6144
 s_waitcnt lgkmcnt(3)
 v_smfmac_f32_16x16x64_bf16 v[16:19], v[28:31], v[32:39], v0
 ds_read_b128 v[32:35], v1 offset:43008
 ds_read_b128 v[36:39], v1 offset:44032
 v_smfmac_f32_16x16x64_bf16 v[8:11], v[28:31], v[136:143], v0
 v_smfmac_f32_16x16x64_bf16 v[12:15], v[28:31], v[128:135], v0
 s_waitcnt lgkmcnt(3)
 v_smfmac_f32_16x16x64_bf16 v[20:23], v[28:31], v[40:47], v0
 ds_read_b128 v[40:43], v1 offset:40960
 ds_read_b128 v[44:47], v1 offset:41984
 ds_read_b128 v[28:31], v1 offset:7168
 s_waitcnt lgkmcnt(5)
 v_smfmac_f32_16x16x64_bf16 v[8:11], v[24:27], a[144:151], v0
 v_smfmac_f32_16x16x64_bf16 v[12:15], v[24:27], a[128:135], v0
 s_waitcnt lgkmcnt(3)
 v_smfmac_f32_16x16x64_bf16 v[16:19], v[24:27], v[32:39], v0
 ds_read_b128 v[32:35], v1 offset:22528
 ds_read_b128 v[36:39], v1 offset:23552
 s_waitcnt vmcnt(2)
 v_smfmac_f32_16x16x64_bf16 v[20:23], v[24:27], v[56:63], v0
 s_add_u32 s3, s61, 4096
 buffer_load_dwordx4 v[56:59], v1, s[4:7], s61 offen offset:1024 sc1
 buffer_load_dwordx4 v[60:63], v1, s[4:7], s3 offen offset:1024 sc1
 ds_read_b128 v[24:27], v1 offset:8192
 s_waitcnt lgkmcnt(3)
 v_smfmac_f32_16x16x64_bf16 v[8:11], v[28:31], a[104:111], v0
 v_smfmac_f32_16x16x64_bf16 v[16:19], v[28:31], v[40:47], v0
 ds_read_b128 v[40:43], v1 offset:20480
 ds_read_b128 v[44:47], v1 offset:21504
 v_smfmac_f32_16x16x64_bf16 v[12:15], v[28:31], a[88:95], v0
 v_smfmac_f32_16x16x64_bf16 v[20:23], v[28:31], v[208:215], v0
 ds_read_b128 v[28:31], v1 offset:9216
 s_waitcnt lgkmcnt(3)
 v_smfmac_f32_16x16x64_bf16 v[16:19], v[24:27], v[32:39], v0
 s_add_u32 s3, s61, 67110912
 buffer_load_dwordx4 v[32:35], v1, s[4:7], s3 offen offset:0 sc1
 buffer_load_dwordx4 v[36:39], v1, s[4:7], s3 offen offset:1024 sc1
 v_lshlrev_b32 v7, 3, v1
 s_add_u32 s3, s61, 524288
 buffer_load_dword v7, v7, s[4:7], s3 offen sc1
 v_smfmac_f32_16x16x64_bf16 v[8:11], v[24:27], a[80:87], v0
 v_smfmac_f32_16x16x64_bf16 v[12:15], v[24:27], a[72:79], v0
 s_waitcnt lgkmcnt(1)
 v_smfmac_f32_16x16x64_bf16 v[20:23], v[24:27], v[40:47], v0
 ds_read_b128 v[40:43], v3 offset:49152
 ds_read_b128 v[44:47], v3 offset:49152
 s_waitcnt lgkmcnt(2)
 v_smfmac_f32_16x16x64_bf16 v[8:11], v[28:31], a[32:39], v0
 v_smfmac_f32_16x16x64_bf16 v[12:15], v[28:31], a[24:31], v0
 v_smfmac_f32_16x16x64_bf16 v[16:19], v[28:31], v[232:239], v0
 s_waitcnt vmcnt(5)
 v_smfmac_f32_16x16x64_bf16 v[20:23], v[28:31], v[48:55], v0
 ds_read_b128 v[52:55], v1 offset:0
 v_add_f32 v8, v8, v10
 v_add_f32 v9, v9, v11
 v_cvt_pk_bf16_f32 v8, v8, v9
 v_add_f32 v12, v12, v14
 v_add_f32 v13, v13, v15
 v_cvt_pk_bf16_f32 v12, v12, v13
 ds_write2_b32 v4, v8, v8 offset0:0 offset1:1
 ds_write2_b32 v4, v12, v12 offset0:128 offset1:129
 ds_read_b64_tr_b16 v[12:13], v5 offset:11264
 ds_read_b64_tr_b16 v[14:15], v5 offset:11776
 v_add_f32 v16, v16, v18
 v_add_f32 v17, v17, v19
 v_cvt_pk_bf16_f32 v16, v16, v17
 v_add_f32 v20, v20, v22
 v_add_f32 v21, v21, v23
 v_cvt_pk_bf16_f32 v20, v20, v21
 ds_write2_b32 v4, v16, v20 offset0:0 offset1:128
 ds_read_b64_tr_b16 v[20:21], v5 offset:11264
 ds_read_b64_tr_b16 v[22:23], v5 offset:11776
 s_waitcnt lgkmcnt(9)
 v_smfmac_f32_16x16x64_bf16 v[40:43], v[24:27], v[96:103], v0
 s_waitcnt lgkmcnt(8)
 v_smfmac_f32_16x16x64_bf16 v[44:47], v[24:27], v[104:111], v0
 ds_read_b128 v[24:27], v1 offset:1024
 v_smfmac_f32_16x16x64_bf16 v[40:43], v[28:31], v[112:119], v0
 v_smfmac_f32_16x16x64_bf16 v[44:47], v[28:31], v[120:127], v0
 ds_read_b128 v[28:31], v1 offset:2048
 s_waitcnt vmcnt(4) lgkmcnt(5)
 v_mfma_f32_16x16x32_bf16 v[8:11], v[56:59], v[12:15], 0
 s_waitcnt vmcnt(3) lgkmcnt(4)
 v_mfma_f32_16x16x32_bf16 v[16:19], v[60:63], v[12:15], 0
 s_waitcnt lgkmcnt(2)
 v_mfma_f32_16x16x32_bf16 v[48:51], v[20:23], v[12:15], 0
 v_smfmac_f32_16x16x64_bf16 v[40:43], v[52:55], a[160:167], v0
 v_smfmac_f32_16x16x64_bf16 v[44:47], v[52:55], a[168:175], v0
 ds_read_b128 v[52:55], v1 offset:3072
 s_waitcnt lgkmcnt(2)
 v_smfmac_f32_16x16x64_bf16 v[40:43], v[24:27], a[176:183], v0
 v_cndmask_b32 v8, v8, v16, s[70:71]
 v_cndmask_b32 v9, v9, v17, s[70:71]
 v_cndmask_b32 v10, v10, v18, s[70:71]
 v_cndmask_b32 v11, v11, v19, s[70:71]
 ds_write_b128 v1, v[8:11] offset:11264
 ds_write_b64 v1, v[48:49] offset:14344
 v_smfmac_f32_16x16x64_bf16 v[44:47], v[24:27], a[184:191], v0
 ds_read_b128 v[24:27], v1 offset:4096
 s_waitcnt lgkmcnt(4)
 v_smfmac_f32_16x16x64_bf16 v[40:43], v[28:31], a[192:199], v0
 v_smfmac_f32_16x16x64_bf16 v[44:47], v[28:31], a[200:207], v0
 ds_read_b128 v[28:31], v1 offset:5120
 s_waitcnt lgkmcnt(4)
 v_smfmac_f32_16x16x64_bf16 v[40:43], v[52:55], a[208:215], v0
 v_smfmac_f32_16x16x64_bf16 v[44:47], v[52:55], a[216:223], v0
 ds_read_b128 v[52:55], v1 offset:6144
 s_waitcnt lgkmcnt(2)
 v_smfmac_f32_16x16x64_bf16 v[40:43], v[24:27], a[224:231], v0
 s_barrier
 ds_read_b128 v[56:59], v1 offset:10240
 ds_read_b128 v[60:63], v1 offset:12288
 ds_read_b128 v[16:19], v1 offset:13312
 ds_read_b128 v[12:15], v1 offset:14336
 ds_read_b128 v[48:51], v1 offset:15360
 v_smfmac_f32_16x16x64_bf16 v[44:47], v[24:27], a[232:239], v0
 ds_read_b128 v[24:27], v1 offset:7168
 s_mov_b64 exec, s[68:69]
 buffer_store_dwordx4 v[20:23], v6, s[4:7], s62 offen offset:512 sc1
 s_mov_b64 exec, -1
 s_waitcnt lgkmcnt(7)
 v_smfmac_f32_16x16x64_bf16 v[40:43], v[28:31], a[240:247], v0
 v_smfmac_f32_16x16x64_bf16 v[44:47], v[28:31], a[248:255], v0
 s_waitcnt lgkmcnt(6)
 v_smfmac_f32_16x16x64_bf16 v[40:43], v[52:55], v[64:71], v0
 v_smfmac_f32_16x16x64_bf16 v[44:47], v[52:55], v[72:79], v0
 s_waitcnt lgkmcnt(0)
 v_smfmac_f32_16x16x64_bf16 v[40:43], v[24:27], v[80:87], v0
 v_smfmac_f32_16x16x64_bf16 v[44:47], v[24:27], v[88:95], v0
 v_pk_add_f32 v[8:9], v[8:9], v[56:57]
 v_pk_add_f32 v[10:11], v[10:11], v[58:59]
 v_pk_add_f32 v[60:61], v[60:61], v[16:17]
 v_pk_add_f32 v[62:63], v[62:63], v[18:19]
 v_pk_add_f32 v[12:13], v[12:13], v[14:15]
 v_pk_add_f32 v[48:49], v[48:49], v[50:51]
 v_pk_add_f32 v[8:9], v[8:9], v[60:61]
 v_pk_add_f32 v[10:11], v[10:11], v[62:63]
 v_pk_add_f32 v[48:49], v[12:13], v[48:49]
 v_max3_f32 v50, v8, v9, v10
 v_max3_f32 v50, v50, v11, v48
 v_max_f32 v50, v50, v49
 v_add_f32 v40, v40, v42
 v_add_f32 v41, v41, v43
 v_max_f32_dpp v50, v50, v50 quad_perm:[2,3,0,1] row_mask:0xf bank_mask:0xf
 v_mov_b32 v51, v50
 v_add_f32 v44, v44, v46
 v_add_f32 v45, v45, v47
 v_permlane16_swap_b32 v50, v51
 v_max_f32 v50, v50, v51
 v_mov_b32 v51, v50
 v_cvt_pk_bf16_f32 v40, v40, v41
 v_cvt_pk_bf16_f32 v41, v44, v45
 v_permlane32_swap_b32 v50, v51
 v_max_f32 v50, v50, v51
 v_mul_f32 v50, s56, v50
 v_fma_f32 v48, v48, s56, -v50
 v_fma_f32 v49, v49, s56, -v50
 v_fma_f32 v8, v8, s56, -v50
 v_fma_f32 v9, v9, s56, -v50
 v_fma_f32 v10, v10, s56, -v50
 v_fma_f32 v11, v11, s56, -v50
 v_exp_f32 v48, v48
 v_exp_f32 v49, v49
 ds_read_b128 v[56:59], v3 offset:26624
 ds_read_b128 v[60:63], v3 offset:27648
 v_exp_f32 v8, v8
 v_exp_f32 v9, v9
 ds_read_b128 v[24:27], v2 offset:45056
 ds_read_b128 v[28:31], v2 offset:46080
 v_exp_f32 v10, v10
 buffer_store_dwordx2 v[40:41], v5, s[4:7], s62 offen offset:2560 sc1
 v_exp_f32 v11, v11
 v_cvt_pk_bf16_f32 v14, v48, v49
 v_cvt_pk_bf16_f32 v12, v8, v9
 v_cvt_pk_bf16_f32 v13, v10, v11
 v_cndmask_b32 v52, 0, v14, s[68:69]
 v_cndmask_b32 v53, 0, v14, s[70:71]
 v_cndmask_b32 v22, 0, v12, s[70:71]
 v_cndmask_b32 v23, 0, v13, s[70:71]
 v_mfma_f32_16x16x16_bf16 v[44:47], v[40:41], v[52:53], 0
 v_cndmask_b32 v16, 0, v12, s[68:69]
 v_cndmask_b32 v17, 0, v13, s[68:69]
 v_mov_b32_dpp v18, v22 quad_perm:[2,3,0,1] row_mask:0xf bank_mask:0xf
 v_mov_b32_dpp v19, v23 quad_perm:[2,3,0,1] row_mask:0xf bank_mask:0xf
 v_mov_b32_dpp v20, v16 quad_perm:[2,3,0,1] row_mask:0xf bank_mask:0xf
 v_mov_b32_dpp v21, v17 quad_perm:[2,3,0,1] row_mask:0xf bank_mask:0xf
 s_waitcnt vmcnt(4)
 v_mfma_f32_16x16x32_bf16 v[44:47], v[32:35], v[16:19], v[44:47]
 v_add_f32 v54, v8, v9
 v_add_f32 v55, v48, v49
 s_waitcnt vmcnt(3)
 v_mfma_f32_16x16x32_bf16 v[44:47], v[36:39], v[20:23], v[44:47]
 v_add_f32 v54, v54, v10
 v_fma_f32 v55, v55, 0.5, v11
 v_add_f32 v54, v54, v55
 ds_read_b128 v[16:19], v3 offset:49152
 ds_read_b128 v[20:23], v3 offset:49152
 v_add_f32_dpp v54, v54, v54 quad_perm:[2,3,0,1] row_mask:0xf bank_mask:0xf
 v_mov_b32 v55, v54
 ds_read_b128 v[32:35], v3 offset:49152
 ds_read_b128 v[36:39], v3 offset:49152
 v_permlane16_swap_b32 v54, v55
 v_add_f32 v54, v54, v55
 v_mov_b32 v55, v54
 ds_read_b128 v[8:11], v3 offset:49152
 s_cmp_eq_u32 s54, 63
 v_permlane32_swap_b32 v54, v55
 v_add_f32 v54, v54, v55
 v_rcp_f32 v54, v54
 s_cbranch_scc1 L_ch1_end
 v_mul_f32 v44, v44, v54
 v_mul_f32 v45, v45, v54
 v_cvt_pk_bf16_f32 v42, v44, v45
 v_mul_f32 v46, v46, v54
 v_mul_f32 v47, v47, v54
 v_cvt_pk_bf16_f32 v43, v46, v47
 ds_write_b64 v6, v[42:43] offset:512
 v_and_b32 v40, -9, v6
 v_mov_b32_dpp v12, v42 quad_perm:[0,1,0,1] row_mask:0xf bank_mask:0xf
 v_mov_b32_dpp v14, v42 quad_perm:[2,3,2,3] row_mask:0xf bank_mask:0xf
 v_mov_b32_dpp v13, v43 quad_perm:[0,1,0,1] row_mask:0xf bank_mask:0xf
 v_mov_b32_dpp v15, v43 quad_perm:[2,3,2,3] row_mask:0xf bank_mask:0xf
 s_waitcnt lgkmcnt(5)
 s_nop 0
 v_smfmac_f32_16x16x64_bf16 v[16:19], v[12:15], a[8:15], v0
 s_waitcnt lgkmcnt(4)
 v_smfmac_f32_16x16x64_bf16 v[20:23], v[12:15], a[40:47], v0
 s_waitcnt lgkmcnt(0)
 s_barrier
 ds_read_b128 v[48:51], v40 offset:0
 ds_read_b128 v[52:55], v40 offset:1024
 ds_read_b128 v[44:47], v40 offset:1536
 v_smfmac_f32_16x16x64_bf16 v[32:35], v[12:15], v[56:63], v0
 ds_read_b128 v[56:59], v3 offset:30720
 ds_read_b128 v[60:63], v3 offset:31744
 v_smfmac_f32_16x16x64_bf16 v[36:39], v[12:15], v[24:31], v0
 ds_read_b128 v[24:27], v3 offset:28672
 ds_read_b128 v[28:31], v3 offset:29696
 v_smfmac_f32_16x16x64_bf16 v[8:11], v[12:15], a[136:143], v0
 s_waitcnt lgkmcnt(6)
 v_smfmac_f32_16x16x64_bf16 v[16:19], v[48:51], a[0:7], v0
 s_waitcnt lgkmcnt(5)
 v_smfmac_f32_16x16x64_bf16 v[16:19], v[52:55], a[16:23], v0
 s_waitcnt lgkmcnt(2)
 v_smfmac_f32_16x16x64_bf16 v[16:19], v[44:47], v[56:63], v0
 ds_read_b128 v[56:59], v3 offset:24576
 ds_read_b128 v[60:63], v3 offset:25600
 s_waitcnt lgkmcnt(2)
 v_smfmac_f32_16x16x64_bf16 v[20:23], v[48:51], v[24:31], v0
 ds_read_b128 v[24:27], v2 offset:47104
 ds_read_b128 v[28:31], v2 offset:48128
 v_smfmac_f32_16x16x64_bf16 v[20:23], v[52:55], a[48:55], v0
 v_smfmac_f32_16x16x64_bf16 v[20:23], v[44:47], a[56:63], v0
 v_cvt_pk_bf16_f32 v16, v16, v17
 v_smfmac_f32_16x16x64_bf16 v[32:35], v[48:51], a[64:71], v0
 v_cvt_pk_bf16_f32 v17, v18, v19
 s_waitcnt lgkmcnt(2)
 v_smfmac_f32_16x16x64_bf16 v[32:35], v[52:55], v[56:63], v0
 ds_read_b128 v[56:59], v2 offset:43008
 ds_read_b128 v[60:63], v2 offset:44032
 v_and_or_b32 v16, v16, -2, s55
 s_waitcnt lgkmcnt(2)
 v_smfmac_f32_16x16x64_bf16 v[32:35], v[44:47], v[24:31], v0
 ds_read_b128 v[24:27], v2 offset:40960
 ds_read_b128 v[28:31], v2 offset:41984
 v_cvt_pk_bf16_f32 v18, v20, v21
 v_smfmac_f32_16x16x64_bf16 v[36:39], v[48:51], a[96:103], v0
 v_cvt_pk_bf16_f32 v19, v22, v23
 v_smfmac_f32_16x16x64_bf16 v[36:39], v[52:55], a[112:119], v0
 v_and_or_b32 v18, v18, -2, s55
 buffer_store_dwordx4 v[16:19], v1, s[4:7], s60 offen offset:0
 v_smfmac_f32_16x16x64_bf16 v[36:39], v[44:47], a[120:127], v0
 v_cvt_pk_bf16_f32 v32, v32, v33
 s_waitcnt lgkmcnt(2)
 v_smfmac_f32_16x16x64_bf16 v[8:11], v[48:51], v[56:63], v0
 v_cvt_pk_bf16_f32 v33, v34, v35
 s_waitcnt lgkmcnt(0)
 v_smfmac_f32_16x16x64_bf16 v[8:11], v[52:55], v[24:31], v0
 v_and_or_b32 v32, v32, -2, s55
 v_smfmac_f32_16x16x64_bf16 v[8:11], v[44:47], a[152:159], v0
 v_cvt_pk_bf16_f32 v34, v36, v37
 v_cvt_pk_bf16_f32 v35, v38, v39
 v_and_or_b32 v34, v34, -2, s55
 buffer_store_dwordx4 v[32:35], v1, s[4:7], s60 offen offset:1024
 s_add_u32 s3, s60, 6144
 s_nop 2
 v_cvt_pk_bf16_f32 v8, v8, v9
 v_cvt_pk_bf16_f32 v9, v10, v11
 v_and_or_b32 v8, v8, -2, s55
 buffer_store_dwordx2 v[8:9], v1, s[4:7], s3 offen offset:8
 buffer_load_dwordx4 v[32:35], v1, s[4:7], s63 offen offset:0
 buffer_load_dwordx4 v[36:39], v1, s[4:7], s63 offen offset:1024
 s_add_u32 s54, s54, 1
 s_add_u32 s61, s61, 524288
 s_and_b32 s3, s54, 7
 s_cselect_b32 s3, 1, -7
 s_lshl_b32 s3, s3, 17
 s_add_u32 s62, s62, s3
 s_and_b32 s3, s54, 3
 s_cselect_b32 s3, 1, -3
 s_lshl_b32 s3, s3, 14
 s_add_u32 s58, s57, s3
 s_add_u32 s59, s59, s3
 v_lshrrev_b32 v56, 7, v1
 v_mul_u32_u24 v56, 10240, v56
 v_and_b32 v60, 112, v1
 v_add_u32 v56, v56, v60
 v_and_b32 v57, 32, v1
 v_and_b32 v60, 64, v1
 v_lshl_add_u32 v57, v60, 2, v57
 v_bfe_u32 v60, v1, 8, 1
 v_lshl_add_u32 v57, v60, 4, v57
 v_and_b32 v60, 8, v5
 v_add_u32 v57, v57, v60
 v_mov_b32 v60, 0x3f80
 v_mov_b32 v28, 0x3f800000
 v_cndmask_b32 v60, v60, v28, s[82:83]
 v_cndmask_b32 v28, 0, v60, s[72:73]
 v_cndmask_b32 v29, 0, v60, s[74:75]
 v_cndmask_b32 v30, 0, v60, s[76:77]
 v_cndmask_b32 v31, 0, v60, s[78:79]
 v_mov_b64 v[58:59], -1
 s_nop 15
 s_nop 15
 s_nop 15
 s_nop 1
 s_mov_b32 s51, 0
L_pp_181:
 buffer_load_dwordx4 v[8:11], v56, s[4:7], s64 offen sc1
 buffer_load_dwordx4 v[12:15], v56, s[4:7], s65 offen sc1
 buffer_load_dwordx4 v[16:19], v56, s[4:7], s66 offen sc1
 buffer_load_dwordx4 v[20:23], v56, s[4:7], s67 offen sc1
 s_waitcnt vmcnt(3)
 v_mfma_f32_16x16x32_bf16 v[24:27], v[28:31], v[8:11], 0
 v_bitop3_b32 v60, v8, v10, s55 bitop3:0x7e
 s_waitcnt vmcnt(2)
 v_mfma_f32_16x16x32_bf16 v[24:27], v[28:31], v[12:15], v[24:27]
 v_bitop3_b32 v61, v12, v14, s55 bitop3:0x7e
 s_waitcnt vmcnt(1)
 v_mfma_f32_16x16x32_bf16 v[24:27], v[28:31], v[16:19], v[24:27]
 v_bitop3_b32 v62, v16, v18, s55 bitop3:0x7e
 s_waitcnt vmcnt(0)
 v_mfma_f32_16x16x32_bf16 v[24:27], v[28:31], v[20:23], v[24:27]
 v_bitop3_b32 v63, v20, v22, s55 bitop3:0x7e
 v_or3_b32 v7, v60, v61, v62
 v_bitop3_b32 v7, v7, v63, 1 bitop3:0xa8
 v_cmp_ne_u32 vcc, 0, v7
 s_cbranch_vccnz L_rt_182
 s_nop 2
 v_add_f32_dpp v24, v24, v24 row_ror:8 row_mask:0xf bank_mask:0xf
 v_add_f32_dpp v25, v25, v25 row_ror:8 row_mask:0xf bank_mask:0xf
 v_add_f32_dpp v26, v26, v26 row_ror:8 row_mask:0xf bank_mask:0xf
 v_add_f32_dpp v27, v27, v27 row_ror:8 row_mask:0xf bank_mask:0xf
 s_mov_b64 exec, s[84:85]
 v_cvt_pk_bf16_f32 v24, v24, v25
 v_cvt_pk_bf16_f32 v25, v26, v27
 buffer_store_dwordx2 v[24:25], v57, s[4:7], s58 offen
 buffer_store_dwordx2 v[58:59], v57, s[4:7], s57 offen
 s_mov_b64 exec, -1
 s_mov_b32 s57, s58
 s_xor_b32 s55, s55, 1
 buffer_load_dwordx4 v[40:43], v1, s[4:7], s63 offen offset:2048
 buffer_load_dwordx4 v[44:47], v1, s[4:7], s63 offen offset:3072
 s_add_u32 s3, s63, 4096
 buffer_load_dwordx4 v[48:51], v1, s[4:7], s3 offen offset:0
 buffer_load_dwordx4 v[52:55], v1, s[4:7], s3 offen offset:1024
 s_add_u32 s3, s63, 4096
 buffer_load_dwordx4 v[56:59], v1, s[4:7], s3 offen offset:2048
 buffer_load_dwordx4 v[60:63], v1, s[4:7], s3 offen offset:3072
 ds_read_b128 v[8:11], v3 offset:49152
 ds_read_b128 v[12:15], v3 offset:49152
 ds_read_b128 v[16:19], v3 offset:49152
 ds_read_b128 v[20:23], v3 offset:49152
 s_waitcnt lgkmcnt(0)
 s_nop 15
 s_nop 15
 s_nop 7
 s_branch L_ch1_f
L_rt_180:
 s_waitcnt lgkmcnt(0)
 s_add_u32 s51, s51, 1
 s_cmp_lt_u32 s51, 131072
 s_cbranch_scc1 L_pm_179
 s_branch L_bail
L_rt_182:
 s_add_u32 s51, s51, 1
 s_cmp_lt_u32 s51, 131072
 s_cbranch_scc1 L_pp_181
 s_branch L_bail
.p2align 6
L_ch1_s:
 s_mov_b32 s51, 0
L_pm_183:
 buffer_load_dwordx4 v[24:27], v1, s[4:7], s59 offen offset:0 sc1
 buffer_load_dwordx4 v[28:31], v1, s[4:7], s59 offen offset:1024 sc1
 s_waitcnt vmcnt(1)
 ds_write_b128 v1, v[24:27] offset:2048
 v_max_u32 v7, v24, v26
 s_waitcnt vmcnt(0)
 ds_write_b128 v1, v[28:31] offset:3072
 v_max3_u32 v7, v7, v28, v30
 v_cmp_eq_u32 vcc, -1, v7
 s_cbranch_vccnz L_rt_184
 v_smfmac_f32_16x16x64_bf16 v[16:19], v[24:27], v[32:39], v0
 ds_read_b128 v[32:35], v2 offset:14336
 ds_read_b128 v[36:39], v2 offset:15360
 v_smfmac_f32_16x16x64_bf16 v[20:23], v[24:27], v[40:47], v0
 ds_read_b128 v[40:43], v2 offset:12288
 ds_read_b128 v[44:47], v2 offset:13312
 v_smfmac_f32_16x16x64_bf16 v[16:19], v[28:31], v[48:55], v0
 v_smfmac_f32_16x16x64_bf16 v[20:23], v[28:31], v[56:63], v0
 s_waitcnt lgkmcnt(4)
 s_barrier
 s_add_u32 s3, s63, 8192
 buffer_load_dwordx4 v[56:59], v1, s[4:7], s3 offen offset:0
 buffer_load_dwordx4 v[60:63], v1, s[4:7], s3 offen offset:1024
 s_add_u32 s3, s63, 8192
 buffer_load_dwordx4 v[48:51], v1, s[4:7], s3 offen offset:2048
 buffer_load_dwordx4 v[52:55], v1, s[4:7], s3 offen offset:3072
 v_smfmac_f32_16x16x64_bf16 v[8:11], v[24:27], v[200:207], v0
 v_smfmac_f32_16x16x64_bf16 v[8:11], v[28:31], v[184:191], v0
 v_smfmac_f32_16x16x64_bf16 v[12:15], v[24:27], v[192:199], v0
 ds_read_b128 v[24:27], v1 offset:0
 v_smfmac_f32_16x16x64_bf16 v[12:15], v[28:31], v[176:183], v0
 ds_read_b128 v[28:31], v1 offset:1024
 s_waitcnt lgkmcnt(1)
 v_smfmac_f32_16x16x64_bf16 v[16:19], v[24:27], v[32:39], v0
 ds_read_b128 v[32:35], v2 offset:10240
 ds_read_b128 v[36:39], v2 offset:11264
 v_smfmac_f32_16x16x64_bf16 v[8:11], v[24:27], v[240:247], v0
 v_smfmac_f32_16x16x64_bf16 v[12:15], v[24:27], v[248:255], v0
 v_smfmac_f32_16x16x64_bf16 v[20:23], v[24:27], v[40:47], v0
 ds_read_b128 v[40:43], v2 offset:8192
 ds_read_b128 v[44:47], v2 offset:9216
 ds_read_b128 v[24:27], v1 offset:4096
 s_waitcnt lgkmcnt(5)
 v_smfmac_f32_16x16x64_bf16 v[8:11], v[28:31], v[224:231], v0
 v_smfmac_f32_16x16x64_bf16 v[12:15], v[28:31], v[216:223], v0
 s_waitcnt lgkmcnt(3)
 v_smfmac_f32_16x16x64_bf16 v[16:19], v[28:31], v[32:39], v0
 ds_read_b128 v[32:35], v1 offset:47104
 ds_read_b128 v[36:39], v1 offset:48128
 v_smfmac_f32_16x16x64_bf16 v[20:23], v[28:31], v[152:159], v0
 ds_read_b128 v[28:31], v1 offset:5120
 s_waitcnt lgkmcnt(3)
 v_smfmac_f32_16x16x64_bf16 v[8:11], v[24:27], v[160:167], v0
 v_smfmac_f32_16x16x64_bf16 v[16:19], v[24:27], v[40:47], v0
 ds_read_b128 v[40:43], v1 offset:45056
 ds_read_b128 v[44:47], v1 offset:46080
 v_smfmac_f32_16x16x64_bf16 v[12:15], v[24:27], v[144:151], v0
 v_smfmac_f32_16x16x64_bf16 v[20:23], v[24:27], v[168:175], v0
 ds_read_b128 v[24:27], v1 offset:6144
 s_waitcnt lgkmcnt(3)
 v_smfmac_f32_16x16x64_bf16 v[16:19], v[28:31], v[32:39], v0
 ds_read_b128 v[32:35], v1 offset:43008
 ds_read_b128 v[36:39], v1 offset:44032
 v_smfmac_f32_16x16x64_bf16 v[8:11], v[28:31], v[136:143], v0
 v_smfmac_f32_16x16x64_bf16 v[12:15], v[28:31], v[128:135], v0
 s_waitcnt lgkmcnt(3)
 v_smfmac_f32_16x16x64_bf16 v[20:23], v[28:31], v[40:47], v0
 ds_read_b128 v[40:43], v1 offset:40960
 ds_read_b128 v[44:47], v1 offset:41984
 ds_read_b128 v[28:31], v1 offset:7168
 s_waitcnt lgkmcnt(5)
 v_smfmac_f32_16x16x64_bf16 v[8:11], v[24:27], a[144:151], v0
 v_smfmac_f32_16x16x64_bf16 v[12:15], v[24:27], a[128:135], v0
 s_waitcnt lgkmcnt(3)
 v_smfmac_f32_16x16x64_bf16 v[16:19], v[24:27], v[32:39], v0
 ds_read_b128 v[32:35], v1 offset:22528
 ds_read_b128 v[36:39], v1 offset:23552
 s_waitcnt vmcnt(2)
 v_smfmac_f32_16x16x64_bf16 v[20:23], v[24:27], v[56:63], v0
 s_add_u32 s3, s61, 4096
 buffer_load_dwordx4 v[56:59], v1, s[4:7], s61 offen offset:1024 sc1
 buffer_load_dwordx4 v[60:63], v1, s[4:7], s3 offen offset:1024 sc1
 ds_read_b128 v[24:27], v1 offset:8192
 s_waitcnt lgkmcnt(3)
 v_smfmac_f32_16x16x64_bf16 v[8:11], v[28:31], a[104:111], v0
 v_smfmac_f32_16x16x64_bf16 v[16:19], v[28:31], v[40:47], v0
 ds_read_b128 v[40:43], v1 offset:20480
 ds_read_b128 v[44:47], v1 offset:21504
 v_smfmac_f32_16x16x64_bf16 v[12:15], v[28:31], a[88:95], v0
 v_smfmac_f32_16x16x64_bf16 v[20:23], v[28:31], v[208:215], v0
 ds_read_b128 v[28:31], v1 offset:9216
 s_waitcnt lgkmcnt(3)
 v_smfmac_f32_16x16x64_bf16 v[16:19], v[24:27], v[32:39], v0
 s_add_u32 s3, s61, 67110912
 buffer_load_dwordx4 v[32:35], v1, s[4:7], s3 offen offset:0 sc1
 buffer_load_dwordx4 v[36:39], v1, s[4:7], s3 offen offset:1024 sc1
 v_lshlrev_b32 v7, 3, v1
 s_add_u32 s3, s61, 524288
 buffer_load_dword v7, v7, s[4:7], s3 offen sc1
 v_smfmac_f32_16x16x64_bf16 v[8:11], v[24:27], a[80:87], v0
 v_smfmac_f32_16x16x64_bf16 v[12:15], v[24:27], a[72:79], v0
 s_waitcnt lgkmcnt(1)
 v_smfmac_f32_16x16x64_bf16 v[20:23], v[24:27], v[40:47], v0
 ds_read_b128 v[40:43], v3 offset:49152
 ds_read_b128 v[44:47], v3 offset:49152
 s_waitcnt lgkmcnt(2)
 v_smfmac_f32_16x16x64_bf16 v[8:11], v[28:31], a[32:39], v0
 v_smfmac_f32_16x16x64_bf16 v[12:15], v[28:31], a[24:31], v0
 v_smfmac_f32_16x16x64_bf16 v[16:19], v[28:31], v[232:239], v0
 s_waitcnt vmcnt(5)
 v_smfmac_f32_16x16x64_bf16 v[20:23], v[28:31], v[48:55], v0
 ds_read_b128 v[52:55], v1 offset:0
 v_add_f32 v8, v8, v10
 v_add_f32 v9, v9, v11
 v_cvt_pk_bf16_f32 v8, v8, v9
 v_add_f32 v12, v12, v14
 v_add_f32 v13, v13, v15
 v_cvt_pk_bf16_f32 v12, v12, v13
 ds_write2_b32 v4, v8, v8 offset0:0 offset1:1
 ds_write2_b32 v4, v12, v12 offset0:128 offset1:129
 ds_read_b64_tr_b16 v[12:13], v5 offset:11264
 ds_read_b64_tr_b16 v[14:15], v5 offset:11776
 v_add_f32 v16, v16, v18
 v_add_f32 v17, v17, v19
 v_cvt_pk_bf16_f32 v16, v16, v17
 v_add_f32 v20, v20, v22
 v_add_f32 v21, v21, v23
 v_cvt_pk_bf16_f32 v20, v20, v21
 ds_write2_b32 v4, v16, v20 offset0:0 offset1:128
 ds_read_b64_tr_b16 v[20:21], v5 offset:11264
 ds_read_b64_tr_b16 v[22:23], v5 offset:11776
 s_waitcnt lgkmcnt(9)
 v_smfmac_f32_16x16x64_bf16 v[40:43], v[24:27], v[96:103], v0
 s_waitcnt lgkmcnt(8)
 v_smfmac_f32_16x16x64_bf16 v[44:47], v[24:27], v[104:111], v0
 ds_read_b128 v[24:27], v1 offset:1024
 v_smfmac_f32_16x16x64_bf16 v[40:43], v[28:31], v[112:119], v0
 v_smfmac_f32_16x16x64_bf16 v[44:47], v[28:31], v[120:127], v0
 ds_read_b128 v[28:31], v1 offset:2048
 s_waitcnt vmcnt(4) lgkmcnt(5)
 v_mfma_f32_16x16x32_bf16 v[8:11], v[56:59], v[12:15], 0
 s_waitcnt vmcnt(3) lgkmcnt(4)
 v_mfma_f32_16x16x32_bf16 v[16:19], v[60:63], v[12:15], 0
 s_waitcnt lgkmcnt(2)
 v_mfma_f32_16x16x32_bf16 v[48:51], v[20:23], v[12:15], 0
 v_smfmac_f32_16x16x64_bf16 v[40:43], v[52:55], a[160:167], v0
 v_smfmac_f32_16x16x64_bf16 v[44:47], v[52:55], a[168:175], v0
 ds_read_b128 v[52:55], v1 offset:3072
 s_waitcnt lgkmcnt(2)
 v_smfmac_f32_16x16x64_bf16 v[40:43], v[24:27], a[176:183], v0
 v_cndmask_b32 v8, v8, v16, s[70:71]
 v_cndmask_b32 v9, v9, v17, s[70:71]
 v_cndmask_b32 v10, v10, v18, s[70:71]
 v_cndmask_b32 v11, v11, v19, s[70:71]
 ds_write_b128 v1, v[8:11] offset:11264
 ds_write_b64 v1, v[48:49] offset:14344
 v_smfmac_f32_16x16x64_bf16 v[44:47], v[24:27], a[184:191], v0
 ds_read_b128 v[24:27], v1 offset:4096
 s_waitcnt lgkmcnt(4)
 v_smfmac_f32_16x16x64_bf16 v[40:43], v[28:31], a[192:199], v0
 v_smfmac_f32_16x16x64_bf16 v[44:47], v[28:31], a[200:207], v0
 ds_read_b128 v[28:31], v1 offset:5120
 s_waitcnt lgkmcnt(4)
 v_smfmac_f32_16x16x64_bf16 v[40:43], v[52:55], a[208:215], v0
 v_smfmac_f32_16x16x64_bf16 v[44:47], v[52:55], a[216:223], v0
 ds_read_b128 v[52:55], v1 offset:6144
 s_waitcnt lgkmcnt(2)
 v_smfmac_f32_16x16x64_bf16 v[40:43], v[24:27], a[224:231], v0
 s_barrier
 ds_read_b128 v[56:59], v1 offset:10240
 ds_read_b128 v[60:63], v1 offset:12288
 ds_read_b128 v[16:19], v1 offset:13312
 ds_read_b128 v[12:15], v1 offset:14336
 ds_read_b128 v[48:51], v1 offset:15360
 v_smfmac_f32_16x16x64_bf16 v[44:47], v[24:27], a[232:239], v0
 ds_read_b128 v[24:27], v1 offset:7168
 s_mov_b64 exec, s[68:69]
 buffer_store_dwordx4 v[20:23], v6, s[4:7], s62 offen offset:512 sc1
 s_mov_b64 exec, -1
 s_waitcnt lgkmcnt(7)
 v_smfmac_f32_16x16x64_bf16 v[40:43], v[28:31], a[240:247], v0
 v_smfmac_f32_16x16x64_bf16 v[44:47], v[28:31], a[248:255], v0
 s_waitcnt lgkmcnt(6)
 v_smfmac_f32_16x16x64_bf16 v[40:43], v[52:55], v[64:71], v0
 v_smfmac_f32_16x16x64_bf16 v[44:47], v[52:55], v[72:79], v0
 s_waitcnt lgkmcnt(0)
 v_smfmac_f32_16x16x64_bf16 v[40:43], v[24:27], v[80:87], v0
 v_smfmac_f32_16x16x64_bf16 v[44:47], v[24:27], v[88:95], v0
 v_pk_add_f32 v[8:9], v[8:9], v[56:57]
 v_pk_add_f32 v[10:11], v[10:11], v[58:59]
 v_pk_add_f32 v[60:61], v[60:61], v[16:17]
 v_pk_add_f32 v[62:63], v[62:63], v[18:19]
 v_pk_add_f32 v[12:13], v[12:13], v[14:15]
 v_pk_add_f32 v[48:49], v[48:49], v[50:51]
 v_pk_add_f32 v[8:9], v[8:9], v[60:61]
 v_pk_add_f32 v[10:11], v[10:11], v[62:63]
 v_pk_add_f32 v[48:49], v[12:13], v[48:49]
 v_max3_f32 v50, v8, v9, v10
 v_max3_f32 v50, v50, v11, v48
 v_max_f32 v50, v50, v49
 v_add_f32 v40, v40, v42
 v_add_f32 v41, v41, v43
 v_max_f32_dpp v50, v50, v50 quad_perm:[2,3,0,1] row_mask:0xf bank_mask:0xf
 v_mov_b32 v51, v50
 v_add_f32 v44, v44, v46
 v_add_f32 v45, v45, v47
 v_permlane16_swap_b32 v50, v51
 v_max_f32 v50, v50, v51
 v_mov_b32 v51, v50
 v_cvt_pk_bf16_f32 v40, v40, v41
 v_cvt_pk_bf16_f32 v41, v44, v45
 v_permlane32_swap_b32 v50, v51
 v_max_f32 v50, v50, v51
 v_mul_f32 v50, s56, v50
 v_fma_f32 v48, v48, s56, -v50
 v_fma_f32 v49, v49, s56, -v50
 v_fma_f32 v8, v8, s56, -v50
 v_fma_f32 v9, v9, s56, -v50
 v_fma_f32 v10, v10, s56, -v50
 v_fma_f32 v11, v11, s56, -v50
 v_exp_f32 v48, v48
 v_exp_f32 v49, v49
 ds_read_b128 v[56:59], v3 offset:26624
 ds_read_b128 v[60:63], v3 offset:27648
 v_exp_f32 v8, v8
 v_exp_f32 v9, v9
 ds_read_b128 v[24:27], v2 offset:45056
 ds_read_b128 v[28:31], v2 offset:46080
 v_exp_f32 v10, v10
 buffer_store_dwordx2 v[40:41], v5, s[4:7], s62 offen offset:2560 sc1
 v_exp_f32 v11, v11
 v_cvt_pk_bf16_f32 v14, v48, v49
 v_cvt_pk_bf16_f32 v12, v8, v9
 v_cvt_pk_bf16_f32 v13, v10, v11
 v_cndmask_b32 v52, 0, v14, s[68:69]
 v_cndmask_b32 v53, 0, v14, s[70:71]
 v_cndmask_b32 v22, 0, v12, s[70:71]
 v_cndmask_b32 v23, 0, v13, s[70:71]
 v_mfma_f32_16x16x16_bf16 v[44:47], v[40:41], v[52:53], 0
 v_cndmask_b32 v16, 0, v12, s[68:69]
 v_cndmask_b32 v17, 0, v13, s[68:69]
 v_mov_b32_dpp v18, v22 quad_perm:[2,3,0,1] row_mask:0xf bank_mask:0xf
 v_mov_b32_dpp v19, v23 quad_perm:[2,3,0,1] row_mask:0xf bank_mask:0xf
 v_mov_b32_dpp v20, v16 quad_perm:[2,3,0,1] row_mask:0xf bank_mask:0xf
 v_mov_b32_dpp v21, v17 quad_perm:[2,3,0,1] row_mask:0xf bank_mask:0xf
 s_waitcnt vmcnt(4)
 v_mfma_f32_16x16x32_bf16 v[44:47], v[32:35], v[16:19], v[44:47]
 v_add_f32 v54, v8, v9
 v_add_f32 v55, v48, v49
 s_waitcnt vmcnt(3)
 v_mfma_f32_16x16x32_bf16 v[44:47], v[36:39], v[20:23], v[44:47]
 v_add_f32 v54, v54, v10
 v_fma_f32 v55, v55, 0.5, v11
 v_add_f32 v54, v54, v55
 ds_read_b128 v[16:19], v3 offset:49152
 ds_read_b128 v[20:23], v3 offset:49152
 v_add_f32_dpp v54, v54, v54 quad_perm:[2,3,0,1] row_mask:0xf bank_mask:0xf
 v_mov_b32 v55, v54
 ds_read_b128 v[32:35], v3 offset:49152
 ds_read_b128 v[36:39], v3 offset:49152
 v_permlane16_swap_b32 v54, v55
 v_add_f32 v54, v54, v55
 v_mov_b32 v55, v54
 ds_read_b128 v[8:11], v3 offset:49152
 s_cmp_eq_u32 s54, 63
 v_permlane32_swap_b32 v54, v55
 v_add_f32 v54, v54, v55
 v_rcp_f32 v54, v54
 s_cbranch_scc1 L_ch1_end
 v_mul_f32 v44, v44, v54
 v_mul_f32 v45, v45, v54
 v_cvt_pk_bf16_f32 v42, v44, v45
 v_mul_f32 v46, v46, v54
 v_mul_f32 v47, v47, v54
 v_cvt_pk_bf16_f32 v43, v46, v47
 ds_write_b64 v6, v[42:43] offset:512
 v_and_b32 v40, -9, v6
 v_mov_b32_dpp v12, v42 quad_perm:[0,1,0,1] row_mask:0xf bank_mask:0xf
 v_mov_b32_dpp v14, v42 quad_perm:[2,3,2,3] row_mask:0xf bank_mask:0xf
 v_mov_b32_dpp v13, v43 quad_perm:[0,1,0,1] row_mask:0xf bank_mask:0xf
 v_mov_b32_dpp v15, v43 quad_perm:[2,3,2,3] row_mask:0xf bank_mask:0xf
 s_waitcnt lgkmcnt(5)
 s_nop 0
 v_smfmac_f32_16x16x64_bf16 v[16:19], v[12:15], a[8:15], v0
 s_waitcnt lgkmcnt(4)
 v_smfmac_f32_16x16x64_bf16 v[20:23], v[12:15], a[40:47], v0
 s_waitcnt lgkmcnt(0)
 s_barrier
 ds_read_b128 v[48:51], v40 offset:0
 ds_read_b128 v[52:55], v40 offset:1024
 ds_read_b128 v[44:47], v40 offset:1536
 v_smfmac_f32_16x16x64_bf16 v[32:35], v[12:15], v[56:63], v0
 ds_read_b128 v[56:59], v3 offset:30720
 ds_read_b128 v[60:63], v3 offset:31744
 v_smfmac_f32_16x16x64_bf16 v[36:39], v[12:15], v[24:31], v0
 ds_read_b128 v[24:27], v3 offset:28672
 ds_read_b128 v[28:31], v3 offset:29696
 v_smfmac_f32_16x16x64_bf16 v[8:11], v[12:15], a[136:143], v0
 s_waitcnt lgkmcnt(6)
 v_smfmac_f32_16x16x64_bf16 v[16:19], v[48:51], a[0:7], v0
 s_waitcnt lgkmcnt(5)
 v_smfmac_f32_16x16x64_bf16 v[16:19], v[52:55], a[16:23], v0
 s_waitcnt lgkmcnt(2)
 v_smfmac_f32_16x16x64_bf16 v[16:19], v[44:47], v[56:63], v0
 ds_read_b128 v[56:59], v3 offset:24576
 ds_read_b128 v[60:63], v3 offset:25600
 s_waitcnt lgkmcnt(2)
 v_smfmac_f32_16x16x64_bf16 v[20:23], v[48:51], v[24:31], v0
 ds_read_b128 v[24:27], v2 offset:47104
 ds_read_b128 v[28:31], v2 offset:48128
 v_smfmac_f32_16x16x64_bf16 v[20:23], v[52:55], a[48:55], v0
 v_smfmac_f32_16x16x64_bf16 v[20:23], v[44:47], a[56:63], v0
 v_cvt_pk_bf16_f32 v16, v16, v17
 v_smfmac_f32_16x16x64_bf16 v[32:35], v[48:51], a[64:71], v0
 v_cvt_pk_bf16_f32 v17, v18, v19
 s_waitcnt lgkmcnt(2)
 v_smfmac_f32_16x16x64_bf16 v[32:35], v[52:55], v[56:63], v0
 ds_read_b128 v[56:59], v2 offset:43008
 ds_read_b128 v[60:63], v2 offset:44032
 v_and_or_b32 v16, v16, -2, s55
 s_waitcnt lgkmcnt(2)
 v_smfmac_f32_16x16x64_bf16 v[32:35], v[44:47], v[24:31], v0
 ds_read_b128 v[24:27], v2 offset:40960
 ds_read_b128 v[28:31], v2 offset:41984
 v_cvt_pk_bf16_f32 v18, v20, v21
 v_smfmac_f32_16x16x64_bf16 v[36:39], v[48:51], a[96:103], v0
 v_cvt_pk_bf16_f32 v19, v22, v23
 v_smfmac_f32_16x16x64_bf16 v[36:39], v[52:55], a[112:119], v0
 v_and_or_b32 v18, v18, -2, s55
 buffer_store_dwordx4 v[16:19], v1, s[4:7], s60 offen offset:0 sc1
 v_smfmac_f32_16x16x64_bf16 v[36:39], v[44:47], a[120:127], v0
 v_cvt_pk_bf16_f32 v32, v32, v33
 s_waitcnt lgkmcnt(2)
 v_smfmac_f32_16x16x64_bf16 v[8:11], v[48:51], v[56:63], v0
 v_cvt_pk_bf16_f32 v33, v34, v35
 s_waitcnt lgkmcnt(0)
 v_smfmac_f32_16x16x64_bf16 v[8:11], v[52:55], v[24:31], v0
 v_and_or_b32 v32, v32, -2, s55
 v_smfmac_f32_16x16x64_bf16 v[8:11], v[44:47], a[152:159], v0
 v_cvt_pk_bf16_f32 v34, v36, v37
 v_cvt_pk_bf16_f32 v35, v38, v39
 v_and_or_b32 v34, v34, -2, s55
 buffer_store_dwordx4 v[32:35], v1, s[4:7], s60 offen offset:1024 sc1
 s_add_u32 s3, s60, 6144
 s_nop 2
 v_cvt_pk_bf16_f32 v8, v8, v9
 v_cvt_pk_bf16_f32 v9, v10, v11
 v_and_or_b32 v8, v8, -2, s55
 buffer_store_dwordx2 v[8:9], v1, s[4:7], s3 offen offset:8 sc1
 buffer_load_dwordx4 v[32:35], v1, s[4:7], s63 offen offset:0
 buffer_load_dwordx4 v[36:39], v1, s[4:7], s63 offen offset:1024
 s_add_u32 s54, s54, 1
 s_add_u32 s61, s61, 524288
 s_and_b32 s3, s54, 7
 s_cselect_b32 s3, 1, -7
 s_lshl_b32 s3, s3, 17
 s_add_u32 s62, s62, s3
 s_and_b32 s3, s54, 3
 s_cselect_b32 s3, 1, -3
 s_lshl_b32 s3, s3, 14
 s_add_u32 s58, s57, s3
 s_add_u32 s59, s59, s3
 v_lshrrev_b32 v56, 7, v1
 v_mul_u32_u24 v56, 10240, v56
 v_and_b32 v60, 112, v1
 v_add_u32 v56, v56, v60
 v_and_b32 v57, 32, v1
 v_and_b32 v60, 64, v1
 v_lshl_add_u32 v57, v60, 2, v57
 v_bfe_u32 v60, v1, 8, 1
 v_lshl_add_u32 v57, v60, 4, v57
 v_and_b32 v60, 8, v5
 v_add_u32 v57, v57, v60
 v_mov_b32 v60, 0x3f80
 v_mov_b32 v28, 0x3f800000
 v_cndmask_b32 v60, v60, v28, s[82:83]
 v_cndmask_b32 v28, 0, v60, s[72:73]
 v_cndmask_b32 v29, 0, v60, s[74:75]
 v_cndmask_b32 v30, 0, v60, s[76:77]
 v_cndmask_b32 v31, 0, v60, s[78:79]
 v_mov_b64 v[58:59], -1
 s_nop 15
 s_nop 15
 s_nop 15
 s_nop 1
 s_mov_b32 s51, 0
L_pp_185:
 buffer_load_dwordx4 v[8:11], v56, s[4:7], s64 offen sc1
 buffer_load_dwordx4 v[12:15], v56, s[4:7], s65 offen sc1
 buffer_load_dwordx4 v[16:19], v56, s[4:7], s66 offen sc1
 buffer_load_dwordx4 v[20:23], v56, s[4:7], s67 offen sc1
 s_waitcnt vmcnt(3)
 v_mfma_f32_16x16x32_bf16 v[24:27], v[28:31], v[8:11], 0
 v_bitop3_b32 v60, v8, v10, s55 bitop3:0x7e
 s_waitcnt vmcnt(2)
 v_mfma_f32_16x16x32_bf16 v[24:27], v[28:31], v[12:15], v[24:27]
 v_bitop3_b32 v61, v12, v14, s55 bitop3:0x7e
 s_waitcnt vmcnt(1)
 v_mfma_f32_16x16x32_bf16 v[24:27], v[28:31], v[16:19], v[24:27]
 v_bitop3_b32 v62, v16, v18, s55 bitop3:0x7e
 s_waitcnt vmcnt(0)
 v_mfma_f32_16x16x32_bf16 v[24:27], v[28:31], v[20:23], v[24:27]
 v_bitop3_b32 v63, v20, v22, s55 bitop3:0x7e
 v_or3_b32 v7, v60, v61, v62
 v_bitop3_b32 v7, v7, v63, 1 bitop3:0xa8
 v_cmp_ne_u32 vcc, 0, v7
 s_cbranch_vccnz L_rt_186
 s_nop 2
 v_add_f32_dpp v24, v24, v24 row_ror:8 row_mask:0xf bank_mask:0xf
 v_add_f32_dpp v25, v25, v25 row_ror:8 row_mask:0xf bank_mask:0xf
 v_add_f32_dpp v26, v26, v26 row_ror:8 row_mask:0xf bank_mask:0xf
 v_add_f32_dpp v27, v27, v27 row_ror:8 row_mask:0xf bank_mask:0xf
 s_mov_b64 exec, s[84:85]
 v_cvt_pk_bf16_f32 v24, v24, v25
 v_cvt_pk_bf16_f32 v25, v26, v27
 buffer_store_dwordx2 v[24:25], v57, s[4:7], s58 offen sc1
 buffer_store_dwordx2 v[58:59], v57, s[4:7], s57 offen sc1
 s_mov_b64 exec, -1
 s_mov_b32 s57, s58
 s_xor_b32 s55, s55, 1
 buffer_load_dwordx4 v[40:43], v1, s[4:7], s63 offen offset:2048
 buffer_load_dwordx4 v[44:47], v1, s[4:7], s63 offen offset:3072
 s_add_u32 s3, s63, 4096
 buffer_load_dwordx4 v[48:51], v1, s[4:7], s3 offen offset:0
 buffer_load_dwordx4 v[52:55], v1, s[4:7], s3 offen offset:1024
 s_add_u32 s3, s63, 4096
 buffer_load_dwordx4 v[56:59], v1, s[4:7], s3 offen offset:2048
 buffer_load_dwordx4 v[60:63], v1, s[4:7], s3 offen offset:3072
 ds_read_b128 v[8:11], v3 offset:49152
 ds_read_b128 v[12:15], v3 offset:49152
 ds_read_b128 v[16:19], v3 offset:49152
 ds_read_b128 v[20:23], v3 offset:49152
 s_waitcnt lgkmcnt(0)
 s_nop 15
 s_nop 15
 s_nop 7
 s_branch L_ch1_s
L_rt_184:
 s_waitcnt lgkmcnt(0)
 s_add_u32 s51, s51, 1
 s_cmp_lt_u32 s51, 131072
 s_cbranch_scc1 L_pm_183
 s_branch L_bail
L_rt_186:
 s_add_u32 s51, s51, 1
 s_cmp_lt_u32 s51, 131072
 s_cbranch_scc1 L_pp_185
 s_branch L_bail
L_ch1_end:
 s_waitcnt vmcnt(0)
 s_endpgm
L_ch2:
 v_lshrrev_b32 v8, 4, v0
 s_mov_b32 s3, 1280
 v_mul_lo_u32 v8, v8, s3
 v_lshrrev_b32 v7, 3, v0
 v_and_b32 v7, 6, v7
 v_xor_b32 v7, v7, v0
 v_and_b32 v7, 15, v7
 v_lshl_add_u32 v8, v7, 4, v8
 v_xor_b32 v9, 128, v8
 v_lshrrev_b32 v10, 4, v0
 s_mov_b32 s3, 8192
 v_mul_lo_u32 v10, v10, s3
 v_lshrrev_b32 v7, 3, v0
 v_and_b32 v7, 6, v7
 v_xor_b32 v7, v7, v0
 v_and_b32 v7, 15, v7
 v_lshl_add_u32 v10, v7, 4, v10
 v_xor_b32 v11, 128, v10
 s_mov_b32 s8, s26
 s_and_b32 s9, s27, 0xffff
 s_mov_b32 s10, 5242880
 s_mul_i32 s14, s52, 163840
 s_add_u32 s14, s14, 81920
 s_mov_b32 m0, 16384
 s_nop 0
 buffer_load_dwordx4 v8, s[8:11], s14 offen lds
 s_add_u32 s14, s14, 5120
 s_mov_b32 m0, 17408
 s_nop 0
 buffer_load_dwordx4 v8, s[8:11], s14 offen lds
 s_add_u32 s14, s14, 5120
 s_mov_b32 m0, 18432
 s_nop 0
 buffer_load_dwordx4 v8, s[8:11], s14 offen lds
 s_add_u32 s14, s14, 5120
 s_mov_b32 m0, 19456
 s_nop 0
 buffer_load_dwordx4 v8, s[8:11], s14 offen lds
 s_add_u32 s14, s14, 5120
 s_mov_b32 m0, 20480
 s_nop 0
 buffer_load_dwordx4 v9, s[8:11], s14 offen lds
 s_add_u32 s14, s14, 5120
 s_mov_b32 m0, 21504
 s_nop 0
 buffer_load_dwordx4 v9, s[8:11], s14 offen lds
 s_add_u32 s14, s14, 5120
 s_mov_b32 m0, 22528
 s_nop 0
 buffer_load_dwordx4 v9, s[8:11], s14 offen lds
 s_add_u32 s14, s14, 5120
 s_mov_b32 m0, 23552
 s_nop 0
 buffer_load_dwordx4 v9, s[8:11], s14 offen lds
 s_mul_i32 s14, s52, 163840
 s_add_u32 s14, s14, 82176
 s_mov_b32 m0, 49152
 s_nop 0
 buffer_load_dwordx4 v8, s[8:11], s14 offen lds
 s_add_u32 s14, s14, 5120
 s_mov_b32 m0, 50176
 s_nop 0
 buffer_load_dwordx4 v8, s[8:11], s14 offen lds
 s_add_u32 s14, s14, 5120
 s_mov_b32 m0, 51200
 s_nop 0
 buffer_load_dwordx4 v8, s[8:11], s14 offen lds
 s_add_u32 s14, s14, 5120
 s_mov_b32 m0, 52224
 s_nop 0
 buffer_load_dwordx4 v8, s[8:11], s14 offen lds
 s_add_u32 s14, s14, 5120
 s_mov_b32 m0, 53248
 s_nop 0
 buffer_load_dwordx4 v9, s[8:11], s14 offen lds
 s_add_u32 s14, s14, 5120
 s_mov_b32 m0, 54272
 s_nop 0
 buffer_load_dwordx4 v9, s[8:11], s14 offen lds
 s_add_u32 s14, s14, 5120
 s_mov_b32 m0, 55296
 s_nop 0
 buffer_load_dwordx4 v9, s[8:11], s14 offen lds
 s_add_u32 s14, s14, 5120
 s_mov_b32 m0, 56320
 s_nop 0
 buffer_load_dwordx4 v9, s[8:11], s14 offen lds
 s_mul_i32 s14, s52, 163840
 s_add_u32 s14, s14, 82432
 s_mov_b32 m0, 81920
 s_nop 0
 buffer_load_dwordx4 v8, s[8:11], s14 offen lds
 s_add_u32 s14, s14, 5120
 s_mov_b32 m0, 82944
 s_nop 0
 buffer_load_dwordx4 v8, s[8:11], s14 offen lds
 s_add_u32 s14, s14, 5120
 s_mov_b32 m0, 83968
 s_nop 0
 buffer_load_dwordx4 v8, s[8:11], s14 offen lds
 s_add_u32 s14, s14, 5120
 s_mov_b32 m0, 84992
 s_nop 0
 buffer_load_dwordx4 v8, s[8:11], s14 offen lds
 s_add_u32 s14, s14, 5120
 s_mov_b32 m0, 86016
 s_nop 0
 buffer_load_dwordx4 v9, s[8:11], s14 offen lds
 s_add_u32 s14, s14, 5120
 s_mov_b32 m0, 87040
 s_nop 0
 buffer_load_dwordx4 v9, s[8:11], s14 offen lds
 s_add_u32 s14, s14, 5120
 s_mov_b32 m0, 88064
 s_nop 0
 buffer_load_dwordx4 v9, s[8:11], s14 offen lds
 s_add_u32 s14, s14, 5120
 s_mov_b32 m0, 89088
 s_nop 0
 buffer_load_dwordx4 v9, s[8:11], s14 offen lds
 s_mul_i32 s14, s52, 163840
 s_add_u32 s14, s14, 82688
 s_mov_b32 m0, 114688
 s_nop 0
 buffer_load_dwordx4 v8, s[8:11], s14 offen lds
 s_add_u32 s14, s14, 5120
 s_mov_b32 m0, 115712
 s_nop 0
 buffer_load_dwordx4 v8, s[8:11], s14 offen lds
 s_add_u32 s14, s14, 5120
 s_mov_b32 m0, 116736
 s_nop 0
 buffer_load_dwordx4 v8, s[8:11], s14 offen lds
 s_add_u32 s14, s14, 5120
 s_mov_b32 m0, 117760
 s_nop 0
 buffer_load_dwordx4 v8, s[8:11], s14 offen lds
 s_add_u32 s14, s14, 5120
 s_mov_b32 m0, 118784
 s_nop 0
 buffer_load_dwordx4 v9, s[8:11], s14 offen lds
 s_add_u32 s14, s14, 5120
 s_mov_b32 m0, 119808
 s_nop 0
 buffer_load_dwordx4 v9, s[8:11], s14 offen lds
 s_add_u32 s14, s14, 5120
 s_mov_b32 m0, 120832
 s_nop 0
 buffer_load_dwordx4 v9, s[8:11], s14 offen lds
 s_add_u32 s14, s14, 5120
 s_mov_b32 m0, 121856
 s_nop 0
 buffer_load_dwordx4 v9, s[8:11], s14 offen lds
 s_mul_i32 s14, s52, 163840
 s_add_u32 s14, s14, 82944
 s_mov_b32 m0, 147456
 s_nop 0
 buffer_load_dwordx4 v8, s[8:11], s14 offen lds
 s_add_u32 s14, s14, 5120
 s_mov_b32 m0, 148480
 s_nop 0
 buffer_load_dwordx4 v8, s[8:11], s14 offen lds
 s_add_u32 s14, s14, 5120
 s_mov_b32 m0, 149504
 s_nop 0
 buffer_load_dwordx4 v8, s[8:11], s14 offen lds
 s_add_u32 s14, s14, 5120
 s_mov_b32 m0, 150528
 s_nop 0
 buffer_load_dwordx4 v8, s[8:11], s14 offen lds
 s_add_u32 s14, s14, 5120
 s_mov_b32 m0, 151552
 s_nop 0
 buffer_load_dwordx4 v9, s[8:11], s14 offen lds
 s_add_u32 s14, s14, 5120
 s_mov_b32 m0, 152576
 s_nop 0
 buffer_load_dwordx4 v9, s[8:11], s14 offen lds
 s_add_u32 s14, s14, 5120
 s_mov_b32 m0, 153600
 s_nop 0
 buffer_load_dwordx4 v9, s[8:11], s14 offen lds
 s_add_u32 s14, s14, 5120
 s_mov_b32 m0, 154624
 s_nop 0
 buffer_load_dwordx4 v9, s[8:11], s14 offen lds
 v_lshrrev_b32 v20, 4, v0
 v_bfe_u32 v21, v0, 2, 1
 v_bfe_u32 v22, v0, 3, 1
 v_and_b32 v23, 1, v20
 v_lshrrev_b32 v24, 1, v20
 v_and_b32 v25, 3, v0
 v_lshlrev_b32 v25, 3, v25
 v_lshl_add_u32 v26, v22, 1, v23
 v_lshl_add_u32 v27, v21, 2, v26
 v_lshl_add_u32 v26, v24, 2, v26
 v_lshl_add_u32 v26, v21, 4, v26
 v_xor_b32 v27, 4, v27
 v_lshl_add_u32 v27, v27, 5, v25
 v_lshl_add_u32 v12, v26, 8, v27
 v_lshl_add_u32 v26, v24, 2, v21
 v_lshl_add_u32 v26, v23, 4, v26
 v_lshl_add_u32 v27, v23, 2, v21
 v_lshl_add_u32 v27, v22, 1, v27
 v_lshl_add_u32 v27, v27, 5, v25
 v_lshl_add_u32 v14, v26, 8, v27
 v_lshlrev_b32 v1, 4, v0
 v_add_u32 v2, 65536, v1
 v_add_u32 v3, 114688, v1
 s_waitcnt vmcnt(32)
 s_barrier
 s_waitcnt lgkmcnt(0)
 s_barrier
 s_mov_b32 s8, s24
 s_and_b32 s9, s25, 0xffff
 s_mov_b32 s10, 5242880
 s_lshl_b32 s14, s52, 8
 s_add_u32 s14, s14, 524288
 s_mov_b32 m0, 16384
 s_nop 0
 buffer_load_dwordx4 v10, s[8:11], s14 offen lds
 s_add_u32 s14, s14, 32768
 s_mov_b32 m0, 17408
 s_nop 0
 buffer_load_dwordx4 v10, s[8:11], s14 offen lds
 s_add_u32 s14, s14, 32768
 s_mov_b32 m0, 18432
 s_nop 0
 buffer_load_dwordx4 v10, s[8:11], s14 offen lds
 s_add_u32 s14, s14, 32768
 s_mov_b32 m0, 19456
 s_nop 0
 buffer_load_dwordx4 v10, s[8:11], s14 offen lds
 s_add_u32 s14, s14, 32768
 s_mov_b32 m0, 20480
 s_nop 0
 buffer_load_dwordx4 v11, s[8:11], s14 offen lds
 s_add_u32 s14, s14, 32768
 s_mov_b32 m0, 21504
 s_nop 0
 buffer_load_dwordx4 v11, s[8:11], s14 offen lds
 s_add_u32 s14, s14, 32768
 s_mov_b32 m0, 22528
 s_nop 0
 buffer_load_dwordx4 v11, s[8:11], s14 offen lds
 s_add_u32 s14, s14, 32768
 s_mov_b32 m0, 23552
 s_nop 0
 buffer_load_dwordx4 v11, s[8:11], s14 offen lds
 s_waitcnt vmcnt(32)
 s_barrier
 s_waitcnt lgkmcnt(0)
 s_barrier
 s_lshl_b32 s14, s52, 8
 s_add_u32 s14, s14, 1572864
 s_mov_b32 m0, 49152
 s_nop 0
 buffer_load_dwordx4 v10, s[8:11], s14 offen lds
 s_add_u32 s14, s14, 32768
 s_mov_b32 m0, 50176
 s_nop 0
 buffer_load_dwordx4 v10, s[8:11], s14 offen lds
 s_add_u32 s14, s14, 32768
 s_mov_b32 m0, 51200
 s_nop 0
 buffer_load_dwordx4 v10, s[8:11], s14 offen lds
 s_add_u32 s14, s14, 32768
 s_mov_b32 m0, 52224
 s_nop 0
 buffer_load_dwordx4 v10, s[8:11], s14 offen lds
 s_add_u32 s14, s14, 32768
 s_mov_b32 m0, 53248
 s_nop 0
 buffer_load_dwordx4 v11, s[8:11], s14 offen lds
 s_add_u32 s14, s14, 32768
 s_mov_b32 m0, 54272
 s_nop 0
 buffer_load_dwordx4 v11, s[8:11], s14 offen lds
 s_add_u32 s14, s14, 32768
 s_mov_b32 m0, 55296
 s_nop 0
 buffer_load_dwordx4 v11, s[8:11], s14 offen lds
 s_add_u32 s14, s14, 32768
 s_mov_b32 m0, 56320
 s_nop 0
 buffer_load_dwordx4 v11, s[8:11], s14 offen lds
 s_waitcnt vmcnt(32)
 s_barrier
 v_xor_b32 v16, 0, v14
 v_add_u32 v16, 65536, v16
 v_xor_b32 v17, 64, v16
 ds_read_b64_tr_b16 a[0:1], v16 offset:0
 ds_read_b64_tr_b16 a[2:3], v17 offset:512
 ds_read_b64_tr_b16 a[4:5], v16 offset:2048
 ds_read_b64_tr_b16 a[6:7], v17 offset:2560
 v_xor_b32 v16, 0, v14
 v_add_u32 v16, 65536, v16
 v_xor_b32 v17, 64, v16
 ds_read_b64_tr_b16 a[8:9], v16 offset:8192
 ds_read_b64_tr_b16 a[10:11], v17 offset:8704
 ds_read_b64_tr_b16 a[12:13], v16 offset:10240
 ds_read_b64_tr_b16 a[14:15], v17 offset:10752
 v_xor_b32 v16, 0, v14
 v_add_u32 v16, 65536, v16
 v_xor_b32 v17, 64, v16
 ds_read_b64_tr_b16 a[16:17], v16 offset:16384
 ds_read_b64_tr_b16 a[18:19], v17 offset:16896
 ds_read_b64_tr_b16 a[20:21], v16 offset:18432
 ds_read_b64_tr_b16 a[22:23], v17 offset:18944
 v_xor_b32 v16, 0, v14
 v_add_u32 v16, 65536, v16
 v_xor_b32 v17, 64, v16
 ds_read_b64_tr_b16 a[24:25], v16 offset:24576
 ds_read_b64_tr_b16 a[26:27], v17 offset:25088
 ds_read_b64_tr_b16 a[28:29], v16 offset:26624
 ds_read_b64_tr_b16 a[30:31], v17 offset:27136
 v_xor_b32 v16, 32, v14
 v_add_u32 v16, 65536, v16
 v_xor_b32 v17, 64, v16
 ds_read_b64_tr_b16 a[32:33], v16 offset:0
 ds_read_b64_tr_b16 a[34:35], v17 offset:512
 ds_read_b64_tr_b16 a[36:37], v16 offset:2048
 ds_read_b64_tr_b16 a[38:39], v17 offset:2560
 v_xor_b32 v16, 32, v14
 v_add_u32 v16, 65536, v16
 v_xor_b32 v17, 64, v16
 ds_read_b64_tr_b16 a[40:41], v16 offset:8192
 ds_read_b64_tr_b16 a[42:43], v17 offset:8704
 ds_read_b64_tr_b16 a[44:45], v16 offset:10240
 ds_read_b64_tr_b16 a[46:47], v17 offset:10752
 v_xor_b32 v16, 32, v14
 v_add_u32 v16, 65536, v16
 v_xor_b32 v17, 64, v16
 ds_read_b64_tr_b16 a[48:49], v16 offset:16384
 ds_read_b64_tr_b16 a[50:51], v17 offset:16896
 ds_read_b64_tr_b16 a[52:53], v16 offset:18432
 ds_read_b64_tr_b16 a[54:55], v17 offset:18944
 v_xor_b32 v16, 32, v14
 v_add_u32 v16, 65536, v16
 v_xor_b32 v17, 64, v16
 ds_read_b64_tr_b16 a[56:57], v16 offset:24576
 ds_read_b64_tr_b16 a[58:59], v17 offset:25088
 ds_read_b64_tr_b16 a[60:61], v16 offset:26624
 ds_read_b64_tr_b16 a[62:63], v17 offset:27136
 v_xor_b32 v16, 128, v14
 v_add_u32 v16, 65536, v16
 v_xor_b32 v17, 64, v16
 ds_read_b64_tr_b16 a[64:65], v16 offset:0
 ds_read_b64_tr_b16 a[66:67], v17 offset:512
 ds_read_b64_tr_b16 a[68:69], v16 offset:2048
 ds_read_b64_tr_b16 a[70:71], v17 offset:2560
 v_xor_b32 v16, 128, v14
 v_add_u32 v16, 65536, v16
 v_xor_b32 v17, 64, v16
 ds_read_b64_tr_b16 a[72:73], v16 offset:8192
 ds_read_b64_tr_b16 a[74:75], v17 offset:8704
 ds_read_b64_tr_b16 a[76:77], v16 offset:10240
 ds_read_b64_tr_b16 a[78:79], v17 offset:10752
 v_xor_b32 v16, 128, v14
 v_add_u32 v16, 65536, v16
 v_xor_b32 v17, 64, v16
 ds_read_b64_tr_b16 a[80:81], v16 offset:16384
 ds_read_b64_tr_b16 a[82:83], v17 offset:16896
 ds_read_b64_tr_b16 a[84:85], v16 offset:18432
 ds_read_b64_tr_b16 a[86:87], v17 offset:18944
 v_xor_b32 v16, 128, v14
 v_add_u32 v16, 65536, v16
 v_xor_b32 v17, 64, v16
 ds_read_b64_tr_b16 a[88:89], v16 offset:24576
 ds_read_b64_tr_b16 a[90:91], v17 offset:25088
 ds_read_b64_tr_b16 a[92:93], v16 offset:26624
 ds_read_b64_tr_b16 a[94:95], v17 offset:27136
 v_xor_b32 v16, 160, v14
 v_add_u32 v16, 65536, v16
 v_xor_b32 v17, 64, v16
 ds_read_b64_tr_b16 a[96:97], v16 offset:0
 ds_read_b64_tr_b16 a[98:99], v17 offset:512
 ds_read_b64_tr_b16 a[100:101], v16 offset:2048
 ds_read_b64_tr_b16 a[102:103], v17 offset:2560
 v_xor_b32 v16, 160, v14
 v_add_u32 v16, 65536, v16
 v_xor_b32 v17, 64, v16
 ds_read_b64_tr_b16 a[104:105], v16 offset:8192
 ds_read_b64_tr_b16 a[106:107], v17 offset:8704
 ds_read_b64_tr_b16 a[108:109], v16 offset:10240
 ds_read_b64_tr_b16 a[110:111], v17 offset:10752
 v_xor_b32 v16, 160, v14
 v_add_u32 v16, 65536, v16
 v_xor_b32 v17, 64, v16
 ds_read_b64_tr_b16 a[112:113], v16 offset:16384
 ds_read_b64_tr_b16 a[114:115], v17 offset:16896
 ds_read_b64_tr_b16 a[116:117], v16 offset:18432
 ds_read_b64_tr_b16 a[118:119], v17 offset:18944
 v_xor_b32 v16, 160, v14
 v_add_u32 v16, 65536, v16
 v_xor_b32 v17, 64, v16
 ds_read_b64_tr_b16 a[120:121], v16 offset:24576
 ds_read_b64_tr_b16 a[122:123], v17 offset:25088
 ds_read_b64_tr_b16 a[124:125], v16 offset:26624
 ds_read_b64_tr_b16 a[126:127], v17 offset:27136
 s_waitcnt lgkmcnt(0)
 s_barrier
 s_lshl_b32 s14, s52, 8
 s_add_u32 s14, s14, 2621440
 s_mov_b32 m0, 81920
 s_nop 0
 buffer_load_dwordx4 v10, s[8:11], s14 offen lds
 s_add_u32 s14, s14, 32768
 s_mov_b32 m0, 82944
 s_nop 0
 buffer_load_dwordx4 v10, s[8:11], s14 offen lds
 s_add_u32 s14, s14, 32768
 s_mov_b32 m0, 83968
 s_nop 0
 buffer_load_dwordx4 v10, s[8:11], s14 offen lds
 s_add_u32 s14, s14, 32768
 s_mov_b32 m0, 84992
 s_nop 0
 buffer_load_dwordx4 v10, s[8:11], s14 offen lds
 s_add_u32 s14, s14, 32768
 s_mov_b32 m0, 86016
 s_nop 0
 buffer_load_dwordx4 v11, s[8:11], s14 offen lds
 s_add_u32 s14, s14, 32768
 s_mov_b32 m0, 87040
 s_nop 0
 buffer_load_dwordx4 v11, s[8:11], s14 offen lds
 s_add_u32 s14, s14, 32768
 s_mov_b32 m0, 88064
 s_nop 0
 buffer_load_dwordx4 v11, s[8:11], s14 offen lds
 s_add_u32 s14, s14, 32768
 s_mov_b32 m0, 89088
 s_nop 0
 buffer_load_dwordx4 v11, s[8:11], s14 offen lds
 s_waitcnt vmcnt(32)
 s_barrier
 s_waitcnt lgkmcnt(0)
 s_barrier
 s_lshl_b32 s14, s52, 8
 s_add_u32 s14, s14, 3670016
 s_mov_b32 m0, 114688
 s_nop 0
 buffer_load_dwordx4 v10, s[8:11], s14 offen lds
 s_add_u32 s14, s14, 32768
 s_mov_b32 m0, 115712
 s_nop 0
 buffer_load_dwordx4 v10, s[8:11], s14 offen lds
 s_add_u32 s14, s14, 32768
 s_mov_b32 m0, 116736
 s_nop 0
 buffer_load_dwordx4 v10, s[8:11], s14 offen lds
 s_add_u32 s14, s14, 32768
 s_mov_b32 m0, 117760
 s_nop 0
 buffer_load_dwordx4 v10, s[8:11], s14 offen lds
 s_add_u32 s14, s14, 32768
 s_mov_b32 m0, 118784
 s_nop 0
 buffer_load_dwordx4 v11, s[8:11], s14 offen lds
 s_add_u32 s14, s14, 32768
 s_mov_b32 m0, 119808
 s_nop 0
 buffer_load_dwordx4 v11, s[8:11], s14 offen lds
 s_add_u32 s14, s14, 32768
 s_mov_b32 m0, 120832
 s_nop 0
 buffer_load_dwordx4 v11, s[8:11], s14 offen lds
 s_add_u32 s14, s14, 32768
 s_mov_b32 m0, 121856
 s_nop 0
 buffer_load_dwordx4 v11, s[8:11], s14 offen lds
 s_waitcnt vmcnt(32)
 s_barrier
 v_xor_b32 v16, 128, v14
 v_add_u32 v16, 131072, v16
 v_xor_b32 v17, 64, v16
 ds_read_b64_tr_b16 a[128:129], v16 offset:0
 ds_read_b64_tr_b16 a[130:131], v17 offset:512
 ds_read_b64_tr_b16 a[132:133], v16 offset:2048
 ds_read_b64_tr_b16 a[134:135], v17 offset:2560
 v_xor_b32 v16, 128, v14
 v_add_u32 v16, 131072, v16
 v_xor_b32 v17, 64, v16
 ds_read_b64_tr_b16 a[136:137], v16 offset:8192
 ds_read_b64_tr_b16 a[138:139], v17 offset:8704
 ds_read_b64_tr_b16 a[140:141], v16 offset:10240
 ds_read_b64_tr_b16 a[142:143], v17 offset:10752
 v_xor_b32 v16, 128, v14
 v_add_u32 v16, 131072, v16
 v_xor_b32 v17, 64, v16
 ds_read_b64_tr_b16 a[144:145], v16 offset:16384
 ds_read_b64_tr_b16 a[146:147], v17 offset:16896
 ds_read_b64_tr_b16 a[148:149], v16 offset:18432
 ds_read_b64_tr_b16 a[150:151], v17 offset:18944
 v_xor_b32 v16, 128, v14
 v_add_u32 v16, 131072, v16
 v_xor_b32 v17, 64, v16
 ds_read_b64_tr_b16 a[152:153], v16 offset:24576
 ds_read_b64_tr_b16 a[154:155], v17 offset:25088
 ds_read_b64_tr_b16 a[156:157], v16 offset:26624
 ds_read_b64_tr_b16 a[158:159], v17 offset:27136
 s_waitcnt lgkmcnt(0)
 s_barrier
 s_lshl_b32 s14, s52, 8
 s_add_u32 s14, s14, 4718592
 s_mov_b32 m0, 147456
 s_nop 0
 buffer_load_dwordx4 v10, s[8:11], s14 offen lds
 s_add_u32 s14, s14, 32768
 s_mov_b32 m0, 148480
 s_nop 0
 buffer_load_dwordx4 v10, s[8:11], s14 offen lds
 s_add_u32 s14, s14, 32768
 s_mov_b32 m0, 149504
 s_nop 0
 buffer_load_dwordx4 v10, s[8:11], s14 offen lds
 s_add_u32 s14, s14, 32768
 s_mov_b32 m0, 150528
 s_nop 0
 buffer_load_dwordx4 v10, s[8:11], s14 offen lds
 s_add_u32 s14, s14, 32768
 s_mov_b32 m0, 151552
 s_nop 0
 buffer_load_dwordx4 v11, s[8:11], s14 offen lds
 s_add_u32 s14, s14, 32768
 s_mov_b32 m0, 152576
 s_nop 0
 buffer_load_dwordx4 v11, s[8:11], s14 offen lds
 s_add_u32 s14, s14, 32768
 s_mov_b32 m0, 153600
 s_nop 0
 buffer_load_dwordx4 v11, s[8:11], s14 offen lds
 s_add_u32 s14, s14, 32768
 s_mov_b32 m0, 154624
 s_nop 0
 buffer_load_dwordx4 v11, s[8:11], s14 offen lds
 s_waitcnt vmcnt(32)
 s_barrier
 v_xor_b32 v16, 0, v12
 v_add_u32 v16, 0, v16
 ds_read_b64_tr_b16 a[160:161], v16 offset:0
 ds_read_b64_tr_b16 a[162:163], v16 offset:8192
 ds_read_b64_tr_b16 a[164:165], v16 offset:2048
 ds_read_b64_tr_b16 a[166:167], v16 offset:10240
 v_xor_b32 v16, 32, v12
 v_add_u32 v16, 0, v16
 ds_read_b64_tr_b16 a[168:169], v16 offset:0
 ds_read_b64_tr_b16 a[170:171], v16 offset:8192
 ds_read_b64_tr_b16 a[172:173], v16 offset:2048
 ds_read_b64_tr_b16 a[174:175], v16 offset:10240
 v_xor_b32 v16, 0, v12
 v_add_u32 v16, 0, v16
 ds_read_b64_tr_b16 a[176:177], v16 offset:16384
 ds_read_b64_tr_b16 a[178:179], v16 offset:24576
 ds_read_b64_tr_b16 a[180:181], v16 offset:18432
 ds_read_b64_tr_b16 a[182:183], v16 offset:26624
 v_xor_b32 v16, 32, v12
 v_add_u32 v16, 0, v16
 ds_read_b64_tr_b16 a[184:185], v16 offset:16384
 ds_read_b64_tr_b16 a[186:187], v16 offset:24576
 ds_read_b64_tr_b16 a[188:189], v16 offset:18432
 ds_read_b64_tr_b16 a[190:191], v16 offset:26624
 s_waitcnt lgkmcnt(0)
 s_barrier
 s_mov_b32 s8, s22
 s_and_b32 s9, s23, 0xffff
 s_mov_b32 s10, 5242880
 s_lshl_b32 s14, s52, 8
 s_add_u32 s14, s14, 524288
 s_mov_b32 m0, 16384
 s_nop 0
 buffer_load_dwordx4 v10, s[8:11], s14 offen lds
 s_add_u32 s14, s14, 32768
 s_mov_b32 m0, 17408
 s_nop 0
 buffer_load_dwordx4 v10, s[8:11], s14 offen lds
 s_add_u32 s14, s14, 32768
 s_mov_b32 m0, 18432
 s_nop 0
 buffer_load_dwordx4 v10, s[8:11], s14 offen lds
 s_add_u32 s14, s14, 32768
 s_mov_b32 m0, 19456
 s_nop 0
 buffer_load_dwordx4 v10, s[8:11], s14 offen lds
 s_add_u32 s14, s14, 32768
 s_mov_b32 m0, 20480
 s_nop 0
 buffer_load_dwordx4 v11, s[8:11], s14 offen lds
 s_add_u32 s14, s14, 32768
 s_mov_b32 m0, 21504
 s_nop 0
 buffer_load_dwordx4 v11, s[8:11], s14 offen lds
 s_add_u32 s14, s14, 32768
 s_mov_b32 m0, 22528
 s_nop 0
 buffer_load_dwordx4 v11, s[8:11], s14 offen lds
 s_add_u32 s14, s14, 32768
 s_mov_b32 m0, 23552
 s_nop 0
 buffer_load_dwordx4 v11, s[8:11], s14 offen lds
 s_waitcnt vmcnt(32)
 s_barrier
 v_xor_b32 v16, 0, v12
 v_add_u32 v16, 32768, v16
 ds_read_b64_tr_b16 a[192:193], v16 offset:0
 ds_read_b64_tr_b16 a[194:195], v16 offset:8192
 ds_read_b64_tr_b16 a[196:197], v16 offset:2048
 ds_read_b64_tr_b16 a[198:199], v16 offset:10240
 v_xor_b32 v16, 32, v12
 v_add_u32 v16, 32768, v16
 ds_read_b64_tr_b16 a[200:201], v16 offset:0
 ds_read_b64_tr_b16 a[202:203], v16 offset:8192
 ds_read_b64_tr_b16 a[204:205], v16 offset:2048
 ds_read_b64_tr_b16 a[206:207], v16 offset:10240
 v_xor_b32 v16, 0, v12
 v_add_u32 v16, 32768, v16
 ds_read_b64_tr_b16 a[208:209], v16 offset:16384
 ds_read_b64_tr_b16 a[210:211], v16 offset:24576
 ds_read_b64_tr_b16 a[212:213], v16 offset:18432
 ds_read_b64_tr_b16 a[214:215], v16 offset:26624
 v_xor_b32 v16, 32, v12
 v_add_u32 v16, 32768, v16
 ds_read_b64_tr_b16 a[216:217], v16 offset:16384
 ds_read_b64_tr_b16 a[218:219], v16 offset:24576
 ds_read_b64_tr_b16 a[220:221], v16 offset:18432
 ds_read_b64_tr_b16 a[222:223], v16 offset:26624
 s_waitcnt lgkmcnt(0)
 s_barrier
 s_lshl_b32 s14, s52, 8
 s_add_u32 s14, s14, 1572864
 s_mov_b32 m0, 49152
 s_nop 0
 buffer_load_dwordx4 v10, s[8:11], s14 offen lds
 s_add_u32 s14, s14, 32768
 s_mov_b32 m0, 50176
 s_nop 0
 buffer_load_dwordx4 v10, s[8:11], s14 offen lds
 s_add_u32 s14, s14, 32768
 s_mov_b32 m0, 51200
 s_nop 0
 buffer_load_dwordx4 v10, s[8:11], s14 offen lds
 s_add_u32 s14, s14, 32768
 s_mov_b32 m0, 52224
 s_nop 0
 buffer_load_dwordx4 v10, s[8:11], s14 offen lds
 s_add_u32 s14, s14, 32768
 s_mov_b32 m0, 53248
 s_nop 0
 buffer_load_dwordx4 v11, s[8:11], s14 offen lds
 s_add_u32 s14, s14, 32768
 s_mov_b32 m0, 54272
 s_nop 0
 buffer_load_dwordx4 v11, s[8:11], s14 offen lds
 s_add_u32 s14, s14, 32768
 s_mov_b32 m0, 55296
 s_nop 0
 buffer_load_dwordx4 v11, s[8:11], s14 offen lds
 s_add_u32 s14, s14, 32768
 s_mov_b32 m0, 56320
 s_nop 0
 buffer_load_dwordx4 v11, s[8:11], s14 offen lds
 s_waitcnt vmcnt(32)
 s_barrier
 v_xor_b32 v16, 0, v12
 v_add_u32 v16, 65536, v16
 ds_read_b64_tr_b16 a[224:225], v16 offset:0
 ds_read_b64_tr_b16 a[226:227], v16 offset:8192
 ds_read_b64_tr_b16 a[228:229], v16 offset:2048
 ds_read_b64_tr_b16 a[230:231], v16 offset:10240
 v_xor_b32 v16, 32, v12
 v_add_u32 v16, 65536, v16
 ds_read_b64_tr_b16 a[232:233], v16 offset:0
 ds_read_b64_tr_b16 a[234:235], v16 offset:8192
 ds_read_b64_tr_b16 a[236:237], v16 offset:2048
 ds_read_b64_tr_b16 a[238:239], v16 offset:10240
 v_xor_b32 v16, 0, v12
 v_add_u32 v16, 65536, v16
 ds_read_b64_tr_b16 a[240:241], v16 offset:16384
 ds_read_b64_tr_b16 a[242:243], v16 offset:24576
 ds_read_b64_tr_b16 a[244:245], v16 offset:18432
 ds_read_b64_tr_b16 a[246:247], v16 offset:26624
 v_xor_b32 v16, 32, v12
 v_add_u32 v16, 65536, v16
 ds_read_b64_tr_b16 a[248:249], v16 offset:16384
 ds_read_b64_tr_b16 a[250:251], v16 offset:24576
 ds_read_b64_tr_b16 a[252:253], v16 offset:18432
 ds_read_b64_tr_b16 a[254:255], v16 offset:26624
 s_waitcnt lgkmcnt(0)
 s_barrier
 s_lshl_b32 s14, s52, 8
 s_add_u32 s14, s14, 2621440
 s_mov_b32 m0, 81920
 s_nop 0
 buffer_load_dwordx4 v10, s[8:11], s14 offen lds
 s_add_u32 s14, s14, 32768
 s_mov_b32 m0, 82944
 s_nop 0
 buffer_load_dwordx4 v10, s[8:11], s14 offen lds
 s_add_u32 s14, s14, 32768
 s_mov_b32 m0, 83968
 s_nop 0
 buffer_load_dwordx4 v10, s[8:11], s14 offen lds
 s_add_u32 s14, s14, 32768
 s_mov_b32 m0, 84992
 s_nop 0
 buffer_load_dwordx4 v10, s[8:11], s14 offen lds
 s_add_u32 s14, s14, 32768
 s_mov_b32 m0, 86016
 s_nop 0
 buffer_load_dwordx4 v11, s[8:11], s14 offen lds
 s_add_u32 s14, s14, 32768
 s_mov_b32 m0, 87040
 s_nop 0
 buffer_load_dwordx4 v11, s[8:11], s14 offen lds
 s_add_u32 s14, s14, 32768
 s_mov_b32 m0, 88064
 s_nop 0
 buffer_load_dwordx4 v11, s[8:11], s14 offen lds
 s_add_u32 s14, s14, 32768
 s_mov_b32 m0, 89088
 s_nop 0
 buffer_load_dwordx4 v11, s[8:11], s14 offen lds
 s_waitcnt vmcnt(32)
 s_barrier
 v_xor_b32 v16, 0, v12
 v_add_u32 v16, 98304, v16
 ds_read_b64_tr_b16 v[64:65], v16 offset:0
 ds_read_b64_tr_b16 v[66:67], v16 offset:8192
 ds_read_b64_tr_b16 v[68:69], v16 offset:2048
 ds_read_b64_tr_b16 v[70:71], v16 offset:10240
 v_xor_b32 v16, 32, v12
 v_add_u32 v16, 98304, v16
 ds_read_b64_tr_b16 v[72:73], v16 offset:0
 ds_read_b64_tr_b16 v[74:75], v16 offset:8192
 ds_read_b64_tr_b16 v[76:77], v16 offset:2048
 ds_read_b64_tr_b16 v[78:79], v16 offset:10240
 v_xor_b32 v16, 0, v12
 v_add_u32 v16, 98304, v16
 ds_read_b64_tr_b16 v[80:81], v16 offset:16384
 ds_read_b64_tr_b16 v[82:83], v16 offset:24576
 ds_read_b64_tr_b16 v[84:85], v16 offset:18432
 ds_read_b64_tr_b16 v[86:87], v16 offset:26624
 v_xor_b32 v16, 32, v12
 v_add_u32 v16, 98304, v16
 ds_read_b64_tr_b16 v[88:89], v16 offset:16384
 ds_read_b64_tr_b16 v[90:91], v16 offset:24576
 ds_read_b64_tr_b16 v[92:93], v16 offset:18432
 ds_read_b64_tr_b16 v[94:95], v16 offset:26624
 s_waitcnt lgkmcnt(0)
 s_barrier
 s_lshl_b32 s14, s52, 8
 s_add_u32 s14, s14, 3670016
 s_mov_b32 m0, 114688
 s_nop 0
 buffer_load_dwordx4 v10, s[8:11], s14 offen lds
 s_add_u32 s14, s14, 32768
 s_mov_b32 m0, 115712
 s_nop 0
 buffer_load_dwordx4 v10, s[8:11], s14 offen lds
 s_add_u32 s14, s14, 32768
 s_mov_b32 m0, 116736
 s_nop 0
 buffer_load_dwordx4 v10, s[8:11], s14 offen lds
 s_add_u32 s14, s14, 32768
 s_mov_b32 m0, 117760
 s_nop 0
 buffer_load_dwordx4 v10, s[8:11], s14 offen lds
 s_add_u32 s14, s14, 32768
 s_mov_b32 m0, 118784
 s_nop 0
 buffer_load_dwordx4 v11, s[8:11], s14 offen lds
 s_add_u32 s14, s14, 32768
 s_mov_b32 m0, 119808
 s_nop 0
 buffer_load_dwordx4 v11, s[8:11], s14 offen lds
 s_add_u32 s14, s14, 32768
 s_mov_b32 m0, 120832
 s_nop 0
 buffer_load_dwordx4 v11, s[8:11], s14 offen lds
 s_add_u32 s14, s14, 32768
 s_mov_b32 m0, 121856
 s_nop 0
 buffer_load_dwordx4 v11, s[8:11], s14 offen lds
 s_waitcnt vmcnt(32)
 s_barrier
 v_xor_b32 v16, 0, v12
 v_add_u32 v16, 131072, v16
 ds_read_b64_tr_b16 v[96:97], v16 offset:0
 ds_read_b64_tr_b16 v[98:99], v16 offset:8192
 ds_read_b64_tr_b16 v[100:101], v16 offset:2048
 ds_read_b64_tr_b16 v[102:103], v16 offset:10240
 v_xor_b32 v16, 32, v12
 v_add_u32 v16, 131072, v16
 ds_read_b64_tr_b16 v[104:105], v16 offset:0
 ds_read_b64_tr_b16 v[106:107], v16 offset:8192
 ds_read_b64_tr_b16 v[108:109], v16 offset:2048
 ds_read_b64_tr_b16 v[110:111], v16 offset:10240
 v_xor_b32 v16, 0, v12
 v_add_u32 v16, 131072, v16
 ds_read_b64_tr_b16 v[112:113], v16 offset:16384
 ds_read_b64_tr_b16 v[114:115], v16 offset:24576
 ds_read_b64_tr_b16 v[116:117], v16 offset:18432
 ds_read_b64_tr_b16 v[118:119], v16 offset:26624
 v_xor_b32 v16, 32, v12
 v_add_u32 v16, 131072, v16
 ds_read_b64_tr_b16 v[120:121], v16 offset:16384
 ds_read_b64_tr_b16 v[122:123], v16 offset:24576
 ds_read_b64_tr_b16 v[124:125], v16 offset:18432
 ds_read_b64_tr_b16 v[126:127], v16 offset:26624
 s_waitcnt lgkmcnt(0)
 s_barrier
 s_lshl_b32 s14, s52, 8
 s_add_u32 s14, s14, 4718592
 s_mov_b32 m0, 147456
 s_nop 0
 buffer_load_dwordx4 v10, s[8:11], s14 offen lds
 s_add_u32 s14, s14, 32768
 s_mov_b32 m0, 148480
 s_nop 0
 buffer_load_dwordx4 v10, s[8:11], s14 offen lds
 s_add_u32 s14, s14, 32768
 s_mov_b32 m0, 149504
 s_nop 0
 buffer_load_dwordx4 v10, s[8:11], s14 offen lds
 s_add_u32 s14, s14, 32768
 s_mov_b32 m0, 150528
 s_nop 0
 buffer_load_dwordx4 v10, s[8:11], s14 offen lds
 s_add_u32 s14, s14, 32768
 s_mov_b32 m0, 151552
 s_nop 0
 buffer_load_dwordx4 v11, s[8:11], s14 offen lds
 s_add_u32 s14, s14, 32768
 s_mov_b32 m0, 152576
 s_nop 0
 buffer_load_dwordx4 v11, s[8:11], s14 offen lds
 s_add_u32 s14, s14, 32768
 s_mov_b32 m0, 153600
 s_nop 0
 buffer_load_dwordx4 v11, s[8:11], s14 offen lds
 s_add_u32 s14, s14, 32768
 s_mov_b32 m0, 154624
 s_nop 0
 buffer_load_dwordx4 v11, s[8:11], s14 offen lds
 s_waitcnt vmcnt(32)
 s_barrier
 v_xor_b32 v16, 0, v12
 v_add_u32 v16, 0, v16
 ds_read_b64_tr_b16 v[128:129], v16 offset:0
 ds_read_b64_tr_b16 v[130:131], v16 offset:8192
 ds_read_b64_tr_b16 v[132:133], v16 offset:2048
 ds_read_b64_tr_b16 v[134:135], v16 offset:10240
 v_xor_b32 v16, 32, v12
 v_add_u32 v16, 0, v16
 ds_read_b64_tr_b16 v[136:137], v16 offset:0
 ds_read_b64_tr_b16 v[138:139], v16 offset:8192
 ds_read_b64_tr_b16 v[140:141], v16 offset:2048
 ds_read_b64_tr_b16 v[142:143], v16 offset:10240
 v_xor_b32 v16, 0, v12
 v_add_u32 v16, 0, v16
 ds_read_b64_tr_b16 v[144:145], v16 offset:16384
 ds_read_b64_tr_b16 v[146:147], v16 offset:24576
 ds_read_b64_tr_b16 v[148:149], v16 offset:18432
 ds_read_b64_tr_b16 v[150:151], v16 offset:26624
 v_xor_b32 v16, 32, v12
 v_add_u32 v16, 0, v16
 ds_read_b64_tr_b16 v[152:153], v16 offset:16384
 ds_read_b64_tr_b16 v[154:155], v16 offset:24576
 ds_read_b64_tr_b16 v[156:157], v16 offset:18432
 ds_read_b64_tr_b16 v[158:159], v16 offset:26624
 s_waitcnt lgkmcnt(0)
 s_barrier
 s_mov_b32 s8, s20
 s_and_b32 s9, s21, 0xffff
 s_mov_b32 s10, 5242880
 s_lshl_b32 s14, s52, 8
 s_add_u32 s14, s14, 524288
 s_mov_b32 m0, 16384
 s_nop 0
 buffer_load_dwordx4 v10, s[8:11], s14 offen lds
 s_add_u32 s14, s14, 32768
 s_mov_b32 m0, 17408
 s_nop 0
 buffer_load_dwordx4 v10, s[8:11], s14 offen lds
 s_add_u32 s14, s14, 32768
 s_mov_b32 m0, 18432
 s_nop 0
 buffer_load_dwordx4 v10, s[8:11], s14 offen lds
 s_add_u32 s14, s14, 32768
 s_mov_b32 m0, 19456
 s_nop 0
 buffer_load_dwordx4 v10, s[8:11], s14 offen lds
 s_add_u32 s14, s14, 32768
 s_mov_b32 m0, 20480
 s_nop 0
 buffer_load_dwordx4 v11, s[8:11], s14 offen lds
 s_add_u32 s14, s14, 32768
 s_mov_b32 m0, 21504
 s_nop 0
 buffer_load_dwordx4 v11, s[8:11], s14 offen lds
 s_add_u32 s14, s14, 32768
 s_mov_b32 m0, 22528
 s_nop 0
 buffer_load_dwordx4 v11, s[8:11], s14 offen lds
 s_add_u32 s14, s14, 32768
 s_mov_b32 m0, 23552
 s_nop 0
 buffer_load_dwordx4 v11, s[8:11], s14 offen lds
 s_waitcnt vmcnt(32)
 s_barrier
 v_xor_b32 v16, 0, v12
 v_add_u32 v16, 32768, v16
 ds_read_b64_tr_b16 v[160:161], v16 offset:0
 ds_read_b64_tr_b16 v[162:163], v16 offset:8192
 ds_read_b64_tr_b16 v[164:165], v16 offset:2048
 ds_read_b64_tr_b16 v[166:167], v16 offset:10240
 v_xor_b32 v16, 32, v12
 v_add_u32 v16, 32768, v16
 ds_read_b64_tr_b16 v[168:169], v16 offset:0
 ds_read_b64_tr_b16 v[170:171], v16 offset:8192
 ds_read_b64_tr_b16 v[172:173], v16 offset:2048
 ds_read_b64_tr_b16 v[174:175], v16 offset:10240
 v_xor_b32 v16, 0, v12
 v_add_u32 v16, 32768, v16
 ds_read_b64_tr_b16 v[176:177], v16 offset:16384
 ds_read_b64_tr_b16 v[178:179], v16 offset:24576
 ds_read_b64_tr_b16 v[180:181], v16 offset:18432
 ds_read_b64_tr_b16 v[182:183], v16 offset:26624
 v_xor_b32 v16, 32, v12
 v_add_u32 v16, 32768, v16
 ds_read_b64_tr_b16 v[32:33], v16 offset:16384
 ds_read_b64_tr_b16 v[34:35], v16 offset:24576
 ds_read_b64_tr_b16 v[36:37], v16 offset:18432
 ds_read_b64_tr_b16 v[38:39], v16 offset:26624
 s_add_u32 s3, s63, 0
 s_waitcnt lgkmcnt(2)
 buffer_store_dwordx4 v[32:35], v1, s[4:7], s3 offen offset:0
 s_waitcnt lgkmcnt(0)
 buffer_store_dwordx4 v[36:39], v1, s[4:7], s3 offen offset:1024
 s_waitcnt lgkmcnt(0)
 s_barrier
 s_lshl_b32 s14, s52, 8
 s_add_u32 s14, s14, 1572864
 s_mov_b32 m0, 49152
 s_nop 0
 buffer_load_dwordx4 v10, s[8:11], s14 offen lds
 s_add_u32 s14, s14, 32768
 s_mov_b32 m0, 50176
 s_nop 0
 buffer_load_dwordx4 v10, s[8:11], s14 offen lds
 s_add_u32 s14, s14, 32768
 s_mov_b32 m0, 51200
 s_nop 0
 buffer_load_dwordx4 v10, s[8:11], s14 offen lds
 s_add_u32 s14, s14, 32768
 s_mov_b32 m0, 52224
 s_nop 0
 buffer_load_dwordx4 v10, s[8:11], s14 offen lds
 s_add_u32 s14, s14, 32768
 s_mov_b32 m0, 53248
 s_nop 0
 buffer_load_dwordx4 v11, s[8:11], s14 offen lds
 s_add_u32 s14, s14, 32768
 s_mov_b32 m0, 54272
 s_nop 0
 buffer_load_dwordx4 v11, s[8:11], s14 offen lds
 s_add_u32 s14, s14, 32768
 s_mov_b32 m0, 55296
 s_nop 0
 buffer_load_dwordx4 v11, s[8:11], s14 offen lds
 s_add_u32 s14, s14, 32768
 s_mov_b32 m0, 56320
 s_nop 0
 buffer_load_dwordx4 v11, s[8:11], s14 offen lds
 s_waitcnt vmcnt(34)
 s_barrier
 v_xor_b32 v16, 0, v12
 v_add_u32 v16, 65536, v16
 ds_read_b64_tr_b16 v[40:41], v16 offset:0
 ds_read_b64_tr_b16 v[42:43], v16 offset:8192
 ds_read_b64_tr_b16 v[44:45], v16 offset:2048
 ds_read_b64_tr_b16 v[46:47], v16 offset:10240
 s_add_u32 s3, s63, 2048
 s_waitcnt lgkmcnt(2)
 buffer_store_dwordx4 v[40:43], v1, s[4:7], s3 offen offset:0
 s_waitcnt lgkmcnt(0)
 buffer_store_dwordx4 v[44:47], v1, s[4:7], s3 offen offset:1024
 v_xor_b32 v16, 32, v12
 v_add_u32 v16, 65536, v16
 ds_read_b64_tr_b16 v[48:49], v16 offset:0
 ds_read_b64_tr_b16 v[50:51], v16 offset:8192
 ds_read_b64_tr_b16 v[52:53], v16 offset:2048
 ds_read_b64_tr_b16 v[54:55], v16 offset:10240
 s_add_u32 s3, s63, 4096
 s_waitcnt lgkmcnt(2)
 buffer_store_dwordx4 v[48:51], v1, s[4:7], s3 offen offset:0
 s_waitcnt lgkmcnt(0)
 buffer_store_dwordx4 v[52:55], v1, s[4:7], s3 offen offset:1024
 v_xor_b32 v16, 0, v12
 v_add_u32 v16, 65536, v16
 ds_read_b64_tr_b16 v[56:57], v16 offset:16384
 ds_read_b64_tr_b16 v[58:59], v16 offset:24576
 ds_read_b64_tr_b16 v[60:61], v16 offset:18432
 ds_read_b64_tr_b16 v[62:63], v16 offset:26624
 s_add_u32 s3, s63, 6144
 s_waitcnt lgkmcnt(2)
 buffer_store_dwordx4 v[56:59], v1, s[4:7], s3 offen offset:0
 s_waitcnt lgkmcnt(0)
 buffer_store_dwordx4 v[60:63], v1, s[4:7], s3 offen offset:1024
 v_xor_b32 v16, 32, v12
 v_add_u32 v16, 65536, v16
 ds_read_b64_tr_b16 v[32:33], v16 offset:16384
 ds_read_b64_tr_b16 v[34:35], v16 offset:24576
 ds_read_b64_tr_b16 v[36:37], v16 offset:18432
 ds_read_b64_tr_b16 v[38:39], v16 offset:26624
 s_add_u32 s3, s63, 8192
 s_waitcnt lgkmcnt(2)
 buffer_store_dwordx4 v[32:35], v1, s[4:7], s3 offen offset:0
 s_waitcnt lgkmcnt(0)
 buffer_store_dwordx4 v[36:39], v1, s[4:7], s3 offen offset:1024
 s_waitcnt lgkmcnt(0)
 s_barrier
 s_lshl_b32 s14, s52, 8
 s_add_u32 s14, s14, 2621440
 s_mov_b32 m0, 81920
 s_nop 0
 buffer_load_dwordx4 v10, s[8:11], s14 offen lds
 s_add_u32 s14, s14, 32768
 s_mov_b32 m0, 82944
 s_nop 0
 buffer_load_dwordx4 v10, s[8:11], s14 offen lds
 s_add_u32 s14, s14, 32768
 s_mov_b32 m0, 83968
 s_nop 0
 buffer_load_dwordx4 v10, s[8:11], s14 offen lds
 s_add_u32 s14, s14, 32768
 s_mov_b32 m0, 84992
 s_nop 0
 buffer_load_dwordx4 v10, s[8:11], s14 offen lds
 s_add_u32 s14, s14, 32768
 s_mov_b32 m0, 86016
 s_nop 0
 buffer_load_dwordx4 v11, s[8:11], s14 offen lds
 s_add_u32 s14, s14, 32768
 s_mov_b32 m0, 87040
 s_nop 0
 buffer_load_dwordx4 v11, s[8:11], s14 offen lds
 s_add_u32 s14, s14, 32768
 s_mov_b32 m0, 88064
 s_nop 0
 buffer_load_dwordx4 v11, s[8:11], s14 offen lds
 s_add_u32 s14, s14, 32768
 s_mov_b32 m0, 89088
 s_nop 0
 buffer_load_dwordx4 v11, s[8:11], s14 offen lds
 s_waitcnt vmcnt(42)
 s_barrier
 v_xor_b32 v16, 0, v12
 v_add_u32 v16, 98304, v16
 ds_read_b64_tr_b16 v[184:185], v16 offset:0
 ds_read_b64_tr_b16 v[186:187], v16 offset:8192
 ds_read_b64_tr_b16 v[188:189], v16 offset:2048
 ds_read_b64_tr_b16 v[190:191], v16 offset:10240
 v_xor_b32 v16, 32, v12
 v_add_u32 v16, 98304, v16
 ds_read_b64_tr_b16 v[192:193], v16 offset:0
 ds_read_b64_tr_b16 v[194:195], v16 offset:8192
 ds_read_b64_tr_b16 v[196:197], v16 offset:2048
 ds_read_b64_tr_b16 v[198:199], v16 offset:10240
 v_xor_b32 v16, 0, v12
 v_add_u32 v16, 98304, v16
 ds_read_b64_tr_b16 v[200:201], v16 offset:16384
 ds_read_b64_tr_b16 v[202:203], v16 offset:24576
 ds_read_b64_tr_b16 v[204:205], v16 offset:18432
 ds_read_b64_tr_b16 v[206:207], v16 offset:26624
 v_xor_b32 v16, 32, v12
 v_add_u32 v16, 98304, v16
 ds_read_b64_tr_b16 v[208:209], v16 offset:16384
 ds_read_b64_tr_b16 v[210:211], v16 offset:24576
 ds_read_b64_tr_b16 v[212:213], v16 offset:18432
 ds_read_b64_tr_b16 v[214:215], v16 offset:26624
 s_waitcnt lgkmcnt(0)
 s_barrier
 s_lshl_b32 s14, s52, 8
 s_add_u32 s14, s14, 3670016
 s_mov_b32 m0, 114688
 s_nop 0
 buffer_load_dwordx4 v10, s[8:11], s14 offen lds
 s_add_u32 s14, s14, 32768
 s_mov_b32 m0, 115712
 s_nop 0
 buffer_load_dwordx4 v10, s[8:11], s14 offen lds
 s_add_u32 s14, s14, 32768
 s_mov_b32 m0, 116736
 s_nop 0
 buffer_load_dwordx4 v10, s[8:11], s14 offen lds
 s_add_u32 s14, s14, 32768
 s_mov_b32 m0, 117760
 s_nop 0
 buffer_load_dwordx4 v10, s[8:11], s14 offen lds
 s_add_u32 s14, s14, 32768
 s_mov_b32 m0, 118784
 s_nop 0
 buffer_load_dwordx4 v11, s[8:11], s14 offen lds
 s_add_u32 s14, s14, 32768
 s_mov_b32 m0, 119808
 s_nop 0
 buffer_load_dwordx4 v11, s[8:11], s14 offen lds
 s_add_u32 s14, s14, 32768
 s_mov_b32 m0, 120832
 s_nop 0
 buffer_load_dwordx4 v11, s[8:11], s14 offen lds
 s_add_u32 s14, s14, 32768
 s_mov_b32 m0, 121856
 s_nop 0
 buffer_load_dwordx4 v11, s[8:11], s14 offen lds
 s_waitcnt vmcnt(42)
 s_barrier
 v_xor_b32 v16, 0, v12
 v_add_u32 v16, 131072, v16
 ds_read_b64_tr_b16 v[216:217], v16 offset:0
 ds_read_b64_tr_b16 v[218:219], v16 offset:8192
 ds_read_b64_tr_b16 v[220:221], v16 offset:2048
 ds_read_b64_tr_b16 v[222:223], v16 offset:10240
 v_xor_b32 v16, 32, v12
 v_add_u32 v16, 131072, v16
 ds_read_b64_tr_b16 v[224:225], v16 offset:0
 ds_read_b64_tr_b16 v[226:227], v16 offset:8192
 ds_read_b64_tr_b16 v[228:229], v16 offset:2048
 ds_read_b64_tr_b16 v[230:231], v16 offset:10240
 v_xor_b32 v16, 0, v12
 v_add_u32 v16, 131072, v16
 ds_read_b64_tr_b16 v[232:233], v16 offset:16384
 ds_read_b64_tr_b16 v[234:235], v16 offset:24576
 ds_read_b64_tr_b16 v[236:237], v16 offset:18432
 ds_read_b64_tr_b16 v[238:239], v16 offset:26624
 v_xor_b32 v16, 32, v12
 v_add_u32 v16, 131072, v16
 ds_read_b64_tr_b16 v[40:41], v16 offset:16384
 ds_read_b64_tr_b16 v[42:43], v16 offset:24576
 ds_read_b64_tr_b16 v[44:45], v16 offset:18432
 ds_read_b64_tr_b16 v[46:47], v16 offset:26624
 s_add_u32 s3, s63, 10240
 s_waitcnt lgkmcnt(2)
 buffer_store_dwordx4 v[40:43], v1, s[4:7], s3 offen offset:0
 s_waitcnt lgkmcnt(0)
 buffer_store_dwordx4 v[44:47], v1, s[4:7], s3 offen offset:1024
 s_waitcnt lgkmcnt(0)
 s_barrier
 s_lshl_b32 s14, s52, 8
 s_add_u32 s14, s14, 4718592
 s_mov_b32 m0, 147456
 s_nop 0
 buffer_load_dwordx4 v10, s[8:11], s14 offen lds
 s_add_u32 s14, s14, 32768
 s_mov_b32 m0, 148480
 s_nop 0
 buffer_load_dwordx4 v10, s[8:11], s14 offen lds
 s_add_u32 s14, s14, 32768
 s_mov_b32 m0, 149504
 s_nop 0
 buffer_load_dwordx4 v10, s[8:11], s14 offen lds
 s_add_u32 s14, s14, 32768
 s_mov_b32 m0, 150528
 s_nop 0
 buffer_load_dwordx4 v10, s[8:11], s14 offen lds
 s_add_u32 s14, s14, 32768
 s_mov_b32 m0, 151552
 s_nop 0
 buffer_load_dwordx4 v11, s[8:11], s14 offen lds
 s_add_u32 s14, s14, 32768
 s_mov_b32 m0, 152576
 s_nop 0
 buffer_load_dwordx4 v11, s[8:11], s14 offen lds
 s_add_u32 s14, s14, 32768
 s_mov_b32 m0, 153600
 s_nop 0
 buffer_load_dwordx4 v11, s[8:11], s14 offen lds
 s_add_u32 s14, s14, 32768
 s_mov_b32 m0, 154624
 s_nop 0
 buffer_load_dwordx4 v11, s[8:11], s14 offen lds
 s_waitcnt vmcnt(44)
 s_barrier
 v_xor_b32 v16, 0, v12
 v_add_u32 v16, 0, v16
 ds_read_b64_tr_b16 v[240:241], v16 offset:0
 ds_read_b64_tr_b16 v[242:243], v16 offset:8192
 ds_read_b64_tr_b16 v[244:245], v16 offset:2048
 ds_read_b64_tr_b16 v[246:247], v16 offset:10240
 v_xor_b32 v16, 32, v12
 v_add_u32 v16, 0, v16
 ds_read_b64_tr_b16 v[248:249], v16 offset:0
 ds_read_b64_tr_b16 v[250:251], v16 offset:8192
 ds_read_b64_tr_b16 v[252:253], v16 offset:2048
 ds_read_b64_tr_b16 v[254:255], v16 offset:10240
 v_xor_b32 v16, 0, v12
 v_add_u32 v16, 0, v16
 ds_read_b64_tr_b16 v[32:33], v16 offset:16384
 ds_read_b64_tr_b16 v[34:35], v16 offset:24576
 ds_read_b64_tr_b16 v[36:37], v16 offset:18432
 ds_read_b64_tr_b16 v[38:39], v16 offset:26624
 v_xor_b32 v16, 32, v12
 v_add_u32 v16, 0, v16
 ds_read_b64_tr_b16 v[40:41], v16 offset:16384
 ds_read_b64_tr_b16 v[42:43], v16 offset:24576
 ds_read_b64_tr_b16 v[44:45], v16 offset:18432
 ds_read_b64_tr_b16 v[46:47], v16 offset:26624
 s_waitcnt lgkmcnt(0)
 s_barrier
 ds_write_b128 v1, v[224:227] offset:24576
 ds_write_b128 v1, v[228:231] offset:25600
 ds_write_b128 v1, v[216:219] offset:26624
 ds_write_b128 v1, v[220:223] offset:27648
 s_waitcnt lgkmcnt(0)
 v_mov_b32 v224, v32
 v_mov_b32 v225, v33
 v_mov_b32 v226, v34
 v_mov_b32 v227, v35
 v_mov_b32 v228, v36
 v_mov_b32 v229, v37
 v_mov_b32 v230, v38
 v_mov_b32 v231, v39
 v_mov_b32 v216, v40
 v_mov_b32 v217, v41
 v_mov_b32 v218, v42
 v_mov_b32 v219, v43
 v_mov_b32 v220, v44
 v_mov_b32 v221, v45
 v_mov_b32 v222, v46
 v_mov_b32 v223, v47
 s_waitcnt vmcnt(34)
 s_barrier
 v_xor_b32 v16, 0, v12
 v_add_u32 v16, 32768, v16
 ds_read_b64_tr_b16 v[32:33], v16 offset:0
 ds_read_b64_tr_b16 v[34:35], v16 offset:8192
 ds_read_b64_tr_b16 v[36:37], v16 offset:2048
 ds_read_b64_tr_b16 v[38:39], v16 offset:10240
 v_xor_b32 v16, 32, v12
 v_add_u32 v16, 32768, v16
 ds_read_b64_tr_b16 v[40:41], v16 offset:0
 ds_read_b64_tr_b16 v[42:43], v16 offset:8192
 ds_read_b64_tr_b16 v[44:45], v16 offset:2048
 ds_read_b64_tr_b16 v[46:47], v16 offset:10240
 v_xor_b32 v16, 0, v12
 v_add_u32 v16, 32768, v16
 ds_read_b64_tr_b16 v[48:49], v16 offset:16384
 ds_read_b64_tr_b16 v[50:51], v16 offset:24576
 ds_read_b64_tr_b16 v[52:53], v16 offset:18432
 ds_read_b64_tr_b16 v[54:55], v16 offset:26624
 v_xor_b32 v16, 32, v12
 v_add_u32 v16, 32768, v16
 ds_read_b64_tr_b16 v[56:57], v16 offset:16384
 ds_read_b64_tr_b16 v[58:59], v16 offset:24576
 ds_read_b64_tr_b16 v[60:61], v16 offset:18432
 ds_read_b64_tr_b16 v[62:63], v16 offset:26624
 s_waitcnt lgkmcnt(0)
 s_barrier
 ds_write_b128 v1, v[208:211] offset:49152
 ds_write_b128 v1, v[212:215] offset:50176
 ds_write_b128 v1, v[200:203] offset:51200
 ds_write_b128 v1, v[204:207] offset:52224
 ds_write_b128 v1, v[184:187] offset:53248
 ds_write_b128 v1, v[188:191] offset:54272
 ds_write_b128 v1, v[176:179] offset:55296
 ds_write_b128 v1, v[180:183] offset:56320
 s_waitcnt lgkmcnt(0)
 v_mov_b32 v208, v32
 v_mov_b32 v209, v33
 v_mov_b32 v210, v34
 v_mov_b32 v211, v35
 v_mov_b32 v212, v36
 v_mov_b32 v213, v37
 v_mov_b32 v214, v38
 v_mov_b32 v215, v39
 v_mov_b32 v200, v40
 v_mov_b32 v201, v41
 v_mov_b32 v202, v42
 v_mov_b32 v203, v43
 v_mov_b32 v204, v44
 v_mov_b32 v205, v45
 v_mov_b32 v206, v46
 v_mov_b32 v207, v47
 v_mov_b32 v184, v48
 v_mov_b32 v185, v49
 v_mov_b32 v186, v50
 v_mov_b32 v187, v51
 v_mov_b32 v188, v52
 v_mov_b32 v189, v53
 v_mov_b32 v190, v54
 v_mov_b32 v191, v55
 v_mov_b32 v176, v56
 v_mov_b32 v177, v57
 v_mov_b32 v178, v58
 v_mov_b32 v179, v59
 v_mov_b32 v180, v60
 v_mov_b32 v181, v61
 v_mov_b32 v182, v62
 v_mov_b32 v183, v63
 s_waitcnt vmcnt(18)
 s_barrier
 v_xor_b32 v16, 0, v12
 v_add_u32 v16, 65536, v16
 ds_read_b64_tr_b16 v[32:33], v16 offset:0
 ds_read_b64_tr_b16 v[34:35], v16 offset:8192
 ds_read_b64_tr_b16 v[36:37], v16 offset:2048
 ds_read_b64_tr_b16 v[38:39], v16 offset:10240
 v_xor_b32 v16, 32, v12
 v_add_u32 v16, 65536, v16
 ds_read_b64_tr_b16 v[40:41], v16 offset:0
 ds_read_b64_tr_b16 v[42:43], v16 offset:8192
 ds_read_b64_tr_b16 v[44:45], v16 offset:2048
 ds_read_b64_tr_b16 v[46:47], v16 offset:10240
 v_xor_b32 v16, 0, v12
 v_add_u32 v16, 65536, v16
 ds_read_b64_tr_b16 v[48:49], v16 offset:16384
 ds_read_b64_tr_b16 v[50:51], v16 offset:24576
 ds_read_b64_tr_b16 v[52:53], v16 offset:18432
 ds_read_b64_tr_b16 v[54:55], v16 offset:26624
 v_xor_b32 v16, 32, v12
 v_add_u32 v16, 65536, v16
 ds_read_b64_tr_b16 v[56:57], v16 offset:16384
 ds_read_b64_tr_b16 v[58:59], v16 offset:24576
 ds_read_b64_tr_b16 v[60:61], v16 offset:18432
 ds_read_b64_tr_b16 v[62:63], v16 offset:26624
 s_waitcnt lgkmcnt(0)
 s_barrier
 ds_write_b128 v2, v[168:171] offset:16384
 ds_write_b128 v2, v[172:175] offset:17408
 ds_write_b128 v2, v[160:163] offset:18432
 ds_write_b128 v2, v[164:167] offset:19456
 ds_write_b128 v2, v[144:147] offset:20480
 ds_write_b128 v2, v[148:151] offset:21504
 ds_write_b128 v2, v[128:131] offset:22528
 ds_write_b128 v2, v[132:135] offset:23552
 s_waitcnt lgkmcnt(0)
 v_mov_b32 v168, v32
 v_mov_b32 v169, v33
 v_mov_b32 v170, v34
 v_mov_b32 v171, v35
 v_mov_b32 v172, v36
 v_mov_b32 v173, v37
 v_mov_b32 v174, v38
 v_mov_b32 v175, v39
 v_mov_b32 v160, v40
 v_mov_b32 v161, v41
 v_mov_b32 v162, v42
 v_mov_b32 v163, v43
 v_mov_b32 v164, v44
 v_mov_b32 v165, v45
 v_mov_b32 v166, v46
 v_mov_b32 v167, v47
 v_mov_b32 v144, v48
 v_mov_b32 v145, v49
 v_mov_b32 v146, v50
 v_mov_b32 v147, v51
 v_mov_b32 v148, v52
 v_mov_b32 v149, v53
 v_mov_b32 v150, v54
 v_mov_b32 v151, v55
 v_mov_b32 v128, v56
 v_mov_b32 v129, v57
 v_mov_b32 v130, v58
 v_mov_b32 v131, v59
 v_mov_b32 v132, v60
 v_mov_b32 v133, v61
 v_mov_b32 v134, v62
 v_mov_b32 v135, v63
 s_waitcnt vmcnt(10)
 s_barrier
 v_xor_b32 v16, 0, v12
 v_add_u32 v16, 98304, v16
 ds_read_b64_tr_b16 v[32:33], v16 offset:0
 ds_read_b64_tr_b16 v[34:35], v16 offset:8192
 ds_read_b64_tr_b16 v[36:37], v16 offset:2048
 ds_read_b64_tr_b16 v[38:39], v16 offset:10240
 v_xor_b32 v16, 32, v12
 v_add_u32 v16, 98304, v16
 ds_read_b64_tr_b16 v[40:41], v16 offset:0
 ds_read_b64_tr_b16 v[42:43], v16 offset:8192
 ds_read_b64_tr_b16 v[44:45], v16 offset:2048
 ds_read_b64_tr_b16 v[46:47], v16 offset:10240
 v_xor_b32 v16, 0, v12
 v_add_u32 v16, 98304, v16
 ds_read_b64_tr_b16 v[48:49], v16 offset:16384
 ds_read_b64_tr_b16 v[50:51], v16 offset:24576
 ds_read_b64_tr_b16 v[52:53], v16 offset:18432
 ds_read_b64_tr_b16 v[54:55], v16 offset:26624
 v_xor_b32 v16, 32, v12
 v_add_u32 v16, 98304, v16
 ds_read_b64_tr_b16 v[56:57], v16 offset:16384
 ds_read_b64_tr_b16 v[58:59], v16 offset:24576
 ds_read_b64_tr_b16 v[60:61], v16 offset:18432
 ds_read_b64_tr_b16 v[62:63], v16 offset:26624
 s_waitcnt lgkmcnt(0)
 s_barrier
 ds_write_b128 v3, a[136:139] offset:0
 ds_write_b128 v3, a[140:143] offset:1024
 ds_write_b128 v3, a[128:131] offset:2048
 ds_write_b128 v3, a[132:135] offset:3072
 ds_write_b128 v3, a[112:115] offset:4096
 ds_write_b128 v3, a[116:119] offset:5120
 ds_write_b128 v3, a[88:91] offset:6144
 ds_write_b128 v3, a[92:95] offset:7168
 s_waitcnt lgkmcnt(0)
 v_accvgpr_write_b32 a136, v32
 v_accvgpr_write_b32 a137, v33
 v_accvgpr_write_b32 a138, v34
 v_accvgpr_write_b32 a139, v35
 v_accvgpr_write_b32 a140, v36
 v_accvgpr_write_b32 a141, v37
 v_accvgpr_write_b32 a142, v38
 v_accvgpr_write_b32 a143, v39
 v_accvgpr_write_b32 a128, v40
 v_accvgpr_write_b32 a129, v41
 v_accvgpr_write_b32 a130, v42
 v_accvgpr_write_b32 a131, v43
 v_accvgpr_write_b32 a132, v44
 v_accvgpr_write_b32 a133, v45
 v_accvgpr_write_b32 a134, v46
 v_accvgpr_write_b32 a135, v47
 v_accvgpr_write_b32 a112, v48
 v_accvgpr_write_b32 a113, v49
 v_accvgpr_write_b32 a114, v50
 v_accvgpr_write_b32 a115, v51
 v_accvgpr_write_b32 a116, v52
 v_accvgpr_write_b32 a117, v53
 v_accvgpr_write_b32 a118, v54
 v_accvgpr_write_b32 a119, v55
 v_accvgpr_write_b32 a88, v56
 v_accvgpr_write_b32 a89, v57
 v_accvgpr_write_b32 a90, v58
 v_accvgpr_write_b32 a91, v59
 v_accvgpr_write_b32 a92, v60
 v_accvgpr_write_b32 a93, v61
 v_accvgpr_write_b32 a94, v62
 v_accvgpr_write_b32 a95, v63
 s_waitcnt vmcnt(0)
 s_barrier
 v_xor_b32 v16, 0, v12
 v_add_u32 v16, 131072, v16
 ds_read_b64_tr_b16 v[32:33], v16 offset:0
 ds_read_b64_tr_b16 v[34:35], v16 offset:8192
 ds_read_b64_tr_b16 v[36:37], v16 offset:2048
 ds_read_b64_tr_b16 v[38:39], v16 offset:10240
 v_xor_b32 v16, 32, v12
 v_add_u32 v16, 131072, v16
 ds_read_b64_tr_b16 v[40:41], v16 offset:0
 ds_read_b64_tr_b16 v[42:43], v16 offset:8192
 ds_read_b64_tr_b16 v[44:45], v16 offset:2048
 ds_read_b64_tr_b16 v[46:47], v16 offset:10240
 v_xor_b32 v16, 0, v12
 v_add_u32 v16, 131072, v16
 ds_read_b64_tr_b16 v[48:49], v16 offset:16384
 ds_read_b64_tr_b16 v[50:51], v16 offset:24576
 ds_read_b64_tr_b16 v[52:53], v16 offset:18432
 ds_read_b64_tr_b16 v[54:55], v16 offset:26624
 v_xor_b32 v16, 32, v12
 v_add_u32 v16, 131072, v16
 ds_read_b64_tr_b16 v[56:57], v16 offset:16384
 ds_read_b64_tr_b16 v[58:59], v16 offset:24576
 ds_read_b64_tr_b16 v[60:61], v16 offset:18432
 ds_read_b64_tr_b16 v[62:63], v16 offset:26624
 s_waitcnt lgkmcnt(0)
 s_barrier
 ds_write_b128 v3, a[80:83] offset:32768
 ds_write_b128 v3, a[84:87] offset:33792
 ds_write_b128 v3, a[72:75] offset:34816
 ds_write_b128 v3, a[76:79] offset:35840
 ds_write_b128 v3, a[32:35] offset:36864
 ds_write_b128 v3, a[36:39] offset:37888
 ds_write_b128 v3, a[24:27] offset:38912
 ds_write_b128 v3, a[28:31] offset:39936
 s_waitcnt lgkmcnt(0)
 v_accvgpr_write_b32 a80, v32
 v_accvgpr_write_b32 a81, v33
 v_accvgpr_write_b32 a82, v34
 v_accvgpr_write_b32 a83, v35
 v_accvgpr_write_b32 a84, v36
 v_accvgpr_write_b32 a85, v37
 v_accvgpr_write_b32 a86, v38
 v_accvgpr_write_b32 a87, v39
 v_accvgpr_write_b32 a72, v40
 v_accvgpr_write_b32 a73, v41
 v_accvgpr_write_b32 a74, v42
 v_accvgpr_write_b32 a75, v43
 v_accvgpr_write_b32 a76, v44
 v_accvgpr_write_b32 a77, v45
 v_accvgpr_write_b32 a78, v46
 v_accvgpr_write_b32 a79, v47
 v_accvgpr_write_b32 a32, v48
 v_accvgpr_write_b32 a33, v49
 v_accvgpr_write_b32 a34, v50
 v_accvgpr_write_b32 a35, v51
 v_accvgpr_write_b32 a36, v52
 v_accvgpr_write_b32 a37, v53
 v_accvgpr_write_b32 a38, v54
 v_accvgpr_write_b32 a39, v55
 v_accvgpr_write_b32 a24, v56
 v_accvgpr_write_b32 a25, v57
 v_accvgpr_write_b32 a26, v58
 v_accvgpr_write_b32 a27, v59
 v_accvgpr_write_b32 a28, v60
 v_accvgpr_write_b32 a29, v61
 v_accvgpr_write_b32 a30, v62
 v_accvgpr_write_b32 a31, v63
 v_lshlrev_b32 v5, 3, v0
 v_and_b32 v4, 15, v0
 v_lshlrev_b32 v4, 5, v4
 v_lshrrev_b32 v7, 4, v0
 v_lshl_add_u32 v4, v7, 3, v4
 v_add_u32 v4, 12288, v4
 v_and_b32 v6, 0x1e0, v5
 v_and_b32 v7, 1, v0
 v_lshl_add_u32 v6, v7, 4, v6
 v_and_b32 v7, 2, v0
 v_lshl_add_u32 v6, v7, 2, v6
 s_lshl_b32 s59, s53, 16
 s_add_u32 s59, s59, 917504
 s_mul_i32 s15, s53, 327680
 s_add_u32 s15, s15, 225280
 s_lshl_b32 s3, s52, 6
 s_add_u32 s15, s15, s3
 s_add_u32 s64, s15, 8192
 s_add_u32 s65, s15, 172032
 s_lshr_b32 s14, s52, 4
 s_add_u32 s14, s14, 8
 s_bfe_u32 s15, s52, 0x20002
 s_and_b32 s16, s52, 3
 s_mov_b32 s84, 0x000f000f
 s_mov_b32 s85, 0
 s_lshl_b32 s57, s14, 10
 s_lshl_b32 s3, s15, 6
 s_add_u32 s57, s57, s3
 s_lshl_b32 s3, s16, 8
 s_add_u32 s57, s57, s3
 s_add_u32 s57, s57, s59
 s_add_u32 s59, s59, 4096
 s_lshl_b32 s14, s14, 7
 s_mul_i32 s15, s15, 2560
 s_add_u32 s14, s14, s15
 s_lshl_b32 s3, s16, 3
 s_add_u32 s14, s14, s3
 s_mov_b32 s8, s18
 s_and_b32 s9, s19, 0xffff
 s_mov_b32 s10, 10240
 s_mov_b32 s11, 0x00020000
 v_bfe_u32 v40, v0, 4, 1
 v_mul_u32_u24 v40, 1280, v40
 v_and_b32 v41, 7, v0
 v_lshl_add_u32 v40, v41, 1, v40
 buffer_load_ushort v44, v40, s[8:11], s14 offen offset:0
 buffer_load_ushort v45, v40, s[8:11], s14 offen offset:32
 buffer_load_ushort v46, v40, s[8:11], s14 offen offset:64
 buffer_load_ushort v47, v40, s[8:11], s14 offen offset:96
 v_lshrrev_b32 v42, 6, v1
 v_mul_u32_u24 v42, 10240, v42
 v_and_b32 v7, 48, v1
 v_add_u32 v42, v42, v7
 v_and_b32 v43, 32, v1
 v_and_b32 v7, 64, v1
 v_lshl_add_u32 v43, v7, 2, v43
 v_bfe_u32 v7, v1, 8, 1
 v_lshl_add_u32 v43, v7, 4, v43
 v_and_b32 v7, 8, v5
 v_add_u32 v43, v43, v7
 s_waitcnt vmcnt(2)
 v_lshl_or_b32 v44, v45, 16, v44
 s_waitcnt vmcnt(0)
 v_lshl_or_b32 v45, v47, 16, v46
 s_waitcnt vmcnt(0) lgkmcnt(0)
 s_mov_b32 s96, s44
 s_and_b32 s97, s45, 0xffff
 s_mov_b32 s98, 256
 s_mov_b32 s99, 0x00020000
 v_mov_b32 v8, 132
 s_mov_b32 s51, 0
 s_mov_b64 exec, 1
L_wb_187:
 buffer_load_dword v9, v8, s[96:99], 0 offen sc1
 s_waitcnt vmcnt(0)
 v_cmp_eq_u32 vcc, 0, v9
 s_cbranch_vccz L_wbd_188
 s_sleep 2
 s_add_u32 s51, s51, 1
 s_cmp_lt_u32 s51, 131072
 s_cbranch_scc1 L_wb_187
 s_branch L_bail
L_wbd_188:
 s_mov_b64 exec, -1
 s_mov_b32 s96, s44
 s_and_b32 s97, s45, 0xffff
 s_mov_b32 s98, 256
 s_mov_b32 s99, 0x00020000
 v_mov_b32 v8, 212
 s_mov_b32 s51, 0
 s_mov_b64 exec, 1
L_wb_189:
 buffer_load_dword v9, v8, s[96:99], 0 offen sc1
 s_waitcnt vmcnt(0)
 v_cmp_eq_u32 vcc, 0, v9
 s_cbranch_vccz L_wbd_190
 s_sleep 2
 s_add_u32 s51, s51, 1
 s_cmp_lt_u32 s51, 131072
 s_cbranch_scc1 L_wb_189
 s_branch L_bail
L_wbd_190:
 s_mov_b64 exec, -1
 s_mov_b32 s96, s44
 s_and_b32 s97, s45, 0xffff
 s_mov_b32 s98, 256
 s_mov_b32 s99, 0x00020000
 v_lshlrev_b32 v8, 5, v0
 s_mov_b32 s51, 0
L_gl_191:
 buffer_load_dword v9, v8, s[96:99], 0 offen sc1
 s_waitcnt vmcnt(0)
 v_readlane_b32 s3, v9, s48
 s_mov_b32 s80, 0
 s_nop 2
 s_cmp_ge_u32 s3, 32
 s_cbranch_scc1 L_gld_192
 s_mov_b32 s80, 0
 v_readlane_b32 s3, v9, 0
 s_nop 3
 s_add_u32 s80, s80, s3
 v_readlane_b32 s3, v9, 1
 s_nop 3
 s_add_u32 s80, s80, s3
 v_readlane_b32 s3, v9, 2
 s_nop 3
 s_add_u32 s80, s80, s3
 v_readlane_b32 s3, v9, 3
 s_nop 3
 s_add_u32 s80, s80, s3
 v_readlane_b32 s3, v9, 4
 s_nop 3
 s_add_u32 s80, s80, s3
 v_readlane_b32 s3, v9, 5
 s_nop 3
 s_add_u32 s80, s80, s3
 v_readlane_b32 s3, v9, 6
 s_nop 3
 s_add_u32 s80, s80, s3
 v_readlane_b32 s3, v9, 7
 s_nop 3
 s_add_u32 s80, s80, s3
 s_cmp_ge_u32 s80, 256
 s_cbranch_scc1 L_gld_192
 s_sleep 4
 s_add_u32 s51, s51, 1
 s_cmp_lt_u32 s51, 131072
 s_cbranch_scc1 L_gl_191
 s_branch L_bail
L_gld_192:
 s_mov_b64 exec, s[84:85]
 buffer_store_dwordx2 v[44:45], v43, s[4:7], s57 offen sc1
 s_mov_b64 exec, -1
 v_and_b32 v7, 2, v0
 v_mul_u32_u24 v7, 0x5555, v7
 v_add_u32 v0, 0x4444, v7
 s_mov_b32 m0, 2048
 s_waitcnt vmcnt(0) lgkmcnt(0)
 s_barrier
 buffer_load_dwordx4 v[32:35], v1, s[4:7], s63 offen offset:2048
 buffer_load_dwordx4 v[36:39], v1, s[4:7], s63 offen offset:3072
 s_add_u32 s3, s63, 4096
 buffer_load_dwordx4 v[40:43], v1, s[4:7], s3 offen offset:0
 buffer_load_dwordx4 v[44:47], v1, s[4:7], s3 offen offset:1024
 s_add_u32 s3, s63, 4096
 buffer_load_dwordx4 v[48:51], v1, s[4:7], s3 offen offset:2048
 buffer_load_dwordx4 v[52:55], v1, s[4:7], s3 offen offset:3072
 s_add_u32 s3, s63, 8192
 buffer_load_dwordx4 v[56:59], v1, s[4:7], s3 offen offset:0
 buffer_load_dwordx4 v[60:63], v1, s[4:7], s3 offen offset:1024
 ds_read_b128 v[8:11], v3 offset:49152
 ds_read_b128 v[12:15], v3 offset:49152
 ds_read_b128 v[16:19], v3 offset:49152
 ds_read_b128 v[20:23], v3 offset:49152
 s_waitcnt vmcnt(0) lgkmcnt(0)
 s_cmp_lg_u32 s80, 0
 s_cbranch_scc1 L_ch2_s
.p2align 6
L_ch2_f:
 s_mov_b32 s51, 0
L_pm_193:
 buffer_load_dwordx4 v[24:27], v1, s[4:7], s59 offen offset:0 sc1
 buffer_load_dwordx4 v[28:31], v1, s[4:7], s59 offen offset:1024 sc1
 s_add_u32 s3, s59, 4096
 buffer_load_dwordx4 v[12:15], v1, s[4:7], s3 offen offset:0 sc1
 s_waitcnt vmcnt(2)
 ds_write_b128 v1, v[24:27] offset:4096
 v_max_u32 v7, v24, v26
 s_waitcnt vmcnt(1)
 ds_write_b128 v1, v[28:31] offset:5120
 v_max3_u32 v7, v7, v28, v30
 s_waitcnt vmcnt(0)
 ds_write_b128 v1, v[12:15] offset:8192
 v_max3_u32 v7, v7, v12, v14
 v_cmp_eq_u32 vcc, -1, v7
 s_cbranch_vccnz L_rt_194
 ds_read_b128 v[12:15], v3 offset:49152
 v_smfmac_f32_16x16x64_bf16 v[16:19], v[24:27], v[32:39], v0
 ds_read_b128 v[32:35], v1 offset:26624
 ds_read_b128 v[36:39], v1 offset:27648
 v_smfmac_f32_16x16x64_bf16 v[20:23], v[24:27], v[40:47], v0
 ds_read_b128 v[40:43], v1 offset:24576
 ds_read_b128 v[44:47], v1 offset:25600
 v_smfmac_f32_16x16x64_bf16 v[16:19], v[28:31], v[48:55], v0
 v_smfmac_f32_16x16x64_bf16 v[20:23], v[28:31], v[56:63], v0
 s_waitcnt lgkmcnt(5)
 s_barrier
 buffer_load_dwordx4 v[56:59], v1, s[4:7], s63 offen offset:0
 buffer_load_dwordx4 v[60:63], v1, s[4:7], s63 offen offset:1024
 s_add_u32 s3, s63, 8192
 buffer_load_dwordx4 v[48:51], v1, s[4:7], s3 offen offset:2048
 buffer_load_dwordx4 v[52:55], v1, s[4:7], s3 offen offset:3072
 v_smfmac_f32_16x16x64_bf16 v[8:11], v[24:27], v[168:175], v0
 v_smfmac_f32_16x16x64_bf16 v[8:11], v[28:31], v[144:151], v0
 s_waitcnt lgkmcnt(4)
 v_smfmac_f32_16x16x64_bf16 v[12:15], v[24:27], v[160:167], v0
 ds_read_b128 v[24:27], v1 offset:8192
 v_smfmac_f32_16x16x64_bf16 v[12:15], v[28:31], v[128:135], v0
 ds_read_b128 v[28:31], v1 offset:0
 s_waitcnt lgkmcnt(1)
 v_smfmac_f32_16x16x64_bf16 v[16:19], v[24:27], v[32:39], v0
 ds_read_b128 v[32:35], v2 offset:22528
 ds_read_b128 v[36:39], v2 offset:23552
 v_smfmac_f32_16x16x64_bf16 v[8:11], v[24:27], a[80:87], v0
 v_smfmac_f32_16x16x64_bf16 v[12:15], v[24:27], a[72:79], v0
 v_smfmac_f32_16x16x64_bf16 v[20:23], v[24:27], v[40:47], v0
 ds_read_b128 v[40:43], v2 offset:20480
 ds_read_b128 v[44:47], v2 offset:21504
 ds_read_b128 v[24:27], v1 offset:1024
 s_waitcnt lgkmcnt(5)
 v_smfmac_f32_16x16x64_bf16 v[8:11], v[28:31], v[240:247], v0
 v_smfmac_f32_16x16x64_bf16 v[12:15], v[28:31], v[248:255], v0
 s_waitcnt lgkmcnt(3)
 v_smfmac_f32_16x16x64_bf16 v[16:19], v[28:31], v[32:39], v0
 ds_read_b128 v[32:35], v2 offset:18432
 ds_read_b128 v[36:39], v2 offset:19456
 v_smfmac_f32_16x16x64_bf16 v[20:23], v[28:31], v[136:143], v0
 ds_read_b128 v[28:31], v1 offset:2048
 s_waitcnt lgkmcnt(3)
 v_smfmac_f32_16x16x64_bf16 v[8:11], v[24:27], v[224:231], v0
 v_smfmac_f32_16x16x64_bf16 v[16:19], v[24:27], v[40:47], v0
 ds_read_b128 v[40:43], v2 offset:16384
 ds_read_b128 v[44:47], v2 offset:17408
 v_smfmac_f32_16x16x64_bf16 v[12:15], v[24:27], v[216:223], v0
 v_smfmac_f32_16x16x64_bf16 v[20:23], v[24:27], v[152:159], v0
 ds_read_b128 v[24:27], v1 offset:3072
 s_waitcnt lgkmcnt(3)
 v_smfmac_f32_16x16x64_bf16 v[16:19], v[28:31], v[32:39], v0
 ds_read_b128 v[32:35], v1 offset:55296
 ds_read_b128 v[36:39], v1 offset:56320
 v_smfmac_f32_16x16x64_bf16 v[8:11], v[28:31], v[208:215], v0
 v_smfmac_f32_16x16x64_bf16 v[12:15], v[28:31], v[200:207], v0
 s_waitcnt lgkmcnt(3)
 v_smfmac_f32_16x16x64_bf16 v[20:23], v[28:31], v[40:47], v0
 ds_read_b128 v[40:43], v1 offset:53248
 ds_read_b128 v[44:47], v1 offset:54272
 ds_read_b128 v[28:31], v1 offset:6144
 s_waitcnt lgkmcnt(5)
 v_smfmac_f32_16x16x64_bf16 v[8:11], v[24:27], v[184:191], v0
 v_smfmac_f32_16x16x64_bf16 v[12:15], v[24:27], v[176:183], v0
 s_waitcnt lgkmcnt(3)
 v_smfmac_f32_16x16x64_bf16 v[16:19], v[24:27], v[32:39], v0
 ds_read_b128 v[32:35], v1 offset:51200
 ds_read_b128 v[36:39], v1 offset:52224
 s_waitcnt vmcnt(2)
 v_smfmac_f32_16x16x64_bf16 v[20:23], v[24:27], v[56:63], v0
 s_add_u32 s3, s61, 4096
 buffer_load_dwordx4 v[56:59], v1, s[4:7], s61 offen offset:2048 sc1
 buffer_load_dwordx4 v[60:63], v1, s[4:7], s3 offen offset:2048 sc1
 ds_read_b128 v[24:27], v1 offset:7168
 s_waitcnt lgkmcnt(3)
 v_smfmac_f32_16x16x64_bf16 v[8:11], v[28:31], a[136:143], v0
 v_smfmac_f32_16x16x64_bf16 v[16:19], v[28:31], v[40:47], v0
 ds_read_b128 v[40:43], v1 offset:49152
 ds_read_b128 v[44:47], v1 offset:50176
 v_smfmac_f32_16x16x64_bf16 v[12:15], v[28:31], a[128:135], v0
 v_smfmac_f32_16x16x64_bf16 v[20:23], v[28:31], v[192:199], v0
 ds_read_b128 v[28:31], v1 offset:9216
 s_waitcnt lgkmcnt(3)
 v_smfmac_f32_16x16x64_bf16 v[16:19], v[24:27], v[32:39], v0
 s_add_u32 s3, s61, 67112960
 buffer_load_dwordx4 v[32:35], v1, s[4:7], s3 offen offset:0 sc1
 buffer_load_dwordx4 v[36:39], v1, s[4:7], s3 offen offset:1024 sc1
 v_lshlrev_b32 v7, 3, v1
 s_add_u32 s3, s61, 67633152
 buffer_load_dword v7, v7, s[4:7], s3 offen sc1
 v_smfmac_f32_16x16x64_bf16 v[8:11], v[24:27], a[112:119], v0
 v_smfmac_f32_16x16x64_bf16 v[12:15], v[24:27], a[88:95], v0
 s_waitcnt lgkmcnt(1)
 v_smfmac_f32_16x16x64_bf16 v[20:23], v[24:27], v[40:47], v0
 ds_read_b128 v[40:43], v3 offset:49152
 ds_read_b128 v[44:47], v3 offset:49152
 s_waitcnt lgkmcnt(2)
 v_smfmac_f32_16x16x64_bf16 v[8:11], v[28:31], a[32:39], v0
 v_smfmac_f32_16x16x64_bf16 v[12:15], v[28:31], a[24:31], v0
 v_smfmac_f32_16x16x64_bf16 v[16:19], v[28:31], v[232:239], v0
 s_waitcnt vmcnt(5)
 v_smfmac_f32_16x16x64_bf16 v[20:23], v[28:31], v[48:55], v0
 ds_read_b128 v[52:55], v1 offset:0
 v_add_f32 v8, v8, v10
 v_add_f32 v9, v9, v11
 v_cvt_pk_bf16_f32 v8, v8, v9
 v_add_f32 v12, v12, v14
 v_add_f32 v13, v13, v15
 v_cvt_pk_bf16_f32 v12, v12, v13
 ds_write2_b32 v4, v8, v8 offset0:0 offset1:1
 ds_write2_b32 v4, v12, v12 offset0:128 offset1:129
 ds_read_b64_tr_b16 v[12:13], v5 offset:12288
 ds_read_b64_tr_b16 v[14:15], v5 offset:12800
 v_add_f32 v16, v16, v18
 v_add_f32 v17, v17, v19
 v_cvt_pk_bf16_f32 v16, v16, v17
 v_add_f32 v20, v20, v22
 v_add_f32 v21, v21, v23
 v_cvt_pk_bf16_f32 v20, v20, v21
 ds_write2_b32 v4, v16, v20 offset0:0 offset1:128
 ds_read_b64_tr_b16 v[20:21], v5 offset:12288
 ds_read_b64_tr_b16 v[22:23], v5 offset:12800
 s_waitcnt lgkmcnt(9)
 v_smfmac_f32_16x16x64_bf16 v[40:43], v[24:27], v[80:87], v0
 s_waitcnt lgkmcnt(8)
 v_smfmac_f32_16x16x64_bf16 v[44:47], v[24:27], v[88:95], v0
 ds_read_b128 v[24:27], v1 offset:1024
 v_smfmac_f32_16x16x64_bf16 v[40:43], v[28:31], v[112:119], v0
 v_smfmac_f32_16x16x64_bf16 v[44:47], v[28:31], v[120:127], v0
 ds_read_b128 v[28:31], v1 offset:2048
 s_waitcnt vmcnt(4) lgkmcnt(5)
 v_mfma_f32_16x16x32_bf16 v[8:11], v[56:59], v[12:15], 0
 s_waitcnt vmcnt(3) lgkmcnt(4)
 v_mfma_f32_16x16x32_bf16 v[16:19], v[60:63], v[12:15], 0
 s_waitcnt lgkmcnt(2)
 v_mfma_f32_16x16x32_bf16 v[48:51], v[20:23], v[12:15], 0
 v_smfmac_f32_16x16x64_bf16 v[40:43], v[52:55], a[160:167], v0
 v_smfmac_f32_16x16x64_bf16 v[44:47], v[52:55], a[168:175], v0
 ds_read_b128 v[52:55], v1 offset:3072
 s_waitcnt lgkmcnt(2)
 v_smfmac_f32_16x16x64_bf16 v[40:43], v[24:27], a[176:183], v0
 v_cndmask_b32 v8, v8, v16, s[70:71]
 v_cndmask_b32 v9, v9, v17, s[70:71]
 v_cndmask_b32 v10, v10, v18, s[70:71]
 v_cndmask_b32 v11, v11, v19, s[70:71]
 ds_write_b128 v1, v[8:11] offset:12288
 ds_write_b64 v1, v[48:49] offset:15360
 v_smfmac_f32_16x16x64_bf16 v[44:47], v[24:27], a[184:191], v0
 ds_read_b128 v[24:27], v1 offset:4096
 s_waitcnt lgkmcnt(4)
 v_smfmac_f32_16x16x64_bf16 v[40:43], v[28:31], a[192:199], v0
 v_smfmac_f32_16x16x64_bf16 v[44:47], v[28:31], a[200:207], v0
 ds_read_b128 v[28:31], v1 offset:5120
 s_waitcnt lgkmcnt(4)
 v_smfmac_f32_16x16x64_bf16 v[40:43], v[52:55], a[208:215], v0
 v_smfmac_f32_16x16x64_bf16 v[44:47], v[52:55], a[216:223], v0
 ds_read_b128 v[52:55], v1 offset:6144
 s_waitcnt lgkmcnt(2)
 v_smfmac_f32_16x16x64_bf16 v[40:43], v[24:27], a[224:231], v0
 s_barrier
 ds_read_b128 v[56:59], v1 offset:10240
 ds_read_b128 v[60:63], v1 offset:11264
 ds_read_b128 v[16:19], v1 offset:13312
 ds_read_b128 v[12:15], v1 offset:14336
 ds_read_b128 v[48:51], v1 offset:15360
 v_smfmac_f32_16x16x64_bf16 v[44:47], v[24:27], a[232:239], v0
 ds_read_b128 v[24:27], v1 offset:8192
 s_mov_b64 exec, s[68:69]
 buffer_store_dwordx4 v[20:23], v6, s[4:7], s62 offen offset:1024 sc1
 s_mov_b64 exec, -1
 s_waitcnt lgkmcnt(7)
 v_smfmac_f32_16x16x64_bf16 v[40:43], v[28:31], a[240:247], v0
 v_smfmac_f32_16x16x64_bf16 v[44:47], v[28:31], a[248:255], v0
 s_waitcnt lgkmcnt(6)
 v_smfmac_f32_16x16x64_bf16 v[40:43], v[52:55], v[64:71], v0
 v_smfmac_f32_16x16x64_bf16 v[44:47], v[52:55], v[72:79], v0
 s_waitcnt lgkmcnt(0)
 v_smfmac_f32_16x16x64_bf16 v[40:43], v[24:27], v[96:103], v0
 v_smfmac_f32_16x16x64_bf16 v[44:47], v[24:27], v[104:111], v0
 v_pk_add_f32 v[8:9], v[8:9], v[56:57]
 v_pk_add_f32 v[10:11], v[10:11], v[58:59]
 v_pk_add_f32 v[60:61], v[60:61], v[16:17]
 v_pk_add_f32 v[62:63], v[62:63], v[18:19]
 v_pk_add_f32 v[12:13], v[12:13], v[14:15]
 v_pk_add_f32 v[48:49], v[48:49], v[50:51]
 v_pk_add_f32 v[8:9], v[8:9], v[60:61]
 v_pk_add_f32 v[10:11], v[10:11], v[62:63]
 v_pk_add_f32 v[48:49], v[12:13], v[48:49]
 v_max3_f32 v50, v8, v9, v10
 v_max3_f32 v50, v50, v11, v48
 v_max_f32 v50, v50, v49
 v_add_f32 v40, v40, v42
 v_add_f32 v41, v41, v43
 v_max_f32_dpp v50, v50, v50 quad_perm:[2,3,0,1] row_mask:0xf bank_mask:0xf
 v_mov_b32 v51, v50
 v_add_f32 v44, v44, v46
 v_add_f32 v45, v45, v47
 v_permlane16_swap_b32 v50, v51
 v_max_f32 v50, v50, v51
 v_mov_b32 v51, v50
 v_cvt_pk_bf16_f32 v40, v40, v41
 v_cvt_pk_bf16_f32 v41, v44, v45
 v_permlane32_swap_b32 v50, v51
 v_max_f32 v50, v50, v51
 v_mul_f32 v50, s56, v50
 v_fma_f32 v48, v48, s56, -v50
 v_fma_f32 v49, v49, s56, -v50
 v_fma_f32 v8, v8, s56, -v50
 v_fma_f32 v9, v9, s56, -v50
 v_fma_f32 v10, v10, s56, -v50
 v_fma_f32 v11, v11, s56, -v50
 v_exp_f32 v48, v48
 v_exp_f32 v49, v49
 ds_read_b128 v[56:59], v3 offset:32768
 ds_read_b128 v[60:63], v3 offset:33792
 v_exp_f32 v8, v8
 v_exp_f32 v9, v9
 ds_read_b128 v[24:27], v3 offset:4096
 ds_read_b128 v[28:31], v3 offset:5120
 v_exp_f32 v10, v10
 buffer_store_dwordx2 v[40:41], v5, s[4:7], s62 offen offset:3072 sc1
 v_exp_f32 v11, v11
 v_cvt_pk_bf16_f32 v14, v48, v49
 v_cvt_pk_bf16_f32 v12, v8, v9
 v_cvt_pk_bf16_f32 v13, v10, v11
 v_cndmask_b32 v52, 0, v14, s[68:69]
 v_cndmask_b32 v53, 0, v14, s[70:71]
 v_cndmask_b32 v22, 0, v12, s[70:71]
 v_cndmask_b32 v23, 0, v13, s[70:71]
 v_mfma_f32_16x16x16_bf16 v[44:47], v[40:41], v[52:53], 0
 v_cndmask_b32 v16, 0, v12, s[68:69]
 v_cndmask_b32 v17, 0, v13, s[68:69]
 v_mov_b32_dpp v18, v22 quad_perm:[2,3,0,1] row_mask:0xf bank_mask:0xf
 v_mov_b32_dpp v19, v23 quad_perm:[2,3,0,1] row_mask:0xf bank_mask:0xf
 v_mov_b32_dpp v20, v16 quad_perm:[2,3,0,1] row_mask:0xf bank_mask:0xf
 v_mov_b32_dpp v21, v17 quad_perm:[2,3,0,1] row_mask:0xf bank_mask:0xf
 s_waitcnt vmcnt(4)
 v_mfma_f32_16x16x32_bf16 v[44:47], v[32:35], v[16:19], v[44:47]
 v_add_f32 v54, v8, v9
 v_add_f32 v55, v48, v49
 s_waitcnt vmcnt(3)
 v_mfma_f32_16x16x32_bf16 v[44:47], v[36:39], v[20:23], v[44:47]
 v_add_f32 v54, v54, v10
 v_fma_f32 v55, v55, 0.5, v11
 v_add_f32 v54, v54, v55
 ds_read_b128 v[16:19], v3 offset:49152
 ds_read_b128 v[20:23], v3 offset:49152
 v_add_f32_dpp v54, v54, v54 quad_perm:[2,3,0,1] row_mask:0xf bank_mask:0xf
 v_mov_b32 v55, v54
 ds_read_b128 v[32:35], v3 offset:49152
 ds_read_b128 v[36:39], v3 offset:49152
 v_permlane16_swap_b32 v54, v55
 v_add_f32 v54, v54, v55
 v_mov_b32 v55, v54
 ds_read_b128 v[8:11], v3 offset:49152
 s_cmp_eq_u32 s54, 63
 v_permlane32_swap_b32 v54, v55
 v_add_f32 v54, v54, v55
 v_rcp_f32 v54, v54
 s_cbranch_scc1 L_ch2_end
 v_mul_f32 v44, v44, v54
 v_mul_f32 v45, v45, v54
 v_cvt_pk_bf16_f32 v42, v44, v45
 v_mul_f32 v46, v46, v54
 v_mul_f32 v47, v47, v54
 v_cvt_pk_bf16_f32 v43, v46, v47
 ds_write_b64 v6, v[42:43] offset:1024
 v_and_b32 v40, -9, v6
 v_mov_b32_dpp v12, v42 quad_perm:[0,1,0,1] row_mask:0xf bank_mask:0xf
 v_mov_b32_dpp v14, v42 quad_perm:[2,3,2,3] row_mask:0xf bank_mask:0xf
 v_mov_b32_dpp v13, v43 quad_perm:[0,1,0,1] row_mask:0xf bank_mask:0xf
 v_mov_b32_dpp v15, v43 quad_perm:[2,3,2,3] row_mask:0xf bank_mask:0xf
 s_waitcnt lgkmcnt(5)
 s_nop 0
 v_smfmac_f32_16x16x64_bf16 v[16:19], v[12:15], a[16:23], v0
 s_waitcnt lgkmcnt(4)
 v_smfmac_f32_16x16x64_bf16 v[20:23], v[12:15], a[48:55], v0
 s_waitcnt lgkmcnt(0)
 s_barrier
 ds_read_b128 v[48:51], v40 offset:0
 ds_read_b128 v[52:55], v40 offset:512
 ds_read_b128 v[44:47], v40 offset:1536
 v_smfmac_f32_16x16x64_bf16 v[32:35], v[12:15], v[56:63], v0
 ds_read_b128 v[56:59], v3 offset:38912
 ds_read_b128 v[60:63], v3 offset:39936
 v_smfmac_f32_16x16x64_bf16 v[36:39], v[12:15], v[24:31], v0
 ds_read_b128 v[24:27], v3 offset:36864
 ds_read_b128 v[28:31], v3 offset:37888
 v_smfmac_f32_16x16x64_bf16 v[8:11], v[12:15], a[144:151], v0
 s_waitcnt lgkmcnt(6)
 v_smfmac_f32_16x16x64_bf16 v[16:19], v[48:51], a[0:7], v0
 s_waitcnt lgkmcnt(5)
 v_smfmac_f32_16x16x64_bf16 v[16:19], v[52:55], a[8:15], v0
 s_waitcnt lgkmcnt(2)
 v_smfmac_f32_16x16x64_bf16 v[16:19], v[44:47], v[56:63], v0
 ds_read_b128 v[56:59], v3 offset:34816
 ds_read_b128 v[60:63], v3 offset:35840
 s_waitcnt lgkmcnt(2)
 v_smfmac_f32_16x16x64_bf16 v[20:23], v[48:51], v[24:31], v0
 ds_read_b128 v[24:27], v3 offset:6144
 ds_read_b128 v[28:31], v3 offset:7168
 v_smfmac_f32_16x16x64_bf16 v[20:23], v[52:55], a[40:47], v0
 v_smfmac_f32_16x16x64_bf16 v[20:23], v[44:47], a[56:63], v0
 v_cvt_pk_bf16_f32 v16, v16, v17
 v_smfmac_f32_16x16x64_bf16 v[32:35], v[48:51], a[64:71], v0
 v_cvt_pk_bf16_f32 v17, v18, v19
 s_waitcnt lgkmcnt(2)
 v_smfmac_f32_16x16x64_bf16 v[32:35], v[52:55], v[56:63], v0
 ds_read_b128 v[56:59], v3 offset:2048
 ds_read_b128 v[60:63], v3 offset:3072
 v_and_or_b32 v16, v16, -2, s55
 s_waitcnt lgkmcnt(2)
 v_smfmac_f32_16x16x64_bf16 v[32:35], v[44:47], v[24:31], v0
 ds_read_b128 v[24:27], v3 offset:0
 ds_read_b128 v[28:31], v3 offset:1024
 v_cvt_pk_bf16_f32 v18, v20, v21
 v_smfmac_f32_16x16x64_bf16 v[36:39], v[48:51], a[96:103], v0
 v_cvt_pk_bf16_f32 v19, v22, v23
 v_smfmac_f32_16x16x64_bf16 v[36:39], v[52:55], a[104:111], v0
 v_and_or_b32 v18, v18, -2, s55
 buffer_store_dwordx4 v[16:19], v1, s[4:7], s60 offen offset:0
 v_smfmac_f32_16x16x64_bf16 v[36:39], v[44:47], a[120:127], v0
 v_cvt_pk_bf16_f32 v32, v32, v33
 s_waitcnt lgkmcnt(2)
 v_smfmac_f32_16x16x64_bf16 v[8:11], v[48:51], v[56:63], v0
 v_cvt_pk_bf16_f32 v33, v34, v35
 s_waitcnt lgkmcnt(0)
 v_smfmac_f32_16x16x64_bf16 v[8:11], v[52:55], v[24:31], v0
 v_and_or_b32 v32, v32, -2, s55
 v_smfmac_f32_16x16x64_bf16 v[8:11], v[44:47], a[152:159], v0
 v_cvt_pk_bf16_f32 v34, v36, v37
 v_cvt_pk_bf16_f32 v35, v38, v39
 v_and_or_b32 v34, v34, -2, s55
 buffer_store_dwordx4 v[32:35], v1, s[4:7], s60 offen offset:1024
 s_add_u32 s3, s60, 5120
 s_nop 2
 v_cvt_pk_bf16_f32 v8, v8, v9
 v_cvt_pk_bf16_f32 v9, v10, v11
 v_and_or_b32 v8, v8, -2, s55
 buffer_store_dwordx2 v[8:9], v1, s[4:7], s3 offen offset:0
 buffer_load_dwordx4 v[32:35], v1, s[4:7], s63 offen offset:2048
 buffer_load_dwordx4 v[36:39], v1, s[4:7], s63 offen offset:3072
 s_add_u32 s54, s54, 1
 s_add_u32 s61, s61, 524288
 s_and_b32 s3, s54, 7
 s_cselect_b32 s3, 1, -7
 s_lshl_b32 s3, s3, 17
 s_add_u32 s62, s62, s3
 s_and_b32 s3, s54, 3
 s_cselect_b32 s3, 1, -3
 s_lshl_b32 s3, s3, 14
 s_add_u32 s58, s57, s3
 s_add_u32 s59, s59, s3
 v_lshrrev_b32 v56, 6, v1
 v_mul_u32_u24 v56, 10240, v56
 v_and_b32 v60, 48, v1
 v_add_u32 v56, v56, v60
 v_and_b32 v57, 32, v1
 v_and_b32 v60, 64, v1
 v_lshl_add_u32 v57, v60, 2, v57
 v_bfe_u32 v60, v1, 8, 1
 v_lshl_add_u32 v57, v60, 4, v57
 v_and_b32 v60, 8, v5
 v_add_u32 v57, v57, v60
 v_mov_b32 v60, 0x3f80
 v_mov_b32 v28, 0x3f800000
 v_cndmask_b32 v60, v60, v28, s[82:83]
 v_cndmask_b32 v28, 0, v60, s[72:73]
 v_cndmask_b32 v29, 0, v60, s[74:75]
 v_cndmask_b32 v30, 0, v60, s[76:77]
 v_cndmask_b32 v31, 0, v60, s[78:79]
 v_mov_b64 v[58:59], -1
 s_nop 15
 s_nop 15
 s_nop 15
 s_nop 1
 s_mov_b32 s51, 0
L_pp_195:
 buffer_load_dwordx4 v[8:11], v56, s[4:7], s64 offen sc1
 buffer_load_dwordx4 v[12:15], v56, s[4:7], s65 offen sc1
 s_waitcnt vmcnt(1)
 v_mfma_f32_16x16x32_bf16 v[24:27], v[28:31], v[8:11], 0
 v_bitop3_b32 v60, v8, v10, s55 bitop3:0x7e
 s_waitcnt vmcnt(0)
 v_mfma_f32_16x16x32_bf16 v[24:27], v[28:31], v[12:15], v[24:27]
 v_bitop3_b32 v61, v12, v14, s55 bitop3:0x7e
 v_bitop3_b32 v7, v60, v61, 1 bitop3:0xa8
 v_cmp_ne_u32 vcc, 0, v7
 s_cbranch_vccnz L_rt_196
 s_nop 3
 v_add_f32_dpp v24, v24, v24 row_ror:8 row_mask:0xf bank_mask:0xf
 v_add_f32_dpp v25, v25, v25 row_ror:8 row_mask:0xf bank_mask:0xf
 v_add_f32_dpp v26, v26, v26 row_ror:8 row_mask:0xf bank_mask:0xf
 v_add_f32_dpp v27, v27, v27 row_ror:8 row_mask:0xf bank_mask:0xf
 v_add_f32_dpp v24, v24, v24 row_ror:4 row_mask:0xf bank_mask:0xf
 v_add_f32_dpp v25, v25, v25 row_ror:4 row_mask:0xf bank_mask:0xf
 v_add_f32_dpp v26, v26, v26 row_ror:4 row_mask:0xf bank_mask:0xf
 v_add_f32_dpp v27, v27, v27 row_ror:4 row_mask:0xf bank_mask:0xf
 s_mov_b64 exec, s[84:85]
 v_cvt_pk_bf16_f32 v24, v24, v25
 v_cvt_pk_bf16_f32 v25, v26, v27
 buffer_store_dwordx2 v[24:25], v57, s[4:7], s58 offen
 buffer_store_dwordx2 v[58:59], v57, s[4:7], s57 offen
 s_mov_b64 exec, -1
 s_mov_b32 s57, s58
 s_xor_b32 s55, s55, 1
 s_add_u32 s3, s63, 4096
 buffer_load_dwordx4 v[40:43], v1, s[4:7], s3 offen offset:0
 buffer_load_dwordx4 v[44:47], v1, s[4:7], s3 offen offset:1024
 s_add_u32 s3, s63, 4096
 buffer_load_dwordx4 v[48:51], v1, s[4:7], s3 offen offset:2048
 buffer_load_dwordx4 v[52:55], v1, s[4:7], s3 offen offset:3072
 s_add_u32 s3, s63, 8192
 buffer_load_dwordx4 v[56:59], v1, s[4:7], s3 offen offset:0
 buffer_load_dwordx4 v[60:63], v1, s[4:7], s3 offen offset:1024
 ds_read_b128 v[8:11], v3 offset:49152
 ds_read_b128 v[16:19], v3 offset:49152
 ds_read_b128 v[20:23], v3 offset:49152
 s_waitcnt lgkmcnt(0)
 s_nop 15
 s_nop 15
 s_nop 7
 s_branch L_ch2_f
L_rt_194:
 s_waitcnt lgkmcnt(0)
 s_add_u32 s51, s51, 1
 s_cmp_lt_u32 s51, 131072
 s_cbranch_scc1 L_pm_193
 s_branch L_bail
L_rt_196:
 s_add_u32 s51, s51, 1
 s_cmp_lt_u32 s51, 131072
 s_cbranch_scc1 L_pp_195
 s_branch L_bail
.p2align 6
L_ch2_s:
 s_mov_b32 s51, 0
L_pm_197:
 buffer_load_dwordx4 v[24:27], v1, s[4:7], s59 offen offset:0 sc1
 buffer_load_dwordx4 v[28:31], v1, s[4:7], s59 offen offset:1024 sc1
 s_add_u32 s3, s59, 4096
 buffer_load_dwordx4 v[12:15], v1, s[4:7], s3 offen offset:0 sc1
 s_waitcnt vmcnt(2)
 ds_write_b128 v1, v[24:27] offset:4096
 v_max_u32 v7, v24, v26
 s_waitcnt vmcnt(1)
 ds_write_b128 v1, v[28:31] offset:5120
 v_max3_u32 v7, v7, v28, v30
 s_waitcnt vmcnt(0)
 ds_write_b128 v1, v[12:15] offset:8192
 v_max3_u32 v7, v7, v12, v14
 v_cmp_eq_u32 vcc, -1, v7
 s_cbranch_vccnz L_rt_198
 ds_read_b128 v[12:15], v3 offset:49152
 v_smfmac_f32_16x16x64_bf16 v[16:19], v[24:27], v[32:39], v0
 ds_read_b128 v[32:35], v1 offset:26624
 ds_read_b128 v[36:39], v1 offset:27648
 v_smfmac_f32_16x16x64_bf16 v[20:23], v[24:27], v[40:47], v0
 ds_read_b128 v[40:43], v1 offset:24576
 ds_read_b128 v[44:47], v1 offset:25600
 v_smfmac_f32_16x16x64_bf16 v[16:19], v[28:31], v[48:55], v0
 v_smfmac_f32_16x16x64_bf16 v[20:23], v[28:31], v[56:63], v0
 s_waitcnt lgkmcnt(5)
 s_barrier
 buffer_load_dwordx4 v[56:59], v1, s[4:7], s63 offen offset:0
 buffer_load_dwordx4 v[60:63], v1, s[4:7], s63 offen offset:1024
 s_add_u32 s3, s63, 8192
 buffer_load_dwordx4 v[48:51], v1, s[4:7], s3 offen offset:2048
 buffer_load_dwordx4 v[52:55], v1, s[4:7], s3 offen offset:3072
 v_smfmac_f32_16x16x64_bf16 v[8:11], v[24:27], v[168:175], v0
 v_smfmac_f32_16x16x64_bf16 v[8:11], v[28:31], v[144:151], v0
 s_waitcnt lgkmcnt(4)
 v_smfmac_f32_16x16x64_bf16 v[12:15], v[24:27], v[160:167], v0
 ds_read_b128 v[24:27], v1 offset:8192
 v_smfmac_f32_16x16x64_bf16 v[12:15], v[28:31], v[128:135], v0
 ds_read_b128 v[28:31], v1 offset:0
 s_waitcnt lgkmcnt(1)
 v_smfmac_f32_16x16x64_bf16 v[16:19], v[24:27], v[32:39], v0
 ds_read_b128 v[32:35], v2 offset:22528
 ds_read_b128 v[36:39], v2 offset:23552
 v_smfmac_f32_16x16x64_bf16 v[8:11], v[24:27], a[80:87], v0
 v_smfmac_f32_16x16x64_bf16 v[12:15], v[24:27], a[72:79], v0
 v_smfmac_f32_16x16x64_bf16 v[20:23], v[24:27], v[40:47], v0
 ds_read_b128 v[40:43], v2 offset:20480
 ds_read_b128 v[44:47], v2 offset:21504
 ds_read_b128 v[24:27], v1 offset:1024
 s_waitcnt lgkmcnt(5)
 v_smfmac_f32_16x16x64_bf16 v[8:11], v[28:31], v[240:247], v0
 v_smfmac_f32_16x16x64_bf16 v[12:15], v[28:31], v[248:255], v0
 s_waitcnt lgkmcnt(3)
 v_smfmac_f32_16x16x64_bf16 v[16:19], v[28:31], v[32:39], v0
 ds_read_b128 v[32:35], v2 offset:18432
 ds_read_b128 v[36:39], v2 offset:19456
 v_smfmac_f32_16x16x64_bf16 v[20:23], v[28:31], v[136:143], v0
 ds_read_b128 v[28:31], v1 offset:2048
 s_waitcnt lgkmcnt(3)
 v_smfmac_f32_16x16x64_bf16 v[8:11], v[24:27], v[224:231], v0
 v_smfmac_f32_16x16x64_bf16 v[16:19], v[24:27], v[40:47], v0
 ds_read_b128 v[40:43], v2 offset:16384
 ds_read_b128 v[44:47], v2 offset:17408
 v_smfmac_f32_16x16x64_bf16 v[12:15], v[24:27], v[216:223], v0
 v_smfmac_f32_16x16x64_bf16 v[20:23], v[24:27], v[152:159], v0
 ds_read_b128 v[24:27], v1 offset:3072
 s_waitcnt lgkmcnt(3)
 v_smfmac_f32_16x16x64_bf16 v[16:19], v[28:31], v[32:39], v0
 ds_read_b128 v[32:35], v1 offset:55296
 ds_read_b128 v[36:39], v1 offset:56320
 v_smfmac_f32_16x16x64_bf16 v[8:11], v[28:31], v[208:215], v0
 v_smfmac_f32_16x16x64_bf16 v[12:15], v[28:31], v[200:207], v0
 s_waitcnt lgkmcnt(3)
 v_smfmac_f32_16x16x64_bf16 v[20:23], v[28:31], v[40:47], v0
 ds_read_b128 v[40:43], v1 offset:53248
 ds_read_b128 v[44:47], v1 offset:54272
 ds_read_b128 v[28:31], v1 offset:6144
 s_waitcnt lgkmcnt(5)
 v_smfmac_f32_16x16x64_bf16 v[8:11], v[24:27], v[184:191], v0
 v_smfmac_f32_16x16x64_bf16 v[12:15], v[24:27], v[176:183], v0
 s_waitcnt lgkmcnt(3)
 v_smfmac_f32_16x16x64_bf16 v[16:19], v[24:27], v[32:39], v0
 ds_read_b128 v[32:35], v1 offset:51200
 ds_read_b128 v[36:39], v1 offset:52224
 s_waitcnt vmcnt(2)
 v_smfmac_f32_16x16x64_bf16 v[20:23], v[24:27], v[56:63], v0
 s_add_u32 s3, s61, 4096
 buffer_load_dwordx4 v[56:59], v1, s[4:7], s61 offen offset:2048 sc1
 buffer_load_dwordx4 v[60:63], v1, s[4:7], s3 offen offset:2048 sc1
 ds_read_b128 v[24:27], v1 offset:7168
 s_waitcnt lgkmcnt(3)
 v_smfmac_f32_16x16x64_bf16 v[8:11], v[28:31], a[136:143], v0
 v_smfmac_f32_16x16x64_bf16 v[16:19], v[28:31], v[40:47], v0
 ds_read_b128 v[40:43], v1 offset:49152
 ds_read_b128 v[44:47], v1 offset:50176
 v_smfmac_f32_16x16x64_bf16 v[12:15], v[28:31], a[128:135], v0
 v_smfmac_f32_16x16x64_bf16 v[20:23], v[28:31], v[192:199], v0
 ds_read_b128 v[28:31], v1 offset:9216
 s_waitcnt lgkmcnt(3)
 v_smfmac_f32_16x16x64_bf16 v[16:19], v[24:27], v[32:39], v0
 s_add_u32 s3, s61, 67112960
 buffer_load_dwordx4 v[32:35], v1, s[4:7], s3 offen offset:0 sc1
 buffer_load_dwordx4 v[36:39], v1, s[4:7], s3 offen offset:1024 sc1
 v_lshlrev_b32 v7, 3, v1
 s_add_u32 s3, s61, 67633152
 buffer_load_dword v7, v7, s[4:7], s3 offen sc1
 v_smfmac_f32_16x16x64_bf16 v[8:11], v[24:27], a[112:119], v0
 v_smfmac_f32_16x16x64_bf16 v[12:15], v[24:27], a[88:95], v0
 s_waitcnt lgkmcnt(1)
 v_smfmac_f32_16x16x64_bf16 v[20:23], v[24:27], v[40:47], v0
 ds_read_b128 v[40:43], v3 offset:49152
 ds_read_b128 v[44:47], v3 offset:49152
 s_waitcnt lgkmcnt(2)
 v_smfmac_f32_16x16x64_bf16 v[8:11], v[28:31], a[32:39], v0
 v_smfmac_f32_16x16x64_bf16 v[12:15], v[28:31], a[24:31], v0
 v_smfmac_f32_16x16x64_bf16 v[16:19], v[28:31], v[232:239], v0
 s_waitcnt vmcnt(5)
 v_smfmac_f32_16x16x64_bf16 v[20:23], v[28:31], v[48:55], v0
 ds_read_b128 v[52:55], v1 offset:0
 v_add_f32 v8, v8, v10
 v_add_f32 v9, v9, v11
 v_cvt_pk_bf16_f32 v8, v8, v9
 v_add_f32 v12, v12, v14
 v_add_f32 v13, v13, v15
 v_cvt_pk_bf16_f32 v12, v12, v13
 ds_write2_b32 v4, v8, v8 offset0:0 offset1:1
 ds_write2_b32 v4, v12, v12 offset0:128 offset1:129
 ds_read_b64_tr_b16 v[12:13], v5 offset:12288
 ds_read_b64_tr_b16 v[14:15], v5 offset:12800
 v_add_f32 v16, v16, v18
 v_add_f32 v17, v17, v19
 v_cvt_pk_bf16_f32 v16, v16, v17
 v_add_f32 v20, v20, v22
 v_add_f32 v21, v21, v23
 v_cvt_pk_bf16_f32 v20, v20, v21
 ds_write2_b32 v4, v16, v20 offset0:0 offset1:128
 ds_read_b64_tr_b16 v[20:21], v5 offset:12288
 ds_read_b64_tr_b16 v[22:23], v5 offset:12800
 s_waitcnt lgkmcnt(9)
 v_smfmac_f32_16x16x64_bf16 v[40:43], v[24:27], v[80:87], v0
 s_waitcnt lgkmcnt(8)
 v_smfmac_f32_16x16x64_bf16 v[44:47], v[24:27], v[88:95], v0
 ds_read_b128 v[24:27], v1 offset:1024
 v_smfmac_f32_16x16x64_bf16 v[40:43], v[28:31], v[112:119], v0
 v_smfmac_f32_16x16x64_bf16 v[44:47], v[28:31], v[120:127], v0
 ds_read_b128 v[28:31], v1 offset:2048
 s_waitcnt vmcnt(4) lgkmcnt(5)
 v_mfma_f32_16x16x32_bf16 v[8:11], v[56:59], v[12:15], 0
 s_waitcnt vmcnt(3) lgkmcnt(4)
 v_mfma_f32_16x16x32_bf16 v[16:19], v[60:63], v[12:15], 0
 s_waitcnt lgkmcnt(2)
 v_mfma_f32_16x16x32_bf16 v[48:51], v[20:23], v[12:15], 0
 v_smfmac_f32_16x16x64_bf16 v[40:43], v[52:55], a[160:167], v0
 v_smfmac_f32_16x16x64_bf16 v[44:47], v[52:55], a[168:175], v0
 ds_read_b128 v[52:55], v1 offset:3072
 s_waitcnt lgkmcnt(2)
 v_smfmac_f32_16x16x64_bf16 v[40:43], v[24:27], a[176:183], v0
 v_cndmask_b32 v8, v8, v16, s[70:71]
 v_cndmask_b32 v9, v9, v17, s[70:71]
 v_cndmask_b32 v10, v10, v18, s[70:71]
 v_cndmask_b32 v11, v11, v19, s[70:71]
 ds_write_b128 v1, v[8:11] offset:12288
 ds_write_b64 v1, v[48:49] offset:15360
 v_smfmac_f32_16x16x64_bf16 v[44:47], v[24:27], a[184:191], v0
 ds_read_b128 v[24:27], v1 offset:4096
 s_waitcnt lgkmcnt(4)
 v_smfmac_f32_16x16x64_bf16 v[40:43], v[28:31], a[192:199], v0
 v_smfmac_f32_16x16x64_bf16 v[44:47], v[28:31], a[200:207], v0
 ds_read_b128 v[28:31], v1 offset:5120
 s_waitcnt lgkmcnt(4)
 v_smfmac_f32_16x16x64_bf16 v[40:43], v[52:55], a[208:215], v0
 v_smfmac_f32_16x16x64_bf16 v[44:47], v[52:55], a[216:223], v0
 ds_read_b128 v[52:55], v1 offset:6144
 s_waitcnt lgkmcnt(2)
 v_smfmac_f32_16x16x64_bf16 v[40:43], v[24:27], a[224:231], v0
 s_barrier
 ds_read_b128 v[56:59], v1 offset:10240
 ds_read_b128 v[60:63], v1 offset:11264
 ds_read_b128 v[16:19], v1 offset:13312
 ds_read_b128 v[12:15], v1 offset:14336
 ds_read_b128 v[48:51], v1 offset:15360
 v_smfmac_f32_16x16x64_bf16 v[44:47], v[24:27], a[232:239], v0
 ds_read_b128 v[24:27], v1 offset:8192
 s_mov_b64 exec, s[68:69]
 buffer_store_dwordx4 v[20:23], v6, s[4:7], s62 offen offset:1024 sc1
 s_mov_b64 exec, -1
 s_waitcnt lgkmcnt(7)
 v_smfmac_f32_16x16x64_bf16 v[40:43], v[28:31], a[240:247], v0
 v_smfmac_f32_16x16x64_bf16 v[44:47], v[28:31], a[248:255], v0
 s_waitcnt lgkmcnt(6)
 v_smfmac_f32_16x16x64_bf16 v[40:43], v[52:55], v[64:71], v0
 v_smfmac_f32_16x16x64_bf16 v[44:47], v[52:55], v[72:79], v0
 s_waitcnt lgkmcnt(0)
 v_smfmac_f32_16x16x64_bf16 v[40:43], v[24:27], v[96:103], v0
 v_smfmac_f32_16x16x64_bf16 v[44:47], v[24:27], v[104:111], v0
 v_pk_add_f32 v[8:9], v[8:9], v[56:57]
 v_pk_add_f32 v[10:11], v[10:11], v[58:59]
 v_pk_add_f32 v[60:61], v[60:61], v[16:17]
 v_pk_add_f32 v[62:63], v[62:63], v[18:19]
 v_pk_add_f32 v[12:13], v[12:13], v[14:15]
 v_pk_add_f32 v[48:49], v[48:49], v[50:51]
 v_pk_add_f32 v[8:9], v[8:9], v[60:61]
 v_pk_add_f32 v[10:11], v[10:11], v[62:63]
 v_pk_add_f32 v[48:49], v[12:13], v[48:49]
 v_max3_f32 v50, v8, v9, v10
 v_max3_f32 v50, v50, v11, v48
 v_max_f32 v50, v50, v49
 v_add_f32 v40, v40, v42
 v_add_f32 v41, v41, v43
 v_max_f32_dpp v50, v50, v50 quad_perm:[2,3,0,1] row_mask:0xf bank_mask:0xf
 v_mov_b32 v51, v50
 v_add_f32 v44, v44, v46
 v_add_f32 v45, v45, v47
 v_permlane16_swap_b32 v50, v51
 v_max_f32 v50, v50, v51
 v_mov_b32 v51, v50
 v_cvt_pk_bf16_f32 v40, v40, v41
 v_cvt_pk_bf16_f32 v41, v44, v45
 v_permlane32_swap_b32 v50, v51
 v_max_f32 v50, v50, v51
 v_mul_f32 v50, s56, v50
 v_fma_f32 v48, v48, s56, -v50
 v_fma_f32 v49, v49, s56, -v50
 v_fma_f32 v8, v8, s56, -v50
 v_fma_f32 v9, v9, s56, -v50
 v_fma_f32 v10, v10, s56, -v50
 v_fma_f32 v11, v11, s56, -v50
 v_exp_f32 v48, v48
 v_exp_f32 v49, v49
 ds_read_b128 v[56:59], v3 offset:32768
 ds_read_b128 v[60:63], v3 offset:33792
 v_exp_f32 v8, v8
 v_exp_f32 v9, v9
 ds_read_b128 v[24:27], v3 offset:4096
 ds_read_b128 v[28:31], v3 offset:5120
 v_exp_f32 v10, v10
 buffer_store_dwordx2 v[40:41], v5, s[4:7], s62 offen offset:3072 sc1
 v_exp_f32 v11, v11
 v_cvt_pk_bf16_f32 v14, v48, v49
 v_cvt_pk_bf16_f32 v12, v8, v9
 v_cvt_pk_bf16_f32 v13, v10, v11
 v_cndmask_b32 v52, 0, v14, s[68:69]
 v_cndmask_b32 v53, 0, v14, s[70:71]
 v_cndmask_b32 v22, 0, v12, s[70:71]
 v_cndmask_b32 v23, 0, v13, s[70:71]
 v_mfma_f32_16x16x16_bf16 v[44:47], v[40:41], v[52:53], 0
 v_cndmask_b32 v16, 0, v12, s[68:69]
 v_cndmask_b32 v17, 0, v13, s[68:69]
 v_mov_b32_dpp v18, v22 quad_perm:[2,3,0,1] row_mask:0xf bank_mask:0xf
 v_mov_b32_dpp v19, v23 quad_perm:[2,3,0,1] row_mask:0xf bank_mask:0xf
 v_mov_b32_dpp v20, v16 quad_perm:[2,3,0,1] row_mask:0xf bank_mask:0xf
 v_mov_b32_dpp v21, v17 quad_perm:[2,3,0,1] row_mask:0xf bank_mask:0xf
 s_waitcnt vmcnt(4)
 v_mfma_f32_16x16x32_bf16 v[44:47], v[32:35], v[16:19], v[44:47]
 v_add_f32 v54, v8, v9
 v_add_f32 v55, v48, v49
 s_waitcnt vmcnt(3)
 v_mfma_f32_16x16x32_bf16 v[44:47], v[36:39], v[20:23], v[44:47]
 v_add_f32 v54, v54, v10
 v_fma_f32 v55, v55, 0.5, v11
 v_add_f32 v54, v54, v55
 ds_read_b128 v[16:19], v3 offset:49152
 ds_read_b128 v[20:23], v3 offset:49152
 v_add_f32_dpp v54, v54, v54 quad_perm:[2,3,0,1] row_mask:0xf bank_mask:0xf
 v_mov_b32 v55, v54
 ds_read_b128 v[32:35], v3 offset:49152
 ds_read_b128 v[36:39], v3 offset:49152
 v_permlane16_swap_b32 v54, v55
 v_add_f32 v54, v54, v55
 v_mov_b32 v55, v54
 ds_read_b128 v[8:11], v3 offset:49152
 s_cmp_eq_u32 s54, 63
 v_permlane32_swap_b32 v54, v55
 v_add_f32 v54, v54, v55
 v_rcp_f32 v54, v54
 s_cbranch_scc1 L_ch2_end
 v_mul_f32 v44, v44, v54
 v_mul_f32 v45, v45, v54
 v_cvt_pk_bf16_f32 v42, v44, v45
 v_mul_f32 v46, v46, v54
 v_mul_f32 v47, v47, v54
 v_cvt_pk_bf16_f32 v43, v46, v47
 ds_write_b64 v6, v[42:43] offset:1024
 v_and_b32 v40, -9, v6
 v_mov_b32_dpp v12, v42 quad_perm:[0,1,0,1] row_mask:0xf bank_mask:0xf
 v_mov_b32_dpp v14, v42 quad_perm:[2,3,2,3] row_mask:0xf bank_mask:0xf
 v_mov_b32_dpp v13, v43 quad_perm:[0,1,0,1] row_mask:0xf bank_mask:0xf
 v_mov_b32_dpp v15, v43 quad_perm:[2,3,2,3] row_mask:0xf bank_mask:0xf
 s_waitcnt lgkmcnt(5)
 s_nop 0
 v_smfmac_f32_16x16x64_bf16 v[16:19], v[12:15], a[16:23], v0
 s_waitcnt lgkmcnt(4)
 v_smfmac_f32_16x16x64_bf16 v[20:23], v[12:15], a[48:55], v0
 s_waitcnt lgkmcnt(0)
 s_barrier
 ds_read_b128 v[48:51], v40 offset:0
 ds_read_b128 v[52:55], v40 offset:512
 ds_read_b128 v[44:47], v40 offset:1536
 v_smfmac_f32_16x16x64_bf16 v[32:35], v[12:15], v[56:63], v0
 ds_read_b128 v[56:59], v3 offset:38912
 ds_read_b128 v[60:63], v3 offset:39936
 v_smfmac_f32_16x16x64_bf16 v[36:39], v[12:15], v[24:31], v0
 ds_read_b128 v[24:27], v3 offset:36864
 ds_read_b128 v[28:31], v3 offset:37888
 v_smfmac_f32_16x16x64_bf16 v[8:11], v[12:15], a[144:151], v0
 s_waitcnt lgkmcnt(6)
 v_smfmac_f32_16x16x64_bf16 v[16:19], v[48:51], a[0:7], v0
 s_waitcnt lgkmcnt(5)
 v_smfmac_f32_16x16x64_bf16 v[16:19], v[52:55], a[8:15], v0
 s_waitcnt lgkmcnt(2)
 v_smfmac_f32_16x16x64_bf16 v[16:19], v[44:47], v[56:63], v0
 ds_read_b128 v[56:59], v3 offset:34816
 ds_read_b128 v[60:63], v3 offset:35840
 s_waitcnt lgkmcnt(2)
 v_smfmac_f32_16x16x64_bf16 v[20:23], v[48:51], v[24:31], v0
 ds_read_b128 v[24:27], v3 offset:6144
 ds_read_b128 v[28:31], v3 offset:7168
 v_smfmac_f32_16x16x64_bf16 v[20:23], v[52:55], a[40:47], v0
 v_smfmac_f32_16x16x64_bf16 v[20:23], v[44:47], a[56:63], v0
 v_cvt_pk_bf16_f32 v16, v16, v17
 v_smfmac_f32_16x16x64_bf16 v[32:35], v[48:51], a[64:71], v0
 v_cvt_pk_bf16_f32 v17, v18, v19
 s_waitcnt lgkmcnt(2)
 v_smfmac_f32_16x16x64_bf16 v[32:35], v[52:55], v[56:63], v0
 ds_read_b128 v[56:59], v3 offset:2048
 ds_read_b128 v[60:63], v3 offset:3072
 v_and_or_b32 v16, v16, -2, s55
 s_waitcnt lgkmcnt(2)
 v_smfmac_f32_16x16x64_bf16 v[32:35], v[44:47], v[24:31], v0
 ds_read_b128 v[24:27], v3 offset:0
 ds_read_b128 v[28:31], v3 offset:1024
 v_cvt_pk_bf16_f32 v18, v20, v21
 v_smfmac_f32_16x16x64_bf16 v[36:39], v[48:51], a[96:103], v0
 v_cvt_pk_bf16_f32 v19, v22, v23
 v_smfmac_f32_16x16x64_bf16 v[36:39], v[52:55], a[104:111], v0
 v_and_or_b32 v18, v18, -2, s55
 buffer_store_dwordx4 v[16:19], v1, s[4:7], s60 offen offset:0 sc1
 v_smfmac_f32_16x16x64_bf16 v[36:39], v[44:47], a[120:127], v0
 v_cvt_pk_bf16_f32 v32, v32, v33
 s_waitcnt lgkmcnt(2)
 v_smfmac_f32_16x16x64_bf16 v[8:11], v[48:51], v[56:63], v0
 v_cvt_pk_bf16_f32 v33, v34, v35
 s_waitcnt lgkmcnt(0)
 v_smfmac_f32_16x16x64_bf16 v[8:11], v[52:55], v[24:31], v0
 v_and_or_b32 v32, v32, -2, s55
 v_smfmac_f32_16x16x64_bf16 v[8:11], v[44:47], a[152:159], v0
 v_cvt_pk_bf16_f32 v34, v36, v37
 v_cvt_pk_bf16_f32 v35, v38, v39
 v_and_or_b32 v34, v34, -2, s55
 buffer_store_dwordx4 v[32:35], v1, s[4:7], s60 offen offset:1024 sc1
 s_add_u32 s3, s60, 5120
 s_nop 2
 v_cvt_pk_bf16_f32 v8, v8, v9
 v_cvt_pk_bf16_f32 v9, v10, v11
 v_and_or_b32 v8, v8, -2, s55
 buffer_store_dwordx2 v[8:9], v1, s[4:7], s3 offen offset:0 sc1
 buffer_load_dwordx4 v[32:35], v1, s[4:7], s63 offen offset:2048
 buffer_load_dwordx4 v[36:39], v1, s[4:7], s63 offen offset:3072
 s_add_u32 s54, s54, 1
 s_add_u32 s61, s61, 524288
 s_and_b32 s3, s54, 7
 s_cselect_b32 s3, 1, -7
 s_lshl_b32 s3, s3, 17
 s_add_u32 s62, s62, s3
 s_and_b32 s3, s54, 3
 s_cselect_b32 s3, 1, -3
 s_lshl_b32 s3, s3, 14
 s_add_u32 s58, s57, s3
 s_add_u32 s59, s59, s3
 v_lshrrev_b32 v56, 6, v1
 v_mul_u32_u24 v56, 10240, v56
 v_and_b32 v60, 48, v1
 v_add_u32 v56, v56, v60
 v_and_b32 v57, 32, v1
 v_and_b32 v60, 64, v1
 v_lshl_add_u32 v57, v60, 2, v57
 v_bfe_u32 v60, v1, 8, 1
 v_lshl_add_u32 v57, v60, 4, v57
 v_and_b32 v60, 8, v5
 v_add_u32 v57, v57, v60
 v_mov_b32 v60, 0x3f80
 v_mov_b32 v28, 0x3f800000
 v_cndmask_b32 v60, v60, v28, s[82:83]
 v_cndmask_b32 v28, 0, v60, s[72:73]
 v_cndmask_b32 v29, 0, v60, s[74:75]
 v_cndmask_b32 v30, 0, v60, s[76:77]
 v_cndmask_b32 v31, 0, v60, s[78:79]
 v_mov_b64 v[58:59], -1
 s_nop 15
 s_nop 15
 s_nop 15
 s_nop 1
 s_mov_b32 s51, 0
L_pp_199:
 buffer_load_dwordx4 v[8:11], v56, s[4:7], s64 offen sc1
 buffer_load_dwordx4 v[12:15], v56, s[4:7], s65 offen sc1
 s_waitcnt vmcnt(1)
 v_mfma_f32_16x16x32_bf16 v[24:27], v[28:31], v[8:11], 0
 v_bitop3_b32 v60, v8, v10, s55 bitop3:0x7e
 s_waitcnt vmcnt(0)
 v_mfma_f32_16x16x32_bf16 v[24:27], v[28:31], v[12:15], v[24:27]
 v_bitop3_b32 v61, v12, v14, s55 bitop3:0x7e
 v_bitop3_b32 v7, v60, v61, 1 bitop3:0xa8
 v_cmp_ne_u32 vcc, 0, v7
 s_cbranch_vccnz L_rt_200
 s_nop 3
 v_add_f32_dpp v24, v24, v24 row_ror:8 row_mask:0xf bank_mask:0xf
 v_add_f32_dpp v25, v25, v25 row_ror:8 row_mask:0xf bank_mask:0xf
 v_add_f32_dpp v26, v26, v26 row_ror:8 row_mask:0xf bank_mask:0xf
 v_add_f32_dpp v27, v27, v27 row_ror:8 row_mask:0xf bank_mask:0xf
 v_add_f32_dpp v24, v24, v24 row_ror:4 row_mask:0xf bank_mask:0xf
 v_add_f32_dpp v25, v25, v25 row_ror:4 row_mask:0xf bank_mask:0xf
 v_add_f32_dpp v26, v26, v26 row_ror:4 row_mask:0xf bank_mask:0xf
 v_add_f32_dpp v27, v27, v27 row_ror:4 row_mask:0xf bank_mask:0xf
 s_mov_b64 exec, s[84:85]
 v_cvt_pk_bf16_f32 v24, v24, v25
 v_cvt_pk_bf16_f32 v25, v26, v27
 buffer_store_dwordx2 v[24:25], v57, s[4:7], s58 offen sc1
 buffer_store_dwordx2 v[58:59], v57, s[4:7], s57 offen sc1
 s_mov_b64 exec, -1
 s_mov_b32 s57, s58
 s_xor_b32 s55, s55, 1
 s_add_u32 s3, s63, 4096
 buffer_load_dwordx4 v[40:43], v1, s[4:7], s3 offen offset:0
 buffer_load_dwordx4 v[44:47], v1, s[4:7], s3 offen offset:1024
 s_add_u32 s3, s63, 4096
 buffer_load_dwordx4 v[48:51], v1, s[4:7], s3 offen offset:2048
 buffer_load_dwordx4 v[52:55], v1, s[4:7], s3 offen offset:3072
 s_add_u32 s3, s63, 8192
 buffer_load_dwordx4 v[56:59], v1, s[4:7], s3 offen offset:0
 buffer_load_dwordx4 v[60:63], v1, s[4:7], s3 offen offset:1024
 ds_read_b128 v[8:11], v3 offset:49152
 ds_read_b128 v[16:19], v3 offset:49152
 ds_read_b128 v[20:23], v3 offset:49152
 s_waitcnt lgkmcnt(0)
 s_nop 15
 s_nop 15
 s_nop 7
 s_branch L_ch2_s
L_rt_198:
 s_waitcnt lgkmcnt(0)
 s_add_u32 s51, s51, 1
 s_cmp_lt_u32 s51, 131072
 s_cbranch_scc1 L_pm_197
 s_branch L_bail
L_rt_200:
 s_add_u32 s51, s51, 1
 s_cmp_lt_u32 s51, 131072
 s_cbranch_scc1 L_pp_199
 s_branch L_bail
L_ch2_end:
 s_waitcnt vmcnt(0)
 s_endpgm
L_ch3:
 v_lshrrev_b32 v8, 4, v0
 s_mov_b32 s3, 1280
 v_mul_lo_u32 v8, v8, s3
 v_lshrrev_b32 v7, 3, v0
 v_and_b32 v7, 6, v7
 v_xor_b32 v7, v7, v0
 v_and_b32 v7, 15, v7
 v_lshl_add_u32 v8, v7, 4, v8
 v_xor_b32 v9, 128, v8
 v_lshrrev_b32 v10, 4, v0
 s_mov_b32 s3, 8192
 v_mul_lo_u32 v10, v10, s3
 v_lshrrev_b32 v7, 3, v0
 v_and_b32 v7, 6, v7
 v_xor_b32 v7, v7, v0
 v_and_b32 v7, 15, v7
 v_lshl_add_u32 v10, v7, 4, v10
 v_xor_b32 v11, 128, v10
 s_mov_b32 s8, s26
 s_and_b32 s9, s27, 0xffff
 s_mov_b32 s10, 5242880
 s_mul_i32 s14, s52, 163840
 s_add_u32 s14, s14, 122880
 s_mov_b32 m0, 24576
 s_nop 0
 buffer_load_dwordx4 v8, s[8:11], s14 offen lds
 s_add_u32 s14, s14, 5120
 s_mov_b32 m0, 25600
 s_nop 0
 buffer_load_dwordx4 v8, s[8:11], s14 offen lds
 s_add_u32 s14, s14, 5120
 s_mov_b32 m0, 26624
 s_nop 0
 buffer_load_dwordx4 v8, s[8:11], s14 offen lds
 s_add_u32 s14, s14, 5120
 s_mov_b32 m0, 27648
 s_nop 0
 buffer_load_dwordx4 v8, s[8:11], s14 offen lds
 s_add_u32 s14, s14, 5120
 s_mov_b32 m0, 28672
 s_nop 0
 buffer_load_dwordx4 v9, s[8:11], s14 offen lds
 s_add_u32 s14, s14, 5120
 s_mov_b32 m0, 29696
 s_nop 0
 buffer_load_dwordx4 v9, s[8:11], s14 offen lds
 s_add_u32 s14, s14, 5120
 s_mov_b32 m0, 30720
 s_nop 0
 buffer_load_dwordx4 v9, s[8:11], s14 offen lds
 s_add_u32 s14, s14, 5120
 s_mov_b32 m0, 31744
 s_nop 0
 buffer_load_dwordx4 v9, s[8:11], s14 offen lds
 s_mul_i32 s14, s52, 163840
 s_add_u32 s14, s14, 123136
 s_mov_b32 m0, 57344
 s_nop 0
 buffer_load_dwordx4 v8, s[8:11], s14 offen lds
 s_add_u32 s14, s14, 5120
 s_mov_b32 m0, 58368
 s_nop 0
 buffer_load_dwordx4 v8, s[8:11], s14 offen lds
 s_add_u32 s14, s14, 5120
 s_mov_b32 m0, 59392
 s_nop 0
 buffer_load_dwordx4 v8, s[8:11], s14 offen lds
 s_add_u32 s14, s14, 5120
 s_mov_b32 m0, 60416
 s_nop 0
 buffer_load_dwordx4 v8, s[8:11], s14 offen lds
 s_add_u32 s14, s14, 5120
 s_mov_b32 m0, 61440
 s_nop 0
 buffer_load_dwordx4 v9, s[8:11], s14 offen lds
 s_add_u32 s14, s14, 5120
 s_mov_b32 m0, 62464
 s_nop 0
 buffer_load_dwordx4 v9, s[8:11], s14 offen lds
 s_add_u32 s14, s14, 5120
 s_mov_b32 m0, 63488
 s_nop 0
 buffer_load_dwordx4 v9, s[8:11], s14 offen lds
 s_add_u32 s14, s14, 5120
 s_mov_b32 m0, 64512
 s_nop 0
 buffer_load_dwordx4 v9, s[8:11], s14 offen lds
 s_mul_i32 s14, s52, 163840
 s_add_u32 s14, s14, 123392
 s_mov_b32 m0, 90112
 s_nop 0
 buffer_load_dwordx4 v8, s[8:11], s14 offen lds
 s_add_u32 s14, s14, 5120
 s_mov_b32 m0, 91136
 s_nop 0
 buffer_load_dwordx4 v8, s[8:11], s14 offen lds
 s_add_u32 s14, s14, 5120
 s_mov_b32 m0, 92160
 s_nop 0
 buffer_load_dwordx4 v8, s[8:11], s14 offen lds
 s_add_u32 s14, s14, 5120
 s_mov_b32 m0, 93184
 s_nop 0
 buffer_load_dwordx4 v8, s[8:11], s14 offen lds
 s_add_u32 s14, s14, 5120
 s_mov_b32 m0, 94208
 s_nop 0
 buffer_load_dwordx4 v9, s[8:11], s14 offen lds
 s_add_u32 s14, s14, 5120
 s_mov_b32 m0, 95232
 s_nop 0
 buffer_load_dwordx4 v9, s[8:11], s14 offen lds
 s_add_u32 s14, s14, 5120
 s_mov_b32 m0, 96256
 s_nop 0
 buffer_load_dwordx4 v9, s[8:11], s14 offen lds
 s_add_u32 s14, s14, 5120
 s_mov_b32 m0, 97280
 s_nop 0
 buffer_load_dwordx4 v9, s[8:11], s14 offen lds
 s_mul_i32 s14, s52, 163840
 s_add_u32 s14, s14, 123648
 s_mov_b32 m0, 122880
 s_nop 0
 buffer_load_dwordx4 v8, s[8:11], s14 offen lds
 s_add_u32 s14, s14, 5120
 s_mov_b32 m0, 123904
 s_nop 0
 buffer_load_dwordx4 v8, s[8:11], s14 offen lds
 s_add_u32 s14, s14, 5120
 s_mov_b32 m0, 124928
 s_nop 0
 buffer_load_dwordx4 v8, s[8:11], s14 offen lds
 s_add_u32 s14, s14, 5120
 s_mov_b32 m0, 125952
 s_nop 0
 buffer_load_dwordx4 v8, s[8:11], s14 offen lds
 s_add_u32 s14, s14, 5120
 s_mov_b32 m0, 126976
 s_nop 0
 buffer_load_dwordx4 v9, s[8:11], s14 offen lds
 s_add_u32 s14, s14, 5120
 s_mov_b32 m0, 128000
 s_nop 0
 buffer_load_dwordx4 v9, s[8:11], s14 offen lds
 s_add_u32 s14, s14, 5120
 s_mov_b32 m0, 129024
 s_nop 0
 buffer_load_dwordx4 v9, s[8:11], s14 offen lds
 s_add_u32 s14, s14, 5120
 s_mov_b32 m0, 130048
 s_nop 0
 buffer_load_dwordx4 v9, s[8:11], s14 offen lds
 s_mul_i32 s14, s52, 163840
 s_add_u32 s14, s14, 123904
 s_mov_b32 m0, 155648
 s_nop 0
 buffer_load_dwordx4 v8, s[8:11], s14 offen lds
 s_add_u32 s14, s14, 5120
 s_mov_b32 m0, 156672
 s_nop 0
 buffer_load_dwordx4 v8, s[8:11], s14 offen lds
 s_add_u32 s14, s14, 5120
 s_mov_b32 m0, 157696
 s_nop 0
 buffer_load_dwordx4 v8, s[8:11], s14 offen lds
 s_add_u32 s14, s14, 5120
 s_mov_b32 m0, 158720
 s_nop 0
 buffer_load_dwordx4 v8, s[8:11], s14 offen lds
 s_add_u32 s14, s14, 5120
 s_mov_b32 m0, 159744
 s_nop 0
 buffer_load_dwordx4 v9, s[8:11], s14 offen lds
 s_add_u32 s14, s14, 5120
 s_mov_b32 m0, 160768
 s_nop 0
 buffer_load_dwordx4 v9, s[8:11], s14 offen lds
 s_add_u32 s14, s14, 5120
 s_mov_b32 m0, 161792
 s_nop 0
 buffer_load_dwordx4 v9, s[8:11], s14 offen lds
 s_add_u32 s14, s14, 5120
 s_mov_b32 m0, 162816
 s_nop 0
 buffer_load_dwordx4 v9, s[8:11], s14 offen lds
 v_lshrrev_b32 v20, 4, v0
 v_bfe_u32 v21, v0, 2, 1
 v_bfe_u32 v22, v0, 3, 1
 v_and_b32 v23, 1, v20
 v_lshrrev_b32 v24, 1, v20
 v_and_b32 v25, 3, v0
 v_lshlrev_b32 v25, 3, v25
 v_lshl_add_u32 v26, v22, 1, v23
 v_lshl_add_u32 v27, v21, 2, v26
 v_lshl_add_u32 v26, v24, 2, v26
 v_lshl_add_u32 v26, v21, 4, v26
 v_xor_b32 v27, 6, v27
 v_lshl_add_u32 v27, v27, 5, v25
 v_lshl_add_u32 v12, v26, 8, v27
 v_lshl_add_u32 v26, v24, 2, v21
 v_lshl_add_u32 v26, v23, 4, v26
 v_lshl_add_u32 v27, v23, 2, v21
 v_lshl_add_u32 v27, v22, 1, v27
 v_lshl_add_u32 v27, v27, 5, v25
 v_lshl_add_u32 v14, v26, 8, v27
 v_lshlrev_b32 v1, 4, v0
 v_add_u32 v2, 65536, v1
 v_add_u32 v3, 114688, v1
 s_waitcnt vmcnt(32)
 s_barrier
 s_waitcnt lgkmcnt(0)
 s_barrier
 s_mov_b32 s8, s24
 s_and_b32 s9, s25, 0xffff
 s_mov_b32 s10, 5242880
 s_lshl_b32 s14, s52, 8
 s_add_u32 s14, s14, 786432
 s_mov_b32 m0, 24576
 s_nop 0
 buffer_load_dwordx4 v10, s[8:11], s14 offen lds
 s_add_u32 s14, s14, 32768
 s_mov_b32 m0, 25600
 s_nop 0
 buffer_load_dwordx4 v10, s[8:11], s14 offen lds
 s_add_u32 s14, s14, 32768
 s_mov_b32 m0, 26624
 s_nop 0
 buffer_load_dwordx4 v10, s[8:11], s14 offen lds
 s_add_u32 s14, s14, 32768
 s_mov_b32 m0, 27648
 s_nop 0
 buffer_load_dwordx4 v10, s[8:11], s14 offen lds
 s_add_u32 s14, s14, 32768
 s_mov_b32 m0, 28672
 s_nop 0
 buffer_load_dwordx4 v11, s[8:11], s14 offen lds
 s_add_u32 s14, s14, 32768
 s_mov_b32 m0, 29696
 s_nop 0
 buffer_load_dwordx4 v11, s[8:11], s14 offen lds
 s_add_u32 s14, s14, 32768
 s_mov_b32 m0, 30720
 s_nop 0
 buffer_load_dwordx4 v11, s[8:11], s14 offen lds
 s_add_u32 s14, s14, 32768
 s_mov_b32 m0, 31744
 s_nop 0
 buffer_load_dwordx4 v11, s[8:11], s14 offen lds
 s_waitcnt vmcnt(32)
 s_barrier
 s_waitcnt lgkmcnt(0)
 s_barrier
 s_lshl_b32 s14, s52, 8
 s_add_u32 s14, s14, 1835008
 s_mov_b32 m0, 57344
 s_nop 0
 buffer_load_dwordx4 v10, s[8:11], s14 offen lds
 s_add_u32 s14, s14, 32768
 s_mov_b32 m0, 58368
 s_nop 0
 buffer_load_dwordx4 v10, s[8:11], s14 offen lds
 s_add_u32 s14, s14, 32768
 s_mov_b32 m0, 59392
 s_nop 0
 buffer_load_dwordx4 v10, s[8:11], s14 offen lds
 s_add_u32 s14, s14, 32768
 s_mov_b32 m0, 60416
 s_nop 0
 buffer_load_dwordx4 v10, s[8:11], s14 offen lds
 s_add_u32 s14, s14, 32768
 s_mov_b32 m0, 61440
 s_nop 0
 buffer_load_dwordx4 v11, s[8:11], s14 offen lds
 s_add_u32 s14, s14, 32768
 s_mov_b32 m0, 62464
 s_nop 0
 buffer_load_dwordx4 v11, s[8:11], s14 offen lds
 s_add_u32 s14, s14, 32768
 s_mov_b32 m0, 63488
 s_nop 0
 buffer_load_dwordx4 v11, s[8:11], s14 offen lds
 s_add_u32 s14, s14, 32768
 s_mov_b32 m0, 64512
 s_nop 0
 buffer_load_dwordx4 v11, s[8:11], s14 offen lds
 s_waitcnt vmcnt(32)
 s_barrier
 s_waitcnt lgkmcnt(0)
 s_barrier
 s_lshl_b32 s14, s52, 8
 s_add_u32 s14, s14, 2883584
 s_mov_b32 m0, 90112
 s_nop 0
 buffer_load_dwordx4 v10, s[8:11], s14 offen lds
 s_add_u32 s14, s14, 32768
 s_mov_b32 m0, 91136
 s_nop 0
 buffer_load_dwordx4 v10, s[8:11], s14 offen lds
 s_add_u32 s14, s14, 32768
 s_mov_b32 m0, 92160
 s_nop 0
 buffer_load_dwordx4 v10, s[8:11], s14 offen lds
 s_add_u32 s14, s14, 32768
 s_mov_b32 m0, 93184
 s_nop 0
 buffer_load_dwordx4 v10, s[8:11], s14 offen lds
 s_add_u32 s14, s14, 32768
 s_mov_b32 m0, 94208
 s_nop 0
 buffer_load_dwordx4 v11, s[8:11], s14 offen lds
 s_add_u32 s14, s14, 32768
 s_mov_b32 m0, 95232
 s_nop 0
 buffer_load_dwordx4 v11, s[8:11], s14 offen lds
 s_add_u32 s14, s14, 32768
 s_mov_b32 m0, 96256
 s_nop 0
 buffer_load_dwordx4 v11, s[8:11], s14 offen lds
 s_add_u32 s14, s14, 32768
 s_mov_b32 m0, 97280
 s_nop 0
 buffer_load_dwordx4 v11, s[8:11], s14 offen lds
 s_waitcnt vmcnt(32)
 s_barrier
 v_xor_b32 v16, 0, v14
 v_add_u32 v16, 98304, v16
 v_xor_b32 v17, 64, v16
 ds_read_b64_tr_b16 a[0:1], v16 offset:0
 ds_read_b64_tr_b16 a[2:3], v17 offset:512
 ds_read_b64_tr_b16 a[4:5], v16 offset:2048
 ds_read_b64_tr_b16 a[6:7], v17 offset:2560
 v_xor_b32 v16, 0, v14
 v_add_u32 v16, 98304, v16
 v_xor_b32 v17, 64, v16
 ds_read_b64_tr_b16 a[8:9], v16 offset:8192
 ds_read_b64_tr_b16 a[10:11], v17 offset:8704
 ds_read_b64_tr_b16 a[12:13], v16 offset:10240
 ds_read_b64_tr_b16 a[14:15], v17 offset:10752
 v_xor_b32 v16, 0, v14
 v_add_u32 v16, 98304, v16
 v_xor_b32 v17, 64, v16
 ds_read_b64_tr_b16 a[16:17], v16 offset:16384
 ds_read_b64_tr_b16 a[18:19], v17 offset:16896
 ds_read_b64_tr_b16 a[20:21], v16 offset:18432
 ds_read_b64_tr_b16 a[22:23], v17 offset:18944
 v_xor_b32 v16, 0, v14
 v_add_u32 v16, 98304, v16
 v_xor_b32 v17, 64, v16
 ds_read_b64_tr_b16 a[24:25], v16 offset:24576
 ds_read_b64_tr_b16 a[26:27], v17 offset:25088
 ds_read_b64_tr_b16 a[28:29], v16 offset:26624
 ds_read_b64_tr_b16 a[30:31], v17 offset:27136
 v_xor_b32 v16, 32, v14
 v_add_u32 v16, 98304, v16
 v_xor_b32 v17, 64, v16
 ds_read_b64_tr_b16 a[32:33], v16 offset:0
 ds_read_b64_tr_b16 a[34:35], v17 offset:512
 ds_read_b64_tr_b16 a[36:37], v16 offset:2048
 ds_read_b64_tr_b16 a[38:39], v17 offset:2560
 v_xor_b32 v16, 32, v14
 v_add_u32 v16, 98304, v16
 v_xor_b32 v17, 64, v16
 ds_read_b64_tr_b16 a[40:41], v16 offset:8192
 ds_read_b64_tr_b16 a[42:43], v17 offset:8704
 ds_read_b64_tr_b16 a[44:45], v16 offset:10240
 ds_read_b64_tr_b16 a[46:47], v17 offset:10752
 v_xor_b32 v16, 32, v14
 v_add_u32 v16, 98304, v16
 v_xor_b32 v17, 64, v16
 ds_read_b64_tr_b16 a[48:49], v16 offset:16384
 ds_read_b64_tr_b16 a[50:51], v17 offset:16896
 ds_read_b64_tr_b16 a[52:53], v16 offset:18432
 ds_read_b64_tr_b16 a[54:55], v17 offset:18944
 v_xor_b32 v16, 32, v14
 v_add_u32 v16, 98304, v16
 v_xor_b32 v17, 64, v16
 ds_read_b64_tr_b16 a[56:57], v16 offset:24576
 ds_read_b64_tr_b16 a[58:59], v17 offset:25088
 ds_read_b64_tr_b16 a[60:61], v16 offset:26624
 ds_read_b64_tr_b16 a[62:63], v17 offset:27136
 v_xor_b32 v16, 128, v14
 v_add_u32 v16, 98304, v16
 v_xor_b32 v17, 64, v16
 ds_read_b64_tr_b16 a[64:65], v16 offset:0
 ds_read_b64_tr_b16 a[66:67], v17 offset:512
 ds_read_b64_tr_b16 a[68:69], v16 offset:2048
 ds_read_b64_tr_b16 a[70:71], v17 offset:2560
 v_xor_b32 v16, 128, v14
 v_add_u32 v16, 98304, v16
 v_xor_b32 v17, 64, v16
 ds_read_b64_tr_b16 a[72:73], v16 offset:8192
 ds_read_b64_tr_b16 a[74:75], v17 offset:8704
 ds_read_b64_tr_b16 a[76:77], v16 offset:10240
 ds_read_b64_tr_b16 a[78:79], v17 offset:10752
 v_xor_b32 v16, 128, v14
 v_add_u32 v16, 98304, v16
 v_xor_b32 v17, 64, v16
 ds_read_b64_tr_b16 a[80:81], v16 offset:16384
 ds_read_b64_tr_b16 a[82:83], v17 offset:16896
 ds_read_b64_tr_b16 a[84:85], v16 offset:18432
 ds_read_b64_tr_b16 a[86:87], v17 offset:18944
 v_xor_b32 v16, 128, v14
 v_add_u32 v16, 98304, v16
 v_xor_b32 v17, 64, v16
 ds_read_b64_tr_b16 a[88:89], v16 offset:24576
 ds_read_b64_tr_b16 a[90:91], v17 offset:25088
 ds_read_b64_tr_b16 a[92:93], v16 offset:26624
 ds_read_b64_tr_b16 a[94:95], v17 offset:27136
 v_xor_b32 v16, 160, v14
 v_add_u32 v16, 98304, v16
 v_xor_b32 v17, 64, v16
 ds_read_b64_tr_b16 a[96:97], v16 offset:0
 ds_read_b64_tr_b16 a[98:99], v17 offset:512
 ds_read_b64_tr_b16 a[100:101], v16 offset:2048
 ds_read_b64_tr_b16 a[102:103], v17 offset:2560
 v_xor_b32 v16, 160, v14
 v_add_u32 v16, 98304, v16
 v_xor_b32 v17, 64, v16
 ds_read_b64_tr_b16 a[104:105], v16 offset:8192
 ds_read_b64_tr_b16 a[106:107], v17 offset:8704
 ds_read_b64_tr_b16 a[108:109], v16 offset:10240
 ds_read_b64_tr_b16 a[110:111], v17 offset:10752
 v_xor_b32 v16, 160, v14
 v_add_u32 v16, 98304, v16
 v_xor_b32 v17, 64, v16
 ds_read_b64_tr_b16 a[112:113], v16 offset:16384
 ds_read_b64_tr_b16 a[114:115], v17 offset:16896
 ds_read_b64_tr_b16 a[116:117], v16 offset:18432
 ds_read_b64_tr_b16 a[118:119], v17 offset:18944
 v_xor_b32 v16, 160, v14
 v_add_u32 v16, 98304, v16
 v_xor_b32 v17, 64, v16
 ds_read_b64_tr_b16 a[120:121], v16 offset:24576
 ds_read_b64_tr_b16 a[122:123], v17 offset:25088
 ds_read_b64_tr_b16 a[124:125], v16 offset:26624
 ds_read_b64_tr_b16 a[126:127], v17 offset:27136
 s_waitcnt lgkmcnt(0)
 s_barrier
 s_lshl_b32 s14, s52, 8
 s_add_u32 s14, s14, 3932160
 s_mov_b32 m0, 122880
 s_nop 0
 buffer_load_dwordx4 v10, s[8:11], s14 offen lds
 s_add_u32 s14, s14, 32768
 s_mov_b32 m0, 123904
 s_nop 0
 buffer_load_dwordx4 v10, s[8:11], s14 offen lds
 s_add_u32 s14, s14, 32768
 s_mov_b32 m0, 124928
 s_nop 0
 buffer_load_dwordx4 v10, s[8:11], s14 offen lds
 s_add_u32 s14, s14, 32768
 s_mov_b32 m0, 125952
 s_nop 0
 buffer_load_dwordx4 v10, s[8:11], s14 offen lds
 s_add_u32 s14, s14, 32768
 s_mov_b32 m0, 126976
 s_nop 0
 buffer_load_dwordx4 v11, s[8:11], s14 offen lds
 s_add_u32 s14, s14, 32768
 s_mov_b32 m0, 128000
 s_nop 0
 buffer_load_dwordx4 v11, s[8:11], s14 offen lds
 s_add_u32 s14, s14, 32768
 s_mov_b32 m0, 129024
 s_nop 0
 buffer_load_dwordx4 v11, s[8:11], s14 offen lds
 s_add_u32 s14, s14, 32768
 s_mov_b32 m0, 130048
 s_nop 0
 buffer_load_dwordx4 v11, s[8:11], s14 offen lds
 s_waitcnt vmcnt(32)
 s_barrier
 v_xor_b32 v16, 160, v14
 v_add_u32 v16, 131072, v16
 v_xor_b32 v17, 64, v16
 ds_read_b64_tr_b16 a[128:129], v16 offset:0
 ds_read_b64_tr_b16 a[130:131], v17 offset:512
 ds_read_b64_tr_b16 a[132:133], v16 offset:2048
 ds_read_b64_tr_b16 a[134:135], v17 offset:2560
 v_xor_b32 v16, 160, v14
 v_add_u32 v16, 131072, v16
 v_xor_b32 v17, 64, v16
 ds_read_b64_tr_b16 a[136:137], v16 offset:8192
 ds_read_b64_tr_b16 a[138:139], v17 offset:8704
 ds_read_b64_tr_b16 a[140:141], v16 offset:10240
 ds_read_b64_tr_b16 a[142:143], v17 offset:10752
 v_xor_b32 v16, 160, v14
 v_add_u32 v16, 131072, v16
 v_xor_b32 v17, 64, v16
 ds_read_b64_tr_b16 a[144:145], v16 offset:16384
 ds_read_b64_tr_b16 a[146:147], v17 offset:16896
 ds_read_b64_tr_b16 a[148:149], v16 offset:18432
 ds_read_b64_tr_b16 a[150:151], v17 offset:18944
 v_xor_b32 v16, 160, v14
 v_add_u32 v16, 131072, v16
 v_xor_b32 v17, 64, v16
 ds_read_b64_tr_b16 a[152:153], v16 offset:24576
 ds_read_b64_tr_b16 a[154:155], v17 offset:25088
 ds_read_b64_tr_b16 a[156:157], v16 offset:26624
 ds_read_b64_tr_b16 a[158:159], v17 offset:27136
 s_waitcnt lgkmcnt(0)
 s_barrier
 s_lshl_b32 s14, s52, 8
 s_add_u32 s14, s14, 4980736
 s_mov_b32 m0, 155648
 s_nop 0
 buffer_load_dwordx4 v10, s[8:11], s14 offen lds
 s_add_u32 s14, s14, 32768
 s_mov_b32 m0, 156672
 s_nop 0
 buffer_load_dwordx4 v10, s[8:11], s14 offen lds
 s_add_u32 s14, s14, 32768
 s_mov_b32 m0, 157696
 s_nop 0
 buffer_load_dwordx4 v10, s[8:11], s14 offen lds
 s_add_u32 s14, s14, 32768
 s_mov_b32 m0, 158720
 s_nop 0
 buffer_load_dwordx4 v10, s[8:11], s14 offen lds
 s_add_u32 s14, s14, 32768
 s_mov_b32 m0, 159744
 s_nop 0
 buffer_load_dwordx4 v11, s[8:11], s14 offen lds
 s_add_u32 s14, s14, 32768
 s_mov_b32 m0, 160768
 s_nop 0
 buffer_load_dwordx4 v11, s[8:11], s14 offen lds
 s_add_u32 s14, s14, 32768
 s_mov_b32 m0, 161792
 s_nop 0
 buffer_load_dwordx4 v11, s[8:11], s14 offen lds
 s_add_u32 s14, s14, 32768
 s_mov_b32 m0, 162816
 s_nop 0
 buffer_load_dwordx4 v11, s[8:11], s14 offen lds
 s_waitcnt vmcnt(32)
 s_barrier
 v_xor_b32 v16, 0, v12
 v_add_u32 v16, 0, v16
 ds_read_b64_tr_b16 a[160:161], v16 offset:0
 ds_read_b64_tr_b16 a[162:163], v16 offset:8192
 ds_read_b64_tr_b16 a[164:165], v16 offset:2048
 ds_read_b64_tr_b16 a[166:167], v16 offset:10240
 v_xor_b32 v16, 32, v12
 v_add_u32 v16, 0, v16
 ds_read_b64_tr_b16 a[168:169], v16 offset:0
 ds_read_b64_tr_b16 a[170:171], v16 offset:8192
 ds_read_b64_tr_b16 a[172:173], v16 offset:2048
 ds_read_b64_tr_b16 a[174:175], v16 offset:10240
 v_xor_b32 v16, 0, v12
 v_add_u32 v16, 0, v16
 ds_read_b64_tr_b16 a[176:177], v16 offset:16384
 ds_read_b64_tr_b16 a[178:179], v16 offset:24576
 ds_read_b64_tr_b16 a[180:181], v16 offset:18432
 ds_read_b64_tr_b16 a[182:183], v16 offset:26624
 v_xor_b32 v16, 32, v12
 v_add_u32 v16, 0, v16
 ds_read_b64_tr_b16 a[184:185], v16 offset:16384
 ds_read_b64_tr_b16 a[186:187], v16 offset:24576
 ds_read_b64_tr_b16 a[188:189], v16 offset:18432
 ds_read_b64_tr_b16 a[190:191], v16 offset:26624
 s_waitcnt lgkmcnt(0)
 s_barrier
 s_mov_b32 s8, s22
 s_and_b32 s9, s23, 0xffff
 s_mov_b32 s10, 5242880
 s_lshl_b32 s14, s52, 8
 s_add_u32 s14, s14, 786432
 s_mov_b32 m0, 24576
 s_nop 0
 buffer_load_dwordx4 v10, s[8:11], s14 offen lds
 s_add_u32 s14, s14, 32768
 s_mov_b32 m0, 25600
 s_nop 0
 buffer_load_dwordx4 v10, s[8:11], s14 offen lds
 s_add_u32 s14, s14, 32768
 s_mov_b32 m0, 26624
 s_nop 0
 buffer_load_dwordx4 v10, s[8:11], s14 offen lds
 s_add_u32 s14, s14, 32768
 s_mov_b32 m0, 27648
 s_nop 0
 buffer_load_dwordx4 v10, s[8:11], s14 offen lds
 s_add_u32 s14, s14, 32768
 s_mov_b32 m0, 28672
 s_nop 0
 buffer_load_dwordx4 v11, s[8:11], s14 offen lds
 s_add_u32 s14, s14, 32768
 s_mov_b32 m0, 29696
 s_nop 0
 buffer_load_dwordx4 v11, s[8:11], s14 offen lds
 s_add_u32 s14, s14, 32768
 s_mov_b32 m0, 30720
 s_nop 0
 buffer_load_dwordx4 v11, s[8:11], s14 offen lds
 s_add_u32 s14, s14, 32768
 s_mov_b32 m0, 31744
 s_nop 0
 buffer_load_dwordx4 v11, s[8:11], s14 offen lds
 s_waitcnt vmcnt(32)
 s_barrier
 v_xor_b32 v16, 0, v12
 v_add_u32 v16, 32768, v16
 ds_read_b64_tr_b16 a[192:193], v16 offset:0
 ds_read_b64_tr_b16 a[194:195], v16 offset:8192
 ds_read_b64_tr_b16 a[196:197], v16 offset:2048
 ds_read_b64_tr_b16 a[198:199], v16 offset:10240
 v_xor_b32 v16, 32, v12
 v_add_u32 v16, 32768, v16
 ds_read_b64_tr_b16 a[200:201], v16 offset:0
 ds_read_b64_tr_b16 a[202:203], v16 offset:8192
 ds_read_b64_tr_b16 a[204:205], v16 offset:2048
 ds_read_b64_tr_b16 a[206:207], v16 offset:10240
 v_xor_b32 v16, 0, v12
 v_add_u32 v16, 32768, v16
 ds_read_b64_tr_b16 a[208:209], v16 offset:16384
 ds_read_b64_tr_b16 a[210:211], v16 offset:24576
 ds_read_b64_tr_b16 a[212:213], v16 offset:18432
 ds_read_b64_tr_b16 a[214:215], v16 offset:26624
 v_xor_b32 v16, 32, v12
 v_add_u32 v16, 32768, v16
 ds_read_b64_tr_b16 a[216:217], v16 offset:16384
 ds_read_b64_tr_b16 a[218:219], v16 offset:24576
 ds_read_b64_tr_b16 a[220:221], v16 offset:18432
 ds_read_b64_tr_b16 a[222:223], v16 offset:26624
 s_waitcnt lgkmcnt(0)
 s_barrier
 s_lshl_b32 s14, s52, 8
 s_add_u32 s14, s14, 1835008
 s_mov_b32 m0, 57344
 s_nop 0
 buffer_load_dwordx4 v10, s[8:11], s14 offen lds
 s_add_u32 s14, s14, 32768
 s_mov_b32 m0, 58368
 s_nop 0
 buffer_load_dwordx4 v10, s[8:11], s14 offen lds
 s_add_u32 s14, s14, 32768
 s_mov_b32 m0, 59392
 s_nop 0
 buffer_load_dwordx4 v10, s[8:11], s14 offen lds
 s_add_u32 s14, s14, 32768
 s_mov_b32 m0, 60416
 s_nop 0
 buffer_load_dwordx4 v10, s[8:11], s14 offen lds
 s_add_u32 s14, s14, 32768
 s_mov_b32 m0, 61440
 s_nop 0
 buffer_load_dwordx4 v11, s[8:11], s14 offen lds
 s_add_u32 s14, s14, 32768
 s_mov_b32 m0, 62464
 s_nop 0
 buffer_load_dwordx4 v11, s[8:11], s14 offen lds
 s_add_u32 s14, s14, 32768
 s_mov_b32 m0, 63488
 s_nop 0
 buffer_load_dwordx4 v11, s[8:11], s14 offen lds
 s_add_u32 s14, s14, 32768
 s_mov_b32 m0, 64512
 s_nop 0
 buffer_load_dwordx4 v11, s[8:11], s14 offen lds
 s_waitcnt vmcnt(32)
 s_barrier
 v_xor_b32 v16, 0, v12
 v_add_u32 v16, 65536, v16
 ds_read_b64_tr_b16 a[224:225], v16 offset:0
 ds_read_b64_tr_b16 a[226:227], v16 offset:8192
 ds_read_b64_tr_b16 a[228:229], v16 offset:2048
 ds_read_b64_tr_b16 a[230:231], v16 offset:10240
 v_xor_b32 v16, 32, v12
 v_add_u32 v16, 65536, v16
 ds_read_b64_tr_b16 a[232:233], v16 offset:0
 ds_read_b64_tr_b16 a[234:235], v16 offset:8192
 ds_read_b64_tr_b16 a[236:237], v16 offset:2048
 ds_read_b64_tr_b16 a[238:239], v16 offset:10240
 v_xor_b32 v16, 0, v12
 v_add_u32 v16, 65536, v16
 ds_read_b64_tr_b16 a[240:241], v16 offset:16384
 ds_read_b64_tr_b16 a[242:243], v16 offset:24576
 ds_read_b64_tr_b16 a[244:245], v16 offset:18432
 ds_read_b64_tr_b16 a[246:247], v16 offset:26624
 v_xor_b32 v16, 32, v12
 v_add_u32 v16, 65536, v16
 ds_read_b64_tr_b16 a[248:249], v16 offset:16384
 ds_read_b64_tr_b16 a[250:251], v16 offset:24576
 ds_read_b64_tr_b16 a[252:253], v16 offset:18432
 ds_read_b64_tr_b16 a[254:255], v16 offset:26624
 s_waitcnt lgkmcnt(0)
 s_barrier
 s_lshl_b32 s14, s52, 8
 s_add_u32 s14, s14, 2883584
 s_mov_b32 m0, 90112
 s_nop 0
 buffer_load_dwordx4 v10, s[8:11], s14 offen lds
 s_add_u32 s14, s14, 32768
 s_mov_b32 m0, 91136
 s_nop 0
 buffer_load_dwordx4 v10, s[8:11], s14 offen lds
 s_add_u32 s14, s14, 32768
 s_mov_b32 m0, 92160
 s_nop 0
 buffer_load_dwordx4 v10, s[8:11], s14 offen lds
 s_add_u32 s14, s14, 32768
 s_mov_b32 m0, 93184
 s_nop 0
 buffer_load_dwordx4 v10, s[8:11], s14 offen lds
 s_add_u32 s14, s14, 32768
 s_mov_b32 m0, 94208
 s_nop 0
 buffer_load_dwordx4 v11, s[8:11], s14 offen lds
 s_add_u32 s14, s14, 32768
 s_mov_b32 m0, 95232
 s_nop 0
 buffer_load_dwordx4 v11, s[8:11], s14 offen lds
 s_add_u32 s14, s14, 32768
 s_mov_b32 m0, 96256
 s_nop 0
 buffer_load_dwordx4 v11, s[8:11], s14 offen lds
 s_add_u32 s14, s14, 32768
 s_mov_b32 m0, 97280
 s_nop 0
 buffer_load_dwordx4 v11, s[8:11], s14 offen lds
 s_waitcnt vmcnt(32)
 s_barrier
 v_xor_b32 v16, 0, v12
 v_add_u32 v16, 98304, v16
 ds_read_b64_tr_b16 v[64:65], v16 offset:0
 ds_read_b64_tr_b16 v[66:67], v16 offset:8192
 ds_read_b64_tr_b16 v[68:69], v16 offset:2048
 ds_read_b64_tr_b16 v[70:71], v16 offset:10240
 v_xor_b32 v16, 32, v12
 v_add_u32 v16, 98304, v16
 ds_read_b64_tr_b16 v[72:73], v16 offset:0
 ds_read_b64_tr_b16 v[74:75], v16 offset:8192
 ds_read_b64_tr_b16 v[76:77], v16 offset:2048
 ds_read_b64_tr_b16 v[78:79], v16 offset:10240
 v_xor_b32 v16, 0, v12
 v_add_u32 v16, 98304, v16
 ds_read_b64_tr_b16 v[80:81], v16 offset:16384
 ds_read_b64_tr_b16 v[82:83], v16 offset:24576
 ds_read_b64_tr_b16 v[84:85], v16 offset:18432
 ds_read_b64_tr_b16 v[86:87], v16 offset:26624
 v_xor_b32 v16, 32, v12
 v_add_u32 v16, 98304, v16
 ds_read_b64_tr_b16 v[88:89], v16 offset:16384
 ds_read_b64_tr_b16 v[90:91], v16 offset:24576
 ds_read_b64_tr_b16 v[92:93], v16 offset:18432
 ds_read_b64_tr_b16 v[94:95], v16 offset:26624
 s_waitcnt lgkmcnt(0)
 s_barrier
 s_lshl_b32 s14, s52, 8
 s_add_u32 s14, s14, 3932160
 s_mov_b32 m0, 122880
 s_nop 0
 buffer_load_dwordx4 v10, s[8:11], s14 offen lds
 s_add_u32 s14, s14, 32768
 s_mov_b32 m0, 123904
 s_nop 0
 buffer_load_dwordx4 v10, s[8:11], s14 offen lds
 s_add_u32 s14, s14, 32768
 s_mov_b32 m0, 124928
 s_nop 0
 buffer_load_dwordx4 v10, s[8:11], s14 offen lds
 s_add_u32 s14, s14, 32768
 s_mov_b32 m0, 125952
 s_nop 0
 buffer_load_dwordx4 v10, s[8:11], s14 offen lds
 s_add_u32 s14, s14, 32768
 s_mov_b32 m0, 126976
 s_nop 0
 buffer_load_dwordx4 v11, s[8:11], s14 offen lds
 s_add_u32 s14, s14, 32768
 s_mov_b32 m0, 128000
 s_nop 0
 buffer_load_dwordx4 v11, s[8:11], s14 offen lds
 s_add_u32 s14, s14, 32768
 s_mov_b32 m0, 129024
 s_nop 0
 buffer_load_dwordx4 v11, s[8:11], s14 offen lds
 s_add_u32 s14, s14, 32768
 s_mov_b32 m0, 130048
 s_nop 0
 buffer_load_dwordx4 v11, s[8:11], s14 offen lds
 s_waitcnt vmcnt(32)
 s_barrier
 v_xor_b32 v16, 0, v12
 v_add_u32 v16, 131072, v16
 ds_read_b64_tr_b16 v[96:97], v16 offset:0
 ds_read_b64_tr_b16 v[98:99], v16 offset:8192
 ds_read_b64_tr_b16 v[100:101], v16 offset:2048
 ds_read_b64_tr_b16 v[102:103], v16 offset:10240
 v_xor_b32 v16, 32, v12
 v_add_u32 v16, 131072, v16
 ds_read_b64_tr_b16 v[104:105], v16 offset:0
 ds_read_b64_tr_b16 v[106:107], v16 offset:8192
 ds_read_b64_tr_b16 v[108:109], v16 offset:2048
 ds_read_b64_tr_b16 v[110:111], v16 offset:10240
 v_xor_b32 v16, 0, v12
 v_add_u32 v16, 131072, v16
 ds_read_b64_tr_b16 v[112:113], v16 offset:16384
 ds_read_b64_tr_b16 v[114:115], v16 offset:24576
 ds_read_b64_tr_b16 v[116:117], v16 offset:18432
 ds_read_b64_tr_b16 v[118:119], v16 offset:26624
 v_xor_b32 v16, 32, v12
 v_add_u32 v16, 131072, v16
 ds_read_b64_tr_b16 v[120:121], v16 offset:16384
 ds_read_b64_tr_b16 v[122:123], v16 offset:24576
 ds_read_b64_tr_b16 v[124:125], v16 offset:18432
 ds_read_b64_tr_b16 v[126:127], v16 offset:26624
 s_waitcnt lgkmcnt(0)
 s_barrier
 s_lshl_b32 s14, s52, 8
 s_add_u32 s14, s14, 4980736
 s_mov_b32 m0, 155648
 s_nop 0
 buffer_load_dwordx4 v10, s[8:11], s14 offen lds
 s_add_u32 s14, s14, 32768
 s_mov_b32 m0, 156672
 s_nop 0
 buffer_load_dwordx4 v10, s[8:11], s14 offen lds
 s_add_u32 s14, s14, 32768
 s_mov_b32 m0, 157696
 s_nop 0
 buffer_load_dwordx4 v10, s[8:11], s14 offen lds
 s_add_u32 s14, s14, 32768
 s_mov_b32 m0, 158720
 s_nop 0
 buffer_load_dwordx4 v10, s[8:11], s14 offen lds
 s_add_u32 s14, s14, 32768
 s_mov_b32 m0, 159744
 s_nop 0
 buffer_load_dwordx4 v11, s[8:11], s14 offen lds
 s_add_u32 s14, s14, 32768
 s_mov_b32 m0, 160768
 s_nop 0
 buffer_load_dwordx4 v11, s[8:11], s14 offen lds
 s_add_u32 s14, s14, 32768
 s_mov_b32 m0, 161792
 s_nop 0
 buffer_load_dwordx4 v11, s[8:11], s14 offen lds
 s_add_u32 s14, s14, 32768
 s_mov_b32 m0, 162816
 s_nop 0
 buffer_load_dwordx4 v11, s[8:11], s14 offen lds
 s_waitcnt vmcnt(32)
 s_barrier
 v_xor_b32 v16, 0, v12
 v_add_u32 v16, 0, v16
 ds_read_b64_tr_b16 v[128:129], v16 offset:0
 ds_read_b64_tr_b16 v[130:131], v16 offset:8192
 ds_read_b64_tr_b16 v[132:133], v16 offset:2048
 ds_read_b64_tr_b16 v[134:135], v16 offset:10240
 v_xor_b32 v16, 32, v12
 v_add_u32 v16, 0, v16
 ds_read_b64_tr_b16 v[136:137], v16 offset:0
 ds_read_b64_tr_b16 v[138:139], v16 offset:8192
 ds_read_b64_tr_b16 v[140:141], v16 offset:2048
 ds_read_b64_tr_b16 v[142:143], v16 offset:10240
 v_xor_b32 v16, 0, v12
 v_add_u32 v16, 0, v16
 ds_read_b64_tr_b16 v[144:145], v16 offset:16384
 ds_read_b64_tr_b16 v[146:147], v16 offset:24576
 ds_read_b64_tr_b16 v[148:149], v16 offset:18432
 ds_read_b64_tr_b16 v[150:151], v16 offset:26624
 v_xor_b32 v16, 32, v12
 v_add_u32 v16, 0, v16
 ds_read_b64_tr_b16 v[152:153], v16 offset:16384
 ds_read_b64_tr_b16 v[154:155], v16 offset:24576
 ds_read_b64_tr_b16 v[156:157], v16 offset:18432
 ds_read_b64_tr_b16 v[158:159], v16 offset:26624
 s_waitcnt lgkmcnt(0)
 s_barrier
 s_mov_b32 s8, s20
 s_and_b32 s9, s21, 0xffff
 s_mov_b32 s10, 5242880
 s_lshl_b32 s14, s52, 8
 s_add_u32 s14, s14, 786432
 s_mov_b32 m0, 24576
 s_nop 0
 buffer_load_dwordx4 v10, s[8:11], s14 offen lds
 s_add_u32 s14, s14, 32768
 s_mov_b32 m0, 25600
 s_nop 0
 buffer_load_dwordx4 v10, s[8:11], s14 offen lds
 s_add_u32 s14, s14, 32768
 s_mov_b32 m0, 26624
 s_nop 0
 buffer_load_dwordx4 v10, s[8:11], s14 offen lds
 s_add_u32 s14, s14, 32768
 s_mov_b32 m0, 27648
 s_nop 0
 buffer_load_dwordx4 v10, s[8:11], s14 offen lds
 s_add_u32 s14, s14, 32768
 s_mov_b32 m0, 28672
 s_nop 0
 buffer_load_dwordx4 v11, s[8:11], s14 offen lds
 s_add_u32 s14, s14, 32768
 s_mov_b32 m0, 29696
 s_nop 0
 buffer_load_dwordx4 v11, s[8:11], s14 offen lds
 s_add_u32 s14, s14, 32768
 s_mov_b32 m0, 30720
 s_nop 0
 buffer_load_dwordx4 v11, s[8:11], s14 offen lds
 s_add_u32 s14, s14, 32768
 s_mov_b32 m0, 31744
 s_nop 0
 buffer_load_dwordx4 v11, s[8:11], s14 offen lds
 s_waitcnt vmcnt(32)
 s_barrier
 v_xor_b32 v16, 0, v12
 v_add_u32 v16, 32768, v16
 ds_read_b64_tr_b16 v[160:161], v16 offset:0
 ds_read_b64_tr_b16 v[162:163], v16 offset:8192
 ds_read_b64_tr_b16 v[164:165], v16 offset:2048
 ds_read_b64_tr_b16 v[166:167], v16 offset:10240
 v_xor_b32 v16, 32, v12
 v_add_u32 v16, 32768, v16
 ds_read_b64_tr_b16 v[168:169], v16 offset:0
 ds_read_b64_tr_b16 v[170:171], v16 offset:8192
 ds_read_b64_tr_b16 v[172:173], v16 offset:2048
 ds_read_b64_tr_b16 v[174:175], v16 offset:10240
 v_xor_b32 v16, 0, v12
 v_add_u32 v16, 32768, v16
 ds_read_b64_tr_b16 v[176:177], v16 offset:16384
 ds_read_b64_tr_b16 v[178:179], v16 offset:24576
 ds_read_b64_tr_b16 v[180:181], v16 offset:18432
 ds_read_b64_tr_b16 v[182:183], v16 offset:26624
 v_xor_b32 v16, 32, v12
 v_add_u32 v16, 32768, v16
 ds_read_b64_tr_b16 v[32:33], v16 offset:16384
 ds_read_b64_tr_b16 v[34:35], v16 offset:24576
 ds_read_b64_tr_b16 v[36:37], v16 offset:18432
 ds_read_b64_tr_b16 v[38:39], v16 offset:26624
 s_add_u32 s3, s63, 0
 s_waitcnt lgkmcnt(2)
 buffer_store_dwordx4 v[32:35], v1, s[4:7], s3 offen offset:0
 s_waitcnt lgkmcnt(0)
 buffer_store_dwordx4 v[36:39], v1, s[4:7], s3 offen offset:1024
 s_waitcnt lgkmcnt(0)
 s_barrier
 s_lshl_b32 s14, s52, 8
 s_add_u32 s14, s14, 1835008
 s_mov_b32 m0, 57344
 s_nop 0
 buffer_load_dwordx4 v10, s[8:11], s14 offen lds
 s_add_u32 s14, s14, 32768
 s_mov_b32 m0, 58368
 s_nop 0
 buffer_load_dwordx4 v10, s[8:11], s14 offen lds
 s_add_u32 s14, s14, 32768
 s_mov_b32 m0, 59392
 s_nop 0
 buffer_load_dwordx4 v10, s[8:11], s14 offen lds
 s_add_u32 s14, s14, 32768
 s_mov_b32 m0, 60416
 s_nop 0
 buffer_load_dwordx4 v10, s[8:11], s14 offen lds
 s_add_u32 s14, s14, 32768
 s_mov_b32 m0, 61440
 s_nop 0
 buffer_load_dwordx4 v11, s[8:11], s14 offen lds
 s_add_u32 s14, s14, 32768
 s_mov_b32 m0, 62464
 s_nop 0
 buffer_load_dwordx4 v11, s[8:11], s14 offen lds
 s_add_u32 s14, s14, 32768
 s_mov_b32 m0, 63488
 s_nop 0
 buffer_load_dwordx4 v11, s[8:11], s14 offen lds
 s_add_u32 s14, s14, 32768
 s_mov_b32 m0, 64512
 s_nop 0
 buffer_load_dwordx4 v11, s[8:11], s14 offen lds
 s_waitcnt vmcnt(34)
 s_barrier
 v_xor_b32 v16, 0, v12
 v_add_u32 v16, 65536, v16
 ds_read_b64_tr_b16 v[184:185], v16 offset:0
 ds_read_b64_tr_b16 v[186:187], v16 offset:8192
 ds_read_b64_tr_b16 v[188:189], v16 offset:2048
 ds_read_b64_tr_b16 v[190:191], v16 offset:10240
 v_xor_b32 v16, 32, v12
 v_add_u32 v16, 65536, v16
 ds_read_b64_tr_b16 v[192:193], v16 offset:0
 ds_read_b64_tr_b16 v[194:195], v16 offset:8192
 ds_read_b64_tr_b16 v[196:197], v16 offset:2048
 ds_read_b64_tr_b16 v[198:199], v16 offset:10240
 v_xor_b32 v16, 0, v12
 v_add_u32 v16, 65536, v16
 ds_read_b64_tr_b16 v[200:201], v16 offset:16384
 ds_read_b64_tr_b16 v[202:203], v16 offset:24576
 ds_read_b64_tr_b16 v[204:205], v16 offset:18432
 ds_read_b64_tr_b16 v[206:207], v16 offset:26624
 v_xor_b32 v16, 32, v12
 v_add_u32 v16, 65536, v16
 ds_read_b64_tr_b16 v[208:209], v16 offset:16384
 ds_read_b64_tr_b16 v[210:211], v16 offset:24576
 ds_read_b64_tr_b16 v[212:213], v16 offset:18432
 ds_read_b64_tr_b16 v[214:215], v16 offset:26624
 s_waitcnt lgkmcnt(0)
 s_barrier
 s_lshl_b32 s14, s52, 8
 s_add_u32 s14, s14, 2883584
 s_mov_b32 m0, 90112
 s_nop 0
 buffer_load_dwordx4 v10, s[8:11], s14 offen lds
 s_add_u32 s14, s14, 32768
 s_mov_b32 m0, 91136
 s_nop 0
 buffer_load_dwordx4 v10, s[8:11], s14 offen lds
 s_add_u32 s14, s14, 32768
 s_mov_b32 m0, 92160
 s_nop 0
 buffer_load_dwordx4 v10, s[8:11], s14 offen lds
 s_add_u32 s14, s14, 32768
 s_mov_b32 m0, 93184
 s_nop 0
 buffer_load_dwordx4 v10, s[8:11], s14 offen lds
 s_add_u32 s14, s14, 32768
 s_mov_b32 m0, 94208
 s_nop 0
 buffer_load_dwordx4 v11, s[8:11], s14 offen lds
 s_add_u32 s14, s14, 32768
 s_mov_b32 m0, 95232
 s_nop 0
 buffer_load_dwordx4 v11, s[8:11], s14 offen lds
 s_add_u32 s14, s14, 32768
 s_mov_b32 m0, 96256
 s_nop 0
 buffer_load_dwordx4 v11, s[8:11], s14 offen lds
 s_add_u32 s14, s14, 32768
 s_mov_b32 m0, 97280
 s_nop 0
 buffer_load_dwordx4 v11, s[8:11], s14 offen lds
 s_waitcnt vmcnt(34)
 s_barrier
 v_xor_b32 v16, 0, v12
 v_add_u32 v16, 98304, v16
 ds_read_b64_tr_b16 v[40:41], v16 offset:0
 ds_read_b64_tr_b16 v[42:43], v16 offset:8192
 ds_read_b64_tr_b16 v[44:45], v16 offset:2048
 ds_read_b64_tr_b16 v[46:47], v16 offset:10240
 s_add_u32 s3, s63, 2048
 s_waitcnt lgkmcnt(2)
 buffer_store_dwordx4 v[40:43], v1, s[4:7], s3 offen offset:0
 s_waitcnt lgkmcnt(0)
 buffer_store_dwordx4 v[44:47], v1, s[4:7], s3 offen offset:1024
 v_xor_b32 v16, 32, v12
 v_add_u32 v16, 98304, v16
 ds_read_b64_tr_b16 v[48:49], v16 offset:0
 ds_read_b64_tr_b16 v[50:51], v16 offset:8192
 ds_read_b64_tr_b16 v[52:53], v16 offset:2048
 ds_read_b64_tr_b16 v[54:55], v16 offset:10240
 s_add_u32 s3, s63, 4096
 s_waitcnt lgkmcnt(2)
 buffer_store_dwordx4 v[48:51], v1, s[4:7], s3 offen offset:0
 s_waitcnt lgkmcnt(0)
 buffer_store_dwordx4 v[52:55], v1, s[4:7], s3 offen offset:1024
 v_xor_b32 v16, 0, v12
 v_add_u32 v16, 98304, v16
 ds_read_b64_tr_b16 v[56:57], v16 offset:16384
 ds_read_b64_tr_b16 v[58:59], v16 offset:24576
 ds_read_b64_tr_b16 v[60:61], v16 offset:18432
 ds_read_b64_tr_b16 v[62:63], v16 offset:26624
 s_add_u32 s3, s63, 6144
 s_waitcnt lgkmcnt(2)
 buffer_store_dwordx4 v[56:59], v1, s[4:7], s3 offen offset:0
 s_waitcnt lgkmcnt(0)
 buffer_store_dwordx4 v[60:63], v1, s[4:7], s3 offen offset:1024
 v_xor_b32 v16, 32, v12
 v_add_u32 v16, 98304, v16
 ds_read_b64_tr_b16 v[32:33], v16 offset:16384
 ds_read_b64_tr_b16 v[34:35], v16 offset:24576
 ds_read_b64_tr_b16 v[36:37], v16 offset:18432
 ds_read_b64_tr_b16 v[38:39], v16 offset:26624
 s_add_u32 s3, s63, 8192
 s_waitcnt lgkmcnt(2)
 buffer_store_dwordx4 v[32:35], v1, s[4:7], s3 offen offset:0
 s_waitcnt lgkmcnt(0)
 buffer_store_dwordx4 v[36:39], v1, s[4:7], s3 offen offset:1024
 s_waitcnt lgkmcnt(0)
 s_barrier
 s_lshl_b32 s14, s52, 8
 s_add_u32 s14, s14, 3932160
 s_mov_b32 m0, 122880
 s_nop 0
 buffer_load_dwordx4 v10, s[8:11], s14 offen lds
 s_add_u32 s14, s14, 32768
 s_mov_b32 m0, 123904
 s_nop 0
 buffer_load_dwordx4 v10, s[8:11], s14 offen lds
 s_add_u32 s14, s14, 32768
 s_mov_b32 m0, 124928
 s_nop 0
 buffer_load_dwordx4 v10, s[8:11], s14 offen lds
 s_add_u32 s14, s14, 32768
 s_mov_b32 m0, 125952
 s_nop 0
 buffer_load_dwordx4 v10, s[8:11], s14 offen lds
 s_add_u32 s14, s14, 32768
 s_mov_b32 m0, 126976
 s_nop 0
 buffer_load_dwordx4 v11, s[8:11], s14 offen lds
 s_add_u32 s14, s14, 32768
 s_mov_b32 m0, 128000
 s_nop 0
 buffer_load_dwordx4 v11, s[8:11], s14 offen lds
 s_add_u32 s14, s14, 32768
 s_mov_b32 m0, 129024
 s_nop 0
 buffer_load_dwordx4 v11, s[8:11], s14 offen lds
 s_add_u32 s14, s14, 32768
 s_mov_b32 m0, 130048
 s_nop 0
 buffer_load_dwordx4 v11, s[8:11], s14 offen lds
 s_waitcnt vmcnt(42)
 s_barrier
 v_xor_b32 v16, 0, v12
 v_add_u32 v16, 131072, v16
 ds_read_b64_tr_b16 v[216:217], v16 offset:0
 ds_read_b64_tr_b16 v[218:219], v16 offset:8192
 ds_read_b64_tr_b16 v[220:221], v16 offset:2048
 ds_read_b64_tr_b16 v[222:223], v16 offset:10240
 v_xor_b32 v16, 32, v12
 v_add_u32 v16, 131072, v16
 ds_read_b64_tr_b16 v[40:41], v16 offset:0
 ds_read_b64_tr_b16 v[42:43], v16 offset:8192
 ds_read_b64_tr_b16 v[44:45], v16 offset:2048
 ds_read_b64_tr_b16 v[46:47], v16 offset:10240
 s_add_u32 s3, s63, 10240
 s_waitcnt lgkmcnt(2)
 buffer_store_dwordx4 v[40:43], v1, s[4:7], s3 offen offset:0
 s_waitcnt lgkmcnt(0)
 buffer_store_dwordx4 v[44:47], v1, s[4:7], s3 offen offset:1024
 v_xor_b32 v16, 0, v12
 v_add_u32 v16, 131072, v16
 ds_read_b64_tr_b16 v[224:225], v16 offset:16384
 ds_read_b64_tr_b16 v[226:227], v16 offset:24576
 ds_read_b64_tr_b16 v[228:229], v16 offset:18432
 ds_read_b64_tr_b16 v[230:231], v16 offset:26624
 v_xor_b32 v16, 32, v12
 v_add_u32 v16, 131072, v16
 ds_read_b64_tr_b16 v[232:233], v16 offset:16384
 ds_read_b64_tr_b16 v[234:235], v16 offset:24576
 ds_read_b64_tr_b16 v[236:237], v16 offset:18432
 ds_read_b64_tr_b16 v[238:239], v16 offset:26624
 s_waitcnt lgkmcnt(0)
 s_barrier
 s_lshl_b32 s14, s52, 8
 s_add_u32 s14, s14, 4980736
 s_mov_b32 m0, 155648
 s_nop 0
 buffer_load_dwordx4 v10, s[8:11], s14 offen lds
 s_add_u32 s14, s14, 32768
 s_mov_b32 m0, 156672
 s_nop 0
 buffer_load_dwordx4 v10, s[8:11], s14 offen lds
 s_add_u32 s14, s14, 32768
 s_mov_b32 m0, 157696
 s_nop 0
 buffer_load_dwordx4 v10, s[8:11], s14 offen lds
 s_add_u32 s14, s14, 32768
 s_mov_b32 m0, 158720
 s_nop 0
 buffer_load_dwordx4 v10, s[8:11], s14 offen lds
 s_add_u32 s14, s14, 32768
 s_mov_b32 m0, 159744
 s_nop 0
 buffer_load_dwordx4 v11, s[8:11], s14 offen lds
 s_add_u32 s14, s14, 32768
 s_mov_b32 m0, 160768
 s_nop 0
 buffer_load_dwordx4 v11, s[8:11], s14 offen lds
 s_add_u32 s14, s14, 32768
 s_mov_b32 m0, 161792
 s_nop 0
 buffer_load_dwordx4 v11, s[8:11], s14 offen lds
 s_add_u32 s14, s14, 32768
 s_mov_b32 m0, 162816
 s_nop 0
 buffer_load_dwordx4 v11, s[8:11], s14 offen lds
 s_waitcnt vmcnt(44)
 s_barrier
 v_xor_b32 v16, 0, v12
 v_add_u32 v16, 0, v16
 ds_read_b64_tr_b16 v[240:241], v16 offset:0
 ds_read_b64_tr_b16 v[242:243], v16 offset:8192
 ds_read_b64_tr_b16 v[244:245], v16 offset:2048
 ds_read_b64_tr_b16 v[246:247], v16 offset:10240
 v_xor_b32 v16, 32, v12
 v_add_u32 v16, 0, v16
 ds_read_b64_tr_b16 v[248:249], v16 offset:0
 ds_read_b64_tr_b16 v[250:251], v16 offset:8192
 ds_read_b64_tr_b16 v[252:253], v16 offset:2048
 ds_read_b64_tr_b16 v[254:255], v16 offset:10240
 v_xor_b32 v16, 0, v12
 v_add_u32 v16, 0, v16
 ds_read_b64_tr_b16 v[32:33], v16 offset:16384
 ds_read_b64_tr_b16 v[34:35], v16 offset:24576
 ds_read_b64_tr_b16 v[36:37], v16 offset:18432
 ds_read_b64_tr_b16 v[38:39], v16 offset:26624
 v_xor_b32 v16, 32, v12
 v_add_u32 v16, 0, v16
 ds_read_b64_tr_b16 v[40:41], v16 offset:16384
 ds_read_b64_tr_b16 v[42:43], v16 offset:24576
 ds_read_b64_tr_b16 v[44:45], v16 offset:18432
 ds_read_b64_tr_b16 v[46:47], v16 offset:26624
 s_waitcnt lgkmcnt(0)
 s_barrier
 ds_write_b128 v1, v[232:235] offset:28672
 ds_write_b128 v1, v[236:239] offset:29696
 ds_write_b128 v1, v[224:227] offset:30720
 ds_write_b128 v1, v[228:231] offset:31744
 s_waitcnt lgkmcnt(0)
 v_mov_b32 v232, v32
 v_mov_b32 v233, v33
 v_mov_b32 v234, v34
 v_mov_b32 v235, v35
 v_mov_b32 v236, v36
 v_mov_b32 v237, v37
 v_mov_b32 v238, v38
 v_mov_b32 v239, v39
 v_mov_b32 v224, v40
 v_mov_b32 v225, v41
 v_mov_b32 v226, v42
 v_mov_b32 v227, v43
 v_mov_b32 v228, v44
 v_mov_b32 v229, v45
 v_mov_b32 v230, v46
 v_mov_b32 v231, v47
 s_waitcnt vmcnt(34)
 s_barrier
 v_xor_b32 v16, 0, v12
 v_add_u32 v16, 32768, v16
 ds_read_b64_tr_b16 v[32:33], v16 offset:0
 ds_read_b64_tr_b16 v[34:35], v16 offset:8192
 ds_read_b64_tr_b16 v[36:37], v16 offset:2048
 ds_read_b64_tr_b16 v[38:39], v16 offset:10240
 v_xor_b32 v16, 32, v12
 v_add_u32 v16, 32768, v16
 ds_read_b64_tr_b16 v[40:41], v16 offset:0
 ds_read_b64_tr_b16 v[42:43], v16 offset:8192
 ds_read_b64_tr_b16 v[44:45], v16 offset:2048
 ds_read_b64_tr_b16 v[46:47], v16 offset:10240
 v_xor_b32 v16, 0, v12
 v_add_u32 v16, 32768, v16
 ds_read_b64_tr_b16 v[48:49], v16 offset:16384
 ds_read_b64_tr_b16 v[50:51], v16 offset:24576
 ds_read_b64_tr_b16 v[52:53], v16 offset:18432
 ds_read_b64_tr_b16 v[54:55], v16 offset:26624
 v_xor_b32 v16, 32, v12
 v_add_u32 v16, 32768, v16
 ds_read_b64_tr_b16 v[56:57], v16 offset:16384
 ds_read_b64_tr_b16 v[58:59], v16 offset:24576
 ds_read_b64_tr_b16 v[60:61], v16 offset:18432
 ds_read_b64_tr_b16 v[62:63], v16 offset:26624
 s_waitcnt lgkmcnt(0)
 s_barrier
 ds_write_b128 v1, v[208:211] offset:57344
 ds_write_b128 v1, v[212:215] offset:58368
 ds_write_b128 v1, v[200:203] offset:59392
 ds_write_b128 v1, v[204:207] offset:60416
 ds_write_b128 v1, v[184:187] offset:61440
 ds_write_b128 v1, v[188:191] offset:62464
 ds_write_b128 v1, v[176:179] offset:63488
 ds_write_b128 v1, v[180:183] offset:64512
 s_waitcnt lgkmcnt(0)
 v_mov_b32 v208, v32
 v_mov_b32 v209, v33
 v_mov_b32 v210, v34
 v_mov_b32 v211, v35
 v_mov_b32 v212, v36
 v_mov_b32 v213, v37
 v_mov_b32 v214, v38
 v_mov_b32 v215, v39
 v_mov_b32 v200, v40
 v_mov_b32 v201, v41
 v_mov_b32 v202, v42
 v_mov_b32 v203, v43
 v_mov_b32 v204, v44
 v_mov_b32 v205, v45
 v_mov_b32 v206, v46
 v_mov_b32 v207, v47
 v_mov_b32 v184, v48
 v_mov_b32 v185, v49
 v_mov_b32 v186, v50
 v_mov_b32 v187, v51
 v_mov_b32 v188, v52
 v_mov_b32 v189, v53
 v_mov_b32 v190, v54
 v_mov_b32 v191, v55
 v_mov_b32 v176, v56
 v_mov_b32 v177, v57
 v_mov_b32 v178, v58
 v_mov_b32 v179, v59
 v_mov_b32 v180, v60
 v_mov_b32 v181, v61
 v_mov_b32 v182, v62
 v_mov_b32 v183, v63
 s_waitcnt vmcnt(26)
 s_barrier
 v_xor_b32 v16, 0, v12
 v_add_u32 v16, 65536, v16
 ds_read_b64_tr_b16 v[32:33], v16 offset:0
 ds_read_b64_tr_b16 v[34:35], v16 offset:8192
 ds_read_b64_tr_b16 v[36:37], v16 offset:2048
 ds_read_b64_tr_b16 v[38:39], v16 offset:10240
 v_xor_b32 v16, 32, v12
 v_add_u32 v16, 65536, v16
 ds_read_b64_tr_b16 v[40:41], v16 offset:0
 ds_read_b64_tr_b16 v[42:43], v16 offset:8192
 ds_read_b64_tr_b16 v[44:45], v16 offset:2048
 ds_read_b64_tr_b16 v[46:47], v16 offset:10240
 v_xor_b32 v16, 0, v12
 v_add_u32 v16, 65536, v16
 ds_read_b64_tr_b16 v[48:49], v16 offset:16384
 ds_read_b64_tr_b16 v[50:51], v16 offset:24576
 ds_read_b64_tr_b16 v[52:53], v16 offset:18432
 ds_read_b64_tr_b16 v[54:55], v16 offset:26624
 v_xor_b32 v16, 32, v12
 v_add_u32 v16, 65536, v16
 ds_read_b64_tr_b16 v[56:57], v16 offset:16384
 ds_read_b64_tr_b16 v[58:59], v16 offset:24576
 ds_read_b64_tr_b16 v[60:61], v16 offset:18432
 ds_read_b64_tr_b16 v[62:63], v16 offset:26624
 s_waitcnt lgkmcnt(0)
 s_barrier
 ds_write_b128 v2, v[168:171] offset:24576
 ds_write_b128 v2, v[172:175] offset:25600
 ds_write_b128 v2, v[160:163] offset:26624
 ds_write_b128 v2, v[164:167] offset:27648
 ds_write_b128 v2, v[144:147] offset:28672
 ds_write_b128 v2, v[148:151] offset:29696
 ds_write_b128 v2, v[128:131] offset:30720
 ds_write_b128 v2, v[132:135] offset:31744
 s_waitcnt lgkmcnt(0)
 v_mov_b32 v168, v32
 v_mov_b32 v169, v33
 v_mov_b32 v170, v34
 v_mov_b32 v171, v35
 v_mov_b32 v172, v36
 v_mov_b32 v173, v37
 v_mov_b32 v174, v38
 v_mov_b32 v175, v39
 v_mov_b32 v160, v40
 v_mov_b32 v161, v41
 v_mov_b32 v162, v42
 v_mov_b32 v163, v43
 v_mov_b32 v164, v44
 v_mov_b32 v165, v45
 v_mov_b32 v166, v46
 v_mov_b32 v167, v47
 v_mov_b32 v144, v48
 v_mov_b32 v145, v49
 v_mov_b32 v146, v50
 v_mov_b32 v147, v51
 v_mov_b32 v148, v52
 v_mov_b32 v149, v53
 v_mov_b32 v150, v54
 v_mov_b32 v151, v55
 v_mov_b32 v128, v56
 v_mov_b32 v129, v57
 v_mov_b32 v130, v58
 v_mov_b32 v131, v59
 v_mov_b32 v132, v60
 v_mov_b32 v133, v61
 v_mov_b32 v134, v62
 v_mov_b32 v135, v63
 s_waitcnt vmcnt(10)
 s_barrier
 v_xor_b32 v16, 0, v12
 v_add_u32 v16, 98304, v16
 ds_read_b64_tr_b16 v[32:33], v16 offset:0
 ds_read_b64_tr_b16 v[34:35], v16 offset:8192
 ds_read_b64_tr_b16 v[36:37], v16 offset:2048
 ds_read_b64_tr_b16 v[38:39], v16 offset:10240
 v_xor_b32 v16, 32, v12
 v_add_u32 v16, 98304, v16
 ds_read_b64_tr_b16 v[40:41], v16 offset:0
 ds_read_b64_tr_b16 v[42:43], v16 offset:8192
 ds_read_b64_tr_b16 v[44:45], v16 offset:2048
 ds_read_b64_tr_b16 v[46:47], v16 offset:10240
 v_xor_b32 v16, 0, v12
 v_add_u32 v16, 98304, v16
 ds_read_b64_tr_b16 v[48:49], v16 offset:16384
 ds_read_b64_tr_b16 v[50:51], v16 offset:24576
 ds_read_b64_tr_b16 v[52:53], v16 offset:18432
 ds_read_b64_tr_b16 v[54:55], v16 offset:26624
 v_xor_b32 v16, 32, v12
 v_add_u32 v16, 98304, v16
 ds_read_b64_tr_b16 v[56:57], v16 offset:16384
 ds_read_b64_tr_b16 v[58:59], v16 offset:24576
 ds_read_b64_tr_b16 v[60:61], v16 offset:18432
 ds_read_b64_tr_b16 v[62:63], v16 offset:26624
 s_waitcnt lgkmcnt(0)
 s_barrier
 ds_write_b128 v3, a[136:139] offset:8192
 ds_write_b128 v3, a[140:143] offset:9216
 ds_write_b128 v3, a[128:131] offset:10240
 ds_write_b128 v3, a[132:135] offset:11264
 ds_write_b128 v3, a[120:123] offset:12288
 ds_write_b128 v3, a[124:127] offset:13312
 ds_write_b128 v3, a[88:91] offset:14336
 ds_write_b128 v3, a[92:95] offset:15360
 s_waitcnt lgkmcnt(0)
 v_accvgpr_write_b32 a136, v32
 v_accvgpr_write_b32 a137, v33
 v_accvgpr_write_b32 a138, v34
 v_accvgpr_write_b32 a139, v35
 v_accvgpr_write_b32 a140, v36
 v_accvgpr_write_b32 a141, v37
 v_accvgpr_write_b32 a142, v38
 v_accvgpr_write_b32 a143, v39
 v_accvgpr_write_b32 a128, v40
 v_accvgpr_write_b32 a129, v41
 v_accvgpr_write_b32 a130, v42
 v_accvgpr_write_b32 a131, v43
 v_accvgpr_write_b32 a132, v44
 v_accvgpr_write_b32 a133, v45
 v_accvgpr_write_b32 a134, v46
 v_accvgpr_write_b32 a135, v47
 v_accvgpr_write_b32 a120, v48
 v_accvgpr_write_b32 a121, v49
 v_accvgpr_write_b32 a122, v50
 v_accvgpr_write_b32 a123, v51
 v_accvgpr_write_b32 a124, v52
 v_accvgpr_write_b32 a125, v53
 v_accvgpr_write_b32 a126, v54
 v_accvgpr_write_b32 a127, v55
 v_accvgpr_write_b32 a88, v56
 v_accvgpr_write_b32 a89, v57
 v_accvgpr_write_b32 a90, v58
 v_accvgpr_write_b32 a91, v59
 v_accvgpr_write_b32 a92, v60
 v_accvgpr_write_b32 a93, v61
 v_accvgpr_write_b32 a94, v62
 v_accvgpr_write_b32 a95, v63
 s_waitcnt vmcnt(0)
 s_barrier
 v_xor_b32 v16, 0, v12
 v_add_u32 v16, 131072, v16
 ds_read_b64_tr_b16 v[32:33], v16 offset:0
 ds_read_b64_tr_b16 v[34:35], v16 offset:8192
 ds_read_b64_tr_b16 v[36:37], v16 offset:2048
 ds_read_b64_tr_b16 v[38:39], v16 offset:10240
 v_xor_b32 v16, 32, v12
 v_add_u32 v16, 131072, v16
 ds_read_b64_tr_b16 v[40:41], v16 offset:0
 ds_read_b64_tr_b16 v[42:43], v16 offset:8192
 ds_read_b64_tr_b16 v[44:45], v16 offset:2048
 ds_read_b64_tr_b16 v[46:47], v16 offset:10240
 v_xor_b32 v16, 0, v12
 v_add_u32 v16, 131072, v16
 ds_read_b64_tr_b16 v[48:49], v16 offset:16384
 ds_read_b64_tr_b16 v[50:51], v16 offset:24576
 ds_read_b64_tr_b16 v[52:53], v16 offset:18432
 ds_read_b64_tr_b16 v[54:55], v16 offset:26624
 v_xor_b32 v16, 32, v12
 v_add_u32 v16, 131072, v16
 ds_read_b64_tr_b16 v[56:57], v16 offset:16384
 ds_read_b64_tr_b16 v[58:59], v16 offset:24576
 ds_read_b64_tr_b16 v[60:61], v16 offset:18432
 ds_read_b64_tr_b16 v[62:63], v16 offset:26624
 s_waitcnt lgkmcnt(0)
 s_barrier
 ds_write_b128 v3, a[80:83] offset:40960
 ds_write_b128 v3, a[84:87] offset:41984
 ds_write_b128 v3, a[72:75] offset:43008
 ds_write_b128 v3, a[76:79] offset:44032
 ds_write_b128 v3, a[32:35] offset:45056
 ds_write_b128 v3, a[36:39] offset:46080
 ds_write_b128 v3, a[16:19] offset:47104
 ds_write_b128 v3, a[20:23] offset:48128
 s_waitcnt lgkmcnt(0)
 v_accvgpr_write_b32 a80, v32
 v_accvgpr_write_b32 a81, v33
 v_accvgpr_write_b32 a82, v34
 v_accvgpr_write_b32 a83, v35
 v_accvgpr_write_b32 a84, v36
 v_accvgpr_write_b32 a85, v37
 v_accvgpr_write_b32 a86, v38
 v_accvgpr_write_b32 a87, v39
 v_accvgpr_write_b32 a72, v40
 v_accvgpr_write_b32 a73, v41
 v_accvgpr_write_b32 a74, v42
 v_accvgpr_write_b32 a75, v43
 v_accvgpr_write_b32 a76, v44
 v_accvgpr_write_b32 a77, v45
 v_accvgpr_write_b32 a78, v46
 v_accvgpr_write_b32 a79, v47
 v_accvgpr_write_b32 a32, v48
 v_accvgpr_write_b32 a33, v49
 v_accvgpr_write_b32 a34, v50
 v_accvgpr_write_b32 a35, v51
 v_accvgpr_write_b32 a36, v52
 v_accvgpr_write_b32 a37, v53
 v_accvgpr_write_b32 a38, v54
 v_accvgpr_write_b32 a39, v55
 v_accvgpr_write_b32 a16, v56
 v_accvgpr_write_b32 a17, v57
 v_accvgpr_write_b32 a18, v58
 v_accvgpr_write_b32 a19, v59
 v_accvgpr_write_b32 a20, v60
 v_accvgpr_write_b32 a21, v61
 v_accvgpr_write_b32 a22, v62
 v_accvgpr_write_b32 a23, v63
 v_lshlrev_b32 v5, 3, v0
 v_and_b32 v4, 15, v0
 v_lshlrev_b32 v4, 5, v4
 v_lshrrev_b32 v7, 4, v0
 v_lshl_add_u32 v4, v7, 3, v4
 v_add_u32 v4, 13312, v4
 v_and_b32 v6, 0x1e0, v5
 v_and_b32 v7, 1, v0
 v_lshl_add_u32 v6, v7, 4, v6
 v_and_b32 v7, 2, v0
 v_lshl_add_u32 v6, v7, 2, v6
 s_lshl_b32 s59, s53, 16
 s_add_u32 s59, s59, 917504
 s_mul_i32 s15, s53, 327680
 s_add_u32 s15, s15, 225280
 s_lshl_b32 s3, s52, 6
 s_add_u32 s15, s15, s3
 s_add_u32 s64, s15, 8192
 s_add_u32 s65, s15, 172032
 s_lshr_b32 s14, s52, 4
 s_add_u32 s14, s14, 8
 s_bfe_u32 s15, s52, 0x20002
 s_and_b32 s16, s52, 3
 s_mov_b32 s84, 0x000f000f
 s_mov_b32 s85, 0
 s_lshl_b32 s57, s14, 10
 s_lshl_b32 s3, s15, 6
 s_add_u32 s57, s57, s3
 s_lshl_b32 s3, s16, 8
 s_add_u32 s57, s57, s3
 s_add_u32 s57, s57, s59
 s_add_u32 s59, s59, 6144
 s_waitcnt vmcnt(0) lgkmcnt(0)
 s_mov_b32 s96, s44
 s_and_b32 s97, s45, 0xffff
 s_mov_b32 s98, 256
 s_mov_b32 s99, 0x00020000
 v_mov_b32 v8, 132
 s_mov_b32 s51, 0
 s_mov_b64 exec, 1
L_wb_201:
 buffer_load_dword v9, v8, s[96:99], 0 offen sc1
 s_waitcnt vmcnt(0)
 v_cmp_eq_u32 vcc, 0, v9
 s_cbranch_vccz L_wbd_202
 s_sleep 2
 s_add_u32 s51, s51, 1
 s_cmp_lt_u32 s51, 131072
 s_cbranch_scc1 L_wb_201
 s_branch L_bail
L_wbd_202:
 s_mov_b64 exec, -1
 s_mov_b32 s96, s44
 s_and_b32 s97, s45, 0xffff
 s_mov_b32 s98, 256
 s_mov_b32 s99, 0x00020000
 v_mov_b32 v8, 212
 s_mov_b32 s51, 0
 s_mov_b64 exec, 1
L_wb_203:
 buffer_load_dword v9, v8, s[96:99], 0 offen sc1
 s_waitcnt vmcnt(0)
 v_cmp_eq_u32 vcc, 0, v9
 s_cbranch_vccz L_wbd_204
 s_sleep 2
 s_add_u32 s51, s51, 1
 s_cmp_lt_u32 s51, 131072
 s_cbranch_scc1 L_wb_203
 s_branch L_bail
L_wbd_204:
 s_mov_b64 exec, -1
 s_mov_b32 s96, s44
 s_and_b32 s97, s45, 0xffff
 s_mov_b32 s98, 256
 s_mov_b32 s99, 0x00020000
 v_lshlrev_b32 v8, 5, v0
 s_mov_b32 s51, 0
L_gl_205:
 buffer_load_dword v9, v8, s[96:99], 0 offen sc1
 s_waitcnt vmcnt(0)
 v_readlane_b32 s3, v9, s48
 s_mov_b32 s80, 0
 s_nop 2
 s_cmp_ge_u32 s3, 32
 s_cbranch_scc1 L_gld_206
 s_mov_b32 s80, 0
 v_readlane_b32 s3, v9, 0
 s_nop 3
 s_add_u32 s80, s80, s3
 v_readlane_b32 s3, v9, 1
 s_nop 3
 s_add_u32 s80, s80, s3
 v_readlane_b32 s3, v9, 2
 s_nop 3
 s_add_u32 s80, s80, s3
 v_readlane_b32 s3, v9, 3
 s_nop 3
 s_add_u32 s80, s80, s3
 v_readlane_b32 s3, v9, 4
 s_nop 3
 s_add_u32 s80, s80, s3
 v_readlane_b32 s3, v9, 5
 s_nop 3
 s_add_u32 s80, s80, s3
 v_readlane_b32 s3, v9, 6
 s_nop 3
 s_add_u32 s80, s80, s3
 v_readlane_b32 s3, v9, 7
 s_nop 3
 s_add_u32 s80, s80, s3
 s_cmp_ge_u32 s80, 256
 s_cbranch_scc1 L_gld_206
 s_sleep 4
 s_add_u32 s51, s51, 1
 s_cmp_lt_u32 s51, 131072
 s_cbranch_scc1 L_gl_205
 s_branch L_bail
L_gld_206:
 s_mov_b32 s51, 0
L_f0_207:
 v_mov_b32 v7, 0
 s_mov_b64 exec, 1
 buffer_atomic_add v7, off, s[4:7], s12 sc0
 s_mov_b64 exec, -1
 s_waitcnt vmcnt(0)
 v_readfirstlane_b32 s3, v7
 s_nop 3
 s_cmp_ge_u32 s3, 8
 s_cbranch_scc1 L_f0d_208
 s_sleep 8
 s_add_u32 s51, s51, 1
 s_cmp_lt_u32 s51, 131072
 s_cbranch_scc1 L_f0_207
 s_branch L_bail
L_f0d_208:
 s_add_u32 s12, s12, 4
 v_and_b32 v7, 2, v0
 v_mul_u32_u24 v7, 0x5555, v7
 v_add_u32 v0, 0x4444, v7
 s_mov_b32 m0, 2048
 s_waitcnt vmcnt(0) lgkmcnt(0)
 s_barrier
 buffer_load_dwordx4 v[32:35], v1, s[4:7], s63 offen offset:2048
 buffer_load_dwordx4 v[36:39], v1, s[4:7], s63 offen offset:3072
 s_add_u32 s3, s63, 4096
 buffer_load_dwordx4 v[40:43], v1, s[4:7], s3 offen offset:0
 buffer_load_dwordx4 v[44:47], v1, s[4:7], s3 offen offset:1024
 s_add_u32 s3, s63, 4096
 buffer_load_dwordx4 v[48:51], v1, s[4:7], s3 offen offset:2048
 buffer_load_dwordx4 v[52:55], v1, s[4:7], s3 offen offset:3072
 s_add_u32 s3, s63, 8192
 buffer_load_dwordx4 v[56:59], v1, s[4:7], s3 offen offset:0
 buffer_load_dwordx4 v[60:63], v1, s[4:7], s3 offen offset:1024
 ds_read_b128 v[8:11], v3 offset:49152
 ds_read_b128 v[12:15], v3 offset:49152
 ds_read_b128 v[16:19], v3 offset:49152
 ds_read_b128 v[20:23], v3 offset:49152
 s_waitcnt vmcnt(0) lgkmcnt(0)
 s_cmp_lg_u32 s80, 0
 s_cbranch_scc1 L_ch3_s
.p2align 6
L_ch3_f:
 s_mov_b32 s51, 0
L_pm_209:
 buffer_load_dwordx4 v[24:27], v1, s[4:7], s59 offen offset:0 sc1
 buffer_load_dwordx4 v[28:31], v1, s[4:7], s59 offen offset:1024 sc1
 s_add_u32 s3, s59, 3072
 buffer_load_dwordx4 v[12:15], v1, s[4:7], s3 offen offset:0 sc1
 s_waitcnt vmcnt(2)
 ds_write_b128 v1, v[24:27] offset:6144
 v_max_u32 v7, v24, v26
 s_waitcnt vmcnt(1)
 ds_write_b128 v1, v[28:31] offset:7168
 v_max3_u32 v7, v7, v28, v30
 s_waitcnt vmcnt(0)
 ds_write_b128 v1, v[12:15] offset:9216
 v_max3_u32 v7, v7, v12, v14
 v_cmp_eq_u32 vcc, -1, v7
 s_cbranch_vccnz L_rt_210
 ds_read_b128 v[12:15], v3 offset:49152
 v_smfmac_f32_16x16x64_bf16 v[16:19], v[24:27], v[32:39], v0
 ds_read_b128 v[32:35], v1 offset:30720
 ds_read_b128 v[36:39], v1 offset:31744
 v_smfmac_f32_16x16x64_bf16 v[20:23], v[24:27], v[40:47], v0
 ds_read_b128 v[40:43], v1 offset:28672
 ds_read_b128 v[44:47], v1 offset:29696
 v_smfmac_f32_16x16x64_bf16 v[16:19], v[28:31], v[48:55], v0
 v_smfmac_f32_16x16x64_bf16 v[20:23], v[28:31], v[56:63], v0
 s_waitcnt lgkmcnt(5)
 s_barrier
 buffer_load_dwordx4 v[56:59], v1, s[4:7], s63 offen offset:0
 buffer_load_dwordx4 v[60:63], v1, s[4:7], s63 offen offset:1024
 s_add_u32 s3, s63, 8192
 buffer_load_dwordx4 v[48:51], v1, s[4:7], s3 offen offset:2048
 buffer_load_dwordx4 v[52:55], v1, s[4:7], s3 offen offset:3072
 v_smfmac_f32_16x16x64_bf16 v[8:11], v[24:27], a[136:143], v0
 v_smfmac_f32_16x16x64_bf16 v[8:11], v[28:31], a[120:127], v0
 s_waitcnt lgkmcnt(4)
 v_smfmac_f32_16x16x64_bf16 v[12:15], v[24:27], a[128:135], v0
 ds_read_b128 v[24:27], v1 offset:9216
 v_smfmac_f32_16x16x64_bf16 v[12:15], v[28:31], a[88:95], v0
 ds_read_b128 v[28:31], v1 offset:0
 s_waitcnt lgkmcnt(1)
 v_smfmac_f32_16x16x64_bf16 v[16:19], v[24:27], v[32:39], v0
 ds_read_b128 v[32:35], v2 offset:30720
 ds_read_b128 v[36:39], v2 offset:31744
 v_smfmac_f32_16x16x64_bf16 v[8:11], v[24:27], a[32:39], v0
 v_smfmac_f32_16x16x64_bf16 v[12:15], v[24:27], a[16:23], v0
 v_smfmac_f32_16x16x64_bf16 v[20:23], v[24:27], v[40:47], v0
 ds_read_b128 v[40:43], v2 offset:28672
 ds_read_b128 v[44:47], v2 offset:29696
 ds_read_b128 v[24:27], v1 offset:1024
 s_waitcnt lgkmcnt(5)
 v_smfmac_f32_16x16x64_bf16 v[8:11], v[28:31], v[240:247], v0
 v_smfmac_f32_16x16x64_bf16 v[12:15], v[28:31], v[248:255], v0
 s_waitcnt lgkmcnt(3)
 v_smfmac_f32_16x16x64_bf16 v[16:19], v[28:31], v[32:39], v0
 ds_read_b128 v[32:35], v2 offset:26624
 ds_read_b128 v[36:39], v2 offset:27648
 v_smfmac_f32_16x16x64_bf16 v[20:23], v[28:31], v[136:143], v0
 ds_read_b128 v[28:31], v1 offset:2048
 s_waitcnt lgkmcnt(3)
 v_smfmac_f32_16x16x64_bf16 v[8:11], v[24:27], v[232:239], v0
 v_smfmac_f32_16x16x64_bf16 v[16:19], v[24:27], v[40:47], v0
 ds_read_b128 v[40:43], v2 offset:24576
 ds_read_b128 v[44:47], v2 offset:25600
 v_smfmac_f32_16x16x64_bf16 v[12:15], v[24:27], v[224:231], v0
 v_smfmac_f32_16x16x64_bf16 v[20:23], v[24:27], v[152:159], v0
 ds_read_b128 v[24:27], v1 offset:3072
 s_waitcnt lgkmcnt(3)
 v_smfmac_f32_16x16x64_bf16 v[16:19], v[28:31], v[32:39], v0
 ds_read_b128 v[32:35], v1 offset:63488
 ds_read_b128 v[36:39], v1 offset:64512
 v_smfmac_f32_16x16x64_bf16 v[8:11], v[28:31], v[208:215], v0
 v_smfmac_f32_16x16x64_bf16 v[12:15], v[28:31], v[200:207], v0
 s_waitcnt lgkmcnt(3)
 v_smfmac_f32_16x16x64_bf16 v[20:23], v[28:31], v[40:47], v0
 ds_read_b128 v[40:43], v1 offset:61440
 ds_read_b128 v[44:47], v1 offset:62464
 ds_read_b128 v[28:31], v1 offset:4096
 s_waitcnt lgkmcnt(5)
 v_smfmac_f32_16x16x64_bf16 v[8:11], v[24:27], v[184:191], v0
 v_smfmac_f32_16x16x64_bf16 v[12:15], v[24:27], v[176:183], v0
 s_waitcnt lgkmcnt(3)
 v_smfmac_f32_16x16x64_bf16 v[16:19], v[24:27], v[32:39], v0
 ds_read_b128 v[32:35], v1 offset:59392
 ds_read_b128 v[36:39], v1 offset:60416
 s_waitcnt vmcnt(2)
 v_smfmac_f32_16x16x64_bf16 v[20:23], v[24:27], v[56:63], v0
 s_add_u32 s3, s61, 4096
 buffer_load_dwordx4 v[56:59], v1, s[4:7], s61 offen offset:3072 sc1
 buffer_load_dwordx4 v[60:63], v1, s[4:7], s3 offen offset:3072 sc1
 ds_read_b128 v[24:27], v1 offset:5120
 s_waitcnt lgkmcnt(3)
 v_smfmac_f32_16x16x64_bf16 v[8:11], v[28:31], v[168:175], v0
 v_smfmac_f32_16x16x64_bf16 v[16:19], v[28:31], v[40:47], v0
 ds_read_b128 v[40:43], v1 offset:57344
 ds_read_b128 v[44:47], v1 offset:58368
 v_smfmac_f32_16x16x64_bf16 v[12:15], v[28:31], v[160:167], v0
 v_smfmac_f32_16x16x64_bf16 v[20:23], v[28:31], v[192:199], v0
 ds_read_b128 v[28:31], v1 offset:8192
 s_waitcnt lgkmcnt(3)
 v_smfmac_f32_16x16x64_bf16 v[16:19], v[24:27], v[32:39], v0
 s_add_u32 s3, s61, 67115008
 buffer_load_dwordx4 v[32:35], v1, s[4:7], s3 offen offset:0 sc1
 buffer_load_dwordx4 v[36:39], v1, s[4:7], s3 offen offset:1024 sc1
 v_smfmac_f32_16x16x64_bf16 v[8:11], v[24:27], v[144:151], v0
 v_smfmac_f32_16x16x64_bf16 v[12:15], v[24:27], v[128:135], v0
 s_waitcnt lgkmcnt(1)
 v_smfmac_f32_16x16x64_bf16 v[20:23], v[24:27], v[40:47], v0
 ds_read_b128 v[40:43], v3 offset:49152
 ds_read_b128 v[44:47], v3 offset:49152
 s_waitcnt lgkmcnt(2)
 v_smfmac_f32_16x16x64_bf16 v[8:11], v[28:31], a[80:87], v0
 v_smfmac_f32_16x16x64_bf16 v[12:15], v[28:31], a[72:79], v0
 v_smfmac_f32_16x16x64_bf16 v[16:19], v[28:31], v[216:223], v0
 s_waitcnt vmcnt(4)
 v_smfmac_f32_16x16x64_bf16 v[20:23], v[28:31], v[48:55], v0
 ds_read_b128 v[52:55], v1 offset:0
 v_add_f32 v8, v8, v10
 v_add_f32 v9, v9, v11
 v_cvt_pk_bf16_f32 v8, v8, v9
 v_add_f32 v12, v12, v14
 v_add_f32 v13, v13, v15
 v_cvt_pk_bf16_f32 v12, v12, v13
 ds_write2_b32 v4, v8, v8 offset0:0 offset1:1
 ds_write2_b32 v4, v12, v12 offset0:128 offset1:129
 ds_read_b64_tr_b16 v[12:13], v5 offset:13312
 ds_read_b64_tr_b16 v[14:15], v5 offset:13824
 v_add_f32 v16, v16, v18
 v_add_f32 v17, v17, v19
 v_cvt_pk_bf16_f32 v16, v16, v17
 v_add_f32 v20, v20, v22
 v_add_f32 v21, v21, v23
 v_cvt_pk_bf16_f32 v20, v20, v21
 ds_write2_b32 v4, v16, v20 offset0:0 offset1:128
 ds_read_b64_tr_b16 v[20:21], v5 offset:13312
 ds_read_b64_tr_b16 v[22:23], v5 offset:13824
 s_waitcnt lgkmcnt(9)
 v_smfmac_f32_16x16x64_bf16 v[40:43], v[24:27], a[240:247], v0
 s_waitcnt lgkmcnt(8)
 v_smfmac_f32_16x16x64_bf16 v[44:47], v[24:27], a[248:255], v0
 ds_read_b128 v[24:27], v1 offset:1024
 v_smfmac_f32_16x16x64_bf16 v[40:43], v[28:31], v[96:103], v0
 v_smfmac_f32_16x16x64_bf16 v[44:47], v[28:31], v[104:111], v0
 ds_read_b128 v[28:31], v1 offset:2048
 s_waitcnt vmcnt(3) lgkmcnt(5)
 v_mfma_f32_16x16x32_bf16 v[8:11], v[56:59], v[12:15], 0
 s_waitcnt vmcnt(2) lgkmcnt(4)
 v_mfma_f32_16x16x32_bf16 v[16:19], v[60:63], v[12:15], 0
 s_waitcnt lgkmcnt(2)
 v_mfma_f32_16x16x32_bf16 v[48:51], v[20:23], v[12:15], 0
 v_smfmac_f32_16x16x64_bf16 v[40:43], v[52:55], a[160:167], v0
 v_smfmac_f32_16x16x64_bf16 v[44:47], v[52:55], a[168:175], v0
 ds_read_b128 v[52:55], v1 offset:3072
 s_waitcnt lgkmcnt(2)
 v_smfmac_f32_16x16x64_bf16 v[40:43], v[24:27], a[176:183], v0
 v_cndmask_b32 v8, v8, v16, s[70:71]
 v_cndmask_b32 v9, v9, v17, s[70:71]
 v_cndmask_b32 v10, v10, v18, s[70:71]
 v_cndmask_b32 v11, v11, v19, s[70:71]
 ds_write_b128 v1, v[8:11] offset:13312
 ds_write_b64 v1, v[48:49] offset:15368
 v_smfmac_f32_16x16x64_bf16 v[44:47], v[24:27], a[184:191], v0
 ds_read_b128 v[24:27], v1 offset:4096
 s_waitcnt lgkmcnt(4)
 v_smfmac_f32_16x16x64_bf16 v[40:43], v[28:31], a[192:199], v0
 v_smfmac_f32_16x16x64_bf16 v[44:47], v[28:31], a[200:207], v0
 ds_read_b128 v[28:31], v1 offset:6144
 s_waitcnt lgkmcnt(4)
 v_smfmac_f32_16x16x64_bf16 v[40:43], v[52:55], a[208:215], v0
 v_smfmac_f32_16x16x64_bf16 v[44:47], v[52:55], a[216:223], v0
 ds_read_b128 v[52:55], v1 offset:7168
 s_waitcnt lgkmcnt(2)
 v_smfmac_f32_16x16x64_bf16 v[40:43], v[24:27], a[224:231], v0
 s_barrier
 ds_read_b128 v[56:59], v1 offset:10240
 ds_read_b128 v[60:63], v1 offset:11264
 ds_read_b128 v[16:19], v1 offset:12288
 ds_read_b128 v[12:15], v1 offset:14336
 ds_read_b128 v[48:51], v1 offset:15360
 v_smfmac_f32_16x16x64_bf16 v[44:47], v[24:27], a[232:239], v0
 ds_read_b128 v[24:27], v1 offset:9216
 s_mov_b64 exec, s[68:69]
 buffer_store_dwordx4 v[20:23], v6, s[4:7], s62 offen offset:1536 sc1
 s_mov_b64 exec, -1
 s_waitcnt lgkmcnt(7)
 v_smfmac_f32_16x16x64_bf16 v[40:43], v[28:31], v[64:71], v0
 v_mov_b32 v7, 0
 v_smfmac_f32_16x16x64_bf16 v[44:47], v[28:31], v[72:79], v0
 s_mov_b64 exec, 1
 buffer_atomic_add v7, off, s[4:7], s12 sc0
 s_mov_b64 exec, 2
 buffer_atomic_add v7, off, s[4:7], s13 sc0
 s_mov_b64 exec, -1
 s_waitcnt lgkmcnt(6)
 v_smfmac_f32_16x16x64_bf16 v[40:43], v[52:55], v[80:87], v0
 v_smfmac_f32_16x16x64_bf16 v[44:47], v[52:55], v[88:95], v0
 s_waitcnt lgkmcnt(0)
 v_smfmac_f32_16x16x64_bf16 v[40:43], v[24:27], v[112:119], v0
 v_smfmac_f32_16x16x64_bf16 v[44:47], v[24:27], v[120:127], v0
 v_pk_add_f32 v[8:9], v[8:9], v[56:57]
 v_pk_add_f32 v[10:11], v[10:11], v[58:59]
 v_pk_add_f32 v[60:61], v[60:61], v[16:17]
 v_pk_add_f32 v[62:63], v[62:63], v[18:19]
 v_pk_add_f32 v[12:13], v[12:13], v[14:15]
 v_pk_add_f32 v[48:49], v[48:49], v[50:51]
 v_pk_add_f32 v[8:9], v[8:9], v[60:61]
 v_pk_add_f32 v[10:11], v[10:11], v[62:63]
 v_pk_add_f32 v[48:49], v[12:13], v[48:49]
 v_max3_f32 v50, v8, v9, v10
 v_max3_f32 v50, v50, v11, v48
 v_max_f32 v50, v50, v49
 v_add_f32 v40, v40, v42
 v_add_f32 v41, v41, v43
 v_max_f32_dpp v50, v50, v50 quad_perm:[2,3,0,1] row_mask:0xf bank_mask:0xf
 v_mov_b32 v51, v50
 v_add_f32 v44, v44, v46
 v_add_f32 v45, v45, v47
 v_permlane16_swap_b32 v50, v51
 v_max_f32 v50, v50, v51
 v_mov_b32 v51, v50
 v_cvt_pk_bf16_f32 v40, v40, v41
 v_cvt_pk_bf16_f32 v41, v44, v45
 v_permlane32_swap_b32 v50, v51
 v_max_f32 v50, v50, v51
 v_mul_f32 v50, s56, v50
 v_fma_f32 v48, v48, s56, -v50
 v_fma_f32 v49, v49, s56, -v50
 v_fma_f32 v8, v8, s56, -v50
 v_fma_f32 v9, v9, s56, -v50
 v_fma_f32 v10, v10, s56, -v50
 v_fma_f32 v11, v11, s56, -v50
 v_exp_f32 v48, v48
 v_exp_f32 v49, v49
 ds_read_b128 v[56:59], v3 offset:14336
 ds_read_b128 v[60:63], v3 offset:15360
 v_exp_f32 v8, v8
 v_exp_f32 v9, v9
 ds_read_b128 v[24:27], v3 offset:12288
 ds_read_b128 v[28:31], v3 offset:13312
 v_exp_f32 v10, v10
 buffer_store_dwordx2 v[40:41], v5, s[4:7], s62 offen offset:3584 sc1
 v_exp_f32 v11, v11
 v_cvt_pk_bf16_f32 v14, v48, v49
 v_cvt_pk_bf16_f32 v12, v8, v9
 v_cvt_pk_bf16_f32 v13, v10, v11
 v_cndmask_b32 v52, 0, v14, s[68:69]
 v_cndmask_b32 v53, 0, v14, s[70:71]
 v_cndmask_b32 v22, 0, v12, s[70:71]
 v_cndmask_b32 v23, 0, v13, s[70:71]
 v_mfma_f32_16x16x16_bf16 v[44:47], v[40:41], v[52:53], 0
 v_cndmask_b32 v16, 0, v12, s[68:69]
 v_cndmask_b32 v17, 0, v13, s[68:69]
 v_mov_b32_dpp v18, v22 quad_perm:[2,3,0,1] row_mask:0xf bank_mask:0xf
 v_mov_b32_dpp v19, v23 quad_perm:[2,3,0,1] row_mask:0xf bank_mask:0xf
 v_mov_b32_dpp v20, v16 quad_perm:[2,3,0,1] row_mask:0xf bank_mask:0xf
 v_mov_b32_dpp v21, v17 quad_perm:[2,3,0,1] row_mask:0xf bank_mask:0xf
 s_waitcnt vmcnt(5)
 v_mfma_f32_16x16x32_bf16 v[44:47], v[32:35], v[16:19], v[44:47]
 v_add_f32 v54, v8, v9
 v_add_f32 v55, v48, v49
 s_waitcnt vmcnt(4)
 v_mfma_f32_16x16x32_bf16 v[44:47], v[36:39], v[20:23], v[44:47]
 v_add_f32 v54, v54, v10
 v_fma_f32 v55, v55, 0.5, v11
 v_add_f32 v54, v54, v55
 ds_read_b128 v[16:19], v3 offset:49152
 ds_read_b128 v[20:23], v3 offset:49152
 v_add_f32_dpp v54, v54, v54 quad_perm:[2,3,0,1] row_mask:0xf bank_mask:0xf
 v_mov_b32 v55, v54
 ds_read_b128 v[32:35], v3 offset:49152
 ds_read_b128 v[36:39], v3 offset:49152
 v_permlane16_swap_b32 v54, v55
 v_add_f32 v54, v54, v55
 v_mov_b32 v55, v54
 ds_read_b128 v[8:11], v3 offset:49152
 s_cmp_eq_u32 s54, 63
 v_permlane32_swap_b32 v54, v55
 v_add_f32 v54, v54, v55
 v_rcp_f32 v54, v54
 s_cbranch_scc1 L_ch3_end
 v_mul_f32 v44, v44, v54
 v_mul_f32 v45, v45, v54
 v_cvt_pk_bf16_f32 v42, v44, v45
 v_mul_f32 v46, v46, v54
 v_mul_f32 v47, v47, v54
 v_cvt_pk_bf16_f32 v43, v46, v47
 ds_write_b64 v6, v[42:43] offset:1536
 v_and_b32 v40, -9, v6
 v_mov_b32_dpp v12, v42 quad_perm:[0,1,0,1] row_mask:0xf bank_mask:0xf
 v_mov_b32_dpp v14, v42 quad_perm:[2,3,2,3] row_mask:0xf bank_mask:0xf
 v_mov_b32_dpp v13, v43 quad_perm:[0,1,0,1] row_mask:0xf bank_mask:0xf
 v_mov_b32_dpp v15, v43 quad_perm:[2,3,2,3] row_mask:0xf bank_mask:0xf
 s_waitcnt lgkmcnt(5)
 s_nop 0
 v_smfmac_f32_16x16x64_bf16 v[16:19], v[12:15], a[24:31], v0
 s_waitcnt lgkmcnt(4)
 v_smfmac_f32_16x16x64_bf16 v[20:23], v[12:15], a[56:63], v0
 s_waitcnt lgkmcnt(0)
 s_barrier
 ds_read_b128 v[48:51], v40 offset:0
 ds_read_b128 v[52:55], v40 offset:512
 ds_read_b128 v[44:47], v40 offset:1024
 v_smfmac_f32_16x16x64_bf16 v[32:35], v[12:15], v[56:63], v0
 ds_read_b128 v[56:59], v3 offset:47104
 ds_read_b128 v[60:63], v3 offset:48128
 v_smfmac_f32_16x16x64_bf16 v[36:39], v[12:15], v[24:31], v0
 ds_read_b128 v[24:27], v3 offset:45056
 ds_read_b128 v[28:31], v3 offset:46080
 v_smfmac_f32_16x16x64_bf16 v[8:11], v[12:15], a[152:159], v0
 s_waitcnt lgkmcnt(6)
 v_smfmac_f32_16x16x64_bf16 v[16:19], v[48:51], a[0:7], v0
 s_waitcnt lgkmcnt(5)
 v_smfmac_f32_16x16x64_bf16 v[16:19], v[52:55], a[8:15], v0
 s_waitcnt lgkmcnt(2)
 v_smfmac_f32_16x16x64_bf16 v[16:19], v[44:47], v[56:63], v0
 ds_read_b128 v[56:59], v3 offset:43008
 ds_read_b128 v[60:63], v3 offset:44032
 s_waitcnt lgkmcnt(2)
 v_smfmac_f32_16x16x64_bf16 v[20:23], v[48:51], v[24:31], v0
 ds_read_b128 v[24:27], v3 offset:40960
 ds_read_b128 v[28:31], v3 offset:41984
 v_smfmac_f32_16x16x64_bf16 v[20:23], v[52:55], a[40:47], v0
 v_smfmac_f32_16x16x64_bf16 v[20:23], v[44:47], a[48:55], v0
 v_cvt_pk_bf16_f32 v16, v16, v17
 v_smfmac_f32_16x16x64_bf16 v[32:35], v[48:51], a[64:71], v0
 v_cvt_pk_bf16_f32 v17, v18, v19
 s_waitcnt lgkmcnt(2)
 v_smfmac_f32_16x16x64_bf16 v[32:35], v[52:55], v[56:63], v0
 ds_read_b128 v[56:59], v3 offset:10240
 ds_read_b128 v[60:63], v3 offset:11264
 v_and_or_b32 v16, v16, -2, s55
 s_waitcnt lgkmcnt(2)
 v_smfmac_f32_16x16x64_bf16 v[32:35], v[44:47], v[24:31], v0
 ds_read_b128 v[24:27], v3 offset:8192
 ds_read_b128 v[28:31], v3 offset:9216
 v_cvt_pk_bf16_f32 v18, v20, v21
 v_smfmac_f32_16x16x64_bf16 v[36:39], v[48:51], a[96:103], v0
 v_cvt_pk_bf16_f32 v19, v22, v23
 v_smfmac_f32_16x16x64_bf16 v[36:39], v[52:55], a[104:111], v0
 v_and_or_b32 v18, v18, -2, s55
 buffer_store_dwordx4 v[16:19], v1, s[4:7], s60 offen offset:0
 v_smfmac_f32_16x16x64_bf16 v[36:39], v[44:47], a[112:119], v0
 v_cvt_pk_bf16_f32 v32, v32, v33
 s_waitcnt lgkmcnt(2)
 v_smfmac_f32_16x16x64_bf16 v[8:11], v[48:51], v[56:63], v0
 v_cvt_pk_bf16_f32 v33, v34, v35
 s_waitcnt lgkmcnt(0)
 v_smfmac_f32_16x16x64_bf16 v[8:11], v[52:55], v[24:31], v0
 v_and_or_b32 v32, v32, -2, s55
 v_smfmac_f32_16x16x64_bf16 v[8:11], v[44:47], a[144:151], v0
 v_cvt_pk_bf16_f32 v34, v36, v37
 v_cvt_pk_bf16_f32 v35, v38, v39
 v_and_or_b32 v34, v34, -2, s55
 buffer_store_dwordx4 v[32:35], v1, s[4:7], s60 offen offset:1024
 s_add_u32 s3, s60, 3072
 s_nop 2
 v_cvt_pk_bf16_f32 v8, v8, v9
 v_cvt_pk_bf16_f32 v9, v10, v11
 v_and_or_b32 v8, v8, -2, s55
 buffer_store_dwordx2 v[8:9], v1, s[4:7], s3 offen offset:8
 buffer_load_dwordx4 v[32:35], v1, s[4:7], s63 offen offset:2048
 buffer_load_dwordx4 v[36:39], v1, s[4:7], s63 offen offset:3072
 s_add_u32 s54, s54, 1
 s_add_u32 s61, s61, 524288
 s_and_b32 s3, s54, 7
 s_cselect_b32 s3, 1, -7
 s_lshl_b32 s3, s3, 17
 s_add_u32 s62, s62, s3
 s_and_b32 s3, s54, 3
 s_cselect_b32 s3, 1, -3
 s_lshl_b32 s3, s3, 14
 s_add_u32 s58, s57, s3
 s_add_u32 s59, s59, s3
 s_mov_b32 s51, 0
L_fl_211:
 s_waitcnt vmcnt(6)
 v_readlane_b32 s14, v7, 0
 v_readlane_b32 s15, v7, 1
 s_nop 3
 s_cmp_lt_u32 s14, 8
 s_cbranch_scc1 L_fr_212
 s_add_u32 s15, s15, 8
 s_cmp_le_u32 s15, s54
 s_cbranch_scc1 L_fr_212
 s_add_u32 s12, s12, 4
 s_nop 15
 s_nop 15
 s_nop 15
 s_nop 15
 s_nop 15
 s_nop 15
 s_nop 15
 s_nop 15
 s_nop 15
 s_nop 15
 s_nop 15
 s_nop 3
 s_mov_b32 s57, s58
 s_xor_b32 s55, s55, 1
 s_add_u32 s3, s63, 4096
 buffer_load_dwordx4 v[40:43], v1, s[4:7], s3 offen offset:0
 buffer_load_dwordx4 v[44:47], v1, s[4:7], s3 offen offset:1024
 s_add_u32 s3, s63, 4096
 buffer_load_dwordx4 v[48:51], v1, s[4:7], s3 offen offset:2048
 buffer_load_dwordx4 v[52:55], v1, s[4:7], s3 offen offset:3072
 s_add_u32 s3, s63, 8192
 buffer_load_dwordx4 v[56:59], v1, s[4:7], s3 offen offset:0
 buffer_load_dwordx4 v[60:63], v1, s[4:7], s3 offen offset:1024
 ds_read_b128 v[8:11], v3 offset:49152
 ds_read_b128 v[16:19], v3 offset:49152
 ds_read_b128 v[20:23], v3 offset:49152
 s_waitcnt lgkmcnt(0)
 s_nop 15
 s_nop 15
 s_nop 7
 s_branch L_ch3_f
L_rt_210:
 s_waitcnt lgkmcnt(0)
 s_add_u32 s51, s51, 1
 s_cmp_lt_u32 s51, 131072
 s_cbranch_scc1 L_pm_209
 s_branch L_bail
L_fr_212:
 s_sleep 4
 v_mov_b32 v7, 0
 s_mov_b64 exec, 1
 buffer_atomic_add v7, off, s[4:7], s12 sc0
 s_mov_b64 exec, 2
 buffer_atomic_add v7, off, s[4:7], s13 sc0
 s_mov_b64 exec, -1
 s_waitcnt vmcnt(0)
 s_add_u32 s51, s51, 1
 s_cmp_lt_u32 s51, 131072
 s_cbranch_scc1 L_fl_211
 s_branch L_bail
.p2align 6
L_ch3_s:
 s_mov_b32 s51, 0
L_pm_213:
 buffer_load_dwordx4 v[24:27], v1, s[4:7], s59 offen offset:0 sc1
 buffer_load_dwordx4 v[28:31], v1, s[4:7], s59 offen offset:1024 sc1
 s_add_u32 s3, s59, 3072
 buffer_load_dwordx4 v[12:15], v1, s[4:7], s3 offen offset:0 sc1
 s_waitcnt vmcnt(2)
 ds_write_b128 v1, v[24:27] offset:6144
 v_max_u32 v7, v24, v26
 s_waitcnt vmcnt(1)
 ds_write_b128 v1, v[28:31] offset:7168
 v_max3_u32 v7, v7, v28, v30
 s_waitcnt vmcnt(0)
 ds_write_b128 v1, v[12:15] offset:9216
 v_max3_u32 v7, v7, v12, v14
 v_cmp_eq_u32 vcc, -1, v7
 s_cbranch_vccnz L_rt_214
 ds_read_b128 v[12:15], v3 offset:49152
 v_smfmac_f32_16x16x64_bf16 v[16:19], v[24:27], v[32:39], v0
 ds_read_b128 v[32:35], v1 offset:30720
 ds_read_b128 v[36:39], v1 offset:31744
 v_smfmac_f32_16x16x64_bf16 v[20:23], v[24:27], v[40:47], v0
 ds_read_b128 v[40:43], v1 offset:28672
 ds_read_b128 v[44:47], v1 offset:29696
 v_smfmac_f32_16x16x64_bf16 v[16:19], v[28:31], v[48:55], v0
 v_smfmac_f32_16x16x64_bf16 v[20:23], v[28:31], v[56:63], v0
 s_waitcnt lgkmcnt(5)
 s_barrier
 buffer_load_dwordx4 v[56:59], v1, s[4:7], s63 offen offset:0
 buffer_load_dwordx4 v[60:63], v1, s[4:7], s63 offen offset:1024
 s_add_u32 s3, s63, 8192
 buffer_load_dwordx4 v[48:51], v1, s[4:7], s3 offen offset:2048
 buffer_load_dwordx4 v[52:55], v1, s[4:7], s3 offen offset:3072
 v_smfmac_f32_16x16x64_bf16 v[8:11], v[24:27], a[136:143], v0
 v_smfmac_f32_16x16x64_bf16 v[8:11], v[28:31], a[120:127], v0
 s_waitcnt lgkmcnt(4)
 v_smfmac_f32_16x16x64_bf16 v[12:15], v[24:27], a[128:135], v0
 ds_read_b128 v[24:27], v1 offset:9216
 v_smfmac_f32_16x16x64_bf16 v[12:15], v[28:31], a[88:95], v0
 ds_read_b128 v[28:31], v1 offset:0
 s_waitcnt lgkmcnt(1)
 v_smfmac_f32_16x16x64_bf16 v[16:19], v[24:27], v[32:39], v0
 ds_read_b128 v[32:35], v2 offset:30720
 ds_read_b128 v[36:39], v2 offset:31744
 v_smfmac_f32_16x16x64_bf16 v[8:11], v[24:27], a[32:39], v0
 v_smfmac_f32_16x16x64_bf16 v[12:15], v[24:27], a[16:23], v0
 v_smfmac_f32_16x16x64_bf16 v[20:23], v[24:27], v[40:47], v0
 ds_read_b128 v[40:43], v2 offset:28672
 ds_read_b128 v[44:47], v2 offset:29696
 ds_read_b128 v[24:27], v1 offset:1024
 s_waitcnt lgkmcnt(5)
 v_smfmac_f32_16x16x64_bf16 v[8:11], v[28:31], v[240:247], v0
 v_smfmac_f32_16x16x64_bf16 v[12:15], v[28:31], v[248:255], v0
 s_waitcnt lgkmcnt(3)
 v_smfmac_f32_16x16x64_bf16 v[16:19], v[28:31], v[32:39], v0
 ds_read_b128 v[32:35], v2 offset:26624
 ds_read_b128 v[36:39], v2 offset:27648
 v_smfmac_f32_16x16x64_bf16 v[20:23], v[28:31], v[136:143], v0
 ds_read_b128 v[28:31], v1 offset:2048
 s_waitcnt lgkmcnt(3)
 v_smfmac_f32_16x16x64_bf16 v[8:11], v[24:27], v[232:239], v0
 v_smfmac_f32_16x16x64_bf16 v[16:19], v[24:27], v[40:47], v0
 ds_read_b128 v[40:43], v2 offset:24576
 ds_read_b128 v[44:47], v2 offset:25600
 v_smfmac_f32_16x16x64_bf16 v[12:15], v[24:27], v[224:231], v0
 v_smfmac_f32_16x16x64_bf16 v[20:23], v[24:27], v[152:159], v0
 ds_read_b128 v[24:27], v1 offset:3072
 s_waitcnt lgkmcnt(3)
 v_smfmac_f32_16x16x64_bf16 v[16:19], v[28:31], v[32:39], v0
 ds_read_b128 v[32:35], v1 offset:63488
 ds_read_b128 v[36:39], v1 offset:64512
 v_smfmac_f32_16x16x64_bf16 v[8:11], v[28:31], v[208:215], v0
 v_smfmac_f32_16x16x64_bf16 v[12:15], v[28:31], v[200:207], v0
 s_waitcnt lgkmcnt(3)
 v_smfmac_f32_16x16x64_bf16 v[20:23], v[28:31], v[40:47], v0
 ds_read_b128 v[40:43], v1 offset:61440
 ds_read_b128 v[44:47], v1 offset:62464
 ds_read_b128 v[28:31], v1 offset:4096
 s_waitcnt lgkmcnt(5)
 v_smfmac_f32_16x16x64_bf16 v[8:11], v[24:27], v[184:191], v0
 v_smfmac_f32_16x16x64_bf16 v[12:15], v[24:27], v[176:183], v0
 s_waitcnt lgkmcnt(3)
 v_smfmac_f32_16x16x64_bf16 v[16:19], v[24:27], v[32:39], v0
 ds_read_b128 v[32:35], v1 offset:59392
 ds_read_b128 v[36:39], v1 offset:60416
 s_waitcnt vmcnt(2)
 v_smfmac_f32_16x16x64_bf16 v[20:23], v[24:27], v[56:63], v0
 s_add_u32 s3, s61, 4096
 buffer_load_dwordx4 v[56:59], v1, s[4:7], s61 offen offset:3072 sc1
 buffer_load_dwordx4 v[60:63], v1, s[4:7], s3 offen offset:3072 sc1
 ds_read_b128 v[24:27], v1 offset:5120
 s_waitcnt lgkmcnt(3)
 v_smfmac_f32_16x16x64_bf16 v[8:11], v[28:31], v[168:175], v0
 v_smfmac_f32_16x16x64_bf16 v[16:19], v[28:31], v[40:47], v0
 ds_read_b128 v[40:43], v1 offset:57344
 ds_read_b128 v[44:47], v1 offset:58368
 v_smfmac_f32_16x16x64_bf16 v[12:15], v[28:31], v[160:167], v0
 v_smfmac_f32_16x16x64_bf16 v[20:23], v[28:31], v[192:199], v0
 ds_read_b128 v[28:31], v1 offset:8192
 s_waitcnt lgkmcnt(3)
 v_smfmac_f32_16x16x64_bf16 v[16:19], v[24:27], v[32:39], v0
 s_add_u32 s3, s61, 67115008
 buffer_load_dwordx4 v[32:35], v1, s[4:7], s3 offen offset:0 sc1
 buffer_load_dwordx4 v[36:39], v1, s[4:7], s3 offen offset:1024 sc1
 v_smfmac_f32_16x16x64_bf16 v[8:11], v[24:27], v[144:151], v0
 v_smfmac_f32_16x16x64_bf16 v[12:15], v[24:27], v[128:135], v0
 s_waitcnt lgkmcnt(1)
 v_smfmac_f32_16x16x64_bf16 v[20:23], v[24:27], v[40:47], v0
 ds_read_b128 v[40:43], v3 offset:49152
 ds_read_b128 v[44:47], v3 offset:49152
 s_waitcnt lgkmcnt(2)
 v_smfmac_f32_16x16x64_bf16 v[8:11], v[28:31], a[80:87], v0
 v_smfmac_f32_16x16x64_bf16 v[12:15], v[28:31], a[72:79], v0
 v_smfmac_f32_16x16x64_bf16 v[16:19], v[28:31], v[216:223], v0
 s_waitcnt vmcnt(4)
 v_smfmac_f32_16x16x64_bf16 v[20:23], v[28:31], v[48:55], v0
 ds_read_b128 v[52:55], v1 offset:0
 v_add_f32 v8, v8, v10
 v_add_f32 v9, v9, v11
 v_cvt_pk_bf16_f32 v8, v8, v9
 v_add_f32 v12, v12, v14
 v_add_f32 v13, v13, v15
 v_cvt_pk_bf16_f32 v12, v12, v13
 ds_write2_b32 v4, v8, v8 offset0:0 offset1:1
 ds_write2_b32 v4, v12, v12 offset0:128 offset1:129
 ds_read_b64_tr_b16 v[12:13], v5 offset:13312
 ds_read_b64_tr_b16 v[14:15], v5 offset:13824
 v_add_f32 v16, v16, v18
 v_add_f32 v17, v17, v19
 v_cvt_pk_bf16_f32 v16, v16, v17
 v_add_f32 v20, v20, v22
 v_add_f32 v21, v21, v23
 v_cvt_pk_bf16_f32 v20, v20, v21
 ds_write2_b32 v4, v16, v20 offset0:0 offset1:128
 ds_read_b64_tr_b16 v[20:21], v5 offset:13312
 ds_read_b64_tr_b16 v[22:23], v5 offset:13824
 s_waitcnt lgkmcnt(9)
 v_smfmac_f32_16x16x64_bf16 v[40:43], v[24:27], a[240:247], v0
 s_waitcnt lgkmcnt(8)
 v_smfmac_f32_16x16x64_bf16 v[44:47], v[24:27], a[248:255], v0
 ds_read_b128 v[24:27], v1 offset:1024
 v_smfmac_f32_16x16x64_bf16 v[40:43], v[28:31], v[96:103], v0
 v_smfmac_f32_16x16x64_bf16 v[44:47], v[28:31], v[104:111], v0
 ds_read_b128 v[28:31], v1 offset:2048
 s_waitcnt vmcnt(3) lgkmcnt(5)
 v_mfma_f32_16x16x32_bf16 v[8:11], v[56:59], v[12:15], 0
 s_waitcnt vmcnt(2) lgkmcnt(4)
 v_mfma_f32_16x16x32_bf16 v[16:19], v[60:63], v[12:15], 0
 s_waitcnt lgkmcnt(2)
 v_mfma_f32_16x16x32_bf16 v[48:51], v[20:23], v[12:15], 0
 v_smfmac_f32_16x16x64_bf16 v[40:43], v[52:55], a[160:167], v0
 v_smfmac_f32_16x16x64_bf16 v[44:47], v[52:55], a[168:175], v0
 ds_read_b128 v[52:55], v1 offset:3072
 s_waitcnt lgkmcnt(2)
 v_smfmac_f32_16x16x64_bf16 v[40:43], v[24:27], a[176:183], v0
 v_cndmask_b32 v8, v8, v16, s[70:71]
 v_cndmask_b32 v9, v9, v17, s[70:71]
 v_cndmask_b32 v10, v10, v18, s[70:71]
 v_cndmask_b32 v11, v11, v19, s[70:71]
 ds_write_b128 v1, v[8:11] offset:13312
 ds_write_b64 v1, v[48:49] offset:15368
 v_smfmac_f32_16x16x64_bf16 v[44:47], v[24:27], a[184:191], v0
 ds_read_b128 v[24:27], v1 offset:4096
 s_waitcnt lgkmcnt(4)
 v_smfmac_f32_16x16x64_bf16 v[40:43], v[28:31], a[192:199], v0
 v_smfmac_f32_16x16x64_bf16 v[44:47], v[28:31], a[200:207], v0
 ds_read_b128 v[28:31], v1 offset:6144
 s_waitcnt lgkmcnt(4)
 v_smfmac_f32_16x16x64_bf16 v[40:43], v[52:55], a[208:215], v0
 v_smfmac_f32_16x16x64_bf16 v[44:47], v[52:55], a[216:223], v0
 ds_read_b128 v[52:55], v1 offset:7168
 s_waitcnt lgkmcnt(2)
 v_smfmac_f32_16x16x64_bf16 v[40:43], v[24:27], a[224:231], v0
 s_barrier
 ds_read_b128 v[56:59], v1 offset:10240
 ds_read_b128 v[60:63], v1 offset:11264
 ds_read_b128 v[16:19], v1 offset:12288
 ds_read_b128 v[12:15], v1 offset:14336
 ds_read_b128 v[48:51], v1 offset:15360
 v_smfmac_f32_16x16x64_bf16 v[44:47], v[24:27], a[232:239], v0
 ds_read_b128 v[24:27], v1 offset:9216
 s_mov_b64 exec, s[68:69]
 buffer_store_dwordx4 v[20:23], v6, s[4:7], s62 offen offset:1536 sc1
 s_mov_b64 exec, -1
 s_waitcnt lgkmcnt(7)
 v_smfmac_f32_16x16x64_bf16 v[40:43], v[28:31], v[64:71], v0
 v_mov_b32 v7, 0
 v_smfmac_f32_16x16x64_bf16 v[44:47], v[28:31], v[72:79], v0
 s_mov_b64 exec, 1
 buffer_atomic_add v7, off, s[4:7], s12 sc0
 s_mov_b64 exec, 2
 buffer_atomic_add v7, off, s[4:7], s13 sc0
 s_mov_b64 exec, -1
 s_waitcnt lgkmcnt(6)
 v_smfmac_f32_16x16x64_bf16 v[40:43], v[52:55], v[80:87], v0
 v_smfmac_f32_16x16x64_bf16 v[44:47], v[52:55], v[88:95], v0
 s_waitcnt lgkmcnt(0)
 v_smfmac_f32_16x16x64_bf16 v[40:43], v[24:27], v[112:119], v0
 v_smfmac_f32_16x16x64_bf16 v[44:47], v[24:27], v[120:127], v0
 v_pk_add_f32 v[8:9], v[8:9], v[56:57]
 v_pk_add_f32 v[10:11], v[10:11], v[58:59]
 v_pk_add_f32 v[60:61], v[60:61], v[16:17]
 v_pk_add_f32 v[62:63], v[62:63], v[18:19]
 v_pk_add_f32 v[12:13], v[12:13], v[14:15]
 v_pk_add_f32 v[48:49], v[48:49], v[50:51]
 v_pk_add_f32 v[8:9], v[8:9], v[60:61]
 v_pk_add_f32 v[10:11], v[10:11], v[62:63]
 v_pk_add_f32 v[48:49], v[12:13], v[48:49]
 v_max3_f32 v50, v8, v9, v10
 v_max3_f32 v50, v50, v11, v48
 v_max_f32 v50, v50, v49
 v_add_f32 v40, v40, v42
 v_add_f32 v41, v41, v43
 v_max_f32_dpp v50, v50, v50 quad_perm:[2,3,0,1] row_mask:0xf bank_mask:0xf
 v_mov_b32 v51, v50
 v_add_f32 v44, v44, v46
 v_add_f32 v45, v45, v47
 v_permlane16_swap_b32 v50, v51
 v_max_f32 v50, v50, v51
 v_mov_b32 v51, v50
 v_cvt_pk_bf16_f32 v40, v40, v41
 v_cvt_pk_bf16_f32 v41, v44, v45
 v_permlane32_swap_b32 v50, v51
 v_max_f32 v50, v50, v51
 v_mul_f32 v50, s56, v50
 v_fma_f32 v48, v48, s56, -v50
 v_fma_f32 v49, v49, s56, -v50
 v_fma_f32 v8, v8, s56, -v50
 v_fma_f32 v9, v9, s56, -v50
 v_fma_f32 v10, v10, s56, -v50
 v_fma_f32 v11, v11, s56, -v50
 v_exp_f32 v48, v48
 v_exp_f32 v49, v49
 ds_read_b128 v[56:59], v3 offset:14336
 ds_read_b128 v[60:63], v3 offset:15360
 v_exp_f32 v8, v8
 v_exp_f32 v9, v9
 ds_read_b128 v[24:27], v3 offset:12288
 ds_read_b128 v[28:31], v3 offset:13312
 v_exp_f32 v10, v10
 buffer_store_dwordx2 v[40:41], v5, s[4:7], s62 offen offset:3584 sc1
 v_exp_f32 v11, v11
 v_cvt_pk_bf16_f32 v14, v48, v49
 v_cvt_pk_bf16_f32 v12, v8, v9
 v_cvt_pk_bf16_f32 v13, v10, v11
 v_cndmask_b32 v52, 0, v14, s[68:69]
 v_cndmask_b32 v53, 0, v14, s[70:71]
 v_cndmask_b32 v22, 0, v12, s[70:71]
 v_cndmask_b32 v23, 0, v13, s[70:71]
 v_mfma_f32_16x16x16_bf16 v[44:47], v[40:41], v[52:53], 0
 v_cndmask_b32 v16, 0, v12, s[68:69]
 v_cndmask_b32 v17, 0, v13, s[68:69]
 v_mov_b32_dpp v18, v22 quad_perm:[2,3,0,1] row_mask:0xf bank_mask:0xf
 v_mov_b32_dpp v19, v23 quad_perm:[2,3,0,1] row_mask:0xf bank_mask:0xf
 v_mov_b32_dpp v20, v16 quad_perm:[2,3,0,1] row_mask:0xf bank_mask:0xf
 v_mov_b32_dpp v21, v17 quad_perm:[2,3,0,1] row_mask:0xf bank_mask:0xf
 s_waitcnt vmcnt(5)
 v_mfma_f32_16x16x32_bf16 v[44:47], v[32:35], v[16:19], v[44:47]
 v_add_f32 v54, v8, v9
 v_add_f32 v55, v48, v49
 s_waitcnt vmcnt(4)
 v_mfma_f32_16x16x32_bf16 v[44:47], v[36:39], v[20:23], v[44:47]
 v_add_f32 v54, v54, v10
 v_fma_f32 v55, v55, 0.5, v11
 v_add_f32 v54, v54, v55
 ds_read_b128 v[16:19], v3 offset:49152
 ds_read_b128 v[20:23], v3 offset:49152
 v_add_f32_dpp v54, v54, v54 quad_perm:[2,3,0,1] row_mask:0xf bank_mask:0xf
 v_mov_b32 v55, v54
 ds_read_b128 v[32:35], v3 offset:49152
 ds_read_b128 v[36:39], v3 offset:49152
 v_permlane16_swap_b32 v54, v55
 v_add_f32 v54, v54, v55
 v_mov_b32 v55, v54
 ds_read_b128 v[8:11], v3 offset:49152
 s_cmp_eq_u32 s54, 63
 v_permlane32_swap_b32 v54, v55
 v_add_f32 v54, v54, v55
 v_rcp_f32 v54, v54
 s_cbranch_scc1 L_ch3_end
 v_mul_f32 v44, v44, v54
 v_mul_f32 v45, v45, v54
 v_cvt_pk_bf16_f32 v42, v44, v45
 v_mul_f32 v46, v46, v54
 v_mul_f32 v47, v47, v54
 v_cvt_pk_bf16_f32 v43, v46, v47
 ds_write_b64 v6, v[42:43] offset:1536
 v_and_b32 v40, -9, v6
 v_mov_b32_dpp v12, v42 quad_perm:[0,1,0,1] row_mask:0xf bank_mask:0xf
 v_mov_b32_dpp v14, v42 quad_perm:[2,3,2,3] row_mask:0xf bank_mask:0xf
 v_mov_b32_dpp v13, v43 quad_perm:[0,1,0,1] row_mask:0xf bank_mask:0xf
 v_mov_b32_dpp v15, v43 quad_perm:[2,3,2,3] row_mask:0xf bank_mask:0xf
 s_waitcnt lgkmcnt(5)
 s_nop 0
 v_smfmac_f32_16x16x64_bf16 v[16:19], v[12:15], a[24:31], v0
 s_waitcnt lgkmcnt(4)
 v_smfmac_f32_16x16x64_bf16 v[20:23], v[12:15], a[56:63], v0
 s_waitcnt lgkmcnt(0)
 s_barrier
 ds_read_b128 v[48:51], v40 offset:0
 ds_read_b128 v[52:55], v40 offset:512
 ds_read_b128 v[44:47], v40 offset:1024
 v_smfmac_f32_16x16x64_bf16 v[32:35], v[12:15], v[56:63], v0
 ds_read_b128 v[56:59], v3 offset:47104
 ds_read_b128 v[60:63], v3 offset:48128
 v_smfmac_f32_16x16x64_bf16 v[36:39], v[12:15], v[24:31], v0
 ds_read_b128 v[24:27], v3 offset:45056
 ds_read_b128 v[28:31], v3 offset:46080
 v_smfmac_f32_16x16x64_bf16 v[8:11], v[12:15], a[152:159], v0
 s_waitcnt lgkmcnt(6)
 v_smfmac_f32_16x16x64_bf16 v[16:19], v[48:51], a[0:7], v0
 s_waitcnt lgkmcnt(5)
 v_smfmac_f32_16x16x64_bf16 v[16:19], v[52:55], a[8:15], v0
 s_waitcnt lgkmcnt(2)
 v_smfmac_f32_16x16x64_bf16 v[16:19], v[44:47], v[56:63], v0
 ds_read_b128 v[56:59], v3 offset:43008
 ds_read_b128 v[60:63], v3 offset:44032
 s_waitcnt lgkmcnt(2)
 v_smfmac_f32_16x16x64_bf16 v[20:23], v[48:51], v[24:31], v0
 ds_read_b128 v[24:27], v3 offset:40960
 ds_read_b128 v[28:31], v3 offset:41984
 v_smfmac_f32_16x16x64_bf16 v[20:23], v[52:55], a[40:47], v0
 v_smfmac_f32_16x16x64_bf16 v[20:23], v[44:47], a[48:55], v0
 v_cvt_pk_bf16_f32 v16, v16, v17
 v_smfmac_f32_16x16x64_bf16 v[32:35], v[48:51], a[64:71], v0
 v_cvt_pk_bf16_f32 v17, v18, v19
 s_waitcnt lgkmcnt(2)
 v_smfmac_f32_16x16x64_bf16 v[32:35], v[52:55], v[56:63], v0
 ds_read_b128 v[56:59], v3 offset:10240
 ds_read_b128 v[60:63], v3 offset:11264
 v_and_or_b32 v16, v16, -2, s55
 s_waitcnt lgkmcnt(2)
 v_smfmac_f32_16x16x64_bf16 v[32:35], v[44:47], v[24:31], v0
 ds_read_b128 v[24:27], v3 offset:8192
 ds_read_b128 v[28:31], v3 offset:9216
 v_cvt_pk_bf16_f32 v18, v20, v21
 v_smfmac_f32_16x16x64_bf16 v[36:39], v[48:51], a[96:103], v0
 v_cvt_pk_bf16_f32 v19, v22, v23
 v_smfmac_f32_16x16x64_bf16 v[36:39], v[52:55], a[104:111], v0
 v_and_or_b32 v18, v18, -2, s55
 buffer_store_dwordx4 v[16:19], v1, s[4:7], s60 offen offset:0 sc1
 v_smfmac_f32_16x16x64_bf16 v[36:39], v[44:47], a[112:119], v0
 v_cvt_pk_bf16_f32 v32, v32, v33
 s_waitcnt lgkmcnt(2)
 v_smfmac_f32_16x16x64_bf16 v[8:11], v[48:51], v[56:63], v0
 v_cvt_pk_bf16_f32 v33, v34, v35
 s_waitcnt lgkmcnt(0)
 v_smfmac_f32_16x16x64_bf16 v[8:11], v[52:55], v[24:31], v0
 v_and_or_b32 v32, v32, -2, s55
 v_smfmac_f32_16x16x64_bf16 v[8:11], v[44:47], a[144:151], v0
 v_cvt_pk_bf16_f32 v34, v36, v37
 v_cvt_pk_bf16_f32 v35, v38, v39
 v_and_or_b32 v34, v34, -2, s55
 buffer_store_dwordx4 v[32:35], v1, s[4:7], s60 offen offset:1024 sc1
 s_add_u32 s3, s60, 3072
 s_nop 2
 v_cvt_pk_bf16_f32 v8, v8, v9
 v_cvt_pk_bf16_f32 v9, v10, v11
 v_and_or_b32 v8, v8, -2, s55
 buffer_store_dwordx2 v[8:9], v1, s[4:7], s3 offen offset:8 sc1
 buffer_load_dwordx4 v[32:35], v1, s[4:7], s63 offen offset:2048
 buffer_load_dwordx4 v[36:39], v1, s[4:7], s63 offen offset:3072
 s_add_u32 s54, s54, 1
 s_add_u32 s61, s61, 524288
 s_and_b32 s3, s54, 7
 s_cselect_b32 s3, 1, -7
 s_lshl_b32 s3, s3, 17
 s_add_u32 s62, s62, s3
 s_and_b32 s3, s54, 3
 s_cselect_b32 s3, 1, -3
 s_lshl_b32 s3, s3, 14
 s_add_u32 s58, s57, s3
 s_add_u32 s59, s59, s3
 s_mov_b32 s51, 0
L_fl_215:
 s_waitcnt vmcnt(6)
 v_readlane_b32 s14, v7, 0
 v_readlane_b32 s15, v7, 1
 s_nop 3
 s_cmp_lt_u32 s14, 8
 s_cbranch_scc1 L_fr_216
 s_add_u32 s15, s15, 8
 s_cmp_le_u32 s15, s54
 s_cbranch_scc1 L_fr_216
 s_add_u32 s12, s12, 4
 s_nop 15
 s_nop 15
 s_nop 15
 s_nop 15
 s_nop 15
 s_nop 15
 s_nop 15
 s_nop 15
 s_nop 15
 s_nop 15
 s_nop 15
 s_nop 3
 s_mov_b32 s57, s58
 s_xor_b32 s55, s55, 1
 s_add_u32 s3, s63, 4096
 buffer_load_dwordx4 v[40:43], v1, s[4:7], s3 offen offset:0
 buffer_load_dwordx4 v[44:47], v1, s[4:7], s3 offen offset:1024
 s_add_u32 s3, s63, 4096
 buffer_load_dwordx4 v[48:51], v1, s[4:7], s3 offen offset:2048
 buffer_load_dwordx4 v[52:55], v1, s[4:7], s3 offen offset:3072
 s_add_u32 s3, s63, 8192
 buffer_load_dwordx4 v[56:59], v1, s[4:7], s3 offen offset:0
 buffer_load_dwordx4 v[60:63], v1, s[4:7], s3 offen offset:1024
 ds_read_b128 v[8:11], v3 offset:49152
 ds_read_b128 v[16:19], v3 offset:49152
 ds_read_b128 v[20:23], v3 offset:49152
 s_waitcnt lgkmcnt(0)
 s_nop 15
 s_nop 15
 s_nop 7
 s_branch L_ch3_s
L_rt_214:
 s_waitcnt lgkmcnt(0)
 s_add_u32 s51, s51, 1
 s_cmp_lt_u32 s51, 131072
 s_cbranch_scc1 L_pm_213
 s_branch L_bail
L_fr_216:
 s_sleep 4
 v_mov_b32 v7, 0
 s_mov_b64 exec, 1
 buffer_atomic_add v7, off, s[4:7], s12 sc0
 s_mov_b64 exec, 2
 buffer_atomic_add v7, off, s[4:7], s13 sc0
 s_mov_b64 exec, -1
 s_waitcnt vmcnt(0)
 s_add_u32 s51, s51, 1
 s_cmp_lt_u32 s51, 131072
 s_cbranch_scc1 L_fl_215
 s_branch L_bail
L_ch3_end:
 s_waitcnt vmcnt(0)
 s_endpgm
L_code_end:
 s_endpgm
.section .rodata,"a"
.p2align 6
.amdhsa_kernel interleave_layers__memory_aug_recurrent_mem_tr__ssm_conv_h3__prompt_kernel
  .amdhsa_next_free_vgpr 512
  .amdhsa_next_free_sgpr 102
  .amdhsa_accum_offset 256
  .amdhsa_group_segment_fixed_size 0
  .amdhsa_kernarg_size 128
  .amdhsa_user_sgpr_count 2
  .amdhsa_user_sgpr_kernarg_segment_ptr 1
  .amdhsa_system_sgpr_workgroup_id_x 1
  .amdhsa_float_denorm_mode_32 3
.end_amdhsa_kernel
.text
```

```asm
; @launch grid=(256,1,1) block=(256,1,1) lds=163840
.amdgcn_target "amdgcn-amd-amdhsa--gfx950"
.text
.globl interleave_layers__memory_aug_recurrent_mem_tr__ssm_conv_h3__prompt_kernel
.p2align 8
.type interleave_layers__memory_aug_recurrent_mem_tr__ssm_conv_h3__prompt_kernel,@function
interleave_layers__memory_aug_recurrent_mem_tr__ssm_conv_h3__prompt_kernel:
 s_cmp_ge_u32 s2, 256
 s_cbranch_scc1 L_bail
 s_load_dwordx16 s[16:31], s[0:1], 0
 s_load_dwordx16 s[32:47], s[0:1], 64
 s_getreg_b32 s48, hwreg(HW_REG_XCC_ID, 0, 3)
 v_lshrrev_b32 v1, 6, v0
 v_and_b32 v0, 63, v0
 s_nop 0
 v_readfirstlane_b32 s50, v1
 s_waitcnt lgkmcnt(0)
 s_mov_b32 s4, s46
 s_and_b32 s5, s47, 0xffff
 s_mov_b32 s6, 268435456
 s_mov_b32 s7, 0x00020000
 s_mov_b32 s8, s46
 s_and_b32 s9, s47, 0xffff
 s_mov_b32 s10, 268435456
 s_mov_b32 s11, 0x00020000
 s_mov_b32 s12, s46
 s_and_b32 s13, s47, 0xffff
 s_mov_b32 s14, 268435456
 s_mov_b32 s15, 0x00020000
 s_mov_b32 s96, s44
 s_and_b32 s97, s45, 0xffff
 s_mov_b32 s98, 256
 s_mov_b32 s99, 0x00020000
 s_cmp_lg_u32 s50, 0
 s_cbranch_scc1 L_tk_wait
 s_mov_b32 s96, s44
 s_and_b32 s97, s45, 0xffff
 s_mov_b32 s98, 256
 s_mov_b32 s99, 0x00020000
 s_lshl_b32 s3, s48, 5
 v_mov_b32 v1, 1
 v_mov_b32 v2, 0
 s_mov_b64 exec, 1
 buffer_atomic_add v1, off, s[96:99], s3 sc0
 s_waitcnt vmcnt(0)
 s_mov_b64 exec, -1
 v_readfirstlane_b32 s60, v1
 s_nop 3
 s_cmp_lt_u32 s60, 32
 s_cbranch_scc1 L_tk_ok
 v_lshlrev_b32 v3, 5, v0
 s_mov_b32 s51, 0
L_tk_lp:
 buffer_load_dword v4, v3, s[96:99], 0 offen sc1
 s_waitcnt vmcnt(0)
 s_mov_b32 s61, 0
 v_readlane_b32 s64, v4, 0
 s_nop 3
 s_add_u32 s61, s61, s64
 v_readlane_b32 s65, v4, 1
 s_nop 3
 s_add_u32 s61, s61, s65
 v_readlane_b32 s66, v4, 2
 s_nop 3
 s_add_u32 s61, s61, s66
 v_readlane_b32 s67, v4, 3
 s_nop 3
 s_add_u32 s61, s61, s67
 v_readlane_b32 s68, v4, 4
 s_nop 3
 s_add_u32 s61, s61, s68
 v_readlane_b32 s69, v4, 5
 s_nop 3
 s_add_u32 s61, s61, s69
 v_readlane_b32 s70, v4, 6
 s_nop 3
 s_add_u32 s61, s61, s70
 v_readlane_b32 s71, v4, 7
 s_nop 3
 s_add_u32 s61, s61, s71
 s_cmp_ge_u32 s61, 256
 s_cbranch_scc1 L_tk_all
 s_sleep 4
 s_add_u32 s51, s51, 1
 s_cmp_lt_u32 s51, 131072
 s_cbranch_scc1 L_tk_lp
 s_branch L_bail
L_tk_all:
 v_mov_b32 v1, 1
 s_mov_b64 exec, 1
 buffer_atomic_add v1, off, s[96:99], 0 offset:20 sc0
 s_waitcnt vmcnt(0)
 s_mov_b64 exec, -1
 v_readfirstlane_b32 s61, v1
 s_nop 3
 s_min_u32 s62, s64, 32
 s_add_u32 s60, s62, s61
 s_mov_b32 s48, 0
 s_cmp_lt_u32 s60, 32
 s_cbranch_scc1 L_tk_ok
 s_sub_u32 s61, s60, 32
 s_min_u32 s62, s65, 32
 s_add_u32 s60, s62, s61
 s_mov_b32 s48, 1
 s_cmp_lt_u32 s60, 32
 s_cbranch_scc1 L_tk_ok
 s_sub_u32 s61, s60, 32
 s_min_u32 s62, s66, 32
 s_add_u32 s60, s62, s61
 s_mov_b32 s48, 2
 s_cmp_lt_u32 s60, 32
 s_cbranch_scc1 L_tk_ok
 s_sub_u32 s61, s60, 32
 s_min_u32 s62, s67, 32
 s_add_u32 s60, s62, s61
 s_mov_b32 s48, 3
 s_cmp_lt_u32 s60, 32
 s_cbranch_scc1 L_tk_ok
 s_sub_u32 s61, s60, 32
 s_min_u32 s62, s68, 32
 s_add_u32 s60, s62, s61
 s_mov_b32 s48, 4
 s_cmp_lt_u32 s60, 32
 s_cbranch_scc1 L_tk_ok
 s_sub_u32 s61, s60, 32
 s_min_u32 s62, s69, 32
 s_add_u32 s60, s62, s61
 s_mov_b32 s48, 5
 s_cmp_lt_u32 s60, 32
 s_cbranch_scc1 L_tk_ok
 s_sub_u32 s61, s60, 32
 s_min_u32 s62, s70, 32
 s_add_u32 s60, s62, s61
 s_mov_b32 s48, 6
 s_cmp_lt_u32 s60, 32
 s_cbranch_scc1 L_tk_ok
 s_sub_u32 s61, s60, 32
 s_min_u32 s62, s71, 32
 s_add_u32 s60, s62, s61
 s_mov_b32 s48, 7
 s_cmp_lt_u32 s60, 32
 s_cbranch_scc1 L_tk_ok
 s_sub_u32 s61, s60, 32
 s_mov_b32 s48, 8
 s_mov_b32 s60, 0
L_tk_ok:
 s_lshl_b32 s3, s48, 5
 s_add_u32 s3, s3, s60
 v_mov_b32 v1, s3
 ds_write_b32 v2, v1
 s_waitcnt lgkmcnt(0)
L_tk_wait:
 s_barrier
 v_mov_b32 v2, 0
 ds_read_b32 v1, v2
 s_waitcnt lgkmcnt(0)
 v_readfirstlane_b32 s101, v1
 s_barrier
 s_mov_b32 s51, 0
 s_cmp_ge_u32 s101, 256
 s_cbranch_scc1 L_bail
 s_lshr_b32 s48, s101, 5
 s_and_b32 s48, s48, 7
 s_and_b32 s49, s101, 31
 s_mov_b32 s53, 0
 s_cmp_eq_u32 s48, 0
 s_cbranch_scc1 L_ch
 s_mov_b32 s53, 1
 s_cmp_eq_u32 s48, 4
 s_cbranch_scc1 L_ch
 s_cmp_gt_u32 s48, 4
 s_cselect_b32 s60, 2, 1
 s_sub_u32 s60, s48, s60
 s_lshl_b32 s3, s60, 4
 s_add_u32 s3, s3, s49
 s_cmp_lt_u32 s49, 16
 s_cbranch_scc1 L_qkv_idx
 s_lshl_b32 s82, s60, 2
 s_add_u32 s82, s82, s49
 s_add_u32 s82, s82, 56
 s_mov_b32 s83, 2
 s_cmp_lt_u32 s49, 20
 s_cbranch_scc1 L_helper
 s_min_u32 s61, s60, 2
 s_add_u32 s62, s61, s60
 s_mul_i32 s62, s62, 5
 s_mul_i32 s63, s60, 12
 s_sub_u32 s63, s63, s62
 s_cmp_lt_u32 s60, 2
 s_cselect_b32 s61, 30, 25
 s_sub_u32 s52, s49, s61
 s_add_u32 s52, s52, s63
 s_mov_b32 s82, s52
 s_mov_b32 s83, 0
 s_cmp_ge_u32 s49, s61
 s_cbranch_scc1 L_helper
 s_add_u32 s3, s62, s49
 s_sub_u32 s3, s3, 20
 s_mul_i32 s52, s3, 13108
 s_lshr_b32 s52, s52, 16
 s_mul_i32 s53, s52, 5
 s_sub_u32 s53, s3, s53
 s_add_u32 s82, s3, 32
 s_mov_b32 s83, 1
 s_branch L_helper
L_qkv_idx:
 s_mul_i32 s52, s3, 21846
 s_lshr_b32 s52, s52, 16
 s_mul_i32 s53, s52, 3
 s_sub_u32 s53, s3, s53
 s_mov_b32 s8, s24
 s_and_b32 s9, s25, 0xffff
 s_mov_b32 s10, 5242880
 s_mov_b32 s11, 0x00020000
 s_cmp_eq_u32 s53, 2
 s_cbranch_scc1 L_qkvv
 s_cmp_eq_u32 s53, 0
 s_cselect_b32 s8, s20, s22
 s_cselect_b32 s9, s21, s23
 s_and_b32 s9, s9, 0xffff
 s_branch L_qkvq
L_conv0:
 s_mov_b32 s8, s38
 s_and_b32 s9, s39, 0xffff
 s_mov_b32 s10, 2621440
 s_mov_b32 s11, 0x00020000
 s_mov_b32 s12, s40
 s_and_b32 s13, s41, 0xffff
 s_mov_b32 s14, 1280
 s_mov_b32 s15, 0x00020000
 v_lshlrev_b32 v130, 4, v0
 v_add_u32 v7, s71, v130
 v_mov_b32 v8, 0
 v_mov_b32 v9, 0
 v_mov_b32 v10, 0
 v_mov_b32 v11, 0
 s_mov_b32 exec_hi, 0
 ds_write_b128 v7, v[8:11] offset:0
 s_mov_b32 exec_lo, 3
 ds_write_b128 v7, v[8:11] offset:4608
 ds_write_b128 v7, v[8:11] offset:8768
 s_mov_b64 exec, -1
 v_and_b32 v8, 15, v0
 v_lshrrev_b32 v9, 5, v0
 v_sub_u32 v10, v8, v9
 v_lshlrev_b32 v10, 5, v10
 v_and_b32 v11, 16, v0
 v_add_u32 v10, v10, v11
 s_add_u32 s3, s71, 64
 v_add_u32 v14, s3, v10
 v_lshlrev_b32 v10, 5, v9
 v_lshl_add_u32 v10, v8, 1, v10
 v_sub_u32 v10, v10, v11
 v_and_b32 v11, 1, v0
 v_cmp_eq_u32 vcc, 1, v11
 v_mov_b32 v12, 8784
 v_mov_b32 v11, 4626
 s_nop 0
 v_cndmask_b32 v11, v12, v11, vcc
 v_add3_u32 v16, v10, v11, s71
 v_add_u32 v17, 512, v16
 v_add_u32 v18, 1024, v16
 v_add_u32 v19, 1536, v16
 v_lshlrev_b32 v10, 5, v8
 v_lshl_add_u32 v10, v9, 4, v10
 v_and_b32 v11, 16, v0
 v_lshrrev_b32 v11, 1, v11
 v_xor_b32 v11, 8, v11
 s_add_u32 s3, s71, 512
 v_add3_u32 v15, v10, v11, s3
 v_and_b32 v10, 1, v0
 v_lshlrev_b32 v10, 4, v10
 v_lshrrev_b32 v11, 4, v0
 v_lshl_add_u32 v10, v11, 2, v10
 s_mov_b32 s3, 40960
 v_mul_lo_u32 v13, v10, s3
 v_lshrrev_b32 v11, 1, v8
 v_lshl_add_u32 v13, v11, 3, v13
 s_cmp_lg_u32 s50, 0
 s_cbranch_scc1 L_ww_1
 s_mov_b32 s96, s44
 s_and_b32 s97, s45, 0xffff
 s_mov_b32 s98, 256
 s_mov_b32 s99, 0x00020000
 v_mov_b32 v24, 196
 s_mov_b32 s51, 0
 s_mov_b64 exec, 1
L_wb_2:
 buffer_load_dword v25, v24, s[96:99], 0 offen sc1
 s_waitcnt vmcnt(0)
 v_cmp_eq_u32 vcc, 0, v25
 s_cbranch_vccz L_wbd_3
 s_sleep 2
 s_add_u32 s51, s51, 1
 s_cmp_lt_u32 s51, 131072
 s_cbranch_scc1 L_wb_2
 s_branch L_bail
L_wbd_3:
 s_mov_b64 exec, -1
L_ww_1:
 s_barrier
 s_lshl_b32 s3, s70, 12
 s_add_u32 s3, s3, 231735296
 buffer_load_dwordx4 v[104:107], v130, s[4:7], s3 offen offset:0 sc1
 buffer_load_dwordx4 v[108:111], v130, s[4:7], s3 offen offset:1024 sc1
 s_waitcnt vmcnt(0)
L_cv_4:
 s_waitcnt vmcnt(4)
 ds_write_b128 v7, v[104:107] offset:512
 ds_write_b128 v7, v[96:99] offset:4640
 ds_write_b128 v7, v[112:115] offset:8800
 ds_write_b128 v7, v[108:111] offset:1536
 ds_write_b128 v7, v[100:103] offset:5664
 ds_write_b128 v7, v[116:119] offset:9824
 v_lshlrev_b32 v8, 16, v96
 v_lshlrev_b32 v12, 16, v128
 s_mov_b64 exec, 1
 ds_write_b32 v7, v8 offset:8796
 s_mov_b64 exec, -1
 s_lshl_b32 s72, s70, 6
 s_add_u32 s72, s72, 234356736
 s_add_u32 s70, s70, s69
 s_waitcnt lgkmcnt(0)
 s_lshl_b32 s73, s70, 12
 s_add_u32 s74, s73, 2
 buffer_load_dwordx4 v[96:99], v130, s[8:11], s73 offen offset:0
 buffer_load_dwordx4 v[100:103], v130, s[8:11], s73 offen offset:1024
 buffer_load_dwordx4 v[112:115], v130, s[8:11], s74 offen offset:0
 buffer_load_dwordx4 v[116:119], v130, s[8:11], s74 offen offset:1024
 s_lshl_b32 s3, s70, 1
 buffer_load_ushort v128, off, s[12:15], s3
 s_lshl_b32 s3, s70, 12
 s_add_u32 s3, s3, 231735296
 buffer_load_dwordx4 v[104:107], v130, s[4:7], s3 offen offset:0 sc1
 buffer_load_dwordx4 v[108:111], v130, s[4:7], s3 offen offset:1024 sc1
 ds_read_b128 v[32:35], v14 offset:448
 ds_read2_b32 v[64:65], v16 offset0:0 offset1:1
 ds_read2_b32 v[66:67], v16 offset0:2 offset1:3
 ds_read_b128 v[36:39], v14 offset:960
 ds_read2_b32 v[68:69], v17 offset0:0 offset1:1
 ds_read2_b32 v[70:71], v17 offset0:2 offset1:3
 ds_read_b128 v[40:43], v14 offset:1472
 ds_read2_b32 v[72:73], v18 offset0:0 offset1:1
 ds_read2_b32 v[74:75], v18 offset0:2 offset1:3
 ds_read_b128 v[44:47], v14 offset:1984
 ds_read2_b32 v[76:77], v19 offset0:0 offset1:1
 ds_read2_b32 v[78:79], v19 offset0:2 offset1:3
 s_waitcnt lgkmcnt(0)
 v_mfma_f32_16x16x32_bf16 v[144:147], v[64:67], v[32:35], 0
 ds_read_b128 v[176:179], v14 offset:384
 ds_read2_b32 v[208:209], v16 offset0:16 offset1:17
 v_mfma_f32_16x16x32_bf16 v[148:151], v[64:67], v[36:39], 0
 ds_read2_b32 v[210:211], v16 offset0:18 offset1:19
 ds_read_b128 v[180:183], v14 offset:896
 v_mfma_f32_16x16x32_bf16 v[152:155], v[64:67], v[40:43], 0
 ds_read2_b32 v[212:213], v17 offset0:16 offset1:17
 ds_read2_b32 v[214:215], v17 offset0:18 offset1:19
 v_mfma_f32_16x16x32_bf16 v[156:159], v[64:67], v[44:47], 0
 ds_read_b128 v[184:187], v14 offset:1408
 ds_read2_b32 v[216:217], v18 offset0:16 offset1:17
 v_mfma_f32_16x16x32_bf16 v[148:151], v[68:71], v[32:35], v[148:151]
 ds_read2_b32 v[218:219], v18 offset0:18 offset1:19
 ds_read_b128 v[188:191], v14 offset:1920
 v_mfma_f32_16x16x32_bf16 v[152:155], v[68:71], v[36:39], v[152:155]
 ds_read2_b32 v[220:221], v19 offset0:16 offset1:17
 ds_read2_b32 v[222:223], v19 offset0:18 offset1:19
 v_mfma_f32_16x16x32_bf16 v[156:159], v[68:71], v[40:43], v[156:159]
 v_mfma_f32_16x16x32_bf16 v[152:155], v[72:75], v[32:35], v[152:155]
 v_mfma_f32_16x16x32_bf16 v[156:159], v[72:75], v[36:39], v[156:159]
 v_mfma_f32_16x16x32_bf16 v[156:159], v[76:79], v[32:35], v[156:159]
 s_waitcnt lgkmcnt(0)
 v_mfma_f32_16x16x32_bf16 v[144:147], v[208:211], v[176:179], v[144:147]
 ds_read_b128 v[32:35], v14 offset:320
 ds_read2_b32 v[64:65], v16 offset0:32 offset1:33
 v_mfma_f32_16x16x32_bf16 v[148:151], v[208:211], v[180:183], v[148:151]
 ds_read2_b32 v[66:67], v16 offset0:34 offset1:35
 ds_read_b128 v[36:39], v14 offset:832
 v_mfma_f32_16x16x32_bf16 v[152:155], v[208:211], v[184:187], v[152:155]
 ds_read2_b32 v[68:69], v17 offset0:32 offset1:33
 ds_read2_b32 v[70:71], v17 offset0:34 offset1:35
 v_mfma_f32_16x16x32_bf16 v[156:159], v[208:211], v[188:191], v[156:159]
 ds_read_b128 v[40:43], v14 offset:1344
 ds_read2_b32 v[72:73], v18 offset0:32 offset1:33
 v_mfma_f32_16x16x32_bf16 v[148:151], v[212:215], v[176:179], v[148:151]
 ds_read2_b32 v[74:75], v18 offset0:34 offset1:35
 ds_read_b128 v[44:47], v14 offset:1856
 v_mfma_f32_16x16x32_bf16 v[152:155], v[212:215], v[180:183], v[152:155]
 ds_read2_b32 v[76:77], v19 offset0:32 offset1:33
 ds_read2_b32 v[78:79], v19 offset0:34 offset1:35
 v_mfma_f32_16x16x32_bf16 v[156:159], v[212:215], v[184:187], v[156:159]
 v_mfma_f32_16x16x32_bf16 v[152:155], v[216:219], v[176:179], v[152:155]
 v_mfma_f32_16x16x32_bf16 v[156:159], v[216:219], v[180:183], v[156:159]
 v_mfma_f32_16x16x32_bf16 v[156:159], v[220:223], v[176:179], v[156:159]
 s_waitcnt lgkmcnt(0)
 v_mfma_f32_16x16x32_bf16 v[144:147], v[64:67], v[32:35], v[144:147]
 ds_read_b128 v[176:179], v14 offset:256
 ds_read2_b32 v[208:209], v16 offset0:48 offset1:49
 v_mfma_f32_16x16x32_bf16 v[148:151], v[64:67], v[36:39], v[148:151]
 ds_read2_b32 v[210:211], v16 offset0:50 offset1:51
 ds_read_b128 v[180:183], v14 offset:768
 v_mfma_f32_16x16x32_bf16 v[152:155], v[64:67], v[40:43], v[152:155]
 ds_read2_b32 v[212:213], v17 offset0:48 offset1:49
 ds_read2_b32 v[214:215], v17 offset0:50 offset1:51
 v_mfma_f32_16x16x32_bf16 v[156:159], v[64:67], v[44:47], v[156:159]
 ds_read_b128 v[184:187], v14 offset:1280
 ds_read2_b32 v[216:217], v18 offset0:48 offset1:49
 v_mfma_f32_16x16x32_bf16 v[148:151], v[68:71], v[32:35], v[148:151]
 ds_read2_b32 v[218:219], v18 offset0:50 offset1:51
 ds_read_b128 v[188:191], v14 offset:1792
 v_mfma_f32_16x16x32_bf16 v[152:155], v[68:71], v[36:39], v[152:155]
 ds_read2_b32 v[220:221], v19 offset0:48 offset1:49
 ds_read2_b32 v[222:223], v19 offset0:50 offset1:51
 v_mfma_f32_16x16x32_bf16 v[156:159], v[68:71], v[40:43], v[156:159]
 v_mfma_f32_16x16x32_bf16 v[152:155], v[72:75], v[32:35], v[152:155]
 v_mfma_f32_16x16x32_bf16 v[156:159], v[72:75], v[36:39], v[156:159]
 v_mfma_f32_16x16x32_bf16 v[156:159], v[76:79], v[32:35], v[156:159]
 s_waitcnt lgkmcnt(0)
 v_mfma_f32_16x16x32_bf16 v[144:147], v[208:211], v[176:179], v[144:147]
 ds_read_b128 v[32:35], v14 offset:192
 ds_read2_b32 v[64:65], v16 offset0:64 offset1:65
 v_mfma_f32_16x16x32_bf16 v[148:151], v[208:211], v[180:183], v[148:151]
 ds_read2_b32 v[66:67], v16 offset0:66 offset1:67
 ds_read_b128 v[36:39], v14 offset:704
 v_mfma_f32_16x16x32_bf16 v[152:155], v[208:211], v[184:187], v[152:155]
 ds_read2_b32 v[68:69], v17 offset0:64 offset1:65
 ds_read2_b32 v[70:71], v17 offset0:66 offset1:67
 v_mfma_f32_16x16x32_bf16 v[156:159], v[208:211], v[188:191], v[156:159]
 ds_read_b128 v[40:43], v14 offset:1216
 ds_read2_b32 v[72:73], v18 offset0:64 offset1:65
 v_mfma_f32_16x16x32_bf16 v[148:151], v[212:215], v[176:179], v[148:151]
 ds_read2_b32 v[74:75], v18 offset0:66 offset1:67
 ds_read_b128 v[44:47], v14 offset:1728
 v_mfma_f32_16x16x32_bf16 v[152:155], v[212:215], v[180:183], v[152:155]
 ds_read2_b32 v[76:77], v19 offset0:64 offset1:65
 ds_read2_b32 v[78:79], v19 offset0:66 offset1:67
 v_mfma_f32_16x16x32_bf16 v[156:159], v[212:215], v[184:187], v[156:159]
 v_mfma_f32_16x16x32_bf16 v[152:155], v[216:219], v[176:179], v[152:155]
 v_mfma_f32_16x16x32_bf16 v[156:159], v[216:219], v[180:183], v[156:159]
 v_mfma_f32_16x16x32_bf16 v[156:159], v[220:223], v[176:179], v[156:159]
 s_waitcnt lgkmcnt(0)
 v_mfma_f32_16x16x32_bf16 v[144:147], v[64:67], v[32:35], v[144:147]
 ds_read_b128 v[176:179], v14 offset:128
 ds_read2_b32 v[208:209], v16 offset0:80 offset1:81
 v_mfma_f32_16x16x32_bf16 v[148:151], v[64:67], v[36:39], v[148:151]
 ds_read2_b32 v[210:211], v16 offset0:82 offset1:83
 ds_read_b128 v[180:183], v14 offset:640
 v_mfma_f32_16x16x32_bf16 v[152:155], v[64:67], v[40:43], v[152:155]
 ds_read2_b32 v[212:213], v17 offset0:80 offset1:81
 ds_read2_b32 v[214:215], v17 offset0:82 offset1:83
 v_mfma_f32_16x16x32_bf16 v[156:159], v[64:67], v[44:47], v[156:159]
 ds_read_b128 v[184:187], v14 offset:1152
 ds_read2_b32 v[216:217], v18 offset0:80 offset1:81
 v_mfma_f32_16x16x32_bf16 v[148:151], v[68:71], v[32:35], v[148:151]
 ds_read2_b32 v[218:219], v18 offset0:82 offset1:83
 ds_read_b128 v[188:191], v14 offset:1664
 v_mfma_f32_16x16x32_bf16 v[152:155], v[68:71], v[36:39], v[152:155]
 ds_read2_b32 v[220:221], v19 offset0:80 offset1:81
 ds_read2_b32 v[222:223], v19 offset0:82 offset1:83
 v_mfma_f32_16x16x32_bf16 v[156:159], v[68:71], v[40:43], v[156:159]
 v_mfma_f32_16x16x32_bf16 v[152:155], v[72:75], v[32:35], v[152:155]
 v_mfma_f32_16x16x32_bf16 v[156:159], v[72:75], v[36:39], v[156:159]
 v_mfma_f32_16x16x32_bf16 v[156:159], v[76:79], v[32:35], v[156:159]
 s_waitcnt lgkmcnt(0)
 v_mfma_f32_16x16x32_bf16 v[144:147], v[208:211], v[176:179], v[144:147]
 ds_read_b128 v[32:35], v14 offset:64
 ds_read2_b32 v[64:65], v16 offset0:96 offset1:97
 v_mfma_f32_16x16x32_bf16 v[148:151], v[208:211], v[180:183], v[148:151]
 ds_read2_b32 v[66:67], v16 offset0:98 offset1:99
 ds_read_b128 v[36:39], v14 offset:576
 v_mfma_f32_16x16x32_bf16 v[152:155], v[208:211], v[184:187], v[152:155]
 ds_read2_b32 v[68:69], v17 offset0:96 offset1:97
 ds_read2_b32 v[70:71], v17 offset0:98 offset1:99
 v_mfma_f32_16x16x32_bf16 v[156:159], v[208:211], v[188:191], v[156:159]
 ds_read_b128 v[40:43], v14 offset:1088
 ds_read2_b32 v[72:73], v18 offset0:96 offset1:97
 v_mfma_f32_16x16x32_bf16 v[148:151], v[212:215], v[176:179], v[148:151]
 ds_read2_b32 v[74:75], v18 offset0:98 offset1:99
 ds_read_b128 v[44:47], v14 offset:1600
 v_mfma_f32_16x16x32_bf16 v[152:155], v[212:215], v[180:183], v[152:155]
 ds_read2_b32 v[76:77], v19 offset0:96 offset1:97
 ds_read2_b32 v[78:79], v19 offset0:98 offset1:99
 v_mfma_f32_16x16x32_bf16 v[156:159], v[212:215], v[184:187], v[156:159]
 v_mfma_f32_16x16x32_bf16 v[152:155], v[216:219], v[176:179], v[152:155]
 v_mfma_f32_16x16x32_bf16 v[156:159], v[216:219], v[180:183], v[156:159]
 v_mfma_f32_16x16x32_bf16 v[156:159], v[220:223], v[176:179], v[156:159]
 s_waitcnt lgkmcnt(0)
 v_mfma_f32_16x16x32_bf16 v[144:147], v[64:67], v[32:35], v[144:147]
 ds_read_b128 v[176:179], v14 offset:0
 ds_read2_b32 v[208:209], v16 offset0:112 offset1:113
 v_mfma_f32_16x16x32_bf16 v[148:151], v[64:67], v[36:39], v[148:151]
 ds_read2_b32 v[210:211], v16 offset0:114 offset1:115
 ds_read_b128 v[180:183], v14 offset:512
 v_mfma_f32_16x16x32_bf16 v[152:155], v[64:67], v[40:43], v[152:155]
 ds_read2_b32 v[212:213], v17 offset0:112 offset1:113
 ds_read2_b32 v[214:215], v17 offset0:114 offset1:115
 v_mfma_f32_16x16x32_bf16 v[156:159], v[64:67], v[44:47], v[156:159]
 ds_read_b128 v[184:187], v14 offset:1024
 ds_read2_b32 v[216:217], v18 offset0:112 offset1:113
 v_mfma_f32_16x16x32_bf16 v[148:151], v[68:71], v[32:35], v[148:151]
 ds_read2_b32 v[218:219], v18 offset0:114 offset1:115
 ds_read_b128 v[188:191], v14 offset:1536
 v_mfma_f32_16x16x32_bf16 v[152:155], v[68:71], v[36:39], v[152:155]
 ds_read2_b32 v[220:221], v19 offset0:112 offset1:113
 ds_read2_b32 v[222:223], v19 offset0:114 offset1:115
 v_mfma_f32_16x16x32_bf16 v[156:159], v[68:71], v[40:43], v[156:159]
 v_mfma_f32_16x16x32_bf16 v[152:155], v[72:75], v[32:35], v[152:155]
 v_mfma_f32_16x16x32_bf16 v[156:159], v[72:75], v[36:39], v[156:159]
 v_mfma_f32_16x16x32_bf16 v[156:159], v[76:79], v[32:35], v[156:159]
 s_waitcnt lgkmcnt(0)
 v_mfma_f32_16x16x32_bf16 v[144:147], v[208:211], v[176:179], v[144:147]
 ds_read_b64 v[32:33], v15 offset:0
 ds_read_b64 v[34:35], v15 offset:512
 v_mfma_f32_16x16x32_bf16 v[148:151], v[208:211], v[180:183], v[148:151]
 ds_read_b64 v[36:37], v15 offset:1024
 ds_read_b64 v[38:39], v15 offset:1536
 v_mfma_f32_16x16x32_bf16 v[152:155], v[208:211], v[184:187], v[152:155]
 v_mfma_f32_16x16x32_bf16 v[156:159], v[208:211], v[188:191], v[156:159]
 v_mfma_f32_16x16x32_bf16 v[148:151], v[212:215], v[176:179], v[148:151]
 v_mfma_f32_16x16x32_bf16 v[152:155], v[212:215], v[180:183], v[152:155]
 v_mfma_f32_16x16x32_bf16 v[156:159], v[212:215], v[184:187], v[156:159]
 v_mfma_f32_16x16x32_bf16 v[152:155], v[216:219], v[176:179], v[152:155]
 v_mfma_f32_16x16x32_bf16 v[156:159], v[216:219], v[180:183], v[156:159]
 v_mfma_f32_16x16x32_bf16 v[156:159], v[220:223], v[176:179], v[156:159]
 s_waitcnt lgkmcnt(0)
 v_and_b32 v64, 0xffff0000, v33
 v_lshlrev_b32 v65, 16, v33
 v_and_b32 v66, 0xffff0000, v32
 v_lshlrev_b32 v67, 16, v32
 v_mul_f32 v64, v64, v12
 v_mul_f32 v65, v65, v12
 v_mul_f32 v66, v66, v12
 v_mul_f32 v67, v67, v12
 v_and_b32 v68, 0xffff0000, v35
 v_lshlrev_b32 v69, 16, v35
 v_and_b32 v70, 0xffff0000, v34
 v_lshlrev_b32 v71, 16, v34
 v_mul_f32 v68, v68, v12
 v_mul_f32 v69, v69, v12
 v_mul_f32 v70, v70, v12
 v_mul_f32 v71, v71, v12
 v_and_b32 v72, 0xffff0000, v37
 v_lshlrev_b32 v73, 16, v37
 v_and_b32 v74, 0xffff0000, v36
 v_lshlrev_b32 v75, 16, v36
 v_mul_f32 v72, v72, v12
 v_mul_f32 v73, v73, v12
 v_mul_f32 v74, v74, v12
 v_mul_f32 v75, v75, v12
 v_and_b32 v76, 0xffff0000, v39
 v_lshlrev_b32 v77, 16, v39
 v_and_b32 v78, 0xffff0000, v38
 v_lshlrev_b32 v79, 16, v38
 v_mul_f32 v76, v76, v12
 v_mul_f32 v77, v77, v12
 v_mul_f32 v78, v78, v12
 v_mul_f32 v79, v79, v12
 v_cvt_pk_bf16_f32 v8, v64, v65
 v_lshlrev_b32 v64, 16, v8
 v_and_b32 v65, 0xffff0000, v8
 v_cvt_pk_bf16_f32 v8, v66, v67
 v_lshlrev_b32 v66, 16, v8
 v_and_b32 v67, 0xffff0000, v8
 v_cvt_pk_bf16_f32 v8, v68, v69
 v_lshlrev_b32 v68, 16, v8
 v_and_b32 v69, 0xffff0000, v8
 v_cvt_pk_bf16_f32 v8, v70, v71
 v_lshlrev_b32 v70, 16, v8
 v_and_b32 v71, 0xffff0000, v8
 v_cvt_pk_bf16_f32 v8, v72, v73
 v_lshlrev_b32 v72, 16, v8
 v_and_b32 v73, 0xffff0000, v8
 v_cvt_pk_bf16_f32 v8, v74, v75
 v_lshlrev_b32 v74, 16, v8
 v_and_b32 v75, 0xffff0000, v8
 v_cvt_pk_bf16_f32 v8, v76, v77
 v_lshlrev_b32 v76, 16, v8
 v_and_b32 v77, 0xffff0000, v8
 v_cvt_pk_bf16_f32 v8, v78, v79
 v_lshlrev_b32 v78, 16, v8
 v_and_b32 v79, 0xffff0000, v8
 v_cvt_pk_bf16_f32 v8, v144, v145
 v_lshlrev_b32 v144, 16, v8
 v_and_b32 v145, 0xffff0000, v8
 v_cvt_pk_bf16_f32 v8, v146, v147
 v_lshlrev_b32 v146, 16, v8
 v_and_b32 v147, 0xffff0000, v8
 v_cvt_pk_bf16_f32 v8, v148, v149
 v_lshlrev_b32 v148, 16, v8
 v_and_b32 v149, 0xffff0000, v8
 v_cvt_pk_bf16_f32 v8, v150, v151
 v_lshlrev_b32 v150, 16, v8
 v_and_b32 v151, 0xffff0000, v8
 v_cvt_pk_bf16_f32 v8, v152, v153
 v_lshlrev_b32 v152, 16, v8
 v_and_b32 v153, 0xffff0000, v8
 v_cvt_pk_bf16_f32 v8, v154, v155
 v_lshlrev_b32 v154, 16, v8
 v_and_b32 v155, 0xffff0000, v8
 v_cvt_pk_bf16_f32 v8, v156, v157
 v_lshlrev_b32 v156, 16, v8
 v_and_b32 v157, 0xffff0000, v8
 v_cvt_pk_bf16_f32 v8, v158, v159
 v_lshlrev_b32 v158, 16, v8
 v_and_b32 v159, 0xffff0000, v8
 v_pk_add_f32 v[144:145], v[144:145], v[64:65]
 v_pk_add_f32 v[146:147], v[146:147], v[66:67]
 v_pk_add_f32 v[148:149], v[148:149], v[68:69]
 v_pk_add_f32 v[150:151], v[150:151], v[70:71]
 v_pk_add_f32 v[152:153], v[152:153], v[72:73]
 v_pk_add_f32 v[154:155], v[154:155], v[74:75]
 v_pk_add_f32 v[156:157], v[156:157], v[76:77]
 v_pk_add_f32 v[158:159], v[158:159], v[78:79]
 v_cvt_pk_bf16_f32 v160, v144, v148
 v_cvt_pk_bf16_f32 v161, v152, v156
 buffer_store_dwordx2 v[160:161], v13, s[4:7], s72 offen sc1
 s_add_u32 s72, s72, 40960
 v_cvt_pk_bf16_f32 v162, v145, v149
 v_cvt_pk_bf16_f32 v163, v153, v157
 buffer_store_dwordx2 v[162:163], v13, s[4:7], s72 offen sc1
 s_add_u32 s72, s72, 40960
 v_cvt_pk_bf16_f32 v164, v146, v150
 v_cvt_pk_bf16_f32 v165, v154, v158
 buffer_store_dwordx2 v[164:165], v13, s[4:7], s72 offen sc1
 s_add_u32 s72, s72, 40960
 v_cvt_pk_bf16_f32 v166, v147, v151
 v_cvt_pk_bf16_f32 v167, v155, v159
 buffer_store_dwordx2 v[166:167], v13, s[4:7], s72 offen sc1
 s_add_u32 s72, s72, 40960
 s_cmp_lt_u32 s70, 640
 s_cbranch_scc1 L_cv_4
 s_setpc_b64 s[76:77]
L_conv1:
 s_mov_b32 s8, s38
 s_and_b32 s9, s39, 0xffff
 s_mov_b32 s10, 2621440
 s_mov_b32 s11, 0x00020000
 s_mov_b32 s12, s40
 s_and_b32 s13, s41, 0xffff
 s_mov_b32 s14, 1280
 s_mov_b32 s15, 0x00020000
 v_lshlrev_b32 v130, 4, v0
 v_add_u32 v7, s71, v130
 v_mov_b32 v8, 0
 v_mov_b32 v9, 0
 v_mov_b32 v10, 0
 v_mov_b32 v11, 0
 s_mov_b32 exec_hi, 0
 ds_write_b128 v7, v[8:11] offset:0
 s_mov_b32 exec_lo, 3
 ds_write_b128 v7, v[8:11] offset:4608
 ds_write_b128 v7, v[8:11] offset:8768
 s_mov_b64 exec, -1
 v_and_b32 v8, 15, v0
 v_lshrrev_b32 v9, 5, v0
 v_sub_u32 v10, v8, v9
 v_lshlrev_b32 v10, 5, v10
 v_and_b32 v11, 16, v0
 v_add_u32 v10, v10, v11
 s_add_u32 s3, s71, 64
 v_add_u32 v14, s3, v10
 v_lshlrev_b32 v10, 5, v9
 v_lshl_add_u32 v10, v8, 1, v10
 v_sub_u32 v10, v10, v11
 v_and_b32 v11, 1, v0
 v_cmp_eq_u32 vcc, 1, v11
 v_mov_b32 v12, 8784
 v_mov_b32 v11, 4626
 s_nop 0
 v_cndmask_b32 v11, v12, v11, vcc
 v_add3_u32 v16, v10, v11, s71
 v_add_u32 v17, 512, v16
 v_add_u32 v18, 1024, v16
 v_add_u32 v19, 1536, v16
 v_add_u32 v20, 2048, v16
 v_add_u32 v21, 2560, v16
 v_add_u32 v22, 3072, v16
 v_add_u32 v23, 3584, v16
 v_lshlrev_b32 v10, 5, v8
 v_lshl_add_u32 v10, v9, 4, v10
 v_and_b32 v11, 16, v0
 v_lshrrev_b32 v11, 1, v11
 v_xor_b32 v11, 8, v11
 s_add_u32 s3, s71, 512
 v_add3_u32 v15, v10, v11, s3
 v_and_b32 v10, 1, v0
 v_lshlrev_b32 v10, 4, v10
 v_lshrrev_b32 v11, 4, v0
 v_lshl_add_u32 v10, v11, 2, v10
 s_mov_b32 s3, 40960
 v_mul_lo_u32 v13, v10, s3
 v_lshrrev_b32 v11, 1, v8
 v_lshl_add_u32 v13, v11, 3, v13
 s_waitcnt vmcnt(0)
L_cv_5:
 s_waitcnt vmcnt(4)
 ds_write_b128 v7, v[240:243] offset:512
 ds_write_b128 v7, v[96:99] offset:4640
 ds_write_b128 v7, v[112:115] offset:8800
 ds_write_b128 v7, v[244:247] offset:1536
 ds_write_b128 v7, v[100:103] offset:5664
 ds_write_b128 v7, v[116:119] offset:9824
 ds_write_b128 v7, v[248:251] offset:2560
 ds_write_b128 v7, v[104:107] offset:6688
 ds_write_b128 v7, v[120:123] offset:10848
 ds_write_b128 v7, v[252:255] offset:3584
 ds_write_b128 v7, v[108:111] offset:7712
 ds_write_b128 v7, v[124:127] offset:11872
 v_lshlrev_b32 v8, 16, v96
 v_lshlrev_b32 v12, 16, v128
 s_mov_b64 exec, 1
 ds_write_b32 v7, v8 offset:8796
 s_mov_b64 exec, -1
 s_lshl_b32 s72, s70, 6
 s_add_u32 s72, s72, 235667456
 s_add_u32 s70, s70, s69
 s_waitcnt lgkmcnt(0)
 s_lshl_b32 s73, s70, 12
 s_add_u32 s74, s73, 2
 buffer_load_dwordx4 v[96:99], v130, s[8:11], s73 offen offset:0
 buffer_load_dwordx4 v[100:103], v130, s[8:11], s73 offen offset:1024
 buffer_load_dwordx4 v[104:107], v130, s[8:11], s73 offen offset:2048
 buffer_load_dwordx4 v[108:111], v130, s[8:11], s73 offen offset:3072
 buffer_load_dwordx4 v[112:115], v130, s[8:11], s74 offen offset:0
 buffer_load_dwordx4 v[116:119], v130, s[8:11], s74 offen offset:1024
 buffer_load_dwordx4 v[120:123], v130, s[8:11], s74 offen offset:2048
 buffer_load_dwordx4 v[124:127], v130, s[8:11], s74 offen offset:3072
 s_lshl_b32 s3, s70, 1
 buffer_load_ushort v128, off, s[12:15], s3
 s_lshl_b32 s3, s70, 12
 s_add_u32 s3, s3, 231735296
 buffer_load_dwordx4 v[240:243], v130, s[4:7], s3 offen offset:0 sc1
 buffer_load_dwordx4 v[244:247], v130, s[4:7], s3 offen offset:1024 sc1
 buffer_load_dwordx4 v[248:251], v130, s[4:7], s3 offen offset:2048 sc1
 buffer_load_dwordx4 v[252:255], v130, s[4:7], s3 offen offset:3072 sc1
 ds_read_b128 v[32:35], v14 offset:448
 ds_read2_b32 v[64:65], v16 offset0:0 offset1:1
 ds_read2_b32 v[66:67], v16 offset0:2 offset1:3
 ds_read_b128 v[36:39], v14 offset:960
 ds_read2_b32 v[68:69], v17 offset0:0 offset1:1
 ds_read2_b32 v[70:71], v17 offset0:2 offset1:3
 ds_read_b128 v[40:43], v14 offset:1472
 ds_read2_b32 v[72:73], v18 offset0:0 offset1:1
 ds_read2_b32 v[74:75], v18 offset0:2 offset1:3
 ds_read_b128 v[44:47], v14 offset:1984
 ds_read2_b32 v[76:77], v19 offset0:0 offset1:1
 ds_read2_b32 v[78:79], v19 offset0:2 offset1:3
 ds_read_b128 v[48:51], v14 offset:2496
 ds_read2_b32 v[80:81], v20 offset0:0 offset1:1
 ds_read2_b32 v[82:83], v20 offset0:2 offset1:3
 ds_read_b128 v[52:55], v14 offset:3008
 ds_read2_b32 v[84:85], v21 offset0:0 offset1:1
 ds_read2_b32 v[86:87], v21 offset0:2 offset1:3
 ds_read_b128 v[56:59], v14 offset:3520
 ds_read2_b32 v[88:89], v22 offset0:0 offset1:1
 ds_read2_b32 v[90:91], v22 offset0:2 offset1:3
 ds_read_b128 v[60:63], v14 offset:4032
 ds_read2_b32 v[92:93], v23 offset0:0 offset1:1
 ds_read2_b32 v[94:95], v23 offset0:2 offset1:3
 s_waitcnt lgkmcnt(0)
 v_mfma_f32_16x16x32_bf16 v[144:147], v[64:67], v[48:51], 0
 ds_read_b128 v[176:179], v14 offset:384
 v_mfma_f32_16x16x32_bf16 v[148:151], v[64:67], v[52:55], 0
 ds_read2_b32 v[208:209], v16 offset0:16 offset1:17
 v_mfma_f32_16x16x32_bf16 v[152:155], v[64:67], v[56:59], 0
 ds_read2_b32 v[210:211], v16 offset0:18 offset1:19
 v_mfma_f32_16x16x32_bf16 v[156:159], v[64:67], v[60:63], 0
 ds_read_b128 v[180:183], v14 offset:896
 v_mfma_f32_16x16x32_bf16 v[144:147], v[68:71], v[44:47], v[144:147]
 ds_read2_b32 v[212:213], v17 offset0:16 offset1:17
 v_mfma_f32_16x16x32_bf16 v[148:151], v[68:71], v[48:51], v[148:151]
 ds_read2_b32 v[214:215], v17 offset0:18 offset1:19
 v_mfma_f32_16x16x32_bf16 v[152:155], v[68:71], v[52:55], v[152:155]
 ds_read_b128 v[184:187], v14 offset:1408
 v_mfma_f32_16x16x32_bf16 v[156:159], v[68:71], v[56:59], v[156:159]
 ds_read2_b32 v[216:217], v18 offset0:16 offset1:17
 v_mfma_f32_16x16x32_bf16 v[144:147], v[72:75], v[40:43], v[144:147]
 ds_read2_b32 v[218:219], v18 offset0:18 offset1:19
 v_mfma_f32_16x16x32_bf16 v[148:151], v[72:75], v[44:47], v[148:151]
 ds_read_b128 v[188:191], v14 offset:1920
 v_mfma_f32_16x16x32_bf16 v[152:155], v[72:75], v[48:51], v[152:155]
 ds_read2_b32 v[220:221], v19 offset0:16 offset1:17
 v_mfma_f32_16x16x32_bf16 v[156:159], v[72:75], v[52:55], v[156:159]
 ds_read2_b32 v[222:223], v19 offset0:18 offset1:19
 v_mfma_f32_16x16x32_bf16 v[144:147], v[76:79], v[36:39], v[144:147]
 ds_read_b128 v[192:195], v14 offset:2432
 v_mfma_f32_16x16x32_bf16 v[148:151], v[76:79], v[40:43], v[148:151]
 ds_read2_b32 v[224:225], v20 offset0:16 offset1:17
 v_mfma_f32_16x16x32_bf16 v[152:155], v[76:79], v[44:47], v[152:155]
 ds_read2_b32 v[226:227], v20 offset0:18 offset1:19
 v_mfma_f32_16x16x32_bf16 v[156:159], v[76:79], v[48:51], v[156:159]
 ds_read_b128 v[196:199], v14 offset:2944
 v_mfma_f32_16x16x32_bf16 v[144:147], v[80:83], v[32:35], v[144:147]
 ds_read2_b32 v[228:229], v21 offset0:16 offset1:17
 v_mfma_f32_16x16x32_bf16 v[148:151], v[80:83], v[36:39], v[148:151]
 ds_read2_b32 v[230:231], v21 offset0:18 offset1:19
 v_mfma_f32_16x16x32_bf16 v[152:155], v[80:83], v[40:43], v[152:155]
 ds_read_b128 v[200:203], v14 offset:3456
 v_mfma_f32_16x16x32_bf16 v[156:159], v[80:83], v[44:47], v[156:159]
 ds_read2_b32 v[232:233], v22 offset0:16 offset1:17
 v_mfma_f32_16x16x32_bf16 v[148:151], v[84:87], v[32:35], v[148:151]
 ds_read2_b32 v[234:235], v22 offset0:18 offset1:19
 v_mfma_f32_16x16x32_bf16 v[152:155], v[84:87], v[36:39], v[152:155]
 ds_read_b128 v[204:207], v14 offset:3968
 v_mfma_f32_16x16x32_bf16 v[156:159], v[84:87], v[40:43], v[156:159]
 ds_read2_b32 v[236:237], v23 offset0:16 offset1:17
 v_mfma_f32_16x16x32_bf16 v[152:155], v[88:91], v[32:35], v[152:155]
 ds_read2_b32 v[238:239], v23 offset0:18 offset1:19
 v_mfma_f32_16x16x32_bf16 v[156:159], v[88:91], v[36:39], v[156:159]
 v_mfma_f32_16x16x32_bf16 v[156:159], v[92:95], v[32:35], v[156:159]
 s_waitcnt lgkmcnt(0)
 v_mfma_f32_16x16x32_bf16 v[144:147], v[208:211], v[192:195], v[144:147]
 ds_read_b128 v[32:35], v14 offset:320
 v_mfma_f32_16x16x32_bf16 v[148:151], v[208:211], v[196:199], v[148:151]
 ds_read2_b32 v[64:65], v16 offset0:32 offset1:33
 v_mfma_f32_16x16x32_bf16 v[152:155], v[208:211], v[200:203], v[152:155]
 ds_read2_b32 v[66:67], v16 offset0:34 offset1:35
 v_mfma_f32_16x16x32_bf16 v[156:159], v[208:211], v[204:207], v[156:159]
 ds_read_b128 v[36:39], v14 offset:832
 v_mfma_f32_16x16x32_bf16 v[144:147], v[212:215], v[188:191], v[144:147]
 ds_read2_b32 v[68:69], v17 offset0:32 offset1:33
 v_mfma_f32_16x16x32_bf16 v[148:151], v[212:215], v[192:195], v[148:151]
 ds_read2_b32 v[70:71], v17 offset0:34 offset1:35
 v_mfma_f32_16x16x32_bf16 v[152:155], v[212:215], v[196:199], v[152:155]
 ds_read_b128 v[40:43], v14 offset:1344
 v_mfma_f32_16x16x32_bf16 v[156:159], v[212:215], v[200:203], v[156:159]
 ds_read2_b32 v[72:73], v18 offset0:32 offset1:33
 v_mfma_f32_16x16x32_bf16 v[144:147], v[216:219], v[184:187], v[144:147]
 ds_read2_b32 v[74:75], v18 offset0:34 offset1:35
 v_mfma_f32_16x16x32_bf16 v[148:151], v[216:219], v[188:191], v[148:151]
 ds_read_b128 v[44:47], v14 offset:1856
 v_mfma_f32_16x16x32_bf16 v[152:155], v[216:219], v[192:195], v[152:155]
 ds_read2_b32 v[76:77], v19 offset0:32 offset1:33
 v_mfma_f32_16x16x32_bf16 v[156:159], v[216:219], v[196:199], v[156:159]
 ds_read2_b32 v[78:79], v19 offset0:34 offset1:35
 v_mfma_f32_16x16x32_bf16 v[144:147], v[220:223], v[180:183], v[144:147]
 ds_read_b128 v[48:51], v14 offset:2368
 v_mfma_f32_16x16x32_bf16 v[148:151], v[220:223], v[184:187], v[148:151]
 ds_read2_b32 v[80:81], v20 offset0:32 offset1:33
 v_mfma_f32_16x16x32_bf16 v[152:155], v[220:223], v[188:191], v[152:155]
 ds_read2_b32 v[82:83], v20 offset0:34 offset1:35
 v_mfma_f32_16x16x32_bf16 v[156:159], v[220:223], v[192:195], v[156:159]
 ds_read_b128 v[52:55], v14 offset:2880
 v_mfma_f32_16x16x32_bf16 v[144:147], v[224:227], v[176:179], v[144:147]
 ds_read2_b32 v[84:85], v21 offset0:32 offset1:33
 v_mfma_f32_16x16x32_bf16 v[148:151], v[224:227], v[180:183], v[148:151]
 ds_read2_b32 v[86:87], v21 offset0:34 offset1:35
 v_mfma_f32_16x16x32_bf16 v[152:155], v[224:227], v[184:187], v[152:155]
 ds_read_b128 v[56:59], v14 offset:3392
 v_mfma_f32_16x16x32_bf16 v[156:159], v[224:227], v[188:191], v[156:159]
 ds_read2_b32 v[88:89], v22 offset0:32 offset1:33
 v_mfma_f32_16x16x32_bf16 v[148:151], v[228:231], v[176:179], v[148:151]
 ds_read2_b32 v[90:91], v22 offset0:34 offset1:35
 v_mfma_f32_16x16x32_bf16 v[152:155], v[228:231], v[180:183], v[152:155]
 ds_read_b128 v[60:63], v14 offset:3904
 v_mfma_f32_16x16x32_bf16 v[156:159], v[228:231], v[184:187], v[156:159]
 ds_read2_b32 v[92:93], v23 offset0:32 offset1:33
 v_mfma_f32_16x16x32_bf16 v[152:155], v[232:235], v[176:179], v[152:155]
 ds_read2_b32 v[94:95], v23 offset0:34 offset1:35
 v_mfma_f32_16x16x32_bf16 v[156:159], v[232:235], v[180:183], v[156:159]
 v_mfma_f32_16x16x32_bf16 v[156:159], v[236:239], v[176:179], v[156:159]
 s_waitcnt lgkmcnt(0)
 v_mfma_f32_16x16x32_bf16 v[144:147], v[64:67], v[48:51], v[144:147]
 ds_read_b128 v[176:179], v14 offset:256
 v_mfma_f32_16x16x32_bf16 v[148:151], v[64:67], v[52:55], v[148:151]
 ds_read2_b32 v[208:209], v16 offset0:48 offset1:49
 v_mfma_f32_16x16x32_bf16 v[152:155], v[64:67], v[56:59], v[152:155]
 ds_read2_b32 v[210:211], v16 offset0:50 offset1:51
 v_mfma_f32_16x16x32_bf16 v[156:159], v[64:67], v[60:63], v[156:159]
 ds_read_b128 v[180:183], v14 offset:768
 v_mfma_f32_16x16x32_bf16 v[144:147], v[68:71], v[44:47], v[144:147]
 ds_read2_b32 v[212:213], v17 offset0:48 offset1:49
 v_mfma_f32_16x16x32_bf16 v[148:151], v[68:71], v[48:51], v[148:151]
 ds_read2_b32 v[214:215], v17 offset0:50 offset1:51
 v_mfma_f32_16x16x32_bf16 v[152:155], v[68:71], v[52:55], v[152:155]
 ds_read_b128 v[184:187], v14 offset:1280
 v_mfma_f32_16x16x32_bf16 v[156:159], v[68:71], v[56:59], v[156:159]
 ds_read2_b32 v[216:217], v18 offset0:48 offset1:49
 v_mfma_f32_16x16x32_bf16 v[144:147], v[72:75], v[40:43], v[144:147]
 ds_read2_b32 v[218:219], v18 offset0:50 offset1:51
 v_mfma_f32_16x16x32_bf16 v[148:151], v[72:75], v[44:47], v[148:151]
 ds_read_b128 v[188:191], v14 offset:1792
 v_mfma_f32_16x16x32_bf16 v[152:155], v[72:75], v[48:51], v[152:155]
 ds_read2_b32 v[220:221], v19 offset0:48 offset1:49
 v_mfma_f32_16x16x32_bf16 v[156:159], v[72:75], v[52:55], v[156:159]
 ds_read2_b32 v[222:223], v19 offset0:50 offset1:51
 v_mfma_f32_16x16x32_bf16 v[144:147], v[76:79], v[36:39], v[144:147]
 ds_read_b128 v[192:195], v14 offset:2304
 v_mfma_f32_16x16x32_bf16 v[148:151], v[76:79], v[40:43], v[148:151]
 ds_read2_b32 v[224:225], v20 offset0:48 offset1:49
 v_mfma_f32_16x16x32_bf16 v[152:155], v[76:79], v[44:47], v[152:155]
 ds_read2_b32 v[226:227], v20 offset0:50 offset1:51
 v_mfma_f32_16x16x32_bf16 v[156:159], v[76:79], v[48:51], v[156:159]
 ds_read_b128 v[196:199], v14 offset:2816
 v_mfma_f32_16x16x32_bf16 v[144:147], v[80:83], v[32:35], v[144:147]
 ds_read2_b32 v[228:229], v21 offset0:48 offset1:49
 v_mfma_f32_16x16x32_bf16 v[148:151], v[80:83], v[36:39], v[148:151]
 ds_read2_b32 v[230:231], v21 offset0:50 offset1:51
 v_mfma_f32_16x16x32_bf16 v[152:155], v[80:83], v[40:43], v[152:155]
 ds_read_b128 v[200:203], v14 offset:3328
 v_mfma_f32_16x16x32_bf16 v[156:159], v[80:83], v[44:47], v[156:159]
 ds_read2_b32 v[232:233], v22 offset0:48 offset1:49
 v_mfma_f32_16x16x32_bf16 v[148:151], v[84:87], v[32:35], v[148:151]
 ds_read2_b32 v[234:235], v22 offset0:50 offset1:51
 v_mfma_f32_16x16x32_bf16 v[152:155], v[84:87], v[36:39], v[152:155]
 ds_read_b128 v[204:207], v14 offset:3840
 v_mfma_f32_16x16x32_bf16 v[156:159], v[84:87], v[40:43], v[156:159]
 ds_read2_b32 v[236:237], v23 offset0:48 offset1:49
 v_mfma_f32_16x16x32_bf16 v[152:155], v[88:91], v[32:35], v[152:155]
 ds_read2_b32 v[238:239], v23 offset0:50 offset1:51
 v_mfma_f32_16x16x32_bf16 v[156:159], v[88:91], v[36:39], v[156:159]
 v_mfma_f32_16x16x32_bf16 v[156:159], v[92:95], v[32:35], v[156:159]
 s_waitcnt lgkmcnt(0)
 v_mfma_f32_16x16x32_bf16 v[144:147], v[208:211], v[192:195], v[144:147]
 ds_read_b128 v[32:35], v14 offset:192
 v_mfma_f32_16x16x32_bf16 v[148:151], v[208:211], v[196:199], v[148:151]
 ds_read2_b32 v[64:65], v16 offset0:64 offset1:65
 v_mfma_f32_16x16x32_bf16 v[152:155], v[208:211], v[200:203], v[152:155]
 ds_read2_b32 v[66:67], v16 offset0:66 offset1:67
 v_mfma_f32_16x16x32_bf16 v[156:159], v[208:211], v[204:207], v[156:159]
 ds_read_b128 v[36:39], v14 offset:704
 v_mfma_f32_16x16x32_bf16 v[144:147], v[212:215], v[188:191], v[144:147]
 ds_read2_b32 v[68:69], v17 offset0:64 offset1:65
 v_mfma_f32_16x16x32_bf16 v[148:151], v[212:215], v[192:195], v[148:151]
 ds_read2_b32 v[70:71], v17 offset0:66 offset1:67
 v_mfma_f32_16x16x32_bf16 v[152:155], v[212:215], v[196:199], v[152:155]
 ds_read_b128 v[40:43], v14 offset:1216
 v_mfma_f32_16x16x32_bf16 v[156:159], v[212:215], v[200:203], v[156:159]
 ds_read2_b32 v[72:73], v18 offset0:64 offset1:65
 v_mfma_f32_16x16x32_bf16 v[144:147], v[216:219], v[184:187], v[144:147]
 ds_read2_b32 v[74:75], v18 offset0:66 offset1:67
 v_mfma_f32_16x16x32_bf16 v[148:151], v[216:219], v[188:191], v[148:151]
 ds_read_b128 v[44:47], v14 offset:1728
 v_mfma_f32_16x16x32_bf16 v[152:155], v[216:219], v[192:195], v[152:155]
 ds_read2_b32 v[76:77], v19 offset0:64 offset1:65
 v_mfma_f32_16x16x32_bf16 v[156:159], v[216:219], v[196:199], v[156:159]
 ds_read2_b32 v[78:79], v19 offset0:66 offset1:67
 v_mfma_f32_16x16x32_bf16 v[144:147], v[220:223], v[180:183], v[144:147]
 ds_read_b128 v[48:51], v14 offset:2240
 v_mfma_f32_16x16x32_bf16 v[148:151], v[220:223], v[184:187], v[148:151]
 ds_read2_b32 v[80:81], v20 offset0:64 offset1:65
 v_mfma_f32_16x16x32_bf16 v[152:155], v[220:223], v[188:191], v[152:155]
 ds_read2_b32 v[82:83], v20 offset0:66 offset1:67
 v_mfma_f32_16x16x32_bf16 v[156:159], v[220:223], v[192:195], v[156:159]
 ds_read_b128 v[52:55], v14 offset:2752
 v_mfma_f32_16x16x32_bf16 v[144:147], v[224:227], v[176:179], v[144:147]
 ds_read2_b32 v[84:85], v21 offset0:64 offset1:65
 v_mfma_f32_16x16x32_bf16 v[148:151], v[224:227], v[180:183], v[148:151]
 ds_read2_b32 v[86:87], v21 offset0:66 offset1:67
 v_mfma_f32_16x16x32_bf16 v[152:155], v[224:227], v[184:187], v[152:155]
 ds_read_b128 v[56:59], v14 offset:3264
 v_mfma_f32_16x16x32_bf16 v[156:159], v[224:227], v[188:191], v[156:159]
 ds_read2_b32 v[88:89], v22 offset0:64 offset1:65
 v_mfma_f32_16x16x32_bf16 v[148:151], v[228:231], v[176:179], v[148:151]
 ds_read2_b32 v[90:91], v22 offset0:66 offset1:67
 v_mfma_f32_16x16x32_bf16 v[152:155], v[228:231], v[180:183], v[152:155]
 ds_read_b128 v[60:63], v14 offset:3776
 v_mfma_f32_16x16x32_bf16 v[156:159], v[228:231], v[184:187], v[156:159]
 ds_read2_b32 v[92:93], v23 offset0:64 offset1:65
 v_mfma_f32_16x16x32_bf16 v[152:155], v[232:235], v[176:179], v[152:155]
 ds_read2_b32 v[94:95], v23 offset0:66 offset1:67
 v_mfma_f32_16x16x32_bf16 v[156:159], v[232:235], v[180:183], v[156:159]
 v_mfma_f32_16x16x32_bf16 v[156:159], v[236:239], v[176:179], v[156:159]
 s_waitcnt lgkmcnt(0)
 v_mfma_f32_16x16x32_bf16 v[144:147], v[64:67], v[48:51], v[144:147]
 ds_read_b128 v[176:179], v14 offset:128
 v_mfma_f32_16x16x32_bf16 v[148:151], v[64:67], v[52:55], v[148:151]
 ds_read2_b32 v[208:209], v16 offset0:80 offset1:81
 v_mfma_f32_16x16x32_bf16 v[152:155], v[64:67], v[56:59], v[152:155]
 ds_read2_b32 v[210:211], v16 offset0:82 offset1:83
 v_mfma_f32_16x16x32_bf16 v[156:159], v[64:67], v[60:63], v[156:159]
 ds_read_b128 v[180:183], v14 offset:640
 v_mfma_f32_16x16x32_bf16 v[144:147], v[68:71], v[44:47], v[144:147]
 ds_read2_b32 v[212:213], v17 offset0:80 offset1:81
 v_mfma_f32_16x16x32_bf16 v[148:151], v[68:71], v[48:51], v[148:151]
 ds_read2_b32 v[214:215], v17 offset0:82 offset1:83
 v_mfma_f32_16x16x32_bf16 v[152:155], v[68:71], v[52:55], v[152:155]
 ds_read_b128 v[184:187], v14 offset:1152
 v_mfma_f32_16x16x32_bf16 v[156:159], v[68:71], v[56:59], v[156:159]
 ds_read2_b32 v[216:217], v18 offset0:80 offset1:81
 v_mfma_f32_16x16x32_bf16 v[144:147], v[72:75], v[40:43], v[144:147]
 ds_read2_b32 v[218:219], v18 offset0:82 offset1:83
 v_mfma_f32_16x16x32_bf16 v[148:151], v[72:75], v[44:47], v[148:151]
 ds_read_b128 v[188:191], v14 offset:1664
 v_mfma_f32_16x16x32_bf16 v[152:155], v[72:75], v[48:51], v[152:155]
 ds_read2_b32 v[220:221], v19 offset0:80 offset1:81
 v_mfma_f32_16x16x32_bf16 v[156:159], v[72:75], v[52:55], v[156:159]
 ds_read2_b32 v[222:223], v19 offset0:82 offset1:83
 v_mfma_f32_16x16x32_bf16 v[144:147], v[76:79], v[36:39], v[144:147]
 ds_read_b128 v[192:195], v14 offset:2176
 v_mfma_f32_16x16x32_bf16 v[148:151], v[76:79], v[40:43], v[148:151]
 ds_read2_b32 v[224:225], v20 offset0:80 offset1:81
 v_mfma_f32_16x16x32_bf16 v[152:155], v[76:79], v[44:47], v[152:155]
 ds_read2_b32 v[226:227], v20 offset0:82 offset1:83
 v_mfma_f32_16x16x32_bf16 v[156:159], v[76:79], v[48:51], v[156:159]
 ds_read_b128 v[196:199], v14 offset:2688
 v_mfma_f32_16x16x32_bf16 v[144:147], v[80:83], v[32:35], v[144:147]
 ds_read2_b32 v[228:229], v21 offset0:80 offset1:81
 v_mfma_f32_16x16x32_bf16 v[148:151], v[80:83], v[36:39], v[148:151]
 ds_read2_b32 v[230:231], v21 offset0:82 offset1:83
 v_mfma_f32_16x16x32_bf16 v[152:155], v[80:83], v[40:43], v[152:155]
 ds_read_b128 v[200:203], v14 offset:3200
 v_mfma_f32_16x16x32_bf16 v[156:159], v[80:83], v[44:47], v[156:159]
 ds_read2_b32 v[232:233], v22 offset0:80 offset1:81
 v_mfma_f32_16x16x32_bf16 v[148:151], v[84:87], v[32:35], v[148:151]
 ds_read2_b32 v[234:235], v22 offset0:82 offset1:83
 v_mfma_f32_16x16x32_bf16 v[152:155], v[84:87], v[36:39], v[152:155]
 ds_read_b128 v[204:207], v14 offset:3712
 v_mfma_f32_16x16x32_bf16 v[156:159], v[84:87], v[40:43], v[156:159]
 ds_read2_b32 v[236:237], v23 offset0:80 offset1:81
 v_mfma_f32_16x16x32_bf16 v[152:155], v[88:91], v[32:35], v[152:155]
 ds_read2_b32 v[238:239], v23 offset0:82 offset1:83
 v_mfma_f32_16x16x32_bf16 v[156:159], v[88:91], v[36:39], v[156:159]
 v_mfma_f32_16x16x32_bf16 v[156:159], v[92:95], v[32:35], v[156:159]
 s_waitcnt lgkmcnt(0)
 v_mfma_f32_16x16x32_bf16 v[144:147], v[208:211], v[192:195], v[144:147]
 ds_read_b128 v[32:35], v14 offset:64
 v_mfma_f32_16x16x32_bf16 v[148:151], v[208:211], v[196:199], v[148:151]
 ds_read2_b32 v[64:65], v16 offset0:96 offset1:97
 v_mfma_f32_16x16x32_bf16 v[152:155], v[208:211], v[200:203], v[152:155]
 ds_read2_b32 v[66:67], v16 offset0:98 offset1:99
 v_mfma_f32_16x16x32_bf16 v[156:159], v[208:211], v[204:207], v[156:159]
 ds_read_b128 v[36:39], v14 offset:576
 v_mfma_f32_16x16x32_bf16 v[144:147], v[212:215], v[188:191], v[144:147]
 ds_read2_b32 v[68:69], v17 offset0:96 offset1:97
 v_mfma_f32_16x16x32_bf16 v[148:151], v[212:215], v[192:195], v[148:151]
 ds_read2_b32 v[70:71], v17 offset0:98 offset1:99
 v_mfma_f32_16x16x32_bf16 v[152:155], v[212:215], v[196:199], v[152:155]
 ds_read_b128 v[40:43], v14 offset:1088
 v_mfma_f32_16x16x32_bf16 v[156:159], v[212:215], v[200:203], v[156:159]
 ds_read2_b32 v[72:73], v18 offset0:96 offset1:97
 v_mfma_f32_16x16x32_bf16 v[144:147], v[216:219], v[184:187], v[144:147]
 ds_read2_b32 v[74:75], v18 offset0:98 offset1:99
 v_mfma_f32_16x16x32_bf16 v[148:151], v[216:219], v[188:191], v[148:151]
 ds_read_b128 v[44:47], v14 offset:1600
 v_mfma_f32_16x16x32_bf16 v[152:155], v[216:219], v[192:195], v[152:155]
 ds_read2_b32 v[76:77], v19 offset0:96 offset1:97
 v_mfma_f32_16x16x32_bf16 v[156:159], v[216:219], v[196:199], v[156:159]
 ds_read2_b32 v[78:79], v19 offset0:98 offset1:99
 v_mfma_f32_16x16x32_bf16 v[144:147], v[220:223], v[180:183], v[144:147]
 ds_read_b128 v[48:51], v14 offset:2112
 v_mfma_f32_16x16x32_bf16 v[148:151], v[220:223], v[184:187], v[148:151]
 ds_read2_b32 v[80:81], v20 offset0:96 offset1:97
 v_mfma_f32_16x16x32_bf16 v[152:155], v[220:223], v[188:191], v[152:155]
 ds_read2_b32 v[82:83], v20 offset0:98 offset1:99
 v_mfma_f32_16x16x32_bf16 v[156:159], v[220:223], v[192:195], v[156:159]
 ds_read_b128 v[52:55], v14 offset:2624
 v_mfma_f32_16x16x32_bf16 v[144:147], v[224:227], v[176:179], v[144:147]
 ds_read2_b32 v[84:85], v21 offset0:96 offset1:97
 v_mfma_f32_16x16x32_bf16 v[148:151], v[224:227], v[180:183], v[148:151]
 ds_read2_b32 v[86:87], v21 offset0:98 offset1:99
 v_mfma_f32_16x16x32_bf16 v[152:155], v[224:227], v[184:187], v[152:155]
 ds_read_b128 v[56:59], v14 offset:3136
 v_mfma_f32_16x16x32_bf16 v[156:159], v[224:227], v[188:191], v[156:159]
 ds_read2_b32 v[88:89], v22 offset0:96 offset1:97
 v_mfma_f32_16x16x32_bf16 v[148:151], v[228:231], v[176:179], v[148:151]
 ds_read2_b32 v[90:91], v22 offset0:98 offset1:99
 v_mfma_f32_16x16x32_bf16 v[152:155], v[228:231], v[180:183], v[152:155]
 ds_read_b128 v[60:63], v14 offset:3648
 v_mfma_f32_16x16x32_bf16 v[156:159], v[228:231], v[184:187], v[156:159]
 ds_read2_b32 v[92:93], v23 offset0:96 offset1:97
 v_mfma_f32_16x16x32_bf16 v[152:155], v[232:235], v[176:179], v[152:155]
 ds_read2_b32 v[94:95], v23 offset0:98 offset1:99
 v_mfma_f32_16x16x32_bf16 v[156:159], v[232:235], v[180:183], v[156:159]
 v_mfma_f32_16x16x32_bf16 v[156:159], v[236:239], v[176:179], v[156:159]
 s_waitcnt lgkmcnt(0)
 v_mfma_f32_16x16x32_bf16 v[144:147], v[64:67], v[48:51], v[144:147]
 ds_read_b128 v[176:179], v14 offset:0
 v_mfma_f32_16x16x32_bf16 v[148:151], v[64:67], v[52:55], v[148:151]
 ds_read2_b32 v[208:209], v16 offset0:112 offset1:113
 v_mfma_f32_16x16x32_bf16 v[152:155], v[64:67], v[56:59], v[152:155]
 ds_read2_b32 v[210:211], v16 offset0:114 offset1:115
 v_mfma_f32_16x16x32_bf16 v[156:159], v[64:67], v[60:63], v[156:159]
 ds_read_b128 v[180:183], v14 offset:512
 v_mfma_f32_16x16x32_bf16 v[144:147], v[68:71], v[44:47], v[144:147]
 ds_read2_b32 v[212:213], v17 offset0:112 offset1:113
 v_mfma_f32_16x16x32_bf16 v[148:151], v[68:71], v[48:51], v[148:151]
 ds_read2_b32 v[214:215], v17 offset0:114 offset1:115
 v_mfma_f32_16x16x32_bf16 v[152:155], v[68:71], v[52:55], v[152:155]
 ds_read_b128 v[184:187], v14 offset:1024
 v_mfma_f32_16x16x32_bf16 v[156:159], v[68:71], v[56:59], v[156:159]
 ds_read2_b32 v[216:217], v18 offset0:112 offset1:113
 v_mfma_f32_16x16x32_bf16 v[144:147], v[72:75], v[40:43], v[144:147]
 ds_read2_b32 v[218:219], v18 offset0:114 offset1:115
 v_mfma_f32_16x16x32_bf16 v[148:151], v[72:75], v[44:47], v[148:151]
 ds_read_b128 v[188:191], v14 offset:1536
 v_mfma_f32_16x16x32_bf16 v[152:155], v[72:75], v[48:51], v[152:155]
 ds_read2_b32 v[220:221], v19 offset0:112 offset1:113
 v_mfma_f32_16x16x32_bf16 v[156:159], v[72:75], v[52:55], v[156:159]
 ds_read2_b32 v[222:223], v19 offset0:114 offset1:115
 v_mfma_f32_16x16x32_bf16 v[144:147], v[76:79], v[36:39], v[144:147]
 ds_read_b128 v[192:195], v14 offset:2048
 v_mfma_f32_16x16x32_bf16 v[148:151], v[76:79], v[40:43], v[148:151]
 ds_read2_b32 v[224:225], v20 offset0:112 offset1:113
 v_mfma_f32_16x16x32_bf16 v[152:155], v[76:79], v[44:47], v[152:155]
 ds_read2_b32 v[226:227], v20 offset0:114 offset1:115
 v_mfma_f32_16x16x32_bf16 v[156:159], v[76:79], v[48:51], v[156:159]
 ds_read_b128 v[196:199], v14 offset:2560
 v_mfma_f32_16x16x32_bf16 v[144:147], v[80:83], v[32:35], v[144:147]
 ds_read2_b32 v[228:229], v21 offset0:112 offset1:113
 v_mfma_f32_16x16x32_bf16 v[148:151], v[80:83], v[36:39], v[148:151]
 ds_read2_b32 v[230:231], v21 offset0:114 offset1:115
 v_mfma_f32_16x16x32_bf16 v[152:155], v[80:83], v[40:43], v[152:155]
 ds_read_b128 v[200:203], v14 offset:3072
 v_mfma_f32_16x16x32_bf16 v[156:159], v[80:83], v[44:47], v[156:159]
 ds_read2_b32 v[232:233], v22 offset0:112 offset1:113
 v_mfma_f32_16x16x32_bf16 v[148:151], v[84:87], v[32:35], v[148:151]
 ds_read2_b32 v[234:235], v22 offset0:114 offset1:115
 v_mfma_f32_16x16x32_bf16 v[152:155], v[84:87], v[36:39], v[152:155]
 ds_read_b128 v[204:207], v14 offset:3584
 v_mfma_f32_16x16x32_bf16 v[156:159], v[84:87], v[40:43], v[156:159]
 ds_read2_b32 v[236:237], v23 offset0:112 offset1:113
 v_mfma_f32_16x16x32_bf16 v[152:155], v[88:91], v[32:35], v[152:155]
 ds_read2_b32 v[238:239], v23 offset0:114 offset1:115
 v_mfma_f32_16x16x32_bf16 v[156:159], v[88:91], v[36:39], v[156:159]
 v_mfma_f32_16x16x32_bf16 v[156:159], v[92:95], v[32:35], v[156:159]
 s_waitcnt lgkmcnt(0)
 v_mfma_f32_16x16x32_bf16 v[144:147], v[208:211], v[192:195], v[144:147]
 ds_read_b64 v[32:33], v15 offset:2048
 v_mfma_f32_16x16x32_bf16 v[148:151], v[208:211], v[196:199], v[148:151]
 ds_read_b64 v[34:35], v15 offset:2560
 v_mfma_f32_16x16x32_bf16 v[152:155], v[208:211], v[200:203], v[152:155]
 ds_read_b64 v[36:37], v15 offset:3072
 v_mfma_f32_16x16x32_bf16 v[156:159], v[208:211], v[204:207], v[156:159]
 ds_read_b64 v[38:39], v15 offset:3584
 v_mfma_f32_16x16x32_bf16 v[144:147], v[212:215], v[188:191], v[144:147]
 v_mfma_f32_16x16x32_bf16 v[148:151], v[212:215], v[192:195], v[148:151]
 v_mfma_f32_16x16x32_bf16 v[152:155], v[212:215], v[196:199], v[152:155]
 v_mfma_f32_16x16x32_bf16 v[156:159], v[212:215], v[200:203], v[156:159]
 v_mfma_f32_16x16x32_bf16 v[144:147], v[216:219], v[184:187], v[144:147]
 v_mfma_f32_16x16x32_bf16 v[148:151], v[216:219], v[188:191], v[148:151]
 v_mfma_f32_16x16x32_bf16 v[152:155], v[216:219], v[192:195], v[152:155]
 v_mfma_f32_16x16x32_bf16 v[156:159], v[216:219], v[196:199], v[156:159]
 v_mfma_f32_16x16x32_bf16 v[144:147], v[220:223], v[180:183], v[144:147]
 v_mfma_f32_16x16x32_bf16 v[148:151], v[220:223], v[184:187], v[148:151]
 v_mfma_f32_16x16x32_bf16 v[152:155], v[220:223], v[188:191], v[152:155]
 v_mfma_f32_16x16x32_bf16 v[156:159], v[220:223], v[192:195], v[156:159]
 v_mfma_f32_16x16x32_bf16 v[144:147], v[224:227], v[176:179], v[144:147]
 v_mfma_f32_16x16x32_bf16 v[148:151], v[224:227], v[180:183], v[148:151]
 v_mfma_f32_16x16x32_bf16 v[152:155], v[224:227], v[184:187], v[152:155]
 v_mfma_f32_16x16x32_bf16 v[156:159], v[224:227], v[188:191], v[156:159]
 v_mfma_f32_16x16x32_bf16 v[148:151], v[228:231], v[176:179], v[148:151]
 v_mfma_f32_16x16x32_bf16 v[152:155], v[228:231], v[180:183], v[152:155]
 v_mfma_f32_16x16x32_bf16 v[156:159], v[228:231], v[184:187], v[156:159]
 v_mfma_f32_16x16x32_bf16 v[152:155], v[232:235], v[176:179], v[152:155]
 v_mfma_f32_16x16x32_bf16 v[156:159], v[232:235], v[180:183], v[156:159]
 v_mfma_f32_16x16x32_bf16 v[156:159], v[236:239], v[176:179], v[156:159]
 s_waitcnt lgkmcnt(0)
 v_and_b32 v64, 0xffff0000, v33
 v_lshlrev_b32 v65, 16, v33
 v_and_b32 v66, 0xffff0000, v32
 v_lshlrev_b32 v67, 16, v32
 v_mul_f32 v64, v64, v12
 v_mul_f32 v65, v65, v12
 v_mul_f32 v66, v66, v12
 v_mul_f32 v67, v67, v12
 v_and_b32 v68, 0xffff0000, v35
 v_lshlrev_b32 v69, 16, v35
 v_and_b32 v70, 0xffff0000, v34
 v_lshlrev_b32 v71, 16, v34
 v_mul_f32 v68, v68, v12
 v_mul_f32 v69, v69, v12
 v_mul_f32 v70, v70, v12
 v_mul_f32 v71, v71, v12
 v_and_b32 v72, 0xffff0000, v37
 v_lshlrev_b32 v73, 16, v37
 v_and_b32 v74, 0xffff0000, v36
 v_lshlrev_b32 v75, 16, v36
 v_mul_f32 v72, v72, v12
 v_mul_f32 v73, v73, v12
 v_mul_f32 v74, v74, v12
 v_mul_f32 v75, v75, v12
 v_and_b32 v76, 0xffff0000, v39
 v_lshlrev_b32 v77, 16, v39
 v_and_b32 v78, 0xffff0000, v38
 v_lshlrev_b32 v79, 16, v38
 v_mul_f32 v76, v76, v12
 v_mul_f32 v77, v77, v12
 v_mul_f32 v78, v78, v12
 v_mul_f32 v79, v79, v12
 v_cvt_pk_bf16_f32 v8, v64, v65
 v_lshlrev_b32 v64, 16, v8
 v_and_b32 v65, 0xffff0000, v8
 v_cvt_pk_bf16_f32 v8, v66, v67
 v_lshlrev_b32 v66, 16, v8
 v_and_b32 v67, 0xffff0000, v8
 v_cvt_pk_bf16_f32 v8, v68, v69
 v_lshlrev_b32 v68, 16, v8
 v_and_b32 v69, 0xffff0000, v8
 v_cvt_pk_bf16_f32 v8, v70, v71
 v_lshlrev_b32 v70, 16, v8
 v_and_b32 v71, 0xffff0000, v8
 v_cvt_pk_bf16_f32 v8, v72, v73
 v_lshlrev_b32 v72, 16, v8
 v_and_b32 v73, 0xffff0000, v8
 v_cvt_pk_bf16_f32 v8, v74, v75
 v_lshlrev_b32 v74, 16, v8
 v_and_b32 v75, 0xffff0000, v8
 v_cvt_pk_bf16_f32 v8, v76, v77
 v_lshlrev_b32 v76, 16, v8
 v_and_b32 v77, 0xffff0000, v8
 v_cvt_pk_bf16_f32 v8, v78, v79
 v_lshlrev_b32 v78, 16, v8
 v_and_b32 v79, 0xffff0000, v8
 v_cvt_pk_bf16_f32 v8, v144, v145
 v_lshlrev_b32 v144, 16, v8
 v_and_b32 v145, 0xffff0000, v8
 v_cvt_pk_bf16_f32 v8, v146, v147
 v_lshlrev_b32 v146, 16, v8
 v_and_b32 v147, 0xffff0000, v8
 v_cvt_pk_bf16_f32 v8, v148, v149
 v_lshlrev_b32 v148, 16, v8
 v_and_b32 v149, 0xffff0000, v8
 v_cvt_pk_bf16_f32 v8, v150, v151
 v_lshlrev_b32 v150, 16, v8
 v_and_b32 v151, 0xffff0000, v8
 v_cvt_pk_bf16_f32 v8, v152, v153
 v_lshlrev_b32 v152, 16, v8
 v_and_b32 v153, 0xffff0000, v8
 v_cvt_pk_bf16_f32 v8, v154, v155
 v_lshlrev_b32 v154, 16, v8
 v_and_b32 v155, 0xffff0000, v8
 v_cvt_pk_bf16_f32 v8, v156, v157
 v_lshlrev_b32 v156, 16, v8
 v_and_b32 v157, 0xffff0000, v8
 v_cvt_pk_bf16_f32 v8, v158, v159
 v_lshlrev_b32 v158, 16, v8
 v_and_b32 v159, 0xffff0000, v8
 v_pk_add_f32 v[144:145], v[144:145], v[64:65]
 v_pk_add_f32 v[146:147], v[146:147], v[66:67]
 v_pk_add_f32 v[148:149], v[148:149], v[68:69]
 v_pk_add_f32 v[150:151], v[150:151], v[70:71]
 v_pk_add_f32 v[152:153], v[152:153], v[72:73]
 v_pk_add_f32 v[154:155], v[154:155], v[74:75]
 v_pk_add_f32 v[156:157], v[156:157], v[76:77]
 v_pk_add_f32 v[158:159], v[158:159], v[78:79]
 v_cvt_pk_bf16_f32 v160, v144, v148
 v_cvt_pk_bf16_f32 v161, v152, v156
 buffer_store_dwordx2 v[160:161], v13, s[4:7], s72 offen sc1
 s_add_u32 s72, s72, 40960
 v_cvt_pk_bf16_f32 v162, v145, v149
 v_cvt_pk_bf16_f32 v163, v153, v157
 buffer_store_dwordx2 v[162:163], v13, s[4:7], s72 offen sc1
 s_add_u32 s72, s72, 40960
 v_cvt_pk_bf16_f32 v164, v146, v150
 v_cvt_pk_bf16_f32 v165, v154, v158
 buffer_store_dwordx2 v[164:165], v13, s[4:7], s72 offen sc1
 s_add_u32 s72, s72, 40960
 v_cvt_pk_bf16_f32 v166, v147, v151
 v_cvt_pk_bf16_f32 v167, v155, v159
 buffer_store_dwordx2 v[166:167], v13, s[4:7], s72 offen sc1
 s_add_u32 s72, s72, 40960
 s_cmp_lt_u32 s70, 640
 s_cbranch_scc1 L_cv_5
 s_setpc_b64 s[76:77]
L_helper:
 s_lshl_b32 s60, s82, 2
 s_add_u32 s60, s60, s50
 s_mov_b32 s72, s60
 s_mov_b32 s8, s16
 s_and_b32 s9, s17, 0xffff
 s_mov_b32 s10, 2621440
 s_mov_b32 s11, 0x00020000
 v_lshlrev_b32 v1, 4, v0
 v_lshlrev_b32 v2, 3, v0
 v_cmp_lt_u32 vcc, 31, v0
 v_mov_b32 v3, 268435456
 s_nop 1
 v_cndmask_b32 v7, v2, v3, vcc
 s_mov_b32 s63, 0x3acccccd
 s_mov_b32 s68, 0x3727c5ac
 s_add_u32 s3, s72, 0
 s_mul_i32 s3, s3, 1280
 buffer_load_dwordx2 v[48:49], v2, s[8:11], s3 offen offset:0
 buffer_load_dwordx2 v[50:51], v2, s[8:11], s3 offen offset:512
 buffer_load_dwordx2 v[52:53], v7, s[8:11], s3 offen offset:1024
 v_mov_b32 v12, 0
 v_mov_b32 v13, 0
 v_mov_b32 v14, 0
 v_mov_b32 v15, 0
 s_lshl_b32 s73, s60, 10
 s_add_u32 s73, s73, 0
L_cl_6:
 s_cmp_ge_u32 s73, 225280
 s_cbranch_scc1 L_cle_7
 buffer_store_dwordx4 v[12:15], v1, s[4:7], s73 offen sc1
 s_add_u32 s73, s73, 393216
 s_branch L_cl_6
L_cle_7:
 s_nop 1
 s_waitcnt vmcnt(0)
L_ln_8:
 v_lshlrev_b32 v12, 16, v48
 v_and_b32 v13, 0xffff0000, v48
 v_lshlrev_b32 v14, 16, v49
 v_and_b32 v15, 0xffff0000, v49
 v_lshlrev_b32 v16, 16, v50
 v_and_b32 v17, 0xffff0000, v50
 v_lshlrev_b32 v18, 16, v51
 v_and_b32 v19, 0xffff0000, v51
 v_lshlrev_b32 v20, 16, v52
 v_and_b32 v21, 0xffff0000, v52
 v_lshlrev_b32 v22, 16, v53
 v_and_b32 v23, 0xffff0000, v53
 s_and_b32 s3, s72, 15
 v_lshrrev_b32 v4, 3, v0
 v_lshlrev_b32 v4, 2, v4
 v_and_b32 v9, 3, v0
 v_add_u32 v4, v4, v9
 v_xor_b32 v4, s3, v4
 v_lshlrev_b32 v4, 4, v4
 v_and_b32 v9, 4, v0
 v_lshl_add_u32 v4, v9, 1, v4
 v_cndmask_b32 v8, v4, v3, vcc
 v_readfirstlane_b32 s3, v12
 s_nop 1
 v_subrev_f32 v36, s3, v12
 v_subrev_f32 v37, s3, v13
 v_subrev_f32 v38, s3, v14
 v_subrev_f32 v39, s3, v15
 v_subrev_f32 v40, s3, v16
 v_subrev_f32 v41, s3, v17
 v_subrev_f32 v42, s3, v18
 v_subrev_f32 v43, s3, v19
 v_mov_b32 v44, 0
 v_mov_b32 v45, 0
 v_mov_b32 v46, 0
 v_mov_b32 v47, 0
 s_mov_b32 exec_hi, 0
 v_subrev_f32 v44, s3, v20
 v_subrev_f32 v45, s3, v21
 v_subrev_f32 v46, s3, v22
 v_subrev_f32 v47, s3, v23
 s_mov_b32 exec_hi, -1
 v_pk_mul_f32 v[10:11], v[36:37], v[36:37]
 v_pk_fma_f32 v[10:11], v[38:39], v[38:39], v[10:11]
 v_pk_fma_f32 v[10:11], v[40:41], v[40:41], v[10:11]
 v_pk_fma_f32 v[10:11], v[42:43], v[42:43], v[10:11]
 v_pk_fma_f32 v[10:11], v[44:45], v[44:45], v[10:11]
 v_pk_fma_f32 v[10:11], v[46:47], v[46:47], v[10:11]
 v_pk_add_f32 v[36:37], v[36:37], v[38:39]
 v_pk_add_f32 v[36:37], v[36:37], v[40:41]
 v_pk_add_f32 v[36:37], v[36:37], v[42:43]
 v_pk_add_f32 v[36:37], v[36:37], v[44:45]
 v_pk_add_f32 v[36:37], v[36:37], v[46:47]
 v_add_f32 v11, v10, v11
 v_add_f32 v10, v36, v37
 s_nop 0
 v_add_f32_dpp v11, v11, v11 quad_perm:[1,0,3,2] row_mask:0xf bank_mask:0xf
 v_add_f32_dpp v10, v10, v10 quad_perm:[1,0,3,2] row_mask:0xf bank_mask:0xf
 s_nop 0
 v_add_f32_dpp v11, v11, v11 quad_perm:[2,3,0,1] row_mask:0xf bank_mask:0xf
 v_add_f32_dpp v10, v10, v10 quad_perm:[2,3,0,1] row_mask:0xf bank_mask:0xf
 s_nop 0
 v_add_f32_dpp v11, v11, v11 row_half_mirror row_mask:0xf bank_mask:0xf
 v_add_f32_dpp v10, v10, v10 row_half_mirror row_mask:0xf bank_mask:0xf
 s_nop 0
 v_add_f32_dpp v11, v11, v11 row_mirror row_mask:0xf bank_mask:0xf
 v_add_f32_dpp v10, v10, v10 row_mirror row_mask:0xf bank_mask:0xf
 v_mov_b32 v37, v11
 v_mov_b32 v36, v10
 s_nop 0
 v_permlane16_swap_b32 v11, v37
 v_permlane16_swap_b32 v10, v36
 v_pk_add_f32 v[10:11], v[10:11], v[36:37]
 v_mov_b32 v37, v11
 v_mov_b32 v36, v10
 s_nop 0
 v_permlane32_swap_b32 v11, v37
 v_permlane32_swap_b32 v10, v36
 v_pk_add_f32 v[10:11], v[10:11], v[36:37]
 v_mul_f32 v10, s63, v10
 v_mul_f32 v11, s63, v11
 v_fma_f32 v11, -v10, v10, v11
 v_max_f32 v11, 0, v11
 v_add_f32 v10, s3, v10
 v_cvt_pk_bf16_f32 v9, v10, v11
 v_lshlrev_b32 v10, 16, v9
 v_and_b32 v11, 0xffff0000, v9
 v_add_f32 v11, s68, v11
 v_cvt_pk_bf16_f32 v11, v11, v11
 v_and_b32 v11, 0xffff0000, v11
 v_sqrt_f32 v11, v11
 s_nop 0
 v_pk_add_f32 v[36:37], v[12:13], v[10:11] op_sel_hi:[1,0] neg_lo:[0,1] neg_hi:[0,1]
 v_pk_add_f32 v[38:39], v[14:15], v[10:11] op_sel_hi:[1,0] neg_lo:[0,1] neg_hi:[0,1]
 v_pk_add_f32 v[40:41], v[16:17], v[10:11] op_sel_hi:[1,0] neg_lo:[0,1] neg_hi:[0,1]
 v_pk_add_f32 v[42:43], v[18:19], v[10:11] op_sel_hi:[1,0] neg_lo:[0,1] neg_hi:[0,1]
 v_pk_add_f32 v[44:45], v[20:21], v[10:11] op_sel_hi:[1,0] neg_lo:[0,1] neg_hi:[0,1]
 v_pk_add_f32 v[46:47], v[22:23], v[10:11] op_sel_hi:[1,0] neg_lo:[0,1] neg_hi:[0,1]
 v_cvt_pk_bf16_f32 v11, v11, v11
 v_and_b32 v11, 0xffff0000, v11
 v_rcp_f32 v11, v11
 v_cvt_pk_bf16_f32 v9, v36, v37
 v_lshlrev_b32 v36, 16, v9
 v_and_b32 v37, 0xffff0000, v9
 v_cvt_pk_bf16_f32 v9, v38, v39
 v_lshlrev_b32 v38, 16, v9
 v_and_b32 v39, 0xffff0000, v9
 v_cvt_pk_bf16_f32 v9, v40, v41
 v_lshlrev_b32 v40, 16, v9
 v_and_b32 v41, 0xffff0000, v9
 v_cvt_pk_bf16_f32 v9, v42, v43
 v_lshlrev_b32 v42, 16, v9
 v_and_b32 v43, 0xffff0000, v9
 v_cvt_pk_bf16_f32 v9, v44, v45
 v_lshlrev_b32 v44, 16, v9
 v_and_b32 v45, 0xffff0000, v9
 v_cvt_pk_bf16_f32 v9, v46, v47
 v_lshlrev_b32 v46, 16, v9
 v_and_b32 v47, 0xffff0000, v9
 v_pk_mul_f32 v[36:37], v[36:37], v[10:11] op_sel:[0,1] op_sel_hi:[1,1]
 v_pk_mul_f32 v[38:39], v[38:39], v[10:11] op_sel:[0,1] op_sel_hi:[1,1]
 v_pk_mul_f32 v[40:41], v[40:41], v[10:11] op_sel:[0,1] op_sel_hi:[1,1]
 v_pk_mul_f32 v[42:43], v[42:43], v[10:11] op_sel:[0,1] op_sel_hi:[1,1]
 v_pk_mul_f32 v[44:45], v[44:45], v[10:11] op_sel:[0,1] op_sel_hi:[1,1]
 v_pk_mul_f32 v[46:47], v[46:47], v[10:11] op_sel:[0,1] op_sel_hi:[1,1]
 v_cvt_pk_bf16_f32 v24, v36, v37
 v_cvt_pk_bf16_f32 v25, v38, v39
 v_cvt_pk_bf16_f32 v26, v40, v41
 v_cvt_pk_bf16_f32 v27, v42, v43
 v_cvt_pk_bf16_f32 v28, v44, v45
 v_cvt_pk_bf16_f32 v29, v46, v47
 s_mul_i32 s3, s72, 1280
 s_add_u32 s3, s3, 226492416
 buffer_store_dwordx2 v[24:25], v4, s[4:7], s3 offen offset:0 sc1
 buffer_store_dwordx2 v[26:27], v4, s[4:7], s3 offen offset:512 sc1
 buffer_store_dwordx2 v[28:29], v8, s[4:7], s3 offen offset:1024 sc1
 s_waitcnt vmcnt(0)
 s_barrier
 s_cmp_lg_u32 s50, 3
 s_cbranch_scc1 L_ar_9
 s_mov_b32 s96, s44
 s_and_b32 s97, s45, 0xffff
 s_mov_b32 s98, 256
 s_mov_b32 s99, 0x00020000
 v_mov_b32 v1, 1
 s_mov_b64 exec, 1
 buffer_atomic_add v1, off, s[96:99], 0 offset:4 sc0
 s_waitcnt vmcnt(0)
 v_cmp_eq_u32 vcc, 95, v1
 s_cbranch_vccz L_aw_10
 buffer_store_dword v1, off, s[96:99], 0 offset:132 sc1
L_aw_10:
 s_mov_b64 exec, -1
L_ar_9:
 s_cmp_lt_u32 s82, 72
 s_cbranch_scc1 L_np_11
 s_sub_u32 s60, s60, 288
 v_lshlrev_b32 v1, 4, v0
 v_mov_b32 v12, 0
 v_mov_b32 v13, 0
 v_mov_b32 v14, 0
 v_mov_b32 v15, 0
 s_lshl_b32 s73, s60, 10
 s_add_u32 s73, s73, 225280
L_cl_12:
 s_cmp_ge_u32 s73, 946176
 s_cbranch_scc1 L_cle_13
 buffer_store_dwordx4 v[12:15], v1, s[4:7], s73 offen sc1
 s_add_u32 s73, s73, 98304
 s_branch L_cl_12
L_cle_13:
 s_nop 1
 v_mov_b32 v12, -1
 v_mov_b32 v13, -1
 v_mov_b32 v14, -1
 v_mov_b32 v15, -1
 s_lshl_b32 s73, s60, 10
 s_add_u32 s73, s73, 983040
L_cl_14:
 s_cmp_ge_u32 s73, 3211264
 s_cbranch_scc1 L_cle_15
 buffer_store_dwordx4 v[12:15], v1, s[4:7], s73 offen sc1
 s_add_u32 s73, s73, 98304
 s_branch L_cl_14
L_cle_15:
 s_nop 1
 s_waitcnt vmcnt(29)
 s_waitcnt vmcnt(0)
 s_barrier
 s_cmp_lg_u32 s50, 3
 s_cbranch_scc1 L_ar_16
 s_mov_b32 s96, s44
 s_and_b32 s97, s45, 0xffff
 s_mov_b32 s98, 256
 s_mov_b32 s99, 0x00020000
 v_mov_b32 v1, 1
 s_mov_b64 exec, 1
 buffer_atomic_add v1, off, s[96:99], 0 offset:84 sc0
 s_waitcnt vmcnt(0)
 v_cmp_eq_u32 vcc, 23, v1
 s_cbranch_vccz L_aw_17
 buffer_store_dword v1, off, s[96:99], 0 offset:212 sc1
L_aw_17:
 s_mov_b64 exec, -1
L_ar_16:
 s_add_u32 s60, s60, 288
 s_cmp_lt_u32 s82, 80
 s_cbranch_scc1 L_np_11
 s_add_u32 s72, s60, 64
 s_mov_b32 s8, s16
 s_and_b32 s9, s17, 0xffff
 s_mov_b32 s10, 2621440
 s_mov_b32 s11, 0x00020000
 v_lshlrev_b32 v1, 4, v0
 v_lshlrev_b32 v2, 3, v0
 v_cmp_lt_u32 vcc, 31, v0
 v_mov_b32 v3, 268435456
 s_nop 1
 v_cndmask_b32 v7, v2, v3, vcc
 s_mov_b32 s63, 0x3acccccd
 s_mov_b32 s68, 0x3727c5ac
 s_add_u32 s3, s72, 0
 s_mul_i32 s3, s3, 1280
 buffer_load_dwordx2 v[48:49], v2, s[8:11], s3 offen offset:0
 buffer_load_dwordx2 v[50:51], v2, s[8:11], s3 offen offset:512
 buffer_load_dwordx2 v[52:53], v7, s[8:11], s3 offen offset:1024
 s_waitcnt vmcnt(0)
L_ln_18:
 v_lshlrev_b32 v12, 16, v48
 v_and_b32 v13, 0xffff0000, v48
 v_lshlrev_b32 v14, 16, v49
 v_and_b32 v15, 0xffff0000, v49
 v_lshlrev_b32 v16, 16, v50
 v_and_b32 v17, 0xffff0000, v50
 v_lshlrev_b32 v18, 16, v51
 v_and_b32 v19, 0xffff0000, v51
 v_lshlrev_b32 v20, 16, v52
 v_and_b32 v21, 0xffff0000, v52
 v_lshlrev_b32 v22, 16, v53
 v_and_b32 v23, 0xffff0000, v53
 s_add_u32 s3, s72, 64
 s_mul_i32 s3, s3, 1280
 buffer_load_dwordx2 v[48:49], v2, s[8:11], s3 offen offset:0
 buffer_load_dwordx2 v[50:51], v2, s[8:11], s3 offen offset:512
 buffer_load_dwordx2 v[52:53], v7, s[8:11], s3 offen offset:1024
 s_and_b32 s3, s72, 15
 v_lshrrev_b32 v4, 3, v0
 v_lshlrev_b32 v4, 2, v4
 v_and_b32 v9, 3, v0
 v_add_u32 v4, v4, v9
 v_xor_b32 v4, s3, v4
 v_lshlrev_b32 v4, 4, v4
 v_and_b32 v9, 4, v0
 v_lshl_add_u32 v4, v9, 1, v4
 v_cndmask_b32 v8, v4, v3, vcc
 v_readfirstlane_b32 s3, v12
 s_nop 1
 v_subrev_f32 v36, s3, v12
 v_subrev_f32 v37, s3, v13
 v_subrev_f32 v38, s3, v14
 v_subrev_f32 v39, s3, v15
 v_subrev_f32 v40, s3, v16
 v_subrev_f32 v41, s3, v17
 v_subrev_f32 v42, s3, v18
 v_subrev_f32 v43, s3, v19
 v_mov_b32 v44, 0
 v_mov_b32 v45, 0
 v_mov_b32 v46, 0
 v_mov_b32 v47, 0
 s_mov_b32 exec_hi, 0
 v_subrev_f32 v44, s3, v20
 v_subrev_f32 v45, s3, v21
 v_subrev_f32 v46, s3, v22
 v_subrev_f32 v47, s3, v23
 s_mov_b32 exec_hi, -1
 v_pk_mul_f32 v[10:11], v[36:37], v[36:37]
 v_pk_fma_f32 v[10:11], v[38:39], v[38:39], v[10:11]
 v_pk_fma_f32 v[10:11], v[40:41], v[40:41], v[10:11]
 v_pk_fma_f32 v[10:11], v[42:43], v[42:43], v[10:11]
 v_pk_fma_f32 v[10:11], v[44:45], v[44:45], v[10:11]
 v_pk_fma_f32 v[10:11], v[46:47], v[46:47], v[10:11]
 v_pk_add_f32 v[36:37], v[36:37], v[38:39]
 v_pk_add_f32 v[36:37], v[36:37], v[40:41]
 v_pk_add_f32 v[36:37], v[36:37], v[42:43]
 v_pk_add_f32 v[36:37], v[36:37], v[44:45]
 v_pk_add_f32 v[36:37], v[36:37], v[46:47]
 v_add_f32 v11, v10, v11
 v_add_f32 v10, v36, v37
 s_nop 0
 v_add_f32_dpp v11, v11, v11 quad_perm:[1,0,3,2] row_mask:0xf bank_mask:0xf
 v_add_f32_dpp v10, v10, v10 quad_perm:[1,0,3,2] row_mask:0xf bank_mask:0xf
 s_nop 0
 v_add_f32_dpp v11, v11, v11 quad_perm:[2,3,0,1] row_mask:0xf bank_mask:0xf
 v_add_f32_dpp v10, v10, v10 quad_perm:[2,3,0,1] row_mask:0xf bank_mask:0xf
 s_nop 0
 v_add_f32_dpp v11, v11, v11 row_half_mirror row_mask:0xf bank_mask:0xf
 v_add_f32_dpp v10, v10, v10 row_half_mirror row_mask:0xf bank_mask:0xf
 s_nop 0
 v_add_f32_dpp v11, v11, v11 row_mirror row_mask:0xf bank_mask:0xf
 v_add_f32_dpp v10, v10, v10 row_mirror row_mask:0xf bank_mask:0xf
 v_mov_b32 v37, v11
 v_mov_b32 v36, v10
 s_nop 0
 v_permlane16_swap_b32 v11, v37
 v_permlane16_swap_b32 v10, v36
 v_pk_add_f32 v[10:11], v[10:11], v[36:37]
 v_mov_b32 v37, v11
 v_mov_b32 v36, v10
 s_nop 0
 v_permlane32_swap_b32 v11, v37
 v_permlane32_swap_b32 v10, v36
 v_pk_add_f32 v[10:11], v[10:11], v[36:37]
 v_mul_f32 v10, s63, v10
 v_mul_f32 v11, s63, v11
 v_fma_f32 v11, -v10, v10, v11
 v_max_f32 v11, 0, v11
 v_add_f32 v10, s3, v10
 v_cvt_pk_bf16_f32 v9, v10, v11
 v_lshlrev_b32 v10, 16, v9
 v_and_b32 v11, 0xffff0000, v9
 v_add_f32 v11, s68, v11
 v_cvt_pk_bf16_f32 v11, v11, v11
 v_and_b32 v11, 0xffff0000, v11
 v_sqrt_f32 v11, v11
 s_nop 0
 v_pk_add_f32 v[36:37], v[12:13], v[10:11] op_sel_hi:[1,0] neg_lo:[0,1] neg_hi:[0,1]
 v_pk_add_f32 v[38:39], v[14:15], v[10:11] op_sel_hi:[1,0] neg_lo:[0,1] neg_hi:[0,1]
 v_pk_add_f32 v[40:41], v[16:17], v[10:11] op_sel_hi:[1,0] neg_lo:[0,1] neg_hi:[0,1]
 v_pk_add_f32 v[42:43], v[18:19], v[10:11] op_sel_hi:[1,0] neg_lo:[0,1] neg_hi:[0,1]
 v_pk_add_f32 v[44:45], v[20:21], v[10:11] op_sel_hi:[1,0] neg_lo:[0,1] neg_hi:[0,1]
 v_pk_add_f32 v[46:47], v[22:23], v[10:11] op_sel_hi:[1,0] neg_lo:[0,1] neg_hi:[0,1]
 v_cvt_pk_bf16_f32 v11, v11, v11
 v_and_b32 v11, 0xffff0000, v11
 v_rcp_f32 v11, v11
 v_cvt_pk_bf16_f32 v9, v36, v37
 v_lshlrev_b32 v36, 16, v9
 v_and_b32 v37, 0xffff0000, v9
 v_cvt_pk_bf16_f32 v9, v38, v39
 v_lshlrev_b32 v38, 16, v9
 v_and_b32 v39, 0xffff0000, v9
 v_cvt_pk_bf16_f32 v9, v40, v41
 v_lshlrev_b32 v40, 16, v9
 v_and_b32 v41, 0xffff0000, v9
 v_cvt_pk_bf16_f32 v9, v42, v43
 v_lshlrev_b32 v42, 16, v9
 v_and_b32 v43, 0xffff0000, v9
 v_cvt_pk_bf16_f32 v9, v44, v45
 v_lshlrev_b32 v44, 16, v9
 v_and_b32 v45, 0xffff0000, v9
 v_cvt_pk_bf16_f32 v9, v46, v47
 v_lshlrev_b32 v46, 16, v9
 v_and_b32 v47, 0xffff0000, v9
 v_pk_mul_f32 v[36:37], v[36:37], v[10:11] op_sel:[0,1] op_sel_hi:[1,1]
 v_pk_mul_f32 v[38:39], v[38:39], v[10:11] op_sel:[0,1] op_sel_hi:[1,1]
 v_pk_mul_f32 v[40:41], v[40:41], v[10:11] op_sel:[0,1] op_sel_hi:[1,1]
 v_pk_mul_f32 v[42:43], v[42:43], v[10:11] op_sel:[0,1] op_sel_hi:[1,1]
 v_pk_mul_f32 v[44:45], v[44:45], v[10:11] op_sel:[0,1] op_sel_hi:[1,1]
 v_pk_mul_f32 v[46:47], v[46:47], v[10:11] op_sel:[0,1] op_sel_hi:[1,1]
 v_cvt_pk_bf16_f32 v24, v36, v37
 v_cvt_pk_bf16_f32 v25, v38, v39
 v_cvt_pk_bf16_f32 v26, v40, v41
 v_cvt_pk_bf16_f32 v27, v42, v43
 v_cvt_pk_bf16_f32 v28, v44, v45
 v_cvt_pk_bf16_f32 v29, v46, v47
 s_mul_i32 s3, s72, 1280
 s_add_u32 s3, s3, 226492416
 buffer_store_dwordx2 v[24:25], v4, s[4:7], s3 offen offset:0 sc1
 buffer_store_dwordx2 v[26:27], v4, s[4:7], s3 offen offset:512 sc1
 buffer_store_dwordx2 v[28:29], v8, s[4:7], s3 offen offset:1024 sc1
 s_add_u32 s72, s72, 64
 s_waitcnt vmcnt(3)
 s_cmp_lt_u32 s72, 1024
 s_cbranch_scc1 L_ln_18
 s_waitcnt vmcnt(0)
 s_barrier
 s_cmp_lg_u32 s50, 3
 s_cbranch_scc1 L_ar_19
 s_mov_b32 s96, s44
 s_and_b32 s97, s45, 0xffff
 s_mov_b32 s98, 256
 s_mov_b32 s99, 0x00020000
 v_mov_b32 v1, 1
 s_mov_b64 exec, 1
 buffer_atomic_add v1, off, s[96:99], 0 offset:72 sc0
 s_waitcnt vmcnt(0)
 v_cmp_eq_u32 vcc, 15, v1
 s_cbranch_vccz L_aw_20
 buffer_store_dword v1, off, s[96:99], 0 offset:200 sc1
L_aw_20:
 s_mov_b64 exec, -1
L_ar_19:
L_help_ln2:
 s_cmp_lg_u32 s50, 0
 s_cbranch_scc1 L_ww_21
 s_mov_b32 s96, s44
 s_and_b32 s97, s45, 0xffff
 s_mov_b32 s98, 256
 s_mov_b32 s99, 0x00020000
 v_mov_b32 v1, 212
 s_mov_b32 s51, 0
 s_mov_b64 exec, 1
L_wb_22:
 buffer_load_dword v2, v1, s[96:99], 0 offen sc1
 s_waitcnt vmcnt(0)
 v_cmp_eq_u32 vcc, 0, v2
 s_cbranch_vccz L_wbd_23
 s_sleep 2
 s_add_u32 s51, s51, 1
 s_cmp_lt_u32 s51, 131072
 s_cbranch_scc1 L_wb_22
 s_branch L_bail
L_wbd_23:
 s_mov_b64 exec, -1
L_ww_21:
 s_barrier
 s_branch L_help_done
L_np_11:
 s_sub_u32 s60, s60, 128
 s_cmp_eq_u32 s83, 1
 s_cbranch_scc1 L_k2_24
 s_add_u32 s3, s60, 288
 s_add_u32 s60, s60, 128
 s_cmp_eq_u32 s83, 0
 s_cselect_b32 s60, s3, s60
L_k2_24:
 s_mov_b32 s8, s32
 s_and_b32 s9, s33, 0xffff
 s_mov_b32 s10, 2621440
 s_mov_b32 s11, 0x00020000
 s_mov_b32 s12, s34
 s_and_b32 s13, s35, 0xffff
 s_mov_b32 s14, 2621440
 s_mov_b32 s15, 0x00020000
 s_mul_i32 s73, s60, 6554
 s_lshr_b32 s73, s73, 16
 s_mul_i32 s3, s73, 10
 s_sub_u32 s74, s60, s3
 s_mul_i32 s69, s73, 81920
 s_lshl_b32 s3, s74, 7
 s_add_u32 s69, s69, s3
 v_lshrrev_b32 v90, 3, v0
 s_mov_b32 s3, 10240
 v_mul_lo_u32 v91, v90, s3
 v_and_b32 v92, 7, v0
 v_lshl_add_u32 v91, v92, 4, v91
 v_add_u32 v91, s69, v91
 v_subrev_u32 v93, 3840, v91
 v_cmp_gt_i32 vcc, 0, v93
 s_nop 1
 v_cndmask_b32 v93, v93, v3, vcc
 buffer_load_dwordx4 v[100:103], v93, s[8:11], 0 offen offset:0
 buffer_load_dwordx4 v[104:107], v93, s[8:11], 0 offen offset:1280
 buffer_load_dwordx4 v[108:111], v93, s[8:11], 0 offen offset:2560
 s_mov_b32 s3, 0
 buffer_load_dwordx4 v[112:115], v91, s[8:11], s3 offen
 buffer_load_dwordx4 v[144:147], v91, s[12:15], s3 offen
 s_mov_b32 s3, 1280
 buffer_load_dwordx4 v[116:119], v91, s[8:11], s3 offen
 buffer_load_dwordx4 v[148:151], v91, s[12:15], s3 offen
 s_mov_b32 s3, 2560
 buffer_load_dwordx4 v[120:123], v91, s[8:11], s3 offen
 buffer_load_dwordx4 v[152:155], v91, s[12:15], s3 offen
 s_mov_b32 s3, 3840
 buffer_load_dwordx4 v[124:127], v91, s[8:11], s3 offen
 buffer_load_dwordx4 v[156:159], v91, s[12:15], s3 offen
 s_mov_b32 s3, 5120
 buffer_load_dwordx4 v[128:131], v91, s[8:11], s3 offen
 buffer_load_dwordx4 v[160:163], v91, s[12:15], s3 offen
 s_mov_b32 s3, 6400
 buffer_load_dwordx4 v[132:135], v91, s[8:11], s3 offen
 buffer_load_dwordx4 v[164:167], v91, s[12:15], s3 offen
 s_mov_b32 s3, 7680
 buffer_load_dwordx4 v[136:139], v91, s[8:11], s3 offen
 buffer_load_dwordx4 v[168:171], v91, s[12:15], s3 offen
 s_mov_b32 s3, 8960
 buffer_load_dwordx4 v[140:143], v91, s[8:11], s3 offen
 buffer_load_dwordx4 v[172:175], v91, s[12:15], s3 offen
 s_mov_b32 s8, s36
 s_and_b32 s9, s37, 0xffff
 s_mov_b32 s10, 5120
 s_mov_b32 s11, 0x00020000
 v_lshlrev_b32 v93, 6, v92
 s_lshl_b32 s3, s74, 9
 buffer_load_dwordx4 v[176:179], v93, s[8:11], s3 offen offset:0
 buffer_load_dwordx4 v[180:183], v93, s[8:11], s3 offen offset:16
 buffer_load_dwordx4 v[184:187], v93, s[8:11], s3 offen offset:32
 buffer_load_dwordx4 v[188:191], v93, s[8:11], s3 offen offset:48
 v_lshlrev_b32 v94, 15, v92
 v_lshl_add_u32 v94, v90, 4, v94
 s_lshl_b32 s70, s74, 18
 s_lshl_b32 s3, s73, 7
 s_add_u32 s70, s70, s3
 s_add_u32 s70, s70, 231735296
 s_waitcnt vmcnt(0)
 v_lshlrev_b32 v12, 16, v100
 v_and_b32 v13, 0xffff0000, v100
 v_lshlrev_b32 v14, 16, v104
 v_and_b32 v15, 0xffff0000, v104
 v_lshlrev_b32 v16, 16, v108
 v_and_b32 v17, 0xffff0000, v108
 v_lshlrev_b32 v18, 16, v112
 v_and_b32 v19, 0xffff0000, v112
 v_lshlrev_b32 v20, 16, v116
 v_and_b32 v21, 0xffff0000, v116
 v_lshlrev_b32 v22, 16, v120
 v_and_b32 v23, 0xffff0000, v120
 v_lshlrev_b32 v24, 16, v124
 v_and_b32 v25, 0xffff0000, v124
 v_lshlrev_b32 v26, 16, v128
 v_and_b32 v27, 0xffff0000, v128
 v_lshlrev_b32 v28, 16, v132
 v_and_b32 v29, 0xffff0000, v132
 v_lshlrev_b32 v30, 16, v136
 v_and_b32 v31, 0xffff0000, v136
 v_lshlrev_b32 v32, 16, v140
 v_and_b32 v33, 0xffff0000, v140
 v_lshlrev_b32 v68, 16, v176
 v_lshlrev_b32 v69, 16, v178
 v_and_b32 v70, 0xffff0000, v176
 v_and_b32 v71, 0xffff0000, v178
 v_lshlrev_b32 v72, 16, v177
 v_lshlrev_b32 v73, 16, v179
 v_and_b32 v74, 0xffff0000, v177
 v_and_b32 v75, 0xffff0000, v179
 v_pk_mul_f32 v[36:37], v[12:13], v[74:75]
 v_pk_mul_f32 v[38:39], v[14:15], v[74:75]
 v_pk_mul_f32 v[40:41], v[16:17], v[74:75]
 v_pk_mul_f32 v[42:43], v[18:19], v[74:75]
 v_pk_mul_f32 v[44:45], v[20:21], v[74:75]
 v_pk_mul_f32 v[46:47], v[22:23], v[74:75]
 v_pk_mul_f32 v[48:49], v[24:25], v[74:75]
 v_pk_mul_f32 v[50:51], v[26:27], v[74:75]
 v_cvt_pk_bf16_f32 v84, v36, v37
 v_lshlrev_b32 v36, 16, v84
 v_and_b32 v37, 0xffff0000, v84
 v_cvt_pk_bf16_f32 v84, v38, v39
 v_lshlrev_b32 v38, 16, v84
 v_and_b32 v39, 0xffff0000, v84
 v_cvt_pk_bf16_f32 v84, v40, v41
 v_lshlrev_b32 v40, 16, v84
 v_and_b32 v41, 0xffff0000, v84
 v_cvt_pk_bf16_f32 v84, v42, v43
 v_lshlrev_b32 v42, 16, v84
 v_and_b32 v43, 0xffff0000, v84
 v_cvt_pk_bf16_f32 v84, v44, v45
 v_lshlrev_b32 v44, 16, v84
 v_and_b32 v45, 0xffff0000, v84
 v_cvt_pk_bf16_f32 v84, v46, v47
 v_lshlrev_b32 v46, 16, v84
 v_and_b32 v47, 0xffff0000, v84
 v_cvt_pk_bf16_f32 v84, v48, v49
 v_lshlrev_b32 v48, 16, v84
 v_and_b32 v49, 0xffff0000, v84
 v_cvt_pk_bf16_f32 v84, v50, v51
 v_lshlrev_b32 v50, 16, v84
 v_and_b32 v51, 0xffff0000, v84
 v_pk_mul_f32 v[52:53], v[14:15], v[72:73]
 v_pk_mul_f32 v[54:55], v[16:17], v[72:73]
 v_pk_mul_f32 v[56:57], v[18:19], v[72:73]
 v_pk_mul_f32 v[58:59], v[20:21], v[72:73]
 v_pk_mul_f32 v[60:61], v[22:23], v[72:73]
 v_pk_mul_f32 v[62:63], v[24:25], v[72:73]
 v_pk_mul_f32 v[64:65], v[26:27], v[72:73]
 v_pk_mul_f32 v[66:67], v[28:29], v[72:73]
 v_cvt_pk_bf16_f32 v84, v52, v53
 v_lshlrev_b32 v52, 16, v84
 v_and_b32 v53, 0xffff0000, v84
 v_cvt_pk_bf16_f32 v84, v54, v55
 v_lshlrev_b32 v54, 16, v84
 v_and_b32 v55, 0xffff0000, v84
 v_cvt_pk_bf16_f32 v84, v56, v57
 v_lshlrev_b32 v56, 16, v84
 v_and_b32 v57, 0xffff0000, v84
 v_cvt_pk_bf16_f32 v84, v58, v59
 v_lshlrev_b32 v58, 16, v84
 v_and_b32 v59, 0xffff0000, v84
 v_cvt_pk_bf16_f32 v84, v60, v61
 v_lshlrev_b32 v60, 16, v84
 v_and_b32 v61, 0xffff0000, v84
 v_cvt_pk_bf16_f32 v84, v62, v63
 v_lshlrev_b32 v62, 16, v84
 v_and_b32 v63, 0xffff0000, v84
 v_cvt_pk_bf16_f32 v84, v64, v65
 v_lshlrev_b32 v64, 16, v84
 v_and_b32 v65, 0xffff0000, v84
 v_cvt_pk_bf16_f32 v84, v66, v67
 v_lshlrev_b32 v66, 16, v84
 v_and_b32 v67, 0xffff0000, v84
 v_pk_add_f32 v[36:37], v[36:37], v[52:53]
 v_pk_add_f32 v[38:39], v[38:39], v[54:55]
 v_pk_add_f32 v[40:41], v[40:41], v[56:57]
 v_pk_add_f32 v[42:43], v[42:43], v[58:59]
 v_pk_add_f32 v[44:45], v[44:45], v[60:61]
 v_pk_add_f32 v[46:47], v[46:47], v[62:63]
 v_pk_add_f32 v[48:49], v[48:49], v[64:65]
 v_pk_add_f32 v[50:51], v[50:51], v[66:67]
 v_cvt_pk_bf16_f32 v84, v36, v37
 v_lshlrev_b32 v36, 16, v84
 v_and_b32 v37, 0xffff0000, v84
 v_cvt_pk_bf16_f32 v84, v38, v39
 v_lshlrev_b32 v38, 16, v84
 v_and_b32 v39, 0xffff0000, v84
 v_cvt_pk_bf16_f32 v84, v40, v41
 v_lshlrev_b32 v40, 16, v84
 v_and_b32 v41, 0xffff0000, v84
 v_cvt_pk_bf16_f32 v84, v42, v43
 v_lshlrev_b32 v42, 16, v84
 v_and_b32 v43, 0xffff0000, v84
 v_cvt_pk_bf16_f32 v84, v44, v45
 v_lshlrev_b32 v44, 16, v84
 v_and_b32 v45, 0xffff0000, v84
 v_cvt_pk_bf16_f32 v84, v46, v47
 v_lshlrev_b32 v46, 16, v84
 v_and_b32 v47, 0xffff0000, v84
 v_cvt_pk_bf16_f32 v84, v48, v49
 v_lshlrev_b32 v48, 16, v84
 v_and_b32 v49, 0xffff0000, v84
 v_cvt_pk_bf16_f32 v84, v50, v51
 v_lshlrev_b32 v50, 16, v84
 v_and_b32 v51, 0xffff0000, v84
 v_pk_mul_f32 v[52:53], v[16:17], v[70:71]
 v_pk_mul_f32 v[54:55], v[18:19], v[70:71]
 v_pk_mul_f32 v[56:57], v[20:21], v[70:71]
 v_pk_mul_f32 v[58:59], v[22:23], v[70:71]
 v_pk_mul_f32 v[60:61], v[24:25], v[70:71]
 v_pk_mul_f32 v[62:63], v[26:27], v[70:71]
 v_pk_mul_f32 v[64:65], v[28:29], v[70:71]
 v_pk_mul_f32 v[66:67], v[30:31], v[70:71]
 v_cvt_pk_bf16_f32 v84, v52, v53
 v_lshlrev_b32 v52, 16, v84
 v_and_b32 v53, 0xffff0000, v84
 v_cvt_pk_bf16_f32 v84, v54, v55
 v_lshlrev_b32 v54, 16, v84
 v_and_b32 v55, 0xffff0000, v84
 v_cvt_pk_bf16_f32 v84, v56, v57
 v_lshlrev_b32 v56, 16, v84
 v_and_b32 v57, 0xffff0000, v84
 v_cvt_pk_bf16_f32 v84, v58, v59
 v_lshlrev_b32 v58, 16, v84
 v_and_b32 v59, 0xffff0000, v84
 v_cvt_pk_bf16_f32 v84, v60, v61
 v_lshlrev_b32 v60, 16, v84
 v_and_b32 v61, 0xffff0000, v84
 v_cvt_pk_bf16_f32 v84, v62, v63
 v_lshlrev_b32 v62, 16, v84
 v_and_b32 v63, 0xffff0000, v84
 v_cvt_pk_bf16_f32 v84, v64, v65
 v_lshlrev_b32 v64, 16, v84
 v_and_b32 v65, 0xffff0000, v84
 v_cvt_pk_bf16_f32 v84, v66, v67
 v_lshlrev_b32 v66, 16, v84
 v_and_b32 v67, 0xffff0000, v84
 v_pk_add_f32 v[36:37], v[36:37], v[52:53]
 v_pk_add_f32 v[38:39], v[38:39], v[54:55]
 v_pk_add_f32 v[40:41], v[40:41], v[56:57]
 v_pk_add_f32 v[42:43], v[42:43], v[58:59]
 v_pk_add_f32 v[44:45], v[44:45], v[60:61]
 v_pk_add_f32 v[46:47], v[46:47], v[62:63]
 v_pk_add_f32 v[48:49], v[48:49], v[64:65]
 v_pk_add_f32 v[50:51], v[50:51], v[66:67]
 v_cvt_pk_bf16_f32 v84, v36, v37
 v_lshlrev_b32 v36, 16, v84
 v_and_b32 v37, 0xffff0000, v84
 v_cvt_pk_bf16_f32 v84, v38, v39
 v_lshlrev_b32 v38, 16, v84
 v_and_b32 v39, 0xffff0000, v84
 v_cvt_pk_bf16_f32 v84, v40, v41
 v_lshlrev_b32 v40, 16, v84
 v_and_b32 v41, 0xffff0000, v84
 v_cvt_pk_bf16_f32 v84, v42, v43
 v_lshlrev_b32 v42, 16, v84
 v_and_b32 v43, 0xffff0000, v84
 v_cvt_pk_bf16_f32 v84, v44, v45
 v_lshlrev_b32 v44, 16, v84
 v_and_b32 v45, 0xffff0000, v84
 v_cvt_pk_bf16_f32 v84, v46, v47
 v_lshlrev_b32 v46, 16, v84
 v_and_b32 v47, 0xffff0000, v84
 v_cvt_pk_bf16_f32 v84, v48, v49
 v_lshlrev_b32 v48, 16, v84
 v_and_b32 v49, 0xffff0000, v84
 v_cvt_pk_bf16_f32 v84, v50, v51
 v_lshlrev_b32 v50, 16, v84
 v_and_b32 v51, 0xffff0000, v84
 v_pk_mul_f32 v[52:53], v[18:19], v[68:69]
 v_pk_mul_f32 v[54:55], v[20:21], v[68:69]
 v_pk_mul_f32 v[56:57], v[22:23], v[68:69]
 v_pk_mul_f32 v[58:59], v[24:25], v[68:69]
 v_pk_mul_f32 v[60:61], v[26:27], v[68:69]
 v_pk_mul_f32 v[62:63], v[28:29], v[68:69]
 v_pk_mul_f32 v[64:65], v[30:31], v[68:69]
 v_pk_mul_f32 v[66:67], v[32:33], v[68:69]
 v_cvt_pk_bf16_f32 v84, v52, v53
 v_lshlrev_b32 v52, 16, v84
 v_and_b32 v53, 0xffff0000, v84
 v_cvt_pk_bf16_f32 v84, v54, v55
 v_lshlrev_b32 v54, 16, v84
 v_and_b32 v55, 0xffff0000, v84
 v_cvt_pk_bf16_f32 v84, v56, v57
 v_lshlrev_b32 v56, 16, v84
 v_and_b32 v57, 0xffff0000, v84
 v_cvt_pk_bf16_f32 v84, v58, v59
 v_lshlrev_b32 v58, 16, v84
 v_and_b32 v59, 0xffff0000, v84
 v_cvt_pk_bf16_f32 v84, v60, v61
 v_lshlrev_b32 v60, 16, v84
 v_and_b32 v61, 0xffff0000, v84
 v_cvt_pk_bf16_f32 v84, v62, v63
 v_lshlrev_b32 v62, 16, v84
 v_and_b32 v63, 0xffff0000, v84
 v_cvt_pk_bf16_f32 v84, v64, v65
 v_lshlrev_b32 v64, 16, v84
 v_and_b32 v65, 0xffff0000, v84
 v_cvt_pk_bf16_f32 v84, v66, v67
 v_lshlrev_b32 v66, 16, v84
 v_and_b32 v67, 0xffff0000, v84
 v_pk_add_f32 v[36:37], v[36:37], v[52:53]
 v_pk_add_f32 v[38:39], v[38:39], v[54:55]
 v_pk_add_f32 v[40:41], v[40:41], v[56:57]
 v_pk_add_f32 v[42:43], v[42:43], v[58:59]
 v_pk_add_f32 v[44:45], v[44:45], v[60:61]
 v_pk_add_f32 v[46:47], v[46:47], v[62:63]
 v_pk_add_f32 v[48:49], v[48:49], v[64:65]
 v_pk_add_f32 v[50:51], v[50:51], v[66:67]
 v_cvt_pk_bf16_f32 v84, v36, v37
 v_lshlrev_b32 v36, 16, v84
 v_and_b32 v37, 0xffff0000, v84
 v_cvt_pk_bf16_f32 v84, v38, v39
 v_lshlrev_b32 v38, 16, v84
 v_and_b32 v39, 0xffff0000, v84
 v_cvt_pk_bf16_f32 v84, v40, v41
 v_lshlrev_b32 v40, 16, v84
 v_and_b32 v41, 0xffff0000, v84
 v_cvt_pk_bf16_f32 v84, v42, v43
 v_lshlrev_b32 v42, 16, v84
 v_and_b32 v43, 0xffff0000, v84
 v_cvt_pk_bf16_f32 v84, v44, v45
 v_lshlrev_b32 v44, 16, v84
 v_and_b32 v45, 0xffff0000, v84
 v_cvt_pk_bf16_f32 v84, v46, v47
 v_lshlrev_b32 v46, 16, v84
 v_and_b32 v47, 0xffff0000, v84
 v_cvt_pk_bf16_f32 v84, v48, v49
 v_lshlrev_b32 v48, 16, v84
 v_and_b32 v49, 0xffff0000, v84
 v_cvt_pk_bf16_f32 v84, v50, v51
 v_lshlrev_b32 v50, 16, v84
 v_and_b32 v51, 0xffff0000, v84
 v_lshlrev_b32 v12, 16, v144
 v_and_b32 v13, 0xffff0000, v144
 v_lshlrev_b32 v14, 16, v148
 v_and_b32 v15, 0xffff0000, v148
 v_lshlrev_b32 v16, 16, v152
 v_and_b32 v17, 0xffff0000, v152
 v_lshlrev_b32 v18, 16, v156
 v_and_b32 v19, 0xffff0000, v156
 v_lshlrev_b32 v20, 16, v160
 v_and_b32 v21, 0xffff0000, v160
 v_lshlrev_b32 v22, 16, v164
 v_and_b32 v23, 0xffff0000, v164
 v_lshlrev_b32 v24, 16, v168
 v_and_b32 v25, 0xffff0000, v168
 v_lshlrev_b32 v26, 16, v172
 v_and_b32 v27, 0xffff0000, v172
 v_pk_mul_f32 v[36:37], v[36:37], v[12:13]
 v_pk_mul_f32 v[38:39], v[38:39], v[14:15]
 v_pk_mul_f32 v[40:41], v[40:41], v[16:17]
 v_pk_mul_f32 v[42:43], v[42:43], v[18:19]
 v_pk_mul_f32 v[44:45], v[44:45], v[20:21]
 v_pk_mul_f32 v[46:47], v[46:47], v[22:23]
 v_pk_mul_f32 v[48:49], v[48:49], v[24:25]
 v_pk_mul_f32 v[50:51], v[50:51], v[26:27]
 v_cvt_pk_bf16_f32 v76, v50, v48
 v_cvt_pk_bf16_f32 v77, v46, v44
 v_cvt_pk_bf16_f32 v78, v42, v40
 v_cvt_pk_bf16_f32 v79, v38, v36
 s_add_u32 s3, s70, 0
 buffer_store_dwordx4 v[76:79], v94, s[4:7], s3 offen sc1
 v_cvt_pk_bf16_f32 v80, v51, v49
 v_cvt_pk_bf16_f32 v81, v47, v45
 v_cvt_pk_bf16_f32 v82, v43, v41
 v_cvt_pk_bf16_f32 v83, v39, v37
 s_add_u32 s3, s70, 4096
 buffer_store_dwordx4 v[80:83], v94, s[4:7], s3 offen sc1
 v_lshlrev_b32 v12, 16, v101
 v_and_b32 v13, 0xffff0000, v101
 v_lshlrev_b32 v14, 16, v105
 v_and_b32 v15, 0xffff0000, v105
 v_lshlrev_b32 v16, 16, v109
 v_and_b32 v17, 0xffff0000, v109
 v_lshlrev_b32 v18, 16, v113
 v_and_b32 v19, 0xffff0000, v113
 v_lshlrev_b32 v20, 16, v117
 v_and_b32 v21, 0xffff0000, v117
 v_lshlrev_b32 v22, 16, v121
 v_and_b32 v23, 0xffff0000, v121
 v_lshlrev_b32 v24, 16, v125
 v_and_b32 v25, 0xffff0000, v125
 v_lshlrev_b32 v26, 16, v129
 v_and_b32 v27, 0xffff0000, v129
 v_lshlrev_b32 v28, 16, v133
 v_and_b32 v29, 0xffff0000, v133
 v_lshlrev_b32 v30, 16, v137
 v_and_b32 v31, 0xffff0000, v137
 v_lshlrev_b32 v32, 16, v141
 v_and_b32 v33, 0xffff0000, v141
 v_lshlrev_b32 v68, 16, v180
 v_lshlrev_b32 v69, 16, v182
 v_and_b32 v70, 0xffff0000, v180
 v_and_b32 v71, 0xffff0000, v182
 v_lshlrev_b32 v72, 16, v181
 v_lshlrev_b32 v73, 16, v183
 v_and_b32 v74, 0xffff0000, v181
 v_and_b32 v75, 0xffff0000, v183
 v_pk_mul_f32 v[36:37], v[12:13], v[74:75]
 v_pk_mul_f32 v[38:39], v[14:15], v[74:75]
 v_pk_mul_f32 v[40:41], v[16:17], v[74:75]
 v_pk_mul_f32 v[42:43], v[18:19], v[74:75]
 v_pk_mul_f32 v[44:45], v[20:21], v[74:75]
 v_pk_mul_f32 v[46:47], v[22:23], v[74:75]
 v_pk_mul_f32 v[48:49], v[24:25], v[74:75]
 v_pk_mul_f32 v[50:51], v[26:27], v[74:75]
 v_cvt_pk_bf16_f32 v84, v36, v37
 v_lshlrev_b32 v36, 16, v84
 v_and_b32 v37, 0xffff0000, v84
 v_cvt_pk_bf16_f32 v84, v38, v39
 v_lshlrev_b32 v38, 16, v84
 v_and_b32 v39, 0xffff0000, v84
 v_cvt_pk_bf16_f32 v84, v40, v41
 v_lshlrev_b32 v40, 16, v84
 v_and_b32 v41, 0xffff0000, v84
 v_cvt_pk_bf16_f32 v84, v42, v43
 v_lshlrev_b32 v42, 16, v84
 v_and_b32 v43, 0xffff0000, v84
 v_cvt_pk_bf16_f32 v84, v44, v45
 v_lshlrev_b32 v44, 16, v84
 v_and_b32 v45, 0xffff0000, v84
 v_cvt_pk_bf16_f32 v84, v46, v47
 v_lshlrev_b32 v46, 16, v84
 v_and_b32 v47, 0xffff0000, v84
 v_cvt_pk_bf16_f32 v84, v48, v49
 v_lshlrev_b32 v48, 16, v84
 v_and_b32 v49, 0xffff0000, v84
 v_cvt_pk_bf16_f32 v84, v50, v51
 v_lshlrev_b32 v50, 16, v84
 v_and_b32 v51, 0xffff0000, v84
 v_pk_mul_f32 v[52:53], v[14:15], v[72:73]
 v_pk_mul_f32 v[54:55], v[16:17], v[72:73]
 v_pk_mul_f32 v[56:57], v[18:19], v[72:73]
 v_pk_mul_f32 v[58:59], v[20:21], v[72:73]
 v_pk_mul_f32 v[60:61], v[22:23], v[72:73]
 v_pk_mul_f32 v[62:63], v[24:25], v[72:73]
 v_pk_mul_f32 v[64:65], v[26:27], v[72:73]
 v_pk_mul_f32 v[66:67], v[28:29], v[72:73]
 v_cvt_pk_bf16_f32 v84, v52, v53
 v_lshlrev_b32 v52, 16, v84
 v_and_b32 v53, 0xffff0000, v84
 v_cvt_pk_bf16_f32 v84, v54, v55
 v_lshlrev_b32 v54, 16, v84
 v_and_b32 v55, 0xffff0000, v84
 v_cvt_pk_bf16_f32 v84, v56, v57
 v_lshlrev_b32 v56, 16, v84
 v_and_b32 v57, 0xffff0000, v84
 v_cvt_pk_bf16_f32 v84, v58, v59
 v_lshlrev_b32 v58, 16, v84
 v_and_b32 v59, 0xffff0000, v84
 v_cvt_pk_bf16_f32 v84, v60, v61
 v_lshlrev_b32 v60, 16, v84
 v_and_b32 v61, 0xffff0000, v84
 v_cvt_pk_bf16_f32 v84, v62, v63
 v_lshlrev_b32 v62, 16, v84
 v_and_b32 v63, 0xffff0000, v84
 v_cvt_pk_bf16_f32 v84, v64, v65
 v_lshlrev_b32 v64, 16, v84
 v_and_b32 v65, 0xffff0000, v84
 v_cvt_pk_bf16_f32 v84, v66, v67
 v_lshlrev_b32 v66, 16, v84
 v_and_b32 v67, 0xffff0000, v84
 v_pk_add_f32 v[36:37], v[36:37], v[52:53]
 v_pk_add_f32 v[38:39], v[38:39], v[54:55]
 v_pk_add_f32 v[40:41], v[40:41], v[56:57]
 v_pk_add_f32 v[42:43], v[42:43], v[58:59]
 v_pk_add_f32 v[44:45], v[44:45], v[60:61]
 v_pk_add_f32 v[46:47], v[46:47], v[62:63]
 v_pk_add_f32 v[48:49], v[48:49], v[64:65]
 v_pk_add_f32 v[50:51], v[50:51], v[66:67]
 v_cvt_pk_bf16_f32 v84, v36, v37
 v_lshlrev_b32 v36, 16, v84
 v_and_b32 v37, 0xffff0000, v84
 v_cvt_pk_bf16_f32 v84, v38, v39
 v_lshlrev_b32 v38, 16, v84
 v_and_b32 v39, 0xffff0000, v84
 v_cvt_pk_bf16_f32 v84, v40, v41
 v_lshlrev_b32 v40, 16, v84
 v_and_b32 v41, 0xffff0000, v84
 v_cvt_pk_bf16_f32 v84, v42, v43
 v_lshlrev_b32 v42, 16, v84
 v_and_b32 v43, 0xffff0000, v84
 v_cvt_pk_bf16_f32 v84, v44, v45
 v_lshlrev_b32 v44, 16, v84
 v_and_b32 v45, 0xffff0000, v84
 v_cvt_pk_bf16_f32 v84, v46, v47
 v_lshlrev_b32 v46, 16, v84
 v_and_b32 v47, 0xffff0000, v84
 v_cvt_pk_bf16_f32 v84, v48, v49
 v_lshlrev_b32 v48, 16, v84
 v_and_b32 v49, 0xffff0000, v84
 v_cvt_pk_bf16_f32 v84, v50, v51
 v_lshlrev_b32 v50, 16, v84
 v_and_b32 v51, 0xffff0000, v84
 v_pk_mul_f32 v[52:53], v[16:17], v[70:71]
 v_pk_mul_f32 v[54:55], v[18:19], v[70:71]
 v_pk_mul_f32 v[56:57], v[20:21], v[70:71]
 v_pk_mul_f32 v[58:59], v[22:23], v[70:71]
 v_pk_mul_f32 v[60:61], v[24:25], v[70:71]
 v_pk_mul_f32 v[62:63], v[26:27], v[70:71]
 v_pk_mul_f32 v[64:65], v[28:29], v[70:71]
 v_pk_mul_f32 v[66:67], v[30:31], v[70:71]
 v_cvt_pk_bf16_f32 v84, v52, v53
 v_lshlrev_b32 v52, 16, v84
 v_and_b32 v53, 0xffff0000, v84
 v_cvt_pk_bf16_f32 v84, v54, v55
 v_lshlrev_b32 v54, 16, v84
 v_and_b32 v55, 0xffff0000, v84
 v_cvt_pk_bf16_f32 v84, v56, v57
 v_lshlrev_b32 v56, 16, v84
 v_and_b32 v57, 0xffff0000, v84
 v_cvt_pk_bf16_f32 v84, v58, v59
 v_lshlrev_b32 v58, 16, v84
 v_and_b32 v59, 0xffff0000, v84
 v_cvt_pk_bf16_f32 v84, v60, v61
 v_lshlrev_b32 v60, 16, v84
 v_and_b32 v61, 0xffff0000, v84
 v_cvt_pk_bf16_f32 v84, v62, v63
 v_lshlrev_b32 v62, 16, v84
 v_and_b32 v63, 0xffff0000, v84
 v_cvt_pk_bf16_f32 v84, v64, v65
 v_lshlrev_b32 v64, 16, v84
 v_and_b32 v65, 0xffff0000, v84
 v_cvt_pk_bf16_f32 v84, v66, v67
 v_lshlrev_b32 v66, 16, v84
 v_and_b32 v67, 0xffff0000, v84
 v_pk_add_f32 v[36:37], v[36:37], v[52:53]
 v_pk_add_f32 v[38:39], v[38:39], v[54:55]
 v_pk_add_f32 v[40:41], v[40:41], v[56:57]
 v_pk_add_f32 v[42:43], v[42:43], v[58:59]
 v_pk_add_f32 v[44:45], v[44:45], v[60:61]
 v_pk_add_f32 v[46:47], v[46:47], v[62:63]
 v_pk_add_f32 v[48:49], v[48:49], v[64:65]
 v_pk_add_f32 v[50:51], v[50:51], v[66:67]
 v_cvt_pk_bf16_f32 v84, v36, v37
 v_lshlrev_b32 v36, 16, v84
 v_and_b32 v37, 0xffff0000, v84
 v_cvt_pk_bf16_f32 v84, v38, v39
 v_lshlrev_b32 v38, 16, v84
 v_and_b32 v39, 0xffff0000, v84
 v_cvt_pk_bf16_f32 v84, v40, v41
 v_lshlrev_b32 v40, 16, v84
 v_and_b32 v41, 0xffff0000, v84
 v_cvt_pk_bf16_f32 v84, v42, v43
 v_lshlrev_b32 v42, 16, v84
 v_and_b32 v43, 0xffff0000, v84
 v_cvt_pk_bf16_f32 v84, v44, v45
 v_lshlrev_b32 v44, 16, v84
 v_and_b32 v45, 0xffff0000, v84
 v_cvt_pk_bf16_f32 v84, v46, v47
 v_lshlrev_b32 v46, 16, v84
 v_and_b32 v47, 0xffff0000, v84
 v_cvt_pk_bf16_f32 v84, v48, v49
 v_lshlrev_b32 v48, 16, v84
 v_and_b32 v49, 0xffff0000, v84
 v_cvt_pk_bf16_f32 v84, v50, v51
 v_lshlrev_b32 v50, 16, v84
 v_and_b32 v51, 0xffff0000, v84
 v_pk_mul_f32 v[52:53], v[18:19], v[68:69]
 v_pk_mul_f32 v[54:55], v[20:21], v[68:69]
 v_pk_mul_f32 v[56:57], v[22:23], v[68:69]
 v_pk_mul_f32 v[58:59], v[24:25], v[68:69]
 v_pk_mul_f32 v[60:61], v[26:27], v[68:69]
 v_pk_mul_f32 v[62:63], v[28:29], v[68:69]
 v_pk_mul_f32 v[64:65], v[30:31], v[68:69]
 v_pk_mul_f32 v[66:67], v[32:33], v[68:69]
 v_cvt_pk_bf16_f32 v84, v52, v53
 v_lshlrev_b32 v52, 16, v84
 v_and_b32 v53, 0xffff0000, v84
 v_cvt_pk_bf16_f32 v84, v54, v55
 v_lshlrev_b32 v54, 16, v84
 v_and_b32 v55, 0xffff0000, v84
 v_cvt_pk_bf16_f32 v84, v56, v57
 v_lshlrev_b32 v56, 16, v84
 v_and_b32 v57, 0xffff0000, v84
 v_cvt_pk_bf16_f32 v84, v58, v59
 v_lshlrev_b32 v58, 16, v84
 v_and_b32 v59, 0xffff0000, v84
 v_cvt_pk_bf16_f32 v84, v60, v61
 v_lshlrev_b32 v60, 16, v84
 v_and_b32 v61, 0xffff0000, v84
 v_cvt_pk_bf16_f32 v84, v62, v63
 v_lshlrev_b32 v62, 16, v84
 v_and_b32 v63, 0xffff0000, v84
 v_cvt_pk_bf16_f32 v84, v64, v65
 v_lshlrev_b32 v64, 16, v84
 v_and_b32 v65, 0xffff0000, v84
 v_cvt_pk_bf16_f32 v84, v66, v67
 v_lshlrev_b32 v66, 16, v84
 v_and_b32 v67, 0xffff0000, v84
 v_pk_add_f32 v[36:37], v[36:37], v[52:53]
 v_pk_add_f32 v[38:39], v[38:39], v[54:55]
 v_pk_add_f32 v[40:41], v[40:41], v[56:57]
 v_pk_add_f32 v[42:43], v[42:43], v[58:59]
 v_pk_add_f32 v[44:45], v[44:45], v[60:61]
 v_pk_add_f32 v[46:47], v[46:47], v[62:63]
 v_pk_add_f32 v[48:49], v[48:49], v[64:65]
 v_pk_add_f32 v[50:51], v[50:51], v[66:67]
 v_cvt_pk_bf16_f32 v84, v36, v37
 v_lshlrev_b32 v36, 16, v84
 v_and_b32 v37, 0xffff0000, v84
 v_cvt_pk_bf16_f32 v84, v38, v39
 v_lshlrev_b32 v38, 16, v84
 v_and_b32 v39, 0xffff0000, v84
 v_cvt_pk_bf16_f32 v84, v40, v41
 v_lshlrev_b32 v40, 16, v84
 v_and_b32 v41, 0xffff0000, v84
 v_cvt_pk_bf16_f32 v84, v42, v43
 v_lshlrev_b32 v42, 16, v84
 v_and_b32 v43, 0xffff0000, v84
 v_cvt_pk_bf16_f32 v84, v44, v45
 v_lshlrev_b32 v44, 16, v84
 v_and_b32 v45, 0xffff0000, v84
 v_cvt_pk_bf16_f32 v84, v46, v47
 v_lshlrev_b32 v46, 16, v84
 v_and_b32 v47, 0xffff0000, v84
 v_cvt_pk_bf16_f32 v84, v48, v49
 v_lshlrev_b32 v48, 16, v84
 v_and_b32 v49, 0xffff0000, v84
 v_cvt_pk_bf16_f32 v84, v50, v51
 v_lshlrev_b32 v50, 16, v84
 v_and_b32 v51, 0xffff0000, v84
 v_lshlrev_b32 v12, 16, v145
 v_and_b32 v13, 0xffff0000, v145
 v_lshlrev_b32 v14, 16, v149
 v_and_b32 v15, 0xffff0000, v149
 v_lshlrev_b32 v16, 16, v153
 v_and_b32 v17, 0xffff0000, v153
 v_lshlrev_b32 v18, 16, v157
 v_and_b32 v19, 0xffff0000, v157
 v_lshlrev_b32 v20, 16, v161
 v_and_b32 v21, 0xffff0000, v161
 v_lshlrev_b32 v22, 16, v165
 v_and_b32 v23, 0xffff0000, v165
 v_lshlrev_b32 v24, 16, v169
 v_and_b32 v25, 0xffff0000, v169
 v_lshlrev_b32 v26, 16, v173
 v_and_b32 v27, 0xffff0000, v173
 v_pk_mul_f32 v[36:37], v[36:37], v[12:13]
 v_pk_mul_f32 v[38:39], v[38:39], v[14:15]
 v_pk_mul_f32 v[40:41], v[40:41], v[16:17]
 v_pk_mul_f32 v[42:43], v[42:43], v[18:19]
 v_pk_mul_f32 v[44:45], v[44:45], v[20:21]
 v_pk_mul_f32 v[46:47], v[46:47], v[22:23]
 v_pk_mul_f32 v[48:49], v[48:49], v[24:25]
 v_pk_mul_f32 v[50:51], v[50:51], v[26:27]
 v_cvt_pk_bf16_f32 v76, v50, v48
 v_cvt_pk_bf16_f32 v77, v46, v44
 v_cvt_pk_bf16_f32 v78, v42, v40
 v_cvt_pk_bf16_f32 v79, v38, v36
 s_add_u32 s3, s70, 8192
 buffer_store_dwordx4 v[76:79], v94, s[4:7], s3 offen sc1
 v_cvt_pk_bf16_f32 v80, v51, v49
 v_cvt_pk_bf16_f32 v81, v47, v45
 v_cvt_pk_bf16_f32 v82, v43, v41
 v_cvt_pk_bf16_f32 v83, v39, v37
 s_add_u32 s3, s70, 12288
 buffer_store_dwordx4 v[80:83], v94, s[4:7], s3 offen sc1
 v_lshlrev_b32 v12, 16, v102
 v_and_b32 v13, 0xffff0000, v102
 v_lshlrev_b32 v14, 16, v106
 v_and_b32 v15, 0xffff0000, v106
 v_lshlrev_b32 v16, 16, v110
 v_and_b32 v17, 0xffff0000, v110
 v_lshlrev_b32 v18, 16, v114
 v_and_b32 v19, 0xffff0000, v114
 v_lshlrev_b32 v20, 16, v118
 v_and_b32 v21, 0xffff0000, v118
 v_lshlrev_b32 v22, 16, v122
 v_and_b32 v23, 0xffff0000, v122
 v_lshlrev_b32 v24, 16, v126
 v_and_b32 v25, 0xffff0000, v126
 v_lshlrev_b32 v26, 16, v130
 v_and_b32 v27, 0xffff0000, v130
 v_lshlrev_b32 v28, 16, v134
 v_and_b32 v29, 0xffff0000, v134
 v_lshlrev_b32 v30, 16, v138
 v_and_b32 v31, 0xffff0000, v138
 v_lshlrev_b32 v32, 16, v142
 v_and_b32 v33, 0xffff0000, v142
 v_lshlrev_b32 v68, 16, v184
 v_lshlrev_b32 v69, 16, v186
 v_and_b32 v70, 0xffff0000, v184
 v_and_b32 v71, 0xffff0000, v186
 v_lshlrev_b32 v72, 16, v185
 v_lshlrev_b32 v73, 16, v187
 v_and_b32 v74, 0xffff0000, v185
 v_and_b32 v75, 0xffff0000, v187
 v_pk_mul_f32 v[36:37], v[12:13], v[74:75]
 v_pk_mul_f32 v[38:39], v[14:15], v[74:75]
 v_pk_mul_f32 v[40:41], v[16:17], v[74:75]
 v_pk_mul_f32 v[42:43], v[18:19], v[74:75]
 v_pk_mul_f32 v[44:45], v[20:21], v[74:75]
 v_pk_mul_f32 v[46:47], v[22:23], v[74:75]
 v_pk_mul_f32 v[48:49], v[24:25], v[74:75]
 v_pk_mul_f32 v[50:51], v[26:27], v[74:75]
 v_cvt_pk_bf16_f32 v84, v36, v37
 v_lshlrev_b32 v36, 16, v84
 v_and_b32 v37, 0xffff0000, v84
 v_cvt_pk_bf16_f32 v84, v38, v39
 v_lshlrev_b32 v38, 16, v84
 v_and_b32 v39, 0xffff0000, v84
 v_cvt_pk_bf16_f32 v84, v40, v41
 v_lshlrev_b32 v40, 16, v84
 v_and_b32 v41, 0xffff0000, v84
 v_cvt_pk_bf16_f32 v84, v42, v43
 v_lshlrev_b32 v42, 16, v84
 v_and_b32 v43, 0xffff0000, v84
 v_cvt_pk_bf16_f32 v84, v44, v45
 v_lshlrev_b32 v44, 16, v84
 v_and_b32 v45, 0xffff0000, v84
 v_cvt_pk_bf16_f32 v84, v46, v47
 v_lshlrev_b32 v46, 16, v84
 v_and_b32 v47, 0xffff0000, v84
 v_cvt_pk_bf16_f32 v84, v48, v49
 v_lshlrev_b32 v48, 16, v84
 v_and_b32 v49, 0xffff0000, v84
 v_cvt_pk_bf16_f32 v84, v50, v51
 v_lshlrev_b32 v50, 16, v84
 v_and_b32 v51, 0xffff0000, v84
 v_pk_mul_f32 v[52:53], v[14:15], v[72:73]
 v_pk_mul_f32 v[54:55], v[16:17], v[72:73]
 v_pk_mul_f32 v[56:57], v[18:19], v[72:73]
 v_pk_mul_f32 v[58:59], v[20:21], v[72:73]
 v_pk_mul_f32 v[60:61], v[22:23], v[72:73]
 v_pk_mul_f32 v[62:63], v[24:25], v[72:73]
 v_pk_mul_f32 v[64:65], v[26:27], v[72:73]
 v_pk_mul_f32 v[66:67], v[28:29], v[72:73]
 v_cvt_pk_bf16_f32 v84, v52, v53
 v_lshlrev_b32 v52, 16, v84
 v_and_b32 v53, 0xffff0000, v84
 v_cvt_pk_bf16_f32 v84, v54, v55
 v_lshlrev_b32 v54, 16, v84
 v_and_b32 v55, 0xffff0000, v84
 v_cvt_pk_bf16_f32 v84, v56, v57
 v_lshlrev_b32 v56, 16, v84
 v_and_b32 v57, 0xffff0000, v84
 v_cvt_pk_bf16_f32 v84, v58, v59
 v_lshlrev_b32 v58, 16, v84
 v_and_b32 v59, 0xffff0000, v84
 v_cvt_pk_bf16_f32 v84, v60, v61
 v_lshlrev_b32 v60, 16, v84
 v_and_b32 v61, 0xffff0000, v84
 v_cvt_pk_bf16_f32 v84, v62, v63
 v_lshlrev_b32 v62, 16, v84
 v_and_b32 v63, 0xffff0000, v84
 v_cvt_pk_bf16_f32 v84, v64, v65
 v_lshlrev_b32 v64, 16, v84
 v_and_b32 v65, 0xffff0000, v84
 v_cvt_pk_bf16_f32 v84, v66, v67
 v_lshlrev_b32 v66, 16, v84
 v_and_b32 v67, 0xffff0000, v84
 v_pk_add_f32 v[36:37], v[36:37], v[52:53]
 v_pk_add_f32 v[38:39], v[38:39], v[54:55]
 v_pk_add_f32 v[40:41], v[40:41], v[56:57]
 v_pk_add_f32 v[42:43], v[42:43], v[58:59]
 v_pk_add_f32 v[44:45], v[44:45], v[60:61]
 v_pk_add_f32 v[46:47], v[46:47], v[62:63]
 v_pk_add_f32 v[48:49], v[48:49], v[64:65]
 v_pk_add_f32 v[50:51], v[50:51], v[66:67]
 v_cvt_pk_bf16_f32 v84, v36, v37
 v_lshlrev_b32 v36, 16, v84
 v_and_b32 v37, 0xffff0000, v84
 v_cvt_pk_bf16_f32 v84, v38, v39
 v_lshlrev_b32 v38, 16, v84
 v_and_b32 v39, 0xffff0000, v84
 v_cvt_pk_bf16_f32 v84, v40, v41
 v_lshlrev_b32 v40, 16, v84
 v_and_b32 v41, 0xffff0000, v84
 v_cvt_pk_bf16_f32 v84, v42, v43
 v_lshlrev_b32 v42, 16, v84
 v_and_b32 v43, 0xffff0000, v84
 v_cvt_pk_bf16_f32 v84, v44, v45
 v_lshlrev_b32 v44, 16, v84
 v_and_b32 v45, 0xffff0000, v84
 v_cvt_pk_bf16_f32 v84, v46, v47
 v_lshlrev_b32 v46, 16, v84
 v_and_b32 v47, 0xffff0000, v84
 v_cvt_pk_bf16_f32 v84, v48, v49
 v_lshlrev_b32 v48, 16, v84
 v_and_b32 v49, 0xffff0000, v84
 v_cvt_pk_bf16_f32 v84, v50, v51
 v_lshlrev_b32 v50, 16, v84
 v_and_b32 v51, 0xffff0000, v84
 v_pk_mul_f32 v[52:53], v[16:17], v[70:71]
 v_pk_mul_f32 v[54:55], v[18:19], v[70:71]
 v_pk_mul_f32 v[56:57], v[20:21], v[70:71]
 v_pk_mul_f32 v[58:59], v[22:23], v[70:71]
 v_pk_mul_f32 v[60:61], v[24:25], v[70:71]
 v_pk_mul_f32 v[62:63], v[26:27], v[70:71]
 v_pk_mul_f32 v[64:65], v[28:29], v[70:71]
 v_pk_mul_f32 v[66:67], v[30:31], v[70:71]
 v_cvt_pk_bf16_f32 v84, v52, v53
 v_lshlrev_b32 v52, 16, v84
 v_and_b32 v53, 0xffff0000, v84
 v_cvt_pk_bf16_f32 v84, v54, v55
 v_lshlrev_b32 v54, 16, v84
 v_and_b32 v55, 0xffff0000, v84
 v_cvt_pk_bf16_f32 v84, v56, v57
 v_lshlrev_b32 v56, 16, v84
 v_and_b32 v57, 0xffff0000, v84
 v_cvt_pk_bf16_f32 v84, v58, v59
 v_lshlrev_b32 v58, 16, v84
 v_and_b32 v59, 0xffff0000, v84
 v_cvt_pk_bf16_f32 v84, v60, v61
 v_lshlrev_b32 v60, 16, v84
 v_and_b32 v61, 0xffff0000, v84
 v_cvt_pk_bf16_f32 v84, v62, v63
 v_lshlrev_b32 v62, 16, v84
 v_and_b32 v63, 0xffff0000, v84
 v_cvt_pk_bf16_f32 v84, v64, v65
 v_lshlrev_b32 v64, 16, v84
 v_and_b32 v65, 0xffff0000, v84
 v_cvt_pk_bf16_f32 v84, v66, v67
 v_lshlrev_b32 v66, 16, v84
 v_and_b32 v67, 0xffff0000, v84
 v_pk_add_f32 v[36:37], v[36:37], v[52:53]
 v_pk_add_f32 v[38:39], v[38:39], v[54:55]
 v_pk_add_f32 v[40:41], v[40:41], v[56:57]
 v_pk_add_f32 v[42:43], v[42:43], v[58:59]
 v_pk_add_f32 v[44:45], v[44:45], v[60:61]
 v_pk_add_f32 v[46:47], v[46:47], v[62:63]
 v_pk_add_f32 v[48:49], v[48:49], v[64:65]
 v_pk_add_f32 v[50:51], v[50:51], v[66:67]
 v_cvt_pk_bf16_f32 v84, v36, v37
 v_lshlrev_b32 v36, 16, v84
 v_and_b32 v37, 0xffff0000, v84
 v_cvt_pk_bf16_f32 v84, v38, v39
 v_lshlrev_b32 v38, 16, v84
 v_and_b32 v39, 0xffff0000, v84
 v_cvt_pk_bf16_f32 v84, v40, v41
 v_lshlrev_b32 v40, 16, v84
 v_and_b32 v41, 0xffff0000, v84
 v_cvt_pk_bf16_f32 v84, v42, v43
 v_lshlrev_b32 v42, 16, v84
 v_and_b32 v43, 0xffff0000, v84
 v_cvt_pk_bf16_f32 v84, v44, v45
 v_lshlrev_b32 v44, 16, v84
 v_and_b32 v45, 0xffff0000, v84
 v_cvt_pk_bf16_f32 v84, v46, v47
 v_lshlrev_b32 v46, 16, v84
 v_and_b32 v47, 0xffff0000, v84
 v_cvt_pk_bf16_f32 v84, v48, v49
 v_lshlrev_b32 v48, 16, v84
 v_and_b32 v49, 0xffff0000, v84
 v_cvt_pk_bf16_f32 v84, v50, v51
 v_lshlrev_b32 v50, 16, v84
 v_and_b32 v51, 0xffff0000, v84
 v_pk_mul_f32 v[52:53], v[18:19], v[68:69]
 v_pk_mul_f32 v[54:55], v[20:21], v[68:69]
 v_pk_mul_f32 v[56:57], v[22:23], v[68:69]
 v_pk_mul_f32 v[58:59], v[24:25], v[68:69]
 v_pk_mul_f32 v[60:61], v[26:27], v[68:69]
 v_pk_mul_f32 v[62:63], v[28:29], v[68:69]
 v_pk_mul_f32 v[64:65], v[30:31], v[68:69]
 v_pk_mul_f32 v[66:67], v[32:33], v[68:69]
 v_cvt_pk_bf16_f32 v84, v52, v53
 v_lshlrev_b32 v52, 16, v84
 v_and_b32 v53, 0xffff0000, v84
 v_cvt_pk_bf16_f32 v84, v54, v55
 v_lshlrev_b32 v54, 16, v84
 v_and_b32 v55, 0xffff0000, v84
 v_cvt_pk_bf16_f32 v84, v56, v57
 v_lshlrev_b32 v56, 16, v84
 v_and_b32 v57, 0xffff0000, v84
 v_cvt_pk_bf16_f32 v84, v58, v59
 v_lshlrev_b32 v58, 16, v84
 v_and_b32 v59, 0xffff0000, v84
 v_cvt_pk_bf16_f32 v84, v60, v61
 v_lshlrev_b32 v60, 16, v84
 v_and_b32 v61, 0xffff0000, v84
 v_cvt_pk_bf16_f32 v84, v62, v63
 v_lshlrev_b32 v62, 16, v84
 v_and_b32 v63, 0xffff0000, v84
 v_cvt_pk_bf16_f32 v84, v64, v65
 v_lshlrev_b32 v64, 16, v84
 v_and_b32 v65, 0xffff0000, v84
 v_cvt_pk_bf16_f32 v84, v66, v67
 v_lshlrev_b32 v66, 16, v84
 v_and_b32 v67, 0xffff0000, v84
 v_pk_add_f32 v[36:37], v[36:37], v[52:53]
 v_pk_add_f32 v[38:39], v[38:39], v[54:55]
 v_pk_add_f32 v[40:41], v[40:41], v[56:57]
 v_pk_add_f32 v[42:43], v[42:43], v[58:59]
 v_pk_add_f32 v[44:45], v[44:45], v[60:61]
 v_pk_add_f32 v[46:47], v[46:47], v[62:63]
 v_pk_add_f32 v[48:49], v[48:49], v[64:65]
 v_pk_add_f32 v[50:51], v[50:51], v[66:67]
 v_cvt_pk_bf16_f32 v84, v36, v37
 v_lshlrev_b32 v36, 16, v84
 v_and_b32 v37, 0xffff0000, v84
 v_cvt_pk_bf16_f32 v84, v38, v39
 v_lshlrev_b32 v38, 16, v84
 v_and_b32 v39, 0xffff0000, v84
 v_cvt_pk_bf16_f32 v84, v40, v41
 v_lshlrev_b32 v40, 16, v84
 v_and_b32 v41, 0xffff0000, v84
 v_cvt_pk_bf16_f32 v84, v42, v43
 v_lshlrev_b32 v42, 16, v84
 v_and_b32 v43, 0xffff0000, v84
 v_cvt_pk_bf16_f32 v84, v44, v45
 v_lshlrev_b32 v44, 16, v84
 v_and_b32 v45, 0xffff0000, v84
 v_cvt_pk_bf16_f32 v84, v46, v47
 v_lshlrev_b32 v46, 16, v84
 v_and_b32 v47, 0xffff0000, v84
 v_cvt_pk_bf16_f32 v84, v48, v49
 v_lshlrev_b32 v48, 16, v84
 v_and_b32 v49, 0xffff0000, v84
 v_cvt_pk_bf16_f32 v84, v50, v51
 v_lshlrev_b32 v50, 16, v84
 v_and_b32 v51, 0xffff0000, v84
 v_lshlrev_b32 v12, 16, v146
 v_and_b32 v13, 0xffff0000, v146
 v_lshlrev_b32 v14, 16, v150
 v_and_b32 v15, 0xffff0000, v150
 v_lshlrev_b32 v16, 16, v154
 v_and_b32 v17, 0xffff0000, v154
 v_lshlrev_b32 v18, 16, v158
 v_and_b32 v19, 0xffff0000, v158
 v_lshlrev_b32 v20, 16, v162
 v_and_b32 v21, 0xffff0000, v162
 v_lshlrev_b32 v22, 16, v166
 v_and_b32 v23, 0xffff0000, v166
 v_lshlrev_b32 v24, 16, v170
 v_and_b32 v25, 0xffff0000, v170
 v_lshlrev_b32 v26, 16, v174
 v_and_b32 v27, 0xffff0000, v174
 v_pk_mul_f32 v[36:37], v[36:37], v[12:13]
 v_pk_mul_f32 v[38:39], v[38:39], v[14:15]
 v_pk_mul_f32 v[40:41], v[40:41], v[16:17]
 v_pk_mul_f32 v[42:43], v[42:43], v[18:19]
 v_pk_mul_f32 v[44:45], v[44:45], v[20:21]
 v_pk_mul_f32 v[46:47], v[46:47], v[22:23]
 v_pk_mul_f32 v[48:49], v[48:49], v[24:25]
 v_pk_mul_f32 v[50:51], v[50:51], v[26:27]
 v_cvt_pk_bf16_f32 v76, v50, v48
 v_cvt_pk_bf16_f32 v77, v46, v44
 v_cvt_pk_bf16_f32 v78, v42, v40
 v_cvt_pk_bf16_f32 v79, v38, v36
 s_add_u32 s3, s70, 16384
 buffer_store_dwordx4 v[76:79], v94, s[4:7], s3 offen sc1
 v_cvt_pk_bf16_f32 v80, v51, v49
 v_cvt_pk_bf16_f32 v81, v47, v45
 v_cvt_pk_bf16_f32 v82, v43, v41
 v_cvt_pk_bf16_f32 v83, v39, v37
 s_add_u32 s3, s70, 20480
 buffer_store_dwordx4 v[80:83], v94, s[4:7], s3 offen sc1
 v_lshlrev_b32 v12, 16, v103
 v_and_b32 v13, 0xffff0000, v103
 v_lshlrev_b32 v14, 16, v107
 v_and_b32 v15, 0xffff0000, v107
 v_lshlrev_b32 v16, 16, v111
 v_and_b32 v17, 0xffff0000, v111
 v_lshlrev_b32 v18, 16, v115
 v_and_b32 v19, 0xffff0000, v115
 v_lshlrev_b32 v20, 16, v119
 v_and_b32 v21, 0xffff0000, v119
 v_lshlrev_b32 v22, 16, v123
 v_and_b32 v23, 0xffff0000, v123
 v_lshlrev_b32 v24, 16, v127
 v_and_b32 v25, 0xffff0000, v127
 v_lshlrev_b32 v26, 16, v131
 v_and_b32 v27, 0xffff0000, v131
 v_lshlrev_b32 v28, 16, v135
 v_and_b32 v29, 0xffff0000, v135
 v_lshlrev_b32 v30, 16, v139
 v_and_b32 v31, 0xffff0000, v139
 v_lshlrev_b32 v32, 16, v143
 v_and_b32 v33, 0xffff0000, v143
 v_lshlrev_b32 v68, 16, v188
 v_lshlrev_b32 v69, 16, v190
 v_and_b32 v70, 0xffff0000, v188
 v_and_b32 v71, 0xffff0000, v190
 v_lshlrev_b32 v72, 16, v189
 v_lshlrev_b32 v73, 16, v191
 v_and_b32 v74, 0xffff0000, v189
 v_and_b32 v75, 0xffff0000, v191
 v_pk_mul_f32 v[36:37], v[12:13], v[74:75]
 v_pk_mul_f32 v[38:39], v[14:15], v[74:75]
 v_pk_mul_f32 v[40:41], v[16:17], v[74:75]
 v_pk_mul_f32 v[42:43], v[18:19], v[74:75]
 v_pk_mul_f32 v[44:45], v[20:21], v[74:75]
 v_pk_mul_f32 v[46:47], v[22:23], v[74:75]
 v_pk_mul_f32 v[48:49], v[24:25], v[74:75]
 v_pk_mul_f32 v[50:51], v[26:27], v[74:75]
 v_cvt_pk_bf16_f32 v84, v36, v37
 v_lshlrev_b32 v36, 16, v84
 v_and_b32 v37, 0xffff0000, v84
 v_cvt_pk_bf16_f32 v84, v38, v39
 v_lshlrev_b32 v38, 16, v84
 v_and_b32 v39, 0xffff0000, v84
 v_cvt_pk_bf16_f32 v84, v40, v41
 v_lshlrev_b32 v40, 16, v84
 v_and_b32 v41, 0xffff0000, v84
 v_cvt_pk_bf16_f32 v84, v42, v43
 v_lshlrev_b32 v42, 16, v84
 v_and_b32 v43, 0xffff0000, v84
 v_cvt_pk_bf16_f32 v84, v44, v45
 v_lshlrev_b32 v44, 16, v84
 v_and_b32 v45, 0xffff0000, v84
 v_cvt_pk_bf16_f32 v84, v46, v47
 v_lshlrev_b32 v46, 16, v84
 v_and_b32 v47, 0xffff0000, v84
 v_cvt_pk_bf16_f32 v84, v48, v49
 v_lshlrev_b32 v48, 16, v84
 v_and_b32 v49, 0xffff0000, v84
 v_cvt_pk_bf16_f32 v84, v50, v51
 v_lshlrev_b32 v50, 16, v84
 v_and_b32 v51, 0xffff0000, v84
 v_pk_mul_f32 v[52:53], v[14:15], v[72:73]
 v_pk_mul_f32 v[54:55], v[16:17], v[72:73]
 v_pk_mul_f32 v[56:57], v[18:19], v[72:73]
 v_pk_mul_f32 v[58:59], v[20:21], v[72:73]
 v_pk_mul_f32 v[60:61], v[22:23], v[72:73]
 v_pk_mul_f32 v[62:63], v[24:25], v[72:73]
 v_pk_mul_f32 v[64:65], v[26:27], v[72:73]
 v_pk_mul_f32 v[66:67], v[28:29], v[72:73]
 v_cvt_pk_bf16_f32 v84, v52, v53
 v_lshlrev_b32 v52, 16, v84
 v_and_b32 v53, 0xffff0000, v84
 v_cvt_pk_bf16_f32 v84, v54, v55
 v_lshlrev_b32 v54, 16, v84
 v_and_b32 v55, 0xffff0000, v84
 v_cvt_pk_bf16_f32 v84, v56, v57
 v_lshlrev_b32 v56, 16, v84
 v_and_b32 v57, 0xffff0000, v84
 v_cvt_pk_bf16_f32 v84, v58, v59
 v_lshlrev_b32 v58, 16, v84
 v_and_b32 v59, 0xffff0000, v84
 v_cvt_pk_bf16_f32 v84, v60, v61
 v_lshlrev_b32 v60, 16, v84
 v_and_b32 v61, 0xffff0000, v84
 v_cvt_pk_bf16_f32 v84, v62, v63
 v_lshlrev_b32 v62, 16, v84
 v_and_b32 v63, 0xffff0000, v84
 v_cvt_pk_bf16_f32 v84, v64, v65
 v_lshlrev_b32 v64, 16, v84
 v_and_b32 v65, 0xffff0000, v84
 v_cvt_pk_bf16_f32 v84, v66, v67
 v_lshlrev_b32 v66, 16, v84
 v_and_b32 v67, 0xffff0000, v84
 v_pk_add_f32 v[36:37], v[36:37], v[52:53]
 v_pk_add_f32 v[38:39], v[38:39], v[54:55]
 v_pk_add_f32 v[40:41], v[40:41], v[56:57]
 v_pk_add_f32 v[42:43], v[42:43], v[58:59]
 v_pk_add_f32 v[44:45], v[44:45], v[60:61]
 v_pk_add_f32 v[46:47], v[46:47], v[62:63]
 v_pk_add_f32 v[48:49], v[48:49], v[64:65]
 v_pk_add_f32 v[50:51], v[50:51], v[66:67]
 v_cvt_pk_bf16_f32 v84, v36, v37
 v_lshlrev_b32 v36, 16, v84
 v_and_b32 v37, 0xffff0000, v84
 v_cvt_pk_bf16_f32 v84, v38, v39
 v_lshlrev_b32 v38, 16, v84
 v_and_b32 v39, 0xffff0000, v84
 v_cvt_pk_bf16_f32 v84, v40, v41
 v_lshlrev_b32 v40, 16, v84
 v_and_b32 v41, 0xffff0000, v84
 v_cvt_pk_bf16_f32 v84, v42, v43
 v_lshlrev_b32 v42, 16, v84
 v_and_b32 v43, 0xffff0000, v84
 v_cvt_pk_bf16_f32 v84, v44, v45
 v_lshlrev_b32 v44, 16, v84
 v_and_b32 v45, 0xffff0000, v84
 v_cvt_pk_bf16_f32 v84, v46, v47
 v_lshlrev_b32 v46, 16, v84
 v_and_b32 v47, 0xffff0000, v84
 v_cvt_pk_bf16_f32 v84, v48, v49
 v_lshlrev_b32 v48, 16, v84
 v_and_b32 v49, 0xffff0000, v84
 v_cvt_pk_bf16_f32 v84, v50, v51
 v_lshlrev_b32 v50, 16, v84
 v_and_b32 v51, 0xffff0000, v84
 v_pk_mul_f32 v[52:53], v[16:17], v[70:71]
 v_pk_mul_f32 v[54:55], v[18:19], v[70:71]
 v_pk_mul_f32 v[56:57], v[20:21], v[70:71]
 v_pk_mul_f32 v[58:59], v[22:23], v[70:71]
 v_pk_mul_f32 v[60:61], v[24:25], v[70:71]
 v_pk_mul_f32 v[62:63], v[26:27], v[70:71]
 v_pk_mul_f32 v[64:65], v[28:29], v[70:71]
 v_pk_mul_f32 v[66:67], v[30:31], v[70:71]
 v_cvt_pk_bf16_f32 v84, v52, v53
 v_lshlrev_b32 v52, 16, v84
 v_and_b32 v53, 0xffff0000, v84
 v_cvt_pk_bf16_f32 v84, v54, v55
 v_lshlrev_b32 v54, 16, v84
 v_and_b32 v55, 0xffff0000, v84
 v_cvt_pk_bf16_f32 v84, v56, v57
 v_lshlrev_b32 v56, 16, v84
 v_and_b32 v57, 0xffff0000, v84
 v_cvt_pk_bf16_f32 v84, v58, v59
 v_lshlrev_b32 v58, 16, v84
 v_and_b32 v59, 0xffff0000, v84
 v_cvt_pk_bf16_f32 v84, v60, v61
 v_lshlrev_b32 v60, 16, v84
 v_and_b32 v61, 0xffff0000, v84
 v_cvt_pk_bf16_f32 v84, v62, v63
 v_lshlrev_b32 v62, 16, v84
 v_and_b32 v63, 0xffff0000, v84
 v_cvt_pk_bf16_f32 v84, v64, v65
 v_lshlrev_b32 v64, 16, v84
 v_and_b32 v65, 0xffff0000, v84
 v_cvt_pk_bf16_f32 v84, v66, v67
 v_lshlrev_b32 v66, 16, v84
 v_and_b32 v67, 0xffff0000, v84
 v_pk_add_f32 v[36:37], v[36:37], v[52:53]
 v_pk_add_f32 v[38:39], v[38:39], v[54:55]
 v_pk_add_f32 v[40:41], v[40:41], v[56:57]
 v_pk_add_f32 v[42:43], v[42:43], v[58:59]
 v_pk_add_f32 v[44:45], v[44:45], v[60:61]
 v_pk_add_f32 v[46:47], v[46:47], v[62:63]
 v_pk_add_f32 v[48:49], v[48:49], v[64:65]
 v_pk_add_f32 v[50:51], v[50:51], v[66:67]
 v_cvt_pk_bf16_f32 v84, v36, v37
 v_lshlrev_b32 v36, 16, v84
 v_and_b32 v37, 0xffff0000, v84
 v_cvt_pk_bf16_f32 v84, v38, v39
 v_lshlrev_b32 v38, 16, v84
 v_and_b32 v39, 0xffff0000, v84
 v_cvt_pk_bf16_f32 v84, v40, v41
 v_lshlrev_b32 v40, 16, v84
 v_and_b32 v41, 0xffff0000, v84
 v_cvt_pk_bf16_f32 v84, v42, v43
 v_lshlrev_b32 v42, 16, v84
 v_and_b32 v43, 0xffff0000, v84
 v_cvt_pk_bf16_f32 v84, v44, v45
 v_lshlrev_b32 v44, 16, v84
 v_and_b32 v45, 0xffff0000, v84
 v_cvt_pk_bf16_f32 v84, v46, v47
 v_lshlrev_b32 v46, 16, v84
 v_and_b32 v47, 0xffff0000, v84
 v_cvt_pk_bf16_f32 v84, v48, v49
 v_lshlrev_b32 v48, 16, v84
 v_and_b32 v49, 0xffff0000, v84
 v_cvt_pk_bf16_f32 v84, v50, v51
 v_lshlrev_b32 v50, 16, v84
 v_and_b32 v51, 0xffff0000, v84
 v_pk_mul_f32 v[52:53], v[18:19], v[68:69]
 v_pk_mul_f32 v[54:55], v[20:21], v[68:69]
 v_pk_mul_f32 v[56:57], v[22:23], v[68:69]
 v_pk_mul_f32 v[58:59], v[24:25], v[68:69]
 v_pk_mul_f32 v[60:61], v[26:27], v[68:69]
 v_pk_mul_f32 v[62:63], v[28:29], v[68:69]
 v_pk_mul_f32 v[64:65], v[30:31], v[68:69]
 v_pk_mul_f32 v[66:67], v[32:33], v[68:69]
 v_cvt_pk_bf16_f32 v84, v52, v53
 v_lshlrev_b32 v52, 16, v84
 v_and_b32 v53, 0xffff0000, v84
 v_cvt_pk_bf16_f32 v84, v54, v55
 v_lshlrev_b32 v54, 16, v84
 v_and_b32 v55, 0xffff0000, v84
 v_cvt_pk_bf16_f32 v84, v56, v57
 v_lshlrev_b32 v56, 16, v84
 v_and_b32 v57, 0xffff0000, v84
 v_cvt_pk_bf16_f32 v84, v58, v59
 v_lshlrev_b32 v58, 16, v84
 v_and_b32 v59, 0xffff0000, v84
 v_cvt_pk_bf16_f32 v84, v60, v61
 v_lshlrev_b32 v60, 16, v84
 v_and_b32 v61, 0xffff0000, v84
 v_cvt_pk_bf16_f32 v84, v62, v63
 v_lshlrev_b32 v62, 16, v84
 v_and_b32 v63, 0xffff0000, v84
 v_cvt_pk_bf16_f32 v84, v64, v65
 v_lshlrev_b32 v64, 16, v84
 v_and_b32 v65, 0xffff0000, v84
 v_cvt_pk_bf16_f32 v84, v66, v67
 v_lshlrev_b32 v66, 16, v84
 v_and_b32 v67, 0xffff0000, v84
 v_pk_add_f32 v[36:37], v[36:37], v[52:53]
 v_pk_add_f32 v[38:39], v[38:39], v[54:55]
 v_pk_add_f32 v[40:41], v[40:41], v[56:57]
 v_pk_add_f32 v[42:43], v[42:43], v[58:59]
 v_pk_add_f32 v[44:45], v[44:45], v[60:61]
 v_pk_add_f32 v[46:47], v[46:47], v[62:63]
 v_pk_add_f32 v[48:49], v[48:49], v[64:65]
 v_pk_add_f32 v[50:51], v[50:51], v[66:67]
 v_cvt_pk_bf16_f32 v84, v36, v37
 v_lshlrev_b32 v36, 16, v84
 v_and_b32 v37, 0xffff0000, v84
 v_cvt_pk_bf16_f32 v84, v38, v39
 v_lshlrev_b32 v38, 16, v84
 v_and_b32 v39, 0xffff0000, v84
 v_cvt_pk_bf16_f32 v84, v40, v41
 v_lshlrev_b32 v40, 16, v84
 v_and_b32 v41, 0xffff0000, v84
 v_cvt_pk_bf16_f32 v84, v42, v43
 v_lshlrev_b32 v42, 16, v84
 v_and_b32 v43, 0xffff0000, v84
 v_cvt_pk_bf16_f32 v84, v44, v45
 v_lshlrev_b32 v44, 16, v84
 v_and_b32 v45, 0xffff0000, v84
 v_cvt_pk_bf16_f32 v84, v46, v47
 v_lshlrev_b32 v46, 16, v84
 v_and_b32 v47, 0xffff0000, v84
 v_cvt_pk_bf16_f32 v84, v48, v49
 v_lshlrev_b32 v48, 16, v84
 v_and_b32 v49, 0xffff0000, v84
 v_cvt_pk_bf16_f32 v84, v50, v51
 v_lshlrev_b32 v50, 16, v84
 v_and_b32 v51, 0xffff0000, v84
 v_lshlrev_b32 v12, 16, v147
 v_and_b32 v13, 0xffff0000, v147
 v_lshlrev_b32 v14, 16, v151
 v_and_b32 v15, 0xffff0000, v151
 v_lshlrev_b32 v16, 16, v155
 v_and_b32 v17, 0xffff0000, v155
 v_lshlrev_b32 v18, 16, v159
 v_and_b32 v19, 0xffff0000, v159
 v_lshlrev_b32 v20, 16, v163
 v_and_b32 v21, 0xffff0000, v163
 v_lshlrev_b32 v22, 16, v167
 v_and_b32 v23, 0xffff0000, v167
 v_lshlrev_b32 v24, 16, v171
 v_and_b32 v25, 0xffff0000, v171
 v_lshlrev_b32 v26, 16, v175
 v_and_b32 v27, 0xffff0000, v175
 v_pk_mul_f32 v[36:37], v[36:37], v[12:13]
 v_pk_mul_f32 v[38:39], v[38:39], v[14:15]
 v_pk_mul_f32 v[40:41], v[40:41], v[16:17]
 v_pk_mul_f32 v[42:43], v[42:43], v[18:19]
 v_pk_mul_f32 v[44:45], v[44:45], v[20:21]
 v_pk_mul_f32 v[46:47], v[46:47], v[22:23]
 v_pk_mul_f32 v[48:49], v[48:49], v[24:25]
 v_pk_mul_f32 v[50:51], v[50:51], v[26:27]
 v_cvt_pk_bf16_f32 v76, v50, v48
 v_cvt_pk_bf16_f32 v77, v46, v44
 v_cvt_pk_bf16_f32 v78, v42, v40
 v_cvt_pk_bf16_f32 v79, v38, v36
 s_add_u32 s3, s70, 24576
 buffer_store_dwordx4 v[76:79], v94, s[4:7], s3 offen sc1
 v_cvt_pk_bf16_f32 v80, v51, v49
 v_cvt_pk_bf16_f32 v81, v47, v45
 v_cvt_pk_bf16_f32 v82, v43, v41
 v_cvt_pk_bf16_f32 v83, v39, v37
 s_add_u32 s3, s70, 28672
 buffer_store_dwordx4 v[80:83], v94, s[4:7], s3 offen sc1
 s_cmp_eq_u32 s83, 1
 s_cbranch_scc1 L_k3_25
 s_waitcnt vmcnt(0)
 s_barrier
 s_cmp_lg_u32 s50, 3
 s_cbranch_scc1 L_ar_26
 s_mov_b32 s96, s44
 s_and_b32 s97, s45, 0xffff
 s_mov_b32 s98, 256
 s_mov_b32 s99, 0x00020000
 v_mov_b32 v1, 1
 s_mov_b64 exec, 1
 buffer_atomic_add v1, off, s[96:99], 0 offset:80 sc0
 s_waitcnt vmcnt(0)
 v_cmp_eq_u32 vcc, 39, v1
 s_cbranch_vccz L_aw_27
 buffer_store_dword v1, off, s[96:99], 0 offset:208 sc1
L_aw_27:
 s_mov_b64 exec, -1
L_ar_26:
 s_branch L_help_conv
L_k3_25:
 s_waitcnt vmcnt(0)
 s_barrier
 s_cmp_lg_u32 s50, 3
 s_cbranch_scc1 L_ar_28
 s_mov_b32 s96, s44
 s_and_b32 s97, s45, 0xffff
 s_mov_b32 s98, 256
 s_mov_b32 s99, 0x00020000
 v_mov_b32 v1, 1
 s_mov_b64 exec, 1
 buffer_atomic_add v1, off, s[96:99], 0 offset:68 sc0
 s_waitcnt vmcnt(0)
 v_cmp_eq_u32 vcc, 39, v1
 s_cbranch_vccz L_aw_29
 buffer_store_dword v1, off, s[96:99], 0 offset:196 sc1
L_aw_29:
 s_mov_b64 exec, -1
L_ar_28:
 s_mov_b32 s8, s26
 s_and_b32 s9, s27, 0xffff
 s_mov_b32 s10, 5242880
 s_mov_b32 s11, 0x00020000
 s_mul_i32 s57, s50, 40960
 s_and_b32 s55, s53, 3
 s_add_u32 s64, s55, 0
 s_sub_u32 s3, s64, 4
 s_cmp_ge_u32 s64, 4
 s_cselect_b32 s64, s3, s64
 s_add_u32 s65, s55, 1
 s_sub_u32 s3, s65, 4
 s_cmp_ge_u32 s65, 4
 s_cselect_b32 s65, s3, s65
 s_add_u32 s66, s55, 2
 s_sub_u32 s3, s66, 4
 s_cmp_ge_u32 s66, 4
 s_cselect_b32 s66, s3, s66
 s_add_u32 s67, s55, 3
 s_sub_u32 s3, s67, 4
 s_cmp_ge_u32 s67, 4
 s_cselect_b32 s67, s3, s67
 s_mul_i32 s55, s52, 655360
 s_lshl_b32 s3, s53, 8
 s_add_u32 s55, s55, s3
 v_lshrrev_b32 v4, 4, v0
 s_mov_b32 s3, 1280
 v_mul_lo_u32 v4, v4, s3
 v_lshrrev_b32 v3, 3, v0
 v_and_b32 v3, 6, v3
 v_xor_b32 v3, v3, v0
 v_and_b32 v3, 15, v3
 v_lshl_add_u32 v4, v3, 4, v4
 v_xor_b32 v5, 128, v4
 s_lshl_b32 s57, s50, 13
 s_mul_i32 s3, s50, 40960
 s_add_u32 s55, s55, s3
 s_mul_i32 s51, s64, 163840
 s_add_u32 s51, s51, s55
 s_add_u32 m0, s57, 0
 s_nop 0
 buffer_load_dwordx4 v4, s[8:11], s51 offen lds
 s_add_u32 s51, s51, 5120
 s_add_u32 m0, s57, 1024
 s_nop 0
 buffer_load_dwordx4 v5, s[8:11], s51 offen lds
 s_add_u32 s51, s51, 5120
 s_add_u32 m0, s57, 2048
 s_nop 0
 buffer_load_dwordx4 v4, s[8:11], s51 offen lds
 s_add_u32 s51, s51, 5120
 s_add_u32 m0, s57, 3072
 s_nop 0
 buffer_load_dwordx4 v5, s[8:11], s51 offen lds
 s_add_u32 s51, s51, 5120
 s_add_u32 m0, s57, 4096
 s_nop 0
 buffer_load_dwordx4 v4, s[8:11], s51 offen lds
 s_add_u32 s51, s51, 5120
 s_add_u32 m0, s57, 5120
 s_nop 0
 buffer_load_dwordx4 v5, s[8:11], s51 offen lds
 s_add_u32 s51, s51, 5120
 s_add_u32 m0, s57, 6144
 s_nop 0
 buffer_load_dwordx4 v4, s[8:11], s51 offen lds
 s_add_u32 s51, s51, 5120
 s_add_u32 m0, s57, 7168
 s_nop 0
 buffer_load_dwordx4 v5, s[8:11], s51 offen lds
 s_add_u32 s51, s51, 5120
 s_mul_i32 s51, s65, 163840
 s_add_u32 s51, s51, s55
 s_add_u32 m0, s57, 32768
 s_nop 0
 buffer_load_dwordx4 v4, s[8:11], s51 offen lds
 s_add_u32 s51, s51, 5120
 s_add_u32 m0, s57, 33792
 s_nop 0
 buffer_load_dwordx4 v5, s[8:11], s51 offen lds
 s_add_u32 s51, s51, 5120
 s_add_u32 m0, s57, 34816
 s_nop 0
 buffer_load_dwordx4 v4, s[8:11], s51 offen lds
 s_add_u32 s51, s51, 5120
 s_add_u32 m0, s57, 35840
 s_nop 0
 buffer_load_dwordx4 v5, s[8:11], s51 offen lds
 s_add_u32 s51, s51, 5120
 s_add_u32 m0, s57, 36864
 s_nop 0
 buffer_load_dwordx4 v4, s[8:11], s51 offen lds
 s_add_u32 s51, s51, 5120
 s_add_u32 m0, s57, 37888
 s_nop 0
 buffer_load_dwordx4 v5, s[8:11], s51 offen lds
 s_add_u32 s51, s51, 5120
 s_add_u32 m0, s57, 38912
 s_nop 0
 buffer_load_dwordx4 v4, s[8:11], s51 offen lds
 s_add_u32 s51, s51, 5120
 s_add_u32 m0, s57, 39936
 s_nop 0
 buffer_load_dwordx4 v5, s[8:11], s51 offen lds
 s_add_u32 s51, s51, 5120
 s_mul_i32 s51, s66, 163840
 s_add_u32 s51, s51, s55
 s_add_u32 m0, s57, 65536
 s_nop 0
 buffer_load_dwordx4 v4, s[8:11], s51 offen lds
 s_add_u32 s51, s51, 5120
 s_add_u32 m0, s57, 66560
 s_nop 0
 buffer_load_dwordx4 v5, s[8:11], s51 offen lds
 s_add_u32 s51, s51, 5120
 s_add_u32 m0, s57, 67584
 s_nop 0
 buffer_load_dwordx4 v4, s[8:11], s51 offen lds
 s_add_u32 s51, s51, 5120
 s_add_u32 m0, s57, 68608
 s_nop 0
 buffer_load_dwordx4 v5, s[8:11], s51 offen lds
 s_add_u32 s51, s51, 5120
 s_add_u32 m0, s57, 69632
 s_nop 0
 buffer_load_dwordx4 v4, s[8:11], s51 offen lds
 s_add_u32 s51, s51, 5120
 s_add_u32 m0, s57, 70656
 s_nop 0
 buffer_load_dwordx4 v5, s[8:11], s51 offen lds
 s_add_u32 s51, s51, 5120
 s_add_u32 m0, s57, 71680
 s_nop 0
 buffer_load_dwordx4 v4, s[8:11], s51 offen lds
 s_add_u32 s51, s51, 5120
 s_add_u32 m0, s57, 72704
 s_nop 0
 buffer_load_dwordx4 v5, s[8:11], s51 offen lds
 s_add_u32 s51, s51, 5120
 s_mul_i32 s51, s67, 163840
 s_add_u32 s51, s51, s55
 s_add_u32 m0, s57, 98304
 s_nop 0
 buffer_load_dwordx4 v4, s[8:11], s51 offen lds
 s_add_u32 s51, s51, 5120
 s_add_u32 m0, s57, 99328
 s_nop 0
 buffer_load_dwordx4 v5, s[8:11], s51 offen lds
 s_add_u32 s51, s51, 5120
 s_add_u32 m0, s57, 100352
 s_nop 0
 buffer_load_dwordx4 v4, s[8:11], s51 offen lds
 s_add_u32 s51, s51, 5120
 s_add_u32 m0, s57, 101376
 s_nop 0
 buffer_load_dwordx4 v5, s[8:11], s51 offen lds
 s_add_u32 s51, s51, 5120
 s_add_u32 m0, s57, 102400
 s_nop 0
 buffer_load_dwordx4 v4, s[8:11], s51 offen lds
 s_add_u32 s51, s51, 5120
 s_add_u32 m0, s57, 103424
 s_nop 0
 buffer_load_dwordx4 v5, s[8:11], s51 offen lds
 s_add_u32 s51, s51, 5120
 s_add_u32 m0, s57, 104448
 s_nop 0
 buffer_load_dwordx4 v4, s[8:11], s51 offen lds
 s_add_u32 s51, s51, 5120
 s_add_u32 m0, s57, 105472
 s_nop 0
 buffer_load_dwordx4 v5, s[8:11], s51 offen lds
 s_add_u32 s51, s51, 5120
 v_lshrrev_b32 v2, 3, v0
 v_and_b32 v2, 4, v2
 v_bfe_u32 v3, v0, 2, 2
 v_or_b32 v2, v2, v3
 v_bfe_u32 v3, v0, 4, 1
 v_xor_b32 v3, v3, v2
 s_lshl_b32 s3, s50, 1
 v_xor_b32 v3, s3, v3
 v_lshlrev_b32 v2, 8, v2
 v_lshl_add_u32 v2, v3, 5, v2
 v_and_b32 v3, 3, v0
 v_lshl_add_u32 v2, v3, 3, v2
 s_waitcnt vmcnt(24)
 s_barrier
 ds_read_b64_tr_b16 a[0:1], v2 offset:0
 ds_read_b64_tr_b16 a[2:3], v2 offset:4096
 ds_read_b64_tr_b16 a[4:5], v2 offset:2048
 ds_read_b64_tr_b16 a[6:7], v2 offset:6144
 ds_read_b64_tr_b16 a[8:9], v2 offset:8192
 ds_read_b64_tr_b16 a[10:11], v2 offset:12288
 ds_read_b64_tr_b16 a[12:13], v2 offset:10240
 ds_read_b64_tr_b16 a[14:15], v2 offset:14336
 ds_read_b64_tr_b16 a[16:17], v2 offset:16384
 ds_read_b64_tr_b16 a[18:19], v2 offset:20480
 ds_read_b64_tr_b16 a[20:21], v2 offset:18432
 ds_read_b64_tr_b16 a[22:23], v2 offset:22528
 ds_read_b64_tr_b16 a[24:25], v2 offset:24576
 ds_read_b64_tr_b16 a[26:27], v2 offset:28672
 ds_read_b64_tr_b16 a[28:29], v2 offset:26624
 ds_read_b64_tr_b16 a[30:31], v2 offset:30720
 v_add_u32 v2, 0x8000, v2
 s_waitcnt vmcnt(16)
 s_barrier
 ds_read_b64_tr_b16 a[32:33], v2 offset:0
 ds_read_b64_tr_b16 a[34:35], v2 offset:4096
 ds_read_b64_tr_b16 a[36:37], v2 offset:2048
 ds_read_b64_tr_b16 a[38:39], v2 offset:6144
 ds_read_b64_tr_b16 a[40:41], v2 offset:8192
 ds_read_b64_tr_b16 a[42:43], v2 offset:12288
 ds_read_b64_tr_b16 a[44:45], v2 offset:10240
 ds_read_b64_tr_b16 a[46:47], v2 offset:14336
 ds_read_b64_tr_b16 a[48:49], v2 offset:16384
 ds_read_b64_tr_b16 a[50:51], v2 offset:20480
 ds_read_b64_tr_b16 a[52:53], v2 offset:18432
 ds_read_b64_tr_b16 a[54:55], v2 offset:22528
 ds_read_b64_tr_b16 a[56:57], v2 offset:24576
 ds_read_b64_tr_b16 a[58:59], v2 offset:28672
 ds_read_b64_tr_b16 a[60:61], v2 offset:26624
 ds_read_b64_tr_b16 a[62:63], v2 offset:30720
 v_add_u32 v2, 0x8000, v2
 s_waitcnt vmcnt(8)
 s_barrier
 ds_read_b64_tr_b16 a[64:65], v2 offset:0
 ds_read_b64_tr_b16 a[66:67], v2 offset:4096
 ds_read_b64_tr_b16 a[68:69], v2 offset:2048
 ds_read_b64_tr_b16 a[70:71], v2 offset:6144
 ds_read_b64_tr_b16 a[72:73], v2 offset:8192
 ds_read_b64_tr_b16 a[74:75], v2 offset:12288
 ds_read_b64_tr_b16 a[76:77], v2 offset:10240
 ds_read_b64_tr_b16 a[78:79], v2 offset:14336
 ds_read_b64_tr_b16 a[80:81], v2 offset:16384
 ds_read_b64_tr_b16 a[82:83], v2 offset:20480
 ds_read_b64_tr_b16 a[84:85], v2 offset:18432
 ds_read_b64_tr_b16 a[86:87], v2 offset:22528
 ds_read_b64_tr_b16 a[88:89], v2 offset:24576
 ds_read_b64_tr_b16 a[90:91], v2 offset:28672
 ds_read_b64_tr_b16 a[92:93], v2 offset:26624
 ds_read_b64_tr_b16 a[94:95], v2 offset:30720
 v_add_u32 v2, 0x8000, v2
 s_waitcnt vmcnt(0)
 s_barrier
 ds_read_b64_tr_b16 a[96:97], v2 offset:0
 ds_read_b64_tr_b16 a[98:99], v2 offset:4096
 ds_read_b64_tr_b16 a[100:101], v2 offset:2048
 ds_read_b64_tr_b16 a[102:103], v2 offset:6144
 ds_read_b64_tr_b16 a[104:105], v2 offset:8192
 ds_read_b64_tr_b16 a[106:107], v2 offset:12288
 ds_read_b64_tr_b16 a[108:109], v2 offset:10240
 ds_read_b64_tr_b16 a[110:111], v2 offset:14336
 ds_read_b64_tr_b16 a[112:113], v2 offset:16384
 ds_read_b64_tr_b16 a[114:115], v2 offset:20480
 ds_read_b64_tr_b16 a[116:117], v2 offset:18432
 ds_read_b64_tr_b16 a[118:119], v2 offset:22528
 ds_read_b64_tr_b16 a[120:121], v2 offset:24576
 ds_read_b64_tr_b16 a[122:123], v2 offset:28672
 ds_read_b64_tr_b16 a[124:125], v2 offset:26624
 ds_read_b64_tr_b16 a[126:127], v2 offset:30720
 v_add_u32 v2, 0x8000, v2
 s_waitcnt lgkmcnt(0)
 s_barrier
L_help_conv:
 s_cmp_ge_u32 s82, 72
 s_cbranch_scc1 L_help_ln2
 s_cmp_ge_u32 s82, 64
 s_cbranch_scc1 L_help_done
 s_lshl_b32 s70, s82, 2
 s_add_u32 s70, s70, s50
 s_add_u32 s70, s70, 384
 s_mul_i32 s71, s50, 13312
 s_mov_b32 s69, 640
 s_mov_b32 s8, s38
 s_and_b32 s9, s39, 0xffff
 s_mov_b32 s10, 2621440
 s_mov_b32 s11, 0x00020000
 s_mov_b32 s12, s40
 s_and_b32 s13, s41, 0xffff
 s_mov_b32 s14, 1280
 s_mov_b32 s15, 0x00020000
 v_lshlrev_b32 v130, 4, v0
 s_lshl_b32 s73, s70, 12
 s_add_u32 s74, s73, 2
 buffer_load_dwordx4 v[96:99], v130, s[8:11], s73 offen offset:0
 buffer_load_dwordx4 v[100:103], v130, s[8:11], s73 offen offset:1024
 buffer_load_dwordx4 v[112:115], v130, s[8:11], s74 offen offset:0
 buffer_load_dwordx4 v[116:119], v130, s[8:11], s74 offen offset:1024
 s_lshl_b32 s3, s70, 1
 buffer_load_ushort v128, off, s[12:15], s3
 s_getpc_b64 s[76:77]
L_ca_30:
 s_add_u32 s76, s76, L_conv0-L_ca_30
 s_addc_u32 s77, s77, -1
 s_swappc_b64 s[76:77], s[76:77]
 s_waitcnt vmcnt(0)
 s_barrier
 s_cmp_lg_u32 s50, 3
 s_cbranch_scc1 L_ar_31
 s_mov_b32 s96, s44
 s_and_b32 s97, s45, 0xffff
 s_mov_b32 s98, 256
 s_mov_b32 s99, 0x00020000
 v_mov_b32 v1, 1
 s_mov_b64 exec, 1
 buffer_atomic_add v1, off, s[96:99], 0 offset:8 sc0
 s_waitcnt vmcnt(0)
 v_cmp_eq_u32 vcc, 159, v1
 s_cbranch_vccz L_aw_32
 buffer_store_dword v1, off, s[96:99], 0 offset:136 sc1
L_aw_32:
 s_mov_b64 exec, -1
L_ar_31:
L_help_done:
 s_cmp_lg_u32 s50, 0
 s_cbranch_scc1 L_ww_33
 s_mov_b32 s96, s44
 s_and_b32 s97, s45, 0xffff
 s_mov_b32 s98, 256
 s_mov_b32 s99, 0x00020000
 v_mov_b32 v1, 132
 s_mov_b32 s51, 0
 s_mov_b64 exec, 1
L_wb_34:
 buffer_load_dword v2, v1, s[96:99], 0 offen sc1
 s_waitcnt vmcnt(0)
 v_cmp_eq_u32 vcc, 0, v2
 s_cbranch_vccz L_wbd_35
 s_sleep 2
 s_add_u32 s51, s51, 1
 s_cmp_lt_u32 s51, 131072
 s_cbranch_scc1 L_wb_34
 s_branch L_bail
L_wbd_35:
 s_mov_b64 exec, -1
L_ww_33:
 s_barrier
 s_cmp_eq_u32 s83, 0
 s_cbranch_scc1 L_t4
 s_cmp_eq_u32 s83, 1
 s_cbranch_scc1 L_wo
 s_branch L_att
L_qkvq:
 s_mul_i32 s57, s50, 40960
 s_mul_i32 s62, s52, 3
 s_add_u32 s62, s62, s53
 s_mul_i32 s3, s62, 13108
 s_lshr_b32 s3, s3, 16
 s_mul_i32 s3, s3, 5
 s_sub_u32 s55, s62, s3
 s_add_u32 s64, s55, 0
 s_sub_u32 s3, s64, 5
 s_cmp_ge_u32 s64, 5
 s_cselect_b32 s64, s3, s64
 s_add_u32 s65, s55, 1
 s_sub_u32 s3, s65, 5
 s_cmp_ge_u32 s65, 5
 s_cselect_b32 s65, s3, s65
 s_add_u32 s66, s55, 2
 s_sub_u32 s3, s66, 5
 s_cmp_ge_u32 s66, 5
 s_cselect_b32 s66, s3, s66
 s_add_u32 s67, s55, 3
 s_sub_u32 s3, s67, 5
 s_cmp_ge_u32 s67, 5
 s_cselect_b32 s67, s3, s67
 s_add_u32 s68, s55, 4
 s_sub_u32 s3, s68, 5
 s_cmp_ge_u32 s68, 5
 s_cselect_b32 s68, s3, s68
 s_lshl_b32 s55, s52, 8
 v_lshrrev_b32 v4, 4, v0
 s_mov_b32 s3, 8192
 v_mul_lo_u32 v4, v4, s3
 v_lshrrev_b32 v3, 3, v0
 v_and_b32 v3, 6, v3
 v_xor_b32 v3, v3, v0
 v_and_b32 v3, 15, v3
 v_lshl_add_u32 v4, v3, 4, v4
 v_xor_b32 v5, 128, v4
 s_lshl_b32 s57, s50, 13
 s_mul_i32 s3, s50, 262144
 s_add_u32 s55, s55, s3
 s_mul_i32 s51, s64, 1048576
 s_add_u32 s51, s51, s55
 s_add_u32 m0, s57, 0
 s_nop 0
 buffer_load_dwordx4 v4, s[8:11], s51 offen lds
 s_add_u32 s51, s51, 32768
 s_add_u32 m0, s57, 1024
 s_nop 0
 buffer_load_dwordx4 v5, s[8:11], s51 offen lds
 s_add_u32 s51, s51, 32768
 s_add_u32 m0, s57, 2048
 s_nop 0
 buffer_load_dwordx4 v4, s[8:11], s51 offen lds
 s_add_u32 s51, s51, 32768
 s_add_u32 m0, s57, 3072
 s_nop 0
 buffer_load_dwordx4 v5, s[8:11], s51 offen lds
 s_add_u32 s51, s51, 32768
 s_add_u32 m0, s57, 4096
 s_nop 0
 buffer_load_dwordx4 v4, s[8:11], s51 offen lds
 s_add_u32 s51, s51, 32768
 s_add_u32 m0, s57, 5120
 s_nop 0
 buffer_load_dwordx4 v5, s[8:11], s51 offen lds
 s_add_u32 s51, s51, 32768
 s_add_u32 m0, s57, 6144
 s_nop 0
 buffer_load_dwordx4 v4, s[8:11], s51 offen lds
 s_add_u32 s51, s51, 32768
 s_add_u32 m0, s57, 7168
 s_nop 0
 buffer_load_dwordx4 v5, s[8:11], s51 offen lds
 s_add_u32 s51, s51, 32768
 s_mul_i32 s51, s65, 1048576
 s_add_u32 s51, s51, s55
 s_add_u32 m0, s57, 32768
 s_nop 0
 buffer_load_dwordx4 v4, s[8:11], s51 offen lds
 s_add_u32 s51, s51, 32768
 s_add_u32 m0, s57, 33792
 s_nop 0
 buffer_load_dwordx4 v5, s[8:11], s51 offen lds
 s_add_u32 s51, s51, 32768
 s_add_u32 m0, s57, 34816
 s_nop 0
 buffer_load_dwordx4 v4, s[8:11], s51 offen lds
 s_add_u32 s51, s51, 32768
 s_add_u32 m0, s57, 35840
 s_nop 0
 buffer_load_dwordx4 v5, s[8:11], s51 offen lds
 s_add_u32 s51, s51, 32768
 s_add_u32 m0, s57, 36864
 s_nop 0
 buffer_load_dwordx4 v4, s[8:11], s51 offen lds
 s_add_u32 s51, s51, 32768
 s_add_u32 m0, s57, 37888
 s_nop 0
 buffer_load_dwordx4 v5, s[8:11], s51 offen lds
 s_add_u32 s51, s51, 32768
 s_add_u32 m0, s57, 38912
 s_nop 0
 buffer_load_dwordx4 v4, s[8:11], s51 offen lds
 s_add_u32 s51, s51, 32768
 s_add_u32 m0, s57, 39936
 s_nop 0
 buffer_load_dwordx4 v5, s[8:11], s51 offen lds
 s_add_u32 s51, s51, 32768
 s_mul_i32 s51, s66, 1048576
 s_add_u32 s51, s51, s55
 s_add_u32 m0, s57, 65536
 s_nop 0
 buffer_load_dwordx4 v4, s[8:11], s51 offen lds
 s_add_u32 s51, s51, 32768
 s_add_u32 m0, s57, 66560
 s_nop 0
 buffer_load_dwordx4 v5, s[8:11], s51 offen lds
 s_add_u32 s51, s51, 32768
 s_add_u32 m0, s57, 67584
 s_nop 0
 buffer_load_dwordx4 v4, s[8:11], s51 offen lds
 s_add_u32 s51, s51, 32768
 s_add_u32 m0, s57, 68608
 s_nop 0
 buffer_load_dwordx4 v5, s[8:11], s51 offen lds
 s_add_u32 s51, s51, 32768
 s_add_u32 m0, s57, 69632
 s_nop 0
 buffer_load_dwordx4 v4, s[8:11], s51 offen lds
 s_add_u32 s51, s51, 32768
 s_add_u32 m0, s57, 70656
 s_nop 0
 buffer_load_dwordx4 v5, s[8:11], s51 offen lds
 s_add_u32 s51, s51, 32768
 s_add_u32 m0, s57, 71680
 s_nop 0
 buffer_load_dwordx4 v4, s[8:11], s51 offen lds
 s_add_u32 s51, s51, 32768
 s_add_u32 m0, s57, 72704
 s_nop 0
 buffer_load_dwordx4 v5, s[8:11], s51 offen lds
 s_add_u32 s51, s51, 32768
 s_mul_i32 s51, s67, 1048576
 s_add_u32 s51, s51, s55
 s_add_u32 m0, s57, 98304
 s_nop 0
 buffer_load_dwordx4 v4, s[8:11], s51 offen lds
 s_add_u32 s51, s51, 32768
 s_add_u32 m0, s57, 99328
 s_nop 0
 buffer_load_dwordx4 v5, s[8:11], s51 offen lds
 s_add_u32 s51, s51, 32768
 s_add_u32 m0, s57, 100352
 s_nop 0
 buffer_load_dwordx4 v4, s[8:11], s51 offen lds
 s_add_u32 s51, s51, 32768
 s_add_u32 m0, s57, 101376
 s_nop 0
 buffer_load_dwordx4 v5, s[8:11], s51 offen lds
 s_add_u32 s51, s51, 32768
 s_add_u32 m0, s57, 102400
 s_nop 0
 buffer_load_dwordx4 v4, s[8:11], s51 offen lds
 s_add_u32 s51, s51, 32768
 s_add_u32 m0, s57, 103424
 s_nop 0
 buffer_load_dwordx4 v5, s[8:11], s51 offen lds
 s_add_u32 s51, s51, 32768
 s_add_u32 m0, s57, 104448
 s_nop 0
 buffer_load_dwordx4 v4, s[8:11], s51 offen lds
 s_add_u32 s51, s51, 32768
 s_add_u32 m0, s57, 105472
 s_nop 0
 buffer_load_dwordx4 v5, s[8:11], s51 offen lds
 s_add_u32 s51, s51, 32768
 s_mul_i32 s51, s68, 1048576
 s_add_u32 s51, s51, s55
 s_add_u32 m0, s57, 131072
 s_nop 0
 buffer_load_dwordx4 v4, s[8:11], s51 offen lds
 s_add_u32 s51, s51, 32768
 s_add_u32 m0, s57, 132096
 s_nop 0
 buffer_load_dwordx4 v5, s[8:11], s51 offen lds
 s_add_u32 s51, s51, 32768
 s_add_u32 m0, s57, 133120
 s_nop 0
 buffer_load_dwordx4 v4, s[8:11], s51 offen lds
 s_add_u32 s51, s51, 32768
 s_add_u32 m0, s57, 134144
 s_nop 0
 buffer_load_dwordx4 v5, s[8:11], s51 offen lds
 s_add_u32 s51, s51, 32768
 s_add_u32 m0, s57, 135168
 s_nop 0
 buffer_load_dwordx4 v4, s[8:11], s51 offen lds
 s_add_u32 s51, s51, 32768
 s_add_u32 m0, s57, 136192
 s_nop 0
 buffer_load_dwordx4 v5, s[8:11], s51 offen lds
 s_add_u32 s51, s51, 32768
 s_add_u32 m0, s57, 137216
 s_nop 0
 buffer_load_dwordx4 v4, s[8:11], s51 offen lds
 s_add_u32 s51, s51, 32768
 s_add_u32 m0, s57, 138240
 s_nop 0
 buffer_load_dwordx4 v5, s[8:11], s51 offen lds
 s_add_u32 s51, s51, 32768
 s_mov_b32 s96, s44
 s_and_b32 s97, s45, 0xffff
 s_mov_b32 s98, 256
 s_mov_b32 s99, 0x00020000
 buffer_load_dword v30, off, s[96:99], 0 offset:132 sc1
 v_lshrrev_b32 v2, 3, v0
 v_and_b32 v2, 4, v2
 v_bfe_u32 v3, v0, 2, 2
 v_or_b32 v2, v2, v3
 v_bfe_u32 v3, v0, 4, 1
 v_xor_b32 v3, v3, v2
 s_lshl_b32 s3, s50, 1
 v_xor_b32 v3, s3, v3
 v_lshlrev_b32 v2, 8, v2
 v_lshl_add_u32 v2, v3, 5, v2
 v_and_b32 v3, 3, v0
 v_lshl_add_u32 v2, v3, 3, v2
 s_waitcnt vmcnt(32)
 s_barrier
 ds_read_b64_tr_b16 a[0:1], v2 offset:0
 ds_read_b64_tr_b16 a[2:3], v2 offset:4096
 ds_read_b64_tr_b16 a[4:5], v2 offset:2048
 ds_read_b64_tr_b16 a[6:7], v2 offset:6144
 ds_read_b64_tr_b16 a[8:9], v2 offset:8192
 ds_read_b64_tr_b16 a[10:11], v2 offset:12288
 ds_read_b64_tr_b16 a[12:13], v2 offset:10240
 ds_read_b64_tr_b16 a[14:15], v2 offset:14336
 ds_read_b64_tr_b16 a[16:17], v2 offset:16384
 ds_read_b64_tr_b16 a[18:19], v2 offset:20480
 ds_read_b64_tr_b16 a[20:21], v2 offset:18432
 ds_read_b64_tr_b16 a[22:23], v2 offset:22528
 ds_read_b64_tr_b16 a[24:25], v2 offset:24576
 ds_read_b64_tr_b16 a[26:27], v2 offset:28672
 ds_read_b64_tr_b16 a[28:29], v2 offset:26624
 ds_read_b64_tr_b16 a[30:31], v2 offset:30720
 v_add_u32 v2, 0x8000, v2
 s_waitcnt vmcnt(24)
 s_barrier
 ds_read_b64_tr_b16 a[32:33], v2 offset:0
 ds_read_b64_tr_b16 a[34:35], v2 offset:4096
 ds_read_b64_tr_b16 a[36:37], v2 offset:2048
 ds_read_b64_tr_b16 a[38:39], v2 offset:6144
 ds_read_b64_tr_b16 a[40:41], v2 offset:8192
 ds_read_b64_tr_b16 a[42:43], v2 offset:12288
 ds_read_b64_tr_b16 a[44:45], v2 offset:10240
 ds_read_b64_tr_b16 a[46:47], v2 offset:14336
 ds_read_b64_tr_b16 a[48:49], v2 offset:16384
 ds_read_b64_tr_b16 a[50:51], v2 offset:20480
 ds_read_b64_tr_b16 a[52:53], v2 offset:18432
 ds_read_b64_tr_b16 a[54:55], v2 offset:22528
 ds_read_b64_tr_b16 a[56:57], v2 offset:24576
 ds_read_b64_tr_b16 a[58:59], v2 offset:28672
 ds_read_b64_tr_b16 a[60:61], v2 offset:26624
 ds_read_b64_tr_b16 a[62:63], v2 offset:30720
 v_add_u32 v2, 0x8000, v2
 s_waitcnt vmcnt(16)
 s_barrier
 ds_read_b64_tr_b16 a[64:65], v2 offset:0
 ds_read_b64_tr_b16 a[66:67], v2 offset:4096
 ds_read_b64_tr_b16 a[68:69], v2 offset:2048
 ds_read_b64_tr_b16 a[70:71], v2 offset:6144
 ds_read_b64_tr_b16 a[72:73], v2 offset:8192
 ds_read_b64_tr_b16 a[74:75], v2 offset:12288
 ds_read_b64_tr_b16 a[76:77], v2 offset:10240
 ds_read_b64_tr_b16 a[78:79], v2 offset:14336
 ds_read_b64_tr_b16 a[80:81], v2 offset:16384
 ds_read_b64_tr_b16 a[82:83], v2 offset:20480
 ds_read_b64_tr_b16 a[84:85], v2 offset:18432
 ds_read_b64_tr_b16 a[86:87], v2 offset:22528
 ds_read_b64_tr_b16 a[88:89], v2 offset:24576
 ds_read_b64_tr_b16 a[90:91], v2 offset:28672
 ds_read_b64_tr_b16 a[92:93], v2 offset:26624
 ds_read_b64_tr_b16 a[94:95], v2 offset:30720
 v_add_u32 v2, 0x8000, v2
 s_waitcnt vmcnt(8)
 s_barrier
 ds_read_b64_tr_b16 a[96:97], v2 offset:0
 ds_read_b64_tr_b16 a[98:99], v2 offset:4096
 ds_read_b64_tr_b16 a[100:101], v2 offset:2048
 ds_read_b64_tr_b16 a[102:103], v2 offset:6144
 ds_read_b64_tr_b16 a[104:105], v2 offset:8192
 ds_read_b64_tr_b16 a[106:107], v2 offset:12288
 ds_read_b64_tr_b16 a[108:109], v2 offset:10240
 ds_read_b64_tr_b16 a[110:111], v2 offset:14336
 ds_read_b64_tr_b16 a[112:113], v2 offset:16384
 ds_read_b64_tr_b16 a[114:115], v2 offset:20480
 ds_read_b64_tr_b16 a[116:117], v2 offset:18432
 ds_read_b64_tr_b16 a[118:119], v2 offset:22528
 ds_read_b64_tr_b16 a[120:121], v2 offset:24576
 ds_read_b64_tr_b16 a[122:123], v2 offset:28672
 ds_read_b64_tr_b16 a[124:125], v2 offset:26624
 ds_read_b64_tr_b16 a[126:127], v2 offset:30720
 v_add_u32 v2, 0x8000, v2
 s_waitcnt vmcnt(0)
 s_barrier
 ds_read_b64_tr_b16 a[128:129], v2 offset:0
 ds_read_b64_tr_b16 a[130:131], v2 offset:4096
 ds_read_b64_tr_b16 a[132:133], v2 offset:2048
 ds_read_b64_tr_b16 a[134:135], v2 offset:6144
 ds_read_b64_tr_b16 a[136:137], v2 offset:8192
 ds_read_b64_tr_b16 a[138:139], v2 offset:12288
 ds_read_b64_tr_b16 a[140:141], v2 offset:10240
 ds_read_b64_tr_b16 a[142:143], v2 offset:14336
 ds_read_b64_tr_b16 a[144:145], v2 offset:16384
 ds_read_b64_tr_b16 a[146:147], v2 offset:20480
 ds_read_b64_tr_b16 a[148:149], v2 offset:18432
 ds_read_b64_tr_b16 a[150:151], v2 offset:22528
 ds_read_b64_tr_b16 a[152:153], v2 offset:24576
 ds_read_b64_tr_b16 a[154:155], v2 offset:28672
 ds_read_b64_tr_b16 a[156:157], v2 offset:26624
 ds_read_b64_tr_b16 a[158:159], v2 offset:30720
 v_add_u32 v2, 0x8000, v2
 s_waitcnt lgkmcnt(0)
 s_barrier
 v_cmp_eq_u32 vcc, 0, v30
 s_cbranch_vccz L_qa_36
 s_mov_b32 s96, s44
 s_and_b32 s97, s45, 0xffff
 s_mov_b32 s98, 256
 s_mov_b32 s99, 0x00020000
 v_mov_b32 v1, 132
 s_mov_b32 s51, 0
 s_mov_b64 exec, 1
L_wb_37:
 buffer_load_dword v2, v1, s[96:99], 0 offen sc1
 s_waitcnt vmcnt(0)
 v_cmp_eq_u32 vcc, 0, v2
 s_cbranch_vccz L_wbd_38
 s_sleep 2
 s_add_u32 s51, s51, 1
 s_cmp_lt_u32 s51, 131072
 s_cbranch_scc1 L_wb_37
 s_branch L_bail
L_wbd_38:
 s_mov_b64 exec, -1
L_qa_36:
 s_lshl_b32 s64, s64, 8
 s_lshl_b32 s65, s65, 8
 s_lshl_b32 s66, s66, 8
 s_lshl_b32 s67, s67, 8
 s_lshl_b32 s68, s68, 8
 s_cmp_eq_u32 s53, 0
 s_cselect_b32 s78, 2, 3
 s_mov_b32 s79, 0
 v_lshrrev_b32 v1, 4, v0
 s_mov_b32 s3, 1280
 v_mul_lo_u32 v1, v1, s3
 v_and_b32 v3, 15, v0
 v_lshl_add_u32 v1, v3, 4, v1
 v_add_u32 v6, 5120, v1
 v_mov_b32 v24, v6
 v_and_b32 v2, 31, v0
 v_lshlrev_b32 v2, 8, v2
 v_lshrrev_b32 v4, 5, v0
 v_xor_b32 v4, v4, v3
 v_xor_b32 v8, 0, v4
 v_lshl_add_u32 v8, v8, 4, v2
 v_add_u32 v16, 40960, v8
 v_xor_b32 v9, 2, v4
 v_lshl_add_u32 v9, v9, 4, v2
 v_add_u32 v17, 40960, v9
 v_xor_b32 v10, 4, v4
 v_lshl_add_u32 v10, v10, 4, v2
 v_add_u32 v18, 40960, v10
 v_xor_b32 v11, 6, v4
 v_lshl_add_u32 v11, v11, 4, v2
 v_add_u32 v19, 40960, v11
 v_xor_b32 v12, 8, v4
 v_lshl_add_u32 v12, v12, 4, v2
 v_add_u32 v20, 40960, v12
 v_xor_b32 v13, 10, v4
 v_lshl_add_u32 v13, v13, 4, v2
 v_add_u32 v21, 40960, v13
 v_xor_b32 v14, 12, v4
 v_lshl_add_u32 v14, v14, 4, v2
 v_add_u32 v22, 40960, v14
 v_xor_b32 v15, 14, v4
 v_lshl_add_u32 v15, v15, 4, v2
 v_add_u32 v23, 40960, v15
 v_lshrrev_b32 v4, 5, v0
 v_lshlrev_b32 v4, 8, v4
 v_lshl_add_u32 v4, v3, 4, v4
 v_and_b32 v2, 16, v0
 v_lshl_add_u32 v4, v2, 8, v4
 s_lshl_b32 s3, s50, 10
 v_add_u32 v4, s3, v4
 v_mul_u32_u24 v5, 24576, v0
 v_mov_b32 v7, 163776
 v_mul_u32_u24 v30, 16384, v0
 s_lshl_b32 s75, s62, 2
 s_add_u32 s75, s75, s50
 s_and_b32 s100, s52, 1
 s_lshl_b32 s100, s100, 13
 s_lshl_b32 s58, s52, 14
 s_add_u32 s58, s58, s100
 s_add_u32 s58, s58, 8388608
 s_cmp_eq_u32 s53, 0
 s_cselect_b32 s82, 8192, 0
 s_lshl_b32 s59, s52, 8
 s_add_u32 s59, s59, 8192
 s_lshl_b32 s56, s50, 11
 s_mov_b32 s54, 0
 s_mov_b32 s61, 0
 s_mov_b32 s70, s75
 s_mul_i32 s55, s54, 40960
 s_mul_i32 s3, s50, 10240
 s_add_u32 s55, s55, s3
 s_add_u32 s55, s55, 226492416
 s_add_u32 m0, s56, 0
 s_add_u32 s3, s55, s64
 buffer_load_dwordx4 v1, s[4:7], s3 offen sc1 lds
 s_add_u32 m0, s56, 1024
 s_add_u32 s3, s55, s64
 buffer_load_dwordx4 v24, s[4:7], s3 offen sc1 lds
 s_add_u32 m0, s56, 8192
 s_add_u32 s3, s55, s65
 buffer_load_dwordx4 v1, s[4:7], s3 offen sc1 lds
 s_add_u32 m0, s56, 9216
 s_add_u32 s3, s55, s65
 buffer_load_dwordx4 v24, s[4:7], s3 offen sc1 lds
 s_add_u32 m0, s56, 16384
 s_add_u32 s3, s55, s66
 buffer_load_dwordx4 v1, s[4:7], s3 offen sc1 lds
 s_add_u32 m0, s56, 17408
 s_add_u32 s3, s55, s66
 buffer_load_dwordx4 v24, s[4:7], s3 offen sc1 lds
 s_add_u32 m0, s56, 24576
 s_add_u32 s3, s55, s67
 buffer_load_dwordx4 v1, s[4:7], s3 offen sc1 lds
 s_add_u32 m0, s56, 25600
 s_add_u32 s3, s55, s67
 buffer_load_dwordx4 v24, s[4:7], s3 offen sc1 lds
 s_add_u32 m0, s56, 32768
 s_add_u32 s3, s55, s68
 buffer_load_dwordx4 v1, s[4:7], s3 offen sc1 lds
 s_add_u32 m0, s56, 33792
 s_add_u32 s3, s55, s68
 buffer_load_dwordx4 v24, s[4:7], s3 offen sc1 lds
 s_waitcnt vmcnt(0)
L_qkvq_pre:
 s_barrier
 s_mov_b32 s60, s54
 s_add_u32 s54, s54, 1
 s_mul_i32 s55, s54, 40960
 s_mul_i32 s3, s50, 10240
 s_add_u32 s55, s55, s3
 s_add_u32 s55, s55, 226492416
 ds_read_b128 v[32:35], v8 offset:0
 ds_read_b128 v[36:39], v9 offset:0
 ds_read_b128 v[40:43], v10 offset:0
 ds_read_b128 v[44:47], v11 offset:0
 s_waitcnt lgkmcnt(3)
 v_mfma_f32_32x32x16_bf16 v[64:79], a[0:3], v[32:35], 0
 ds_read_b128 v[48:51], v12 offset:0
 s_add_u32 m0, s56, 40960
 s_add_u32 s3, s55, s64
 buffer_load_dwordx4 v1, s[4:7], s3 offen sc1 lds
 s_waitcnt lgkmcnt(3)
 v_mfma_f32_32x32x16_bf16 v[64:79], a[4:7], v[36:39], v[64:79]
 ds_read_b128 v[52:55], v13 offset:0
 s_waitcnt lgkmcnt(3)
 v_mfma_f32_32x32x16_bf16 v[64:79], a[8:11], v[40:43], v[64:79]
 ds_read_b128 v[56:59], v14 offset:0
 s_waitcnt lgkmcnt(3)
 v_mfma_f32_32x32x16_bf16 v[64:79], a[12:15], v[44:47], v[64:79]
 ds_read_b128 v[60:63], v15 offset:0
 s_add_u32 m0, s56, 41984
 s_add_u32 s3, s55, s64
 buffer_load_dwordx4 v24, s[4:7], s3 offen sc1 lds
 s_waitcnt lgkmcnt(3)
 v_mfma_f32_32x32x16_bf16 v[64:79], a[16:19], v[48:51], v[64:79]
 ds_read_b128 v[32:35], v8 offset:8192
 s_waitcnt lgkmcnt(3)
 v_mfma_f32_32x32x16_bf16 v[64:79], a[20:23], v[52:55], v[64:79]
 ds_read_b128 v[36:39], v9 offset:8192
 s_waitcnt lgkmcnt(3)
 v_mfma_f32_32x32x16_bf16 v[64:79], a[24:27], v[56:59], v[64:79]
 ds_read_b128 v[40:43], v10 offset:8192
 s_add_u32 m0, s56, 49152
 s_add_u32 s3, s55, s65
 buffer_load_dwordx4 v1, s[4:7], s3 offen sc1 lds
 s_waitcnt lgkmcnt(3)
 v_mfma_f32_32x32x16_bf16 v[64:79], a[28:31], v[60:63], v[64:79]
 ds_read_b128 v[44:47], v11 offset:8192
 s_waitcnt lgkmcnt(3)
 v_mfma_f32_32x32x16_bf16 v[64:79], a[32:35], v[32:35], v[64:79]
 ds_read_b128 v[48:51], v12 offset:8192
 s_waitcnt lgkmcnt(3)
 v_mfma_f32_32x32x16_bf16 v[64:79], a[36:39], v[36:39], v[64:79]
 ds_read_b128 v[52:55], v13 offset:8192
 s_add_u32 m0, s56, 50176
 s_add_u32 s3, s55, s65
 buffer_load_dwordx4 v24, s[4:7], s3 offen sc1 lds
 s_waitcnt lgkmcnt(3)
 v_mfma_f32_32x32x16_bf16 v[64:79], a[40:43], v[40:43], v[64:79]
 ds_read_b128 v[56:59], v14 offset:8192
 s_waitcnt lgkmcnt(3)
 v_mfma_f32_32x32x16_bf16 v[64:79], a[44:47], v[44:47], v[64:79]
 ds_read_b128 v[60:63], v15 offset:8192
 s_waitcnt lgkmcnt(3)
 v_mfma_f32_32x32x16_bf16 v[64:79], a[48:51], v[48:51], v[64:79]
 ds_read_b128 v[32:35], v8 offset:16384
 s_add_u32 m0, s56, 57344
 s_add_u32 s3, s55, s66
 buffer_load_dwordx4 v1, s[4:7], s3 offen sc1 lds
 s_waitcnt lgkmcnt(3)
 v_mfma_f32_32x32x16_bf16 v[64:79], a[52:55], v[52:55], v[64:79]
 ds_read_b128 v[36:39], v9 offset:16384
 s_waitcnt lgkmcnt(3)
 v_mfma_f32_32x32x16_bf16 v[64:79], a[56:59], v[56:59], v[64:79]
 ds_read_b128 v[40:43], v10 offset:16384
 s_waitcnt lgkmcnt(3)
 v_mfma_f32_32x32x16_bf16 v[64:79], a[60:63], v[60:63], v[64:79]
 ds_read_b128 v[44:47], v11 offset:16384
 s_add_u32 m0, s56, 58368
 s_add_u32 s3, s55, s66
 buffer_load_dwordx4 v24, s[4:7], s3 offen sc1 lds
 s_waitcnt lgkmcnt(3)
 v_mfma_f32_32x32x16_bf16 v[64:79], a[64:67], v[32:35], v[64:79]
 ds_read_b128 v[48:51], v12 offset:16384
 s_waitcnt lgkmcnt(3)
 v_mfma_f32_32x32x16_bf16 v[64:79], a[68:71], v[36:39], v[64:79]
 ds_read_b128 v[52:55], v13 offset:16384
 s_waitcnt lgkmcnt(3)
 v_mfma_f32_32x32x16_bf16 v[64:79], a[72:75], v[40:43], v[64:79]
 ds_read_b128 v[56:59], v14 offset:16384
 s_add_u32 m0, s56, 65536
 s_add_u32 s3, s55, s67
 buffer_load_dwordx4 v1, s[4:7], s3 offen sc1 lds
 s_waitcnt lgkmcnt(3)
 v_mfma_f32_32x32x16_bf16 v[64:79], a[76:79], v[44:47], v[64:79]
 ds_read_b128 v[60:63], v15 offset:16384
 s_waitcnt vmcnt(7)
 s_cmp_eq_u32 s61, 0
 s_cbranch_scc1 L_pf_39
 s_lshl_b32 s3, s61, 2
 s_add_u32 s3, s3, s59
 s_sub_u32 s3, s3, 4
 v_mov_b32 v3, 1
 s_mov_b64 exec, s[78:79]
 buffer_atomic_add v3, v30, s[4:7], s3 offen
 s_mov_b64 exec, -1
 s_mov_b32 s61, 0
L_pf_39:
 s_waitcnt lgkmcnt(3)
 v_mfma_f32_32x32x16_bf16 v[64:79], a[80:83], v[48:51], v[64:79]
 ds_read_b128 v[32:35], v8 offset:24576
 s_waitcnt lgkmcnt(3)
 v_mfma_f32_32x32x16_bf16 v[64:79], a[84:87], v[52:55], v[64:79]
 ds_read_b128 v[36:39], v9 offset:24576
 s_add_u32 m0, s56, 66560
 s_add_u32 s3, s55, s67
 buffer_load_dwordx4 v24, s[4:7], s3 offen sc1 lds
 s_waitcnt lgkmcnt(3)
 v_mfma_f32_32x32x16_bf16 v[64:79], a[88:91], v[56:59], v[64:79]
 ds_read_b128 v[40:43], v10 offset:24576
 s_waitcnt lgkmcnt(3)
 v_mfma_f32_32x32x16_bf16 v[64:79], a[92:95], v[60:63], v[64:79]
 ds_read_b128 v[44:47], v11 offset:24576
 s_waitcnt lgkmcnt(3)
 v_mfma_f32_32x32x16_bf16 v[64:79], a[96:99], v[32:35], v[64:79]
 ds_read_b128 v[48:51], v12 offset:24576
 s_add_u32 m0, s56, 73728
 s_add_u32 s3, s55, s68
 buffer_load_dwordx4 v1, s[4:7], s3 offen sc1 lds
 s_waitcnt lgkmcnt(3)
 v_mfma_f32_32x32x16_bf16 v[64:79], a[100:103], v[36:39], v[64:79]
 ds_read_b128 v[52:55], v13 offset:24576
 s_waitcnt lgkmcnt(3)
 v_mfma_f32_32x32x16_bf16 v[64:79], a[104:107], v[40:43], v[64:79]
 ds_read_b128 v[56:59], v14 offset:24576
 s_waitcnt lgkmcnt(3)
 v_mfma_f32_32x32x16_bf16 v[64:79], a[108:111], v[44:47], v[64:79]
 ds_read_b128 v[60:63], v15 offset:24576
 s_add_u32 m0, s56, 74752
 s_add_u32 s3, s55, s68
 buffer_load_dwordx4 v24, s[4:7], s3 offen sc1 lds
 s_waitcnt lgkmcnt(3)
 v_mfma_f32_32x32x16_bf16 v[64:79], a[112:115], v[48:51], v[64:79]
 ds_read_b128 v[32:35], v8 offset:32768
 s_waitcnt lgkmcnt(3)
 v_mfma_f32_32x32x16_bf16 v[64:79], a[116:119], v[52:55], v[64:79]
 ds_read_b128 v[36:39], v9 offset:32768
 s_waitcnt lgkmcnt(3)
 v_mfma_f32_32x32x16_bf16 v[64:79], a[120:123], v[56:59], v[64:79]
 ds_read_b128 v[40:43], v10 offset:32768
 s_waitcnt lgkmcnt(3)
 v_mfma_f32_32x32x16_bf16 v[64:79], a[124:127], v[60:63], v[64:79]
 ds_read_b128 v[44:47], v11 offset:32768
 s_waitcnt lgkmcnt(3)
 v_mfma_f32_32x32x16_bf16 v[64:79], a[128:131], v[32:35], v[64:79]
 ds_read_b128 v[48:51], v12 offset:32768
 s_waitcnt lgkmcnt(3)
 v_mfma_f32_32x32x16_bf16 v[64:79], a[132:135], v[36:39], v[64:79]
 ds_read_b128 v[52:55], v13 offset:32768
 s_waitcnt lgkmcnt(3)
 v_mfma_f32_32x32x16_bf16 v[64:79], a[136:139], v[40:43], v[64:79]
 ds_read_b128 v[56:59], v14 offset:32768
 s_waitcnt lgkmcnt(3)
 v_mfma_f32_32x32x16_bf16 v[64:79], a[140:143], v[44:47], v[64:79]
 ds_read_b128 v[60:63], v15 offset:32768
 s_waitcnt lgkmcnt(3)
 v_mfma_f32_32x32x16_bf16 v[64:79], a[144:147], v[48:51], v[64:79]
 s_waitcnt lgkmcnt(2)
 v_mfma_f32_32x32x16_bf16 v[64:79], a[148:151], v[52:55], v[64:79]
 s_waitcnt lgkmcnt(1)
 v_mfma_f32_32x32x16_bf16 v[64:79], a[152:155], v[56:59], v[64:79]
 s_waitcnt lgkmcnt(0)
 v_mfma_f32_32x32x16_bf16 v[64:79], a[156:159], v[60:63], v[64:79]
 s_lshl_b32 s3, s60, 19
 s_add_u32 s3, s3, s58
 s_xor_b32 s3, s3, s82
 s_nop 8
 v_cvt_pk_bf16_f32 v80, v64, v65
 v_cvt_pk_bf16_f32 v81, v66, v67
 v_cvt_pk_bf16_f32 v82, v72, v73
 v_cvt_pk_bf16_f32 v83, v74, v75
 buffer_store_dwordx4 v[80:83], v4, s[4:7], s3 offen offset:0 sc1
 v_cvt_pk_bf16_f32 v84, v68, v69
 v_cvt_pk_bf16_f32 v85, v70, v71
 v_cvt_pk_bf16_f32 v86, v76, v77
 v_cvt_pk_bf16_f32 v87, v78, v79
 buffer_store_dwordx4 v[84:87], v4, s[4:7], s3 offen offset:512 sc1
 s_mov_b32 s61, s54
 s_cmp_lg_u32 s54, 1
 s_cbranch_scc1 L_f1_40
 s_waitcnt vmcnt(0)
 s_cmp_eq_u32 s61, 0
 s_cbranch_scc1 L_pf_41
 s_lshl_b32 s3, s61, 2
 s_add_u32 s3, s3, s59
 s_sub_u32 s3, s3, 4
 v_mov_b32 v3, 1
 s_mov_b64 exec, s[78:79]
 buffer_atomic_add v3, v30, s[4:7], s3 offen
 s_mov_b64 exec, -1
 s_mov_b32 s61, 0
L_pf_41:
 s_mov_b32 s8, s38
 s_and_b32 s9, s39, 0xffff
 s_mov_b32 s10, 2621440
 s_mov_b32 s11, 0x00020000
 s_mov_b32 s12, s40
 s_and_b32 s13, s41, 0xffff
 s_mov_b32 s14, 1280
 s_mov_b32 s15, 0x00020000
 v_lshlrev_b32 v130, 4, v0
 s_lshl_b32 s73, s70, 12
 s_add_u32 s74, s73, 2
 buffer_load_dwordx4 v[96:99], v130, s[8:11], s73 offen offset:0
 buffer_load_dwordx4 v[100:103], v130, s[8:11], s73 offen offset:1024
 buffer_load_dwordx4 v[112:115], v130, s[8:11], s74 offen offset:0
 buffer_load_dwordx4 v[116:119], v130, s[8:11], s74 offen offset:1024
 s_lshl_b32 s3, s70, 1
 buffer_load_ushort v128, off, s[12:15], s3
 s_branch L_f2_42
L_f1_40:
 s_waitcnt vmcnt(2)
L_f2_42:
 s_barrier
 s_mov_b32 s60, s54
 s_add_u32 s54, s54, 1
 s_mul_i32 s55, s54, 40960
 s_mul_i32 s3, s50, 10240
 s_add_u32 s55, s55, s3
 s_add_u32 s55, s55, 226492416
 ds_read_b128 v[32:35], v16 offset:0
 ds_read_b128 v[36:39], v17 offset:0
 ds_read_b128 v[40:43], v18 offset:0
 ds_read_b128 v[44:47], v19 offset:0
 s_waitcnt lgkmcnt(3)
 v_mfma_f32_32x32x16_bf16 v[64:79], a[0:3], v[32:35], 0
 ds_read_b128 v[48:51], v20 offset:0
 s_add_u32 m0, s56, 0
 s_add_u32 s3, s55, s64
 buffer_load_dwordx4 v1, s[4:7], s3 offen sc1 lds
 s_waitcnt lgkmcnt(3)
 v_mfma_f32_32x32x16_bf16 v[64:79], a[4:7], v[36:39], v[64:79]
 ds_read_b128 v[52:55], v21 offset:0
 s_waitcnt lgkmcnt(3)
 v_mfma_f32_32x32x16_bf16 v[64:79], a[8:11], v[40:43], v[64:79]
 ds_read_b128 v[56:59], v22 offset:0
 s_waitcnt lgkmcnt(3)
 v_mfma_f32_32x32x16_bf16 v[64:79], a[12:15], v[44:47], v[64:79]
 ds_read_b128 v[60:63], v23 offset:0
 s_add_u32 m0, s56, 1024
 s_add_u32 s3, s55, s64
 buffer_load_dwordx4 v24, s[4:7], s3 offen sc1 lds
 s_waitcnt lgkmcnt(3)
 v_mfma_f32_32x32x16_bf16 v[64:79], a[16:19], v[48:51], v[64:79]
 ds_read_b128 v[32:35], v16 offset:8192
 s_waitcnt lgkmcnt(3)
 v_mfma_f32_32x32x16_bf16 v[64:79], a[20:23], v[52:55], v[64:79]
 ds_read_b128 v[36:39], v17 offset:8192
 s_waitcnt lgkmcnt(3)
 v_mfma_f32_32x32x16_bf16 v[64:79], a[24:27], v[56:59], v[64:79]
 ds_read_b128 v[40:43], v18 offset:8192
 s_add_u32 m0, s56, 8192
 s_add_u32 s3, s55, s65
 buffer_load_dwordx4 v1, s[4:7], s3 offen sc1 lds
 s_waitcnt lgkmcnt(3)
 v_mfma_f32_32x32x16_bf16 v[64:79], a[28:31], v[60:63], v[64:79]
 ds_read_b128 v[44:47], v19 offset:8192
 s_waitcnt lgkmcnt(3)
 v_mfma_f32_32x32x16_bf16 v[64:79], a[32:35], v[32:35], v[64:79]
 ds_read_b128 v[48:51], v20 offset:8192
 s_waitcnt lgkmcnt(3)
 v_mfma_f32_32x32x16_bf16 v[64:79], a[36:39], v[36:39], v[64:79]
 ds_read_b128 v[52:55], v21 offset:8192
 s_add_u32 m0, s56, 9216
 s_add_u32 s3, s55, s65
 buffer_load_dwordx4 v24, s[4:7], s3 offen sc1 lds
 s_waitcnt lgkmcnt(3)
 v_mfma_f32_32x32x16_bf16 v[64:79], a[40:43], v[40:43], v[64:79]
 ds_read_b128 v[56:59], v22 offset:8192
 s_waitcnt lgkmcnt(3)
 v_mfma_f32_32x32x16_bf16 v[64:79], a[44:47], v[44:47], v[64:79]
 ds_read_b128 v[60:63], v23 offset:8192
 s_waitcnt lgkmcnt(3)
 v_mfma_f32_32x32x16_bf16 v[64:79], a[48:51], v[48:51], v[64:79]
 ds_read_b128 v[32:35], v16 offset:16384
 s_add_u32 m0, s56, 16384
 s_add_u32 s3, s55, s66
 buffer_load_dwordx4 v1, s[4:7], s3 offen sc1 lds
 s_waitcnt lgkmcnt(3)
 v_mfma_f32_32x32x16_bf16 v[64:79], a[52:55], v[52:55], v[64:79]
 ds_read_b128 v[36:39], v17 offset:16384
 s_waitcnt lgkmcnt(3)
 v_mfma_f32_32x32x16_bf16 v[64:79], a[56:59], v[56:59], v[64:79]
 ds_read_b128 v[40:43], v18 offset:16384
 s_waitcnt lgkmcnt(3)
 v_mfma_f32_32x32x16_bf16 v[64:79], a[60:63], v[60:63], v[64:79]
 ds_read_b128 v[44:47], v19 offset:16384
 s_add_u32 m0, s56, 17408
 s_add_u32 s3, s55, s66
 buffer_load_dwordx4 v24, s[4:7], s3 offen sc1 lds
 s_waitcnt lgkmcnt(3)
 v_mfma_f32_32x32x16_bf16 v[64:79], a[64:67], v[32:35], v[64:79]
 ds_read_b128 v[48:51], v20 offset:16384
 s_waitcnt lgkmcnt(3)
 v_mfma_f32_32x32x16_bf16 v[64:79], a[68:71], v[36:39], v[64:79]
 ds_read_b128 v[52:55], v21 offset:16384
 s_waitcnt lgkmcnt(3)
 v_mfma_f32_32x32x16_bf16 v[64:79], a[72:75], v[40:43], v[64:79]
 ds_read_b128 v[56:59], v22 offset:16384
 s_add_u32 m0, s56, 24576
 s_add_u32 s3, s55, s67
 buffer_load_dwordx4 v1, s[4:7], s3 offen sc1 lds
 s_waitcnt lgkmcnt(3)
 v_mfma_f32_32x32x16_bf16 v[64:79], a[76:79], v[44:47], v[64:79]
 ds_read_b128 v[60:63], v23 offset:16384
 s_waitcnt vmcnt(7)
 s_cmp_eq_u32 s61, 0
 s_cbranch_scc1 L_pf_43
 s_lshl_b32 s3, s61, 2
 s_add_u32 s3, s3, s59
 s_sub_u32 s3, s3, 4
 v_mov_b32 v3, 1
 s_mov_b64 exec, s[78:79]
 buffer_atomic_add v3, v30, s[4:7], s3 offen
 s_mov_b64 exec, -1
 s_mov_b32 s61, 0
L_pf_43:
 s_waitcnt lgkmcnt(3)
 v_mfma_f32_32x32x16_bf16 v[64:79], a[80:83], v[48:51], v[64:79]
 ds_read_b128 v[32:35], v16 offset:24576
 s_waitcnt lgkmcnt(3)
 v_mfma_f32_32x32x16_bf16 v[64:79], a[84:87], v[52:55], v[64:79]
 ds_read_b128 v[36:39], v17 offset:24576
 s_add_u32 m0, s56, 25600
 s_add_u32 s3, s55, s67
 buffer_load_dwordx4 v24, s[4:7], s3 offen sc1 lds
 s_waitcnt lgkmcnt(3)
 v_mfma_f32_32x32x16_bf16 v[64:79], a[88:91], v[56:59], v[64:79]
 ds_read_b128 v[40:43], v18 offset:24576
 s_waitcnt lgkmcnt(3)
 v_mfma_f32_32x32x16_bf16 v[64:79], a[92:95], v[60:63], v[64:79]
 ds_read_b128 v[44:47], v19 offset:24576
 s_waitcnt lgkmcnt(3)
 v_mfma_f32_32x32x16_bf16 v[64:79], a[96:99], v[32:35], v[64:79]
 ds_read_b128 v[48:51], v20 offset:24576
 s_add_u32 m0, s56, 32768
 s_add_u32 s3, s55, s68
 buffer_load_dwordx4 v1, s[4:7], s3 offen sc1 lds
 s_waitcnt lgkmcnt(3)
 v_mfma_f32_32x32x16_bf16 v[64:79], a[100:103], v[36:39], v[64:79]
 ds_read_b128 v[52:55], v21 offset:24576
 s_waitcnt lgkmcnt(3)
 v_mfma_f32_32x32x16_bf16 v[64:79], a[104:107], v[40:43], v[64:79]
 ds_read_b128 v[56:59], v22 offset:24576
 s_waitcnt lgkmcnt(3)
 v_mfma_f32_32x32x16_bf16 v[64:79], a[108:111], v[44:47], v[64:79]
 ds_read_b128 v[60:63], v23 offset:24576
 s_add_u32 m0, s56, 33792
 s_add_u32 s3, s55, s68
 buffer_load_dwordx4 v24, s[4:7], s3 offen sc1 lds
 s_waitcnt lgkmcnt(3)
 v_mfma_f32_32x32x16_bf16 v[64:79], a[112:115], v[48:51], v[64:79]
 ds_read_b128 v[32:35], v16 offset:32768
 s_waitcnt lgkmcnt(3)
 v_mfma_f32_32x32x16_bf16 v[64:79], a[116:119], v[52:55], v[64:79]
 ds_read_b128 v[36:39], v17 offset:32768
 s_waitcnt lgkmcnt(3)
 v_mfma_f32_32x32x16_bf16 v[64:79], a[120:123], v[56:59], v[64:79]
 ds_read_b128 v[40:43], v18 offset:32768
 s_waitcnt lgkmcnt(3)
 v_mfma_f32_32x32x16_bf16 v[64:79], a[124:127], v[60:63], v[64:79]
 ds_read_b128 v[44:47], v19 offset:32768
 s_waitcnt lgkmcnt(3)
 v_mfma_f32_32x32x16_bf16 v[64:79], a[128:131], v[32:35], v[64:79]
 ds_read_b128 v[48:51], v20 offset:32768
 s_waitcnt lgkmcnt(3)
 v_mfma_f32_32x32x16_bf16 v[64:79], a[132:135], v[36:39], v[64:79]
 ds_read_b128 v[52:55], v21 offset:32768
 s_waitcnt lgkmcnt(3)
 v_mfma_f32_32x32x16_bf16 v[64:79], a[136:139], v[40:43], v[64:79]
 ds_read_b128 v[56:59], v22 offset:32768
 s_waitcnt lgkmcnt(3)
 v_mfma_f32_32x32x16_bf16 v[64:79], a[140:143], v[44:47], v[64:79]
 ds_read_b128 v[60:63], v23 offset:32768
 s_waitcnt lgkmcnt(3)
 v_mfma_f32_32x32x16_bf16 v[64:79], a[144:147], v[48:51], v[64:79]
 s_waitcnt lgkmcnt(2)
 v_mfma_f32_32x32x16_bf16 v[64:79], a[148:151], v[52:55], v[64:79]
 s_waitcnt lgkmcnt(1)
 v_mfma_f32_32x32x16_bf16 v[64:79], a[152:155], v[56:59], v[64:79]
 s_waitcnt lgkmcnt(0)
 v_mfma_f32_32x32x16_bf16 v[64:79], a[156:159], v[60:63], v[64:79]
 s_lshl_b32 s3, s60, 19
 s_add_u32 s3, s3, s58
 s_xor_b32 s3, s3, s82
 s_nop 8
 v_cvt_pk_bf16_f32 v88, v64, v65
 v_cvt_pk_bf16_f32 v89, v66, v67
 v_cvt_pk_bf16_f32 v90, v72, v73
 v_cvt_pk_bf16_f32 v91, v74, v75
 buffer_store_dwordx4 v[88:91], v4, s[4:7], s3 offen offset:0 sc1
 v_cvt_pk_bf16_f32 v92, v68, v69
 v_cvt_pk_bf16_f32 v93, v70, v71
 v_cvt_pk_bf16_f32 v94, v76, v77
 v_cvt_pk_bf16_f32 v95, v78, v79
 buffer_store_dwordx4 v[92:95], v4, s[4:7], s3 offen offset:512 sc1
 s_mov_b32 s61, s54
 s_waitcnt vmcnt(2)
 s_cmp_lg_u32 s54, 4
 s_cbranch_scc1 L_cv_44
 s_waitcnt vmcnt(0)
 s_cmp_eq_u32 s61, 0
 s_cbranch_scc1 L_pf_45
 s_lshl_b32 s3, s61, 2
 s_add_u32 s3, s3, s59
 s_sub_u32 s3, s3, 4
 v_mov_b32 v3, 1
 s_mov_b64 exec, s[78:79]
 buffer_atomic_add v3, v30, s[4:7], s3 offen
 s_mov_b64 exec, -1
 s_mov_b32 s61, 0
L_pf_45:
 s_mul_i32 s71, s50, 13312
 s_add_u32 s71, s71, 81920
 s_mov_b32 s70, s75
 s_mov_b32 s69, 640
 s_getpc_b64 s[76:77]
L_ca_46:
 s_add_u32 s76, s76, L_conv0-L_ca_46
 s_addc_u32 s77, s77, -1
 s_swappc_b64 s[76:77], s[76:77]
 s_waitcnt vmcnt(0)
 s_barrier
 s_cmp_lg_u32 s50, 3
 s_cbranch_scc1 L_ar_47
 s_mov_b32 s96, s44
 s_and_b32 s97, s45, 0xffff
 s_mov_b32 s98, 256
 s_mov_b32 s99, 0x00020000
 v_mov_b32 v1, 1
 s_mov_b64 exec, 1
 buffer_atomic_add v1, off, s[96:99], 0 offset:8 sc0
 s_waitcnt vmcnt(0)
 v_cmp_eq_u32 vcc, 159, v1
 s_cbranch_vccz L_aw_48
 buffer_store_dword v1, off, s[96:99], 0 offset:136 sc1
L_aw_48:
 s_mov_b64 exec, -1
L_ar_47:
 v_lshrrev_b32 v1, 4, v0
 s_mov_b32 s3, 1280
 v_mul_lo_u32 v1, v1, s3
 v_and_b32 v3, 15, v0
 v_lshl_add_u32 v1, v3, 4, v1
 v_add_u32 v6, 5120, v1
 v_mov_b32 v24, v6
 v_and_b32 v2, 31, v0
 v_lshlrev_b32 v2, 8, v2
 v_lshrrev_b32 v4, 5, v0
 v_xor_b32 v4, v4, v3
 v_xor_b32 v8, 0, v4
 v_lshl_add_u32 v8, v8, 4, v2
 v_add_u32 v16, 40960, v8
 v_xor_b32 v9, 2, v4
 v_lshl_add_u32 v9, v9, 4, v2
 v_add_u32 v17, 40960, v9
 v_xor_b32 v10, 4, v4
 v_lshl_add_u32 v10, v10, 4, v2
 v_add_u32 v18, 40960, v10
 v_xor_b32 v11, 6, v4
 v_lshl_add_u32 v11, v11, 4, v2
 v_add_u32 v19, 40960, v11
 v_xor_b32 v12, 8, v4
 v_lshl_add_u32 v12, v12, 4, v2
 v_add_u32 v20, 40960, v12
 v_xor_b32 v13, 10, v4
 v_lshl_add_u32 v13, v13, 4, v2
 v_add_u32 v21, 40960, v13
 v_xor_b32 v14, 12, v4
 v_lshl_add_u32 v14, v14, 4, v2
 v_add_u32 v22, 40960, v14
 v_xor_b32 v15, 14, v4
 v_lshl_add_u32 v15, v15, 4, v2
 v_add_u32 v23, 40960, v15
 v_lshrrev_b32 v4, 5, v0
 v_lshlrev_b32 v4, 8, v4
 v_lshl_add_u32 v4, v3, 4, v4
 v_and_b32 v2, 16, v0
 v_lshl_add_u32 v4, v2, 8, v4
 s_lshl_b32 s3, s50, 10
 v_add_u32 v4, s3, v4
 v_mul_u32_u24 v5, 24576, v0
 v_mov_b32 v7, 163776
 v_mul_u32_u24 v30, 16384, v0
L_cv_44:
 s_cmp_lg_u32 s54, 10
 s_cbranch_scc1 L_cb_49
 s_cmp_lg_u32 s50, 0
 s_cbranch_scc1 L_ww_50
 s_mov_b32 s96, s44
 s_and_b32 s97, s45, 0xffff
 s_mov_b32 s98, 256
 s_mov_b32 s99, 0x00020000
 v_mov_b32 v25, 200
 s_mov_b32 s51, 0
 s_mov_b64 exec, 1
L_wb_51:
 buffer_load_dword v26, v25, s[96:99], 0 offen sc1
 s_waitcnt vmcnt(0)
 v_cmp_eq_u32 vcc, 0, v26
 s_cbranch_vccz L_wbd_52
 s_sleep 2
 s_add_u32 s51, s51, 1
 s_cmp_lt_u32 s51, 131072
 s_cbranch_scc1 L_wb_51
 s_branch L_bail
L_wbd_52:
 s_mov_b64 exec, -1
L_ww_50:
 s_barrier
L_cb_49:
 s_cmp_lt_u32 s54, 16
 s_cbranch_scc1 L_qkvq_pre
 s_waitcnt vmcnt(0)
 s_cmp_eq_u32 s61, 0
 s_cbranch_scc1 L_pf_54
 s_lshl_b32 s3, s61, 2
 s_add_u32 s3, s3, s59
 s_sub_u32 s3, s3, 4
 v_mov_b32 v3, 1
 s_mov_b64 exec, s[78:79]
 buffer_atomic_add v3, v30, s[4:7], s3 offen
 s_mov_b64 exec, -1
 s_mov_b32 s61, 0
L_pf_54:
 s_lshl_b32 s62, s62, 8
 s_add_u32 s62, s62, 126976
 s_add_u32 s63, s59, 8128
L_qkvq_block:
 s_lshl_b32 s55, s54, 2
 s_add_u32 s55, s55, s62
 s_sub_u32 s55, s55, 64
 s_cmp_lg_u32 s50, 0
 s_cselect_b32 s3, 268435456, s55
 v_mov_b32 v6, 8
 s_mov_b64 exec, 15
 v_mov_b32 v6, 0
 buffer_atomic_add v6, v5, s[4:7], s3 offen sc0
 s_mov_b64 exec, -1
 s_waitcnt vmcnt(0)
 s_cmp_eq_u32 s61, 0
 s_cbranch_scc1 L_pf_57
 s_lshl_b32 s3, s61, 2
 s_add_u32 s3, s3, s59
 s_sub_u32 s3, s3, 4
 v_mov_b32 v3, 1
 s_mov_b64 exec, s[78:79]
 buffer_atomic_add v3, v30, s[4:7], s3 offen
 s_mov_b64 exec, -1
 s_mov_b32 s61, 0
L_pf_57:
 s_cmp_lg_u32 s50, 0
 s_cbranch_scc1 L_w_55
 v_cmp_gt_u32 vcc, 8, v6
 s_cbranch_vccz L_w_55
 s_mov_b32 s51, 0
 s_mov_b64 exec, 15
 v_mov_b32 v28, 0
 buffer_atomic_add v28, v5, s[4:7], s55 offen sc0
 s_sleep 5
L_wc_58:
 v_mov_b32 v29, 0
 buffer_atomic_add v29, v5, s[4:7], s55 offen sc0
 s_waitcnt vmcnt(1)
 v_cmp_gt_u32 vcc, 8, v28
 s_cbranch_vccz L_wcd_59
 v_mov_b32 v28, 0
 buffer_atomic_add v28, v5, s[4:7], s55 offen sc0
 s_waitcnt vmcnt(1)
 v_cmp_gt_u32 vcc, 8, v29
 s_cbranch_vccz L_wcd_59
 s_add_u32 s51, s51, 1
 s_cmp_lt_u32 s51, 131072
 s_cbranch_scc1 L_wc_58
 s_branch L_bail
L_wcd_59:
 s_mov_b64 exec, -1
L_w_55:
 s_barrier
 s_branch L_qkvq_loop
L_qkvq_fast:
 s_cmp_lg_u32 s54, 32
 s_cbranch_scc1 L_c2_61
 s_cmp_lg_u32 s50, 0
 s_cbranch_scc1 L_ww_62
 s_mov_b32 s96, s44
 s_and_b32 s97, s45, 0xffff
 s_mov_b32 s98, 256
 s_mov_b32 s99, 0x00020000
 v_mov_b32 v25, 140
 s_mov_b32 s51, 0
 s_mov_b64 exec, 1
L_wb_63:
 buffer_load_dword v26, v25, s[96:99], 0 offen sc1
 s_waitcnt vmcnt(0)
 v_cmp_eq_u32 vcc, 0, v26
 s_cbranch_vccz L_wbd_64
 s_sleep 2
 s_add_u32 s51, s51, 1
 s_cmp_lt_u32 s51, 131072
 s_cbranch_scc1 L_wb_63
 s_branch L_bail
L_wbd_64:
 s_mov_b64 exec, -1
L_ww_62:
 s_barrier
L_c2_61:
 s_sub_u32 s60, s54, 16
 s_lshl_b32 s70, s54, 2
 s_add_u32 s70, s70, s62
 s_sub_u32 s70, s70, 60
 s_cmp_lg_u32 s50, 0
 s_cselect_b32 s70, 268435456, s70
 s_min_u32 s51, s54, 63
 s_mul_i32 s55, s51, 40960
 s_mul_i32 s3, s50, 10240
 s_add_u32 s55, s55, s3
 s_add_u32 s55, s55, 226492416
 ds_read_b128 v[32:35], v16 offset:0
 ds_read_b128 v[36:39], v17 offset:0
 ds_read_b128 v[40:43], v18 offset:0
 ds_read_b128 v[44:47], v19 offset:0
 s_waitcnt lgkmcnt(3)
 v_mfma_f32_32x32x16_bf16 v[64:79], a[0:3], v[32:35], 0
 ds_read_b128 v[48:51], v20 offset:0
 s_add_u32 m0, s56, 0
 s_add_u32 s3, s55, s64
 buffer_load_dwordx4 v1, s[4:7], s3 offen sc1 lds
 s_waitcnt lgkmcnt(3)
 v_mfma_f32_32x32x16_bf16 v[64:79], a[4:7], v[36:39], v[64:79]
 ds_read_b128 v[52:55], v21 offset:0
 s_waitcnt lgkmcnt(3)
 v_mfma_f32_32x32x16_bf16 v[64:79], a[8:11], v[40:43], v[64:79]
 ds_read_b128 v[56:59], v22 offset:0
 s_waitcnt lgkmcnt(3)
 v_mfma_f32_32x32x16_bf16 v[64:79], a[12:15], v[44:47], v[64:79]
 ds_read_b128 v[60:63], v23 offset:0
 s_add_u32 m0, s56, 1024
 s_add_u32 s3, s55, s64
 buffer_load_dwordx4 v24, s[4:7], s3 offen sc1 lds
 s_waitcnt lgkmcnt(3)
 v_mfma_f32_32x32x16_bf16 v[64:79], a[16:19], v[48:51], v[64:79]
 ds_read_b128 v[32:35], v16 offset:8192
 s_waitcnt lgkmcnt(3)
 v_mfma_f32_32x32x16_bf16 v[64:79], a[20:23], v[52:55], v[64:79]
 ds_read_b128 v[36:39], v17 offset:8192
 s_waitcnt lgkmcnt(3)
 v_mfma_f32_32x32x16_bf16 v[64:79], a[24:27], v[56:59], v[64:79]
 ds_read_b128 v[40:43], v18 offset:8192
 s_add_u32 m0, s56, 8192
 s_add_u32 s3, s55, s65
 buffer_load_dwordx4 v1, s[4:7], s3 offen sc1 lds
 s_waitcnt lgkmcnt(3)
 v_mfma_f32_32x32x16_bf16 v[64:79], a[28:31], v[60:63], v[64:79]
 ds_read_b128 v[44:47], v19 offset:8192
 s_waitcnt lgkmcnt(3)
 v_mfma_f32_32x32x16_bf16 v[64:79], a[32:35], v[32:35], v[64:79]
 ds_read_b128 v[48:51], v20 offset:8192
 s_waitcnt lgkmcnt(3)
 v_mfma_f32_32x32x16_bf16 v[64:79], a[36:39], v[36:39], v[64:79]
 ds_read_b128 v[52:55], v21 offset:8192
 s_add_u32 m0, s56, 9216
 s_add_u32 s3, s55, s65
 buffer_load_dwordx4 v24, s[4:7], s3 offen sc1 lds
 s_waitcnt lgkmcnt(3)
 v_mfma_f32_32x32x16_bf16 v[64:79], a[40:43], v[40:43], v[64:79]
 ds_read_b128 v[56:59], v22 offset:8192
 s_waitcnt lgkmcnt(3)
 v_mfma_f32_32x32x16_bf16 v[64:79], a[44:47], v[44:47], v[64:79]
 ds_read_b128 v[60:63], v23 offset:8192
 s_waitcnt lgkmcnt(3)
 v_mfma_f32_32x32x16_bf16 v[64:79], a[48:51], v[48:51], v[64:79]
 ds_read_b128 v[32:35], v16 offset:16384
 s_add_u32 m0, s56, 16384
 s_add_u32 s3, s55, s66
 buffer_load_dwordx4 v1, s[4:7], s3 offen sc1 lds
 s_waitcnt lgkmcnt(3)
 v_mfma_f32_32x32x16_bf16 v[64:79], a[52:55], v[52:55], v[64:79]
 ds_read_b128 v[36:39], v17 offset:16384
 s_waitcnt lgkmcnt(3)
 v_mfma_f32_32x32x16_bf16 v[64:79], a[56:59], v[56:59], v[64:79]
 ds_read_b128 v[40:43], v18 offset:16384
 s_waitcnt lgkmcnt(3)
 v_mfma_f32_32x32x16_bf16 v[64:79], a[60:63], v[60:63], v[64:79]
 ds_read_b128 v[44:47], v19 offset:16384
 s_add_u32 m0, s56, 17408
 s_add_u32 s3, s55, s66
 buffer_load_dwordx4 v24, s[4:7], s3 offen sc1 lds
 s_waitcnt lgkmcnt(3)
 v_mfma_f32_32x32x16_bf16 v[64:79], a[64:67], v[32:35], v[64:79]
 ds_read_b128 v[48:51], v20 offset:16384
 s_waitcnt lgkmcnt(3)
 v_mfma_f32_32x32x16_bf16 v[64:79], a[68:71], v[36:39], v[64:79]
 ds_read_b128 v[52:55], v21 offset:16384
 s_waitcnt lgkmcnt(3)
 v_mfma_f32_32x32x16_bf16 v[64:79], a[72:75], v[40:43], v[64:79]
 ds_read_b128 v[56:59], v22 offset:16384
 s_add_u32 m0, s56, 24576
 s_add_u32 s3, s55, s67
 buffer_load_dwordx4 v1, s[4:7], s3 offen sc1 lds
 s_waitcnt lgkmcnt(3)
 v_mfma_f32_32x32x16_bf16 v[64:79], a[76:79], v[44:47], v[64:79]
 ds_read_b128 v[60:63], v23 offset:16384
 s_waitcnt lgkmcnt(3)
 v_mfma_f32_32x32x16_bf16 v[64:79], a[80:83], v[48:51], v[64:79]
 ds_read_b128 v[32:35], v16 offset:24576
 s_waitcnt lgkmcnt(3)
 v_mfma_f32_32x32x16_bf16 v[64:79], a[84:87], v[52:55], v[64:79]
 ds_read_b128 v[36:39], v17 offset:24576
 s_add_u32 m0, s56, 25600
 s_add_u32 s3, s55, s67
 buffer_load_dwordx4 v24, s[4:7], s3 offen sc1 lds
 s_waitcnt lgkmcnt(3)
 v_mfma_f32_32x32x16_bf16 v[64:79], a[88:91], v[56:59], v[64:79]
 ds_read_b128 v[40:43], v18 offset:24576
 s_waitcnt lgkmcnt(3)
 v_mfma_f32_32x32x16_bf16 v[64:79], a[92:95], v[60:63], v[64:79]
 ds_read_b128 v[44:47], v19 offset:24576
 s_waitcnt lgkmcnt(3)
 v_mfma_f32_32x32x16_bf16 v[64:79], a[96:99], v[32:35], v[64:79]
 ds_read_b128 v[48:51], v20 offset:24576
 s_add_u32 m0, s56, 32768
 s_add_u32 s3, s55, s68
 buffer_load_dwordx4 v1, s[4:7], s3 offen sc1 lds
 s_waitcnt lgkmcnt(3)
 v_mfma_f32_32x32x16_bf16 v[64:79], a[100:103], v[36:39], v[64:79]
 ds_read_b128 v[52:55], v21 offset:24576
 s_waitcnt lgkmcnt(3)
 v_mfma_f32_32x32x16_bf16 v[64:79], a[104:107], v[40:43], v[64:79]
 ds_read_b128 v[56:59], v22 offset:24576
 s_waitcnt lgkmcnt(3)
 v_mfma_f32_32x32x16_bf16 v[64:79], a[108:111], v[44:47], v[64:79]
 ds_read_b128 v[60:63], v23 offset:24576
 s_add_u32 m0, s56, 33792
 s_add_u32 s3, s55, s68
 buffer_load_dwordx4 v24, s[4:7], s3 offen sc1 lds
 s_waitcnt lgkmcnt(3)
 v_mfma_f32_32x32x16_bf16 v[64:79], a[112:115], v[48:51], v[64:79]
 ds_read_b128 v[32:35], v16 offset:32768
 s_waitcnt lgkmcnt(3)
 v_mfma_f32_32x32x16_bf16 v[64:79], a[116:119], v[52:55], v[64:79]
 ds_read_b128 v[36:39], v17 offset:32768
 v_mov_b32 v6, 8
 s_mov_b64 exec, 15
 v_mov_b32 v6, 0
 buffer_atomic_add v6, v5, s[4:7], s70 offen sc0
 s_mov_b64 exec, -1
 s_waitcnt lgkmcnt(3)
 v_mfma_f32_32x32x16_bf16 v[64:79], a[120:123], v[56:59], v[64:79]
 ds_read_b128 v[40:43], v18 offset:32768
 s_waitcnt lgkmcnt(3)
 v_mfma_f32_32x32x16_bf16 v[64:79], a[124:127], v[60:63], v[64:79]
 ds_read_b128 v[44:47], v19 offset:32768
 s_waitcnt lgkmcnt(3)
 v_mfma_f32_32x32x16_bf16 v[64:79], a[128:131], v[32:35], v[64:79]
 ds_read_b128 v[48:51], v20 offset:32768
 s_waitcnt lgkmcnt(3)
 v_mfma_f32_32x32x16_bf16 v[64:79], a[132:135], v[36:39], v[64:79]
 ds_read_b128 v[52:55], v21 offset:32768
 s_waitcnt lgkmcnt(3)
 v_mfma_f32_32x32x16_bf16 v[64:79], a[136:139], v[40:43], v[64:79]
 ds_read_b128 v[56:59], v22 offset:32768
 s_waitcnt lgkmcnt(3)
 v_mfma_f32_32x32x16_bf16 v[64:79], a[140:143], v[44:47], v[64:79]
 ds_read_b128 v[60:63], v23 offset:32768
 s_waitcnt lgkmcnt(3)
 v_mfma_f32_32x32x16_bf16 v[64:79], a[144:147], v[48:51], v[64:79]
 s_waitcnt lgkmcnt(2)
 v_mfma_f32_32x32x16_bf16 v[64:79], a[148:151], v[52:55], v[64:79]
 s_waitcnt lgkmcnt(1)
 v_mfma_f32_32x32x16_bf16 v[64:79], a[152:155], v[56:59], v[64:79]
 s_waitcnt lgkmcnt(0)
 v_mfma_f32_32x32x16_bf16 v[64:79], a[156:159], v[60:63], v[64:79]
 s_lshl_b32 s3, s60, 19
 s_add_u32 s3, s3, s58
 s_xor_b32 s3, s3, s82
 s_add_u32 s3, s3, 33554432
 s_nop 8
 v_cvt_pk_bf16_f32 v88, v64, v65
 v_cvt_pk_bf16_f32 v89, v66, v67
 v_cvt_pk_bf16_f32 v90, v72, v73
 v_cvt_pk_bf16_f32 v91, v74, v75
 buffer_store_dwordx4 v[88:91], v4, s[4:7], s3 offen offset:0 sc1
 v_cvt_pk_bf16_f32 v92, v68, v69
 v_cvt_pk_bf16_f32 v93, v70, v71
 v_cvt_pk_bf16_f32 v94, v76, v77
 v_cvt_pk_bf16_f32 v95, v78, v79
 buffer_store_dwordx4 v[92:95], v4, s[4:7], s3 offen offset:512 sc1
 s_branch L_qkvq_mid
L_qkvq_loop:
 s_cmp_lg_u32 s54, 32
 s_cbranch_scc1 L_c2_65
 s_cmp_lg_u32 s50, 0
 s_cbranch_scc1 L_ww_66
 s_mov_b32 s96, s44
 s_and_b32 s97, s45, 0xffff
 s_mov_b32 s98, 256
 s_mov_b32 s99, 0x00020000
 v_mov_b32 v25, 140
 s_mov_b32 s51, 0
 s_mov_b64 exec, 1
L_wb_67:
 buffer_load_dword v26, v25, s[96:99], 0 offen sc1
 s_waitcnt vmcnt(0)
 v_cmp_eq_u32 vcc, 0, v26
 s_cbranch_vccz L_wbd_68
 s_sleep 2
 s_add_u32 s51, s51, 1
 s_cmp_lt_u32 s51, 131072
 s_cbranch_scc1 L_wb_67
 s_branch L_bail
L_wbd_68:
 s_mov_b64 exec, -1
L_ww_66:
 s_barrier
L_c2_65:
 s_sub_u32 s60, s54, 16
 s_mul_i32 s55, s60, 40960
 s_mul_i32 s3, s50, 10240
 s_add_u32 s55, s55, s3
 s_add_u32 s55, s55, 229113856
 s_add_u32 m0, s56, 40960
 s_add_u32 s3, s55, s64
 buffer_load_dwordx4 v1, s[4:7], s3 offen sc1 lds
 s_add_u32 m0, s56, 41984
 s_add_u32 s3, s55, s64
 buffer_load_dwordx4 v24, s[4:7], s3 offen sc1 lds
 s_add_u32 m0, s56, 49152
 s_add_u32 s3, s55, s65
 buffer_load_dwordx4 v1, s[4:7], s3 offen sc1 lds
 s_add_u32 m0, s56, 50176
 s_add_u32 s3, s55, s65
 buffer_load_dwordx4 v24, s[4:7], s3 offen sc1 lds
 s_add_u32 m0, s56, 57344
 s_add_u32 s3, s55, s66
 buffer_load_dwordx4 v1, s[4:7], s3 offen sc1 lds
 s_add_u32 m0, s56, 58368
 s_add_u32 s3, s55, s66
 buffer_load_dwordx4 v24, s[4:7], s3 offen sc1 lds
 s_add_u32 m0, s56, 65536
 s_add_u32 s3, s55, s67
 buffer_load_dwordx4 v1, s[4:7], s3 offen sc1 lds
 s_add_u32 m0, s56, 66560
 s_add_u32 s3, s55, s67
 buffer_load_dwordx4 v24, s[4:7], s3 offen sc1 lds
 s_add_u32 m0, s56, 73728
 s_add_u32 s3, s55, s68
 buffer_load_dwordx4 v1, s[4:7], s3 offen sc1 lds
 s_add_u32 m0, s56, 74752
 s_add_u32 s3, s55, s68
 buffer_load_dwordx4 v24, s[4:7], s3 offen sc1 lds
 s_lshl_b32 s70, s54, 2
 s_add_u32 s70, s70, s62
 s_sub_u32 s70, s70, 60
 s_cmp_lg_u32 s50, 0
 s_cselect_b32 s70, 268435456, s70
 s_min_u32 s51, s54, 63
 s_mul_i32 s55, s51, 40960
 s_mul_i32 s3, s50, 10240
 s_add_u32 s55, s55, s3
 s_add_u32 s55, s55, 226492416
 s_waitcnt vmcnt(8)
 s_barrier
 ds_read_b128 v[32:35], v16 offset:0
 ds_read_b128 v[36:39], v17 offset:0
 ds_read_b128 v[40:43], v18 offset:0
 ds_read_b128 v[44:47], v19 offset:0
 s_waitcnt lgkmcnt(3)
 v_mfma_f32_32x32x16_bf16 v[64:79], a[0:3], v[32:35], 0
 ds_read_b128 v[48:51], v20 offset:0
 s_add_u32 m0, s56, 0
 s_add_u32 s3, s55, s64
 buffer_load_dwordx4 v1, s[4:7], s3 offen sc1 lds
 s_waitcnt lgkmcnt(3)
 v_mfma_f32_32x32x16_bf16 v[64:79], a[4:7], v[36:39], v[64:79]
 ds_read_b128 v[52:55], v21 offset:0
 s_waitcnt lgkmcnt(3)
 v_mfma_f32_32x32x16_bf16 v[64:79], a[8:11], v[40:43], v[64:79]
 ds_read_b128 v[56:59], v22 offset:0
 s_waitcnt lgkmcnt(3)
 v_mfma_f32_32x32x16_bf16 v[64:79], a[12:15], v[44:47], v[64:79]
 ds_read_b128 v[60:63], v23 offset:0
 s_add_u32 m0, s56, 1024
 s_add_u32 s3, s55, s64
 buffer_load_dwordx4 v24, s[4:7], s3 offen sc1 lds
 s_waitcnt lgkmcnt(3)
 v_mfma_f32_32x32x16_bf16 v[64:79], a[16:19], v[48:51], v[64:79]
 s_waitcnt vmcnt(8)
 s_barrier
 ds_read_b128 v[32:35], v16 offset:8192
 s_waitcnt lgkmcnt(3)
 v_mfma_f32_32x32x16_bf16 v[64:79], a[20:23], v[52:55], v[64:79]
 ds_read_b128 v[36:39], v17 offset:8192
 s_waitcnt lgkmcnt(3)
 v_mfma_f32_32x32x16_bf16 v[64:79], a[24:27], v[56:59], v[64:79]
 ds_read_b128 v[40:43], v18 offset:8192
 s_add_u32 m0, s56, 8192
 s_add_u32 s3, s55, s65
 buffer_load_dwordx4 v1, s[4:7], s3 offen sc1 lds
 s_waitcnt lgkmcnt(3)
 v_mfma_f32_32x32x16_bf16 v[64:79], a[28:31], v[60:63], v[64:79]
 ds_read_b128 v[44:47], v19 offset:8192
 s_waitcnt lgkmcnt(3)
 v_mfma_f32_32x32x16_bf16 v[64:79], a[32:35], v[32:35], v[64:79]
 ds_read_b128 v[48:51], v20 offset:8192
 s_waitcnt lgkmcnt(3)
 v_mfma_f32_32x32x16_bf16 v[64:79], a[36:39], v[36:39], v[64:79]
 ds_read_b128 v[52:55], v21 offset:8192
 s_add_u32 m0, s56, 9216
 s_add_u32 s3, s55, s65
 buffer_load_dwordx4 v24, s[4:7], s3 offen sc1 lds
 s_waitcnt lgkmcnt(3)
 v_mfma_f32_32x32x16_bf16 v[64:79], a[40:43], v[40:43], v[64:79]
 ds_read_b128 v[56:59], v22 offset:8192
 s_waitcnt lgkmcnt(3)
 v_mfma_f32_32x32x16_bf16 v[64:79], a[44:47], v[44:47], v[64:79]
 ds_read_b128 v[60:63], v23 offset:8192
 s_waitcnt lgkmcnt(3)
 v_mfma_f32_32x32x16_bf16 v[64:79], a[48:51], v[48:51], v[64:79]
 s_waitcnt vmcnt(8)
 s_barrier
 ds_read_b128 v[32:35], v16 offset:16384
 s_add_u32 m0, s56, 16384
 s_add_u32 s3, s55, s66
 buffer_load_dwordx4 v1, s[4:7], s3 offen sc1 lds
 s_waitcnt lgkmcnt(3)
 v_mfma_f32_32x32x16_bf16 v[64:79], a[52:55], v[52:55], v[64:79]
 ds_read_b128 v[36:39], v17 offset:16384
 s_waitcnt lgkmcnt(3)
 v_mfma_f32_32x32x16_bf16 v[64:79], a[56:59], v[56:59], v[64:79]
 ds_read_b128 v[40:43], v18 offset:16384
 s_waitcnt lgkmcnt(3)
 v_mfma_f32_32x32x16_bf16 v[64:79], a[60:63], v[60:63], v[64:79]
 ds_read_b128 v[44:47], v19 offset:16384
 s_add_u32 m0, s56, 17408
 s_add_u32 s3, s55, s66
 buffer_load_dwordx4 v24, s[4:7], s3 offen sc1 lds
 s_waitcnt lgkmcnt(3)
 v_mfma_f32_32x32x16_bf16 v[64:79], a[64:67], v[32:35], v[64:79]
 ds_read_b128 v[48:51], v20 offset:16384
 s_waitcnt lgkmcnt(3)
 v_mfma_f32_32x32x16_bf16 v[64:79], a[68:71], v[36:39], v[64:79]
 ds_read_b128 v[52:55], v21 offset:16384
 s_waitcnt lgkmcnt(3)
 v_mfma_f32_32x32x16_bf16 v[64:79], a[72:75], v[40:43], v[64:79]
 ds_read_b128 v[56:59], v22 offset:16384
 s_add_u32 m0, s56, 24576
 s_add_u32 s3, s55, s67
 buffer_load_dwordx4 v1, s[4:7], s3 offen sc1 lds
 s_waitcnt lgkmcnt(3)
 v_mfma_f32_32x32x16_bf16 v[64:79], a[76:79], v[44:47], v[64:79]
 ds_read_b128 v[60:63], v23 offset:16384
 s_waitcnt lgkmcnt(3)
 v_mfma_f32_32x32x16_bf16 v[64:79], a[80:83], v[48:51], v[64:79]
 s_waitcnt vmcnt(9)
 s_barrier
 ds_read_b128 v[32:35], v16 offset:24576
 s_waitcnt lgkmcnt(3)
 v_mfma_f32_32x32x16_bf16 v[64:79], a[84:87], v[52:55], v[64:79]
 ds_read_b128 v[36:39], v17 offset:24576
 s_add_u32 m0, s56, 25600
 s_add_u32 s3, s55, s67
 buffer_load_dwordx4 v24, s[4:7], s3 offen sc1 lds
 s_waitcnt lgkmcnt(3)
 v_mfma_f32_32x32x16_bf16 v[64:79], a[88:91], v[56:59], v[64:79]
 ds_read_b128 v[40:43], v18 offset:24576
 s_waitcnt lgkmcnt(3)
 v_mfma_f32_32x32x16_bf16 v[64:79], a[92:95], v[60:63], v[64:79]
 ds_read_b128 v[44:47], v19 offset:24576
 s_waitcnt lgkmcnt(3)
 v_mfma_f32_32x32x16_bf16 v[64:79], a[96:99], v[32:35], v[64:79]
 ds_read_b128 v[48:51], v20 offset:24576
 s_add_u32 m0, s56, 32768
 s_add_u32 s3, s55, s68
 buffer_load_dwordx4 v1, s[4:7], s3 offen sc1 lds
 s_waitcnt lgkmcnt(3)
 v_mfma_f32_32x32x16_bf16 v[64:79], a[100:103], v[36:39], v[64:79]
 ds_read_b128 v[52:55], v21 offset:24576
 s_waitcnt lgkmcnt(3)
 v_mfma_f32_32x32x16_bf16 v[64:79], a[104:107], v[40:43], v[64:79]
 ds_read_b128 v[56:59], v22 offset:24576
 s_waitcnt lgkmcnt(3)
 v_mfma_f32_32x32x16_bf16 v[64:79], a[108:111], v[44:47], v[64:79]
 ds_read_b128 v[60:63], v23 offset:24576
 s_add_u32 m0, s56, 33792
 s_add_u32 s3, s55, s68
 buffer_load_dwordx4 v24, s[4:7], s3 offen sc1 lds
 s_waitcnt lgkmcnt(3)
 v_mfma_f32_32x32x16_bf16 v[64:79], a[112:115], v[48:51], v[64:79]
 s_waitcnt vmcnt(10)
 s_barrier
 ds_read_b128 v[32:35], v16 offset:32768
 s_waitcnt lgkmcnt(3)
 v_mfma_f32_32x32x16_bf16 v[64:79], a[116:119], v[52:55], v[64:79]
 ds_read_b128 v[36:39], v17 offset:32768
 v_mov_b32 v6, 8
 s_mov_b64 exec, 15
 v_mov_b32 v6, 0
 buffer_atomic_add v6, v5, s[4:7], s70 offen sc0
 s_mov_b64 exec, -1
 s_waitcnt lgkmcnt(3)
 v_mfma_f32_32x32x16_bf16 v[64:79], a[120:123], v[56:59], v[64:79]
 ds_read_b128 v[40:43], v18 offset:32768
 s_waitcnt lgkmcnt(3)
 v_mfma_f32_32x32x16_bf16 v[64:79], a[124:127], v[60:63], v[64:79]
 ds_read_b128 v[44:47], v19 offset:32768
 s_waitcnt lgkmcnt(3)
 v_mfma_f32_32x32x16_bf16 v[64:79], a[128:131], v[32:35], v[64:79]
 ds_read_b128 v[48:51], v20 offset:32768
 s_waitcnt lgkmcnt(3)
 v_mfma_f32_32x32x16_bf16 v[64:79], a[132:135], v[36:39], v[64:79]
 ds_read_b128 v[52:55], v21 offset:32768
 s_waitcnt lgkmcnt(3)
 v_mfma_f32_32x32x16_bf16 v[64:79], a[136:139], v[40:43], v[64:79]
 ds_read_b128 v[56:59], v22 offset:32768
 s_waitcnt lgkmcnt(3)
 v_mfma_f32_32x32x16_bf16 v[64:79], a[140:143], v[44:47], v[64:79]
 ds_read_b128 v[60:63], v23 offset:32768
 s_waitcnt lgkmcnt(3)
 v_mfma_f32_32x32x16_bf16 v[64:79], a[144:147], v[48:51], v[64:79]
 s_waitcnt lgkmcnt(2)
 v_mfma_f32_32x32x16_bf16 v[64:79], a[148:151], v[52:55], v[64:79]
 s_waitcnt lgkmcnt(1)
 v_mfma_f32_32x32x16_bf16 v[64:79], a[152:155], v[56:59], v[64:79]
 s_waitcnt lgkmcnt(0)
 v_mfma_f32_32x32x16_bf16 v[64:79], a[156:159], v[60:63], v[64:79]
 s_lshl_b32 s3, s60, 19
 s_add_u32 s3, s3, s58
 s_xor_b32 s3, s3, s82
 s_add_u32 s3, s3, 33554432
 s_nop 8
 v_cvt_pk_bf16_f32 v88, v64, v65
 v_cvt_pk_bf16_f32 v89, v66, v67
 v_cvt_pk_bf16_f32 v90, v72, v73
 v_cvt_pk_bf16_f32 v91, v74, v75
 buffer_store_dwordx4 v[88:91], v4, s[4:7], s3 offen offset:0 sc1
 v_cvt_pk_bf16_f32 v92, v68, v69
 v_cvt_pk_bf16_f32 v93, v70, v71
 v_cvt_pk_bf16_f32 v94, v76, v77
 v_cvt_pk_bf16_f32 v95, v78, v79
 buffer_store_dwordx4 v[92:95], v4, s[4:7], s3 offen offset:512 sc1
L_qkvq_mid:
 s_cmp_ge_u32 s54, 64
 s_cbranch_scc1 L_n0_60
 s_waitcnt vmcnt(2)
 s_cmp_lg_u32 s50, 0
 s_cbranch_scc1 L_w_69
 v_cmp_gt_u32 vcc, 8, v6
 s_nop 1
 v_mov_b32 v3, vcc_lo
 ds_write_b32 v7, v3
 s_waitcnt lgkmcnt(0)
L_w_69:
 s_barrier
 ds_read_b32 v3, v7
 s_waitcnt lgkmcnt(0)
 v_readfirstlane_b32 s3, v3
 s_mov_b32 s69, s3
 s_add_u32 s51, s60, 1
 s_mov_b32 s60, s54
 s_mul_i32 s55, s51, 40960
 s_mul_i32 s3, s50, 10240
 s_add_u32 s55, s55, s3
 s_add_u32 s55, s55, 229113856
 s_cmp_eq_u32 s69, 0
 s_cselect_b32 s55, s55, 268435456
 ds_read_b128 v[32:35], v8 offset:0
 ds_read_b128 v[36:39], v9 offset:0
 ds_read_b128 v[40:43], v10 offset:0
 ds_read_b128 v[44:47], v11 offset:0
 s_waitcnt lgkmcnt(3)
 v_mfma_f32_32x32x16_bf16 v[64:79], a[0:3], v[32:35], 0
 ds_read_b128 v[48:51], v12 offset:0
 s_add_u32 m0, s56, 40960
 s_add_u32 s3, s55, s64
 buffer_load_dwordx4 v1, s[4:7], s3 offen sc1 lds
 s_waitcnt lgkmcnt(3)
 v_mfma_f32_32x32x16_bf16 v[64:79], a[4:7], v[36:39], v[64:79]
 ds_read_b128 v[52:55], v13 offset:0
 s_waitcnt lgkmcnt(3)
 v_mfma_f32_32x32x16_bf16 v[64:79], a[8:11], v[40:43], v[64:79]
 ds_read_b128 v[56:59], v14 offset:0
 s_waitcnt lgkmcnt(3)
 v_mfma_f32_32x32x16_bf16 v[64:79], a[12:15], v[44:47], v[64:79]
 ds_read_b128 v[60:63], v15 offset:0
 s_add_u32 m0, s56, 41984
 s_add_u32 s3, s55, s64
 buffer_load_dwordx4 v24, s[4:7], s3 offen sc1 lds
 s_waitcnt lgkmcnt(3)
 v_mfma_f32_32x32x16_bf16 v[64:79], a[16:19], v[48:51], v[64:79]
 ds_read_b128 v[32:35], v8 offset:8192
 s_waitcnt lgkmcnt(3)
 v_mfma_f32_32x32x16_bf16 v[64:79], a[20:23], v[52:55], v[64:79]
 ds_read_b128 v[36:39], v9 offset:8192
 s_waitcnt lgkmcnt(3)
 v_mfma_f32_32x32x16_bf16 v[64:79], a[24:27], v[56:59], v[64:79]
 ds_read_b128 v[40:43], v10 offset:8192
 s_add_u32 m0, s56, 49152
 s_add_u32 s3, s55, s65
 buffer_load_dwordx4 v1, s[4:7], s3 offen sc1 lds
 s_waitcnt lgkmcnt(3)
 v_mfma_f32_32x32x16_bf16 v[64:79], a[28:31], v[60:63], v[64:79]
 ds_read_b128 v[44:47], v11 offset:8192
 s_waitcnt lgkmcnt(3)
 v_mfma_f32_32x32x16_bf16 v[64:79], a[32:35], v[32:35], v[64:79]
 ds_read_b128 v[48:51], v12 offset:8192
 s_waitcnt lgkmcnt(3)
 v_mfma_f32_32x32x16_bf16 v[64:79], a[36:39], v[36:39], v[64:79]
 ds_read_b128 v[52:55], v13 offset:8192
 s_add_u32 m0, s56, 50176
 s_add_u32 s3, s55, s65
 buffer_load_dwordx4 v24, s[4:7], s3 offen sc1 lds
 s_waitcnt lgkmcnt(3)
 v_mfma_f32_32x32x16_bf16 v[64:79], a[40:43], v[40:43], v[64:79]
 ds_read_b128 v[56:59], v14 offset:8192
 s_waitcnt lgkmcnt(3)
 v_mfma_f32_32x32x16_bf16 v[64:79], a[44:47], v[44:47], v[64:79]
 ds_read_b128 v[60:63], v15 offset:8192
 s_waitcnt lgkmcnt(3)
 v_mfma_f32_32x32x16_bf16 v[64:79], a[48:51], v[48:51], v[64:79]
 ds_read_b128 v[32:35], v8 offset:16384
 s_add_u32 m0, s56, 57344
 s_add_u32 s3, s55, s66
 buffer_load_dwordx4 v1, s[4:7], s3 offen sc1 lds
 s_waitcnt lgkmcnt(3)
 v_mfma_f32_32x32x16_bf16 v[64:79], a[52:55], v[52:55], v[64:79]
 ds_read_b128 v[36:39], v9 offset:16384
 s_waitcnt lgkmcnt(3)
 v_mfma_f32_32x32x16_bf16 v[64:79], a[56:59], v[56:59], v[64:79]
 ds_read_b128 v[40:43], v10 offset:16384
 s_waitcnt lgkmcnt(3)
 v_mfma_f32_32x32x16_bf16 v[64:79], a[60:63], v[60:63], v[64:79]
 ds_read_b128 v[44:47], v11 offset:16384
 s_add_u32 m0, s56, 58368
 s_add_u32 s3, s55, s66
 buffer_load_dwordx4 v24, s[4:7], s3 offen sc1 lds
 s_waitcnt lgkmcnt(3)
 v_mfma_f32_32x32x16_bf16 v[64:79], a[64:67], v[32:35], v[64:79]
 ds_read_b128 v[48:51], v12 offset:16384
 s_waitcnt lgkmcnt(3)
 v_mfma_f32_32x32x16_bf16 v[64:79], a[68:71], v[36:39], v[64:79]
 ds_read_b128 v[52:55], v13 offset:16384
 s_waitcnt vmcnt(6)
 s_lshl_b32 s3, s54, 2
 s_add_u32 s3, s3, s63
 v_mov_b32 v3, 1
 s_mov_b64 exec, s[78:79]
 buffer_atomic_add v3, v30, s[4:7], s3 offen
 s_mov_b64 exec, -1
 s_cmp_eq_u32 s61, 0
 s_cbranch_scc1 L_pf_70
 s_lshl_b32 s3, s61, 2
 s_add_u32 s3, s3, s59
 s_sub_u32 s3, s3, 4
 v_mov_b32 v3, 1
 s_mov_b64 exec, s[78:79]
 buffer_atomic_add v3, v30, s[4:7], s3 offen
 s_mov_b64 exec, -1
 s_mov_b32 s61, 0
L_pf_70:
 s_waitcnt lgkmcnt(3)
 v_mfma_f32_32x32x16_bf16 v[64:79], a[72:75], v[40:43], v[64:79]
 ds_read_b128 v[56:59], v14 offset:16384
 s_add_u32 m0, s56, 65536
 s_add_u32 s3, s55, s67
 buffer_load_dwordx4 v1, s[4:7], s3 offen sc1 lds
 s_waitcnt lgkmcnt(3)
 v_mfma_f32_32x32x16_bf16 v[64:79], a[76:79], v[44:47], v[64:79]
 ds_read_b128 v[60:63], v15 offset:16384
 s_waitcnt lgkmcnt(3)
 v_mfma_f32_32x32x16_bf16 v[64:79], a[80:83], v[48:51], v[64:79]
 ds_read_b128 v[32:35], v8 offset:24576
 s_waitcnt lgkmcnt(3)
 v_mfma_f32_32x32x16_bf16 v[64:79], a[84:87], v[52:55], v[64:79]
 ds_read_b128 v[36:39], v9 offset:24576
 s_add_u32 m0, s56, 66560
 s_add_u32 s3, s55, s67
 buffer_load_dwordx4 v24, s[4:7], s3 offen sc1 lds
 s_waitcnt lgkmcnt(3)
 v_mfma_f32_32x32x16_bf16 v[64:79], a[88:91], v[56:59], v[64:79]
 ds_read_b128 v[40:43], v10 offset:24576
 s_waitcnt lgkmcnt(3)
 v_mfma_f32_32x32x16_bf16 v[64:79], a[92:95], v[60:63], v[64:79]
 ds_read_b128 v[44:47], v11 offset:24576
 s_waitcnt lgkmcnt(3)
 v_mfma_f32_32x32x16_bf16 v[64:79], a[96:99], v[32:35], v[64:79]
 ds_read_b128 v[48:51], v12 offset:24576
 s_add_u32 m0, s56, 73728
 s_add_u32 s3, s55, s68
 buffer_load_dwordx4 v1, s[4:7], s3 offen sc1 lds
 s_waitcnt lgkmcnt(3)
 v_mfma_f32_32x32x16_bf16 v[64:79], a[100:103], v[36:39], v[64:79]
 ds_read_b128 v[52:55], v13 offset:24576
 s_waitcnt lgkmcnt(3)
 v_mfma_f32_32x32x16_bf16 v[64:79], a[104:107], v[40:43], v[64:79]
 ds_read_b128 v[56:59], v14 offset:24576
 s_waitcnt lgkmcnt(3)
 v_mfma_f32_32x32x16_bf16 v[64:79], a[108:111], v[44:47], v[64:79]
 ds_read_b128 v[60:63], v15 offset:24576
 s_add_u32 m0, s56, 74752
 s_add_u32 s3, s55, s68
 buffer_load_dwordx4 v24, s[4:7], s3 offen sc1 lds
 v_mov_b32 v6, 8
 s_mov_b64 exec, 15
 v_mov_b32 v6, 0
 buffer_atomic_add v6, v5, s[4:7], s70 offen sc0
 s_mov_b64 exec, -1
 s_waitcnt lgkmcnt(3)
 v_mfma_f32_32x32x16_bf16 v[64:79], a[112:115], v[48:51], v[64:79]
 ds_read_b128 v[32:35], v8 offset:32768
 s_waitcnt lgkmcnt(3)
 v_mfma_f32_32x32x16_bf16 v[64:79], a[116:119], v[52:55], v[64:79]
 ds_read_b128 v[36:39], v9 offset:32768
 s_waitcnt lgkmcnt(3)
 v_mfma_f32_32x32x16_bf16 v[64:79], a[120:123], v[56:59], v[64:79]
 ds_read_b128 v[40:43], v10 offset:32768
 s_waitcnt lgkmcnt(3)
 v_mfma_f32_32x32x16_bf16 v[64:79], a[124:127], v[60:63], v[64:79]
 ds_read_b128 v[44:47], v11 offset:32768
 s_waitcnt lgkmcnt(3)
 v_mfma_f32_32x32x16_bf16 v[64:79], a[128:131], v[32:35], v[64:79]
 ds_read_b128 v[48:51], v12 offset:32768
 s_waitcnt lgkmcnt(3)
 v_mfma_f32_32x32x16_bf16 v[64:79], a[132:135], v[36:39], v[64:79]
 ds_read_b128 v[52:55], v13 offset:32768
 s_waitcnt lgkmcnt(3)
 v_mfma_f32_32x32x16_bf16 v[64:79], a[136:139], v[40:43], v[64:79]
 ds_read_b128 v[56:59], v14 offset:32768
 s_waitcnt lgkmcnt(3)
 v_mfma_f32_32x32x16_bf16 v[64:79], a[140:143], v[44:47], v[64:79]
 ds_read_b128 v[60:63], v15 offset:32768
 s_waitcnt lgkmcnt(3)
 v_mfma_f32_32x32x16_bf16 v[64:79], a[144:147], v[48:51], v[64:79]
 s_waitcnt lgkmcnt(2)
 v_mfma_f32_32x32x16_bf16 v[64:79], a[148:151], v[52:55], v[64:79]
 s_waitcnt lgkmcnt(1)
 v_mfma_f32_32x32x16_bf16 v[64:79], a[152:155], v[56:59], v[64:79]
 s_waitcnt lgkmcnt(0)
 v_mfma_f32_32x32x16_bf16 v[64:79], a[156:159], v[60:63], v[64:79]
 s_lshl_b32 s3, s60, 19
 s_add_u32 s3, s3, s58
 s_xor_b32 s3, s3, s82
 s_nop 8
 v_cvt_pk_bf16_f32 v80, v64, v65
 v_cvt_pk_bf16_f32 v81, v66, v67
 v_cvt_pk_bf16_f32 v82, v72, v73
 v_cvt_pk_bf16_f32 v83, v74, v75
 buffer_store_dwordx4 v[80:83], v4, s[4:7], s3 offen offset:0 sc1
 v_cvt_pk_bf16_f32 v84, v68, v69
 v_cvt_pk_bf16_f32 v85, v70, v71
 v_cvt_pk_bf16_f32 v86, v76, v77
 v_cvt_pk_bf16_f32 v87, v78, v79
 buffer_store_dwordx4 v[84:87], v4, s[4:7], s3 offen offset:512 sc1
 s_add_u32 s54, s54, 1
 s_mov_b32 s61, s54
 s_waitcnt vmcnt(2)
 s_cmp_lg_u32 s50, 0
 s_cbranch_scc1 L_w_71
 v_cmp_gt_u32 vcc, 8, v6
 s_nop 1
 v_mov_b32 v3, vcc_lo
 ds_write_b32 v7, v3
 s_waitcnt lgkmcnt(0)
L_w_71:
 s_barrier
 ds_read_b32 v3, v7
 s_waitcnt lgkmcnt(0)
 v_readfirstlane_b32 s3, v3
 s_cmp_eq_u32 s69, 0
 s_cbranch_scc1 L_qkvq_fast
 s_cmp_eq_u32 s3, 0
 s_cbranch_scc1 L_qkvq_loop
 s_branch L_qkvq_block
L_n0_60:
 s_waitcnt vmcnt(0)
 s_lshl_b32 s3, s54, 2
 s_add_u32 s3, s3, s63
 v_mov_b32 v3, 1
 s_mov_b64 exec, s[78:79]
 buffer_atomic_add v3, v30, s[4:7], s3 offen
 s_mov_b64 exec, -1
 s_add_u32 s54, s54, 1
 s_cmp_lt_u32 s54, 80
 s_cbranch_scc1 L_qkvq_block
 s_endpgm
L_qkvv:
 s_mul_i32 s57, s50, 40960
 s_mul_i32 s62, s52, 3
 s_add_u32 s62, s62, s53
 s_mul_i32 s3, s62, 13108
 s_lshr_b32 s3, s3, 16
 s_mul_i32 s3, s3, 5
 s_sub_u32 s55, s62, s3
 s_add_u32 s64, s55, 0
 s_sub_u32 s3, s64, 5
 s_cmp_ge_u32 s64, 5
 s_cselect_b32 s64, s3, s64
 s_add_u32 s65, s55, 1
 s_sub_u32 s3, s65, 5
 s_cmp_ge_u32 s65, 5
 s_cselect_b32 s65, s3, s65
 s_add_u32 s66, s55, 2
 s_sub_u32 s3, s66, 5
 s_cmp_ge_u32 s66, 5
 s_cselect_b32 s66, s3, s66
 s_add_u32 s67, s55, 3
 s_sub_u32 s3, s67, 5
 s_cmp_ge_u32 s67, 5
 s_cselect_b32 s67, s3, s67
 s_add_u32 s68, s55, 4
 s_sub_u32 s3, s68, 5
 s_cmp_ge_u32 s68, 5
 s_cselect_b32 s68, s3, s68
 s_lshl_b32 s55, s52, 8
 v_lshrrev_b32 v4, 4, v0
 s_mov_b32 s3, 8192
 v_mul_lo_u32 v4, v4, s3
 v_lshrrev_b32 v3, 3, v0
 v_and_b32 v3, 6, v3
 v_xor_b32 v3, v3, v0
 v_and_b32 v3, 15, v3
 v_lshl_add_u32 v4, v3, 4, v4
 v_xor_b32 v5, 128, v4
 s_lshl_b32 s57, s50, 13
 s_mul_i32 s3, s50, 262144
 s_add_u32 s55, s55, s3
 s_mul_i32 s51, s64, 1048576
 s_add_u32 s51, s51, s55
 s_add_u32 m0, s57, 0
 s_nop 0
 buffer_load_dwordx4 v4, s[8:11], s51 offen lds
 s_add_u32 s51, s51, 32768
 s_add_u32 m0, s57, 1024
 s_nop 0
 buffer_load_dwordx4 v5, s[8:11], s51 offen lds
 s_add_u32 s51, s51, 32768
 s_add_u32 m0, s57, 2048
 s_nop 0
 buffer_load_dwordx4 v4, s[8:11], s51 offen lds
 s_add_u32 s51, s51, 32768
 s_add_u32 m0, s57, 3072
 s_nop 0
 buffer_load_dwordx4 v5, s[8:11], s51 offen lds
 s_add_u32 s51, s51, 32768
 s_add_u32 m0, s57, 4096
 s_nop 0
 buffer_load_dwordx4 v4, s[8:11], s51 offen lds
 s_add_u32 s51, s51, 32768
 s_add_u32 m0, s57, 5120
 s_nop 0
 buffer_load_dwordx4 v5, s[8:11], s51 offen lds
 s_add_u32 s51, s51, 32768
 s_add_u32 m0, s57, 6144
 s_nop 0
 buffer_load_dwordx4 v4, s[8:11], s51 offen lds
 s_add_u32 s51, s51, 32768
 s_add_u32 m0, s57, 7168
 s_nop 0
 buffer_load_dwordx4 v5, s[8:11], s51 offen lds
 s_add_u32 s51, s51, 32768
 s_mul_i32 s51, s65, 1048576
 s_add_u32 s51, s51, s55
 s_add_u32 m0, s57, 32768
 s_nop 0
 buffer_load_dwordx4 v4, s[8:11], s51 offen lds
 s_add_u32 s51, s51, 32768
 s_add_u32 m0, s57, 33792
 s_nop 0
 buffer_load_dwordx4 v5, s[8:11], s51 offen lds
 s_add_u32 s51, s51, 32768
 s_add_u32 m0, s57, 34816
 s_nop 0
 buffer_load_dwordx4 v4, s[8:11], s51 offen lds
 s_add_u32 s51, s51, 32768
 s_add_u32 m0, s57, 35840
 s_nop 0
 buffer_load_dwordx4 v5, s[8:11], s51 offen lds
 s_add_u32 s51, s51, 32768
 s_add_u32 m0, s57, 36864
 s_nop 0
 buffer_load_dwordx4 v4, s[8:11], s51 offen lds
 s_add_u32 s51, s51, 32768
 s_add_u32 m0, s57, 37888
 s_nop 0
 buffer_load_dwordx4 v5, s[8:11], s51 offen lds
 s_add_u32 s51, s51, 32768
 s_add_u32 m0, s57, 38912
 s_nop 0
 buffer_load_dwordx4 v4, s[8:11], s51 offen lds
 s_add_u32 s51, s51, 32768
 s_add_u32 m0, s57, 39936
 s_nop 0
 buffer_load_dwordx4 v5, s[8:11], s51 offen lds
 s_add_u32 s51, s51, 32768
 s_mul_i32 s51, s66, 1048576
 s_add_u32 s51, s51, s55
 s_add_u32 m0, s57, 65536
 s_nop 0
 buffer_load_dwordx4 v4, s[8:11], s51 offen lds
 s_add_u32 s51, s51, 32768
 s_add_u32 m0, s57, 66560
 s_nop 0
 buffer_load_dwordx4 v5, s[8:11], s51 offen lds
 s_add_u32 s51, s51, 32768
 s_add_u32 m0, s57, 67584
 s_nop 0
 buffer_load_dwordx4 v4, s[8:11], s51 offen lds
 s_add_u32 s51, s51, 32768
 s_add_u32 m0, s57, 68608
 s_nop 0
 buffer_load_dwordx4 v5, s[8:11], s51 offen lds
 s_add_u32 s51, s51, 32768
 s_add_u32 m0, s57, 69632
 s_nop 0
 buffer_load_dwordx4 v4, s[8:11], s51 offen lds
 s_add_u32 s51, s51, 32768
 s_add_u32 m0, s57, 70656
 s_nop 0
 buffer_load_dwordx4 v5, s[8:11], s51 offen lds
 s_add_u32 s51, s51, 32768
 s_add_u32 m0, s57, 71680
 s_nop 0
 buffer_load_dwordx4 v4, s[8:11], s51 offen lds
 s_add_u32 s51, s51, 32768
 s_add_u32 m0, s57, 72704
 s_nop 0
 buffer_load_dwordx4 v5, s[8:11], s51 offen lds
 s_add_u32 s51, s51, 32768
 s_mul_i32 s51, s67, 1048576
 s_add_u32 s51, s51, s55
 s_add_u32 m0, s57, 98304
 s_nop 0
 buffer_load_dwordx4 v4, s[8:11], s51 offen lds
 s_add_u32 s51, s51, 32768
 s_add_u32 m0, s57, 99328
 s_nop 0
 buffer_load_dwordx4 v5, s[8:11], s51 offen lds
 s_add_u32 s51, s51, 32768
 s_add_u32 m0, s57, 100352
 s_nop 0
 buffer_load_dwordx4 v4, s[8:11], s51 offen lds
 s_add_u32 s51, s51, 32768
 s_add_u32 m0, s57, 101376
 s_nop 0
 buffer_load_dwordx4 v5, s[8:11], s51 offen lds
 s_add_u32 s51, s51, 32768
 s_add_u32 m0, s57, 102400
 s_nop 0
 buffer_load_dwordx4 v4, s[8:11], s51 offen lds
 s_add_u32 s51, s51, 32768
 s_add_u32 m0, s57, 103424
 s_nop 0
 buffer_load_dwordx4 v5, s[8:11], s51 offen lds
 s_add_u32 s51, s51, 32768
 s_add_u32 m0, s57, 104448
 s_nop 0
 buffer_load_dwordx4 v4, s[8:11], s51 offen lds
 s_add_u32 s51, s51, 32768
 s_add_u32 m0, s57, 105472
 s_nop 0
 buffer_load_dwordx4 v5, s[8:11], s51 offen lds
 s_add_u32 s51, s51, 32768
 s_mul_i32 s51, s68, 1048576
 s_add_u32 s51, s51, s55
 s_add_u32 m0, s57, 131072
 s_nop 0
 buffer_load_dwordx4 v4, s[8:11], s51 offen lds
 s_add_u32 s51, s51, 32768
 s_add_u32 m0, s57, 132096
 s_nop 0
 buffer_load_dwordx4 v5, s[8:11], s51 offen lds
 s_add_u32 s51, s51, 32768
 s_add_u32 m0, s57, 133120
 s_nop 0
 buffer_load_dwordx4 v4, s[8:11], s51 offen lds
 s_add_u32 s51, s51, 32768
 s_add_u32 m0, s57, 134144
 s_nop 0
 buffer_load_dwordx4 v5, s[8:11], s51 offen lds
 s_add_u32 s51, s51, 32768
 s_add_u32 m0, s57, 135168
 s_nop 0
 buffer_load_dwordx4 v4, s[8:11], s51 offen lds
 s_add_u32 s51, s51, 32768
 s_add_u32 m0, s57, 136192
 s_nop 0
 buffer_load_dwordx4 v5, s[8:11], s51 offen lds
 s_add_u32 s51, s51, 32768
 s_add_u32 m0, s57, 137216
 s_nop 0
 buffer_load_dwordx4 v4, s[8:11], s51 offen lds
 s_add_u32 s51, s51, 32768
 s_add_u32 m0, s57, 138240
 s_nop 0
 buffer_load_dwordx4 v5, s[8:11], s51 offen lds
 s_add_u32 s51, s51, 32768
 s_mov_b32 s96, s44
 s_and_b32 s97, s45, 0xffff
 s_mov_b32 s98, 256
 s_mov_b32 s99, 0x00020000
 buffer_load_dword v30, off, s[96:99], 0 offset:132 sc1
 v_lshrrev_b32 v2, 3, v0
 v_and_b32 v2, 4, v2
 v_bfe_u32 v3, v0, 2, 2
 v_or_b32 v2, v2, v3
 v_bfe_u32 v3, v0, 4, 1
 v_xor_b32 v3, v3, v2
 s_lshl_b32 s3, s50, 1
 v_xor_b32 v3, s3, v3
 v_lshlrev_b32 v2, 8, v2
 v_lshl_add_u32 v2, v3, 5, v2
 v_and_b32 v3, 3, v0
 v_lshl_add_u32 v2, v3, 3, v2
 s_waitcnt vmcnt(32)
 s_barrier
 ds_read_b64_tr_b16 a[0:1], v2 offset:0
 ds_read_b64_tr_b16 a[2:3], v2 offset:4096
 ds_read_b64_tr_b16 a[4:5], v2 offset:2048
 ds_read_b64_tr_b16 a[6:7], v2 offset:6144
 ds_read_b64_tr_b16 a[8:9], v2 offset:8192
 ds_read_b64_tr_b16 a[10:11], v2 offset:12288
 ds_read_b64_tr_b16 a[12:13], v2 offset:10240
 ds_read_b64_tr_b16 a[14:15], v2 offset:14336
 ds_read_b64_tr_b16 a[16:17], v2 offset:16384
 ds_read_b64_tr_b16 a[18:19], v2 offset:20480
 ds_read_b64_tr_b16 a[20:21], v2 offset:18432
 ds_read_b64_tr_b16 a[22:23], v2 offset:22528
 ds_read_b64_tr_b16 a[24:25], v2 offset:24576
 ds_read_b64_tr_b16 a[26:27], v2 offset:28672
 ds_read_b64_tr_b16 a[28:29], v2 offset:26624
 ds_read_b64_tr_b16 a[30:31], v2 offset:30720
 v_add_u32 v2, 0x8000, v2
 s_waitcnt vmcnt(24)
 s_barrier
 ds_read_b64_tr_b16 a[32:33], v2 offset:0
 ds_read_b64_tr_b16 a[34:35], v2 offset:4096
 ds_read_b64_tr_b16 a[36:37], v2 offset:2048
 ds_read_b64_tr_b16 a[38:39], v2 offset:6144
 ds_read_b64_tr_b16 a[40:41], v2 offset:8192
 ds_read_b64_tr_b16 a[42:43], v2 offset:12288
 ds_read_b64_tr_b16 a[44:45], v2 offset:10240
 ds_read_b64_tr_b16 a[46:47], v2 offset:14336
 ds_read_b64_tr_b16 a[48:49], v2 offset:16384
 ds_read_b64_tr_b16 a[50:51], v2 offset:20480
 ds_read_b64_tr_b16 a[52:53], v2 offset:18432
 ds_read_b64_tr_b16 a[54:55], v2 offset:22528
 ds_read_b64_tr_b16 a[56:57], v2 offset:24576
 ds_read_b64_tr_b16 a[58:59], v2 offset:28672
 ds_read_b64_tr_b16 a[60:61], v2 offset:26624
 ds_read_b64_tr_b16 a[62:63], v2 offset:30720
 v_add_u32 v2, 0x8000, v2
 s_waitcnt vmcnt(16)
 s_barrier
 ds_read_b64_tr_b16 a[64:65], v2 offset:0
 ds_read_b64_tr_b16 a[66:67], v2 offset:4096
 ds_read_b64_tr_b16 a[68:69], v2 offset:2048
 ds_read_b64_tr_b16 a[70:71], v2 offset:6144
 ds_read_b64_tr_b16 a[72:73], v2 offset:8192
 ds_read_b64_tr_b16 a[74:75], v2 offset:12288
 ds_read_b64_tr_b16 a[76:77], v2 offset:10240
 ds_read_b64_tr_b16 a[78:79], v2 offset:14336
 ds_read_b64_tr_b16 a[80:81], v2 offset:16384
 ds_read_b64_tr_b16 a[82:83], v2 offset:20480
 ds_read_b64_tr_b16 a[84:85], v2 offset:18432
 ds_read_b64_tr_b16 a[86:87], v2 offset:22528
 ds_read_b64_tr_b16 a[88:89], v2 offset:24576
 ds_read_b64_tr_b16 a[90:91], v2 offset:28672
 ds_read_b64_tr_b16 a[92:93], v2 offset:26624
 ds_read_b64_tr_b16 a[94:95], v2 offset:30720
 v_add_u32 v2, 0x8000, v2
 s_waitcnt vmcnt(8)
 s_barrier
 ds_read_b64_tr_b16 a[96:97], v2 offset:0
 ds_read_b64_tr_b16 a[98:99], v2 offset:4096
 ds_read_b64_tr_b16 a[100:101], v2 offset:2048
 ds_read_b64_tr_b16 a[102:103], v2 offset:6144
 ds_read_b64_tr_b16 a[104:105], v2 offset:8192
 ds_read_b64_tr_b16 a[106:107], v2 offset:12288
 ds_read_b64_tr_b16 a[108:109], v2 offset:10240
 ds_read_b64_tr_b16 a[110:111], v2 offset:14336
 ds_read_b64_tr_b16 a[112:113], v2 offset:16384
 ds_read_b64_tr_b16 a[114:115], v2 offset:20480
 ds_read_b64_tr_b16 a[116:117], v2 offset:18432
 ds_read_b64_tr_b16 a[118:119], v2 offset:22528
 ds_read_b64_tr_b16 a[120:121], v2 offset:24576
 ds_read_b64_tr_b16 a[122:123], v2 offset:28672
 ds_read_b64_tr_b16 a[124:125], v2 offset:26624
 ds_read_b64_tr_b16 a[126:127], v2 offset:30720
 v_add_u32 v2, 0x8000, v2
 s_waitcnt vmcnt(0)
 s_barrier
 ds_read_b64_tr_b16 a[128:129], v2 offset:0
 ds_read_b64_tr_b16 a[130:131], v2 offset:4096
 ds_read_b64_tr_b16 a[132:133], v2 offset:2048
 ds_read_b64_tr_b16 a[134:135], v2 offset:6144
 ds_read_b64_tr_b16 a[136:137], v2 offset:8192
 ds_read_b64_tr_b16 a[138:139], v2 offset:12288
 ds_read_b64_tr_b16 a[140:141], v2 offset:10240
 ds_read_b64_tr_b16 a[142:143], v2 offset:14336
 ds_read_b64_tr_b16 a[144:145], v2 offset:16384
 ds_read_b64_tr_b16 a[146:147], v2 offset:20480
 ds_read_b64_tr_b16 a[148:149], v2 offset:18432
 ds_read_b64_tr_b16 a[150:151], v2 offset:22528
 ds_read_b64_tr_b16 a[152:153], v2 offset:24576
 ds_read_b64_tr_b16 a[154:155], v2 offset:28672
 ds_read_b64_tr_b16 a[156:157], v2 offset:26624
 ds_read_b64_tr_b16 a[158:159], v2 offset:30720
 v_add_u32 v2, 0x8000, v2
 s_waitcnt lgkmcnt(0)
 s_barrier
 v_cmp_eq_u32 vcc, 0, v30
 s_cbranch_vccz L_qa_72
 s_mov_b32 s96, s44
 s_and_b32 s97, s45, 0xffff
 s_mov_b32 s98, 256
 s_mov_b32 s99, 0x00020000
 v_mov_b32 v1, 132
 s_mov_b32 s51, 0
 s_mov_b64 exec, 1
L_wb_73:
 buffer_load_dword v2, v1, s[96:99], 0 offen sc1
 s_waitcnt vmcnt(0)
 v_cmp_eq_u32 vcc, 0, v2
 s_cbranch_vccz L_wbd_74
 s_sleep 2
 s_add_u32 s51, s51, 1
 s_cmp_lt_u32 s51, 131072
 s_cbranch_scc1 L_wb_73
 s_branch L_bail
L_wbd_74:
 s_mov_b64 exec, -1
L_qa_72:
 s_lshl_b32 s64, s64, 8
 s_lshl_b32 s65, s65, 8
 s_lshl_b32 s66, s66, 8
 s_lshl_b32 s67, s67, 8
 s_lshl_b32 s68, s68, 8
 s_cmp_eq_u32 s53, 0
 s_cselect_b32 s78, 2, 3
 s_mov_b32 s79, 0
 v_lshrrev_b32 v1, 4, v0
 s_mov_b32 s3, 1280
 v_mul_lo_u32 v1, v1, s3
 v_and_b32 v3, 15, v0
 v_lshl_add_u32 v1, v3, 4, v1
 v_add_u32 v6, 5120, v1
 v_mov_b32 v24, v6
 v_and_b32 v2, 31, v0
 v_lshlrev_b32 v2, 8, v2
 v_lshrrev_b32 v4, 5, v0
 v_xor_b32 v4, v4, v3
 v_xor_b32 v8, 0, v4
 v_lshl_add_u32 v8, v8, 4, v2
 v_add_u32 v16, 40960, v8
 v_xor_b32 v9, 2, v4
 v_lshl_add_u32 v9, v9, 4, v2
 v_add_u32 v17, 40960, v9
 v_xor_b32 v10, 4, v4
 v_lshl_add_u32 v10, v10, 4, v2
 v_add_u32 v18, 40960, v10
 v_xor_b32 v11, 6, v4
 v_lshl_add_u32 v11, v11, 4, v2
 v_add_u32 v19, 40960, v11
 v_xor_b32 v12, 8, v4
 v_lshl_add_u32 v12, v12, 4, v2
 v_add_u32 v20, 40960, v12
 v_xor_b32 v13, 10, v4
 v_lshl_add_u32 v13, v13, 4, v2
 v_add_u32 v21, 40960, v13
 v_xor_b32 v14, 12, v4
 v_lshl_add_u32 v14, v14, 4, v2
 v_add_u32 v22, 40960, v14
 v_xor_b32 v15, 14, v4
 v_lshl_add_u32 v15, v15, 4, v2
 v_add_u32 v23, 40960, v15
 v_lshrrev_b32 v4, 5, v0
 v_lshlrev_b32 v4, 8, v4
 v_lshl_add_u32 v4, v3, 4, v4
 v_and_b32 v2, 16, v0
 v_lshl_add_u32 v4, v2, 6, v4
 s_lshl_b32 s3, s50, 11
 v_add_u32 v4, s3, v4
 v_mul_u32_u24 v5, 24576, v0
 v_mov_b32 v7, 163776
 v_mul_u32_u24 v30, 16384, v0
 s_lshl_b32 s75, s62, 2
 s_add_u32 s75, s75, s50
 s_and_b32 s100, s52, 1
 s_lshl_b32 s100, s100, 13
 s_lshl_b32 s58, s52, 14
 s_add_u32 s58, s58, s100
 s_add_u32 s58, s58, 75497472
 s_cmp_eq_u32 s53, 0
 s_cselect_b32 s82, 8192, 0
 s_lshl_b32 s59, s52, 8
 s_add_u32 s59, s59, 8192
 s_lshl_b32 s56, s50, 11
 s_mov_b32 s54, 0
 s_mov_b32 s61, 0
 s_mov_b32 s70, s75
 s_mul_i32 s55, s54, 40960
 s_mul_i32 s3, s50, 10240
 s_add_u32 s55, s55, s3
 s_add_u32 s55, s55, 226492416
 s_add_u32 m0, s56, 0
 s_add_u32 s3, s55, s64
 buffer_load_dwordx4 v1, s[4:7], s3 offen sc1 lds
 s_add_u32 m0, s56, 1024
 s_add_u32 s3, s55, s64
 buffer_load_dwordx4 v24, s[4:7], s3 offen sc1 lds
 s_add_u32 m0, s56, 8192
 s_add_u32 s3, s55, s65
 buffer_load_dwordx4 v1, s[4:7], s3 offen sc1 lds
 s_add_u32 m0, s56, 9216
 s_add_u32 s3, s55, s65
 buffer_load_dwordx4 v24, s[4:7], s3 offen sc1 lds
 s_add_u32 m0, s56, 16384
 s_add_u32 s3, s55, s66
 buffer_load_dwordx4 v1, s[4:7], s3 offen sc1 lds
 s_add_u32 m0, s56, 17408
 s_add_u32 s3, s55, s66
 buffer_load_dwordx4 v24, s[4:7], s3 offen sc1 lds
 s_add_u32 m0, s56, 24576
 s_add_u32 s3, s55, s67
 buffer_load_dwordx4 v1, s[4:7], s3 offen sc1 lds
 s_add_u32 m0, s56, 25600
 s_add_u32 s3, s55, s67
 buffer_load_dwordx4 v24, s[4:7], s3 offen sc1 lds
 s_add_u32 m0, s56, 32768
 s_add_u32 s3, s55, s68
 buffer_load_dwordx4 v1, s[4:7], s3 offen sc1 lds
 s_add_u32 m0, s56, 33792
 s_add_u32 s3, s55, s68
 buffer_load_dwordx4 v24, s[4:7], s3 offen sc1 lds
 s_waitcnt vmcnt(0)
L_qkvv_pre:
 s_barrier
 s_mov_b32 s60, s54
 s_add_u32 s54, s54, 1
 s_mul_i32 s55, s54, 40960
 s_mul_i32 s3, s50, 10240
 s_add_u32 s55, s55, s3
 s_add_u32 s55, s55, 226492416
 ds_read_b128 v[32:35], v8 offset:0
 ds_read_b128 v[36:39], v9 offset:0
 ds_read_b128 v[40:43], v10 offset:0
 ds_read_b128 v[44:47], v11 offset:0
 s_waitcnt lgkmcnt(3)
 v_mfma_f32_32x32x16_bf16 v[64:79], v[32:35], a[0:3], 0
 ds_read_b128 v[48:51], v12 offset:0
 s_add_u32 m0, s56, 40960
 s_add_u32 s3, s55, s64
 buffer_load_dwordx4 v1, s[4:7], s3 offen sc1 lds
 s_waitcnt lgkmcnt(3)
 v_mfma_f32_32x32x16_bf16 v[64:79], v[36:39], a[4:7], v[64:79]
 ds_read_b128 v[52:55], v13 offset:0
 s_waitcnt lgkmcnt(3)
 v_mfma_f32_32x32x16_bf16 v[64:79], v[40:43], a[8:11], v[64:79]
 ds_read_b128 v[56:59], v14 offset:0
 s_waitcnt lgkmcnt(3)
 v_mfma_f32_32x32x16_bf16 v[64:79], v[44:47], a[12:15], v[64:79]
 ds_read_b128 v[60:63], v15 offset:0
 s_add_u32 m0, s56, 41984
 s_add_u32 s3, s55, s64
 buffer_load_dwordx4 v24, s[4:7], s3 offen sc1 lds
 s_waitcnt lgkmcnt(3)
 v_mfma_f32_32x32x16_bf16 v[64:79], v[48:51], a[16:19], v[64:79]
 ds_read_b128 v[32:35], v8 offset:8192
 s_waitcnt lgkmcnt(3)
 v_mfma_f32_32x32x16_bf16 v[64:79], v[52:55], a[20:23], v[64:79]
 ds_read_b128 v[36:39], v9 offset:8192
 s_waitcnt lgkmcnt(3)
 v_mfma_f32_32x32x16_bf16 v[64:79], v[56:59], a[24:27], v[64:79]
 ds_read_b128 v[40:43], v10 offset:8192
 s_add_u32 m0, s56, 49152
 s_add_u32 s3, s55, s65
 buffer_load_dwordx4 v1, s[4:7], s3 offen sc1 lds
 s_waitcnt lgkmcnt(3)
 v_mfma_f32_32x32x16_bf16 v[64:79], v[60:63], a[28:31], v[64:79]
 ds_read_b128 v[44:47], v11 offset:8192
 s_waitcnt lgkmcnt(3)
 v_mfma_f32_32x32x16_bf16 v[64:79], v[32:35], a[32:35], v[64:79]
 ds_read_b128 v[48:51], v12 offset:8192
 s_waitcnt lgkmcnt(3)
 v_mfma_f32_32x32x16_bf16 v[64:79], v[36:39], a[36:39], v[64:79]
 ds_read_b128 v[52:55], v13 offset:8192
 s_add_u32 m0, s56, 50176
 s_add_u32 s3, s55, s65
 buffer_load_dwordx4 v24, s[4:7], s3 offen sc1 lds
 s_waitcnt lgkmcnt(3)
 v_mfma_f32_32x32x16_bf16 v[64:79], v[40:43], a[40:43], v[64:79]
 ds_read_b128 v[56:59], v14 offset:8192
 s_waitcnt lgkmcnt(3)
 v_mfma_f32_32x32x16_bf16 v[64:79], v[44:47], a[44:47], v[64:79]
 ds_read_b128 v[60:63], v15 offset:8192
 s_waitcnt lgkmcnt(3)
 v_mfma_f32_32x32x16_bf16 v[64:79], v[48:51], a[48:51], v[64:79]
 ds_read_b128 v[32:35], v8 offset:16384
 s_add_u32 m0, s56, 57344
 s_add_u32 s3, s55, s66
 buffer_load_dwordx4 v1, s[4:7], s3 offen sc1 lds
 s_waitcnt lgkmcnt(3)
 v_mfma_f32_32x32x16_bf16 v[64:79], v[52:55], a[52:55], v[64:79]
 ds_read_b128 v[36:39], v9 offset:16384
 s_waitcnt lgkmcnt(3)
 v_mfma_f32_32x32x16_bf16 v[64:79], v[56:59], a[56:59], v[64:79]
 ds_read_b128 v[40:43], v10 offset:16384
 s_waitcnt lgkmcnt(3)
 v_mfma_f32_32x32x16_bf16 v[64:79], v[60:63], a[60:63], v[64:79]
 ds_read_b128 v[44:47], v11 offset:16384
 s_add_u32 m0, s56, 58368
 s_add_u32 s3, s55, s66
 buffer_load_dwordx4 v24, s[4:7], s3 offen sc1 lds
 s_waitcnt lgkmcnt(3)
 v_mfma_f32_32x32x16_bf16 v[64:79], v[32:35], a[64:67], v[64:79]
 ds_read_b128 v[48:51], v12 offset:16384
 s_waitcnt lgkmcnt(3)
 v_mfma_f32_32x32x16_bf16 v[64:79], v[36:39], a[68:71], v[64:79]
 ds_read_b128 v[52:55], v13 offset:16384
 s_waitcnt lgkmcnt(3)
 v_mfma_f32_32x32x16_bf16 v[64:79], v[40:43], a[72:75], v[64:79]
 ds_read_b128 v[56:59], v14 offset:16384
 s_add_u32 m0, s56, 65536
 s_add_u32 s3, s55, s67
 buffer_load_dwordx4 v1, s[4:7], s3 offen sc1 lds
 s_waitcnt lgkmcnt(3)
 v_mfma_f32_32x32x16_bf16 v[64:79], v[44:47], a[76:79], v[64:79]
 ds_read_b128 v[60:63], v15 offset:16384
 s_waitcnt vmcnt(7)
 s_cmp_eq_u32 s61, 0
 s_cbranch_scc1 L_pf_75
 s_lshl_b32 s3, s61, 2
 s_add_u32 s3, s3, s59
 s_sub_u32 s3, s3, 4
 v_mov_b32 v3, 1
 s_mov_b64 exec, s[78:79]
 buffer_atomic_add v3, v30, s[4:7], s3 offen
 s_mov_b64 exec, -1
 s_mov_b32 s61, 0
L_pf_75:
 s_waitcnt lgkmcnt(3)
 v_mfma_f32_32x32x16_bf16 v[64:79], v[48:51], a[80:83], v[64:79]
 ds_read_b128 v[32:35], v8 offset:24576
 s_waitcnt lgkmcnt(3)
 v_mfma_f32_32x32x16_bf16 v[64:79], v[52:55], a[84:87], v[64:79]
 ds_read_b128 v[36:39], v9 offset:24576
 s_add_u32 m0, s56, 66560
 s_add_u32 s3, s55, s67
 buffer_load_dwordx4 v24, s[4:7], s3 offen sc1 lds
 s_waitcnt lgkmcnt(3)
 v_mfma_f32_32x32x16_bf16 v[64:79], v[56:59], a[88:91], v[64:79]
 ds_read_b128 v[40:43], v10 offset:24576
 s_waitcnt lgkmcnt(3)
 v_mfma_f32_32x32x16_bf16 v[64:79], v[60:63], a[92:95], v[64:79]
 ds_read_b128 v[44:47], v11 offset:24576
 s_waitcnt lgkmcnt(3)
 v_mfma_f32_32x32x16_bf16 v[64:79], v[32:35], a[96:99], v[64:79]
 ds_read_b128 v[48:51], v12 offset:24576
 s_add_u32 m0, s56, 73728
 s_add_u32 s3, s55, s68
 buffer_load_dwordx4 v1, s[4:7], s3 offen sc1 lds
 s_waitcnt lgkmcnt(3)
 v_mfma_f32_32x32x16_bf16 v[64:79], v[36:39], a[100:103], v[64:79]
 ds_read_b128 v[52:55], v13 offset:24576
 s_waitcnt lgkmcnt(3)
 v_mfma_f32_32x32x16_bf16 v[64:79], v[40:43], a[104:107], v[64:79]
 ds_read_b128 v[56:59], v14 offset:24576
 s_waitcnt lgkmcnt(3)
 v_mfma_f32_32x32x16_bf16 v[64:79], v[44:47], a[108:111], v[64:79]
 ds_read_b128 v[60:63], v15 offset:24576
 s_add_u32 m0, s56, 74752
 s_add_u32 s3, s55, s68
 buffer_load_dwordx4 v24, s[4:7], s3 offen sc1 lds
 s_waitcnt lgkmcnt(3)
 v_mfma_f32_32x32x16_bf16 v[64:79], v[48:51], a[112:115], v[64:79]
 ds_read_b128 v[32:35], v8 offset:32768
 s_waitcnt lgkmcnt(3)
 v_mfma_f32_32x32x16_bf16 v[64:79], v[52:55], a[116:119], v[64:79]
 ds_read_b128 v[36:39], v9 offset:32768
 s_waitcnt lgkmcnt(3)
 v_mfma_f32_32x32x16_bf16 v[64:79], v[56:59], a[120:123], v[64:79]
 ds_read_b128 v[40:43], v10 offset:32768
 s_waitcnt lgkmcnt(3)
 v_mfma_f32_32x32x16_bf16 v[64:79], v[60:63], a[124:127], v[64:79]
 ds_read_b128 v[44:47], v11 offset:32768
 s_waitcnt lgkmcnt(3)
 v_mfma_f32_32x32x16_bf16 v[64:79], v[32:35], a[128:131], v[64:79]
 ds_read_b128 v[48:51], v12 offset:32768
 s_waitcnt lgkmcnt(3)
 v_mfma_f32_32x32x16_bf16 v[64:79], v[36:39], a[132:135], v[64:79]
 ds_read_b128 v[52:55], v13 offset:32768
 s_waitcnt lgkmcnt(3)
 v_mfma_f32_32x32x16_bf16 v[64:79], v[40:43], a[136:139], v[64:79]
 ds_read_b128 v[56:59], v14 offset:32768
 s_waitcnt lgkmcnt(3)
 v_mfma_f32_32x32x16_bf16 v[64:79], v[44:47], a[140:143], v[64:79]
 ds_read_b128 v[60:63], v15 offset:32768
 s_waitcnt lgkmcnt(3)
 v_mfma_f32_32x32x16_bf16 v[64:79], v[48:51], a[144:147], v[64:79]
 s_waitcnt lgkmcnt(2)
 v_mfma_f32_32x32x16_bf16 v[64:79], v[52:55], a[148:151], v[64:79]
 s_waitcnt lgkmcnt(1)
 v_mfma_f32_32x32x16_bf16 v[64:79], v[56:59], a[152:155], v[64:79]
 s_waitcnt lgkmcnt(0)
 v_mfma_f32_32x32x16_bf16 v[64:79], v[60:63], a[156:159], v[64:79]
 s_lshl_b32 s3, s60, 19
 s_add_u32 s3, s3, s58
 s_xor_b32 s3, s3, s82
 s_nop 8
 v_cvt_pk_bf16_f32 v80, v64, v65
 v_cvt_pk_bf16_f32 v81, v66, v67
 v_cvt_pk_bf16_f32 v82, v72, v73
 v_cvt_pk_bf16_f32 v83, v74, v75
 buffer_store_dwordx4 v[80:83], v4, s[4:7], s3 offen offset:0 sc1
 v_cvt_pk_bf16_f32 v84, v68, v69
 v_cvt_pk_bf16_f32 v85, v70, v71
 v_cvt_pk_bf16_f32 v86, v76, v77
 v_cvt_pk_bf16_f32 v87, v78, v79
 buffer_store_dwordx4 v[84:87], v4, s[4:7], s3 offen offset:512 sc1
 s_mov_b32 s61, s54
 s_cmp_lg_u32 s54, 1
 s_cbranch_scc1 L_f1_76
 s_waitcnt vmcnt(0)
 s_cmp_eq_u32 s61, 0
 s_cbranch_scc1 L_pf_77
 s_lshl_b32 s3, s61, 2
 s_add_u32 s3, s3, s59
 s_sub_u32 s3, s3, 4
 v_mov_b32 v3, 1
 s_mov_b64 exec, s[78:79]
 buffer_atomic_add v3, v30, s[4:7], s3 offen
 s_mov_b64 exec, -1
 s_mov_b32 s61, 0
L_pf_77:
 s_mov_b32 s8, s38
 s_and_b32 s9, s39, 0xffff
 s_mov_b32 s10, 2621440
 s_mov_b32 s11, 0x00020000
 s_mov_b32 s12, s40
 s_and_b32 s13, s41, 0xffff
 s_mov_b32 s14, 1280
 s_mov_b32 s15, 0x00020000
 v_lshlrev_b32 v130, 4, v0
 s_lshl_b32 s73, s70, 12
 s_add_u32 s74, s73, 2
 buffer_load_dwordx4 v[96:99], v130, s[8:11], s73 offen offset:0
 buffer_load_dwordx4 v[100:103], v130, s[8:11], s73 offen offset:1024
 buffer_load_dwordx4 v[112:115], v130, s[8:11], s74 offen offset:0
 buffer_load_dwordx4 v[116:119], v130, s[8:11], s74 offen offset:1024
 s_lshl_b32 s3, s70, 1
 buffer_load_ushort v128, off, s[12:15], s3
 s_branch L_f2_78
L_f1_76:
 s_waitcnt vmcnt(2)
L_f2_78:
 s_barrier
 s_mov_b32 s60, s54
 s_add_u32 s54, s54, 1
 s_mul_i32 s55, s54, 40960
 s_mul_i32 s3, s50, 10240
 s_add_u32 s55, s55, s3
 s_add_u32 s55, s55, 226492416
 ds_read_b128 v[32:35], v16 offset:0
 ds_read_b128 v[36:39], v17 offset:0
 ds_read_b128 v[40:43], v18 offset:0
 ds_read_b128 v[44:47], v19 offset:0
 s_waitcnt lgkmcnt(3)
 v_mfma_f32_32x32x16_bf16 v[64:79], v[32:35], a[0:3], 0
 ds_read_b128 v[48:51], v20 offset:0
 s_add_u32 m0, s56, 0
 s_add_u32 s3, s55, s64
 buffer_load_dwordx4 v1, s[4:7], s3 offen sc1 lds
 s_waitcnt lgkmcnt(3)
 v_mfma_f32_32x32x16_bf16 v[64:79], v[36:39], a[4:7], v[64:79]
 ds_read_b128 v[52:55], v21 offset:0
 s_waitcnt lgkmcnt(3)
 v_mfma_f32_32x32x16_bf16 v[64:79], v[40:43], a[8:11], v[64:79]
 ds_read_b128 v[56:59], v22 offset:0
 s_waitcnt lgkmcnt(3)
 v_mfma_f32_32x32x16_bf16 v[64:79], v[44:47], a[12:15], v[64:79]
 ds_read_b128 v[60:63], v23 offset:0
 s_add_u32 m0, s56, 1024
 s_add_u32 s3, s55, s64
 buffer_load_dwordx4 v24, s[4:7], s3 offen sc1 lds
 s_waitcnt lgkmcnt(3)
 v_mfma_f32_32x32x16_bf16 v[64:79], v[48:51], a[16:19], v[64:79]
 ds_read_b128 v[32:35], v16 offset:8192
 s_waitcnt lgkmcnt(3)
 v_mfma_f32_32x32x16_bf16 v[64:79], v[52:55], a[20:23], v[64:79]
 ds_read_b128 v[36:39], v17 offset:8192
 s_waitcnt lgkmcnt(3)
 v_mfma_f32_32x32x16_bf16 v[64:79], v[56:59], a[24:27], v[64:79]
 ds_read_b128 v[40:43], v18 offset:8192
 s_add_u32 m0, s56, 8192
 s_add_u32 s3, s55, s65
 buffer_load_dwordx4 v1, s[4:7], s3 offen sc1 lds
 s_waitcnt lgkmcnt(3)
 v_mfma_f32_32x32x16_bf16 v[64:79], v[60:63], a[28:31], v[64:79]
 ds_read_b128 v[44:47], v19 offset:8192
 s_waitcnt lgkmcnt(3)
 v_mfma_f32_32x32x16_bf16 v[64:79], v[32:35], a[32:35], v[64:79]
 ds_read_b128 v[48:51], v20 offset:8192
 s_waitcnt lgkmcnt(3)
 v_mfma_f32_32x32x16_bf16 v[64:79], v[36:39], a[36:39], v[64:79]
 ds_read_b128 v[52:55], v21 offset:8192
 s_add_u32 m0, s56, 9216
 s_add_u32 s3, s55, s65
 buffer_load_dwordx4 v24, s[4:7], s3 offen sc1 lds
 s_waitcnt lgkmcnt(3)
 v_mfma_f32_32x32x16_bf16 v[64:79], v[40:43], a[40:43], v[64:79]
 ds_read_b128 v[56:59], v22 offset:8192
 s_waitcnt lgkmcnt(3)
 v_mfma_f32_32x32x16_bf16 v[64:79], v[44:47], a[44:47], v[64:79]
 ds_read_b128 v[60:63], v23 offset:8192
 s_waitcnt lgkmcnt(3)
 v_mfma_f32_32x32x16_bf16 v[64:79], v[48:51], a[48:51], v[64:79]
 ds_read_b128 v[32:35], v16 offset:16384
 s_add_u32 m0, s56, 16384
 s_add_u32 s3, s55, s66
 buffer_load_dwordx4 v1, s[4:7], s3 offen sc1 lds
 s_waitcnt lgkmcnt(3)
 v_mfma_f32_32x32x16_bf16 v[64:79], v[52:55], a[52:55], v[64:79]
 ds_read_b128 v[36:39], v17 offset:16384
 s_waitcnt lgkmcnt(3)
 v_mfma_f32_32x32x16_bf16 v[64:79], v[56:59], a[56:59], v[64:79]
 ds_read_b128 v[40:43], v18 offset:16384
 s_waitcnt lgkmcnt(3)
 v_mfma_f32_32x32x16_bf16 v[64:79], v[60:63], a[60:63], v[64:79]
 ds_read_b128 v[44:47], v19 offset:16384
 s_add_u32 m0, s56, 17408
 s_add_u32 s3, s55, s66
 buffer_load_dwordx4 v24, s[4:7], s3 offen sc1 lds
 s_waitcnt lgkmcnt(3)
 v_mfma_f32_32x32x16_bf16 v[64:79], v[32:35], a[64:67], v[64:79]
 ds_read_b128 v[48:51], v20 offset:16384
 s_waitcnt lgkmcnt(3)
 v_mfma_f32_32x32x16_bf16 v[64:79], v[36:39], a[68:71], v[64:79]
 ds_read_b128 v[52:55], v21 offset:16384
 s_waitcnt lgkmcnt(3)
 v_mfma_f32_32x32x16_bf16 v[64:79], v[40:43], a[72:75], v[64:79]
 ds_read_b128 v[56:59], v22 offset:16384
 s_add_u32 m0, s56, 24576
 s_add_u32 s3, s55, s67
 buffer_load_dwordx4 v1, s[4:7], s3 offen sc1 lds
 s_waitcnt lgkmcnt(3)
 v_mfma_f32_32x32x16_bf16 v[64:79], v[44:47], a[76:79], v[64:79]
 ds_read_b128 v[60:63], v23 offset:16384
 s_waitcnt vmcnt(7)
 s_cmp_eq_u32 s61, 0
 s_cbranch_scc1 L_pf_79
 s_lshl_b32 s3, s61, 2
 s_add_u32 s3, s3, s59
 s_sub_u32 s3, s3, 4
 v_mov_b32 v3, 1
 s_mov_b64 exec, s[78:79]
 buffer_atomic_add v3, v30, s[4:7], s3 offen
 s_mov_b64 exec, -1
 s_mov_b32 s61, 0
L_pf_79:
 s_waitcnt lgkmcnt(3)
 v_mfma_f32_32x32x16_bf16 v[64:79], v[48:51], a[80:83], v[64:79]
 ds_read_b128 v[32:35], v16 offset:24576
 s_waitcnt lgkmcnt(3)
 v_mfma_f32_32x32x16_bf16 v[64:79], v[52:55], a[84:87], v[64:79]
 ds_read_b128 v[36:39], v17 offset:24576
 s_add_u32 m0, s56, 25600
 s_add_u32 s3, s55, s67
 buffer_load_dwordx4 v24, s[4:7], s3 offen sc1 lds
 s_waitcnt lgkmcnt(3)
 v_mfma_f32_32x32x16_bf16 v[64:79], v[56:59], a[88:91], v[64:79]
 ds_read_b128 v[40:43], v18 offset:24576
 s_waitcnt lgkmcnt(3)
 v_mfma_f32_32x32x16_bf16 v[64:79], v[60:63], a[92:95], v[64:79]
 ds_read_b128 v[44:47], v19 offset:24576
 s_waitcnt lgkmcnt(3)
 v_mfma_f32_32x32x16_bf16 v[64:79], v[32:35], a[96:99], v[64:79]
 ds_read_b128 v[48:51], v20 offset:24576
 s_add_u32 m0, s56, 32768
 s_add_u32 s3, s55, s68
 buffer_load_dwordx4 v1, s[4:7], s3 offen sc1 lds
 s_waitcnt lgkmcnt(3)
 v_mfma_f32_32x32x16_bf16 v[64:79], v[36:39], a[100:103], v[64:79]
 ds_read_b128 v[52:55], v21 offset:24576
 s_waitcnt lgkmcnt(3)
 v_mfma_f32_32x32x16_bf16 v[64:79], v[40:43], a[104:107], v[64:79]
 ds_read_b128 v[56:59], v22 offset:24576
 s_waitcnt lgkmcnt(3)
 v_mfma_f32_32x32x16_bf16 v[64:79], v[44:47], a[108:111], v[64:79]
 ds_read_b128 v[60:63], v23 offset:24576
 s_add_u32 m0, s56, 33792
 s_add_u32 s3, s55, s68
 buffer_load_dwordx4 v24, s[4:7], s3 offen sc1 lds
 s_waitcnt lgkmcnt(3)
 v_mfma_f32_32x32x16_bf16 v[64:79], v[48:51], a[112:115], v[64:79]
 ds_read_b128 v[32:35], v16 offset:32768
 s_waitcnt lgkmcnt(3)
 v_mfma_f32_32x32x16_bf16 v[64:79], v[52:55], a[116:119], v[64:79]
 ds_read_b128 v[36:39], v17 offset:32768
 s_waitcnt lgkmcnt(3)
 v_mfma_f32_32x32x16_bf16 v[64:79], v[56:59], a[120:123], v[64:79]
 ds_read_b128 v[40:43], v18 offset:32768
 s_waitcnt lgkmcnt(3)
 v_mfma_f32_32x32x16_bf16 v[64:79], v[60:63], a[124:127], v[64:79]
 ds_read_b128 v[44:47], v19 offset:32768
 s_waitcnt lgkmcnt(3)
 v_mfma_f32_32x32x16_bf16 v[64:79], v[32:35], a[128:131], v[64:79]
 ds_read_b128 v[48:51], v20 offset:32768
 s_waitcnt lgkmcnt(3)
 v_mfma_f32_32x32x16_bf16 v[64:79], v[36:39], a[132:135], v[64:79]
 ds_read_b128 v[52:55], v21 offset:32768
 s_waitcnt lgkmcnt(3)
 v_mfma_f32_32x32x16_bf16 v[64:79], v[40:43], a[136:139], v[64:79]
 ds_read_b128 v[56:59], v22 offset:32768
 s_waitcnt lgkmcnt(3)
 v_mfma_f32_32x32x16_bf16 v[64:79], v[44:47], a[140:143], v[64:79]
 ds_read_b128 v[60:63], v23 offset:32768
 s_waitcnt lgkmcnt(3)
 v_mfma_f32_32x32x16_bf16 v[64:79], v[48:51], a[144:147], v[64:79]
 s_waitcnt lgkmcnt(2)
 v_mfma_f32_32x32x16_bf16 v[64:79], v[52:55], a[148:151], v[64:79]
 s_waitcnt lgkmcnt(1)
 v_mfma_f32_32x32x16_bf16 v[64:79], v[56:59], a[152:155], v[64:79]
 s_waitcnt lgkmcnt(0)
 v_mfma_f32_32x32x16_bf16 v[64:79], v[60:63], a[156:159], v[64:79]
 s_lshl_b32 s3, s60, 19
 s_add_u32 s3, s3, s58
 s_xor_b32 s3, s3, s82
 s_nop 8
 v_cvt_pk_bf16_f32 v88, v64, v65
 v_cvt_pk_bf16_f32 v89, v66, v67
 v_cvt_pk_bf16_f32 v90, v72, v73
 v_cvt_pk_bf16_f32 v91, v74, v75
 buffer_store_dwordx4 v[88:91], v4, s[4:7], s3 offen offset:0 sc1
 v_cvt_pk_bf16_f32 v92, v68, v69
 v_cvt_pk_bf16_f32 v93, v70, v71
 v_cvt_pk_bf16_f32 v94, v76, v77
 v_cvt_pk_bf16_f32 v95, v78, v79
 buffer_store_dwordx4 v[92:95], v4, s[4:7], s3 offen offset:512 sc1
 s_mov_b32 s61, s54
 s_waitcnt vmcnt(2)
 s_cmp_lg_u32 s54, 4
 s_cbranch_scc1 L_cv_80
 s_waitcnt vmcnt(0)
 s_cmp_eq_u32 s61, 0
 s_cbranch_scc1 L_pf_81
 s_lshl_b32 s3, s61, 2
 s_add_u32 s3, s3, s59
 s_sub_u32 s3, s3, 4
 v_mov_b32 v3, 1
 s_mov_b64 exec, s[78:79]
 buffer_atomic_add v3, v30, s[4:7], s3 offen
 s_mov_b64 exec, -1
 s_mov_b32 s61, 0
L_pf_81:
 s_mul_i32 s71, s50, 13312
 s_add_u32 s71, s71, 81920
 s_mov_b32 s70, s75
 s_mov_b32 s69, 640
 s_getpc_b64 s[76:77]
L_ca_82:
 s_add_u32 s76, s76, L_conv0-L_ca_82
 s_addc_u32 s77, s77, -1
 s_swappc_b64 s[76:77], s[76:77]
 s_waitcnt vmcnt(0)
 s_barrier
 s_cmp_lg_u32 s50, 3
 s_cbranch_scc1 L_ar_83
 s_mov_b32 s96, s44
 s_and_b32 s97, s45, 0xffff
 s_mov_b32 s98, 256
 s_mov_b32 s99, 0x00020000
 v_mov_b32 v1, 1
 s_mov_b64 exec, 1
 buffer_atomic_add v1, off, s[96:99], 0 offset:8 sc0
 s_waitcnt vmcnt(0)
 v_cmp_eq_u32 vcc, 159, v1
 s_cbranch_vccz L_aw_84
 buffer_store_dword v1, off, s[96:99], 0 offset:136 sc1
L_aw_84:
 s_mov_b64 exec, -1
L_ar_83:
 v_lshrrev_b32 v1, 4, v0
 s_mov_b32 s3, 1280
 v_mul_lo_u32 v1, v1, s3
 v_and_b32 v3, 15, v0
 v_lshl_add_u32 v1, v3, 4, v1
 v_add_u32 v6, 5120, v1
 v_mov_b32 v24, v6
 v_and_b32 v2, 31, v0
 v_lshlrev_b32 v2, 8, v2
 v_lshrrev_b32 v4, 5, v0
 v_xor_b32 v4, v4, v3
 v_xor_b32 v8, 0, v4
 v_lshl_add_u32 v8, v8, 4, v2
 v_add_u32 v16, 40960, v8
 v_xor_b32 v9, 2, v4
 v_lshl_add_u32 v9, v9, 4, v2
 v_add_u32 v17, 40960, v9
 v_xor_b32 v10, 4, v4
 v_lshl_add_u32 v10, v10, 4, v2
 v_add_u32 v18, 40960, v10
 v_xor_b32 v11, 6, v4
 v_lshl_add_u32 v11, v11, 4, v2
 v_add_u32 v19, 40960, v11
 v_xor_b32 v12, 8, v4
 v_lshl_add_u32 v12, v12, 4, v2
 v_add_u32 v20, 40960, v12
 v_xor_b32 v13, 10, v4
 v_lshl_add_u32 v13, v13, 4, v2
 v_add_u32 v21, 40960, v13
 v_xor_b32 v14, 12, v4
 v_lshl_add_u32 v14, v14, 4, v2
 v_add_u32 v22, 40960, v14
 v_xor_b32 v15, 14, v4
 v_lshl_add_u32 v15, v15, 4, v2
 v_add_u32 v23, 40960, v15
 v_lshrrev_b32 v4, 5, v0
 v_lshlrev_b32 v4, 8, v4
 v_lshl_add_u32 v4, v3, 4, v4
 v_and_b32 v2, 16, v0
 v_lshl_add_u32 v4, v2, 6, v4
 s_lshl_b32 s3, s50, 11
 v_add_u32 v4, s3, v4
 v_mul_u32_u24 v5, 24576, v0
 v_mov_b32 v7, 163776
 v_mul_u32_u24 v30, 16384, v0
L_cv_80:
 s_cmp_lg_u32 s54, 10
 s_cbranch_scc1 L_cb_85
 s_cmp_lg_u32 s50, 0
 s_cbranch_scc1 L_ww_86
 s_mov_b32 s96, s44
 s_and_b32 s97, s45, 0xffff
 s_mov_b32 s98, 256
 s_mov_b32 s99, 0x00020000
 v_mov_b32 v25, 200
 s_mov_b32 s51, 0
 s_mov_b64 exec, 1
L_wb_87:
 buffer_load_dword v26, v25, s[96:99], 0 offen sc1
 s_waitcnt vmcnt(0)
 v_cmp_eq_u32 vcc, 0, v26
 s_cbranch_vccz L_wbd_88
 s_sleep 2
 s_add_u32 s51, s51, 1
 s_cmp_lt_u32 s51, 131072
 s_cbranch_scc1 L_wb_87
 s_branch L_bail
L_wbd_88:
 s_mov_b64 exec, -1
L_ww_86:
 s_barrier
L_cb_85:
 s_cmp_lt_u32 s54, 16
 s_cbranch_scc1 L_qkvv_pre
 s_waitcnt vmcnt(0)
 s_cmp_eq_u32 s61, 0
 s_cbranch_scc1 L_pf_90
 s_lshl_b32 s3, s61, 2
 s_add_u32 s3, s3, s59
 s_sub_u32 s3, s3, 4
 v_mov_b32 v3, 1
 s_mov_b64 exec, s[78:79]
 buffer_atomic_add v3, v30, s[4:7], s3 offen
 s_mov_b64 exec, -1
 s_mov_b32 s61, 0
L_pf_90:
 s_lshl_b32 s62, s62, 8
 s_add_u32 s62, s62, 126976
 s_add_u32 s63, s59, 8128
L_qkvv_block:
 s_lshl_b32 s55, s54, 2
 s_add_u32 s55, s55, s62
 s_sub_u32 s55, s55, 64
 s_cmp_lg_u32 s50, 0
 s_cselect_b32 s3, 268435456, s55
 v_mov_b32 v6, 8
 s_mov_b64 exec, 15
 v_mov_b32 v6, 0
 buffer_atomic_add v6, v5, s[4:7], s3 offen sc0
 s_mov_b64 exec, -1
 s_waitcnt vmcnt(0)
 s_cmp_eq_u32 s61, 0
 s_cbranch_scc1 L_pf_93
 s_lshl_b32 s3, s61, 2
 s_add_u32 s3, s3, s59
 s_sub_u32 s3, s3, 4
 v_mov_b32 v3, 1
 s_mov_b64 exec, s[78:79]
 buffer_atomic_add v3, v30, s[4:7], s3 offen
 s_mov_b64 exec, -1
 s_mov_b32 s61, 0
L_pf_93:
 s_cmp_lg_u32 s50, 0
 s_cbranch_scc1 L_w_91
 v_cmp_gt_u32 vcc, 8, v6
 s_cbranch_vccz L_w_91
 s_mov_b32 s51, 0
 s_mov_b64 exec, 15
 v_mov_b32 v28, 0
 buffer_atomic_add v28, v5, s[4:7], s55 offen sc0
 s_sleep 5
L_wc_94:
 v_mov_b32 v29, 0
 buffer_atomic_add v29, v5, s[4:7], s55 offen sc0
 s_waitcnt vmcnt(1)
 v_cmp_gt_u32 vcc, 8, v28
 s_cbranch_vccz L_wcd_95
 v_mov_b32 v28, 0
 buffer_atomic_add v28, v5, s[4:7], s55 offen sc0
 s_waitcnt vmcnt(1)
 v_cmp_gt_u32 vcc, 8, v29
 s_cbranch_vccz L_wcd_95
 s_add_u32 s51, s51, 1
 s_cmp_lt_u32 s51, 131072
 s_cbranch_scc1 L_wc_94
 s_branch L_bail
L_wcd_95:
 s_mov_b64 exec, -1
L_w_91:
 s_barrier
 s_branch L_qkvv_loop
L_qkvv_fast:
 s_cmp_lg_u32 s54, 32
 s_cbranch_scc1 L_c2_97
 s_cmp_lg_u32 s50, 0
 s_cbranch_scc1 L_ww_98
 s_mov_b32 s96, s44
 s_and_b32 s97, s45, 0xffff
 s_mov_b32 s98, 256
 s_mov_b32 s99, 0x00020000
 v_mov_b32 v25, 140
 s_mov_b32 s51, 0
 s_mov_b64 exec, 1
L_wb_99:
 buffer_load_dword v26, v25, s[96:99], 0 offen sc1
 s_waitcnt vmcnt(0)
 v_cmp_eq_u32 vcc, 0, v26
 s_cbranch_vccz L_wbd_100
 s_sleep 2
 s_add_u32 s51, s51, 1
 s_cmp_lt_u32 s51, 131072
 s_cbranch_scc1 L_wb_99
 s_branch L_bail
L_wbd_100:
 s_mov_b64 exec, -1
L_ww_98:
 s_barrier
L_c2_97:
 s_sub_u32 s60, s54, 16
 s_lshl_b32 s70, s54, 2
 s_add_u32 s70, s70, s62
 s_sub_u32 s70, s70, 60
 s_cmp_lg_u32 s50, 0
 s_cselect_b32 s70, 268435456, s70
 s_min_u32 s51, s54, 63
 s_mul_i32 s55, s51, 40960
 s_mul_i32 s3, s50, 10240
 s_add_u32 s55, s55, s3
 s_add_u32 s55, s55, 226492416
 ds_read_b128 v[32:35], v16 offset:0
 ds_read_b128 v[36:39], v17 offset:0
 ds_read_b128 v[40:43], v18 offset:0
 ds_read_b128 v[44:47], v19 offset:0
 s_waitcnt lgkmcnt(3)
 v_mfma_f32_32x32x16_bf16 v[64:79], v[32:35], a[0:3], 0
 ds_read_b128 v[48:51], v20 offset:0
 s_add_u32 m0, s56, 0
 s_add_u32 s3, s55, s64
 buffer_load_dwordx4 v1, s[4:7], s3 offen sc1 lds
 s_waitcnt lgkmcnt(3)
 v_mfma_f32_32x32x16_bf16 v[64:79], v[36:39], a[4:7], v[64:79]
 ds_read_b128 v[52:55], v21 offset:0
 s_waitcnt lgkmcnt(3)
 v_mfma_f32_32x32x16_bf16 v[64:79], v[40:43], a[8:11], v[64:79]
 ds_read_b128 v[56:59], v22 offset:0
 s_waitcnt lgkmcnt(3)
 v_mfma_f32_32x32x16_bf16 v[64:79], v[44:47], a[12:15], v[64:79]
 ds_read_b128 v[60:63], v23 offset:0
 s_add_u32 m0, s56, 1024
 s_add_u32 s3, s55, s64
 buffer_load_dwordx4 v24, s[4:7], s3 offen sc1 lds
 s_waitcnt lgkmcnt(3)
 v_mfma_f32_32x32x16_bf16 v[64:79], v[48:51], a[16:19], v[64:79]
 ds_read_b128 v[32:35], v16 offset:8192
 s_waitcnt lgkmcnt(3)
 v_mfma_f32_32x32x16_bf16 v[64:79], v[52:55], a[20:23], v[64:79]
 ds_read_b128 v[36:39], v17 offset:8192
 s_waitcnt lgkmcnt(3)
 v_mfma_f32_32x32x16_bf16 v[64:79], v[56:59], a[24:27], v[64:79]
 ds_read_b128 v[40:43], v18 offset:8192
 s_add_u32 m0, s56, 8192
 s_add_u32 s3, s55, s65
 buffer_load_dwordx4 v1, s[4:7], s3 offen sc1 lds
 s_waitcnt lgkmcnt(3)
 v_mfma_f32_32x32x16_bf16 v[64:79], v[60:63], a[28:31], v[64:79]
 ds_read_b128 v[44:47], v19 offset:8192
 s_waitcnt lgkmcnt(3)
 v_mfma_f32_32x32x16_bf16 v[64:79], v[32:35], a[32:35], v[64:79]
 ds_read_b128 v[48:51], v20 offset:8192
 s_waitcnt lgkmcnt(3)
 v_mfma_f32_32x32x16_bf16 v[64:79], v[36:39], a[36:39], v[64:79]
 ds_read_b128 v[52:55], v21 offset:8192
 s_add_u32 m0, s56, 9216
 s_add_u32 s3, s55, s65
 buffer_load_dwordx4 v24, s[4:7], s3 offen sc1 lds
 s_waitcnt lgkmcnt(3)
 v_mfma_f32_32x32x16_bf16 v[64:79], v[40:43], a[40:43], v[64:79]
 ds_read_b128 v[56:59], v22 offset:8192
 s_waitcnt lgkmcnt(3)
 v_mfma_f32_32x32x16_bf16 v[64:79], v[44:47], a[44:47], v[64:79]
 ds_read_b128 v[60:63], v23 offset:8192
 s_waitcnt lgkmcnt(3)
 v_mfma_f32_32x32x16_bf16 v[64:79], v[48:51], a[48:51], v[64:79]
 ds_read_b128 v[32:35], v16 offset:16384
 s_add_u32 m0, s56, 16384
 s_add_u32 s3, s55, s66
 buffer_load_dwordx4 v1, s[4:7], s3 offen sc1 lds
 s_waitcnt lgkmcnt(3)
 v_mfma_f32_32x32x16_bf16 v[64:79], v[52:55], a[52:55], v[64:79]
 ds_read_b128 v[36:39], v17 offset:16384
 s_waitcnt lgkmcnt(3)
 v_mfma_f32_32x32x16_bf16 v[64:79], v[56:59], a[56:59], v[64:79]
 ds_read_b128 v[40:43], v18 offset:16384
 s_waitcnt lgkmcnt(3)
 v_mfma_f32_32x32x16_bf16 v[64:79], v[60:63], a[60:63], v[64:79]
 ds_read_b128 v[44:47], v19 offset:16384
 s_add_u32 m0, s56, 17408
 s_add_u32 s3, s55, s66
 buffer_load_dwordx4 v24, s[4:7], s3 offen sc1 lds
 s_waitcnt lgkmcnt(3)
 v_mfma_f32_32x32x16_bf16 v[64:79], v[32:35], a[64:67], v[64:79]
 ds_read_b128 v[48:51], v20 offset:16384
 s_waitcnt lgkmcnt(3)
 v_mfma_f32_32x32x16_bf16 v[64:79], v[36:39], a[68:71], v[64:79]
 ds_read_b128 v[52:55], v21 offset:16384
 s_waitcnt lgkmcnt(3)
 v_mfma_f32_32x32x16_bf16 v[64:79], v[40:43], a[72:75], v[64:79]
 ds_read_b128 v[56:59], v22 offset:16384
 s_add_u32 m0, s56, 24576
 s_add_u32 s3, s55, s67
 buffer_load_dwordx4 v1, s[4:7], s3 offen sc1 lds
 s_waitcnt lgkmcnt(3)
 v_mfma_f32_32x32x16_bf16 v[64:79], v[44:47], a[76:79], v[64:79]
 ds_read_b128 v[60:63], v23 offset:16384
 s_waitcnt lgkmcnt(3)
 v_mfma_f32_32x32x16_bf16 v[64:79], v[48:51], a[80:83], v[64:79]
 ds_read_b128 v[32:35], v16 offset:24576
 s_waitcnt lgkmcnt(3)
 v_mfma_f32_32x32x16_bf16 v[64:79], v[52:55], a[84:87], v[64:79]
 ds_read_b128 v[36:39], v17 offset:24576
 s_add_u32 m0, s56, 25600
 s_add_u32 s3, s55, s67
 buffer_load_dwordx4 v24, s[4:7], s3 offen sc1 lds
 s_waitcnt lgkmcnt(3)
 v_mfma_f32_32x32x16_bf16 v[64:79], v[56:59], a[88:91], v[64:79]
 ds_read_b128 v[40:43], v18 offset:24576
 s_waitcnt lgkmcnt(3)
 v_mfma_f32_32x32x16_bf16 v[64:79], v[60:63], a[92:95], v[64:79]
 ds_read_b128 v[44:47], v19 offset:24576
 s_waitcnt lgkmcnt(3)
 v_mfma_f32_32x32x16_bf16 v[64:79], v[32:35], a[96:99], v[64:79]
 ds_read_b128 v[48:51], v20 offset:24576
 s_add_u32 m0, s56, 32768
 s_add_u32 s3, s55, s68
 buffer_load_dwordx4 v1, s[4:7], s3 offen sc1 lds
 s_waitcnt lgkmcnt(3)
 v_mfma_f32_32x32x16_bf16 v[64:79], v[36:39], a[100:103], v[64:79]
 ds_read_b128 v[52:55], v21 offset:24576
 s_waitcnt lgkmcnt(3)
 v_mfma_f32_32x32x16_bf16 v[64:79], v[40:43], a[104:107], v[64:79]
 ds_read_b128 v[56:59], v22 offset:24576
 s_waitcnt lgkmcnt(3)
 v_mfma_f32_32x32x16_bf16 v[64:79], v[44:47], a[108:111], v[64:79]
 ds_read_b128 v[60:63], v23 offset:24576
 s_add_u32 m0, s56, 33792
 s_add_u32 s3, s55, s68
 buffer_load_dwordx4 v24, s[4:7], s3 offen sc1 lds
 s_waitcnt lgkmcnt(3)
 v_mfma_f32_32x32x16_bf16 v[64:79], v[48:51], a[112:115], v[64:79]
 ds_read_b128 v[32:35], v16 offset:32768
 s_waitcnt lgkmcnt(3)
 v_mfma_f32_32x32x16_bf16 v[64:79], v[52:55], a[116:119], v[64:79]
 ds_read_b128 v[36:39], v17 offset:32768
 v_mov_b32 v6, 8
 s_mov_b64 exec, 15
 v_mov_b32 v6, 0
 buffer_atomic_add v6, v5, s[4:7], s70 offen sc0
 s_mov_b64 exec, -1
 s_waitcnt lgkmcnt(3)
 v_mfma_f32_32x32x16_bf16 v[64:79], v[56:59], a[120:123], v[64:79]
 ds_read_b128 v[40:43], v18 offset:32768
 s_waitcnt lgkmcnt(3)
 v_mfma_f32_32x32x16_bf16 v[64:79], v[60:63], a[124:127], v[64:79]
 ds_read_b128 v[44:47], v19 offset:32768
 s_waitcnt lgkmcnt(3)
 v_mfma_f32_32x32x16_bf16 v[64:79], v[32:35], a[128:131], v[64:79]
 ds_read_b128 v[48:51], v20 offset:32768
 s_waitcnt lgkmcnt(3)
 v_mfma_f32_32x32x16_bf16 v[64:79], v[36:39], a[132:135], v[64:79]
 ds_read_b128 v[52:55], v21 offset:32768
 s_waitcnt lgkmcnt(3)
 v_mfma_f32_32x32x16_bf16 v[64:79], v[40:43], a[136:139], v[64:79]
 ds_read_b128 v[56:59], v22 offset:32768
 s_waitcnt lgkmcnt(3)
 v_mfma_f32_32x32x16_bf16 v[64:79], v[44:47], a[140:143], v[64:79]
 ds_read_b128 v[60:63], v23 offset:32768
 s_waitcnt lgkmcnt(3)
 v_mfma_f32_32x32x16_bf16 v[64:79], v[48:51], a[144:147], v[64:79]
 s_waitcnt lgkmcnt(2)
 v_mfma_f32_32x32x16_bf16 v[64:79], v[52:55], a[148:151], v[64:79]
 s_waitcnt lgkmcnt(1)
 v_mfma_f32_32x32x16_bf16 v[64:79], v[56:59], a[152:155], v[64:79]
 s_waitcnt lgkmcnt(0)
 v_mfma_f32_32x32x16_bf16 v[64:79], v[60:63], a[156:159], v[64:79]
 s_lshl_b32 s3, s60, 19
 s_add_u32 s3, s3, s58
 s_xor_b32 s3, s3, s82
 s_add_u32 s3, s3, 33554432
 s_nop 8
 v_cvt_pk_bf16_f32 v88, v64, v65
 v_cvt_pk_bf16_f32 v89, v66, v67
 v_cvt_pk_bf16_f32 v90, v72, v73
 v_cvt_pk_bf16_f32 v91, v74, v75
 buffer_store_dwordx4 v[88:91], v4, s[4:7], s3 offen offset:0 sc1
 v_cvt_pk_bf16_f32 v92, v68, v69
 v_cvt_pk_bf16_f32 v93, v70, v71
 v_cvt_pk_bf16_f32 v94, v76, v77
 v_cvt_pk_bf16_f32 v95, v78, v79
 buffer_store_dwordx4 v[92:95], v4, s[4:7], s3 offen offset:512 sc1
 s_branch L_qkvv_mid
L_qkvv_loop:
 s_cmp_lg_u32 s54, 32
 s_cbranch_scc1 L_c2_101
 s_cmp_lg_u32 s50, 0
 s_cbranch_scc1 L_ww_102
 s_mov_b32 s96, s44
 s_and_b32 s97, s45, 0xffff
 s_mov_b32 s98, 256
 s_mov_b32 s99, 0x00020000
 v_mov_b32 v25, 140
 s_mov_b32 s51, 0
 s_mov_b64 exec, 1
L_wb_103:
 buffer_load_dword v26, v25, s[96:99], 0 offen sc1
 s_waitcnt vmcnt(0)
 v_cmp_eq_u32 vcc, 0, v26
 s_cbranch_vccz L_wbd_104
 s_sleep 2
 s_add_u32 s51, s51, 1
 s_cmp_lt_u32 s51, 131072
 s_cbranch_scc1 L_wb_103
 s_branch L_bail
L_wbd_104:
 s_mov_b64 exec, -1
L_ww_102:
 s_barrier
L_c2_101:
 s_sub_u32 s60, s54, 16
 s_mul_i32 s55, s60, 40960
 s_mul_i32 s3, s50, 10240
 s_add_u32 s55, s55, s3
 s_add_u32 s55, s55, 229113856
 s_add_u32 m0, s56, 40960
 s_add_u32 s3, s55, s64
 buffer_load_dwordx4 v1, s[4:7], s3 offen sc1 lds
 s_add_u32 m0, s56, 41984
 s_add_u32 s3, s55, s64
 buffer_load_dwordx4 v24, s[4:7], s3 offen sc1 lds
 s_add_u32 m0, s56, 49152
 s_add_u32 s3, s55, s65
 buffer_load_dwordx4 v1, s[4:7], s3 offen sc1 lds
 s_add_u32 m0, s56, 50176
 s_add_u32 s3, s55, s65
 buffer_load_dwordx4 v24, s[4:7], s3 offen sc1 lds
 s_add_u32 m0, s56, 57344
 s_add_u32 s3, s55, s66
 buffer_load_dwordx4 v1, s[4:7], s3 offen sc1 lds
 s_add_u32 m0, s56, 58368
 s_add_u32 s3, s55, s66
 buffer_load_dwordx4 v24, s[4:7], s3 offen sc1 lds
 s_add_u32 m0, s56, 65536
 s_add_u32 s3, s55, s67
 buffer_load_dwordx4 v1, s[4:7], s3 offen sc1 lds
 s_add_u32 m0, s56, 66560
 s_add_u32 s3, s55, s67
 buffer_load_dwordx4 v24, s[4:7], s3 offen sc1 lds
 s_add_u32 m0, s56, 73728
 s_add_u32 s3, s55, s68
 buffer_load_dwordx4 v1, s[4:7], s3 offen sc1 lds
 s_add_u32 m0, s56, 74752
 s_add_u32 s3, s55, s68
 buffer_load_dwordx4 v24, s[4:7], s3 offen sc1 lds
 s_lshl_b32 s70, s54, 2
 s_add_u32 s70, s70, s62
 s_sub_u32 s70, s70, 60
 s_cmp_lg_u32 s50, 0
 s_cselect_b32 s70, 268435456, s70
 s_min_u32 s51, s54, 63
 s_mul_i32 s55, s51, 40960
 s_mul_i32 s3, s50, 10240
 s_add_u32 s55, s55, s3
 s_add_u32 s55, s55, 226492416
 s_waitcnt vmcnt(8)
 s_barrier
 ds_read_b128 v[32:35], v16 offset:0
 ds_read_b128 v[36:39], v17 offset:0
 ds_read_b128 v[40:43], v18 offset:0
 ds_read_b128 v[44:47], v19 offset:0
 s_waitcnt lgkmcnt(3)
 v_mfma_f32_32x32x16_bf16 v[64:79], v[32:35], a[0:3], 0
 ds_read_b128 v[48:51], v20 offset:0
 s_add_u32 m0, s56, 0
 s_add_u32 s3, s55, s64
 buffer_load_dwordx4 v1, s[4:7], s3 offen sc1 lds
 s_waitcnt lgkmcnt(3)
 v_mfma_f32_32x32x16_bf16 v[64:79], v[36:39], a[4:7], v[64:79]
 ds_read_b128 v[52:55], v21 offset:0
 s_waitcnt lgkmcnt(3)
 v_mfma_f32_32x32x16_bf16 v[64:79], v[40:43], a[8:11], v[64:79]
 ds_read_b128 v[56:59], v22 offset:0
 s_waitcnt lgkmcnt(3)
 v_mfma_f32_32x32x16_bf16 v[64:79], v[44:47], a[12:15], v[64:79]
 ds_read_b128 v[60:63], v23 offset:0
 s_add_u32 m0, s56, 1024
 s_add_u32 s3, s55, s64
 buffer_load_dwordx4 v24, s[4:7], s3 offen sc1 lds
 s_waitcnt lgkmcnt(3)
 v_mfma_f32_32x32x16_bf16 v[64:79], v[48:51], a[16:19], v[64:79]
 s_waitcnt vmcnt(8)
 s_barrier
 ds_read_b128 v[32:35], v16 offset:8192
 s_waitcnt lgkmcnt(3)
 v_mfma_f32_32x32x16_bf16 v[64:79], v[52:55], a[20:23], v[64:79]
 ds_read_b128 v[36:39], v17 offset:8192
 s_waitcnt lgkmcnt(3)
 v_mfma_f32_32x32x16_bf16 v[64:79], v[56:59], a[24:27], v[64:79]
 ds_read_b128 v[40:43], v18 offset:8192
 s_add_u32 m0, s56, 8192
 s_add_u32 s3, s55, s65
 buffer_load_dwordx4 v1, s[4:7], s3 offen sc1 lds
 s_waitcnt lgkmcnt(3)
 v_mfma_f32_32x32x16_bf16 v[64:79], v[60:63], a[28:31], v[64:79]
 ds_read_b128 v[44:47], v19 offset:8192
 s_waitcnt lgkmcnt(3)
 v_mfma_f32_32x32x16_bf16 v[64:79], v[32:35], a[32:35], v[64:79]
 ds_read_b128 v[48:51], v20 offset:8192
 s_waitcnt lgkmcnt(3)
 v_mfma_f32_32x32x16_bf16 v[64:79], v[36:39], a[36:39], v[64:79]
 ds_read_b128 v[52:55], v21 offset:8192
 s_add_u32 m0, s56, 9216
 s_add_u32 s3, s55, s65
 buffer_load_dwordx4 v24, s[4:7], s3 offen sc1 lds
 s_waitcnt lgkmcnt(3)
 v_mfma_f32_32x32x16_bf16 v[64:79], v[40:43], a[40:43], v[64:79]
 ds_read_b128 v[56:59], v22 offset:8192
 s_waitcnt lgkmcnt(3)
 v_mfma_f32_32x32x16_bf16 v[64:79], v[44:47], a[44:47], v[64:79]
 ds_read_b128 v[60:63], v23 offset:8192
 s_waitcnt lgkmcnt(3)
 v_mfma_f32_32x32x16_bf16 v[64:79], v[48:51], a[48:51], v[64:79]
 s_waitcnt vmcnt(8)
 s_barrier
 ds_read_b128 v[32:35], v16 offset:16384
 s_add_u32 m0, s56, 16384
 s_add_u32 s3, s55, s66
 buffer_load_dwordx4 v1, s[4:7], s3 offen sc1 lds
 s_waitcnt lgkmcnt(3)
 v_mfma_f32_32x32x16_bf16 v[64:79], v[52:55], a[52:55], v[64:79]
 ds_read_b128 v[36:39], v17 offset:16384
 s_waitcnt lgkmcnt(3)
 v_mfma_f32_32x32x16_bf16 v[64:79], v[56:59], a[56:59], v[64:79]
 ds_read_b128 v[40:43], v18 offset:16384
 s_waitcnt lgkmcnt(3)
 v_mfma_f32_32x32x16_bf16 v[64:79], v[60:63], a[60:63], v[64:79]
 ds_read_b128 v[44:47], v19 offset:16384
 s_add_u32 m0, s56, 17408
 s_add_u32 s3, s55, s66
 buffer_load_dwordx4 v24, s[4:7], s3 offen sc1 lds
 s_waitcnt lgkmcnt(3)
 v_mfma_f32_32x32x16_bf16 v[64:79], v[32:35], a[64:67], v[64:79]
 ds_read_b128 v[48:51], v20 offset:16384
 s_waitcnt lgkmcnt(3)
 v_mfma_f32_32x32x16_bf16 v[64:79], v[36:39], a[68:71], v[64:79]
 ds_read_b128 v[52:55], v21 offset:16384
 s_waitcnt lgkmcnt(3)
 v_mfma_f32_32x32x16_bf16 v[64:79], v[40:43], a[72:75], v[64:79]
 ds_read_b128 v[56:59], v22 offset:16384
 s_add_u32 m0, s56, 24576
 s_add_u32 s3, s55, s67
 buffer_load_dwordx4 v1, s[4:7], s3 offen sc1 lds
 s_waitcnt lgkmcnt(3)
 v_mfma_f32_32x32x16_bf16 v[64:79], v[44:47], a[76:79], v[64:79]
 ds_read_b128 v[60:63], v23 offset:16384
 s_waitcnt lgkmcnt(3)
 v_mfma_f32_32x32x16_bf16 v[64:79], v[48:51], a[80:83], v[64:79]
 s_waitcnt vmcnt(9)
 s_barrier
 ds_read_b128 v[32:35], v16 offset:24576
 s_waitcnt lgkmcnt(3)
 v_mfma_f32_32x32x16_bf16 v[64:79], v[52:55], a[84:87], v[64:79]
 ds_read_b128 v[36:39], v17 offset:24576
 s_add_u32 m0, s56, 25600
 s_add_u32 s3, s55, s67
 buffer_load_dwordx4 v24, s[4:7], s3 offen sc1 lds
 s_waitcnt lgkmcnt(3)
 v_mfma_f32_32x32x16_bf16 v[64:79], v[56:59], a[88:91], v[64:79]
 ds_read_b128 v[40:43], v18 offset:24576
 s_waitcnt lgkmcnt(3)
 v_mfma_f32_32x32x16_bf16 v[64:79], v[60:63], a[92:95], v[64:79]
 ds_read_b128 v[44:47], v19 offset:24576
 s_waitcnt lgkmcnt(3)
 v_mfma_f32_32x32x16_bf16 v[64:79], v[32:35], a[96:99], v[64:79]
 ds_read_b128 v[48:51], v20 offset:24576
 s_add_u32 m0, s56, 32768
 s_add_u32 s3, s55, s68
 buffer_load_dwordx4 v1, s[4:7], s3 offen sc1 lds
 s_waitcnt lgkmcnt(3)
 v_mfma_f32_32x32x16_bf16 v[64:79], v[36:39], a[100:103], v[64:79]
 ds_read_b128 v[52:55], v21 offset:24576
 s_waitcnt lgkmcnt(3)
 v_mfma_f32_32x32x16_bf16 v[64:79], v[40:43], a[104:107], v[64:79]
 ds_read_b128 v[56:59], v22 offset:24576
 s_waitcnt lgkmcnt(3)
 v_mfma_f32_32x32x16_bf16 v[64:79], v[44:47], a[108:111], v[64:79]
 ds_read_b128 v[60:63], v23 offset:24576
 s_add_u32 m0, s56, 33792
 s_add_u32 s3, s55, s68
 buffer_load_dwordx4 v24, s[4:7], s3 offen sc1 lds
 s_waitcnt lgkmcnt(3)
 v_mfma_f32_32x32x16_bf16 v[64:79], v[48:51], a[112:115], v[64:79]
 s_waitcnt vmcnt(10)
 s_barrier
 ds_read_b128 v[32:35], v16 offset:32768
 s_waitcnt lgkmcnt(3)
 v_mfma_f32_32x32x16_bf16 v[64:79], v[52:55], a[116:119], v[64:79]
 ds_read_b128 v[36:39], v17 offset:32768
 v_mov_b32 v6, 8
 s_mov_b64 exec, 15
 v_mov_b32 v6, 0
 buffer_atomic_add v6, v5, s[4:7], s70 offen sc0
 s_mov_b64 exec, -1
 s_waitcnt lgkmcnt(3)
 v_mfma_f32_32x32x16_bf16 v[64:79], v[56:59], a[120:123], v[64:79]
 ds_read_b128 v[40:43], v18 offset:32768
 s_waitcnt lgkmcnt(3)
 v_mfma_f32_32x32x16_bf16 v[64:79], v[60:63], a[124:127], v[64:79]
 ds_read_b128 v[44:47], v19 offset:32768
 s_waitcnt lgkmcnt(3)
 v_mfma_f32_32x32x16_bf16 v[64:79], v[32:35], a[128:131], v[64:79]
 ds_read_b128 v[48:51], v20 offset:32768
 s_waitcnt lgkmcnt(3)
 v_mfma_f32_32x32x16_bf16 v[64:79], v[36:39], a[132:135], v[64:79]
 ds_read_b128 v[52:55], v21 offset:32768
 s_waitcnt lgkmcnt(3)
 v_mfma_f32_32x32x16_bf16 v[64:79], v[40:43], a[136:139], v[64:79]
 ds_read_b128 v[56:59], v22 offset:32768
 s_waitcnt lgkmcnt(3)
 v_mfma_f32_32x32x16_bf16 v[64:79], v[44:47], a[140:143], v[64:79]
 ds_read_b128 v[60:63], v23 offset:32768
 s_waitcnt lgkmcnt(3)
 v_mfma_f32_32x32x16_bf16 v[64:79], v[48:51], a[144:147], v[64:79]
 s_waitcnt lgkmcnt(2)
 v_mfma_f32_32x32x16_bf16 v[64:79], v[52:55], a[148:151], v[64:79]
 s_waitcnt lgkmcnt(1)
 v_mfma_f32_32x32x16_bf16 v[64:79], v[56:59], a[152:155], v[64:79]
 s_waitcnt lgkmcnt(0)
 v_mfma_f32_32x32x16_bf16 v[64:79], v[60:63], a[156:159], v[64:79]
 s_lshl_b32 s3, s60, 19
 s_add_u32 s3, s3, s58
 s_xor_b32 s3, s3, s82
 s_add_u32 s3, s3, 33554432
 s_nop 8
 v_cvt_pk_bf16_f32 v88, v64, v65
 v_cvt_pk_bf16_f32 v89, v66, v67
 v_cvt_pk_bf16_f32 v90, v72, v73
 v_cvt_pk_bf16_f32 v91, v74, v75
 buffer_store_dwordx4 v[88:91], v4, s[4:7], s3 offen offset:0 sc1
 v_cvt_pk_bf16_f32 v92, v68, v69
 v_cvt_pk_bf16_f32 v93, v70, v71
 v_cvt_pk_bf16_f32 v94, v76, v77
 v_cvt_pk_bf16_f32 v95, v78, v79
 buffer_store_dwordx4 v[92:95], v4, s[4:7], s3 offen offset:512 sc1
L_qkvv_mid:
 s_cmp_ge_u32 s54, 64
 s_cbranch_scc1 L_n0_96
 s_waitcnt vmcnt(2)
 s_cmp_lg_u32 s50, 0
 s_cbranch_scc1 L_w_105
 v_cmp_gt_u32 vcc, 8, v6
 s_nop 1
 v_mov_b32 v3, vcc_lo
 ds_write_b32 v7, v3
 s_waitcnt lgkmcnt(0)
L_w_105:
 s_barrier
 ds_read_b32 v3, v7
 s_waitcnt lgkmcnt(0)
 v_readfirstlane_b32 s3, v3
 s_mov_b32 s69, s3
 s_add_u32 s51, s60, 1
 s_mov_b32 s60, s54
 s_mul_i32 s55, s51, 40960
 s_mul_i32 s3, s50, 10240
 s_add_u32 s55, s55, s3
 s_add_u32 s55, s55, 229113856
 s_cmp_eq_u32 s69, 0
 s_cselect_b32 s55, s55, 268435456
 ds_read_b128 v[32:35], v8 offset:0
 ds_read_b128 v[36:39], v9 offset:0
 ds_read_b128 v[40:43], v10 offset:0
 ds_read_b128 v[44:47], v11 offset:0
 s_waitcnt lgkmcnt(3)
 v_mfma_f32_32x32x16_bf16 v[64:79], v[32:35], a[0:3], 0
 ds_read_b128 v[48:51], v12 offset:0
 s_add_u32 m0, s56, 40960
 s_add_u32 s3, s55, s64
 buffer_load_dwordx4 v1, s[4:7], s3 offen sc1 lds
 s_waitcnt lgkmcnt(3)
 v_mfma_f32_32x32x16_bf16 v[64:79], v[36:39], a[4:7], v[64:79]
 ds_read_b128 v[52:55], v13 offset:0
 s_waitcnt lgkmcnt(3)
 v_mfma_f32_32x32x16_bf16 v[64:79], v[40:43], a[8:11], v[64:79]
 ds_read_b128 v[56:59], v14 offset:0
 s_waitcnt lgkmcnt(3)
 v_mfma_f32_32x32x16_bf16 v[64:79], v[44:47], a[12:15], v[64:79]
 ds_read_b128 v[60:63], v15 offset:0
 s_add_u32 m0, s56, 41984
 s_add_u32 s3, s55, s64
 buffer_load_dwordx4 v24, s[4:7], s3 offen sc1 lds
 s_waitcnt lgkmcnt(3)
 v_mfma_f32_32x32x16_bf16 v[64:79], v[48:51], a[16:19], v[64:79]
 ds_read_b128 v[32:35], v8 offset:8192
 s_waitcnt lgkmcnt(3)
 v_mfma_f32_32x32x16_bf16 v[64:79], v[52:55], a[20:23], v[64:79]
 ds_read_b128 v[36:39], v9 offset:8192
 s_waitcnt lgkmcnt(3)
 v_mfma_f32_32x32x16_bf16 v[64:79], v[56:59], a[24:27], v[64:79]
 ds_read_b128 v[40:43], v10 offset:8192
 s_add_u32 m0, s56, 49152
 s_add_u32 s3, s55, s65
 buffer_load_dwordx4 v1, s[4:7], s3 offen sc1 lds
 s_waitcnt lgkmcnt(3)
 v_mfma_f32_32x32x16_bf16 v[64:79], v[60:63], a[28:31], v[64:79]
 ds_read_b128 v[44:47], v11 offset:8192
 s_waitcnt lgkmcnt(3)
 v_mfma_f32_32x32x16_bf16 v[64:79], v[32:35], a[32:35], v[64:79]
 ds_read_b128 v[48:51], v12 offset:8192
 s_waitcnt lgkmcnt(3)
 v_mfma_f32_32x32x16_bf16 v[64:79], v[36:39], a[36:39], v[64:79]
 ds_read_b128 v[52:55], v13 offset:8192
 s_add_u32 m0, s56, 50176
 s_add_u32 s3, s55, s65
 buffer_load_dwordx4 v24, s[4:7], s3 offen sc1 lds
 s_waitcnt lgkmcnt(3)
 v_mfma_f32_32x32x16_bf16 v[64:79], v[40:43], a[40:43], v[64:79]
 ds_read_b128 v[56:59], v14 offset:8192
 s_waitcnt lgkmcnt(3)
 v_mfma_f32_32x32x16_bf16 v[64:79], v[44:47], a[44:47], v[64:79]
 ds_read_b128 v[60:63], v15 offset:8192
 s_waitcnt lgkmcnt(3)
 v_mfma_f32_32x32x16_bf16 v[64:79], v[48:51], a[48:51], v[64:79]
 ds_read_b128 v[32:35], v8 offset:16384
 s_add_u32 m0, s56, 57344
 s_add_u32 s3, s55, s66
 buffer_load_dwordx4 v1, s[4:7], s3 offen sc1 lds
 s_waitcnt lgkmcnt(3)
 v_mfma_f32_32x32x16_bf16 v[64:79], v[52:55], a[52:55], v[64:79]
 ds_read_b128 v[36:39], v9 offset:16384
 s_waitcnt lgkmcnt(3)
 v_mfma_f32_32x32x16_bf16 v[64:79], v[56:59], a[56:59], v[64:79]
 ds_read_b128 v[40:43], v10 offset:16384
 s_waitcnt lgkmcnt(3)
 v_mfma_f32_32x32x16_bf16 v[64:79], v[60:63], a[60:63], v[64:79]
 ds_read_b128 v[44:47], v11 offset:16384
 s_add_u32 m0, s56, 58368
 s_add_u32 s3, s55, s66
 buffer_load_dwordx4 v24, s[4:7], s3 offen sc1 lds
 s_waitcnt lgkmcnt(3)
 v_mfma_f32_32x32x16_bf16 v[64:79], v[32:35], a[64:67], v[64:79]
 ds_read_b128 v[48:51], v12 offset:16384
 s_waitcnt lgkmcnt(3)
 v_mfma_f32_32x32x16_bf16 v[64:79], v[36:39], a[68:71], v[64:79]
 ds_read_b128 v[52:55], v13 offset:16384
 s_waitcnt vmcnt(6)
 s_lshl_b32 s3, s54, 2
 s_add_u32 s3, s3, s63
 v_mov_b32 v3, 1
 s_mov_b64 exec, s[78:79]
 buffer_atomic_add v3, v30, s[4:7], s3 offen
 s_mov_b64 exec, -1
 s_cmp_eq_u32 s61, 0
 s_cbranch_scc1 L_pf_106
 s_lshl_b32 s3, s61, 2
 s_add_u32 s3, s3, s59
 s_sub_u32 s3, s3, 4
 v_mov_b32 v3, 1
 s_mov_b64 exec, s[78:79]
 buffer_atomic_add v3, v30, s[4:7], s3 offen
 s_mov_b64 exec, -1
 s_mov_b32 s61, 0
L_pf_106:
 s_waitcnt lgkmcnt(3)
 v_mfma_f32_32x32x16_bf16 v[64:79], v[40:43], a[72:75], v[64:79]
 ds_read_b128 v[56:59], v14 offset:16384
 s_add_u32 m0, s56, 65536
 s_add_u32 s3, s55, s67
 buffer_load_dwordx4 v1, s[4:7], s3 offen sc1 lds
 s_waitcnt lgkmcnt(3)
 v_mfma_f32_32x32x16_bf16 v[64:79], v[44:47], a[76:79], v[64:79]
 ds_read_b128 v[60:63], v15 offset:16384
 s_waitcnt lgkmcnt(3)
 v_mfma_f32_32x32x16_bf16 v[64:79], v[48:51], a[80:83], v[64:79]
 ds_read_b128 v[32:35], v8 offset:24576
 s_waitcnt lgkmcnt(3)
 v_mfma_f32_32x32x16_bf16 v[64:79], v[52:55], a[84:87], v[64:79]
 ds_read_b128 v[36:39], v9 offset:24576
 s_add_u32 m0, s56, 66560
 s_add_u32 s3, s55, s67
 buffer_load_dwordx4 v24, s[4:7], s3 offen sc1 lds
 s_waitcnt lgkmcnt(3)
 v_mfma_f32_32x32x16_bf16 v[64:79], v[56:59], a[88:91], v[64:79]
 ds_read_b128 v[40:43], v10 offset:24576
 s_waitcnt lgkmcnt(3)
 v_mfma_f32_32x32x16_bf16 v[64:79], v[60:63], a[92:95], v[64:79]
 ds_read_b128 v[44:47], v11 offset:24576
 s_waitcnt lgkmcnt(3)
 v_mfma_f32_32x32x16_bf16 v[64:79], v[32:35], a[96:99], v[64:79]
 ds_read_b128 v[48:51], v12 offset:24576
 s_add_u32 m0, s56, 73728
 s_add_u32 s3, s55, s68
 buffer_load_dwordx4 v1, s[4:7], s3 offen sc1 lds
 s_waitcnt lgkmcnt(3)
 v_mfma_f32_32x32x16_bf16 v[64:79], v[36:39], a[100:103], v[64:79]
 ds_read_b128 v[52:55], v13 offset:24576
 s_waitcnt lgkmcnt(3)
 v_mfma_f32_32x32x16_bf16 v[64:79], v[40:43], a[104:107], v[64:79]
 ds_read_b128 v[56:59], v14 offset:24576
 s_waitcnt lgkmcnt(3)
 v_mfma_f32_32x32x16_bf16 v[64:79], v[44:47], a[108:111], v[64:79]
 ds_read_b128 v[60:63], v15 offset:24576
 s_add_u32 m0, s56, 74752
 s_add_u32 s3, s55, s68
 buffer_load_dwordx4 v24, s[4:7], s3 offen sc1 lds
 v_mov_b32 v6, 8
 s_mov_b64 exec, 15
 v_mov_b32 v6, 0
 buffer_atomic_add v6, v5, s[4:7], s70 offen sc0
 s_mov_b64 exec, -1
 s_waitcnt lgkmcnt(3)
 v_mfma_f32_32x32x16_bf16 v[64:79], v[48:51], a[112:115], v[64:79]
 ds_read_b128 v[32:35], v8 offset:32768
 s_waitcnt lgkmcnt(3)
 v_mfma_f32_32x32x16_bf16 v[64:79], v[52:55], a[116:119], v[64:79]
 ds_read_b128 v[36:39], v9 offset:32768
 s_waitcnt lgkmcnt(3)
 v_mfma_f32_32x32x16_bf16 v[64:79], v[56:59], a[120:123], v[64:79]
 ds_read_b128 v[40:43], v10 offset:32768
 s_waitcnt lgkmcnt(3)
 v_mfma_f32_32x32x16_bf16 v[64:79], v[60:63], a[124:127], v[64:79]
 ds_read_b128 v[44:47], v11 offset:32768
 s_waitcnt lgkmcnt(3)
 v_mfma_f32_32x32x16_bf16 v[64:79], v[32:35], a[128:131], v[64:79]
 ds_read_b128 v[48:51], v12 offset:32768
 s_waitcnt lgkmcnt(3)
 v_mfma_f32_32x32x16_bf16 v[64:79], v[36:39], a[132:135], v[64:79]
 ds_read_b128 v[52:55], v13 offset:32768
 s_waitcnt lgkmcnt(3)
 v_mfma_f32_32x32x16_bf16 v[64:79], v[40:43], a[136:139], v[64:79]
 ds_read_b128 v[56:59], v14 offset:32768
 s_waitcnt lgkmcnt(3)
 v_mfma_f32_32x32x16_bf16 v[64:79], v[44:47], a[140:143], v[64:79]
 ds_read_b128 v[60:63], v15 offset:32768
 s_waitcnt lgkmcnt(3)
 v_mfma_f32_32x32x16_bf16 v[64:79], v[48:51], a[144:147], v[64:79]
 s_waitcnt lgkmcnt(2)
 v_mfma_f32_32x32x16_bf16 v[64:79], v[52:55], a[148:151], v[64:79]
 s_waitcnt lgkmcnt(1)
 v_mfma_f32_32x32x16_bf16 v[64:79], v[56:59], a[152:155], v[64:79]
 s_waitcnt lgkmcnt(0)
 v_mfma_f32_32x32x16_bf16 v[64:79], v[60:63], a[156:159], v[64:79]
 s_lshl_b32 s3, s60, 19
 s_add_u32 s3, s3, s58
 s_xor_b32 s3, s3, s82
 s_nop 8
 v_cvt_pk_bf16_f32 v80, v64, v65
 v_cvt_pk_bf16_f32 v81, v66, v67
 v_cvt_pk_bf16_f32 v82, v72, v73
 v_cvt_pk_bf16_f32 v83, v74, v75
 buffer_store_dwordx4 v[80:83], v4, s[4:7], s3 offen offset:0 sc1
 v_cvt_pk_bf16_f32 v84, v68, v69
 v_cvt_pk_bf16_f32 v85, v70, v71
 v_cvt_pk_bf16_f32 v86, v76, v77
 v_cvt_pk_bf16_f32 v87, v78, v79
 buffer_store_dwordx4 v[84:87], v4, s[4:7], s3 offen offset:512 sc1
 s_add_u32 s54, s54, 1
 s_mov_b32 s61, s54
 s_waitcnt vmcnt(2)
 s_cmp_lg_u32 s50, 0
 s_cbranch_scc1 L_w_107
 v_cmp_gt_u32 vcc, 8, v6
 s_nop 1
 v_mov_b32 v3, vcc_lo
 ds_write_b32 v7, v3
 s_waitcnt lgkmcnt(0)
L_w_107:
 s_barrier
 ds_read_b32 v3, v7
 s_waitcnt lgkmcnt(0)
 v_readfirstlane_b32 s3, v3
 s_cmp_eq_u32 s69, 0
 s_cbranch_scc1 L_qkvv_fast
 s_cmp_eq_u32 s3, 0
 s_cbranch_scc1 L_qkvv_loop
 s_branch L_qkvv_block
L_n0_96:
 s_waitcnt vmcnt(0)
 s_lshl_b32 s3, s54, 2
 s_add_u32 s3, s3, s63
 v_mov_b32 v3, 1
 s_mov_b64 exec, s[78:79]
 buffer_atomic_add v3, v30, s[4:7], s3 offen
 s_mov_b64 exec, -1
 s_add_u32 s54, s54, 1
 s_cmp_lt_u32 s54, 80
 s_cbranch_scc1 L_qkvv_block
 s_endpgm
L_att:
 s_mul_i32 s3, s50, 24
 s_add_u32 s3, s3, s82
 s_sub_u32 s3, s3, 72
 s_cmp_lt_u32 s3, 64
 s_cbranch_scc1 L_att_go
 s_mov_b32 s60, s3
 s_mul_i32 s71, s50, 13312
 s_mov_b32 s70, s60
 s_mov_b32 s69, 96
 s_mov_b32 s96, s44
 s_and_b32 s97, s45, 0xffff
 s_mov_b32 s98, 256
 s_mov_b32 s99, 0x00020000
 v_mov_b32 v1, 196
 s_mov_b32 s51, 0
 s_mov_b64 exec, 1
L_wb_108:
 buffer_load_dword v2, v1, s[96:99], 0 offen sc1
 s_waitcnt vmcnt(0)
 v_cmp_eq_u32 vcc, 0, v2
 s_cbranch_vccz L_wbd_109
 s_sleep 2
 s_add_u32 s51, s51, 1
 s_cmp_lt_u32 s51, 131072
 s_cbranch_scc1 L_wb_108
 s_branch L_bail
L_wbd_109:
 s_mov_b64 exec, -1
 s_mov_b32 s96, s44
 s_and_b32 s97, s45, 0xffff
 s_mov_b32 s98, 256
 s_mov_b32 s99, 0x00020000
 v_mov_b32 v1, 208
 s_mov_b32 s51, 0
 s_mov_b64 exec, 1
L_wb_110:
 buffer_load_dword v2, v1, s[96:99], 0 offen sc1
 s_waitcnt vmcnt(0)
 v_cmp_eq_u32 vcc, 0, v2
 s_cbranch_vccz L_wbd_111
 s_sleep 2
 s_add_u32 s51, s51, 1
 s_cmp_lt_u32 s51, 131072
 s_cbranch_scc1 L_wb_110
 s_branch L_bail
L_wbd_111:
 s_mov_b64 exec, -1
 s_mov_b32 s8, s38
 s_and_b32 s9, s39, 0xffff
 s_mov_b32 s10, 2621440
 s_mov_b32 s11, 0x00020000
 s_mov_b32 s12, s40
 s_and_b32 s13, s41, 0xffff
 s_mov_b32 s14, 1280
 s_mov_b32 s15, 0x00020000
 v_lshlrev_b32 v130, 4, v0
 s_lshl_b32 s73, s70, 12
 s_add_u32 s74, s73, 2
 buffer_load_dwordx4 v[96:99], v130, s[8:11], s73 offen offset:0
 buffer_load_dwordx4 v[100:103], v130, s[8:11], s73 offen offset:1024
 buffer_load_dwordx4 v[104:107], v130, s[8:11], s73 offen offset:2048
 buffer_load_dwordx4 v[108:111], v130, s[8:11], s73 offen offset:3072
 buffer_load_dwordx4 v[112:115], v130, s[8:11], s74 offen offset:0
 buffer_load_dwordx4 v[116:119], v130, s[8:11], s74 offen offset:1024
 buffer_load_dwordx4 v[120:123], v130, s[8:11], s74 offen offset:2048
 buffer_load_dwordx4 v[124:127], v130, s[8:11], s74 offen offset:3072
 s_lshl_b32 s3, s70, 1
 buffer_load_ushort v128, off, s[12:15], s3
 s_lshl_b32 s3, s70, 12
 s_add_u32 s3, s3, 231735296
 buffer_load_dwordx4 v[240:243], v130, s[4:7], s3 offen offset:0 sc1
 buffer_load_dwordx4 v[244:247], v130, s[4:7], s3 offen offset:1024 sc1
 buffer_load_dwordx4 v[248:251], v130, s[4:7], s3 offen offset:2048 sc1
 buffer_load_dwordx4 v[252:255], v130, s[4:7], s3 offen offset:3072 sc1
 s_getpc_b64 s[76:77]
L_ca_112:
 s_add_u32 s76, s76, L_conv1-L_ca_112
 s_addc_u32 s77, s77, -1
 s_swappc_b64 s[76:77], s[76:77]
 s_waitcnt vmcnt(0)
 s_mov_b32 s96, s44
 s_and_b32 s97, s45, 0xffff
 s_mov_b32 s98, 256
 s_mov_b32 s99, 0x00020000
 v_mov_b32 v1, 1
 s_mov_b64 exec, 1
 buffer_atomic_add v1, off, s[96:99], 0 offset:76 sc0
 s_waitcnt vmcnt(0)
 v_cmp_eq_u32 vcc, 95, v1
 s_cbranch_vccz L_aw_113
 buffer_store_dword v1, off, s[96:99], 0 offset:204 sc1
L_aw_113:
 s_mov_b64 exec, -1
 s_endpgm
L_att_go:
 s_and_b32 s53, s3, 1
 s_lshr_b32 s52, s3, 1
 v_lshlrev_b32 v1, 4, v0
 v_add_u32 v2, 4096, v1
 v_mov_b32 v5, 0
 v_lshlrev_b32 v30, 3, v0
 v_and_b32 v6, 0x1e0, v30
 v_and_b32 v3, 16, v1
 v_add_u32 v6, v6, v3
 s_lshl_b32 s3, s53, 5
 s_add_u32 s3, s3, s52
 s_lshl_b32 s61, s3, 8
 s_add_u32 s61, s61, 24576
 s_lshl_b32 s66, s3, 7
 s_add_u32 s66, s66, 0
 s_lshl_b32 s57, s53, 11
 s_add_u32 s57, s57, s52
 s_and_b32 s100, s57, 1
 s_lshl_b32 s100, s100, 13
 s_lshl_b32 s57, s57, 14
 s_add_u32 s57, s57, s100
 s_add_u32 s57, s57, 8388608
 s_mul_i32 s58, s53, 1048576
 s_lshl_b32 s3, s52, 12
 s_add_u32 s58, s58, s3
 s_add_u32 s58, s58, 1114112
 s_add_u32 s59, s57, 67108864
 s_lshl_b32 s60, s53, 8
 s_add_u32 s60, s60, 40960
 s_lshr_b32 s3, s52, 2
 s_mul_i32 s3, s3, 2560
 v_lshl_add_u32 v31, v0, 9, s3
 v_mov_b32 v208, -1
 v_mov_b32 v209, -1
 v_mov_b32 v210, -1
 v_mov_b32 v211, -1
 v_lshrrev_b32 v3, 4, v0
 v_lshlrev_b32 v7, 9, v3
 v_and_b32 v4, 15, v0
 v_lshl_add_u32 v7, v4, 4, v7
 v_mov_b32 v88, 0xff61b1e6
 v_lshlrev_b32 v3, 2, v3
 v_add_u32 v89, 0, v3
 v_cmp_gt_u32 vcc, v89, v4
 s_nop 1
 v_cndmask_b32 v12, 0, v88, vcc
 v_add_u32 v89, 1, v3
 v_cmp_gt_u32 vcc, v89, v4
 s_nop 1
 v_cndmask_b32 v13, 0, v88, vcc
 v_add_u32 v89, 2, v3
 v_cmp_gt_u32 vcc, v89, v4
 s_nop 1
 v_cndmask_b32 v14, 0, v88, vcc
 v_add_u32 v89, 3, v3
 v_cmp_gt_u32 vcc, v89, v4
 s_nop 1
 v_cndmask_b32 v15, 0, v88, vcc
 v_mov_b32 v152, 0
 v_mov_b32 v153, 0
 v_mov_b32 v154, 0
 v_mov_b32 v155, 0
 v_mov_b32 v156, 0
 v_mov_b32 v157, 0
 v_mov_b32 v158, 0
 v_mov_b32 v159, 0
 v_mov_b32 v160, 0
 v_mov_b32 v161, 0
 v_mov_b32 v162, 0
 v_mov_b32 v163, 0
 v_mov_b32 v164, 0
 v_mov_b32 v165, 0
 v_mov_b32 v166, 0
 v_mov_b32 v167, 0
 v_mov_b32 v168, 0
 v_mov_b32 v169, 0
 v_mov_b32 v170, 0
 v_mov_b32 v171, 0
 v_mov_b32 v172, 0
 v_mov_b32 v173, 0
 v_mov_b32 v174, 0
 v_mov_b32 v175, 0
 s_mov_b32 s62, 0x3db504f3
 s_mov_b32 s63, 0x3fb8aa3b
 s_mov_b32 s54, 0
 s_mov_b32 s51, 0
 s_mov_b64 exec, 1
L_wc_114:
 v_mov_b32 v3, 0
 buffer_atomic_add v3, v5, s[4:7], s61 offen sc0
 s_waitcnt vmcnt(0)
 v_cmp_gt_u32 vcc, 12, v3
 s_cbranch_vccz L_wcd_115
 s_sleep 16
 s_add_u32 s51, s51, 1
 s_cmp_lt_u32 s51, 131072
 s_cbranch_scc1 L_wc_114
 s_branch L_bail
L_wcd_115:
 s_mov_b64 exec, -1
 s_lshl_b32 s56, s54, 19
 s_add_u32 s56, s56, s57
 s_cmp_lt_u32 s54, 64
 s_cselect_b32 s56, s56, 268435456
 s_xor_b32 s3, s56, 8192
 buffer_load_dwordx4 a[0:3], v1, s[4:7], s3 offen offset:0 sc1
 buffer_load_dwordx4 a[4:7], v1, s[4:7], s3 offen offset:1024 sc1
 buffer_load_dwordx4 a[8:11], v1, s[4:7], s3 offen offset:2048 sc1
 buffer_load_dwordx4 a[12:15], v1, s[4:7], s3 offen offset:3072 sc1
 buffer_load_dwordx4 a[16:19], v2, s[4:7], s3 offen offset:0 sc1
 buffer_load_dwordx4 a[20:23], v2, s[4:7], s3 offen offset:1024 sc1
 buffer_load_dwordx4 a[24:27], v2, s[4:7], s3 offen offset:2048 sc1
 buffer_load_dwordx4 a[28:31], v2, s[4:7], s3 offen offset:3072 sc1
 s_mov_b32 s3, s56
 buffer_load_dwordx4 a[32:35], v1, s[4:7], s3 offen offset:0 sc1
 buffer_load_dwordx4 a[36:39], v1, s[4:7], s3 offen offset:1024 sc1
 buffer_load_dwordx4 a[40:43], v1, s[4:7], s3 offen offset:2048 sc1
 buffer_load_dwordx4 a[44:47], v1, s[4:7], s3 offen offset:3072 sc1
 buffer_load_dwordx4 a[48:51], v2, s[4:7], s3 offen offset:0 sc1
 buffer_load_dwordx4 a[52:55], v2, s[4:7], s3 offen offset:1024 sc1
 buffer_load_dwordx4 a[56:59], v2, s[4:7], s3 offen offset:2048 sc1
 buffer_load_dwordx4 a[60:63], v2, s[4:7], s3 offen offset:3072 sc1
 s_add_u32 s3, s56, 67108864
 buffer_load_dwordx4 a[64:67], v1, s[4:7], s3 offen offset:0 sc1
 buffer_load_dwordx4 a[68:71], v1, s[4:7], s3 offen offset:1024 sc1
 buffer_load_dwordx4 a[72:75], v1, s[4:7], s3 offen offset:2048 sc1
 buffer_load_dwordx4 a[76:79], v1, s[4:7], s3 offen offset:3072 sc1
 buffer_load_dwordx4 a[80:83], v2, s[4:7], s3 offen offset:0 sc1
 buffer_load_dwordx4 a[84:87], v2, s[4:7], s3 offen offset:1024 sc1
 buffer_load_dwordx4 a[88:91], v2, s[4:7], s3 offen offset:2048 sc1
 buffer_load_dwordx4 a[92:95], v2, s[4:7], s3 offen offset:3072 sc1
L_att_loop:
 s_and_b32 s3, s54, 7
 s_lshl_b32 s65, s3, 17
 s_add_u32 s65, s65, s58
 buffer_load_dwordx4 v[32:35], v6, s[4:7], s65 offen offset:0 sc1
 buffer_load_dwordx4 v[36:39], v6, s[4:7], s65 offen offset:512 sc1
 buffer_load_dwordx4 v[40:43], v6, s[4:7], s65 offen offset:1024 sc1
 buffer_load_dwordx4 v[44:47], v6, s[4:7], s65 offen offset:1536 sc1
 buffer_load_dwordx2 v[48:49], v30, s[4:7], s65 offen offset:2048 sc1
 buffer_load_dwordx2 v[50:51], v30, s[4:7], s65 offen offset:2560 sc1
 buffer_load_dwordx2 v[52:53], v30, s[4:7], s65 offen offset:3072 sc1
 buffer_load_dwordx2 v[54:55], v30, s[4:7], s65 offen offset:3584 sc1
 s_lshl_b32 s55, s54, 19
 s_add_u32 s55, s55, s59
 s_xor_b32 s55, s55, 8192
 s_waitcnt vmcnt(16)
 v_mfma_f32_16x16x32_bf16 v[68:71], a[32:35], a[0:3], v[12:15]
 v_mfma_f32_16x16x32_bf16 v[68:71], a[36:39], a[4:7], v[68:71]
 v_mfma_f32_16x16x32_bf16 v[68:71], a[40:43], a[8:11], v[68:71]
 v_mfma_f32_16x16x32_bf16 v[68:71], a[44:47], a[12:15], v[68:71]
 v_mfma_f32_16x16x32_bf16 v[80:83], a[32:35], a[16:19], 0
 v_mfma_f32_16x16x32_bf16 v[80:83], a[36:39], a[20:23], v[80:83]
 v_mfma_f32_16x16x32_bf16 v[80:83], a[40:43], a[24:27], v[80:83]
 v_mfma_f32_16x16x32_bf16 v[80:83], a[44:47], a[28:31], v[80:83]
 v_mfma_f32_16x16x32_bf16 v[84:87], a[48:51], a[16:19], v[12:15]
 v_mfma_f32_16x16x32_bf16 v[84:87], a[52:55], a[20:23], v[84:87]
 v_mfma_f32_16x16x32_bf16 v[84:87], a[56:59], a[24:27], v[84:87]
 v_mfma_f32_16x16x32_bf16 v[84:87], a[60:63], a[28:31], v[84:87]
 s_nop 7
 v_cvt_pk_bf16_f32 v3, v68, v69
 v_lshlrev_b32 v68, 16, v3
 v_and_b32 v69, 0xffff0000, v3
 v_cvt_pk_bf16_f32 v3, v70, v71
 v_lshlrev_b32 v70, 16, v3
 v_and_b32 v71, 0xffff0000, v3
 v_cvt_pk_bf16_f32 v3, v80, v81
 v_lshlrev_b32 v80, 16, v3
 v_and_b32 v81, 0xffff0000, v3
 v_cvt_pk_bf16_f32 v3, v82, v83
 v_lshlrev_b32 v82, 16, v3
 v_and_b32 v83, 0xffff0000, v3
 v_cvt_pk_bf16_f32 v3, v84, v85
 v_lshlrev_b32 v84, 16, v3
 v_and_b32 v85, 0xffff0000, v3
 v_cvt_pk_bf16_f32 v3, v86, v87
 v_lshlrev_b32 v86, 16, v3
 v_and_b32 v87, 0xffff0000, v3
 v_mul_f32 v68, s62, v68
 v_mul_f32 v69, s62, v69
 v_mul_f32 v70, s62, v70
 v_mul_f32 v71, s62, v71
 v_mul_f32 v80, s62, v80
 v_mul_f32 v81, s62, v81
 v_mul_f32 v82, s62, v82
 v_mul_f32 v83, s62, v83
 v_mul_f32 v84, s62, v84
 v_mul_f32 v85, s62, v85
 v_mul_f32 v86, s62, v86
 v_mul_f32 v87, s62, v87
 v_cvt_pk_bf16_f32 v3, v68, v69
 v_lshlrev_b32 v68, 16, v3
 v_and_b32 v69, 0xffff0000, v3
 v_cvt_pk_bf16_f32 v3, v70, v71
 v_lshlrev_b32 v70, 16, v3
 v_and_b32 v71, 0xffff0000, v3
 v_cvt_pk_bf16_f32 v3, v80, v81
 v_lshlrev_b32 v80, 16, v3
 v_and_b32 v81, 0xffff0000, v3
 v_cvt_pk_bf16_f32 v3, v82, v83
 v_lshlrev_b32 v82, 16, v3
 v_and_b32 v83, 0xffff0000, v3
 v_cvt_pk_bf16_f32 v3, v84, v85
 v_lshlrev_b32 v84, 16, v3
 v_and_b32 v85, 0xffff0000, v3
 v_cvt_pk_bf16_f32 v3, v86, v87
 v_lshlrev_b32 v86, 16, v3
 v_and_b32 v87, 0xffff0000, v3
 v_max3_f32 v16, v68, v69, v70
 v_max_f32 v16, v16, v71
 v_max3_f32 v17, v80, v81, v82
 v_max3_f32 v17, v17, v83, v84
 v_max3_f32 v17, v17, v85, v86
 v_max_f32 v17, v17, v87
 v_mov_b32 v22, v16
 v_mov_b32 v23, v17
 s_nop 0
 v_permlane16_swap_b32 v16, v22
 v_permlane16_swap_b32 v17, v23
 v_max_f32 v16, v16, v22
 v_max_f32 v17, v17, v23
 v_mov_b32 v22, v16
 v_mov_b32 v23, v17
 s_nop 0
 v_permlane32_swap_b32 v16, v22
 v_permlane32_swap_b32 v17, v23
 v_max_f32 v16, v16, v22
 v_max_f32 v17, v17, v23
 v_mul_f32 v22, s63, v16
 v_fma_f32 v68, v68, s63, -v22
 v_fma_f32 v69, v69, s63, -v22
 v_fma_f32 v70, v70, s63, -v22
 v_fma_f32 v71, v71, s63, -v22
 v_mul_f32 v23, s63, v17
 v_fma_f32 v80, v80, s63, -v23
 v_fma_f32 v81, v81, s63, -v23
 v_fma_f32 v82, v82, s63, -v23
 v_fma_f32 v83, v83, s63, -v23
 v_fma_f32 v84, v84, s63, -v23
 v_fma_f32 v85, v85, s63, -v23
 v_fma_f32 v86, v86, s63, -v23
 v_fma_f32 v87, v87, s63, -v23
 v_exp_f32 v68, v68
 v_exp_f32 v69, v69
 v_exp_f32 v70, v70
 v_exp_f32 v71, v71
 v_exp_f32 v80, v80
 v_exp_f32 v81, v81
 v_exp_f32 v82, v82
 v_exp_f32 v83, v83
 v_exp_f32 v84, v84
 v_exp_f32 v85, v85
 v_exp_f32 v86, v86
 v_exp_f32 v87, v87
 v_add_f32 v18, v68, v69
 v_add_f32 v18, v18, v70
 v_add_f32 v18, v18, v71
 v_add_f32 v19, v80, v81
 v_add_f32 v19, v19, v82
 v_add_f32 v19, v19, v83
 v_add_f32 v19, v19, v84
 v_add_f32 v19, v19, v85
 v_add_f32 v19, v19, v86
 v_add_f32 v19, v19, v87
 s_mov_b32 s51, 0
 s_waitcnt vmcnt(4)
 v_max_u32 v3, v32, v34
 v_max3_u32 v3, v3, v36, v38
 v_max3_u32 v3, v3, v40, v42
 v_max3_u32 v3, v3, v44, v46
 v_cmp_eq_u32 vcc, -1, v3
 s_cbranch_vccz L_pkd_117
L_pk_116:
 s_sleep 2
 buffer_load_dwordx4 v[32:35], v6, s[4:7], s65 offen offset:0 sc1
 buffer_load_dwordx4 v[36:39], v6, s[4:7], s65 offen offset:512 sc1
 buffer_load_dwordx4 v[40:43], v6, s[4:7], s65 offen offset:1024 sc1
 buffer_load_dwordx4 v[44:47], v6, s[4:7], s65 offen offset:1536 sc1
 s_waitcnt vmcnt(0)
 v_max_u32 v3, v32, v34
 v_max3_u32 v3, v3, v36, v38
 v_max3_u32 v3, v3, v40, v42
 v_max3_u32 v3, v3, v44, v46
 v_cmp_eq_u32 vcc, -1, v3
 s_cbranch_vccz L_pke_118
 s_add_u32 s51, s51, 1
 s_cmp_lt_u32 s51, 131072
 s_cbranch_scc1 L_pk_116
 s_branch L_bail
L_pke_118:
 s_mov_b32 s51, 1
L_pkd_117:
 v_mfma_f32_16x16x32_bf16 v[64:67], v[32:35], a[0:3], 0
 v_mfma_f32_16x16x32_bf16 v[64:67], v[36:39], a[4:7], v[64:67]
 v_mfma_f32_16x16x32_bf16 v[64:67], v[40:43], a[8:11], v[64:67]
 v_mfma_f32_16x16x32_bf16 v[64:67], v[44:47], a[12:15], v[64:67]
 v_mfma_f32_16x16x32_bf16 v[76:79], v[32:35], a[16:19], 0
 v_mfma_f32_16x16x32_bf16 v[76:79], v[36:39], a[20:23], v[76:79]
 v_mfma_f32_16x16x32_bf16 v[76:79], v[40:43], a[24:27], v[76:79]
 v_mfma_f32_16x16x32_bf16 v[76:79], v[44:47], a[28:31], v[76:79]
 v_mov_b32 v29, 0
 s_nop 6
 v_cvt_pk_bf16_f32 v3, v64, v65
 v_lshlrev_b32 v64, 16, v3
 v_and_b32 v65, 0xffff0000, v3
 v_cvt_pk_bf16_f32 v3, v76, v77
 v_lshlrev_b32 v76, 16, v3
 v_and_b32 v77, 0xffff0000, v3
 v_mul_f32 v64, s62, v64
 v_mul_f32 v65, s62, v65
 v_mul_f32 v76, s62, v76
 v_mul_f32 v77, s62, v77
 v_cvt_pk_bf16_f32 v3, v64, v65
 v_lshlrev_b32 v64, 16, v3
 v_and_b32 v65, 0xffff0000, v3
 v_cvt_pk_bf16_f32 v3, v76, v77
 v_lshlrev_b32 v76, 16, v3
 v_and_b32 v77, 0xffff0000, v3
 s_cmp_eq_u32 s51, 0
 s_cbranch_scc1 L_nv_119
 buffer_load_dwordx2 v[48:49], v30, s[4:7], s65 offen offset:2048 sc1
 buffer_load_dwordx2 v[50:51], v30, s[4:7], s65 offen offset:2560 sc1
 buffer_load_dwordx2 v[52:53], v30, s[4:7], s65 offen offset:3072 sc1
 buffer_load_dwordx2 v[54:55], v30, s[4:7], s65 offen offset:3584 sc1
L_nv_119:
 s_mov_b64 exec, 1
 buffer_atomic_add v29, off, s[4:7], s61 offset:4 sc0
 s_mov_b64 exec, -1
 v_max3_f32 v20, v64, v65, v16
 v_max3_f32 v21, v76, v77, v17
 v_mov_b32 v22, v20
 v_mov_b32 v23, v21
 s_nop 0
 v_permlane16_swap_b32 v20, v22
 v_permlane16_swap_b32 v21, v23
 v_max_f32 v20, v20, v22
 v_max_f32 v21, v21, v23
 v_mov_b32 v22, v20
 v_mov_b32 v23, v21
 s_nop 0
 v_permlane32_swap_b32 v20, v22
 v_permlane32_swap_b32 v21, v23
 v_max_f32 v20, v20, v22
 v_max_f32 v21, v21, v23
 v_mul_f32 v20, s63, v20
 v_fma_f32 v24, v16, s63, -v20
 v_fma_f32 v64, v64, s63, -v20
 v_fma_f32 v65, v65, s63, -v20
 v_mul_f32 v21, s63, v21
 v_fma_f32 v26, v17, s63, -v21
 v_fma_f32 v76, v76, s63, -v21
 v_fma_f32 v77, v77, s63, -v21
 v_exp_f32 v24, v24
 v_exp_f32 v64, v64
 v_exp_f32 v65, v65
 v_exp_f32 v26, v26
 v_exp_f32 v76, v76
 v_exp_f32 v77, v77
 s_nop 0
 v_fma_f32 v18, v18, v24, v64
 v_add_f32 v18, v18, v65
 v_fma_f32 v19, v19, v26, v76
 v_add_f32 v19, v19, v77
 v_mov_b32 v22, v18
 v_mov_b32 v23, v19
 s_nop 0
 v_permlane16_swap_b32 v18, v22
 v_permlane16_swap_b32 v19, v23
 v_add_f32 v18, v18, v22
 v_add_f32 v19, v19, v23
 v_mov_b32 v22, v18
 v_mov_b32 v23, v19
 s_nop 0
 v_permlane32_swap_b32 v18, v22
 v_permlane32_swap_b32 v19, v23
 v_add_f32 v18, v18, v22
 v_add_f32 v19, v19, v23
 v_rcp_f32 v18, v18
 v_rcp_f32 v19, v19
 v_mul_f32 v24, v24, v18
 v_mul_f32 v26, v26, v19
 v_pk_mul_f32 v[68:69], v[68:69], v[24:25] op_sel_hi:[1,0]
 v_cvt_pk_bf16_f32 v168, v68, v69
 v_pk_mul_f32 v[70:71], v[70:71], v[24:25] op_sel_hi:[1,0]
 v_cvt_pk_bf16_f32 v169, v70, v71
 v_mul_f32 v64, v64, v18
 v_mul_f32 v65, v65, v18
 v_cvt_pk_bf16_f32 v152, v64, v65
 v_cvt_pk_bf16_f32 v155, v64, v65
 v_mfma_f32_16x16x32_bf16 v[88:91], a[64:67], v[168:171], 0
 v_pk_mul_f32 v[80:81], v[80:81], v[26:27] op_sel_hi:[1,0]
 v_cvt_pk_bf16_f32 v172, v80, v81
 v_mfma_f32_16x16x32_bf16 v[92:95], a[68:71], v[168:171], 0
 v_pk_mul_f32 v[82:83], v[82:83], v[26:27] op_sel_hi:[1,0]
 v_cvt_pk_bf16_f32 v173, v82, v83
 v_mfma_f32_16x16x32_bf16 v[96:99], a[72:75], v[168:171], 0
 v_pk_mul_f32 v[84:85], v[84:85], v[26:27] op_sel_hi:[1,0]
 v_cvt_pk_bf16_f32 v174, v84, v85
 v_mfma_f32_16x16x32_bf16 v[100:103], a[76:79], v[168:171], 0
 v_pk_mul_f32 v[86:87], v[86:87], v[26:27] op_sel_hi:[1,0]
 v_cvt_pk_bf16_f32 v175, v86, v87
 v_mfma_f32_16x16x32_bf16 v[104:107], a[80:83], v[168:171], 0
 v_mul_f32 v76, v76, v19
 v_mul_f32 v77, v77, v19
 v_mfma_f32_16x16x32_bf16 v[108:111], a[84:87], v[168:171], 0
 v_cvt_pk_bf16_f32 v160, v76, v77
 v_cvt_pk_bf16_f32 v163, v76, v77
 v_mfma_f32_16x16x32_bf16 v[112:115], a[88:91], v[168:171], 0
 v_mfma_f32_16x16x32_bf16 v[116:119], a[92:95], v[168:171], 0
 v_mfma_f32_16x16x32_bf16 v[120:123], a[64:67], v[172:175], 0
 v_mfma_f32_16x16x32_bf16 v[124:127], a[68:71], v[172:175], 0
 v_mfma_f32_16x16x32_bf16 v[128:131], a[72:75], v[172:175], 0
 v_mfma_f32_16x16x32_bf16 v[132:135], a[76:79], v[172:175], 0
 v_mfma_f32_16x16x32_bf16 v[136:139], a[80:83], v[172:175], 0
 v_mfma_f32_16x16x32_bf16 v[140:143], a[84:87], v[172:175], 0
 v_mfma_f32_16x16x32_bf16 v[144:147], a[88:91], v[172:175], 0
 v_mfma_f32_16x16x32_bf16 v[148:151], a[92:95], v[172:175], 0
 s_waitcnt vmcnt(1)
L_pv_120:
 v_max_u32 v3, v48, v50
 v_max3_u32 v3, v3, v52, v54
 v_cmp_eq_u32 vcc, -1, v3
 s_cbranch_vccz L_pvd_121
 buffer_load_dwordx2 v[48:49], v30, s[4:7], s65 offen offset:2048 sc1
 buffer_load_dwordx2 v[50:51], v30, s[4:7], s65 offen offset:2560 sc1
 buffer_load_dwordx2 v[52:53], v30, s[4:7], s65 offen offset:3072 sc1
 buffer_load_dwordx2 v[54:55], v30, s[4:7], s65 offen offset:3584 sc1
 s_waitcnt vmcnt(0)
 s_add_u32 s51, s51, 1
 s_cmp_lt_u32 s51, 131072
 s_cbranch_scc1 L_pv_120
 s_branch L_bail
L_pvd_121:
 v_mfma_f32_16x16x16_bf16 v[88:91], v[48:49], v[152:153], v[88:91]
 v_mfma_f32_16x16x16_bf16 v[92:95], v[48:49], v[154:155], v[92:95]
 v_mfma_f32_16x16x16_bf16 v[96:99], v[50:51], v[152:153], v[96:99]
 v_mfma_f32_16x16x16_bf16 v[100:103], v[50:51], v[154:155], v[100:103]
 v_mfma_f32_16x16x16_bf16 v[104:107], v[52:53], v[152:153], v[104:107]
 v_mfma_f32_16x16x16_bf16 v[108:111], v[52:53], v[154:155], v[108:111]
 v_mfma_f32_16x16x16_bf16 v[112:115], v[54:55], v[152:153], v[112:115]
 v_mfma_f32_16x16x16_bf16 v[116:119], v[54:55], v[154:155], v[116:119]
 v_mfma_f32_16x16x16_bf16 v[120:123], v[48:49], v[160:161], v[120:123]
 v_mfma_f32_16x16x16_bf16 v[124:127], v[48:49], v[162:163], v[124:127]
 v_cvt_pk_bf16_f32 v176, v88, v89
 v_cvt_pk_bf16_f32 v177, v90, v91
 v_mfma_f32_16x16x16_bf16 v[128:131], v[50:51], v[160:161], v[128:131]
 v_cvt_pk_bf16_f32 v178, v92, v93
 v_cvt_pk_bf16_f32 v179, v94, v95
 v_mfma_f32_16x16x16_bf16 v[132:135], v[50:51], v[162:163], v[132:135]
 s_add_u32 s3, s55, 0
 buffer_store_dwordx4 v[176:179], v7, s[4:7], s3 offen offset:0 sc1
 v_cvt_pk_bf16_f32 v180, v96, v97
 v_mfma_f32_16x16x16_bf16 v[136:139], v[52:53], v[160:161], v[136:139]
 v_cvt_pk_bf16_f32 v181, v98, v99
 v_cvt_pk_bf16_f32 v182, v100, v101
 v_mfma_f32_16x16x16_bf16 v[140:143], v[52:53], v[162:163], v[140:143]
 v_cvt_pk_bf16_f32 v183, v102, v103
 s_add_u32 s3, s55, 2048
 buffer_store_dwordx4 v[180:183], v7, s[4:7], s3 offen offset:0 sc1
 v_mfma_f32_16x16x16_bf16 v[144:147], v[54:55], v[160:161], v[144:147]
 v_cvt_pk_bf16_f32 v184, v104, v105
 v_cvt_pk_bf16_f32 v185, v106, v107
 v_mfma_f32_16x16x16_bf16 v[148:151], v[54:55], v[162:163], v[148:151]
 v_cvt_pk_bf16_f32 v186, v108, v109
 v_cvt_pk_bf16_f32 v187, v110, v111
 s_add_u32 s3, s55, 4096
 buffer_store_dwordx4 v[184:187], v7, s[4:7], s3 offen offset:0 sc1
 v_cvt_pk_bf16_f32 v188, v112, v113
 v_cvt_pk_bf16_f32 v189, v114, v115
 v_cvt_pk_bf16_f32 v190, v116, v117
 v_cvt_pk_bf16_f32 v191, v118, v119
 s_add_u32 s3, s55, 6144
 buffer_store_dwordx4 v[188:191], v7, s[4:7], s3 offen offset:0 sc1
 v_cvt_pk_bf16_f32 v192, v120, v121
 v_cvt_pk_bf16_f32 v193, v122, v123
 v_cvt_pk_bf16_f32 v194, v124, v125
 v_cvt_pk_bf16_f32 v195, v126, v127
 s_add_u32 s3, s55, 0
 buffer_store_dwordx4 v[192:195], v7, s[4:7], s3 offen offset:256 sc1
 v_cvt_pk_bf16_f32 v196, v128, v129
 v_cvt_pk_bf16_f32 v197, v130, v131
 v_cvt_pk_bf16_f32 v198, v132, v133
 v_cvt_pk_bf16_f32 v199, v134, v135
 s_add_u32 s3, s55, 2048
 buffer_store_dwordx4 v[196:199], v7, s[4:7], s3 offen offset:256 sc1
 v_cvt_pk_bf16_f32 v200, v136, v137
 v_cvt_pk_bf16_f32 v201, v138, v139
 v_cvt_pk_bf16_f32 v202, v140, v141
 v_cvt_pk_bf16_f32 v203, v142, v143
 s_add_u32 s3, s55, 4096
 buffer_store_dwordx4 v[200:203], v7, s[4:7], s3 offen offset:256 sc1
 v_cvt_pk_bf16_f32 v204, v144, v145
 v_cvt_pk_bf16_f32 v205, v146, v147
 v_cvt_pk_bf16_f32 v206, v148, v149
 v_cvt_pk_bf16_f32 v207, v150, v151
 s_add_u32 s3, s55, 6144
 buffer_store_dwordx4 v[204:207], v7, s[4:7], s3 offen offset:256 sc1
 buffer_store_dwordx4 v[208:211], v1, s[4:7], s65 offen offset:0 sc1
 buffer_store_dwordx4 v[208:211], v1, s[4:7], s65 offen offset:1024 sc1
 buffer_store_dwordx4 v[208:211], v1, s[4:7], s65 offen offset:2048 sc1
 buffer_store_dwordx4 v[208:211], v1, s[4:7], s65 offen offset:3072 sc1
 s_add_u32 s54, s54, 1
 s_add_u32 s61, s61, 4
 s_cmp_lt_u32 s54, 64
 s_cselect_b32 s64, 12, 0
 s_waitcnt vmcnt(12)
 v_readfirstlane_b32 s3, v29
 s_nop 3
 s_cmp_ge_u32 s3, s64
 s_cbranch_scc1 L_aj_122
 s_waitcnt vmcnt(4)
 v_mov_b32 v3, 1
 s_mov_b64 exec, 31
 buffer_atomic_add v3, v31, s[4:7], s60 offen
 s_mov_b64 exec, -1
 s_waitcnt vmcnt(1)
 v_mov_b32 v3, 1
 s_mov_b64 exec, 1
 buffer_atomic_add v3, v5, s[4:7], s66 offen
 s_mov_b64 exec, -1
 s_mov_b32 s51, 0
 s_mov_b64 exec, 1
L_wc_124:
 v_mov_b32 v3, 0
 buffer_atomic_add v3, v5, s[4:7], s61 offen sc0
 s_waitcnt vmcnt(0)
 v_cmp_gt_u32 vcc, s64, v3
 s_cbranch_vccz L_wcd_125
 s_sleep 4
 s_add_u32 s51, s51, 1
 s_cmp_lt_u32 s51, 131072
 s_cbranch_scc1 L_wc_124
 s_branch L_bail
L_wcd_125:
 s_mov_b64 exec, -1
 s_lshl_b32 s56, s54, 19
 s_add_u32 s56, s56, s57
 s_cmp_lt_u32 s54, 64
 s_cselect_b32 s56, s56, 268435456
 s_xor_b32 s3, s56, 8192
 buffer_load_dwordx4 a[0:3], v1, s[4:7], s3 offen offset:0 sc1
 buffer_load_dwordx4 a[4:7], v1, s[4:7], s3 offen offset:1024 sc1
 buffer_load_dwordx4 a[8:11], v1, s[4:7], s3 offen offset:2048 sc1
 buffer_load_dwordx4 a[12:15], v1, s[4:7], s3 offen offset:3072 sc1
 buffer_load_dwordx4 a[16:19], v2, s[4:7], s3 offen offset:0 sc1
 buffer_load_dwordx4 a[20:23], v2, s[4:7], s3 offen offset:1024 sc1
 buffer_load_dwordx4 a[24:27], v2, s[4:7], s3 offen offset:2048 sc1
 buffer_load_dwordx4 a[28:31], v2, s[4:7], s3 offen offset:3072 sc1
 s_mov_b32 s3, s56
 buffer_load_dwordx4 a[32:35], v1, s[4:7], s3 offen offset:0 sc1
 buffer_load_dwordx4 a[36:39], v1, s[4:7], s3 offen offset:1024 sc1
 buffer_load_dwordx4 a[40:43], v1, s[4:7], s3 offen offset:2048 sc1
 buffer_load_dwordx4 a[44:47], v1, s[4:7], s3 offen offset:3072 sc1
 buffer_load_dwordx4 a[48:51], v2, s[4:7], s3 offen offset:0 sc1
 buffer_load_dwordx4 a[52:55], v2, s[4:7], s3 offen offset:1024 sc1
 buffer_load_dwordx4 a[56:59], v2, s[4:7], s3 offen offset:2048 sc1
 buffer_load_dwordx4 a[60:63], v2, s[4:7], s3 offen offset:3072 sc1
 s_add_u32 s3, s56, 67108864
 buffer_load_dwordx4 a[64:67], v1, s[4:7], s3 offen offset:0 sc1
 buffer_load_dwordx4 a[68:71], v1, s[4:7], s3 offen offset:1024 sc1
 buffer_load_dwordx4 a[72:75], v1, s[4:7], s3 offen offset:2048 sc1
 buffer_load_dwordx4 a[76:79], v1, s[4:7], s3 offen offset:3072 sc1
 buffer_load_dwordx4 a[80:83], v2, s[4:7], s3 offen offset:0 sc1
 buffer_load_dwordx4 a[84:87], v2, s[4:7], s3 offen offset:1024 sc1
 buffer_load_dwordx4 a[88:91], v2, s[4:7], s3 offen offset:2048 sc1
 buffer_load_dwordx4 a[92:95], v2, s[4:7], s3 offen offset:3072 sc1
 s_branch L_ak_123
L_aj_122:
 s_lshl_b32 s56, s54, 19
 s_add_u32 s56, s56, s57
 s_cmp_lt_u32 s54, 64
 s_cselect_b32 s56, s56, 268435456
 s_xor_b32 s3, s56, 8192
 buffer_load_dwordx4 a[0:3], v1, s[4:7], s3 offen offset:0 sc1
 buffer_load_dwordx4 a[4:7], v1, s[4:7], s3 offen offset:1024 sc1
 buffer_load_dwordx4 a[8:11], v1, s[4:7], s3 offen offset:2048 sc1
 buffer_load_dwordx4 a[12:15], v1, s[4:7], s3 offen offset:3072 sc1
 buffer_load_dwordx4 a[16:19], v2, s[4:7], s3 offen offset:0 sc1
 buffer_load_dwordx4 a[20:23], v2, s[4:7], s3 offen offset:1024 sc1
 buffer_load_dwordx4 a[24:27], v2, s[4:7], s3 offen offset:2048 sc1
 buffer_load_dwordx4 a[28:31], v2, s[4:7], s3 offen offset:3072 sc1
 s_mov_b32 s3, s56
 buffer_load_dwordx4 a[32:35], v1, s[4:7], s3 offen offset:0 sc1
 buffer_load_dwordx4 a[36:39], v1, s[4:7], s3 offen offset:1024 sc1
 buffer_load_dwordx4 a[40:43], v1, s[4:7], s3 offen offset:2048 sc1
 buffer_load_dwordx4 a[44:47], v1, s[4:7], s3 offen offset:3072 sc1
 buffer_load_dwordx4 a[48:51], v2, s[4:7], s3 offen offset:0 sc1
 buffer_load_dwordx4 a[52:55], v2, s[4:7], s3 offen offset:1024 sc1
 buffer_load_dwordx4 a[56:59], v2, s[4:7], s3 offen offset:2048 sc1
 buffer_load_dwordx4 a[60:63], v2, s[4:7], s3 offen offset:3072 sc1
 s_add_u32 s3, s56, 67108864
 buffer_load_dwordx4 a[64:67], v1, s[4:7], s3 offen offset:0 sc1
 buffer_load_dwordx4 a[68:71], v1, s[4:7], s3 offen offset:1024 sc1
 buffer_load_dwordx4 a[72:75], v1, s[4:7], s3 offen offset:2048 sc1
 buffer_load_dwordx4 a[76:79], v1, s[4:7], s3 offen offset:3072 sc1
 buffer_load_dwordx4 a[80:83], v2, s[4:7], s3 offen offset:0 sc1
 buffer_load_dwordx4 a[84:87], v2, s[4:7], s3 offen offset:1024 sc1
 buffer_load_dwordx4 a[88:91], v2, s[4:7], s3 offen offset:2048 sc1
 buffer_load_dwordx4 a[92:95], v2, s[4:7], s3 offen offset:3072 sc1
 s_waitcnt vmcnt(28)
 v_mov_b32 v3, 1
 s_mov_b64 exec, 31
 buffer_atomic_add v3, v31, s[4:7], s60 offen
 s_mov_b64 exec, -1
 s_waitcnt vmcnt(25)
 v_mov_b32 v3, 1
 s_mov_b64 exec, 1
 buffer_atomic_add v3, v5, s[4:7], s66 offen
 s_mov_b64 exec, -1
L_ak_123:
 s_add_u32 s60, s60, 4
 s_cmp_lt_u32 s54, 64
 s_cbranch_scc1 L_att_loop
 s_endpgm
L_wo:
 s_and_b32 s100, s64, 1
 s_lshl_b32 s100, s100, 13
 s_lshl_b32 s64, s64, 14
 s_add_u32 s64, s64, s100
 s_xor_b32 s64, s64, 8192
 s_and_b32 s100, s65, 1
 s_lshl_b32 s100, s100, 13
 s_lshl_b32 s65, s65, 14
 s_add_u32 s65, s65, s100
 s_xor_b32 s65, s65, 8192
 s_and_b32 s100, s66, 1
 s_lshl_b32 s100, s100, 13
 s_lshl_b32 s66, s66, 14
 s_add_u32 s66, s66, s100
 s_xor_b32 s66, s66, 8192
 s_and_b32 s100, s67, 1
 s_lshl_b32 s100, s100, 13
 s_lshl_b32 s67, s67, 14
 s_add_u32 s67, s67, s100
 s_xor_b32 s67, s67, 8192
 v_lshlrev_b32 v7, 4, v0
 v_lshrrev_b32 v4, 5, v0
 s_mov_b32 s3, 10240
 v_mul_lo_u32 v4, v4, s3
 v_and_b32 v3, 31, v0
 v_lshl_add_u32 v4, v3, 2, v4
 s_lshl_b32 s3, s53, 9
 s_lshl_b32 s55, s50, 7
 s_add_u32 s3, s3, s55
 v_add_u32 v4, s3, v4
 s_mul_i32 s58, s52, 81920
 s_add_u32 s58, s58, 142606336
 v_lshlrev_b32 v8, 9, v0
 s_mul_i32 s3, s52, 5
 s_add_u32 s3, s3, s53
 s_and_b32 s55, s3, 3
 s_mul_i32 s55, s55, 16384
 v_add_u32 v8, s55, v8
 s_lshl_b32 s3, s3, 9
 s_add_u32 s3, s3, 40960
 v_mul_u32_u24 v5, 224, v0
 v_add_u32 v5, s3, v5
 v_mov_b32 v6, 0
 v_mov_b32 v10, 163776
 s_lshl_b32 s56, s50, 11
 s_mov_b32 s54, 0
 s_mov_b32 s61, -1
L_wo_loop:
 s_cmp_lt_u32 s54, 64
 s_cselect_b32 s3, 4, 0
 v_writelane_b32 v6, s3, 0
 s_cmp_ge_u32 s54, 8
 s_cselect_b32 s3, 4, 0
 v_writelane_b32 v6, s3, 1
 s_lshl_b32 s55, s54, 2
 s_cmp_lg_u32 s50, 0
 s_cselect_b32 s3, 268435456, s55
 v_mov_b32 v9, 0
 s_mov_b64 exec, 3
 buffer_atomic_add v9, v5, s[4:7], s3 offen sc0
 s_mov_b64 exec, -1
 s_waitcnt vmcnt(1)
 s_barrier
 s_cmp_lg_u32 s50, 1
 s_cbranch_scc1 L_sg_126
 s_cmp_ge_u32 s61, 64
 s_cbranch_scc1 L_sg_126
 s_lshl_b32 s3, s61, 2
 s_add_u32 s3, s3, 61696
 v_mov_b32 v3, 1
 s_mov_b32 exec_hi, 0
 buffer_atomic_add v3, v8, s[4:7], s3 offen
 s_mov_b64 exec, -1
L_sg_126:
 s_cmp_ge_u32 s54, 72
 s_cbranch_scc1 L_bail
 s_cmp_lg_u32 s50, 0
 s_cbranch_scc1 L_w_127
 s_waitcnt vmcnt(0)
 v_cmp_gt_u32 vcc, v6, v9
 s_cbranch_vccz L_w_127
 s_mov_b32 s51, 0
 s_mov_b64 exec, 3
 v_mov_b32 v12, 0
 buffer_atomic_add v12, v5, s[4:7], s55 offen sc0
 s_sleep 5
L_wc_128:
 v_mov_b32 v13, 0
 buffer_atomic_add v13, v5, s[4:7], s55 offen sc0
 s_waitcnt vmcnt(1)
 v_cmp_gt_u32 vcc, v6, v12
 s_cbranch_vccz L_wcd_129
 v_mov_b32 v12, 0
 buffer_atomic_add v12, v5, s[4:7], s55 offen sc0
 s_waitcnt vmcnt(1)
 v_cmp_gt_u32 vcc, v6, v13
 s_cbranch_vccz L_wcd_129
 s_add_u32 s51, s51, 1
 s_cmp_lt_u32 s51, 131072
 s_cbranch_scc1 L_wc_128
 s_branch L_bail
L_wcd_129:
 s_mov_b64 exec, -1
L_w_127:
 s_barrier
 s_sub_u32 s61, s54, 8
 s_cmp_ge_u32 s54, 64
 s_cbranch_scc1 L_tail_130
 s_lshl_b32 s3, s52, 16
 s_add_u32 s3, s3, s56
 s_add_u32 s3, s3, 75497472
 s_lshl_b32 s55, s54, 19
 s_add_u32 s55, s55, s3
 s_cmp_lt_u32 s54, 64
 s_cselect_b32 s55, s55, 268435456
 s_add_u32 m0, s56, 0
 s_add_u32 s3, s55, s64
 buffer_load_dwordx4 v7, s[4:7], s3 offen offset:0 sc1 lds
 s_add_u32 m0, s56, 0
 s_add_u32 s3, s55, s64
 buffer_load_dwordx4 v7, s[4:7], s3 offen offset:1024 sc1 lds
 s_add_u32 m0, s56, 8192
 s_add_u32 s3, s55, s65
 buffer_load_dwordx4 v7, s[4:7], s3 offen offset:0 sc1 lds
 s_add_u32 m0, s56, 8192
 s_add_u32 s3, s55, s65
 buffer_load_dwordx4 v7, s[4:7], s3 offen offset:1024 sc1 lds
 s_add_u32 m0, s56, 16384
 s_add_u32 s3, s55, s66
 buffer_load_dwordx4 v7, s[4:7], s3 offen offset:0 sc1 lds
 s_add_u32 m0, s56, 16384
 s_add_u32 s3, s55, s66
 buffer_load_dwordx4 v7, s[4:7], s3 offen offset:1024 sc1 lds
 s_add_u32 m0, s56, 24576
 s_add_u32 s3, s55, s67
 buffer_load_dwordx4 v7, s[4:7], s3 offen offset:0 sc1 lds
 s_add_u32 m0, s56, 24576
 s_add_u32 s3, s55, s67
 buffer_load_dwordx4 v7, s[4:7], s3 offen offset:1024 sc1 lds
 s_mov_b32 s60, s54
 s_lshl_b32 s3, s52, 16
 s_add_u32 s3, s3, s56
 s_add_u32 s3, s3, 109051904
 s_lshl_b32 s55, s61, 19
 s_add_u32 s55, s55, s3
 s_cmp_lt_u32 s61, 64
 s_cselect_b32 s55, s55, 268435456
 s_waitcnt vmcnt(6)
 s_barrier
 ds_read_b128 v[32:35], v7 offset:0
 ds_read_b128 v[36:39], v7 offset:1024
 ds_read_b128 v[40:43], v7 offset:2048
 ds_read_b128 v[44:47], v7 offset:3072
 s_waitcnt lgkmcnt(3)
 v_mfma_f32_32x32x16_bf16 v[64:79], v[32:35], a[0:3], 0
 ds_read_b128 v[48:51], v7 offset:4096
 s_add_u32 m0, s56, 32768
 s_add_u32 s3, s55, s64
 buffer_load_dwordx4 v7, s[4:7], s3 offen offset:0 sc1 lds
 s_waitcnt lgkmcnt(3)
 v_mfma_f32_32x32x16_bf16 v[64:79], v[36:39], a[4:7], v[64:79]
 ds_read_b128 v[52:55], v7 offset:5120
 s_waitcnt lgkmcnt(3)
 v_mfma_f32_32x32x16_bf16 v[64:79], v[40:43], a[8:11], v[64:79]
 ds_read_b128 v[56:59], v7 offset:6144
 s_waitcnt lgkmcnt(3)
 v_mfma_f32_32x32x16_bf16 v[64:79], v[44:47], a[12:15], v[64:79]
 ds_read_b128 v[60:63], v7 offset:7168
 s_add_u32 m0, s56, 32768
 s_add_u32 s3, s55, s64
 buffer_load_dwordx4 v7, s[4:7], s3 offen offset:1024 sc1 lds
 s_waitcnt lgkmcnt(3)
 v_mfma_f32_32x32x16_bf16 v[64:79], v[48:51], a[16:19], v[64:79]
 s_waitcnt vmcnt(6)
 s_barrier
 ds_read_b128 v[32:35], v7 offset:8192
 s_waitcnt lgkmcnt(3)
 v_mfma_f32_32x32x16_bf16 v[64:79], v[52:55], a[20:23], v[64:79]
 ds_read_b128 v[36:39], v7 offset:9216
 s_waitcnt lgkmcnt(3)
 v_mfma_f32_32x32x16_bf16 v[64:79], v[56:59], a[24:27], v[64:79]
 ds_read_b128 v[40:43], v7 offset:10240
 s_add_u32 m0, s56, 40960
 s_add_u32 s3, s55, s65
 buffer_load_dwordx4 v7, s[4:7], s3 offen offset:0 sc1 lds
 s_waitcnt lgkmcnt(3)
 v_mfma_f32_32x32x16_bf16 v[64:79], v[60:63], a[28:31], v[64:79]
 ds_read_b128 v[44:47], v7 offset:11264
 s_waitcnt lgkmcnt(3)
 v_mfma_f32_32x32x16_bf16 v[64:79], v[32:35], a[32:35], v[64:79]
 ds_read_b128 v[48:51], v7 offset:12288
 s_waitcnt lgkmcnt(3)
 v_mfma_f32_32x32x16_bf16 v[64:79], v[36:39], a[36:39], v[64:79]
 ds_read_b128 v[52:55], v7 offset:13312
 s_add_u32 m0, s56, 40960
 s_add_u32 s3, s55, s65
 buffer_load_dwordx4 v7, s[4:7], s3 offen offset:1024 sc1 lds
 s_waitcnt lgkmcnt(3)
 v_mfma_f32_32x32x16_bf16 v[64:79], v[40:43], a[40:43], v[64:79]
 ds_read_b128 v[56:59], v7 offset:14336
 s_waitcnt lgkmcnt(3)
 v_mfma_f32_32x32x16_bf16 v[64:79], v[44:47], a[44:47], v[64:79]
 ds_read_b128 v[60:63], v7 offset:15360
 s_waitcnt lgkmcnt(3)
 v_mfma_f32_32x32x16_bf16 v[64:79], v[48:51], a[48:51], v[64:79]
 s_waitcnt vmcnt(6)
 s_barrier
 ds_read_b128 v[32:35], v7 offset:16384
 s_add_u32 m0, s56, 49152
 s_add_u32 s3, s55, s66
 buffer_load_dwordx4 v7, s[4:7], s3 offen offset:0 sc1 lds
 s_waitcnt lgkmcnt(3)
 v_mfma_f32_32x32x16_bf16 v[64:79], v[52:55], a[52:55], v[64:79]
 ds_read_b128 v[36:39], v7 offset:17408
 s_waitcnt lgkmcnt(3)
 v_mfma_f32_32x32x16_bf16 v[64:79], v[56:59], a[56:59], v[64:79]
 ds_read_b128 v[40:43], v7 offset:18432
 s_waitcnt lgkmcnt(3)
 v_mfma_f32_32x32x16_bf16 v[64:79], v[60:63], a[60:63], v[64:79]
 ds_read_b128 v[44:47], v7 offset:19456
 s_add_u32 m0, s56, 49152
 s_add_u32 s3, s55, s66
 buffer_load_dwordx4 v7, s[4:7], s3 offen offset:1024 sc1 lds
 s_waitcnt lgkmcnt(3)
 v_mfma_f32_32x32x16_bf16 v[64:79], v[32:35], a[64:67], v[64:79]
 ds_read_b128 v[48:51], v7 offset:20480
 s_waitcnt lgkmcnt(3)
 v_mfma_f32_32x32x16_bf16 v[64:79], v[36:39], a[68:71], v[64:79]
 ds_read_b128 v[52:55], v7 offset:21504
 s_waitcnt lgkmcnt(3)
 v_mfma_f32_32x32x16_bf16 v[64:79], v[40:43], a[72:75], v[64:79]
 ds_read_b128 v[56:59], v7 offset:22528
 s_add_u32 m0, s56, 57344
 s_add_u32 s3, s55, s67
 buffer_load_dwordx4 v7, s[4:7], s3 offen offset:0 sc1 lds
 s_waitcnt lgkmcnt(3)
 v_mfma_f32_32x32x16_bf16 v[64:79], v[44:47], a[76:79], v[64:79]
 ds_read_b128 v[60:63], v7 offset:23552
 s_waitcnt lgkmcnt(3)
 v_mfma_f32_32x32x16_bf16 v[64:79], v[48:51], a[80:83], v[64:79]
 s_waitcnt vmcnt(7)
 s_barrier
 ds_read_b128 v[32:35], v7 offset:24576
 s_waitcnt lgkmcnt(3)
 v_mfma_f32_32x32x16_bf16 v[64:79], v[52:55], a[84:87], v[64:79]
 ds_read_b128 v[36:39], v7 offset:25600
 s_add_u32 m0, s56, 57344
 s_add_u32 s3, s55, s67
 buffer_load_dwordx4 v7, s[4:7], s3 offen offset:1024 sc1 lds
 s_waitcnt lgkmcnt(3)
 v_mfma_f32_32x32x16_bf16 v[64:79], v[56:59], a[88:91], v[64:79]
 ds_read_b128 v[40:43], v7 offset:26624
 s_waitcnt lgkmcnt(3)
 v_mfma_f32_32x32x16_bf16 v[64:79], v[60:63], a[92:95], v[64:79]
 ds_read_b128 v[44:47], v7 offset:27648
 s_waitcnt lgkmcnt(3)
 v_mfma_f32_32x32x16_bf16 v[64:79], v[32:35], a[96:99], v[64:79]
 ds_read_b128 v[48:51], v7 offset:28672
 s_waitcnt lgkmcnt(3)
 v_mfma_f32_32x32x16_bf16 v[64:79], v[36:39], a[100:103], v[64:79]
 ds_read_b128 v[52:55], v7 offset:29696
 s_waitcnt lgkmcnt(3)
 v_mfma_f32_32x32x16_bf16 v[64:79], v[40:43], a[104:107], v[64:79]
 ds_read_b128 v[56:59], v7 offset:30720
 s_waitcnt lgkmcnt(3)
 v_mfma_f32_32x32x16_bf16 v[64:79], v[44:47], a[108:111], v[64:79]
 ds_read_b128 v[60:63], v7 offset:31744
 s_waitcnt lgkmcnt(3)
 v_mfma_f32_32x32x16_bf16 v[64:79], v[48:51], a[112:115], v[64:79]
 s_waitcnt lgkmcnt(2)
 v_mfma_f32_32x32x16_bf16 v[64:79], v[52:55], a[116:119], v[64:79]
 s_waitcnt lgkmcnt(1)
 v_mfma_f32_32x32x16_bf16 v[64:79], v[56:59], a[120:123], v[64:79]
 s_waitcnt lgkmcnt(0)
 v_mfma_f32_32x32x16_bf16 v[64:79], v[60:63], a[124:127], v[64:79]
 s_mul_i32 s55, s60, 655360
 s_add_u32 s55, s55, s58
 s_cmp_lt_u32 s60, 64
 s_cselect_b32 s55, s55, 268435456
 s_nop 7
 s_add_u32 s3, s55, 0
 buffer_store_dword v64, v4, s[4:7], s3 offen sc1
 s_add_u32 s3, s55, 2560
 buffer_store_dword v65, v4, s[4:7], s3 offen sc1
 s_add_u32 s3, s55, 5120
 buffer_store_dword v66, v4, s[4:7], s3 offen sc1
 s_add_u32 s3, s55, 7680
 buffer_store_dword v67, v4, s[4:7], s3 offen sc1
 s_add_u32 s3, s55, 20480
 buffer_store_dword v68, v4, s[4:7], s3 offen sc1
 s_add_u32 s3, s55, 23040
 buffer_store_dword v69, v4, s[4:7], s3 offen sc1
 s_add_u32 s3, s55, 25600
 buffer_store_dword v70, v4, s[4:7], s3 offen sc1
 s_add_u32 s3, s55, 28160
 buffer_store_dword v71, v4, s[4:7], s3 offen sc1
 s_add_u32 s3, s55, 40960
 buffer_store_dword v72, v4, s[4:7], s3 offen sc1
 s_add_u32 s3, s55, 43520
 buffer_store_dword v73, v4, s[4:7], s3 offen sc1
 s_add_u32 s3, s55, 46080
 buffer_store_dword v74, v4, s[4:7], s3 offen sc1
 s_add_u32 s3, s55, 48640
 buffer_store_dword v75, v4, s[4:7], s3 offen sc1
 s_add_u32 s3, s55, 61440
 buffer_store_dword v76, v4, s[4:7], s3 offen sc1
 s_add_u32 s3, s55, 64000
 buffer_store_dword v77, v4, s[4:7], s3 offen sc1
 s_add_u32 s3, s55, 66560
 buffer_store_dword v78, v4, s[4:7], s3 offen sc1
 s_add_u32 s3, s55, 69120
 buffer_store_dword v79, v4, s[4:7], s3 offen sc1
L_wo_mid:
 s_add_u32 s62, s54, 1
 s_cmp_lt_u32 s62, 64
 s_cselect_b32 s3, 4, 0
 v_writelane_b32 v6, s3, 0
 s_cmp_ge_u32 s62, 8
 s_cselect_b32 s3, 4, 0
 v_writelane_b32 v6, s3, 1
 s_lshl_b32 s55, s62, 2
 s_cmp_lg_u32 s50, 0
 s_cselect_b32 s3, 268435456, s55
 v_mov_b32 v9, 0
 s_mov_b64 exec, 3
 buffer_atomic_add v9, v5, s[4:7], s3 offen sc0
 s_mov_b64 exec, -1
 s_waitcnt vmcnt(17)
 s_barrier
 s_mov_b32 s60, s61
 ds_read_b128 v[32:35], v7 offset:32768
 ds_read_b128 v[36:39], v7 offset:33792
 ds_read_b128 v[40:43], v7 offset:34816
 ds_read_b128 v[44:47], v7 offset:35840
 s_waitcnt lgkmcnt(3)
 v_mfma_f32_32x32x16_bf16 v[80:95], v[32:35], a[0:3], 0
 ds_read_b128 v[48:51], v7 offset:36864
 s_waitcnt lgkmcnt(3)
 v_mfma_f32_32x32x16_bf16 v[80:95], v[36:39], a[4:7], v[80:95]
 ds_read_b128 v[52:55], v7 offset:37888
 s_waitcnt lgkmcnt(3)
 v_mfma_f32_32x32x16_bf16 v[80:95], v[40:43], a[8:11], v[80:95]
 ds_read_b128 v[56:59], v7 offset:38912
 s_waitcnt lgkmcnt(3)
 v_mfma_f32_32x32x16_bf16 v[80:95], v[44:47], a[12:15], v[80:95]
 ds_read_b128 v[60:63], v7 offset:39936
 s_waitcnt lgkmcnt(3)
 v_mfma_f32_32x32x16_bf16 v[80:95], v[48:51], a[16:19], v[80:95]
 ds_read_b128 v[32:35], v7 offset:40960
 s_waitcnt lgkmcnt(3)
 v_mfma_f32_32x32x16_bf16 v[80:95], v[52:55], a[20:23], v[80:95]
 ds_read_b128 v[36:39], v7 offset:41984
 s_waitcnt lgkmcnt(3)
 v_mfma_f32_32x32x16_bf16 v[80:95], v[56:59], a[24:27], v[80:95]
 ds_read_b128 v[40:43], v7 offset:43008
 s_waitcnt lgkmcnt(3)
 v_mfma_f32_32x32x16_bf16 v[80:95], v[60:63], a[28:31], v[80:95]
 ds_read_b128 v[44:47], v7 offset:44032
 s_waitcnt lgkmcnt(3)
 v_mfma_f32_32x32x16_bf16 v[80:95], v[32:35], a[32:35], v[80:95]
 ds_read_b128 v[48:51], v7 offset:45056
 s_waitcnt lgkmcnt(3)
 v_mfma_f32_32x32x16_bf16 v[80:95], v[36:39], a[36:39], v[80:95]
 ds_read_b128 v[52:55], v7 offset:46080
 s_waitcnt lgkmcnt(3)
 v_mfma_f32_32x32x16_bf16 v[80:95], v[40:43], a[40:43], v[80:95]
 ds_read_b128 v[56:59], v7 offset:47104
 s_waitcnt lgkmcnt(3)
 v_mfma_f32_32x32x16_bf16 v[80:95], v[44:47], a[44:47], v[80:95]
 ds_read_b128 v[60:63], v7 offset:48128
 s_waitcnt lgkmcnt(3)
 v_mfma_f32_32x32x16_bf16 v[80:95], v[48:51], a[48:51], v[80:95]
 ds_read_b128 v[32:35], v7 offset:49152
 s_waitcnt lgkmcnt(3)
 v_mfma_f32_32x32x16_bf16 v[80:95], v[52:55], a[52:55], v[80:95]
 ds_read_b128 v[36:39], v7 offset:50176
 s_waitcnt lgkmcnt(3)
 v_mfma_f32_32x32x16_bf16 v[80:95], v[56:59], a[56:59], v[80:95]
 ds_read_b128 v[40:43], v7 offset:51200
 s_waitcnt lgkmcnt(3)
 v_mfma_f32_32x32x16_bf16 v[80:95], v[60:63], a[60:63], v[80:95]
 ds_read_b128 v[44:47], v7 offset:52224
 s_waitcnt vmcnt(0)
 s_cmp_lg_u32 s50, 0
 s_cbranch_scc1 L_hs_132
 v_cmp_gt_u32 vcc, v6, v9
 s_nop 1
 v_mov_b32 v3, vcc_lo
 ds_write_b32 v10, v3
 s_waitcnt lgkmcnt(0)
L_hs_132:
 s_barrier
 ds_read_b32 v9, v10
 s_cmp_lg_u32 s50, 1
 s_cbranch_scc1 L_sg_133
 s_cmp_ge_u32 s54, 64
 s_cbranch_scc1 L_sg_133
 s_lshl_b32 s3, s54, 2
 s_add_u32 s3, s3, 61440
 v_mov_b32 v3, 1
 s_mov_b32 exec_hi, 0
 buffer_atomic_add v3, v8, s[4:7], s3 offen
 s_mov_b64 exec, -1
L_sg_133:
 s_waitcnt lgkmcnt(0)
 v_readfirstlane_b32 s3, v9
 s_nop 3
 s_cmp_eq_u32 s3, 0
 s_cselect_b32 s62, s62, 64
 s_lshl_b32 s3, s52, 16
 s_add_u32 s3, s3, s56
 s_add_u32 s3, s3, 75497472
 s_lshl_b32 s55, s62, 19
 s_add_u32 s55, s55, s3
 s_cmp_lt_u32 s62, 64
 s_cselect_b32 s55, s55, 268435456
 s_waitcnt lgkmcnt(3)
 v_mfma_f32_32x32x16_bf16 v[80:95], v[32:35], a[64:67], v[80:95]
 ds_read_b128 v[48:51], v7 offset:53248
 s_add_u32 m0, s56, 0
 s_add_u32 s3, s55, s64
 buffer_load_dwordx4 v7, s[4:7], s3 offen offset:0 sc1 lds
 s_waitcnt lgkmcnt(3)
 v_mfma_f32_32x32x16_bf16 v[80:95], v[36:39], a[68:71], v[80:95]
 ds_read_b128 v[52:55], v7 offset:54272
 s_waitcnt lgkmcnt(3)
 v_mfma_f32_32x32x16_bf16 v[80:95], v[40:43], a[72:75], v[80:95]
 ds_read_b128 v[56:59], v7 offset:55296
 s_add_u32 m0, s56, 0
 s_add_u32 s3, s55, s64
 buffer_load_dwordx4 v7, s[4:7], s3 offen offset:1024 sc1 lds
 s_waitcnt lgkmcnt(3)
 v_mfma_f32_32x32x16_bf16 v[80:95], v[44:47], a[76:79], v[80:95]
 ds_read_b128 v[60:63], v7 offset:56320
 s_waitcnt lgkmcnt(3)
 v_mfma_f32_32x32x16_bf16 v[80:95], v[48:51], a[80:83], v[80:95]
 ds_read_b128 v[32:35], v7 offset:57344
 s_add_u32 m0, s56, 8192
 s_add_u32 s3, s55, s65
 buffer_load_dwordx4 v7, s[4:7], s3 offen offset:0 sc1 lds
 s_waitcnt lgkmcnt(3)
 v_mfma_f32_32x32x16_bf16 v[80:95], v[52:55], a[84:87], v[80:95]
 ds_read_b128 v[36:39], v7 offset:58368
 s_waitcnt lgkmcnt(3)
 v_mfma_f32_32x32x16_bf16 v[80:95], v[56:59], a[88:91], v[80:95]
 ds_read_b128 v[40:43], v7 offset:59392
 s_add_u32 m0, s56, 8192
 s_add_u32 s3, s55, s65
 buffer_load_dwordx4 v7, s[4:7], s3 offen offset:1024 sc1 lds
 s_waitcnt lgkmcnt(3)
 v_mfma_f32_32x32x16_bf16 v[80:95], v[60:63], a[92:95], v[80:95]
 ds_read_b128 v[44:47], v7 offset:60416
 s_waitcnt lgkmcnt(3)
 v_mfma_f32_32x32x16_bf16 v[80:95], v[32:35], a[96:99], v[80:95]
 ds_read_b128 v[48:51], v7 offset:61440
 s_add_u32 m0, s56, 16384
 s_add_u32 s3, s55, s66
 buffer_load_dwordx4 v7, s[4:7], s3 offen offset:0 sc1 lds
 s_waitcnt lgkmcnt(3)
 v_mfma_f32_32x32x16_bf16 v[80:95], v[36:39], a[100:103], v[80:95]
 ds_read_b128 v[52:55], v7 offset:62464
 s_waitcnt lgkmcnt(3)
 v_mfma_f32_32x32x16_bf16 v[80:95], v[40:43], a[104:107], v[80:95]
 ds_read_b128 v[56:59], v7 offset:63488
 s_add_u32 m0, s56, 16384
 s_add_u32 s3, s55, s66
 buffer_load_dwordx4 v7, s[4:7], s3 offen offset:1024 sc1 lds
 s_waitcnt lgkmcnt(3)
 v_mfma_f32_32x32x16_bf16 v[80:95], v[44:47], a[108:111], v[80:95]
 ds_read_b128 v[60:63], v7 offset:64512
 s_waitcnt lgkmcnt(3)
 v_mfma_f32_32x32x16_bf16 v[80:95], v[48:51], a[112:115], v[80:95]
 s_add_u32 m0, s56, 24576
 s_add_u32 s3, s55, s67
 buffer_load_dwordx4 v7, s[4:7], s3 offen offset:0 sc1 lds
 s_waitcnt lgkmcnt(2)
 v_mfma_f32_32x32x16_bf16 v[80:95], v[52:55], a[116:119], v[80:95]
 s_waitcnt lgkmcnt(1)
 v_mfma_f32_32x32x16_bf16 v[80:95], v[56:59], a[120:123], v[80:95]
 s_add_u32 m0, s56, 24576
 s_add_u32 s3, s55, s67
 buffer_load_dwordx4 v7, s[4:7], s3 offen offset:1024 sc1 lds
 s_waitcnt lgkmcnt(0)
 v_mfma_f32_32x32x16_bf16 v[80:95], v[60:63], a[124:127], v[80:95]
 s_mul_i32 s55, s60, 655360
 s_add_u32 s55, s55, s58
 s_add_u32 s55, s55, 41943040
 s_cmp_lt_u32 s60, 64
 s_cselect_b32 s55, s55, 268435456
 s_nop 7
 s_add_u32 s3, s55, 0
 buffer_store_dword v80, v4, s[4:7], s3 offen sc1
 s_add_u32 s3, s55, 2560
 buffer_store_dword v81, v4, s[4:7], s3 offen sc1
 s_add_u32 s3, s55, 5120
 buffer_store_dword v82, v4, s[4:7], s3 offen sc1
 s_add_u32 s3, s55, 7680
 buffer_store_dword v83, v4, s[4:7], s3 offen sc1
 s_add_u32 s3, s55, 20480
 buffer_store_dword v84, v4, s[4:7], s3 offen sc1
 s_add_u32 s3, s55, 23040
 buffer_store_dword v85, v4, s[4:7], s3 offen sc1
 s_add_u32 s3, s55, 25600
 buffer_store_dword v86, v4, s[4:7], s3 offen sc1
 s_add_u32 s3, s55, 28160
 buffer_store_dword v87, v4, s[4:7], s3 offen sc1
 s_add_u32 s3, s55, 40960
 buffer_store_dword v88, v4, s[4:7], s3 offen sc1
 s_add_u32 s3, s55, 43520
 buffer_store_dword v89, v4, s[4:7], s3 offen sc1
 s_add_u32 s3, s55, 46080
 buffer_store_dword v90, v4, s[4:7], s3 offen sc1
 s_add_u32 s3, s55, 48640
 buffer_store_dword v91, v4, s[4:7], s3 offen sc1
 s_add_u32 s3, s55, 61440
 buffer_store_dword v92, v4, s[4:7], s3 offen sc1
 s_add_u32 s3, s55, 64000
 buffer_store_dword v93, v4, s[4:7], s3 offen sc1
 s_add_u32 s3, s55, 66560
 buffer_store_dword v94, v4, s[4:7], s3 offen sc1
 s_add_u32 s3, s55, 69120
 buffer_store_dword v95, v4, s[4:7], s3 offen sc1
 s_cmp_ge_u32 s62, 64
 s_cbranch_scc1 L_e_131
 s_mov_b32 s54, s62
 s_mov_b32 s63, s61
 s_sub_u32 s61, s54, 8
 s_mov_b32 s60, s54
 s_waitcnt vmcnt(16)
 s_barrier
 s_lshl_b32 s3, s52, 16
 s_add_u32 s3, s3, s56
 s_add_u32 s3, s3, 109051904
 s_lshl_b32 s55, s61, 19
 s_add_u32 s55, s55, s3
 s_cmp_lt_u32 s61, 64
 s_cselect_b32 s55, s55, 268435456
 ds_read_b128 v[32:35], v7 offset:0
 ds_read_b128 v[36:39], v7 offset:1024
 ds_read_b128 v[40:43], v7 offset:2048
 ds_read_b128 v[44:47], v7 offset:3072
 s_waitcnt lgkmcnt(3)
 v_mfma_f32_32x32x16_bf16 v[64:79], v[32:35], a[0:3], 0
 ds_read_b128 v[48:51], v7 offset:4096
 s_add_u32 m0, s56, 32768
 s_add_u32 s3, s55, s64
 buffer_load_dwordx4 v7, s[4:7], s3 offen offset:0 sc1 lds
 s_waitcnt lgkmcnt(3)
 v_mfma_f32_32x32x16_bf16 v[64:79], v[36:39], a[4:7], v[64:79]
 ds_read_b128 v[52:55], v7 offset:5120
 s_waitcnt lgkmcnt(3)
 v_mfma_f32_32x32x16_bf16 v[64:79], v[40:43], a[8:11], v[64:79]
 ds_read_b128 v[56:59], v7 offset:6144
 s_waitcnt lgkmcnt(3)
 v_mfma_f32_32x32x16_bf16 v[64:79], v[44:47], a[12:15], v[64:79]
 ds_read_b128 v[60:63], v7 offset:7168
 s_add_u32 m0, s56, 32768
 s_add_u32 s3, s55, s64
 buffer_load_dwordx4 v7, s[4:7], s3 offen offset:1024 sc1 lds
 s_waitcnt lgkmcnt(3)
 v_mfma_f32_32x32x16_bf16 v[64:79], v[48:51], a[16:19], v[64:79]
 ds_read_b128 v[32:35], v7 offset:8192
 s_waitcnt lgkmcnt(3)
 v_mfma_f32_32x32x16_bf16 v[64:79], v[52:55], a[20:23], v[64:79]
 ds_read_b128 v[36:39], v7 offset:9216
 s_waitcnt lgkmcnt(3)
 v_mfma_f32_32x32x16_bf16 v[64:79], v[56:59], a[24:27], v[64:79]
 ds_read_b128 v[40:43], v7 offset:10240
 s_add_u32 m0, s56, 40960
 s_add_u32 s3, s55, s65
 buffer_load_dwordx4 v7, s[4:7], s3 offen offset:0 sc1 lds
 s_waitcnt lgkmcnt(3)
 v_mfma_f32_32x32x16_bf16 v[64:79], v[60:63], a[28:31], v[64:79]
 ds_read_b128 v[44:47], v7 offset:11264
 s_waitcnt lgkmcnt(3)
 v_mfma_f32_32x32x16_bf16 v[64:79], v[32:35], a[32:35], v[64:79]
 ds_read_b128 v[48:51], v7 offset:12288
 s_waitcnt lgkmcnt(3)
 v_mfma_f32_32x32x16_bf16 v[64:79], v[36:39], a[36:39], v[64:79]
 ds_read_b128 v[52:55], v7 offset:13312
 s_add_u32 m0, s56, 40960
 s_add_u32 s3, s55, s65
 buffer_load_dwordx4 v7, s[4:7], s3 offen offset:1024 sc1 lds
 s_waitcnt lgkmcnt(3)
 v_mfma_f32_32x32x16_bf16 v[64:79], v[40:43], a[40:43], v[64:79]
 ds_read_b128 v[56:59], v7 offset:14336
 s_waitcnt lgkmcnt(3)
 v_mfma_f32_32x32x16_bf16 v[64:79], v[44:47], a[44:47], v[64:79]
 ds_read_b128 v[60:63], v7 offset:15360
 s_waitcnt lgkmcnt(3)
 v_mfma_f32_32x32x16_bf16 v[64:79], v[48:51], a[48:51], v[64:79]
 ds_read_b128 v[32:35], v7 offset:16384
 s_add_u32 m0, s56, 49152
 s_add_u32 s3, s55, s66
 buffer_load_dwordx4 v7, s[4:7], s3 offen offset:0 sc1 lds
 s_waitcnt lgkmcnt(3)
 v_mfma_f32_32x32x16_bf16 v[64:79], v[52:55], a[52:55], v[64:79]
 ds_read_b128 v[36:39], v7 offset:17408
 s_waitcnt lgkmcnt(3)
 v_mfma_f32_32x32x16_bf16 v[64:79], v[56:59], a[56:59], v[64:79]
 ds_read_b128 v[40:43], v7 offset:18432
 s_waitcnt lgkmcnt(3)
 v_mfma_f32_32x32x16_bf16 v[64:79], v[60:63], a[60:63], v[64:79]
 ds_read_b128 v[44:47], v7 offset:19456
 s_add_u32 m0, s56, 49152
 s_add_u32 s3, s55, s66
 buffer_load_dwordx4 v7, s[4:7], s3 offen offset:1024 sc1 lds
 s_waitcnt vmcnt(6)
 s_barrier
 s_cmp_lg_u32 s50, 1
 s_cbranch_scc1 L_sg_134
 s_cmp_ge_u32 s63, 64
 s_cbranch_scc1 L_sg_134
 s_lshl_b32 s3, s63, 2
 s_add_u32 s3, s3, 61696
 v_mov_b32 v3, 1
 s_mov_b32 exec_hi, 0
 buffer_atomic_add v3, v8, s[4:7], s3 offen
 s_mov_b64 exec, -1
L_sg_134:
 s_waitcnt lgkmcnt(3)
 v_mfma_f32_32x32x16_bf16 v[64:79], v[32:35], a[64:67], v[64:79]
 ds_read_b128 v[48:51], v7 offset:20480
 s_waitcnt lgkmcnt(3)
 v_mfma_f32_32x32x16_bf16 v[64:79], v[36:39], a[68:71], v[64:79]
 ds_read_b128 v[52:55], v7 offset:21504
 s_waitcnt lgkmcnt(3)
 v_mfma_f32_32x32x16_bf16 v[64:79], v[40:43], a[72:75], v[64:79]
 ds_read_b128 v[56:59], v7 offset:22528
 s_add_u32 m0, s56, 57344
 s_add_u32 s3, s55, s67
 buffer_load_dwordx4 v7, s[4:7], s3 offen offset:0 sc1 lds
 s_waitcnt lgkmcnt(3)
 v_mfma_f32_32x32x16_bf16 v[64:79], v[44:47], a[76:79], v[64:79]
 ds_read_b128 v[60:63], v7 offset:23552
 s_waitcnt lgkmcnt(3)
 v_mfma_f32_32x32x16_bf16 v[64:79], v[48:51], a[80:83], v[64:79]
 ds_read_b128 v[32:35], v7 offset:24576
 s_waitcnt lgkmcnt(3)
 v_mfma_f32_32x32x16_bf16 v[64:79], v[52:55], a[84:87], v[64:79]
 ds_read_b128 v[36:39], v7 offset:25600
 s_add_u32 m0, s56, 57344
 s_add_u32 s3, s55, s67
 buffer_load_dwordx4 v7, s[4:7], s3 offen offset:1024 sc1 lds
 s_waitcnt lgkmcnt(3)
 v_mfma_f32_32x32x16_bf16 v[64:79], v[56:59], a[88:91], v[64:79]
 ds_read_b128 v[40:43], v7 offset:26624
 s_waitcnt lgkmcnt(3)
 v_mfma_f32_32x32x16_bf16 v[64:79], v[60:63], a[92:95], v[64:79]
 ds_read_b128 v[44:47], v7 offset:27648
 s_waitcnt lgkmcnt(3)
 v_mfma_f32_32x32x16_bf16 v[64:79], v[32:35], a[96:99], v[64:79]
 ds_read_b128 v[48:51], v7 offset:28672
 s_waitcnt lgkmcnt(3)
 v_mfma_f32_32x32x16_bf16 v[64:79], v[36:39], a[100:103], v[64:79]
 ds_read_b128 v[52:55], v7 offset:29696
 s_waitcnt lgkmcnt(3)
 v_mfma_f32_32x32x16_bf16 v[64:79], v[40:43], a[104:107], v[64:79]
 ds_read_b128 v[56:59], v7 offset:30720
 s_waitcnt lgkmcnt(3)
 v_mfma_f32_32x32x16_bf16 v[64:79], v[44:47], a[108:111], v[64:79]
 ds_read_b128 v[60:63], v7 offset:31744
 s_waitcnt lgkmcnt(3)
 v_mfma_f32_32x32x16_bf16 v[64:79], v[48:51], a[112:115], v[64:79]
 s_waitcnt lgkmcnt(2)
 v_mfma_f32_32x32x16_bf16 v[64:79], v[52:55], a[116:119], v[64:79]
 s_waitcnt lgkmcnt(1)
 v_mfma_f32_32x32x16_bf16 v[64:79], v[56:59], a[120:123], v[64:79]
 s_waitcnt lgkmcnt(0)
 v_mfma_f32_32x32x16_bf16 v[64:79], v[60:63], a[124:127], v[64:79]
 s_mul_i32 s55, s60, 655360
 s_add_u32 s55, s55, s58
 s_cmp_lt_u32 s60, 64
 s_cselect_b32 s55, s55, 268435456
 s_nop 7
 s_add_u32 s3, s55, 0
 buffer_store_dword v64, v4, s[4:7], s3 offen sc1
 s_add_u32 s3, s55, 2560
 buffer_store_dword v65, v4, s[4:7], s3 offen sc1
 s_add_u32 s3, s55, 5120
 buffer_store_dword v66, v4, s[4:7], s3 offen sc1
 s_add_u32 s3, s55, 7680
 buffer_store_dword v67, v4, s[4:7], s3 offen sc1
 s_add_u32 s3, s55, 20480
 buffer_store_dword v68, v4, s[4:7], s3 offen sc1
 s_add_u32 s3, s55, 23040
 buffer_store_dword v69, v4, s[4:7], s3 offen sc1
 s_add_u32 s3, s55, 25600
 buffer_store_dword v70, v4, s[4:7], s3 offen sc1
 s_add_u32 s3, s55, 28160
 buffer_store_dword v71, v4, s[4:7], s3 offen sc1
 s_add_u32 s3, s55, 40960
 buffer_store_dword v72, v4, s[4:7], s3 offen sc1
 s_add_u32 s3, s55, 43520
 buffer_store_dword v73, v4, s[4:7], s3 offen sc1
 s_add_u32 s3, s55, 46080
 buffer_store_dword v74, v4, s[4:7], s3 offen sc1
 s_add_u32 s3, s55, 48640
 buffer_store_dword v75, v4, s[4:7], s3 offen sc1
 s_add_u32 s3, s55, 61440
 buffer_store_dword v76, v4, s[4:7], s3 offen sc1
 s_add_u32 s3, s55, 64000
 buffer_store_dword v77, v4, s[4:7], s3 offen sc1
 s_add_u32 s3, s55, 66560
 buffer_store_dword v78, v4, s[4:7], s3 offen sc1
 s_add_u32 s3, s55, 69120
 buffer_store_dword v79, v4, s[4:7], s3 offen sc1
 s_branch L_wo_mid
L_tail_130:
 s_lshl_b32 s3, s52, 16
 s_add_u32 s3, s3, s56
 s_add_u32 s3, s3, 109051904
 s_lshl_b32 s55, s61, 19
 s_add_u32 s55, s55, s3
 s_cmp_lt_u32 s61, 64
 s_cselect_b32 s55, s55, 268435456
 s_add_u32 m0, s56, 32768
 s_add_u32 s3, s55, s64
 buffer_load_dwordx4 v7, s[4:7], s3 offen offset:0 sc1 lds
 s_add_u32 m0, s56, 32768
 s_add_u32 s3, s55, s64
 buffer_load_dwordx4 v7, s[4:7], s3 offen offset:1024 sc1 lds
 s_add_u32 m0, s56, 40960
 s_add_u32 s3, s55, s65
 buffer_load_dwordx4 v7, s[4:7], s3 offen offset:0 sc1 lds
 s_add_u32 m0, s56, 40960
 s_add_u32 s3, s55, s65
 buffer_load_dwordx4 v7, s[4:7], s3 offen offset:1024 sc1 lds
 s_add_u32 m0, s56, 49152
 s_add_u32 s3, s55, s66
 buffer_load_dwordx4 v7, s[4:7], s3 offen offset:0 sc1 lds
 s_add_u32 m0, s56, 49152
 s_add_u32 s3, s55, s66
 buffer_load_dwordx4 v7, s[4:7], s3 offen offset:1024 sc1 lds
 s_add_u32 m0, s56, 57344
 s_add_u32 s3, s55, s67
 buffer_load_dwordx4 v7, s[4:7], s3 offen offset:0 sc1 lds
 s_add_u32 m0, s56, 57344
 s_add_u32 s3, s55, s67
 buffer_load_dwordx4 v7, s[4:7], s3 offen offset:1024 sc1 lds
 s_mov_b32 s60, s61
 s_waitcnt vmcnt(6)
 s_barrier
 ds_read_b128 v[32:35], v7 offset:32768
 ds_read_b128 v[36:39], v7 offset:33792
 ds_read_b128 v[40:43], v7 offset:34816
 ds_read_b128 v[44:47], v7 offset:35840
 s_waitcnt lgkmcnt(3)
 v_mfma_f32_32x32x16_bf16 v[80:95], v[32:35], a[0:3], 0
 ds_read_b128 v[48:51], v7 offset:36864
 s_waitcnt lgkmcnt(3)
 v_mfma_f32_32x32x16_bf16 v[80:95], v[36:39], a[4:7], v[80:95]
 ds_read_b128 v[52:55], v7 offset:37888
 s_waitcnt lgkmcnt(3)
 v_mfma_f32_32x32x16_bf16 v[80:95], v[40:43], a[8:11], v[80:95]
 ds_read_b128 v[56:59], v7 offset:38912
 s_waitcnt lgkmcnt(3)
 v_mfma_f32_32x32x16_bf16 v[80:95], v[44:47], a[12:15], v[80:95]
 ds_read_b128 v[60:63], v7 offset:39936
 s_waitcnt lgkmcnt(3)
 v_mfma_f32_32x32x16_bf16 v[80:95], v[48:51], a[16:19], v[80:95]
 s_waitcnt vmcnt(4)
 s_barrier
 ds_read_b128 v[32:35], v7 offset:40960
 s_waitcnt lgkmcnt(3)
 v_mfma_f32_32x32x16_bf16 v[80:95], v[52:55], a[20:23], v[80:95]
 ds_read_b128 v[36:39], v7 offset:41984
 s_waitcnt lgkmcnt(3)
 v_mfma_f32_32x32x16_bf16 v[80:95], v[56:59], a[24:27], v[80:95]
 ds_read_b128 v[40:43], v7 offset:43008
 s_waitcnt lgkmcnt(3)
 v_mfma_f32_32x32x16_bf16 v[80:95], v[60:63], a[28:31], v[80:95]
 ds_read_b128 v[44:47], v7 offset:44032
 s_waitcnt lgkmcnt(3)
 v_mfma_f32_32x32x16_bf16 v[80:95], v[32:35], a[32:35], v[80:95]
 ds_read_b128 v[48:51], v7 offset:45056
 s_waitcnt lgkmcnt(3)
 v_mfma_f32_32x32x16_bf16 v[80:95], v[36:39], a[36:39], v[80:95]
 ds_read_b128 v[52:55], v7 offset:46080
 s_waitcnt lgkmcnt(3)
 v_mfma_f32_32x32x16_bf16 v[80:95], v[40:43], a[40:43], v[80:95]
 ds_read_b128 v[56:59], v7 offset:47104
 s_waitcnt lgkmcnt(3)
 v_mfma_f32_32x32x16_bf16 v[80:95], v[44:47], a[44:47], v[80:95]
 ds_read_b128 v[60:63], v7 offset:48128
 s_waitcnt lgkmcnt(3)
 v_mfma_f32_32x32x16_bf16 v[80:95], v[48:51], a[48:51], v[80:95]
 s_waitcnt vmcnt(2)
 s_barrier
 ds_read_b128 v[32:35], v7 offset:49152
 s_waitcnt lgkmcnt(3)
 v_mfma_f32_32x32x16_bf16 v[80:95], v[52:55], a[52:55], v[80:95]
 ds_read_b128 v[36:39], v7 offset:50176
 s_waitcnt lgkmcnt(3)
 v_mfma_f32_32x32x16_bf16 v[80:95], v[56:59], a[56:59], v[80:95]
 ds_read_b128 v[40:43], v7 offset:51200
 s_waitcnt lgkmcnt(3)
 v_mfma_f32_32x32x16_bf16 v[80:95], v[60:63], a[60:63], v[80:95]
 ds_read_b128 v[44:47], v7 offset:52224
 s_waitcnt lgkmcnt(3)
 v_mfma_f32_32x32x16_bf16 v[80:95], v[32:35], a[64:67], v[80:95]
 ds_read_b128 v[48:51], v7 offset:53248
 s_waitcnt lgkmcnt(3)
 v_mfma_f32_32x32x16_bf16 v[80:95], v[36:39], a[68:71], v[80:95]
 ds_read_b128 v[52:55], v7 offset:54272
 s_waitcnt lgkmcnt(3)
 v_mfma_f32_32x32x16_bf16 v[80:95], v[40:43], a[72:75], v[80:95]
 ds_read_b128 v[56:59], v7 offset:55296
 s_waitcnt lgkmcnt(3)
 v_mfma_f32_32x32x16_bf16 v[80:95], v[44:47], a[76:79], v[80:95]
 ds_read_b128 v[60:63], v7 offset:56320
 s_waitcnt lgkmcnt(3)
 v_mfma_f32_32x32x16_bf16 v[80:95], v[48:51], a[80:83], v[80:95]
 s_waitcnt vmcnt(0)
 s_barrier
 ds_read_b128 v[32:35], v7 offset:57344
 s_waitcnt lgkmcnt(3)
 v_mfma_f32_32x32x16_bf16 v[80:95], v[52:55], a[84:87], v[80:95]
 ds_read_b128 v[36:39], v7 offset:58368
 s_waitcnt lgkmcnt(3)
 v_mfma_f32_32x32x16_bf16 v[80:95], v[56:59], a[88:91], v[80:95]
 ds_read_b128 v[40:43], v7 offset:59392
 s_waitcnt lgkmcnt(3)
 v_mfma_f32_32x32x16_bf16 v[80:95], v[60:63], a[92:95], v[80:95]
 ds_read_b128 v[44:47], v7 offset:60416
 s_waitcnt lgkmcnt(3)
 v_mfma_f32_32x32x16_bf16 v[80:95], v[32:35], a[96:99], v[80:95]
 ds_read_b128 v[48:51], v7 offset:61440
 s_waitcnt lgkmcnt(3)
 v_mfma_f32_32x32x16_bf16 v[80:95], v[36:39], a[100:103], v[80:95]
 ds_read_b128 v[52:55], v7 offset:62464
 s_waitcnt lgkmcnt(3)
 v_mfma_f32_32x32x16_bf16 v[80:95], v[40:43], a[104:107], v[80:95]
 ds_read_b128 v[56:59], v7 offset:63488
 s_waitcnt lgkmcnt(3)
 v_mfma_f32_32x32x16_bf16 v[80:95], v[44:47], a[108:111], v[80:95]
 ds_read_b128 v[60:63], v7 offset:64512
 s_waitcnt lgkmcnt(3)
 v_mfma_f32_32x32x16_bf16 v[80:95], v[48:51], a[112:115], v[80:95]
 s_waitcnt lgkmcnt(2)
 v_mfma_f32_32x32x16_bf16 v[80:95], v[52:55], a[116:119], v[80:95]
 s_waitcnt lgkmcnt(1)
 v_mfma_f32_32x32x16_bf16 v[80:95], v[56:59], a[120:123], v[80:95]
 s_waitcnt lgkmcnt(0)
 v_mfma_f32_32x32x16_bf16 v[80:95], v[60:63], a[124:127], v[80:95]
 s_mul_i32 s55, s60, 655360
 s_add_u32 s55, s55, s58
 s_add_u32 s55, s55, 41943040
 s_cmp_lt_u32 s60, 64
 s_cselect_b32 s55, s55, 268435456
 s_nop 7
 s_add_u32 s3, s55, 0
 buffer_store_dword v80, v4, s[4:7], s3 offen sc1
 s_add_u32 s3, s55, 2560
 buffer_store_dword v81, v4, s[4:7], s3 offen sc1
 s_add_u32 s3, s55, 5120
 buffer_store_dword v82, v4, s[4:7], s3 offen sc1
 s_add_u32 s3, s55, 7680
 buffer_store_dword v83, v4, s[4:7], s3 offen sc1
 s_add_u32 s3, s55, 20480
 buffer_store_dword v84, v4, s[4:7], s3 offen sc1
 s_add_u32 s3, s55, 23040
 buffer_store_dword v85, v4, s[4:7], s3 offen sc1
 s_add_u32 s3, s55, 25600
 buffer_store_dword v86, v4, s[4:7], s3 offen sc1
 s_add_u32 s3, s55, 28160
 buffer_store_dword v87, v4, s[4:7], s3 offen sc1
 s_add_u32 s3, s55, 40960
 buffer_store_dword v88, v4, s[4:7], s3 offen sc1
 s_add_u32 s3, s55, 43520
 buffer_store_dword v89, v4, s[4:7], s3 offen sc1
 s_add_u32 s3, s55, 46080
 buffer_store_dword v90, v4, s[4:7], s3 offen sc1
 s_add_u32 s3, s55, 48640
 buffer_store_dword v91, v4, s[4:7], s3 offen sc1
 s_add_u32 s3, s55, 61440
 buffer_store_dword v92, v4, s[4:7], s3 offen sc1
 s_add_u32 s3, s55, 64000
 buffer_store_dword v93, v4, s[4:7], s3 offen sc1
 s_add_u32 s3, s55, 66560
 buffer_store_dword v94, v4, s[4:7], s3 offen sc1
 s_add_u32 s3, s55, 69120
 buffer_store_dword v95, v4, s[4:7], s3 offen sc1
L_e_131:
 s_add_u32 s54, s54, 1
 s_branch L_wo_loop
L_t4:
 s_lshr_b32 s53, s50, 1
 s_and_b32 s54, s50, 1
 v_lshlrev_b32 v1, 4, v0
 v_mov_b32 v72, 0
 s_lshl_b32 s3, s50, 2
 s_add_u32 s3, s3, 163776
 v_mov_b32 v73, s3
 ds_write_b32 v73, v72
 s_cmp_lg_u32 s50, 0
 s_cbranch_scc1 L_ww_135
 s_mov_b32 s96, s44
 s_and_b32 s97, s45, 0xffff
 s_mov_b32 s98, 256
 s_mov_b32 s99, 0x00020000
 v_mov_b32 v12, 136
 s_mov_b32 s51, 0
 s_mov_b64 exec, 1
L_wb_136:
 buffer_load_dword v13, v12, s[96:99], 0 offen sc1
 s_waitcnt vmcnt(0)
 v_cmp_eq_u32 vcc, 0, v13
 s_cbranch_vccz L_wbd_137
 s_sleep 2
 s_add_u32 s51, s51, 1
 s_cmp_lt_u32 s51, 131072
 s_cbranch_scc1 L_wb_136
 s_branch L_bail
L_wbd_137:
 s_mov_b64 exec, -1
L_ww_135:
 s_barrier
 s_mul_i32 s55, s52, 40960
 s_mul_i32 s56, s50, 10240
 s_add_u32 s55, s55, s56
 s_add_u32 s55, s55, 234356736
 s_add_u32 m0, s56, 0
 s_add_u32 s3, s55, 0
 buffer_load_dwordx4 v1, s[4:7], s3 offen offset:0 sc1 lds
 buffer_load_dwordx4 v1, s[4:7], s3 offen offset:1024 sc1 lds
 s_add_u32 m0, s56, 2048
 s_add_u32 s3, s55, 2048
 buffer_load_dwordx4 v1, s[4:7], s3 offen offset:0 sc1 lds
 buffer_load_dwordx4 v1, s[4:7], s3 offen offset:1024 sc1 lds
 s_add_u32 m0, s56, 4096
 s_add_u32 s3, s55, 4096
 buffer_load_dwordx4 v1, s[4:7], s3 offen offset:0 sc1 lds
 buffer_load_dwordx4 v1, s[4:7], s3 offen offset:1024 sc1 lds
 s_add_u32 m0, s56, 6144
 s_add_u32 s3, s55, 6144
 buffer_load_dwordx4 v1, s[4:7], s3 offen offset:0 sc1 lds
 buffer_load_dwordx4 v1, s[4:7], s3 offen offset:1024 sc1 lds
 s_add_u32 m0, s56, 8192
 s_add_u32 s3, s55, 8192
 buffer_load_dwordx4 v1, s[4:7], s3 offen offset:0 sc1 lds
 buffer_load_dwordx4 v1, s[4:7], s3 offen offset:1024 sc1 lds
 s_waitcnt vmcnt(0) lgkmcnt(0)
 s_barrier
 s_cmp_eq_u32 s53, 0
 s_cbranch_scc1 L_e0_138
 s_lshl_b32 s60, s52, 1
 s_and_b32 s3, s50, 1
 s_add_u32 s60, s60, s3
 s_mul_i32 s71, s3, 13312
 s_add_u32 s71, s71, 131072
 s_add_u32 s72, s60, 1024
 s_mov_b32 s8, s16
 s_and_b32 s9, s17, 0xffff
 s_mov_b32 s10, 2621440
 s_mov_b32 s11, 0x00020000
 v_lshlrev_b32 v1, 4, v0
 v_lshlrev_b32 v2, 3, v0
 v_cmp_lt_u32 vcc, 31, v0
 v_mov_b32 v3, 268435456
 s_nop 1
 v_cndmask_b32 v7, v2, v3, vcc
 s_mov_b32 s63, 0x3acccccd
 s_mov_b32 s68, 0x3727c5ac
 s_add_u32 s3, s72, 0
 s_mul_i32 s3, s3, 1280
 buffer_load_dwordx2 v[48:49], v2, s[8:11], s3 offen offset:0
 buffer_load_dwordx2 v[50:51], v2, s[8:11], s3 offen offset:512
 buffer_load_dwordx2 v[52:53], v7, s[8:11], s3 offen offset:1024
 s_waitcnt vmcnt(0)
L_ln_139:
 v_lshlrev_b32 v12, 16, v48
 v_and_b32 v13, 0xffff0000, v48
 v_lshlrev_b32 v14, 16, v49
 v_and_b32 v15, 0xffff0000, v49
 v_lshlrev_b32 v16, 16, v50
 v_and_b32 v17, 0xffff0000, v50
 v_lshlrev_b32 v18, 16, v51
 v_and_b32 v19, 0xffff0000, v51
 v_lshlrev_b32 v20, 16, v52
 v_and_b32 v21, 0xffff0000, v52
 v_lshlrev_b32 v22, 16, v53
 v_and_b32 v23, 0xffff0000, v53
 s_add_u32 s3, s72, 64
 s_mul_i32 s3, s3, 1280
 buffer_load_dwordx2 v[48:49], v2, s[8:11], s3 offen offset:0
 buffer_load_dwordx2 v[50:51], v2, s[8:11], s3 offen offset:512
 buffer_load_dwordx2 v[52:53], v7, s[8:11], s3 offen offset:1024
 s_and_b32 s3, s72, 15
 v_lshrrev_b32 v4, 3, v0
 v_lshlrev_b32 v4, 2, v4
 v_and_b32 v9, 3, v0
 v_add_u32 v4, v4, v9
 v_xor_b32 v4, s3, v4
 v_lshlrev_b32 v4, 4, v4
 v_and_b32 v9, 4, v0
 v_lshl_add_u32 v4, v9, 1, v4
 v_cndmask_b32 v8, v4, v3, vcc
 v_readfirstlane_b32 s3, v12
 s_nop 1
 v_subrev_f32 v36, s3, v12
 v_subrev_f32 v37, s3, v13
 v_subrev_f32 v38, s3, v14
 v_subrev_f32 v39, s3, v15
 v_subrev_f32 v40, s3, v16
 v_subrev_f32 v41, s3, v17
 v_subrev_f32 v42, s3, v18
 v_subrev_f32 v43, s3, v19
 v_mov_b32 v44, 0
 v_mov_b32 v45, 0
 v_mov_b32 v46, 0
 v_mov_b32 v47, 0
 s_mov_b32 exec_hi, 0
 v_subrev_f32 v44, s3, v20
 v_subrev_f32 v45, s3, v21
 v_subrev_f32 v46, s3, v22
 v_subrev_f32 v47, s3, v23
 s_mov_b32 exec_hi, -1
 v_pk_mul_f32 v[10:11], v[36:37], v[36:37]
 v_pk_fma_f32 v[10:11], v[38:39], v[38:39], v[10:11]
 v_pk_fma_f32 v[10:11], v[40:41], v[40:41], v[10:11]
 v_pk_fma_f32 v[10:11], v[42:43], v[42:43], v[10:11]
 v_pk_fma_f32 v[10:11], v[44:45], v[44:45], v[10:11]
 v_pk_fma_f32 v[10:11], v[46:47], v[46:47], v[10:11]
 v_pk_add_f32 v[36:37], v[36:37], v[38:39]
 v_pk_add_f32 v[36:37], v[36:37], v[40:41]
 v_pk_add_f32 v[36:37], v[36:37], v[42:43]
 v_pk_add_f32 v[36:37], v[36:37], v[44:45]
 v_pk_add_f32 v[36:37], v[36:37], v[46:47]
 v_add_f32 v11, v10, v11
 v_add_f32 v10, v36, v37
 s_nop 0
 v_add_f32_dpp v11, v11, v11 quad_perm:[1,0,3,2] row_mask:0xf bank_mask:0xf
 v_add_f32_dpp v10, v10, v10 quad_perm:[1,0,3,2] row_mask:0xf bank_mask:0xf
 s_nop 0
 v_add_f32_dpp v11, v11, v11 quad_perm:[2,3,0,1] row_mask:0xf bank_mask:0xf
 v_add_f32_dpp v10, v10, v10 quad_perm:[2,3,0,1] row_mask:0xf bank_mask:0xf
 s_nop 0
 v_add_f32_dpp v11, v11, v11 row_half_mirror row_mask:0xf bank_mask:0xf
 v_add_f32_dpp v10, v10, v10 row_half_mirror row_mask:0xf bank_mask:0xf
 s_nop 0
 v_add_f32_dpp v11, v11, v11 row_mirror row_mask:0xf bank_mask:0xf
 v_add_f32_dpp v10, v10, v10 row_mirror row_mask:0xf bank_mask:0xf
 v_mov_b32 v37, v11
 v_mov_b32 v36, v10
 s_nop 0
 v_permlane16_swap_b32 v11, v37
 v_permlane16_swap_b32 v10, v36
 v_pk_add_f32 v[10:11], v[10:11], v[36:37]
 v_mov_b32 v37, v11
 v_mov_b32 v36, v10
 s_nop 0
 v_permlane32_swap_b32 v11, v37
 v_permlane32_swap_b32 v10, v36
 v_pk_add_f32 v[10:11], v[10:11], v[36:37]
 v_mul_f32 v10, s63, v10
 v_mul_f32 v11, s63, v11
 v_fma_f32 v11, -v10, v10, v11
 v_max_f32 v11, 0, v11
 v_add_f32 v10, s3, v10
 v_cvt_pk_bf16_f32 v9, v10, v11
 v_lshlrev_b32 v10, 16, v9
 v_and_b32 v11, 0xffff0000, v9
 v_add_f32 v11, s68, v11
 v_cvt_pk_bf16_f32 v11, v11, v11
 v_and_b32 v11, 0xffff0000, v11
 v_sqrt_f32 v11, v11
 s_nop 0
 v_pk_add_f32 v[36:37], v[12:13], v[10:11] op_sel_hi:[1,0] neg_lo:[0,1] neg_hi:[0,1]
 v_pk_add_f32 v[38:39], v[14:15], v[10:11] op_sel_hi:[1,0] neg_lo:[0,1] neg_hi:[0,1]
 v_pk_add_f32 v[40:41], v[16:17], v[10:11] op_sel_hi:[1,0] neg_lo:[0,1] neg_hi:[0,1]
 v_pk_add_f32 v[42:43], v[18:19], v[10:11] op_sel_hi:[1,0] neg_lo:[0,1] neg_hi:[0,1]
 v_pk_add_f32 v[44:45], v[20:21], v[10:11] op_sel_hi:[1,0] neg_lo:[0,1] neg_hi:[0,1]
 v_pk_add_f32 v[46:47], v[22:23], v[10:11] op_sel_hi:[1,0] neg_lo:[0,1] neg_hi:[0,1]
 v_cvt_pk_bf16_f32 v11, v11, v11
 v_and_b32 v11, 0xffff0000, v11
 v_rcp_f32 v11, v11
 v_cvt_pk_bf16_f32 v9, v36, v37
 v_lshlrev_b32 v36, 16, v9
 v_and_b32 v37, 0xffff0000, v9
 v_cvt_pk_bf16_f32 v9, v38, v39
 v_lshlrev_b32 v38, 16, v9
 v_and_b32 v39, 0xffff0000, v9
 v_cvt_pk_bf16_f32 v9, v40, v41
 v_lshlrev_b32 v40, 16, v9
 v_and_b32 v41, 0xffff0000, v9
 v_cvt_pk_bf16_f32 v9, v42, v43
 v_lshlrev_b32 v42, 16, v9
 v_and_b32 v43, 0xffff0000, v9
 v_cvt_pk_bf16_f32 v9, v44, v45
 v_lshlrev_b32 v44, 16, v9
 v_and_b32 v45, 0xffff0000, v9
 v_cvt_pk_bf16_f32 v9, v46, v47
 v_lshlrev_b32 v46, 16, v9
 v_and_b32 v47, 0xffff0000, v9
 v_pk_mul_f32 v[36:37], v[36:37], v[10:11] op_sel:[0,1] op_sel_hi:[1,1]
 v_pk_mul_f32 v[38:39], v[38:39], v[10:11] op_sel:[0,1] op_sel_hi:[1,1]
 v_pk_mul_f32 v[40:41], v[40:41], v[10:11] op_sel:[0,1] op_sel_hi:[1,1]
 v_pk_mul_f32 v[42:43], v[42:43], v[10:11] op_sel:[0,1] op_sel_hi:[1,1]
 v_pk_mul_f32 v[44:45], v[44:45], v[10:11] op_sel:[0,1] op_sel_hi:[1,1]
 v_pk_mul_f32 v[46:47], v[46:47], v[10:11] op_sel:[0,1] op_sel_hi:[1,1]
 v_cvt_pk_bf16_f32 v24, v36, v37
 v_cvt_pk_bf16_f32 v25, v38, v39
 v_cvt_pk_bf16_f32 v26, v40, v41
 v_cvt_pk_bf16_f32 v27, v42, v43
 v_cvt_pk_bf16_f32 v28, v44, v45
 v_cvt_pk_bf16_f32 v29, v46, v47
 s_mul_i32 s3, s72, 1280
 s_add_u32 s3, s3, 226492416
 buffer_store_dwordx2 v[24:25], v4, s[4:7], s3 offen offset:0 sc1
 buffer_store_dwordx2 v[26:27], v4, s[4:7], s3 offen offset:512 sc1
 buffer_store_dwordx2 v[28:29], v8, s[4:7], s3 offen offset:1024 sc1
 s_add_u32 s72, s72, 64
 s_waitcnt vmcnt(3)
 s_cmp_lt_u32 s72, 2048
 s_cbranch_scc1 L_ln_139
 s_waitcnt vmcnt(0)
 s_mov_b32 s96, s44
 s_and_b32 s97, s45, 0xffff
 s_mov_b32 s98, 256
 s_mov_b32 s99, 0x00020000
 v_mov_b32 v1, 1
 s_mov_b64 exec, 1
 buffer_atomic_add v1, off, s[96:99], 0 offset:12 sc0
 s_waitcnt vmcnt(0)
 v_cmp_eq_u32 vcc, 63, v1
 s_cbranch_vccz L_aw_140
 buffer_store_dword v1, off, s[96:99], 0 offset:140 sc1
L_aw_140:
 s_mov_b64 exec, -1
 s_mov_b32 s70, s60
 s_mov_b32 s69, 96
 s_mov_b32 s96, s44
 s_and_b32 s97, s45, 0xffff
 s_mov_b32 s98, 256
 s_mov_b32 s99, 0x00020000
 v_mov_b32 v1, 196
 s_mov_b32 s51, 0
 s_mov_b64 exec, 1
L_wb_141:
 buffer_load_dword v2, v1, s[96:99], 0 offen sc1
 s_waitcnt vmcnt(0)
 v_cmp_eq_u32 vcc, 0, v2
 s_cbranch_vccz L_wbd_142
 s_sleep 2
 s_add_u32 s51, s51, 1
 s_cmp_lt_u32 s51, 131072
 s_cbranch_scc1 L_wb_141
 s_branch L_bail
L_wbd_142:
 s_mov_b64 exec, -1
 s_mov_b32 s96, s44
 s_and_b32 s97, s45, 0xffff
 s_mov_b32 s98, 256
 s_mov_b32 s99, 0x00020000
 v_mov_b32 v1, 208
 s_mov_b32 s51, 0
 s_mov_b64 exec, 1
L_wb_143:
 buffer_load_dword v2, v1, s[96:99], 0 offen sc1
 s_waitcnt vmcnt(0)
 v_cmp_eq_u32 vcc, 0, v2
 s_cbranch_vccz L_wbd_144
 s_sleep 2
 s_add_u32 s51, s51, 1
 s_cmp_lt_u32 s51, 131072
 s_cbranch_scc1 L_wb_143
 s_branch L_bail
L_wbd_144:
 s_mov_b64 exec, -1
 s_mov_b32 s8, s38
 s_and_b32 s9, s39, 0xffff
 s_mov_b32 s10, 2621440
 s_mov_b32 s11, 0x00020000
 s_mov_b32 s12, s40
 s_and_b32 s13, s41, 0xffff
 s_mov_b32 s14, 1280
 s_mov_b32 s15, 0x00020000
 v_lshlrev_b32 v130, 4, v0
 s_lshl_b32 s73, s70, 12
 s_add_u32 s74, s73, 2
 buffer_load_dwordx4 v[96:99], v130, s[8:11], s73 offen offset:0
 buffer_load_dwordx4 v[100:103], v130, s[8:11], s73 offen offset:1024
 buffer_load_dwordx4 v[104:107], v130, s[8:11], s73 offen offset:2048
 buffer_load_dwordx4 v[108:111], v130, s[8:11], s73 offen offset:3072
 buffer_load_dwordx4 v[112:115], v130, s[8:11], s74 offen offset:0
 buffer_load_dwordx4 v[116:119], v130, s[8:11], s74 offen offset:1024
 buffer_load_dwordx4 v[120:123], v130, s[8:11], s74 offen offset:2048
 buffer_load_dwordx4 v[124:127], v130, s[8:11], s74 offen offset:3072
 s_lshl_b32 s3, s70, 1
 buffer_load_ushort v128, off, s[12:15], s3
 s_lshl_b32 s3, s70, 12
 s_add_u32 s3, s3, 231735296
 buffer_load_dwordx4 v[240:243], v130, s[4:7], s3 offen offset:0 sc1
 buffer_load_dwordx4 v[244:247], v130, s[4:7], s3 offen offset:1024 sc1
 buffer_load_dwordx4 v[248:251], v130, s[4:7], s3 offen offset:2048 sc1
 buffer_load_dwordx4 v[252:255], v130, s[4:7], s3 offen offset:3072 sc1
 s_getpc_b64 s[76:77]
L_ca_145:
 s_add_u32 s76, s76, L_conv1-L_ca_145
 s_addc_u32 s77, s77, -1
 s_swappc_b64 s[76:77], s[76:77]
 s_waitcnt vmcnt(0)
 s_mov_b32 s96, s44
 s_and_b32 s97, s45, 0xffff
 s_mov_b32 s98, 256
 s_mov_b32 s99, 0x00020000
 v_mov_b32 v1, 1
 s_mov_b64 exec, 1
 buffer_atomic_add v1, off, s[96:99], 0 offset:76 sc0
 s_waitcnt vmcnt(0)
 v_cmp_eq_u32 vcc, 95, v1
 s_cbranch_vccz L_aw_146
 buffer_store_dword v1, off, s[96:99], 0 offset:204 sc1
L_aw_146:
 s_mov_b64 exec, -1
 s_mov_b32 s96, s44
 s_and_b32 s97, s45, 0xffff
 s_mov_b32 s98, 256
 s_mov_b32 s99, 0x00020000
 v_mov_b32 v1, 204
 s_mov_b32 s51, 0
 s_mov_b64 exec, 1
L_wb_147:
 buffer_load_dword v2, v1, s[96:99], 0 offen sc1
 s_waitcnt vmcnt(0)
 v_cmp_eq_u32 vcc, 0, v2
 s_cbranch_vccz L_wbd_148
 s_sleep 2
 s_add_u32 s51, s51, 1
 s_cmp_lt_u32 s51, 131072
 s_cbranch_scc1 L_wb_147
 s_branch L_bail
L_wbd_148:
 s_mov_b64 exec, -1
 v_lshlrev_b32 v1, 4, v0
 s_mul_i32 s55, s52, 40960
 s_mul_i32 s56, s54, 20480
 s_add_u32 s55, s55, s56
 s_add_u32 s55, s55, 235667456
 s_add_u32 m0, s56, 40960
 s_add_u32 s3, s55, 0
 buffer_load_dwordx4 v1, s[4:7], s3 offen offset:0 sc1 lds
 buffer_load_dwordx4 v1, s[4:7], s3 offen offset:1024 sc1 lds
 s_add_u32 m0, s56, 43008
 s_add_u32 s3, s55, 2048
 buffer_load_dwordx4 v1, s[4:7], s3 offen offset:0 sc1 lds
 buffer_load_dwordx4 v1, s[4:7], s3 offen offset:1024 sc1 lds
 s_add_u32 m0, s56, 45056
 s_add_u32 s3, s55, 4096
 buffer_load_dwordx4 v1, s[4:7], s3 offen offset:0 sc1 lds
 buffer_load_dwordx4 v1, s[4:7], s3 offen offset:1024 sc1 lds
 s_add_u32 m0, s56, 47104
 s_add_u32 s3, s55, 6144
 buffer_load_dwordx4 v1, s[4:7], s3 offen offset:0 sc1 lds
 buffer_load_dwordx4 v1, s[4:7], s3 offen offset:1024 sc1 lds
 s_add_u32 m0, s56, 49152
 s_add_u32 s3, s55, 8192
 buffer_load_dwordx4 v1, s[4:7], s3 offen offset:0 sc1 lds
 buffer_load_dwordx4 v1, s[4:7], s3 offen offset:1024 sc1 lds
 s_add_u32 m0, s56, 51200
 s_add_u32 s3, s55, 10240
 buffer_load_dwordx4 v1, s[4:7], s3 offen offset:0 sc1 lds
 buffer_load_dwordx4 v1, s[4:7], s3 offen offset:1024 sc1 lds
 s_add_u32 m0, s56, 53248
 s_add_u32 s3, s55, 12288
 buffer_load_dwordx4 v1, s[4:7], s3 offen offset:0 sc1 lds
 buffer_load_dwordx4 v1, s[4:7], s3 offen offset:1024 sc1 lds
 s_add_u32 m0, s56, 55296
 s_add_u32 s3, s55, 14336
 buffer_load_dwordx4 v1, s[4:7], s3 offen offset:0 sc1 lds
 buffer_load_dwordx4 v1, s[4:7], s3 offen offset:1024 sc1 lds
 s_add_u32 m0, s56, 57344
 s_add_u32 s3, s55, 16384
 buffer_load_dwordx4 v1, s[4:7], s3 offen offset:0 sc1 lds
 buffer_load_dwordx4 v1, s[4:7], s3 offen offset:1024 sc1 lds
 s_add_u32 m0, s56, 59392
 s_add_u32 s3, s55, 18432
 buffer_load_dwordx4 v1, s[4:7], s3 offen offset:0 sc1 lds
 buffer_load_dwordx4 v1, s[4:7], s3 offen offset:1024 sc1 lds
 s_waitcnt vmcnt(0) lgkmcnt(0)
 s_lshl_b32 s3, s50, 2
 s_add_u32 s3, s3, 163776
 v_mov_b32 v73, s3
 v_mov_b32 v72, 1
 ds_write_b32 v73, v72
L_e0_138:
 s_lshl_b32 s3, s54, 2
 s_add_u32 s3, s3, 163776
 v_mov_b32 v73, s3
 s_mov_b32 s8, s16
 s_and_b32 s9, s17, 0xffff
 s_mov_b32 s10, 2621440
 s_mov_b32 s11, 0x00020000
 s_mov_b32 s12, s42
 s_and_b32 s13, s43, 0xffff
 s_mov_b32 s14, 2621440
 s_mov_b32 s15, 0x00020000
 v_lshlrev_b32 v1, 4, v0
 v_lshlrev_b32 v2, 3, v0
 v_cmp_lt_u32 vcc, 31, v0
 v_mov_b32 v3, 268435456
 s_nop 1
 v_cndmask_b32 v6, v1, v3, vcc
 v_cndmask_b32 v7, v2, v3, vcc
 s_and_b32 s3, s52, 15
 v_lshrrev_b32 v4, 3, v0
 v_lshlrev_b32 v4, 2, v4
 v_and_b32 v10, 3, v0
 v_add_u32 v4, v4, v10
 v_xor_b32 v4, s3, v4
 v_lshlrev_b32 v4, 4, v4
 v_and_b32 v10, 4, v0
 v_lshl_add_u32 v4, v10, 1, v4
 v_cndmask_b32 v8, v4, v3, vcc
 s_lshl_b32 s3, s52, 9
 s_lshl_b32 s55, s53, 8
 s_add_u32 s3, s3, s55
 s_add_u32 s3, s3, 61440
 v_mul_u32_u24 v5, 16384, v0
 v_add_u32 v5, s3, v5
 s_sub_u32 s3, s3, 4
 v_writelane_b32 v5, s3, 4
 v_lshlrev_b32 v68, 8, v0
 s_mov_b32 s57, 0x3acccccd
 s_mov_b32 s58, 0x3727c5ac
L_t4_loop:
 s_lshl_b32 s60, s54, 5
 s_add_u32 s60, s60, s52
 s_mul_i32 s60, s60, 1280
 s_cmp_eq_u32 s53, 0
 s_cselect_b32 s3, s60, 268435456
 buffer_load_dwordx2 v[48:49], v2, s[8:11], s3 offen offset:0
 buffer_load_dwordx2 v[50:51], v2, s[8:11], s3 offen offset:512
 buffer_load_dwordx2 v[52:53], v7, s[8:11], s3 offen offset:1024
 s_and_b32 s3, s54, 62
 s_cmp_lg_u32 s3, 32
 s_cbranch_scc1 L_yhd_150
 v_mov_b32 v3, 163784
 s_mov_b32 s51, 0
L_yh_149:
 ds_read_b64 v[24:25], v3
 s_waitcnt lgkmcnt(0)
 v_and_b32 v24, v24, v25
 v_cmp_eq_u32 vcc, 0, v24
 s_cbranch_vccz L_yhd_150
 s_sleep 8
 s_add_u32 s51, s51, 1
 s_cmp_lt_u32 s51, 131072
 s_cbranch_scc1 L_yh_149
 s_branch L_bail
L_yhd_150:
 s_and_b32 s3, s54, 7
 s_lshl_b32 s3, s3, 3
 s_bfe_u32 s55, s54, 0x20003
 s_lshl_b32 s55, s55, 1
 s_add_u32 s3, s3, s55
 s_lshr_b32 s55, s54, 5
 s_mul_i32 s55, s55, 40960
 s_add_u32 s3, s3, s55
 v_lshlrev_b32 v72, 8, v0
 v_add_u32 v72, s3, v72
 ds_read_u16 v24, v72 offset:0
 ds_read_u16 v25, v72 offset:64
 ds_read_u16 v26, v72 offset:128
 ds_read_u16 v27, v72 offset:192
 ds_read_u16 v28, v72 offset:16384
 ds_read_u16 v29, v72 offset:16448
 ds_read_u16 v30, v72 offset:16512
 ds_read_u16 v31, v72 offset:16576
 v_mov_b32 v32, 0
 v_mov_b32 v33, 0
 v_mov_b32 v34, 0
 v_mov_b32 v35, 0
 s_mov_b32 exec_hi, 0
 ds_read_u16 v32, v72 offset:32768
 ds_read_u16 v33, v72 offset:32832
 ds_read_u16 v34, v72 offset:32896
 ds_read_u16 v35, v72 offset:32960
 s_mov_b32 exec_hi, -1
 s_waitcnt vmcnt(0) lgkmcnt(0)
 v_lshlrev_b32 v24, 16, v24
 v_lshlrev_b32 v25, 16, v25
 v_lshlrev_b32 v26, 16, v26
 v_lshlrev_b32 v27, 16, v27
 v_lshlrev_b32 v28, 16, v28
 v_lshlrev_b32 v29, 16, v29
 v_lshlrev_b32 v30, 16, v30
 v_lshlrev_b32 v31, 16, v31
 v_lshlrev_b32 v32, 16, v32
 v_lshlrev_b32 v33, 16, v33
 v_lshlrev_b32 v34, 16, v34
 v_lshlrev_b32 v35, 16, v35
 v_lshlrev_b32 v12, 16, v48
 v_and_b32 v13, 0xffff0000, v48
 v_lshlrev_b32 v14, 16, v49
 v_and_b32 v15, 0xffff0000, v49
 v_lshlrev_b32 v16, 16, v50
 v_and_b32 v17, 0xffff0000, v50
 v_lshlrev_b32 v18, 16, v51
 v_and_b32 v19, 0xffff0000, v51
 v_lshlrev_b32 v20, 16, v52
 v_and_b32 v21, 0xffff0000, v52
 v_lshlrev_b32 v22, 16, v53
 v_and_b32 v23, 0xffff0000, v53
 s_lshl_b32 s55, s54, 2
 s_mov_b32 s51, 0
 s_mov_b64 exec, 31
L_tw_151:
 v_mov_b32 v3, 0
 buffer_atomic_add v3, v5, s[4:7], s55 offen sc0
 s_waitcnt vmcnt(0)
 v_cmp_gt_u32 vcc, 10, v3
 s_and_b32 s3, vcc_lo, 15
 s_cbranch_scc0 L_twd_152
 s_bitcmp0_b32 vcc_lo, 4
 s_cbranch_scc1 L_twf_153
 s_cmp_eq_u32 s54, 0
 s_cbranch_scc1 L_twf_153
 s_sleep 24
L_twf_153:
 s_sleep 8
 s_add_u32 s51, s51, 1
 s_cmp_lt_u32 s51, 131072
 s_cbranch_scc1 L_tw_151
 s_branch L_bail
L_twd_152:
 s_mov_b64 exec, -1
 s_lshl_b32 s55, s53, 6
 s_add_u32 s55, s55, s54
 s_mul_i32 s55, s55, 655360
 s_mul_i32 s3, s52, 2560
 s_add_u32 s55, s55, s3
 s_add_u32 s55, s55, 142606336
 buffer_load_dwordx4 v[80:83], v1, s[4:7], s55 offen offset:0 sc1 nt
 buffer_load_dwordx4 v[84:87], v1, s[4:7], s55 offen offset:1024 sc1 nt
 buffer_load_dwordx4 v[88:91], v6, s[4:7], s55 offen offset:2048 sc1 nt
 s_add_u32 s55, s55, 81920
 buffer_load_dwordx4 v[92:95], v1, s[4:7], s55 offen offset:0 sc1 nt
 buffer_load_dwordx4 v[96:99], v1, s[4:7], s55 offen offset:1024 sc1 nt
 buffer_load_dwordx4 v[100:103], v6, s[4:7], s55 offen offset:2048 sc1 nt
 s_add_u32 s55, s55, 81920
 buffer_load_dwordx4 v[104:107], v1, s[4:7], s55 offen offset:0 sc1 nt
 buffer_load_dwordx4 v[108:111], v1, s[4:7], s55 offen offset:1024 sc1 nt
 buffer_load_dwordx4 v[112:115], v6, s[4:7], s55 offen offset:2048 sc1 nt
 s_add_u32 s55, s55, 81920
 buffer_load_dwordx4 v[116:119], v1, s[4:7], s55 offen offset:0 sc1 nt
 buffer_load_dwordx4 v[120:123], v1, s[4:7], s55 offen offset:1024 sc1 nt
 buffer_load_dwordx4 v[124:127], v6, s[4:7], s55 offen offset:2048 sc1 nt
 s_add_u32 s55, s55, 81920
 buffer_load_dwordx4 v[128:131], v1, s[4:7], s55 offen offset:0 sc1 nt
 buffer_load_dwordx4 v[132:135], v1, s[4:7], s55 offen offset:1024 sc1 nt
 buffer_load_dwordx4 v[136:139], v6, s[4:7], s55 offen offset:2048 sc1 nt
 s_add_u32 s55, s55, 81920
 buffer_load_dwordx4 v[140:143], v1, s[4:7], s55 offen offset:0 sc1 nt
 buffer_load_dwordx4 v[144:147], v1, s[4:7], s55 offen offset:1024 sc1 nt
 buffer_load_dwordx4 v[148:151], v6, s[4:7], s55 offen offset:2048 sc1 nt
 s_add_u32 s55, s55, 81920
 buffer_load_dwordx4 v[152:155], v1, s[4:7], s55 offen offset:0 sc1 nt
 buffer_load_dwordx4 v[156:159], v1, s[4:7], s55 offen offset:1024 sc1 nt
 buffer_load_dwordx4 v[160:163], v6, s[4:7], s55 offen offset:2048 sc1 nt
 s_add_u32 s55, s55, 81920
 buffer_load_dwordx4 v[164:167], v1, s[4:7], s55 offen offset:0 sc1 nt
 buffer_load_dwordx4 v[168:171], v1, s[4:7], s55 offen offset:1024 sc1 nt
 buffer_load_dwordx4 v[172:175], v6, s[4:7], s55 offen offset:2048 sc1 nt
 s_add_u32 s55, s55, 81920
 s_and_b32 s56, s54, 31
 s_mul_i32 s56, s56, 1536
 s_add_u32 s56, s56, 81920
 v_add_u32 v3, s56, v2
 s_cmp_eq_u32 s53, 0
 s_cbranch_scc1 L_l0_154
 ds_read_b64 v[48:49], v3 offset:0
 ds_read_b64 v[50:51], v3 offset:512
 ds_read_b64 v[52:53], v3 offset:1024
 s_waitcnt lgkmcnt(0)
 v_lshlrev_b32 v12, 16, v48
 v_and_b32 v13, 0xffff0000, v48
 v_lshlrev_b32 v14, 16, v49
 v_and_b32 v15, 0xffff0000, v49
 v_lshlrev_b32 v16, 16, v50
 v_and_b32 v17, 0xffff0000, v50
 v_lshlrev_b32 v18, 16, v51
 v_and_b32 v19, 0xffff0000, v51
 v_lshlrev_b32 v20, 16, v52
 v_and_b32 v21, 0xffff0000, v52
 v_lshlrev_b32 v22, 16, v53
 v_and_b32 v23, 0xffff0000, v53
 s_add_u32 s3, s54, 1
 v_mov_b32 v10, s3
 ds_write_b32 v73, v10
L_l0_154:
 s_waitcnt vmcnt(18)
 v_pk_add_f32 v[80:81], v[80:81], v[92:93]
 v_pk_add_f32 v[82:83], v[82:83], v[94:95]
 v_pk_add_f32 v[84:85], v[84:85], v[96:97]
 v_pk_add_f32 v[86:87], v[86:87], v[98:99]
 v_pk_add_f32 v[88:89], v[88:89], v[100:101]
 v_pk_add_f32 v[90:91], v[90:91], v[102:103]
 s_waitcnt vmcnt(15)
 v_pk_add_f32 v[80:81], v[80:81], v[104:105]
 v_pk_add_f32 v[82:83], v[82:83], v[106:107]
 v_pk_add_f32 v[84:85], v[84:85], v[108:109]
 v_pk_add_f32 v[86:87], v[86:87], v[110:111]
 v_pk_add_f32 v[88:89], v[88:89], v[112:113]
 v_pk_add_f32 v[90:91], v[90:91], v[114:115]
 s_waitcnt vmcnt(12)
 v_pk_add_f32 v[80:81], v[80:81], v[116:117]
 v_pk_add_f32 v[82:83], v[82:83], v[118:119]
 v_pk_add_f32 v[84:85], v[84:85], v[120:121]
 v_pk_add_f32 v[86:87], v[86:87], v[122:123]
 v_pk_add_f32 v[88:89], v[88:89], v[124:125]
 v_pk_add_f32 v[90:91], v[90:91], v[126:127]
 s_waitcnt vmcnt(9)
 v_pk_add_f32 v[80:81], v[80:81], v[128:129]
 v_pk_add_f32 v[82:83], v[82:83], v[130:131]
 v_pk_add_f32 v[84:85], v[84:85], v[132:133]
 v_pk_add_f32 v[86:87], v[86:87], v[134:135]
 v_pk_add_f32 v[88:89], v[88:89], v[136:137]
 v_pk_add_f32 v[90:91], v[90:91], v[138:139]
 s_waitcnt vmcnt(6)
 v_pk_add_f32 v[80:81], v[80:81], v[140:141]
 v_pk_add_f32 v[82:83], v[82:83], v[142:143]
 v_pk_add_f32 v[84:85], v[84:85], v[144:145]
 v_pk_add_f32 v[86:87], v[86:87], v[146:147]
 v_pk_add_f32 v[88:89], v[88:89], v[148:149]
 v_pk_add_f32 v[90:91], v[90:91], v[150:151]
 s_waitcnt vmcnt(3)
 v_pk_add_f32 v[80:81], v[80:81], v[152:153]
 v_pk_add_f32 v[82:83], v[82:83], v[154:155]
 v_pk_add_f32 v[84:85], v[84:85], v[156:157]
 v_pk_add_f32 v[86:87], v[86:87], v[158:159]
 v_pk_add_f32 v[88:89], v[88:89], v[160:161]
 v_pk_add_f32 v[90:91], v[90:91], v[162:163]
 s_waitcnt vmcnt(0)
 v_pk_add_f32 v[80:81], v[80:81], v[164:165]
 v_pk_add_f32 v[82:83], v[82:83], v[166:167]
 v_pk_add_f32 v[84:85], v[84:85], v[168:169]
 v_pk_add_f32 v[86:87], v[86:87], v[170:171]
 v_pk_add_f32 v[88:89], v[88:89], v[172:173]
 v_pk_add_f32 v[90:91], v[90:91], v[174:175]
 v_cvt_pk_bf16_f32 v9, v80, v81
 v_lshlrev_b32 v80, 16, v9
 v_and_b32 v81, 0xffff0000, v9
 v_cvt_pk_bf16_f32 v9, v82, v83
 v_lshlrev_b32 v82, 16, v9
 v_and_b32 v83, 0xffff0000, v9
 v_cvt_pk_bf16_f32 v9, v84, v85
 v_lshlrev_b32 v84, 16, v9
 v_and_b32 v85, 0xffff0000, v9
 v_cvt_pk_bf16_f32 v9, v86, v87
 v_lshlrev_b32 v86, 16, v9
 v_and_b32 v87, 0xffff0000, v9
 v_cvt_pk_bf16_f32 v9, v88, v89
 v_lshlrev_b32 v88, 16, v9
 v_and_b32 v89, 0xffff0000, v9
 v_cvt_pk_bf16_f32 v9, v90, v91
 v_lshlrev_b32 v90, 16, v9
 v_and_b32 v91, 0xffff0000, v9
 v_pk_add_f32 v[12:13], v[12:13], v[80:81]
 v_pk_add_f32 v[14:15], v[14:15], v[82:83]
 v_pk_add_f32 v[16:17], v[16:17], v[84:85]
 v_pk_add_f32 v[18:19], v[18:19], v[86:87]
 v_pk_add_f32 v[20:21], v[20:21], v[88:89]
 v_pk_add_f32 v[22:23], v[22:23], v[90:91]
 v_cvt_pk_bf16_f32 v9, v12, v13
 v_lshlrev_b32 v12, 16, v9
 v_and_b32 v13, 0xffff0000, v9
 v_cvt_pk_bf16_f32 v9, v14, v15
 v_lshlrev_b32 v14, 16, v9
 v_and_b32 v15, 0xffff0000, v9
 v_cvt_pk_bf16_f32 v9, v16, v17
 v_lshlrev_b32 v16, 16, v9
 v_and_b32 v17, 0xffff0000, v9
 v_cvt_pk_bf16_f32 v9, v18, v19
 v_lshlrev_b32 v18, 16, v9
 v_and_b32 v19, 0xffff0000, v9
 v_cvt_pk_bf16_f32 v9, v20, v21
 v_lshlrev_b32 v20, 16, v9
 v_and_b32 v21, 0xffff0000, v9
 v_cvt_pk_bf16_f32 v9, v22, v23
 v_lshlrev_b32 v22, 16, v9
 v_and_b32 v23, 0xffff0000, v9
 v_readfirstlane_b32 s3, v12
 s_nop 1
 v_subrev_f32 v36, s3, v12
 v_subrev_f32 v37, s3, v13
 v_subrev_f32 v38, s3, v14
 v_subrev_f32 v39, s3, v15
 v_subrev_f32 v40, s3, v16
 v_subrev_f32 v41, s3, v17
 v_subrev_f32 v42, s3, v18
 v_subrev_f32 v43, s3, v19
 v_mov_b32 v44, 0
 v_mov_b32 v45, 0
 v_mov_b32 v46, 0
 v_mov_b32 v47, 0
 s_mov_b32 exec_hi, 0
 v_subrev_f32 v44, s3, v20
 v_subrev_f32 v45, s3, v21
 v_subrev_f32 v46, s3, v22
 v_subrev_f32 v47, s3, v23
 s_mov_b32 exec_hi, -1
 v_pk_mul_f32 v[10:11], v[36:37], v[36:37]
 v_pk_fma_f32 v[10:11], v[38:39], v[38:39], v[10:11]
 v_pk_fma_f32 v[10:11], v[40:41], v[40:41], v[10:11]
 v_pk_fma_f32 v[10:11], v[42:43], v[42:43], v[10:11]
 v_pk_fma_f32 v[10:11], v[44:45], v[44:45], v[10:11]
 v_pk_fma_f32 v[10:11], v[46:47], v[46:47], v[10:11]
 v_pk_add_f32 v[36:37], v[36:37], v[38:39]
 v_pk_add_f32 v[36:37], v[36:37], v[40:41]
 v_pk_add_f32 v[36:37], v[36:37], v[42:43]
 v_pk_add_f32 v[36:37], v[36:37], v[44:45]
 v_pk_add_f32 v[36:37], v[36:37], v[46:47]
 v_add_f32 v11, v10, v11
 v_add_f32 v10, v36, v37
 s_nop 0
 v_add_f32_dpp v11, v11, v11 quad_perm:[1,0,3,2] row_mask:0xf bank_mask:0xf
 v_add_f32_dpp v10, v10, v10 quad_perm:[1,0,3,2] row_mask:0xf bank_mask:0xf
 s_nop 0
 v_add_f32_dpp v11, v11, v11 quad_perm:[2,3,0,1] row_mask:0xf bank_mask:0xf
 v_add_f32_dpp v10, v10, v10 quad_perm:[2,3,0,1] row_mask:0xf bank_mask:0xf
 s_nop 0
 v_add_f32_dpp v11, v11, v11 row_half_mirror row_mask:0xf bank_mask:0xf
 v_add_f32_dpp v10, v10, v10 row_half_mirror row_mask:0xf bank_mask:0xf
 s_nop 0
 v_add_f32_dpp v11, v11, v11 row_mirror row_mask:0xf bank_mask:0xf
 v_add_f32_dpp v10, v10, v10 row_mirror row_mask:0xf bank_mask:0xf
 v_mov_b32 v37, v11
 v_mov_b32 v36, v10
 s_nop 0
 v_permlane16_swap_b32 v11, v37
 v_permlane16_swap_b32 v10, v36
 v_pk_add_f32 v[10:11], v[10:11], v[36:37]
 v_mov_b32 v37, v11
 v_mov_b32 v36, v10
 s_nop 0
 v_permlane32_swap_b32 v11, v37
 v_permlane32_swap_b32 v10, v36
 v_pk_add_f32 v[10:11], v[10:11], v[36:37]
 v_mul_f32 v10, s57, v10
 v_mul_f32 v11, s57, v11
 v_fma_f32 v11, -v10, v10, v11
 v_max_f32 v11, 0, v11
 v_add_f32 v10, s3, v10
 v_cvt_pk_bf16_f32 v9, v10, v11
 v_lshlrev_b32 v10, 16, v9
 v_and_b32 v11, 0xffff0000, v9
 v_add_f32 v11, s58, v11
 v_cvt_pk_bf16_f32 v11, v11, v11
 v_and_b32 v11, 0xffff0000, v11
 v_sqrt_f32 v11, v11
 s_nop 0
 v_pk_add_f32 v[36:37], v[12:13], v[10:11] op_sel_hi:[1,0] neg_lo:[0,1] neg_hi:[0,1]
 v_pk_add_f32 v[38:39], v[14:15], v[10:11] op_sel_hi:[1,0] neg_lo:[0,1] neg_hi:[0,1]
 v_pk_add_f32 v[40:41], v[16:17], v[10:11] op_sel_hi:[1,0] neg_lo:[0,1] neg_hi:[0,1]
 v_pk_add_f32 v[42:43], v[18:19], v[10:11] op_sel_hi:[1,0] neg_lo:[0,1] neg_hi:[0,1]
 v_pk_add_f32 v[44:45], v[20:21], v[10:11] op_sel_hi:[1,0] neg_lo:[0,1] neg_hi:[0,1]
 v_pk_add_f32 v[46:47], v[22:23], v[10:11] op_sel_hi:[1,0] neg_lo:[0,1] neg_hi:[0,1]
 v_cvt_pk_bf16_f32 v11, v11, v11
 v_and_b32 v11, 0xffff0000, v11
 v_rcp_f32 v11, v11
 v_cvt_pk_bf16_f32 v9, v36, v37
 v_lshlrev_b32 v36, 16, v9
 v_and_b32 v37, 0xffff0000, v9
 v_cvt_pk_bf16_f32 v9, v38, v39
 v_lshlrev_b32 v38, 16, v9
 v_and_b32 v39, 0xffff0000, v9
 v_cvt_pk_bf16_f32 v9, v40, v41
 v_lshlrev_b32 v40, 16, v9
 v_and_b32 v41, 0xffff0000, v9
 v_cvt_pk_bf16_f32 v9, v42, v43
 v_lshlrev_b32 v42, 16, v9
 v_and_b32 v43, 0xffff0000, v9
 v_cvt_pk_bf16_f32 v9, v44, v45
 v_lshlrev_b32 v44, 16, v9
 v_and_b32 v45, 0xffff0000, v9
 v_cvt_pk_bf16_f32 v9, v46, v47
 v_lshlrev_b32 v46, 16, v9
 v_and_b32 v47, 0xffff0000, v9
 v_pk_mul_f32 v[36:37], v[36:37], v[10:11] op_sel:[0,1] op_sel_hi:[1,1]
 v_pk_mul_f32 v[38:39], v[38:39], v[10:11] op_sel:[0,1] op_sel_hi:[1,1]
 v_pk_mul_f32 v[40:41], v[40:41], v[10:11] op_sel:[0,1] op_sel_hi:[1,1]
 v_pk_mul_f32 v[42:43], v[42:43], v[10:11] op_sel:[0,1] op_sel_hi:[1,1]
 v_pk_mul_f32 v[44:45], v[44:45], v[10:11] op_sel:[0,1] op_sel_hi:[1,1]
 v_pk_mul_f32 v[46:47], v[46:47], v[10:11] op_sel:[0,1] op_sel_hi:[1,1]
 v_cvt_pk_bf16_f32 v9, v36, v37
 v_lshlrev_b32 v36, 16, v9
 v_and_b32 v37, 0xffff0000, v9
 v_cvt_pk_bf16_f32 v9, v38, v39
 v_lshlrev_b32 v38, 16, v9
 v_and_b32 v39, 0xffff0000, v9
 v_cvt_pk_bf16_f32 v9, v40, v41
 v_lshlrev_b32 v40, 16, v9
 v_and_b32 v41, 0xffff0000, v9
 v_cvt_pk_bf16_f32 v9, v42, v43
 v_lshlrev_b32 v42, 16, v9
 v_and_b32 v43, 0xffff0000, v9
 v_cvt_pk_bf16_f32 v9, v44, v45
 v_lshlrev_b32 v44, 16, v9
 v_and_b32 v45, 0xffff0000, v9
 v_cvt_pk_bf16_f32 v9, v46, v47
 v_lshlrev_b32 v46, 16, v9
 v_and_b32 v47, 0xffff0000, v9
 v_pk_mul_f32 v[36:37], v[36:37], v[24:25]
 v_pk_mul_f32 v[38:39], v[38:39], v[26:27]
 v_pk_mul_f32 v[40:41], v[40:41], v[28:29]
 v_pk_mul_f32 v[42:43], v[42:43], v[30:31]
 v_pk_mul_f32 v[44:45], v[44:45], v[32:33]
 v_pk_mul_f32 v[46:47], v[46:47], v[34:35]
 v_cvt_pk_bf16_f32 v9, v36, v37
 v_lshlrev_b32 v36, 16, v9
 v_and_b32 v37, 0xffff0000, v9
 v_cvt_pk_bf16_f32 v9, v38, v39
 v_lshlrev_b32 v38, 16, v9
 v_and_b32 v39, 0xffff0000, v9
 v_cvt_pk_bf16_f32 v9, v40, v41
 v_lshlrev_b32 v40, 16, v9
 v_and_b32 v41, 0xffff0000, v9
 v_cvt_pk_bf16_f32 v9, v42, v43
 v_lshlrev_b32 v42, 16, v9
 v_and_b32 v43, 0xffff0000, v9
 v_cvt_pk_bf16_f32 v9, v44, v45
 v_lshlrev_b32 v44, 16, v9
 v_and_b32 v45, 0xffff0000, v9
 v_cvt_pk_bf16_f32 v9, v46, v47
 v_lshlrev_b32 v46, 16, v9
 v_and_b32 v47, 0xffff0000, v9
 v_pk_add_f32 v[12:13], v[12:13], v[36:37]
 v_pk_add_f32 v[14:15], v[14:15], v[38:39]
 v_pk_add_f32 v[16:17], v[16:17], v[40:41]
 v_pk_add_f32 v[18:19], v[18:19], v[42:43]
 v_pk_add_f32 v[20:21], v[20:21], v[44:45]
 v_pk_add_f32 v[22:23], v[22:23], v[46:47]
 v_cvt_pk_bf16_f32 v60, v12, v13
 v_cvt_pk_bf16_f32 v61, v14, v15
 v_cvt_pk_bf16_f32 v62, v16, v17
 v_cvt_pk_bf16_f32 v63, v18, v19
 v_cvt_pk_bf16_f32 v64, v20, v21
 v_cvt_pk_bf16_f32 v65, v22, v23
 s_cmp_lg_u32 s53, 0
 s_cbranch_scc1 L_l1_155
 s_cmp_lt_u32 s54, 32
 s_cbranch_scc1 L_rgd_158
 s_sub_u32 s55, s54, 31
 s_mov_b32 s51, 0
L_rg_157:
 ds_read_b32 v10, v73
 s_waitcnt lgkmcnt(0)
 v_cmp_gt_u32 vcc, s55, v10
 s_cbranch_vccz L_rgd_158
 s_sleep 8
 s_add_u32 s51, s51, 1
 s_cmp_lt_u32 s51, 131072
 s_cbranch_scc1 L_rg_157
 s_branch L_bail
L_rgd_158:
 ds_write_b64 v3, v[60:61] offset:0
 ds_write_b64 v3, v[62:63] offset:512
 ds_write_b64 v3, v[64:65] offset:1024
 v_lshlrev_b32 v12, 16, v60
 v_and_b32 v13, 0xffff0000, v60
 v_lshlrev_b32 v14, 16, v61
 v_and_b32 v15, 0xffff0000, v61
 v_lshlrev_b32 v16, 16, v62
 v_and_b32 v17, 0xffff0000, v62
 v_lshlrev_b32 v18, 16, v63
 v_and_b32 v19, 0xffff0000, v63
 v_lshlrev_b32 v20, 16, v64
 v_and_b32 v21, 0xffff0000, v64
 v_lshlrev_b32 v22, 16, v65
 v_and_b32 v23, 0xffff0000, v65
 s_nop 0
 v_readfirstlane_b32 s3, v12
 s_nop 1
 v_subrev_f32 v36, s3, v12
 v_subrev_f32 v37, s3, v13
 v_subrev_f32 v38, s3, v14
 v_subrev_f32 v39, s3, v15
 v_subrev_f32 v40, s3, v16
 v_subrev_f32 v41, s3, v17
 v_subrev_f32 v42, s3, v18
 v_subrev_f32 v43, s3, v19
 v_mov_b32 v44, 0
 v_mov_b32 v45, 0
 v_mov_b32 v46, 0
 v_mov_b32 v47, 0
 s_mov_b32 exec_hi, 0
 v_subrev_f32 v44, s3, v20
 v_subrev_f32 v45, s3, v21
 v_subrev_f32 v46, s3, v22
 v_subrev_f32 v47, s3, v23
 s_mov_b32 exec_hi, -1
 v_pk_mul_f32 v[10:11], v[36:37], v[36:37]
 v_pk_fma_f32 v[10:11], v[38:39], v[38:39], v[10:11]
 v_pk_fma_f32 v[10:11], v[40:41], v[40:41], v[10:11]
 v_pk_fma_f32 v[10:11], v[42:43], v[42:43], v[10:11]
 v_pk_fma_f32 v[10:11], v[44:45], v[44:45], v[10:11]
 v_pk_fma_f32 v[10:11], v[46:47], v[46:47], v[10:11]
 v_pk_add_f32 v[36:37], v[36:37], v[38:39]
 v_pk_add_f32 v[36:37], v[36:37], v[40:41]
 v_pk_add_f32 v[36:37], v[36:37], v[42:43]
 v_pk_add_f32 v[36:37], v[36:37], v[44:45]
 v_pk_add_f32 v[36:37], v[36:37], v[46:47]
 v_add_f32 v11, v10, v11
 v_add_f32 v10, v36, v37
 s_nop 0
 v_add_f32_dpp v11, v11, v11 quad_perm:[1,0,3,2] row_mask:0xf bank_mask:0xf
 v_add_f32_dpp v10, v10, v10 quad_perm:[1,0,3,2] row_mask:0xf bank_mask:0xf
 s_nop 0
 v_add_f32_dpp v11, v11, v11 quad_perm:[2,3,0,1] row_mask:0xf bank_mask:0xf
 v_add_f32_dpp v10, v10, v10 quad_perm:[2,3,0,1] row_mask:0xf bank_mask:0xf
 s_nop 0
 v_add_f32_dpp v11, v11, v11 row_half_mirror row_mask:0xf bank_mask:0xf
 v_add_f32_dpp v10, v10, v10 row_half_mirror row_mask:0xf bank_mask:0xf
 s_nop 0
 v_add_f32_dpp v11, v11, v11 row_mirror row_mask:0xf bank_mask:0xf
 v_add_f32_dpp v10, v10, v10 row_mirror row_mask:0xf bank_mask:0xf
 v_mov_b32 v37, v11
 v_mov_b32 v36, v10
 s_nop 0
 v_permlane16_swap_b32 v11, v37
 v_permlane16_swap_b32 v10, v36
 v_pk_add_f32 v[10:11], v[10:11], v[36:37]
 v_mov_b32 v37, v11
 v_mov_b32 v36, v10
 s_nop 0
 v_permlane32_swap_b32 v11, v37
 v_permlane32_swap_b32 v10, v36
 v_pk_add_f32 v[10:11], v[10:11], v[36:37]
 v_mul_f32 v10, s57, v10
 v_mul_f32 v11, s57, v11
 v_fma_f32 v11, -v10, v10, v11
 v_max_f32 v11, 0, v11
 v_add_f32 v10, s3, v10
 v_cvt_pk_bf16_f32 v9, v10, v11
 v_lshlrev_b32 v10, 16, v9
 v_and_b32 v11, 0xffff0000, v9
 v_add_f32 v11, s58, v11
 v_cvt_pk_bf16_f32 v11, v11, v11
 v_and_b32 v11, 0xffff0000, v11
 v_sqrt_f32 v11, v11
 s_nop 0
 v_pk_add_f32 v[36:37], v[12:13], v[10:11] op_sel_hi:[1,0] neg_lo:[0,1] neg_hi:[0,1]
 v_pk_add_f32 v[38:39], v[14:15], v[10:11] op_sel_hi:[1,0] neg_lo:[0,1] neg_hi:[0,1]
 v_pk_add_f32 v[40:41], v[16:17], v[10:11] op_sel_hi:[1,0] neg_lo:[0,1] neg_hi:[0,1]
 v_pk_add_f32 v[42:43], v[18:19], v[10:11] op_sel_hi:[1,0] neg_lo:[0,1] neg_hi:[0,1]
 v_pk_add_f32 v[44:45], v[20:21], v[10:11] op_sel_hi:[1,0] neg_lo:[0,1] neg_hi:[0,1]
 v_pk_add_f32 v[46:47], v[22:23], v[10:11] op_sel_hi:[1,0] neg_lo:[0,1] neg_hi:[0,1]
 v_cvt_pk_bf16_f32 v11, v11, v11
 v_and_b32 v11, 0xffff0000, v11
 v_rcp_f32 v11, v11
 v_cvt_pk_bf16_f32 v9, v36, v37
 v_lshlrev_b32 v36, 16, v9
 v_and_b32 v37, 0xffff0000, v9
 v_cvt_pk_bf16_f32 v9, v38, v39
 v_lshlrev_b32 v38, 16, v9
 v_and_b32 v39, 0xffff0000, v9
 v_cvt_pk_bf16_f32 v9, v40, v41
 v_lshlrev_b32 v40, 16, v9
 v_and_b32 v41, 0xffff0000, v9
 v_cvt_pk_bf16_f32 v9, v42, v43
 v_lshlrev_b32 v42, 16, v9
 v_and_b32 v43, 0xffff0000, v9
 v_cvt_pk_bf16_f32 v9, v44, v45
 v_lshlrev_b32 v44, 16, v9
 v_and_b32 v45, 0xffff0000, v9
 v_cvt_pk_bf16_f32 v9, v46, v47
 v_lshlrev_b32 v46, 16, v9
 v_and_b32 v47, 0xffff0000, v9
 v_pk_mul_f32 v[36:37], v[36:37], v[10:11] op_sel:[0,1] op_sel_hi:[1,1]
 v_pk_mul_f32 v[38:39], v[38:39], v[10:11] op_sel:[0,1] op_sel_hi:[1,1]
 v_pk_mul_f32 v[40:41], v[40:41], v[10:11] op_sel:[0,1] op_sel_hi:[1,1]
 v_pk_mul_f32 v[42:43], v[42:43], v[10:11] op_sel:[0,1] op_sel_hi:[1,1]
 v_pk_mul_f32 v[44:45], v[44:45], v[10:11] op_sel:[0,1] op_sel_hi:[1,1]
 v_pk_mul_f32 v[46:47], v[46:47], v[10:11] op_sel:[0,1] op_sel_hi:[1,1]
 v_cvt_pk_bf16_f32 v48, v36, v37
 v_cvt_pk_bf16_f32 v49, v38, v39
 v_cvt_pk_bf16_f32 v50, v40, v41
 v_cvt_pk_bf16_f32 v51, v42, v43
 v_cvt_pk_bf16_f32 v52, v44, v45
 v_cvt_pk_bf16_f32 v53, v46, v47
 s_add_u32 s3, s60, 229113856
 buffer_store_dwordx2 v[48:49], v4, s[4:7], s3 offen offset:0 sc1
 buffer_store_dwordx2 v[50:51], v4, s[4:7], s3 offen offset:512 sc1
 buffer_store_dwordx2 v[52:53], v8, s[4:7], s3 offen offset:1024 sc1
 s_waitcnt vmcnt(0) lgkmcnt(0)
 s_and_b32 s55, s52, 3
 s_mul_i32 s55, s55, 24576
 s_lshl_b32 s3, s54, 2
 s_add_u32 s3, s3, s55
 s_add_u32 s3, s3, 126976
 v_mov_b32 v3, 1
 s_mov_b64 exec, -1
 buffer_atomic_add v3, v68, s[4:7], s3 offen
 s_mov_b64 exec, -1
 s_add_u32 s3, s3, 16384
 v_mov_b32 v3, 1
 s_mov_b32 exec_hi, 0
 buffer_atomic_add v3, v68, s[4:7], s3 offen
 s_mov_b64 exec, -1
 s_branch L_le_156
L_l1_155:
 buffer_store_dwordx2 v[60:61], v2, s[12:15], s60 offen offset:0 nt
 buffer_store_dwordx2 v[62:63], v2, s[12:15], s60 offen offset:512 nt
 buffer_store_dwordx2 v[64:65], v7, s[12:15], s60 offen offset:1024 nt
 s_waitcnt vmcnt(0)
L_le_156:
 s_add_u32 s54, s54, 2
 s_cmp_lt_u32 s54, 64
 s_cbranch_scc1 L_t4_loop
 s_cmp_lg_u32 s50, 3
 s_cbranch_scc1 L_bail
 s_endpgm
L_bail:
 s_endpgm
L_ch:
 s_mov_b32 s52, s49
 s_lshl_b32 s14, s53, 5
 s_add_u32 s14, s14, s52
 s_mul_i32 s63, s14, 49152
 s_mul_i32 s3, s50, 12288
 s_add_u32 s63, s63, s3
 s_add_u32 s63, s63, 3211264
 s_add_u32 s81, s63, 4096
 s_add_u32 s101, s63, 8192
 s_mul_i32 s60, s14, 10240
 s_lshl_b32 s3, s50, 11
 s_add_u32 s60, s60, s3
 s_add_u32 s60, s60, 225280
 s_lshl_b32 s12, s14, 8
 s_add_u32 s12, s12, 8192
 s_lshl_b32 s13, s14, 7
 s_add_u32 s13, s13, 0
 s_mul_i32 s62, s53, 1048576
 s_lshl_b32 s3, s52, 12
 s_add_u32 s62, s62, s3
 s_add_u32 s62, s62, 1114112
 s_and_b32 s3, s52, 1
 s_lshl_b32 s3, s3, 13
 s_lshl_b32 s61, s52, 14
 s_add_u32 s61, s61, s3
 s_mul_i32 s3, s53, 33554432
 s_add_u32 s61, s61, s3
 s_add_u32 s61, s61, 8388608
 s_mov_b32 s56, 0x3e0293ee
 s_mov_b32 s54, 0
 s_mov_b32 s55, 1
 s_mov_b32 s68, 0x33333333
 s_mov_b32 s69, 0x33333333
 s_mov_b32 s70, 0xcccccccc
 s_mov_b32 s71, 0xcccccccc
 s_mov_b32 s72, 0x11111111
 s_mov_b32 s73, 0x11111111
 s_mov_b32 s74, 0x44444444
 s_mov_b32 s75, 0x44444444
 s_mov_b32 s76, 0x22222222
 s_mov_b32 s77, 0x22222222
 s_mov_b32 s78, 0x88888888
 s_mov_b32 s79, 0x88888888
 s_mov_b32 s82, 0xf0f0f0f0
 s_mov_b32 s83, 0xf0f0f0f0
 s_cmp_eq_u32 s50, 1
 s_cbranch_scc1 L_ch1
 s_cmp_eq_u32 s50, 2
 s_cbranch_scc1 L_ch2
 s_cmp_eq_u32 s50, 3
 s_cbranch_scc1 L_ch3
L_ch0:
 v_lshrrev_b32 v8, 4, v0
 s_mov_b32 s3, 1280
 v_mul_lo_u32 v8, v8, s3
 v_lshrrev_b32 v7, 3, v0
 v_and_b32 v7, 6, v7
 v_xor_b32 v7, v7, v0
 v_and_b32 v7, 15, v7
 v_lshl_add_u32 v8, v7, 4, v8
 v_xor_b32 v9, 128, v8
 v_lshrrev_b32 v10, 4, v0
 s_mov_b32 s3, 8192
 v_mul_lo_u32 v10, v10, s3
 v_lshrrev_b32 v7, 3, v0
 v_and_b32 v7, 6, v7
 v_xor_b32 v7, v7, v0
 v_and_b32 v7, 15, v7
 v_lshl_add_u32 v10, v7, 4, v10
 v_xor_b32 v11, 128, v10
 s_mov_b32 s8, s26
 s_and_b32 s9, s27, 0xffff
 s_mov_b32 s10, 5242880
 s_mul_i32 s14, s52, 163840
 s_add_u32 s14, s14, 0
 s_mov_b32 m0, 0
 s_nop 0
 buffer_load_dwordx4 v8, s[8:11], s14 offen lds
 s_add_u32 s14, s14, 5120
 s_mov_b32 m0, 1024
 s_nop 0
 buffer_load_dwordx4 v8, s[8:11], s14 offen lds
 s_add_u32 s14, s14, 5120
 s_mov_b32 m0, 2048
 s_nop 0
 buffer_load_dwordx4 v8, s[8:11], s14 offen lds
 s_add_u32 s14, s14, 5120
 s_mov_b32 m0, 3072
 s_nop 0
 buffer_load_dwordx4 v8, s[8:11], s14 offen lds
 s_add_u32 s14, s14, 5120
 s_mov_b32 m0, 4096
 s_nop 0
 buffer_load_dwordx4 v9, s[8:11], s14 offen lds
 s_add_u32 s14, s14, 5120
 s_mov_b32 m0, 5120
 s_nop 0
 buffer_load_dwordx4 v9, s[8:11], s14 offen lds
 s_add_u32 s14, s14, 5120
 s_mov_b32 m0, 6144
 s_nop 0
 buffer_load_dwordx4 v9, s[8:11], s14 offen lds
 s_add_u32 s14, s14, 5120
 s_mov_b32 m0, 7168
 s_nop 0
 buffer_load_dwordx4 v9, s[8:11], s14 offen lds
 s_mul_i32 s14, s52, 163840
 s_add_u32 s14, s14, 256
 s_mov_b32 m0, 32768
 s_nop 0
 buffer_load_dwordx4 v8, s[8:11], s14 offen lds
 s_add_u32 s14, s14, 5120
 s_mov_b32 m0, 33792
 s_nop 0
 buffer_load_dwordx4 v8, s[8:11], s14 offen lds
 s_add_u32 s14, s14, 5120
 s_mov_b32 m0, 34816
 s_nop 0
 buffer_load_dwordx4 v8, s[8:11], s14 offen lds
 s_add_u32 s14, s14, 5120
 s_mov_b32 m0, 35840
 s_nop 0
 buffer_load_dwordx4 v8, s[8:11], s14 offen lds
 s_add_u32 s14, s14, 5120
 s_mov_b32 m0, 36864
 s_nop 0
 buffer_load_dwordx4 v9, s[8:11], s14 offen lds
 s_add_u32 s14, s14, 5120
 s_mov_b32 m0, 37888
 s_nop 0
 buffer_load_dwordx4 v9, s[8:11], s14 offen lds
 s_add_u32 s14, s14, 5120
 s_mov_b32 m0, 38912
 s_nop 0
 buffer_load_dwordx4 v9, s[8:11], s14 offen lds
 s_add_u32 s14, s14, 5120
 s_mov_b32 m0, 39936
 s_nop 0
 buffer_load_dwordx4 v9, s[8:11], s14 offen lds
 s_mul_i32 s14, s52, 163840
 s_add_u32 s14, s14, 512
 s_mov_b32 m0, 65536
 s_nop 0
 buffer_load_dwordx4 v8, s[8:11], s14 offen lds
 s_add_u32 s14, s14, 5120
 s_mov_b32 m0, 66560
 s_nop 0
 buffer_load_dwordx4 v8, s[8:11], s14 offen lds
 s_add_u32 s14, s14, 5120
 s_mov_b32 m0, 67584
 s_nop 0
 buffer_load_dwordx4 v8, s[8:11], s14 offen lds
 s_add_u32 s14, s14, 5120
 s_mov_b32 m0, 68608
 s_nop 0
 buffer_load_dwordx4 v8, s[8:11], s14 offen lds
 s_add_u32 s14, s14, 5120
 s_mov_b32 m0, 69632
 s_nop 0
 buffer_load_dwordx4 v9, s[8:11], s14 offen lds
 s_add_u32 s14, s14, 5120
 s_mov_b32 m0, 70656
 s_nop 0
 buffer_load_dwordx4 v9, s[8:11], s14 offen lds
 s_add_u32 s14, s14, 5120
 s_mov_b32 m0, 71680
 s_nop 0
 buffer_load_dwordx4 v9, s[8:11], s14 offen lds
 s_add_u32 s14, s14, 5120
 s_mov_b32 m0, 72704
 s_nop 0
 buffer_load_dwordx4 v9, s[8:11], s14 offen lds
 s_mul_i32 s14, s52, 163840
 s_add_u32 s14, s14, 768
 s_mov_b32 m0, 98304
 s_nop 0
 buffer_load_dwordx4 v8, s[8:11], s14 offen lds
 s_add_u32 s14, s14, 5120
 s_mov_b32 m0, 99328
 s_nop 0
 buffer_load_dwordx4 v8, s[8:11], s14 offen lds
 s_add_u32 s14, s14, 5120
 s_mov_b32 m0, 100352
 s_nop 0
 buffer_load_dwordx4 v8, s[8:11], s14 offen lds
 s_add_u32 s14, s14, 5120
 s_mov_b32 m0, 101376
 s_nop 0
 buffer_load_dwordx4 v8, s[8:11], s14 offen lds
 s_add_u32 s14, s14, 5120
 s_mov_b32 m0, 102400
 s_nop 0
 buffer_load_dwordx4 v9, s[8:11], s14 offen lds
 s_add_u32 s14, s14, 5120
 s_mov_b32 m0, 103424
 s_nop 0
 buffer_load_dwordx4 v9, s[8:11], s14 offen lds
 s_add_u32 s14, s14, 5120
 s_mov_b32 m0, 104448
 s_nop 0
 buffer_load_dwordx4 v9, s[8:11], s14 offen lds
 s_add_u32 s14, s14, 5120
 s_mov_b32 m0, 105472
 s_nop 0
 buffer_load_dwordx4 v9, s[8:11], s14 offen lds
 s_mul_i32 s14, s52, 163840
 s_add_u32 s14, s14, 1024
 s_mov_b32 m0, 131072
 s_nop 0
 buffer_load_dwordx4 v8, s[8:11], s14 offen lds
 s_add_u32 s14, s14, 5120
 s_mov_b32 m0, 132096
 s_nop 0
 buffer_load_dwordx4 v8, s[8:11], s14 offen lds
 s_add_u32 s14, s14, 5120
 s_mov_b32 m0, 133120
 s_nop 0
 buffer_load_dwordx4 v8, s[8:11], s14 offen lds
 s_add_u32 s14, s14, 5120
 s_mov_b32 m0, 134144
 s_nop 0
 buffer_load_dwordx4 v8, s[8:11], s14 offen lds
 s_add_u32 s14, s14, 5120
 s_mov_b32 m0, 135168
 s_nop 0
 buffer_load_dwordx4 v9, s[8:11], s14 offen lds
 s_add_u32 s14, s14, 5120
 s_mov_b32 m0, 136192
 s_nop 0
 buffer_load_dwordx4 v9, s[8:11], s14 offen lds
 s_add_u32 s14, s14, 5120
 s_mov_b32 m0, 137216
 s_nop 0
 buffer_load_dwordx4 v9, s[8:11], s14 offen lds
 s_add_u32 s14, s14, 5120
 s_mov_b32 m0, 138240
 s_nop 0
 buffer_load_dwordx4 v9, s[8:11], s14 offen lds
 v_lshrrev_b32 v20, 4, v0
 v_bfe_u32 v21, v0, 2, 1
 v_bfe_u32 v22, v0, 3, 1
 v_and_b32 v23, 1, v20
 v_lshrrev_b32 v24, 1, v20
 v_and_b32 v25, 3, v0
 v_lshlrev_b32 v25, 3, v25
 v_lshl_add_u32 v26, v22, 1, v23
 v_lshl_add_u32 v27, v21, 2, v26
 v_lshl_add_u32 v26, v24, 2, v26
 v_lshl_add_u32 v26, v21, 4, v26
 v_xor_b32 v27, 0, v27
 v_lshl_add_u32 v27, v27, 5, v25
 v_lshl_add_u32 v12, v26, 8, v27
 v_lshl_add_u32 v26, v24, 2, v21
 v_lshl_add_u32 v26, v23, 4, v26
 v_lshl_add_u32 v27, v23, 2, v21
 v_lshl_add_u32 v27, v22, 1, v27
 v_lshl_add_u32 v27, v27, 5, v25
 v_lshl_add_u32 v14, v26, 8, v27
 v_lshlrev_b32 v1, 4, v0
 v_add_u32 v2, 65536, v1
 v_add_u32 v3, 114688, v1
 s_waitcnt vmcnt(32)
 s_barrier
 v_xor_b32 v16, 0, v14
 v_add_u32 v16, 0, v16
 v_xor_b32 v17, 64, v16
 ds_read_b64_tr_b16 a[0:1], v16 offset:0
 ds_read_b64_tr_b16 a[2:3], v17 offset:512
 ds_read_b64_tr_b16 a[4:5], v16 offset:2048
 ds_read_b64_tr_b16 a[6:7], v17 offset:2560
 v_xor_b32 v16, 0, v14
 v_add_u32 v16, 0, v16
 v_xor_b32 v17, 64, v16
 ds_read_b64_tr_b16 a[8:9], v16 offset:8192
 ds_read_b64_tr_b16 a[10:11], v17 offset:8704
 ds_read_b64_tr_b16 a[12:13], v16 offset:10240
 ds_read_b64_tr_b16 a[14:15], v17 offset:10752
 v_xor_b32 v16, 0, v14
 v_add_u32 v16, 0, v16
 v_xor_b32 v17, 64, v16
 ds_read_b64_tr_b16 a[16:17], v16 offset:16384
 ds_read_b64_tr_b16 a[18:19], v17 offset:16896
 ds_read_b64_tr_b16 a[20:21], v16 offset:18432
 ds_read_b64_tr_b16 a[22:23], v17 offset:18944
 v_xor_b32 v16, 0, v14
 v_add_u32 v16, 0, v16
 v_xor_b32 v17, 64, v16
 ds_read_b64_tr_b16 a[24:25], v16 offset:24576
 ds_read_b64_tr_b16 a[26:27], v17 offset:25088
 ds_read_b64_tr_b16 a[28:29], v16 offset:26624
 ds_read_b64_tr_b16 a[30:31], v17 offset:27136
 v_xor_b32 v16, 32, v14
 v_add_u32 v16, 0, v16
 v_xor_b32 v17, 64, v16
 ds_read_b64_tr_b16 a[32:33], v16 offset:0
 ds_read_b64_tr_b16 a[34:35], v17 offset:512
 ds_read_b64_tr_b16 a[36:37], v16 offset:2048
 ds_read_b64_tr_b16 a[38:39], v17 offset:2560
 v_xor_b32 v16, 32, v14
 v_add_u32 v16, 0, v16
 v_xor_b32 v17, 64, v16
 ds_read_b64_tr_b16 a[40:41], v16 offset:8192
 ds_read_b64_tr_b16 a[42:43], v17 offset:8704
 ds_read_b64_tr_b16 a[44:45], v16 offset:10240
 ds_read_b64_tr_b16 a[46:47], v17 offset:10752
 v_xor_b32 v16, 32, v14
 v_add_u32 v16, 0, v16
 v_xor_b32 v17, 64, v16
 ds_read_b64_tr_b16 a[48:49], v16 offset:16384
 ds_read_b64_tr_b16 a[50:51], v17 offset:16896
 ds_read_b64_tr_b16 a[52:53], v16 offset:18432
 ds_read_b64_tr_b16 a[54:55], v17 offset:18944
 v_xor_b32 v16, 32, v14
 v_add_u32 v16, 0, v16
 v_xor_b32 v17, 64, v16
 ds_read_b64_tr_b16 a[56:57], v16 offset:24576
 ds_read_b64_tr_b16 a[58:59], v17 offset:25088
 ds_read_b64_tr_b16 a[60:61], v16 offset:26624
 ds_read_b64_tr_b16 a[62:63], v17 offset:27136
 v_xor_b32 v16, 128, v14
 v_add_u32 v16, 0, v16
 v_xor_b32 v17, 64, v16
 ds_read_b64_tr_b16 a[64:65], v16 offset:0
 ds_read_b64_tr_b16 a[66:67], v17 offset:512
 ds_read_b64_tr_b16 a[68:69], v16 offset:2048
 ds_read_b64_tr_b16 a[70:71], v17 offset:2560
 v_xor_b32 v16, 128, v14
 v_add_u32 v16, 0, v16
 v_xor_b32 v17, 64, v16
 ds_read_b64_tr_b16 a[72:73], v16 offset:8192
 ds_read_b64_tr_b16 a[74:75], v17 offset:8704
 ds_read_b64_tr_b16 a[76:77], v16 offset:10240
 ds_read_b64_tr_b16 a[78:79], v17 offset:10752
 v_xor_b32 v16, 128, v14
 v_add_u32 v16, 0, v16
 v_xor_b32 v17, 64, v16
 ds_read_b64_tr_b16 a[80:81], v16 offset:16384
 ds_read_b64_tr_b16 a[82:83], v17 offset:16896
 ds_read_b64_tr_b16 a[84:85], v16 offset:18432
 ds_read_b64_tr_b16 a[86:87], v17 offset:18944
 v_xor_b32 v16, 128, v14
 v_add_u32 v16, 0, v16
 v_xor_b32 v17, 64, v16
 ds_read_b64_tr_b16 a[88:89], v16 offset:24576
 ds_read_b64_tr_b16 a[90:91], v17 offset:25088
 ds_read_b64_tr_b16 a[92:93], v16 offset:26624
 ds_read_b64_tr_b16 a[94:95], v17 offset:27136
 v_xor_b32 v16, 160, v14
 v_add_u32 v16, 0, v16
 v_xor_b32 v17, 64, v16
 ds_read_b64_tr_b16 a[96:97], v16 offset:0
 ds_read_b64_tr_b16 a[98:99], v17 offset:512
 ds_read_b64_tr_b16 a[100:101], v16 offset:2048
 ds_read_b64_tr_b16 a[102:103], v17 offset:2560
 v_xor_b32 v16, 160, v14
 v_add_u32 v16, 0, v16
 v_xor_b32 v17, 64, v16
 ds_read_b64_tr_b16 a[104:105], v16 offset:8192
 ds_read_b64_tr_b16 a[106:107], v17 offset:8704
 ds_read_b64_tr_b16 a[108:109], v16 offset:10240
 ds_read_b64_tr_b16 a[110:111], v17 offset:10752
 v_xor_b32 v16, 160, v14
 v_add_u32 v16, 0, v16
 v_xor_b32 v17, 64, v16
 ds_read_b64_tr_b16 a[112:113], v16 offset:16384
 ds_read_b64_tr_b16 a[114:115], v17 offset:16896
 ds_read_b64_tr_b16 a[116:117], v16 offset:18432
 ds_read_b64_tr_b16 a[118:119], v17 offset:18944
 v_xor_b32 v16, 160, v14
 v_add_u32 v16, 0, v16
 v_xor_b32 v17, 64, v16
 ds_read_b64_tr_b16 a[120:121], v16 offset:24576
 ds_read_b64_tr_b16 a[122:123], v17 offset:25088
 ds_read_b64_tr_b16 a[124:125], v16 offset:26624
 ds_read_b64_tr_b16 a[126:127], v17 offset:27136
 s_waitcnt lgkmcnt(0)
 s_barrier
 s_mov_b32 s8, s24
 s_and_b32 s9, s25, 0xffff
 s_mov_b32 s10, 5242880
 s_lshl_b32 s14, s52, 8
 s_add_u32 s14, s14, 0
 s_mov_b32 m0, 0
 s_nop 0
 buffer_load_dwordx4 v10, s[8:11], s14 offen lds
 s_add_u32 s14, s14, 32768
 s_mov_b32 m0, 1024
 s_nop 0
 buffer_load_dwordx4 v10, s[8:11], s14 offen lds
 s_add_u32 s14, s14, 32768
 s_mov_b32 m0, 2048
 s_nop 0
 buffer_load_dwordx4 v10, s[8:11], s14 offen lds
 s_add_u32 s14, s14, 32768
 s_mov_b32 m0, 3072
 s_nop 0
 buffer_load_dwordx4 v10, s[8:11], s14 offen lds
 s_add_u32 s14, s14, 32768
 s_mov_b32 m0, 4096
 s_nop 0
 buffer_load_dwordx4 v11, s[8:11], s14 offen lds
 s_add_u32 s14, s14, 32768
 s_mov_b32 m0, 5120
 s_nop 0
 buffer_load_dwordx4 v11, s[8:11], s14 offen lds
 s_add_u32 s14, s14, 32768
 s_mov_b32 m0, 6144
 s_nop 0
 buffer_load_dwordx4 v11, s[8:11], s14 offen lds
 s_add_u32 s14, s14, 32768
 s_mov_b32 m0, 7168
 s_nop 0
 buffer_load_dwordx4 v11, s[8:11], s14 offen lds
 s_waitcnt vmcnt(32)
 s_barrier
 s_waitcnt lgkmcnt(0)
 s_barrier
 s_lshl_b32 s14, s52, 8
 s_add_u32 s14, s14, 1048576
 s_mov_b32 m0, 32768
 s_nop 0
 buffer_load_dwordx4 v10, s[8:11], s14 offen lds
 s_add_u32 s14, s14, 32768
 s_mov_b32 m0, 33792
 s_nop 0
 buffer_load_dwordx4 v10, s[8:11], s14 offen lds
 s_add_u32 s14, s14, 32768
 s_mov_b32 m0, 34816
 s_nop 0
 buffer_load_dwordx4 v10, s[8:11], s14 offen lds
 s_add_u32 s14, s14, 32768
 s_mov_b32 m0, 35840
 s_nop 0
 buffer_load_dwordx4 v10, s[8:11], s14 offen lds
 s_add_u32 s14, s14, 32768
 s_mov_b32 m0, 36864
 s_nop 0
 buffer_load_dwordx4 v11, s[8:11], s14 offen lds
 s_add_u32 s14, s14, 32768
 s_mov_b32 m0, 37888
 s_nop 0
 buffer_load_dwordx4 v11, s[8:11], s14 offen lds
 s_add_u32 s14, s14, 32768
 s_mov_b32 m0, 38912
 s_nop 0
 buffer_load_dwordx4 v11, s[8:11], s14 offen lds
 s_add_u32 s14, s14, 32768
 s_mov_b32 m0, 39936
 s_nop 0
 buffer_load_dwordx4 v11, s[8:11], s14 offen lds
 s_waitcnt vmcnt(32)
 s_barrier
 s_waitcnt lgkmcnt(0)
 s_barrier
 s_lshl_b32 s14, s52, 8
 s_add_u32 s14, s14, 2097152
 s_mov_b32 m0, 65536
 s_nop 0
 buffer_load_dwordx4 v10, s[8:11], s14 offen lds
 s_add_u32 s14, s14, 32768
 s_mov_b32 m0, 66560
 s_nop 0
 buffer_load_dwordx4 v10, s[8:11], s14 offen lds
 s_add_u32 s14, s14, 32768
 s_mov_b32 m0, 67584
 s_nop 0
 buffer_load_dwordx4 v10, s[8:11], s14 offen lds
 s_add_u32 s14, s14, 32768
 s_mov_b32 m0, 68608
 s_nop 0
 buffer_load_dwordx4 v10, s[8:11], s14 offen lds
 s_add_u32 s14, s14, 32768
 s_mov_b32 m0, 69632
 s_nop 0
 buffer_load_dwordx4 v11, s[8:11], s14 offen lds
 s_add_u32 s14, s14, 32768
 s_mov_b32 m0, 70656
 s_nop 0
 buffer_load_dwordx4 v11, s[8:11], s14 offen lds
 s_add_u32 s14, s14, 32768
 s_mov_b32 m0, 71680
 s_nop 0
 buffer_load_dwordx4 v11, s[8:11], s14 offen lds
 s_add_u32 s14, s14, 32768
 s_mov_b32 m0, 72704
 s_nop 0
 buffer_load_dwordx4 v11, s[8:11], s14 offen lds
 s_waitcnt vmcnt(32)
 s_barrier
 s_waitcnt lgkmcnt(0)
 s_barrier
 s_lshl_b32 s14, s52, 8
 s_add_u32 s14, s14, 3145728
 s_mov_b32 m0, 98304
 s_nop 0
 buffer_load_dwordx4 v10, s[8:11], s14 offen lds
 s_add_u32 s14, s14, 32768
 s_mov_b32 m0, 99328
 s_nop 0
 buffer_load_dwordx4 v10, s[8:11], s14 offen lds
 s_add_u32 s14, s14, 32768
 s_mov_b32 m0, 100352
 s_nop 0
 buffer_load_dwordx4 v10, s[8:11], s14 offen lds
 s_add_u32 s14, s14, 32768
 s_mov_b32 m0, 101376
 s_nop 0
 buffer_load_dwordx4 v10, s[8:11], s14 offen lds
 s_add_u32 s14, s14, 32768
 s_mov_b32 m0, 102400
 s_nop 0
 buffer_load_dwordx4 v11, s[8:11], s14 offen lds
 s_add_u32 s14, s14, 32768
 s_mov_b32 m0, 103424
 s_nop 0
 buffer_load_dwordx4 v11, s[8:11], s14 offen lds
 s_add_u32 s14, s14, 32768
 s_mov_b32 m0, 104448
 s_nop 0
 buffer_load_dwordx4 v11, s[8:11], s14 offen lds
 s_add_u32 s14, s14, 32768
 s_mov_b32 m0, 105472
 s_nop 0
 buffer_load_dwordx4 v11, s[8:11], s14 offen lds
 s_waitcnt vmcnt(32)
 s_barrier
 v_xor_b32 v16, 0, v14
 v_add_u32 v16, 131072, v16
 v_xor_b32 v17, 64, v16
 ds_read_b64_tr_b16 a[128:129], v16 offset:0
 ds_read_b64_tr_b16 a[130:131], v17 offset:512
 ds_read_b64_tr_b16 a[132:133], v16 offset:2048
 ds_read_b64_tr_b16 a[134:135], v17 offset:2560
 v_xor_b32 v16, 0, v14
 v_add_u32 v16, 131072, v16
 v_xor_b32 v17, 64, v16
 ds_read_b64_tr_b16 a[136:137], v16 offset:8192
 ds_read_b64_tr_b16 a[138:139], v17 offset:8704
 ds_read_b64_tr_b16 a[140:141], v16 offset:10240
 ds_read_b64_tr_b16 a[142:143], v17 offset:10752
 v_xor_b32 v16, 0, v14
 v_add_u32 v16, 131072, v16
 v_xor_b32 v17, 64, v16
 ds_read_b64_tr_b16 a[144:145], v16 offset:16384
 ds_read_b64_tr_b16 a[146:147], v17 offset:16896
 ds_read_b64_tr_b16 a[148:149], v16 offset:18432
 ds_read_b64_tr_b16 a[150:151], v17 offset:18944
 v_xor_b32 v16, 0, v14
 v_add_u32 v16, 131072, v16
 v_xor_b32 v17, 64, v16
 ds_read_b64_tr_b16 a[152:153], v16 offset:24576
 ds_read_b64_tr_b16 a[154:155], v17 offset:25088
 ds_read_b64_tr_b16 a[156:157], v16 offset:26624
 ds_read_b64_tr_b16 a[158:159], v17 offset:27136
 s_waitcnt lgkmcnt(0)
 s_barrier
 s_lshl_b32 s14, s52, 8
 s_add_u32 s14, s14, 4194304
 s_mov_b32 m0, 131072
 s_nop 0
 buffer_load_dwordx4 v10, s[8:11], s14 offen lds
 s_add_u32 s14, s14, 32768
 s_mov_b32 m0, 132096
 s_nop 0
 buffer_load_dwordx4 v10, s[8:11], s14 offen lds
 s_add_u32 s14, s14, 32768
 s_mov_b32 m0, 133120
 s_nop 0
 buffer_load_dwordx4 v10, s[8:11], s14 offen lds
 s_add_u32 s14, s14, 32768
 s_mov_b32 m0, 134144
 s_nop 0
 buffer_load_dwordx4 v10, s[8:11], s14 offen lds
 s_add_u32 s14, s14, 32768
 s_mov_b32 m0, 135168
 s_nop 0
 buffer_load_dwordx4 v11, s[8:11], s14 offen lds
 s_add_u32 s14, s14, 32768
 s_mov_b32 m0, 136192
 s_nop 0
 buffer_load_dwordx4 v11, s[8:11], s14 offen lds
 s_add_u32 s14, s14, 32768
 s_mov_b32 m0, 137216
 s_nop 0
 buffer_load_dwordx4 v11, s[8:11], s14 offen lds
 s_add_u32 s14, s14, 32768
 s_mov_b32 m0, 138240
 s_nop 0
 buffer_load_dwordx4 v11, s[8:11], s14 offen lds
 s_waitcnt vmcnt(32)
 s_barrier
 v_xor_b32 v16, 0, v12
 v_add_u32 v16, 0, v16
 ds_read_b64_tr_b16 a[160:161], v16 offset:0
 ds_read_b64_tr_b16 a[162:163], v16 offset:8192
 ds_read_b64_tr_b16 a[164:165], v16 offset:2048
 ds_read_b64_tr_b16 a[166:167], v16 offset:10240
 v_xor_b32 v16, 32, v12
 v_add_u32 v16, 0, v16
 ds_read_b64_tr_b16 a[168:169], v16 offset:0
 ds_read_b64_tr_b16 a[170:171], v16 offset:8192
 ds_read_b64_tr_b16 a[172:173], v16 offset:2048
 ds_read_b64_tr_b16 a[174:175], v16 offset:10240
 v_xor_b32 v16, 0, v12
 v_add_u32 v16, 0, v16
 ds_read_b64_tr_b16 a[176:177], v16 offset:16384
 ds_read_b64_tr_b16 a[178:179], v16 offset:24576
 ds_read_b64_tr_b16 a[180:181], v16 offset:18432
 ds_read_b64_tr_b16 a[182:183], v16 offset:26624
 v_xor_b32 v16, 32, v12
 v_add_u32 v16, 0, v16
 ds_read_b64_tr_b16 a[184:185], v16 offset:16384
 ds_read_b64_tr_b16 a[186:187], v16 offset:24576
 ds_read_b64_tr_b16 a[188:189], v16 offset:18432
 ds_read_b64_tr_b16 a[190:191], v16 offset:26624
 s_waitcnt lgkmcnt(0)
 s_barrier
 s_mov_b32 s8, s22
 s_and_b32 s9, s23, 0xffff
 s_mov_b32 s10, 5242880
 s_lshl_b32 s14, s52, 8
 s_add_u32 s14, s14, 0
 s_mov_b32 m0, 0
 s_nop 0
 buffer_load_dwordx4 v10, s[8:11], s14 offen lds
 s_add_u32 s14, s14, 32768
 s_mov_b32 m0, 1024
 s_nop 0
 buffer_load_dwordx4 v10, s[8:11], s14 offen lds
 s_add_u32 s14, s14, 32768
 s_mov_b32 m0, 2048
 s_nop 0
 buffer_load_dwordx4 v10, s[8:11], s14 offen lds
 s_add_u32 s14, s14, 32768
 s_mov_b32 m0, 3072
 s_nop 0
 buffer_load_dwordx4 v10, s[8:11], s14 offen lds
 s_add_u32 s14, s14, 32768
 s_mov_b32 m0, 4096
 s_nop 0
 buffer_load_dwordx4 v11, s[8:11], s14 offen lds
 s_add_u32 s14, s14, 32768
 s_mov_b32 m0, 5120
 s_nop 0
 buffer_load_dwordx4 v11, s[8:11], s14 offen lds
 s_add_u32 s14, s14, 32768
 s_mov_b32 m0, 6144
 s_nop 0
 buffer_load_dwordx4 v11, s[8:11], s14 offen lds
 s_add_u32 s14, s14, 32768
 s_mov_b32 m0, 7168
 s_nop 0
 buffer_load_dwordx4 v11, s[8:11], s14 offen lds
 s_waitcnt vmcnt(32)
 s_barrier
 v_xor_b32 v16, 0, v12
 v_add_u32 v16, 32768, v16
 ds_read_b64_tr_b16 a[192:193], v16 offset:0
 ds_read_b64_tr_b16 a[194:195], v16 offset:8192
 ds_read_b64_tr_b16 a[196:197], v16 offset:2048
 ds_read_b64_tr_b16 a[198:199], v16 offset:10240
 v_xor_b32 v16, 32, v12
 v_add_u32 v16, 32768, v16
 ds_read_b64_tr_b16 a[200:201], v16 offset:0
 ds_read_b64_tr_b16 a[202:203], v16 offset:8192
 ds_read_b64_tr_b16 a[204:205], v16 offset:2048
 ds_read_b64_tr_b16 a[206:207], v16 offset:10240
 v_xor_b32 v16, 0, v12
 v_add_u32 v16, 32768, v16
 ds_read_b64_tr_b16 a[208:209], v16 offset:16384
 ds_read_b64_tr_b16 a[210:211], v16 offset:24576
 ds_read_b64_tr_b16 a[212:213], v16 offset:18432
 ds_read_b64_tr_b16 a[214:215], v16 offset:26624
 v_xor_b32 v16, 32, v12
 v_add_u32 v16, 32768, v16
 ds_read_b64_tr_b16 a[216:217], v16 offset:16384
 ds_read_b64_tr_b16 a[218:219], v16 offset:24576
 ds_read_b64_tr_b16 a[220:221], v16 offset:18432
 ds_read_b64_tr_b16 a[222:223], v16 offset:26624
 s_waitcnt lgkmcnt(0)
 s_barrier
 s_lshl_b32 s14, s52, 8
 s_add_u32 s14, s14, 1048576
 s_mov_b32 m0, 32768
 s_nop 0
 buffer_load_dwordx4 v10, s[8:11], s14 offen lds
 s_add_u32 s14, s14, 32768
 s_mov_b32 m0, 33792
 s_nop 0
 buffer_load_dwordx4 v10, s[8:11], s14 offen lds
 s_add_u32 s14, s14, 32768
 s_mov_b32 m0, 34816
 s_nop 0
 buffer_load_dwordx4 v10, s[8:11], s14 offen lds
 s_add_u32 s14, s14, 32768
 s_mov_b32 m0, 35840
 s_nop 0
 buffer_load_dwordx4 v10, s[8:11], s14 offen lds
 s_add_u32 s14, s14, 32768
 s_mov_b32 m0, 36864
 s_nop 0
 buffer_load_dwordx4 v11, s[8:11], s14 offen lds
 s_add_u32 s14, s14, 32768
 s_mov_b32 m0, 37888
 s_nop 0
 buffer_load_dwordx4 v11, s[8:11], s14 offen lds
 s_add_u32 s14, s14, 32768
 s_mov_b32 m0, 38912
 s_nop 0
 buffer_load_dwordx4 v11, s[8:11], s14 offen lds
 s_add_u32 s14, s14, 32768
 s_mov_b32 m0, 39936
 s_nop 0
 buffer_load_dwordx4 v11, s[8:11], s14 offen lds
 s_waitcnt vmcnt(32)
 s_barrier
 v_xor_b32 v16, 0, v12
 v_add_u32 v16, 65536, v16
 ds_read_b64_tr_b16 a[224:225], v16 offset:0
 ds_read_b64_tr_b16 a[226:227], v16 offset:8192
 ds_read_b64_tr_b16 a[228:229], v16 offset:2048
 ds_read_b64_tr_b16 a[230:231], v16 offset:10240
 v_xor_b32 v16, 32, v12
 v_add_u32 v16, 65536, v16
 ds_read_b64_tr_b16 a[232:233], v16 offset:0
 ds_read_b64_tr_b16 a[234:235], v16 offset:8192
 ds_read_b64_tr_b16 a[236:237], v16 offset:2048
 ds_read_b64_tr_b16 a[238:239], v16 offset:10240
 v_xor_b32 v16, 0, v12
 v_add_u32 v16, 65536, v16
 ds_read_b64_tr_b16 a[240:241], v16 offset:16384
 ds_read_b64_tr_b16 a[242:243], v16 offset:24576
 ds_read_b64_tr_b16 a[244:245], v16 offset:18432
 ds_read_b64_tr_b16 a[246:247], v16 offset:26624
 v_xor_b32 v16, 32, v12
 v_add_u32 v16, 65536, v16
 ds_read_b64_tr_b16 a[248:249], v16 offset:16384
 ds_read_b64_tr_b16 a[250:251], v16 offset:24576
 ds_read_b64_tr_b16 a[252:253], v16 offset:18432
 ds_read_b64_tr_b16 a[254:255], v16 offset:26624
 s_waitcnt lgkmcnt(0)
 s_barrier
 s_lshl_b32 s14, s52, 8
 s_add_u32 s14, s14, 2097152
 s_mov_b32 m0, 65536
 s_nop 0
 buffer_load_dwordx4 v10, s[8:11], s14 offen lds
 s_add_u32 s14, s14, 32768
 s_mov_b32 m0, 66560
 s_nop 0
 buffer_load_dwordx4 v10, s[8:11], s14 offen lds
 s_add_u32 s14, s14, 32768
 s_mov_b32 m0, 67584
 s_nop 0
 buffer_load_dwordx4 v10, s[8:11], s14 offen lds
 s_add_u32 s14, s14, 32768
 s_mov_b32 m0, 68608
 s_nop 0
 buffer_load_dwordx4 v10, s[8:11], s14 offen lds
 s_add_u32 s14, s14, 32768
 s_mov_b32 m0, 69632
 s_nop 0
 buffer_load_dwordx4 v11, s[8:11], s14 offen lds
 s_add_u32 s14, s14, 32768
 s_mov_b32 m0, 70656
 s_nop 0
 buffer_load_dwordx4 v11, s[8:11], s14 offen lds
 s_add_u32 s14, s14, 32768
 s_mov_b32 m0, 71680
 s_nop 0
 buffer_load_dwordx4 v11, s[8:11], s14 offen lds
 s_add_u32 s14, s14, 32768
 s_mov_b32 m0, 72704
 s_nop 0
 buffer_load_dwordx4 v11, s[8:11], s14 offen lds
 s_waitcnt vmcnt(32)
 s_barrier
 v_xor_b32 v16, 0, v12
 v_add_u32 v16, 98304, v16
 ds_read_b64_tr_b16 v[64:65], v16 offset:0
 ds_read_b64_tr_b16 v[66:67], v16 offset:8192
 ds_read_b64_tr_b16 v[68:69], v16 offset:2048
 ds_read_b64_tr_b16 v[70:71], v16 offset:10240
 v_xor_b32 v16, 32, v12
 v_add_u32 v16, 98304, v16
 ds_read_b64_tr_b16 v[72:73], v16 offset:0
 ds_read_b64_tr_b16 v[74:75], v16 offset:8192
 ds_read_b64_tr_b16 v[76:77], v16 offset:2048
 ds_read_b64_tr_b16 v[78:79], v16 offset:10240
 v_xor_b32 v16, 0, v12
 v_add_u32 v16, 98304, v16
 ds_read_b64_tr_b16 v[80:81], v16 offset:16384
 ds_read_b64_tr_b16 v[82:83], v16 offset:24576
 ds_read_b64_tr_b16 v[84:85], v16 offset:18432
 ds_read_b64_tr_b16 v[86:87], v16 offset:26624
 v_xor_b32 v16, 32, v12
 v_add_u32 v16, 98304, v16
 ds_read_b64_tr_b16 v[88:89], v16 offset:16384
 ds_read_b64_tr_b16 v[90:91], v16 offset:24576
 ds_read_b64_tr_b16 v[92:93], v16 offset:18432
 ds_read_b64_tr_b16 v[94:95], v16 offset:26624
 s_waitcnt lgkmcnt(0)
 s_barrier
 s_lshl_b32 s14, s52, 8
 s_add_u32 s14, s14, 3145728
 s_mov_b32 m0, 98304
 s_nop 0
 buffer_load_dwordx4 v10, s[8:11], s14 offen lds
 s_add_u32 s14, s14, 32768
 s_mov_b32 m0, 99328
 s_nop 0
 buffer_load_dwordx4 v10, s[8:11], s14 offen lds
 s_add_u32 s14, s14, 32768
 s_mov_b32 m0, 100352
 s_nop 0
 buffer_load_dwordx4 v10, s[8:11], s14 offen lds
 s_add_u32 s14, s14, 32768
 s_mov_b32 m0, 101376
 s_nop 0
 buffer_load_dwordx4 v10, s[8:11], s14 offen lds
 s_add_u32 s14, s14, 32768
 s_mov_b32 m0, 102400
 s_nop 0
 buffer_load_dwordx4 v11, s[8:11], s14 offen lds
 s_add_u32 s14, s14, 32768
 s_mov_b32 m0, 103424
 s_nop 0
 buffer_load_dwordx4 v11, s[8:11], s14 offen lds
 s_add_u32 s14, s14, 32768
 s_mov_b32 m0, 104448
 s_nop 0
 buffer_load_dwordx4 v11, s[8:11], s14 offen lds
 s_add_u32 s14, s14, 32768
 s_mov_b32 m0, 105472
 s_nop 0
 buffer_load_dwordx4 v11, s[8:11], s14 offen lds
 s_waitcnt vmcnt(32)
 s_barrier
 v_xor_b32 v16, 0, v12
 v_add_u32 v16, 131072, v16
 ds_read_b64_tr_b16 v[96:97], v16 offset:0
 ds_read_b64_tr_b16 v[98:99], v16 offset:8192
 ds_read_b64_tr_b16 v[100:101], v16 offset:2048
 ds_read_b64_tr_b16 v[102:103], v16 offset:10240
 v_xor_b32 v16, 32, v12
 v_add_u32 v16, 131072, v16
 ds_read_b64_tr_b16 v[104:105], v16 offset:0
 ds_read_b64_tr_b16 v[106:107], v16 offset:8192
 ds_read_b64_tr_b16 v[108:109], v16 offset:2048
 ds_read_b64_tr_b16 v[110:111], v16 offset:10240
 v_xor_b32 v16, 0, v12
 v_add_u32 v16, 131072, v16
 ds_read_b64_tr_b16 v[112:113], v16 offset:16384
 ds_read_b64_tr_b16 v[114:115], v16 offset:24576
 ds_read_b64_tr_b16 v[116:117], v16 offset:18432
 ds_read_b64_tr_b16 v[118:119], v16 offset:26624
 v_xor_b32 v16, 32, v12
 v_add_u32 v16, 131072, v16
 ds_read_b64_tr_b16 v[120:121], v16 offset:16384
 ds_read_b64_tr_b16 v[122:123], v16 offset:24576
 ds_read_b64_tr_b16 v[124:125], v16 offset:18432
 ds_read_b64_tr_b16 v[126:127], v16 offset:26624
 s_waitcnt lgkmcnt(0)
 s_barrier
 s_lshl_b32 s14, s52, 8
 s_add_u32 s14, s14, 4194304
 s_mov_b32 m0, 131072
 s_nop 0
 buffer_load_dwordx4 v10, s[8:11], s14 offen lds
 s_add_u32 s14, s14, 32768
 s_mov_b32 m0, 132096
 s_nop 0
 buffer_load_dwordx4 v10, s[8:11], s14 offen lds
 s_add_u32 s14, s14, 32768
 s_mov_b32 m0, 133120
 s_nop 0
 buffer_load_dwordx4 v10, s[8:11], s14 offen lds
 s_add_u32 s14, s14, 32768
 s_mov_b32 m0, 134144
 s_nop 0
 buffer_load_dwordx4 v10, s[8:11], s14 offen lds
 s_add_u32 s14, s14, 32768
 s_mov_b32 m0, 135168
 s_nop 0
 buffer_load_dwordx4 v11, s[8:11], s14 offen lds
 s_add_u32 s14, s14, 32768
 s_mov_b32 m0, 136192
 s_nop 0
 buffer_load_dwordx4 v11, s[8:11], s14 offen lds
 s_add_u32 s14, s14, 32768
 s_mov_b32 m0, 137216
 s_nop 0
 buffer_load_dwordx4 v11, s[8:11], s14 offen lds
 s_add_u32 s14, s14, 32768
 s_mov_b32 m0, 138240
 s_nop 0
 buffer_load_dwordx4 v11, s[8:11], s14 offen lds
 s_waitcnt vmcnt(32)
 s_barrier
 v_xor_b32 v16, 0, v12
 v_add_u32 v16, 0, v16
 ds_read_b64_tr_b16 v[32:33], v16 offset:0
 ds_read_b64_tr_b16 v[34:35], v16 offset:8192
 ds_read_b64_tr_b16 v[36:37], v16 offset:2048
 ds_read_b64_tr_b16 v[38:39], v16 offset:10240
 s_add_u32 s3, s63, 0
 s_waitcnt lgkmcnt(2)
 buffer_store_dwordx4 v[32:35], v1, s[4:7], s3 offen offset:0
 s_waitcnt lgkmcnt(0)
 buffer_store_dwordx4 v[36:39], v1, s[4:7], s3 offen offset:1024
 v_xor_b32 v16, 32, v12
 v_add_u32 v16, 0, v16
 ds_read_b64_tr_b16 v[40:41], v16 offset:0
 ds_read_b64_tr_b16 v[42:43], v16 offset:8192
 ds_read_b64_tr_b16 v[44:45], v16 offset:2048
 ds_read_b64_tr_b16 v[46:47], v16 offset:10240
 s_add_u32 s3, s63, 2048
 s_waitcnt lgkmcnt(2)
 buffer_store_dwordx4 v[40:43], v1, s[4:7], s3 offen offset:0
 s_waitcnt lgkmcnt(0)
 buffer_store_dwordx4 v[44:47], v1, s[4:7], s3 offen offset:1024
 v_xor_b32 v16, 0, v12
 v_add_u32 v16, 0, v16
 ds_read_b64_tr_b16 v[48:49], v16 offset:16384
 ds_read_b64_tr_b16 v[50:51], v16 offset:24576
 ds_read_b64_tr_b16 v[52:53], v16 offset:18432
 ds_read_b64_tr_b16 v[54:55], v16 offset:26624
 s_add_u32 s3, s63, 4096
 s_waitcnt lgkmcnt(2)
 buffer_store_dwordx4 v[48:51], v1, s[4:7], s3 offen offset:0
 s_waitcnt lgkmcnt(0)
 buffer_store_dwordx4 v[52:55], v1, s[4:7], s3 offen offset:1024
 v_xor_b32 v16, 32, v12
 v_add_u32 v16, 0, v16
 ds_read_b64_tr_b16 v[56:57], v16 offset:16384
 ds_read_b64_tr_b16 v[58:59], v16 offset:24576
 ds_read_b64_tr_b16 v[60:61], v16 offset:18432
 ds_read_b64_tr_b16 v[62:63], v16 offset:26624
 s_add_u32 s3, s63, 6144
 s_waitcnt lgkmcnt(2)
 buffer_store_dwordx4 v[56:59], v1, s[4:7], s3 offen offset:0
 s_waitcnt lgkmcnt(0)
 buffer_store_dwordx4 v[60:63], v1, s[4:7], s3 offen offset:1024
 s_waitcnt lgkmcnt(0)
 s_barrier
 s_mov_b32 s8, s20
 s_and_b32 s9, s21, 0xffff
 s_mov_b32 s10, 5242880
 s_lshl_b32 s14, s52, 8
 s_add_u32 s14, s14, 0
 s_mov_b32 m0, 0
 s_nop 0
 buffer_load_dwordx4 v10, s[8:11], s14 offen lds
 s_add_u32 s14, s14, 32768
 s_mov_b32 m0, 1024
 s_nop 0
 buffer_load_dwordx4 v10, s[8:11], s14 offen lds
 s_add_u32 s14, s14, 32768
 s_mov_b32 m0, 2048
 s_nop 0
 buffer_load_dwordx4 v10, s[8:11], s14 offen lds
 s_add_u32 s14, s14, 32768
 s_mov_b32 m0, 3072
 s_nop 0
 buffer_load_dwordx4 v10, s[8:11], s14 offen lds
 s_add_u32 s14, s14, 32768
 s_mov_b32 m0, 4096
 s_nop 0
 buffer_load_dwordx4 v11, s[8:11], s14 offen lds
 s_add_u32 s14, s14, 32768
 s_mov_b32 m0, 5120
 s_nop 0
 buffer_load_dwordx4 v11, s[8:11], s14 offen lds
 s_add_u32 s14, s14, 32768
 s_mov_b32 m0, 6144
 s_nop 0
 buffer_load_dwordx4 v11, s[8:11], s14 offen lds
 s_add_u32 s14, s14, 32768
 s_mov_b32 m0, 7168
 s_nop 0
 buffer_load_dwordx4 v11, s[8:11], s14 offen lds
 s_waitcnt vmcnt(40)
 s_barrier
 v_xor_b32 v16, 0, v12
 v_add_u32 v16, 32768, v16
 ds_read_b64_tr_b16 v[128:129], v16 offset:0
 ds_read_b64_tr_b16 v[130:131], v16 offset:8192
 ds_read_b64_tr_b16 v[132:133], v16 offset:2048
 ds_read_b64_tr_b16 v[134:135], v16 offset:10240
 v_xor_b32 v16, 32, v12
 v_add_u32 v16, 32768, v16
 ds_read_b64_tr_b16 v[136:137], v16 offset:0
 ds_read_b64_tr_b16 v[138:139], v16 offset:8192
 ds_read_b64_tr_b16 v[140:141], v16 offset:2048
 ds_read_b64_tr_b16 v[142:143], v16 offset:10240
 v_xor_b32 v16, 0, v12
 v_add_u32 v16, 32768, v16
 ds_read_b64_tr_b16 v[144:145], v16 offset:16384
 ds_read_b64_tr_b16 v[146:147], v16 offset:24576
 ds_read_b64_tr_b16 v[148:149], v16 offset:18432
 ds_read_b64_tr_b16 v[150:151], v16 offset:26624
 v_xor_b32 v16, 32, v12
 v_add_u32 v16, 32768, v16
 ds_read_b64_tr_b16 v[152:153], v16 offset:16384
 ds_read_b64_tr_b16 v[154:155], v16 offset:24576
 ds_read_b64_tr_b16 v[156:157], v16 offset:18432
 ds_read_b64_tr_b16 v[158:159], v16 offset:26624
 s_waitcnt lgkmcnt(0)
 s_barrier
 s_lshl_b32 s14, s52, 8
 s_add_u32 s14, s14, 1048576
 s_mov_b32 m0, 32768
 s_nop 0
 buffer_load_dwordx4 v10, s[8:11], s14 offen lds
 s_add_u32 s14, s14, 32768
 s_mov_b32 m0, 33792
 s_nop 0
 buffer_load_dwordx4 v10, s[8:11], s14 offen lds
 s_add_u32 s14, s14, 32768
 s_mov_b32 m0, 34816
 s_nop 0
 buffer_load_dwordx4 v10, s[8:11], s14 offen lds
 s_add_u32 s14, s14, 32768
 s_mov_b32 m0, 35840
 s_nop 0
 buffer_load_dwordx4 v10, s[8:11], s14 offen lds
 s_add_u32 s14, s14, 32768
 s_mov_b32 m0, 36864
 s_nop 0
 buffer_load_dwordx4 v11, s[8:11], s14 offen lds
 s_add_u32 s14, s14, 32768
 s_mov_b32 m0, 37888
 s_nop 0
 buffer_load_dwordx4 v11, s[8:11], s14 offen lds
 s_add_u32 s14, s14, 32768
 s_mov_b32 m0, 38912
 s_nop 0
 buffer_load_dwordx4 v11, s[8:11], s14 offen lds
 s_add_u32 s14, s14, 32768
 s_mov_b32 m0, 39936
 s_nop 0
 buffer_load_dwordx4 v11, s[8:11], s14 offen lds
 s_waitcnt vmcnt(40)
 s_barrier
 v_xor_b32 v16, 0, v12
 v_add_u32 v16, 65536, v16
 ds_read_b64_tr_b16 v[160:161], v16 offset:0
 ds_read_b64_tr_b16 v[162:163], v16 offset:8192
 ds_read_b64_tr_b16 v[164:165], v16 offset:2048
 ds_read_b64_tr_b16 v[166:167], v16 offset:10240
 v_xor_b32 v16, 32, v12
 v_add_u32 v16, 65536, v16
 ds_read_b64_tr_b16 v[168:169], v16 offset:0
 ds_read_b64_tr_b16 v[170:171], v16 offset:8192
 ds_read_b64_tr_b16 v[172:173], v16 offset:2048
 ds_read_b64_tr_b16 v[174:175], v16 offset:10240
 v_xor_b32 v16, 0, v12
 v_add_u32 v16, 65536, v16
 ds_read_b64_tr_b16 v[176:177], v16 offset:16384
 ds_read_b64_tr_b16 v[178:179], v16 offset:24576
 ds_read_b64_tr_b16 v[180:181], v16 offset:18432
 ds_read_b64_tr_b16 v[182:183], v16 offset:26624
 v_xor_b32 v16, 32, v12
 v_add_u32 v16, 65536, v16
 ds_read_b64_tr_b16 v[184:185], v16 offset:16384
 ds_read_b64_tr_b16 v[186:187], v16 offset:24576
 ds_read_b64_tr_b16 v[188:189], v16 offset:18432
 ds_read_b64_tr_b16 v[190:191], v16 offset:26624
 s_waitcnt lgkmcnt(0)
 s_barrier
 s_lshl_b32 s14, s52, 8
 s_add_u32 s14, s14, 2097152
 s_mov_b32 m0, 65536
 s_nop 0
 buffer_load_dwordx4 v10, s[8:11], s14 offen lds
 s_add_u32 s14, s14, 32768
 s_mov_b32 m0, 66560
 s_nop 0
 buffer_load_dwordx4 v10, s[8:11], s14 offen lds
 s_add_u32 s14, s14, 32768
 s_mov_b32 m0, 67584
 s_nop 0
 buffer_load_dwordx4 v10, s[8:11], s14 offen lds
 s_add_u32 s14, s14, 32768
 s_mov_b32 m0, 68608
 s_nop 0
 buffer_load_dwordx4 v10, s[8:11], s14 offen lds
 s_add_u32 s14, s14, 32768
 s_mov_b32 m0, 69632
 s_nop 0
 buffer_load_dwordx4 v11, s[8:11], s14 offen lds
 s_add_u32 s14, s14, 32768
 s_mov_b32 m0, 70656
 s_nop 0
 buffer_load_dwordx4 v11, s[8:11], s14 offen lds
 s_add_u32 s14, s14, 32768
 s_mov_b32 m0, 71680
 s_nop 0
 buffer_load_dwordx4 v11, s[8:11], s14 offen lds
 s_add_u32 s14, s14, 32768
 s_mov_b32 m0, 72704
 s_nop 0
 buffer_load_dwordx4 v11, s[8:11], s14 offen lds
 s_waitcnt vmcnt(40)
 s_barrier
 v_xor_b32 v16, 0, v12
 v_add_u32 v16, 98304, v16
 ds_read_b64_tr_b16 v[192:193], v16 offset:0
 ds_read_b64_tr_b16 v[194:195], v16 offset:8192
 ds_read_b64_tr_b16 v[196:197], v16 offset:2048
 ds_read_b64_tr_b16 v[198:199], v16 offset:10240
 v_xor_b32 v16, 32, v12
 v_add_u32 v16, 98304, v16
 ds_read_b64_tr_b16 v[32:33], v16 offset:0
 ds_read_b64_tr_b16 v[34:35], v16 offset:8192
 ds_read_b64_tr_b16 v[36:37], v16 offset:2048
 ds_read_b64_tr_b16 v[38:39], v16 offset:10240
 s_add_u32 s3, s63, 8192
 s_waitcnt lgkmcnt(2)
 buffer_store_dwordx4 v[32:35], v1, s[4:7], s3 offen offset:0
 s_waitcnt lgkmcnt(0)
 buffer_store_dwordx4 v[36:39], v1, s[4:7], s3 offen offset:1024
 v_xor_b32 v16, 0, v12
 v_add_u32 v16, 98304, v16
 ds_read_b64_tr_b16 v[200:201], v16 offset:16384
 ds_read_b64_tr_b16 v[202:203], v16 offset:24576
 ds_read_b64_tr_b16 v[204:205], v16 offset:18432
 ds_read_b64_tr_b16 v[206:207], v16 offset:26624
 v_xor_b32 v16, 32, v12
 v_add_u32 v16, 98304, v16
 ds_read_b64_tr_b16 v[208:209], v16 offset:16384
 ds_read_b64_tr_b16 v[210:211], v16 offset:24576
 ds_read_b64_tr_b16 v[212:213], v16 offset:18432
 ds_read_b64_tr_b16 v[214:215], v16 offset:26624
 s_waitcnt lgkmcnt(0)
 s_barrier
 s_lshl_b32 s14, s52, 8
 s_add_u32 s14, s14, 3145728
 s_mov_b32 m0, 98304
 s_nop 0
 buffer_load_dwordx4 v10, s[8:11], s14 offen lds
 s_add_u32 s14, s14, 32768
 s_mov_b32 m0, 99328
 s_nop 0
 buffer_load_dwordx4 v10, s[8:11], s14 offen lds
 s_add_u32 s14, s14, 32768
 s_mov_b32 m0, 100352
 s_nop 0
 buffer_load_dwordx4 v10, s[8:11], s14 offen lds
 s_add_u32 s14, s14, 32768
 s_mov_b32 m0, 101376
 s_nop 0
 buffer_load_dwordx4 v10, s[8:11], s14 offen lds
 s_add_u32 s14, s14, 32768
 s_mov_b32 m0, 102400
 s_nop 0
 buffer_load_dwordx4 v11, s[8:11], s14 offen lds
 s_add_u32 s14, s14, 32768
 s_mov_b32 m0, 103424
 s_nop 0
 buffer_load_dwordx4 v11, s[8:11], s14 offen lds
 s_add_u32 s14, s14, 32768
 s_mov_b32 m0, 104448
 s_nop 0
 buffer_load_dwordx4 v11, s[8:11], s14 offen lds
 s_add_u32 s14, s14, 32768
 s_mov_b32 m0, 105472
 s_nop 0
 buffer_load_dwordx4 v11, s[8:11], s14 offen lds
 s_waitcnt vmcnt(42)
 s_barrier
 v_xor_b32 v16, 0, v12
 v_add_u32 v16, 131072, v16
 ds_read_b64_tr_b16 v[216:217], v16 offset:0
 ds_read_b64_tr_b16 v[218:219], v16 offset:8192
 ds_read_b64_tr_b16 v[220:221], v16 offset:2048
 ds_read_b64_tr_b16 v[222:223], v16 offset:10240
 v_xor_b32 v16, 32, v12
 v_add_u32 v16, 131072, v16
 ds_read_b64_tr_b16 v[224:225], v16 offset:0
 ds_read_b64_tr_b16 v[226:227], v16 offset:8192
 ds_read_b64_tr_b16 v[228:229], v16 offset:2048
 ds_read_b64_tr_b16 v[230:231], v16 offset:10240
 v_xor_b32 v16, 0, v12
 v_add_u32 v16, 131072, v16
 ds_read_b64_tr_b16 v[232:233], v16 offset:16384
 ds_read_b64_tr_b16 v[234:235], v16 offset:24576
 ds_read_b64_tr_b16 v[236:237], v16 offset:18432
 ds_read_b64_tr_b16 v[238:239], v16 offset:26624
 v_xor_b32 v16, 32, v12
 v_add_u32 v16, 131072, v16
 ds_read_b64_tr_b16 v[40:41], v16 offset:16384
 ds_read_b64_tr_b16 v[42:43], v16 offset:24576
 ds_read_b64_tr_b16 v[44:45], v16 offset:18432
 ds_read_b64_tr_b16 v[46:47], v16 offset:26624
 s_add_u32 s3, s63, 10240
 s_waitcnt lgkmcnt(2)
 buffer_store_dwordx4 v[40:43], v1, s[4:7], s3 offen offset:0
 s_waitcnt lgkmcnt(0)
 buffer_store_dwordx4 v[44:47], v1, s[4:7], s3 offen offset:1024
 s_waitcnt lgkmcnt(0)
 s_barrier
 s_lshl_b32 s14, s52, 8
 s_add_u32 s14, s14, 4194304
 s_mov_b32 m0, 131072
 s_nop 0
 buffer_load_dwordx4 v10, s[8:11], s14 offen lds
 s_add_u32 s14, s14, 32768
 s_mov_b32 m0, 132096
 s_nop 0
 buffer_load_dwordx4 v10, s[8:11], s14 offen lds
 s_add_u32 s14, s14, 32768
 s_mov_b32 m0, 133120
 s_nop 0
 buffer_load_dwordx4 v10, s[8:11], s14 offen lds
 s_add_u32 s14, s14, 32768
 s_mov_b32 m0, 134144
 s_nop 0
 buffer_load_dwordx4 v10, s[8:11], s14 offen lds
 s_add_u32 s14, s14, 32768
 s_mov_b32 m0, 135168
 s_nop 0
 buffer_load_dwordx4 v11, s[8:11], s14 offen lds
 s_add_u32 s14, s14, 32768
 s_mov_b32 m0, 136192
 s_nop 0
 buffer_load_dwordx4 v11, s[8:11], s14 offen lds
 s_add_u32 s14, s14, 32768
 s_mov_b32 m0, 137216
 s_nop 0
 buffer_load_dwordx4 v11, s[8:11], s14 offen lds
 s_add_u32 s14, s14, 32768
 s_mov_b32 m0, 138240
 s_nop 0
 buffer_load_dwordx4 v11, s[8:11], s14 offen lds
 s_waitcnt vmcnt(36)
 s_barrier
 v_xor_b32 v16, 0, v12
 v_add_u32 v16, 0, v16
 ds_read_b64_tr_b16 v[240:241], v16 offset:0
 ds_read_b64_tr_b16 v[242:243], v16 offset:8192
 ds_read_b64_tr_b16 v[244:245], v16 offset:2048
 ds_read_b64_tr_b16 v[246:247], v16 offset:10240
 v_xor_b32 v16, 32, v12
 v_add_u32 v16, 0, v16
 ds_read_b64_tr_b16 v[248:249], v16 offset:0
 ds_read_b64_tr_b16 v[250:251], v16 offset:8192
 ds_read_b64_tr_b16 v[252:253], v16 offset:2048
 ds_read_b64_tr_b16 v[254:255], v16 offset:10240
 v_xor_b32 v16, 0, v12
 v_add_u32 v16, 0, v16
 ds_read_b64_tr_b16 v[32:33], v16 offset:16384
 ds_read_b64_tr_b16 v[34:35], v16 offset:24576
 ds_read_b64_tr_b16 v[36:37], v16 offset:18432
 ds_read_b64_tr_b16 v[38:39], v16 offset:26624
 v_xor_b32 v16, 32, v12
 v_add_u32 v16, 0, v16
 ds_read_b64_tr_b16 v[40:41], v16 offset:16384
 ds_read_b64_tr_b16 v[42:43], v16 offset:24576
 ds_read_b64_tr_b16 v[44:45], v16 offset:18432
 ds_read_b64_tr_b16 v[46:47], v16 offset:26624
 s_waitcnt lgkmcnt(0)
 s_barrier
 ds_write_b128 v1, v[224:227] offset:16384
 ds_write_b128 v1, v[228:231] offset:17408
 ds_write_b128 v1, v[216:219] offset:18432
 ds_write_b128 v1, v[220:223] offset:19456
 s_waitcnt lgkmcnt(0)
 v_mov_b32 v224, v32
 v_mov_b32 v225, v33
 v_mov_b32 v226, v34
 v_mov_b32 v227, v35
 v_mov_b32 v228, v36
 v_mov_b32 v229, v37
 v_mov_b32 v230, v38
 v_mov_b32 v231, v39
 v_mov_b32 v216, v40
 v_mov_b32 v217, v41
 v_mov_b32 v218, v42
 v_mov_b32 v219, v43
 v_mov_b32 v220, v44
 v_mov_b32 v221, v45
 v_mov_b32 v222, v46
 v_mov_b32 v223, v47
 s_waitcnt vmcnt(28)
 s_barrier
 v_xor_b32 v16, 0, v12
 v_add_u32 v16, 32768, v16
 ds_read_b64_tr_b16 v[32:33], v16 offset:0
 ds_read_b64_tr_b16 v[34:35], v16 offset:8192
 ds_read_b64_tr_b16 v[36:37], v16 offset:2048
 ds_read_b64_tr_b16 v[38:39], v16 offset:10240
 v_xor_b32 v16, 32, v12
 v_add_u32 v16, 32768, v16
 ds_read_b64_tr_b16 v[40:41], v16 offset:0
 ds_read_b64_tr_b16 v[42:43], v16 offset:8192
 ds_read_b64_tr_b16 v[44:45], v16 offset:2048
 ds_read_b64_tr_b16 v[46:47], v16 offset:10240
 v_xor_b32 v16, 0, v12
 v_add_u32 v16, 32768, v16
 ds_read_b64_tr_b16 v[48:49], v16 offset:16384
 ds_read_b64_tr_b16 v[50:51], v16 offset:24576
 ds_read_b64_tr_b16 v[52:53], v16 offset:18432
 ds_read_b64_tr_b16 v[54:55], v16 offset:26624
 v_xor_b32 v16, 32, v12
 v_add_u32 v16, 32768, v16
 ds_read_b64_tr_b16 v[56:57], v16 offset:16384
 ds_read_b64_tr_b16 v[58:59], v16 offset:24576
 ds_read_b64_tr_b16 v[60:61], v16 offset:18432
 ds_read_b64_tr_b16 v[62:63], v16 offset:26624
 s_waitcnt lgkmcnt(0)
 s_barrier
 ds_write_b128 v1, v[200:203] offset:32768
 ds_write_b128 v1, v[204:207] offset:33792
 ds_write_b128 v1, v[192:195] offset:34816
 ds_write_b128 v1, v[196:199] offset:35840
 ds_write_b128 v1, v[184:187] offset:36864
 ds_write_b128 v1, v[188:191] offset:37888
 ds_write_b128 v1, v[176:179] offset:38912
 ds_write_b128 v1, v[180:183] offset:39936
 s_waitcnt lgkmcnt(0)
 v_mov_b32 v200, v32
 v_mov_b32 v201, v33
 v_mov_b32 v202, v34
 v_mov_b32 v203, v35
 v_mov_b32 v204, v36
 v_mov_b32 v205, v37
 v_mov_b32 v206, v38
 v_mov_b32 v207, v39
 v_mov_b32 v192, v40
 v_mov_b32 v193, v41
 v_mov_b32 v194, v42
 v_mov_b32 v195, v43
 v_mov_b32 v196, v44
 v_mov_b32 v197, v45
 v_mov_b32 v198, v46
 v_mov_b32 v199, v47
 v_mov_b32 v184, v48
 v_mov_b32 v185, v49
 v_mov_b32 v186, v50
 v_mov_b32 v187, v51
 v_mov_b32 v188, v52
 v_mov_b32 v189, v53
 v_mov_b32 v190, v54
 v_mov_b32 v191, v55
 v_mov_b32 v176, v56
 v_mov_b32 v177, v57
 v_mov_b32 v178, v58
 v_mov_b32 v179, v59
 v_mov_b32 v180, v60
 v_mov_b32 v181, v61
 v_mov_b32 v182, v62
 v_mov_b32 v183, v63
 s_waitcnt vmcnt(20)
 s_barrier
 v_xor_b32 v16, 0, v12
 v_add_u32 v16, 65536, v16
 ds_read_b64_tr_b16 v[32:33], v16 offset:0
 ds_read_b64_tr_b16 v[34:35], v16 offset:8192
 ds_read_b64_tr_b16 v[36:37], v16 offset:2048
 ds_read_b64_tr_b16 v[38:39], v16 offset:10240
 v_xor_b32 v16, 32, v12
 v_add_u32 v16, 65536, v16
 ds_read_b64_tr_b16 v[40:41], v16 offset:0
 ds_read_b64_tr_b16 v[42:43], v16 offset:8192
 ds_read_b64_tr_b16 v[44:45], v16 offset:2048
 ds_read_b64_tr_b16 v[46:47], v16 offset:10240
 v_xor_b32 v16, 0, v12
 v_add_u32 v16, 65536, v16
 ds_read_b64_tr_b16 v[48:49], v16 offset:16384
 ds_read_b64_tr_b16 v[50:51], v16 offset:24576
 ds_read_b64_tr_b16 v[52:53], v16 offset:18432
 ds_read_b64_tr_b16 v[54:55], v16 offset:26624
 v_xor_b32 v16, 32, v12
 v_add_u32 v16, 65536, v16
 ds_read_b64_tr_b16 v[56:57], v16 offset:16384
 ds_read_b64_tr_b16 v[58:59], v16 offset:24576
 ds_read_b64_tr_b16 v[60:61], v16 offset:18432
 ds_read_b64_tr_b16 v[62:63], v16 offset:26624
 s_waitcnt lgkmcnt(0)
 s_barrier
 ds_write_b128 v2, v[160:163] offset:0
 ds_write_b128 v2, v[164:167] offset:1024
 ds_write_b128 v2, v[144:147] offset:2048
 ds_write_b128 v2, v[148:151] offset:3072
 ds_write_b128 v2, v[136:139] offset:4096
 ds_write_b128 v2, v[140:143] offset:5120
 ds_write_b128 v2, v[128:131] offset:6144
 ds_write_b128 v2, v[132:135] offset:7168
 s_waitcnt lgkmcnt(0)
 v_mov_b32 v160, v32
 v_mov_b32 v161, v33
 v_mov_b32 v162, v34
 v_mov_b32 v163, v35
 v_mov_b32 v164, v36
 v_mov_b32 v165, v37
 v_mov_b32 v166, v38
 v_mov_b32 v167, v39
 v_mov_b32 v144, v40
 v_mov_b32 v145, v41
 v_mov_b32 v146, v42
 v_mov_b32 v147, v43
 v_mov_b32 v148, v44
 v_mov_b32 v149, v45
 v_mov_b32 v150, v46
 v_mov_b32 v151, v47
 v_mov_b32 v136, v48
 v_mov_b32 v137, v49
 v_mov_b32 v138, v50
 v_mov_b32 v139, v51
 v_mov_b32 v140, v52
 v_mov_b32 v141, v53
 v_mov_b32 v142, v54
 v_mov_b32 v143, v55
 v_mov_b32 v128, v56
 v_mov_b32 v129, v57
 v_mov_b32 v130, v58
 v_mov_b32 v131, v59
 v_mov_b32 v132, v60
 v_mov_b32 v133, v61
 v_mov_b32 v134, v62
 v_mov_b32 v135, v63
 s_waitcnt vmcnt(10)
 s_barrier
 v_xor_b32 v16, 0, v12
 v_add_u32 v16, 98304, v16
 ds_read_b64_tr_b16 v[32:33], v16 offset:0
 ds_read_b64_tr_b16 v[34:35], v16 offset:8192
 ds_read_b64_tr_b16 v[36:37], v16 offset:2048
 ds_read_b64_tr_b16 v[38:39], v16 offset:10240
 v_xor_b32 v16, 32, v12
 v_add_u32 v16, 98304, v16
 ds_read_b64_tr_b16 v[40:41], v16 offset:0
 ds_read_b64_tr_b16 v[42:43], v16 offset:8192
 ds_read_b64_tr_b16 v[44:45], v16 offset:2048
 ds_read_b64_tr_b16 v[46:47], v16 offset:10240
 v_xor_b32 v16, 0, v12
 v_add_u32 v16, 98304, v16
 ds_read_b64_tr_b16 v[48:49], v16 offset:16384
 ds_read_b64_tr_b16 v[50:51], v16 offset:24576
 ds_read_b64_tr_b16 v[52:53], v16 offset:18432
 ds_read_b64_tr_b16 v[54:55], v16 offset:26624
 v_xor_b32 v16, 32, v12
 v_add_u32 v16, 98304, v16
 ds_read_b64_tr_b16 v[56:57], v16 offset:16384
 ds_read_b64_tr_b16 v[58:59], v16 offset:24576
 ds_read_b64_tr_b16 v[60:61], v16 offset:18432
 ds_read_b64_tr_b16 v[62:63], v16 offset:26624
 s_waitcnt lgkmcnt(0)
 s_barrier
 ds_write_b128 v2, a[144:147] offset:32768
 ds_write_b128 v2, a[148:151] offset:33792
 ds_write_b128 v2, a[136:139] offset:34816
 ds_write_b128 v2, a[140:143] offset:35840
 ds_write_b128 v2, a[96:99] offset:36864
 ds_write_b128 v2, a[100:103] offset:37888
 ds_write_b128 v2, a[88:91] offset:38912
 ds_write_b128 v2, a[92:95] offset:39936
 s_waitcnt lgkmcnt(0)
 v_accvgpr_write_b32 a144, v32
 v_accvgpr_write_b32 a145, v33
 v_accvgpr_write_b32 a146, v34
 v_accvgpr_write_b32 a147, v35
 v_accvgpr_write_b32 a148, v36
 v_accvgpr_write_b32 a149, v37
 v_accvgpr_write_b32 a150, v38
 v_accvgpr_write_b32 a151, v39
 v_accvgpr_write_b32 a136, v40
 v_accvgpr_write_b32 a137, v41
 v_accvgpr_write_b32 a138, v42
 v_accvgpr_write_b32 a139, v43
 v_accvgpr_write_b32 a140, v44
 v_accvgpr_write_b32 a141, v45
 v_accvgpr_write_b32 a142, v46
 v_accvgpr_write_b32 a143, v47
 v_accvgpr_write_b32 a96, v48
 v_accvgpr_write_b32 a97, v49
 v_accvgpr_write_b32 a98, v50
 v_accvgpr_write_b32 a99, v51
 v_accvgpr_write_b32 a100, v52
 v_accvgpr_write_b32 a101, v53
 v_accvgpr_write_b32 a102, v54
 v_accvgpr_write_b32 a103, v55
 v_accvgpr_write_b32 a88, v56
 v_accvgpr_write_b32 a89, v57
 v_accvgpr_write_b32 a90, v58
 v_accvgpr_write_b32 a91, v59
 v_accvgpr_write_b32 a92, v60
 v_accvgpr_write_b32 a93, v61
 v_accvgpr_write_b32 a94, v62
 v_accvgpr_write_b32 a95, v63
 s_waitcnt vmcnt(0)
 s_barrier
 v_xor_b32 v16, 0, v12
 v_add_u32 v16, 131072, v16
 ds_read_b64_tr_b16 v[32:33], v16 offset:0
 ds_read_b64_tr_b16 v[34:35], v16 offset:8192
 ds_read_b64_tr_b16 v[36:37], v16 offset:2048
 ds_read_b64_tr_b16 v[38:39], v16 offset:10240
 v_xor_b32 v16, 32, v12
 v_add_u32 v16, 131072, v16
 ds_read_b64_tr_b16 v[40:41], v16 offset:0
 ds_read_b64_tr_b16 v[42:43], v16 offset:8192
 ds_read_b64_tr_b16 v[44:45], v16 offset:2048
 ds_read_b64_tr_b16 v[46:47], v16 offset:10240
 v_xor_b32 v16, 0, v12
 v_add_u32 v16, 131072, v16
 ds_read_b64_tr_b16 v[48:49], v16 offset:16384
 ds_read_b64_tr_b16 v[50:51], v16 offset:24576
 ds_read_b64_tr_b16 v[52:53], v16 offset:18432
 ds_read_b64_tr_b16 v[54:55], v16 offset:26624
 v_xor_b32 v16, 32, v12
 v_add_u32 v16, 131072, v16
 ds_read_b64_tr_b16 v[56:57], v16 offset:16384
 ds_read_b64_tr_b16 v[58:59], v16 offset:24576
 ds_read_b64_tr_b16 v[60:61], v16 offset:18432
 ds_read_b64_tr_b16 v[62:63], v16 offset:26624
 s_waitcnt lgkmcnt(0)
 s_barrier
 ds_write_b128 v3, a[80:83] offset:16384
 ds_write_b128 v3, a[84:87] offset:17408
 ds_write_b128 v3, a[64:67] offset:18432
 ds_write_b128 v3, a[68:71] offset:19456
 ds_write_b128 v3, a[40:43] offset:20480
 ds_write_b128 v3, a[44:47] offset:21504
 ds_write_b128 v3, a[24:27] offset:22528
 ds_write_b128 v3, a[28:31] offset:23552
 s_waitcnt lgkmcnt(0)
 v_accvgpr_write_b32 a80, v32
 v_accvgpr_write_b32 a81, v33
 v_accvgpr_write_b32 a82, v34
 v_accvgpr_write_b32 a83, v35
 v_accvgpr_write_b32 a84, v36
 v_accvgpr_write_b32 a85, v37
 v_accvgpr_write_b32 a86, v38
 v_accvgpr_write_b32 a87, v39
 v_accvgpr_write_b32 a64, v40
 v_accvgpr_write_b32 a65, v41
 v_accvgpr_write_b32 a66, v42
 v_accvgpr_write_b32 a67, v43
 v_accvgpr_write_b32 a68, v44
 v_accvgpr_write_b32 a69, v45
 v_accvgpr_write_b32 a70, v46
 v_accvgpr_write_b32 a71, v47
 v_accvgpr_write_b32 a40, v48
 v_accvgpr_write_b32 a41, v49
 v_accvgpr_write_b32 a42, v50
 v_accvgpr_write_b32 a43, v51
 v_accvgpr_write_b32 a44, v52
 v_accvgpr_write_b32 a45, v53
 v_accvgpr_write_b32 a46, v54
 v_accvgpr_write_b32 a47, v55
 v_accvgpr_write_b32 a24, v56
 v_accvgpr_write_b32 a25, v57
 v_accvgpr_write_b32 a26, v58
 v_accvgpr_write_b32 a27, v59
 v_accvgpr_write_b32 a28, v60
 v_accvgpr_write_b32 a29, v61
 v_accvgpr_write_b32 a30, v62
 v_accvgpr_write_b32 a31, v63
 v_lshlrev_b32 v5, 3, v0
 v_and_b32 v6, 0x1e0, v5
 v_and_b32 v7, 1, v0
 v_lshl_add_u32 v6, v7, 4, v6
 v_and_b32 v7, 2, v0
 v_lshl_add_u32 v6, v7, 2, v6
 v_bfe_u32 v4, v0, 2, 2
 v_lshrrev_b32 v7, 4, v0
 v_cmp_eq_u32 vcc, v4, v7
 v_and_b32 v7, 16, v1
 v_mov_b32 v5, 0x3f80
 v_lshlrev_b32 v7, v7, v5
 v_cndmask_b32 v4, 0, v7, vcc
 v_mov_b32 v5, 0
 s_lshl_b32 s59, s53, 16
 s_add_u32 s59, s59, 983040
 s_mul_i32 s15, s53, 327680
 s_add_u32 s15, s15, 225280
 s_lshl_b32 s3, s52, 8
 s_add_u32 s15, s15, s3
 s_add_u32 s64, s15, 0
 s_add_u32 s65, s15, 81920
 s_add_u32 s66, s15, 163840
 s_add_u32 s67, s15, 245760
 s_lshr_b32 s14, s52, 2
 s_and_b32 s15, s52, 3
 s_mov_b32 s16, 0
 s_mov_b32 s84, 0x00ff00ff
 s_mov_b32 s85, 0
 s_lshl_b32 s57, s14, 10
 s_lshl_b32 s3, s15, 6
 s_add_u32 s57, s57, s3
 s_lshl_b32 s3, s16, 8
 s_add_u32 s57, s57, s3
 s_add_u32 s57, s57, s59
 s_add_u32 s59, s59, 0
 s_lshl_b32 s14, s14, 7
 s_mul_i32 s15, s15, 2560
 s_add_u32 s14, s14, s15
 s_lshl_b32 s3, s16, 3
 s_add_u32 s14, s14, s3
 s_mov_b32 s8, s18
 s_and_b32 s9, s19, 0xffff
 s_mov_b32 s10, 10240
 s_mov_b32 s11, 0x00020000
 v_bfe_u32 v40, v0, 4, 1
 v_mul_u32_u24 v40, 1280, v40
 v_and_b32 v41, 7, v0
 v_lshl_add_u32 v40, v41, 1, v40
 buffer_load_ushort v44, v40, s[8:11], s14 offen offset:0
 buffer_load_ushort v45, v40, s[8:11], s14 offen offset:32
 buffer_load_ushort v46, v40, s[8:11], s14 offen offset:64
 buffer_load_ushort v47, v40, s[8:11], s14 offen offset:96
 v_lshrrev_b32 v42, 7, v1
 v_mul_u32_u24 v42, 10240, v42
 v_and_b32 v7, 112, v1
 v_add_u32 v42, v42, v7
 v_and_b32 v43, 32, v1
 v_and_b32 v7, 64, v1
 v_lshl_add_u32 v43, v7, 2, v43
 v_bfe_u32 v7, v1, 8, 1
 v_lshl_add_u32 v43, v7, 4, v43
 v_bfe_u32 v7, v1, 4, 1
 v_lshl_add_u32 v43, v7, 3, v43
 s_waitcnt vmcnt(2)
 v_lshl_or_b32 v44, v45, 16, v44
 s_waitcnt vmcnt(0)
 v_lshl_or_b32 v45, v47, 16, v46
 s_add_u32 s16, s60, 8192
 s_waitcnt vmcnt(0) lgkmcnt(0)
 s_mov_b32 s96, s44
 s_and_b32 s97, s45, 0xffff
 s_mov_b32 s98, 256
 s_mov_b32 s99, 0x00020000
 v_mov_b32 v8, 132
 s_mov_b32 s51, 0
 s_mov_b64 exec, 1
L_wb_159:
 buffer_load_dword v9, v8, s[96:99], 0 offen sc1
 s_waitcnt vmcnt(0)
 v_cmp_eq_u32 vcc, 0, v9
 s_cbranch_vccz L_wbd_160
 s_sleep 2
 s_add_u32 s51, s51, 1
 s_cmp_lt_u32 s51, 131072
 s_cbranch_scc1 L_wb_159
 s_branch L_bail
L_wbd_160:
 s_mov_b64 exec, -1
 s_mov_b32 s96, s44
 s_and_b32 s97, s45, 0xffff
 s_mov_b32 s98, 256
 s_mov_b32 s99, 0x00020000
 v_mov_b32 v8, 212
 s_mov_b32 s51, 0
 s_mov_b64 exec, 1
L_wb_161:
 buffer_load_dword v9, v8, s[96:99], 0 offen sc1
 s_waitcnt vmcnt(0)
 v_cmp_eq_u32 vcc, 0, v9
 s_cbranch_vccz L_wbd_162
 s_sleep 2
 s_add_u32 s51, s51, 1
 s_cmp_lt_u32 s51, 131072
 s_cbranch_scc1 L_wb_161
 s_branch L_bail
L_wbd_162:
 s_mov_b64 exec, -1
 s_mov_b32 s96, s44
 s_and_b32 s97, s45, 0xffff
 s_mov_b32 s98, 256
 s_mov_b32 s99, 0x00020000
 v_lshlrev_b32 v8, 5, v0
 s_mov_b32 s51, 0
L_gl_163:
 buffer_load_dword v9, v8, s[96:99], 0 offen sc1
 s_waitcnt vmcnt(0)
 v_readlane_b32 s3, v9, s48
 s_mov_b32 s80, 0
 s_nop 2
 s_cmp_ge_u32 s3, 32
 s_cbranch_scc1 L_gld_164
 s_mov_b32 s80, 0
 v_readlane_b32 s3, v9, 0
 s_nop 3
 s_add_u32 s80, s80, s3
 v_readlane_b32 s3, v9, 1
 s_nop 3
 s_add_u32 s80, s80, s3
 v_readlane_b32 s3, v9, 2
 s_nop 3
 s_add_u32 s80, s80, s3
 v_readlane_b32 s3, v9, 3
 s_nop 3
 s_add_u32 s80, s80, s3
 v_readlane_b32 s3, v9, 4
 s_nop 3
 s_add_u32 s80, s80, s3
 v_readlane_b32 s3, v9, 5
 s_nop 3
 s_add_u32 s80, s80, s3
 v_readlane_b32 s3, v9, 6
 s_nop 3
 s_add_u32 s80, s80, s3
 v_readlane_b32 s3, v9, 7
 s_nop 3
 s_add_u32 s80, s80, s3
 s_cmp_ge_u32 s80, 256
 s_cbranch_scc1 L_gld_164
 s_sleep 4
 s_add_u32 s51, s51, 1
 s_cmp_lt_u32 s51, 131072
 s_cbranch_scc1 L_gl_163
 s_branch L_bail
L_gld_164:
 s_mov_b64 exec, s[84:85]
 buffer_store_dwordx2 v[44:45], v43, s[4:7], s57 offen sc1
 s_mov_b64 exec, -1
 v_and_b32 v7, 2, v0
 v_mul_u32_u24 v7, 0x5555, v7
 v_add_u32 v0, 0x4444, v7
 s_mov_b32 m0, 2048
 s_waitcnt vmcnt(0) lgkmcnt(0)
 s_barrier
 buffer_load_dwordx4 v[32:35], v1, s[4:7], s63 offen offset:0
 buffer_load_dwordx4 v[36:39], v1, s[4:7], s63 offen offset:1024
 buffer_load_dwordx4 v[40:43], v1, s[4:7], s63 offen offset:2048
 buffer_load_dwordx4 v[44:47], v1, s[4:7], s63 offen offset:3072
 buffer_load_dwordx4 v[48:51], v1, s[4:7], s81 offen offset:0
 buffer_load_dwordx4 v[52:55], v1, s[4:7], s81 offen offset:1024
 buffer_load_dwordx4 v[56:59], v1, s[4:7], s81 offen offset:2048
 buffer_load_dwordx4 v[60:63], v1, s[4:7], s81 offen offset:3072
 ds_read_b128 v[8:11], v3 offset:49152
 ds_read_b128 v[12:15], v3 offset:49152
 ds_read_b128 v[16:19], v3 offset:49152
 ds_read_b128 v[20:23], v3 offset:49152
 s_waitcnt vmcnt(0) lgkmcnt(0)
 s_cmp_lg_u32 s80, 0
 s_cbranch_scc1 L_ch0_s
.p2align 6
L_ch0_f:
 s_mov_b32 s51, 0
L_pm_165:
 buffer_load_dwordx4 v[24:27], v1, s[4:7], s59 offen offset:0 sc1
 buffer_load_dwordx4 v[28:31], v1, s[4:7], s59 offen offset:1024 sc1
 s_waitcnt vmcnt(1)
 ds_write_b128 v1, v[24:27] offset:0
 v_max_u32 v7, v24, v26
 s_waitcnt vmcnt(0)
 ds_write_b128 v1, v[28:31] offset:1024
 v_max3_u32 v7, v7, v28, v30
 v_cmp_eq_u32 vcc, -1, v7
 s_cbranch_vccnz L_rt_166
 v_smfmac_f32_16x16x64_bf16 v[16:19], v[24:27], v[32:39], v0
 ds_read_b128 v[32:35], v2 offset:6144
 ds_read_b128 v[36:39], v2 offset:7168
 v_smfmac_f32_16x16x64_bf16 v[20:23], v[24:27], v[40:47], v0
 ds_read_b128 v[40:43], v2 offset:4096
 ds_read_b128 v[44:47], v2 offset:5120
 v_smfmac_f32_16x16x64_bf16 v[16:19], v[28:31], v[48:55], v0
 v_smfmac_f32_16x16x64_bf16 v[20:23], v[28:31], v[56:63], v0
 s_waitcnt lgkmcnt(4)
 s_barrier
 buffer_load_dwordx4 v[56:59], v1, s[4:7], s101 offen offset:0
 v_smfmac_f32_16x16x64_bf16 v[8:11], v[24:27], v[240:247], v0
 v_smfmac_f32_16x16x64_bf16 v[12:15], v[24:27], v[248:255], v0
 ds_read_b128 v[24:27], v1 offset:2048
 buffer_load_dwordx4 v[60:63], v1, s[4:7], s101 offen offset:1024
 v_smfmac_f32_16x16x64_bf16 v[8:11], v[28:31], v[224:231], v0
 v_smfmac_f32_16x16x64_bf16 v[12:15], v[28:31], v[216:223], v0
 ds_read_b128 v[28:31], v1 offset:3072
 buffer_load_dwordx4 v[48:51], v1, s[4:7], s101 offen offset:2048
 s_waitcnt lgkmcnt(1)
 v_smfmac_f32_16x16x64_bf16 v[16:19], v[24:27], v[32:39], v0
 ds_read_b128 v[32:35], v2 offset:2048
 ds_read_b128 v[36:39], v2 offset:3072
 v_smfmac_f32_16x16x64_bf16 v[8:11], v[24:27], v[200:207], v0
 buffer_load_dwordx4 v[52:55], v1, s[4:7], s101 offen offset:3072
 v_smfmac_f32_16x16x64_bf16 v[12:15], v[24:27], v[192:199], v0
 v_smfmac_f32_16x16x64_bf16 v[20:23], v[24:27], v[40:47], v0
 ds_read_b128 v[40:43], v2 offset:0
 ds_read_b128 v[44:47], v2 offset:1024
 ds_read_b128 v[24:27], v1 offset:4096
 s_waitcnt lgkmcnt(5)
 v_smfmac_f32_16x16x64_bf16 v[8:11], v[28:31], v[184:191], v0
 v_smfmac_f32_16x16x64_bf16 v[12:15], v[28:31], v[176:183], v0
 s_waitcnt lgkmcnt(3)
 v_smfmac_f32_16x16x64_bf16 v[16:19], v[28:31], v[32:39], v0
 ds_read_b128 v[32:35], v1 offset:38912
 ds_read_b128 v[36:39], v1 offset:39936
 v_smfmac_f32_16x16x64_bf16 v[20:23], v[28:31], v[152:159], v0
 ds_read_b128 v[28:31], v1 offset:5120
 s_waitcnt lgkmcnt(3)
 v_smfmac_f32_16x16x64_bf16 v[8:11], v[24:27], v[160:167], v0
 v_smfmac_f32_16x16x64_bf16 v[16:19], v[24:27], v[40:47], v0
 ds_read_b128 v[40:43], v1 offset:36864
 ds_read_b128 v[44:47], v1 offset:37888
 v_smfmac_f32_16x16x64_bf16 v[12:15], v[24:27], v[144:151], v0
 v_smfmac_f32_16x16x64_bf16 v[20:23], v[24:27], v[168:175], v0
 ds_read_b128 v[24:27], v1 offset:6144
 s_waitcnt lgkmcnt(3)
 v_smfmac_f32_16x16x64_bf16 v[16:19], v[28:31], v[32:39], v0
 ds_read_b128 v[32:35], v1 offset:34816
 ds_read_b128 v[36:39], v1 offset:35840
 v_smfmac_f32_16x16x64_bf16 v[8:11], v[28:31], v[136:143], v0
 v_smfmac_f32_16x16x64_bf16 v[12:15], v[28:31], v[128:135], v0
 s_waitcnt lgkmcnt(3)
 v_smfmac_f32_16x16x64_bf16 v[20:23], v[28:31], v[40:47], v0
 ds_read_b128 v[40:43], v1 offset:32768
 ds_read_b128 v[44:47], v1 offset:33792
 ds_read_b128 v[28:31], v1 offset:7168
 s_waitcnt lgkmcnt(5)
 v_smfmac_f32_16x16x64_bf16 v[8:11], v[24:27], a[144:151], v0
 v_smfmac_f32_16x16x64_bf16 v[12:15], v[24:27], a[136:143], v0
 s_waitcnt lgkmcnt(3)
 v_smfmac_f32_16x16x64_bf16 v[16:19], v[24:27], v[32:39], v0
 ds_read_b128 v[32:35], v1 offset:18432
 ds_read_b128 v[36:39], v1 offset:19456
 s_waitcnt vmcnt(2)
 v_smfmac_f32_16x16x64_bf16 v[20:23], v[24:27], v[56:63], v0
 ds_read_b128 v[24:27], v1 offset:8192
 buffer_load_dwordx4 v[56:59], v1, s[4:7], s61 offen offset:0 sc1 nt
 s_waitcnt lgkmcnt(3)
 v_smfmac_f32_16x16x64_bf16 v[8:11], v[28:31], a[96:103], v0
 v_smfmac_f32_16x16x64_bf16 v[16:19], v[28:31], v[40:47], v0
 ds_read_b128 v[40:43], v1 offset:16384
 ds_read_b128 v[44:47], v1 offset:17408
 s_add_u32 s3, s61, 4096
 buffer_load_dwordx4 v[60:63], v1, s[4:7], s3 offen offset:0 sc1 nt
 v_smfmac_f32_16x16x64_bf16 v[12:15], v[28:31], a[88:95], v0
 v_smfmac_f32_16x16x64_bf16 v[20:23], v[28:31], v[208:215], v0
 ds_read_b128 v[28:31], v1 offset:9216
 s_waitcnt lgkmcnt(3)
 v_smfmac_f32_16x16x64_bf16 v[16:19], v[24:27], v[32:39], v0
 v_smfmac_f32_16x16x64_bf16 v[8:11], v[24:27], a[80:87], v0
 s_add_u32 s3, s61, 67108864
 buffer_load_dwordx4 v[32:35], v1, s[4:7], s3 offen offset:0 sc1 nt
 v_smfmac_f32_16x16x64_bf16 v[12:15], v[24:27], a[64:71], v0
 s_waitcnt lgkmcnt(1)
 v_smfmac_f32_16x16x64_bf16 v[20:23], v[24:27], v[40:47], v0
 ds_read_b128 v[40:43], v3 offset:49152
 ds_read_b128 v[44:47], v3 offset:49152
 buffer_load_dwordx4 v[36:39], v1, s[4:7], s3 offen offset:1024 sc1 nt
 s_waitcnt lgkmcnt(2)
 v_smfmac_f32_16x16x64_bf16 v[8:11], v[28:31], a[40:47], v0
 v_smfmac_f32_16x16x64_bf16 v[12:15], v[28:31], a[24:31], v0
 v_smfmac_f32_16x16x64_bf16 v[16:19], v[28:31], v[232:239], v0
 s_waitcnt vmcnt(4)
 v_smfmac_f32_16x16x64_bf16 v[20:23], v[28:31], v[48:55], v0
 ds_read_b128 v[52:55], v1 offset:0
 v_add_f32 v8, v8, v10
 v_add_f32 v11, v9, v11
 v_cvt_pk_bf16_f32 v9, v8, v11
 v_cvt_pk_bf16_f32 v8, v8, v11
 v_add_f32 v12, v12, v14
 v_add_f32 v15, v13, v15
 v_cvt_pk_bf16_f32 v13, v12, v15
 v_cvt_pk_bf16_f32 v12, v12, v15
 v_mfma_f32_16x16x16_bf16 v[8:11], v[8:9], v[4:5], 0
 v_mfma_f32_16x16x16_bf16 v[12:15], v[12:13], v[4:5], 0
 v_add_f32 v16, v16, v18
 v_add_f32 v19, v17, v19
 v_cvt_pk_bf16_f32 v17, v16, v19
 v_cvt_pk_bf16_f32 v16, v16, v19
 v_add_f32 v20, v20, v22
 v_add_f32 v23, v21, v23
 v_cvt_pk_bf16_f32 v21, v20, v23
 v_cvt_pk_bf16_f32 v20, v20, v23
 v_mfma_f32_16x16x16_bf16 v[16:19], v[16:17], v[4:5], 0
 v_mfma_f32_16x16x16_bf16 v[20:23], v[20:21], v[4:5], 0
 s_waitcnt lgkmcnt(2)
 v_smfmac_f32_16x16x64_bf16 v[40:43], v[24:27], v[96:103], v0
 s_waitcnt lgkmcnt(1)
 v_smfmac_f32_16x16x64_bf16 v[44:47], v[24:27], v[104:111], v0
 ds_read_b128 v[24:27], v1 offset:1024
 v_cvt_pk_bf16_f32 v15, v14, v15
 v_cvt_pk_bf16_f32 v14, v12, v13
 v_cvt_pk_bf16_f32 v13, v10, v11
 v_cvt_pk_bf16_f32 v12, v8, v9
 s_waitcnt vmcnt(3)
 s_nop 0
 v_mfma_f32_16x16x32_bf16 v[8:11], v[56:59], v[12:15], 0
 v_cvt_pk_bf16_f32 v23, v22, v23
 v_cvt_pk_bf16_f32 v22, v20, v21
 v_cvt_pk_bf16_f32 v21, v18, v19
 v_cvt_pk_bf16_f32 v20, v16, v17
 s_waitcnt vmcnt(2)
 v_mfma_f32_16x16x32_bf16 v[16:19], v[60:63], v[12:15], 0
 v_mfma_f32_16x16x32_bf16 v[48:51], v[20:23], v[12:15], 0
 v_smfmac_f32_16x16x64_bf16 v[40:43], v[28:31], v[112:119], v0
 v_smfmac_f32_16x16x64_bf16 v[44:47], v[28:31], v[120:127], v0
 ds_read_b128 v[28:31], v1 offset:2048
 s_waitcnt lgkmcnt(2)
 v_smfmac_f32_16x16x64_bf16 v[40:43], v[52:55], a[160:167], v0
 v_cndmask_b32 v8, v8, v16, s[70:71]
 v_cndmask_b32 v9, v9, v17, s[70:71]
 v_cndmask_b32 v10, v10, v18, s[70:71]
 v_cndmask_b32 v11, v11, v19, s[70:71]
 ds_write_b128 v1, v[8:11] offset:10240
 ds_write_b64 v1, v[48:49] offset:14336
 v_smfmac_f32_16x16x64_bf16 v[44:47], v[52:55], a[168:175], v0
 ds_read_b128 v[52:55], v1 offset:3072
 s_waitcnt lgkmcnt(4)
 v_smfmac_f32_16x16x64_bf16 v[40:43], v[24:27], a[176:183], v0
 v_smfmac_f32_16x16x64_bf16 v[44:47], v[24:27], a[184:191], v0
 ds_read_b128 v[24:27], v1 offset:4096
 s_waitcnt lgkmcnt(4)
 v_smfmac_f32_16x16x64_bf16 v[40:43], v[28:31], a[192:199], v0
 v_smfmac_f32_16x16x64_bf16 v[44:47], v[28:31], a[200:207], v0
 ds_read_b128 v[28:31], v1 offset:5120
 s_waitcnt lgkmcnt(2)
 v_smfmac_f32_16x16x64_bf16 v[40:43], v[52:55], a[208:215], v0
 v_smfmac_f32_16x16x64_bf16 v[44:47], v[52:55], a[216:223], v0
 ds_read_b128 v[52:55], v1 offset:6144
 s_barrier
 ds_read_b128 v[56:59], v1 offset:11264
 ds_read_b128 v[60:63], v1 offset:12288
 ds_read_b128 v[16:19], v1 offset:13312
 ds_read_b128 v[12:15], v1 offset:14336
 ds_read_b128 v[48:51], v1 offset:15360
 s_waitcnt lgkmcnt(7)
 v_smfmac_f32_16x16x64_bf16 v[40:43], v[24:27], a[224:231], v0
 s_mov_b64 exec, s[68:69]
 buffer_store_dwordx4 v[20:23], v6, s[4:7], s62 offen offset:0 sc1
 s_mov_b64 exec, -1
 v_smfmac_f32_16x16x64_bf16 v[44:47], v[24:27], a[232:239], v0
 ds_read_b128 v[24:27], v1 offset:7168
 s_waitcnt lgkmcnt(7)
 v_smfmac_f32_16x16x64_bf16 v[40:43], v[28:31], a[240:247], v0
 v_smfmac_f32_16x16x64_bf16 v[44:47], v[28:31], a[248:255], v0
 s_waitcnt lgkmcnt(6)
 v_smfmac_f32_16x16x64_bf16 v[40:43], v[52:55], v[64:71], v0
 v_smfmac_f32_16x16x64_bf16 v[44:47], v[52:55], v[72:79], v0
 s_waitcnt lgkmcnt(0)
 v_smfmac_f32_16x16x64_bf16 v[40:43], v[24:27], v[80:87], v0
 v_smfmac_f32_16x16x64_bf16 v[44:47], v[24:27], v[88:95], v0
 v_pk_add_f32 v[8:9], v[8:9], v[56:57]
 v_pk_add_f32 v[10:11], v[10:11], v[58:59]
 v_pk_add_f32 v[60:61], v[60:61], v[16:17]
 v_pk_add_f32 v[62:63], v[62:63], v[18:19]
 v_pk_add_f32 v[12:13], v[12:13], v[14:15]
 v_pk_add_f32 v[48:49], v[48:49], v[50:51]
 v_pk_add_f32 v[8:9], v[8:9], v[60:61]
 v_pk_add_f32 v[10:11], v[10:11], v[62:63]
 v_pk_add_f32 v[48:49], v[12:13], v[48:49]
 v_max3_f32 v50, v8, v9, v10
 v_max3_f32 v50, v50, v11, v48
 v_max_f32 v50, v50, v49
 v_add_f32 v40, v40, v42
 v_add_f32 v41, v41, v43
 v_max_f32_dpp v50, v50, v50 quad_perm:[2,3,0,1] row_mask:0xf bank_mask:0xf
 v_mov_b32 v51, v50
 v_add_f32 v44, v44, v46
 v_add_f32 v45, v45, v47
 v_permlane16_swap_b32 v50, v51
 v_max_f32 v50, v50, v51
 v_mov_b32 v51, v50
 v_cvt_pk_bf16_f32 v40, v40, v41
 v_cvt_pk_bf16_f32 v41, v44, v45
 v_permlane32_swap_b32 v50, v51
 v_max_f32 v50, v50, v51
 v_mul_f32 v50, s56, v50
 v_fma_f32 v48, v48, s56, -v50
 v_fma_f32 v49, v49, s56, -v50
 v_fma_f32 v8, v8, s56, -v50
 v_fma_f32 v9, v9, s56, -v50
 v_fma_f32 v10, v10, s56, -v50
 v_fma_f32 v11, v11, s56, -v50
 v_exp_f32 v48, v48
 v_lshrrev_b32 v51, 1, v1
 v_exp_f32 v49, v49
 ds_read_b128 v[56:59], v3 offset:18432
 ds_read_b128 v[60:63], v3 offset:19456
 v_exp_f32 v8, v8
 v_exp_f32 v9, v9
 ds_read_b128 v[24:27], v2 offset:36864
 ds_read_b128 v[28:31], v2 offset:37888
 v_exp_f32 v10, v10
 buffer_store_dwordx2 v[40:41], v51, s[4:7], s62 offen offset:2048 sc1
 v_exp_f32 v11, v11
 v_cvt_pk_bf16_f32 v14, v48, v49
 v_cvt_pk_bf16_f32 v12, v8, v9
 v_cvt_pk_bf16_f32 v13, v10, v11
 v_cndmask_b32 v52, 0, v14, s[68:69]
 v_cndmask_b32 v53, 0, v14, s[70:71]
 v_cndmask_b32 v22, 0, v12, s[70:71]
 v_cndmask_b32 v23, 0, v13, s[70:71]
 v_mfma_f32_16x16x16_bf16 v[44:47], v[40:41], v[52:53], 0
 v_cndmask_b32 v16, 0, v12, s[68:69]
 v_cndmask_b32 v17, 0, v13, s[68:69]
 v_mov_b32_dpp v18, v22 quad_perm:[2,3,0,1] row_mask:0xf bank_mask:0xf
 v_mov_b32_dpp v19, v23 quad_perm:[2,3,0,1] row_mask:0xf bank_mask:0xf
 v_mov_b32_dpp v20, v16 quad_perm:[2,3,0,1] row_mask:0xf bank_mask:0xf
 v_mov_b32_dpp v21, v17 quad_perm:[2,3,0,1] row_mask:0xf bank_mask:0xf
 s_waitcnt vmcnt(3)
 v_mfma_f32_16x16x32_bf16 v[44:47], v[32:35], v[16:19], v[44:47]
 v_add_f32 v54, v8, v9
 v_add_f32 v55, v48, v49
 s_waitcnt vmcnt(2)
 v_mfma_f32_16x16x32_bf16 v[44:47], v[36:39], v[20:23], v[44:47]
 v_add_f32 v54, v54, v10
 v_fma_f32 v55, v55, 0.5, v11
 v_add_f32 v54, v54, v55
 ds_read_b128 v[16:19], v3 offset:49152
 ds_read_b128 v[20:23], v3 offset:49152
 v_add_f32_dpp v54, v54, v54 quad_perm:[2,3,0,1] row_mask:0xf bank_mask:0xf
 v_mov_b32 v55, v54
 ds_read_b128 v[32:35], v3 offset:49152
 ds_read_b128 v[36:39], v3 offset:49152
 v_permlane16_swap_b32 v54, v55
 v_add_f32 v54, v54, v55
 v_mov_b32 v55, v54
 ds_read_b128 v[8:11], v3 offset:49152
 s_cmp_eq_u32 s54, 63
 v_permlane32_swap_b32 v54, v55
 v_add_f32 v54, v54, v55
 v_rcp_f32 v54, v54
 s_cbranch_scc1 L_ch0_end
 v_mul_f32 v44, v44, v54
 v_mul_f32 v45, v45, v54
 v_cvt_pk_bf16_f32 v42, v44, v45
 v_mul_f32 v46, v46, v54
 v_mul_f32 v47, v47, v54
 v_cvt_pk_bf16_f32 v43, v46, v47
 ds_write_b64 v6, v[42:43] offset:0
 v_and_b32 v40, -9, v6
 v_mov_b32_dpp v12, v42 quad_perm:[0,1,0,1] row_mask:0xf bank_mask:0xf
 v_mov_b32_dpp v14, v42 quad_perm:[2,3,2,3] row_mask:0xf bank_mask:0xf
 v_mov_b32_dpp v13, v43 quad_perm:[0,1,0,1] row_mask:0xf bank_mask:0xf
 v_mov_b32_dpp v15, v43 quad_perm:[2,3,2,3] row_mask:0xf bank_mask:0xf
 s_waitcnt lgkmcnt(5)
 s_nop 0
 v_smfmac_f32_16x16x64_bf16 v[16:19], v[12:15], a[0:7], v0
 s_waitcnt lgkmcnt(4)
 v_smfmac_f32_16x16x64_bf16 v[20:23], v[12:15], a[32:39], v0
 s_waitcnt lgkmcnt(0)
 s_barrier
 ds_read_b128 v[48:51], v40 offset:512
 ds_read_b128 v[52:55], v40 offset:1024
 ds_read_b128 v[44:47], v40 offset:1536
 v_smfmac_f32_16x16x64_bf16 v[32:35], v[12:15], v[56:63], v0
 ds_read_b128 v[56:59], v3 offset:22528
 ds_read_b128 v[60:63], v3 offset:23552
 s_mov_b32 m0, 8192
 v_smfmac_f32_16x16x64_bf16 v[36:39], v[12:15], v[24:31], v0
 ds_read_b128 v[24:27], v3 offset:20480
 ds_read_b128 v[28:31], v3 offset:21504
 buffer_load_dwordx4 v1, s[4:7], s63 offen offset:2048 lds
 v_smfmac_f32_16x16x64_bf16 v[8:11], v[12:15], a[128:135], v0
 s_mov_b32 m0, 8192
 s_waitcnt lgkmcnt(6)
 v_smfmac_f32_16x16x64_bf16 v[16:19], v[48:51], a[8:15], v0
 buffer_load_dwordx4 v1, s[4:7], s63 offen offset:3072 lds
 s_waitcnt lgkmcnt(5)
 v_smfmac_f32_16x16x64_bf16 v[16:19], v[52:55], a[16:23], v0
 s_mov_b32 m0, 14336
 s_waitcnt lgkmcnt(2)
 v_smfmac_f32_16x16x64_bf16 v[16:19], v[44:47], v[56:63], v0
 ds_read_b128 v[56:59], v3 offset:16384
 ds_read_b128 v[60:63], v3 offset:17408
 buffer_load_dwordx4 v1, s[4:7], s81 offen offset:0 lds
 s_waitcnt lgkmcnt(2)
 v_smfmac_f32_16x16x64_bf16 v[20:23], v[48:51], v[24:31], v0
 ds_read_b128 v[24:27], v2 offset:38912
 ds_read_b128 v[28:31], v2 offset:39936
 s_mov_b32 m0, 14336
 v_smfmac_f32_16x16x64_bf16 v[20:23], v[52:55], a[48:55], v0
 buffer_load_dwordx4 v1, s[4:7], s81 offen offset:1024 lds
 v_smfmac_f32_16x16x64_bf16 v[20:23], v[44:47], a[56:63], v0
 v_cvt_pk_bf16_f32 v16, v16, v17
 v_smfmac_f32_16x16x64_bf16 v[32:35], v[48:51], a[72:79], v0
 v_cvt_pk_bf16_f32 v17, v18, v19
 s_waitcnt lgkmcnt(2)
 v_smfmac_f32_16x16x64_bf16 v[32:35], v[52:55], v[56:63], v0
 ds_read_b128 v[56:59], v2 offset:34816
 ds_read_b128 v[60:63], v2 offset:35840
 v_and_or_b32 v16, v16, -2, s55
 s_waitcnt lgkmcnt(2)
 v_smfmac_f32_16x16x64_bf16 v[32:35], v[44:47], v[24:31], v0
 ds_read_b128 v[24:27], v2 offset:32768
 ds_read_b128 v[28:31], v2 offset:33792
 v_cvt_pk_bf16_f32 v18, v20, v21
 v_smfmac_f32_16x16x64_bf16 v[36:39], v[48:51], a[104:111], v0
 v_cvt_pk_bf16_f32 v19, v22, v23
 v_smfmac_f32_16x16x64_bf16 v[36:39], v[52:55], a[112:119], v0
 v_and_or_b32 v18, v18, -2, s55
 buffer_store_dwordx4 v[16:19], v1, s[4:7], s60 offen offset:0
 v_smfmac_f32_16x16x64_bf16 v[36:39], v[44:47], a[120:127], v0
 v_cvt_pk_bf16_f32 v32, v32, v33
 s_waitcnt lgkmcnt(2)
 v_smfmac_f32_16x16x64_bf16 v[8:11], v[48:51], v[56:63], v0
 v_cvt_pk_bf16_f32 v33, v34, v35
 s_waitcnt lgkmcnt(0)
 v_smfmac_f32_16x16x64_bf16 v[8:11], v[52:55], v[24:31], v0
 v_and_or_b32 v32, v32, -2, s55
 v_smfmac_f32_16x16x64_bf16 v[8:11], v[44:47], a[152:159], v0
 v_cvt_pk_bf16_f32 v34, v36, v37
 v_cvt_pk_bf16_f32 v35, v38, v39
 v_and_or_b32 v34, v34, -2, s55
 buffer_store_dwordx4 v[32:35], v1, s[4:7], s60 offen offset:1024
 s_nop 3
 v_cvt_pk_bf16_f32 v8, v8, v9
 v_cvt_pk_bf16_f32 v9, v10, v11
 v_and_or_b32 v8, v8, -2, s55
 buffer_store_dwordx2 v[8:9], v1, s[4:7], s16 offen offset:0
 buffer_load_dwordx4 v[32:35], v1, s[4:7], s63 offen offset:0
 buffer_load_dwordx4 v[36:39], v1, s[4:7], s63 offen offset:1024
 s_add_u32 s54, s54, 1
 s_add_u32 s61, s61, 524288
 s_and_b32 s3, s54, 7
 s_cselect_b32 s3, 1, -7
 s_lshl_b32 s3, s3, 17
 s_add_u32 s62, s62, s3
 s_and_b32 s3, s54, 3
 s_cselect_b32 s3, 1, -3
 s_lshl_b32 s3, s3, 14
 s_add_u32 s57, s57, s3
 s_add_u32 s59, s59, s3
 s_xor_b32 s58, s57, 32768
 v_lshrrev_b32 v56, 7, v1
 v_mul_u32_u24 v56, 10240, v56
 v_and_b32 v60, 112, v1
 v_add_u32 v56, v56, v60
 v_and_b32 v57, 32, v1
 v_and_b32 v60, 64, v1
 v_lshl_add_u32 v57, v60, 2, v57
 v_bfe_u32 v60, v1, 8, 1
 v_lshl_add_u32 v57, v60, 4, v57
 v_bfe_u32 v60, v1, 4, 1
 v_lshl_add_u32 v57, v60, 3, v57
 v_mov_b32 v60, 0x3f80
 v_mov_b32 v28, 0x3f800000
 v_cndmask_b32 v60, v60, v28, s[82:83]
 v_cndmask_b32 v28, 0, v60, s[72:73]
 v_cndmask_b32 v29, 0, v60, s[74:75]
 v_cndmask_b32 v30, 0, v60, s[76:77]
 v_cndmask_b32 v31, 0, v60, s[78:79]
 v_mov_b64 v[58:59], -1
 s_mov_b64 exec, s[84:85]
 buffer_store_dwordx2 v[58:59], v57, s[4:7], s58 offen
 s_mov_b64 exec, -1
 s_nop 15
 s_nop 15
 s_nop 15
 s_nop 15
 s_nop 15
 s_mov_b32 s51, 0
 buffer_load_dwordx4 v[8:11], v56, s[4:7], s64 offen sc1
 buffer_load_dwordx4 v[12:15], v56, s[4:7], s65 offen sc1
 buffer_load_dwordx4 v[16:19], v56, s[4:7], s66 offen sc1
 buffer_load_dwordx4 v[20:23], v56, s[4:7], s67 offen sc1
L_pp_167:
 s_waitcnt vmcnt(3)
 v_mfma_f32_16x16x32_bf16 v[24:27], v[28:31], v[8:11], 0
 v_bitop3_b32 v60, v8, v10, s55 bitop3:0x7e
 s_waitcnt vmcnt(2)
 v_mfma_f32_16x16x32_bf16 v[24:27], v[28:31], v[12:15], v[24:27]
 v_bitop3_b32 v61, v12, v14, s55 bitop3:0x7e
 s_waitcnt vmcnt(1)
 v_mfma_f32_16x16x32_bf16 v[24:27], v[28:31], v[16:19], v[24:27]
 v_bitop3_b32 v62, v16, v18, s55 bitop3:0x7e
 s_waitcnt vmcnt(0)
 v_mfma_f32_16x16x32_bf16 v[24:27], v[28:31], v[20:23], v[24:27]
 v_bitop3_b32 v63, v20, v22, s55 bitop3:0x7e
 v_or3_b32 v7, v60, v61, v62
 v_bitop3_b32 v7, v7, v63, 1 bitop3:0xa8
 v_cmp_ne_u32 vcc, 0, v7
 s_cbranch_vccnz L_rt_168
 s_nop 2
 v_add_f32_dpp v24, v24, v24 row_ror:8 row_mask:0xf bank_mask:0xf
 v_add_f32_dpp v25, v25, v25 row_ror:8 row_mask:0xf bank_mask:0xf
 v_add_f32_dpp v26, v26, v26 row_ror:8 row_mask:0xf bank_mask:0xf
 v_add_f32_dpp v27, v27, v27 row_ror:8 row_mask:0xf bank_mask:0xf
 s_mov_b64 exec, s[84:85]
 v_cvt_pk_bf16_f32 v24, v24, v25
 v_cvt_pk_bf16_f32 v25, v26, v27
 buffer_store_dwordx2 v[24:25], v57, s[4:7], s57 offen
 s_mov_b64 exec, -1
 s_xor_b32 s55, s55, 1
 ds_read_b128 v[40:43], v1 offset:10240
 ds_read_b128 v[44:47], v1 offset:11264
 ds_read_b128 v[48:51], v1 offset:14336
 ds_read_b128 v[52:55], v1 offset:15360
 buffer_load_dwordx4 v[56:59], v1, s[4:7], s81 offen offset:2048
 buffer_load_dwordx4 v[60:63], v1, s[4:7], s81 offen offset:3072
 ds_read_b128 v[8:11], v3 offset:49152
 ds_read_b128 v[12:15], v3 offset:49152
 ds_read_b128 v[16:19], v3 offset:49152
 ds_read_b128 v[20:23], v3 offset:49152
 s_waitcnt lgkmcnt(0)
 s_nop 15
 s_nop 15
 s_nop 7
 s_branch L_ch0_f
L_rt_166:
 s_add_u32 s51, s51, 1
 s_cmp_lt_u32 s51, 131072
 s_cbranch_scc1 L_pm_165
 s_branch L_bail
L_rt_168:
 buffer_load_dwordx4 v[8:11], v56, s[4:7], s64 offen sc1
 buffer_load_dwordx4 v[12:15], v56, s[4:7], s65 offen sc1
 buffer_load_dwordx4 v[16:19], v56, s[4:7], s66 offen sc1
 buffer_load_dwordx4 v[20:23], v56, s[4:7], s67 offen sc1
 s_add_u32 s51, s51, 1
 s_cmp_lt_u32 s51, 131072
 s_cbranch_scc1 L_pp_167
 s_branch L_bail
.p2align 6
L_ch0_s:
 s_mov_b32 s51, 0
L_pm_169:
 buffer_load_dwordx4 v[24:27], v1, s[4:7], s59 offen offset:0 sc1
 buffer_load_dwordx4 v[28:31], v1, s[4:7], s59 offen offset:1024 sc1
 s_waitcnt vmcnt(1)
 ds_write_b128 v1, v[24:27] offset:0
 v_max_u32 v7, v24, v26
 s_waitcnt vmcnt(0)
 ds_write_b128 v1, v[28:31] offset:1024
 v_max3_u32 v7, v7, v28, v30
 v_cmp_eq_u32 vcc, -1, v7
 s_cbranch_vccnz L_rt_170
 v_smfmac_f32_16x16x64_bf16 v[16:19], v[24:27], v[32:39], v0
 ds_read_b128 v[32:35], v2 offset:6144
 ds_read_b128 v[36:39], v2 offset:7168
 v_smfmac_f32_16x16x64_bf16 v[20:23], v[24:27], v[40:47], v0
 ds_read_b128 v[40:43], v2 offset:4096
 ds_read_b128 v[44:47], v2 offset:5120
 v_smfmac_f32_16x16x64_bf16 v[16:19], v[28:31], v[48:55], v0
 v_smfmac_f32_16x16x64_bf16 v[20:23], v[28:31], v[56:63], v0
 s_waitcnt lgkmcnt(4)
 s_barrier
 buffer_load_dwordx4 v[56:59], v1, s[4:7], s101 offen offset:0
 v_smfmac_f32_16x16x64_bf16 v[8:11], v[24:27], v[240:247], v0
 v_smfmac_f32_16x16x64_bf16 v[12:15], v[24:27], v[248:255], v0
 ds_read_b128 v[24:27], v1 offset:2048
 buffer_load_dwordx4 v[60:63], v1, s[4:7], s101 offen offset:1024
 v_smfmac_f32_16x16x64_bf16 v[8:11], v[28:31], v[224:231], v0
 v_smfmac_f32_16x16x64_bf16 v[12:15], v[28:31], v[216:223], v0
 ds_read_b128 v[28:31], v1 offset:3072
 buffer_load_dwordx4 v[48:51], v1, s[4:7], s101 offen offset:2048
 s_waitcnt lgkmcnt(1)
 v_smfmac_f32_16x16x64_bf16 v[16:19], v[24:27], v[32:39], v0
 ds_read_b128 v[32:35], v2 offset:2048
 ds_read_b128 v[36:39], v2 offset:3072
 v_smfmac_f32_16x16x64_bf16 v[8:11], v[24:27], v[200:207], v0
 buffer_load_dwordx4 v[52:55], v1, s[4:7], s101 offen offset:3072
 v_smfmac_f32_16x16x64_bf16 v[12:15], v[24:27], v[192:199], v0
 v_smfmac_f32_16x16x64_bf16 v[20:23], v[24:27], v[40:47], v0
 ds_read_b128 v[40:43], v2 offset:0
 ds_read_b128 v[44:47], v2 offset:1024
 ds_read_b128 v[24:27], v1 offset:4096
 s_waitcnt lgkmcnt(5)
 v_smfmac_f32_16x16x64_bf16 v[8:11], v[28:31], v[184:191], v0
 v_smfmac_f32_16x16x64_bf16 v[12:15], v[28:31], v[176:183], v0
 s_waitcnt lgkmcnt(3)
 v_smfmac_f32_16x16x64_bf16 v[16:19], v[28:31], v[32:39], v0
 ds_read_b128 v[32:35], v1 offset:38912
 ds_read_b128 v[36:39], v1 offset:39936
 v_smfmac_f32_16x16x64_bf16 v[20:23], v[28:31], v[152:159], v0
 ds_read_b128 v[28:31], v1 offset:5120
 s_waitcnt lgkmcnt(3)
 v_smfmac_f32_16x16x64_bf16 v[8:11], v[24:27], v[160:167], v0
 v_smfmac_f32_16x16x64_bf16 v[16:19], v[24:27], v[40:47], v0
 ds_read_b128 v[40:43], v1 offset:36864
 ds_read_b128 v[44:47], v1 offset:37888
 v_smfmac_f32_16x16x64_bf16 v[12:15], v[24:27], v[144:151], v0
 v_smfmac_f32_16x16x64_bf16 v[20:23], v[24:27], v[168:175], v0
 ds_read_b128 v[24:27], v1 offset:6144
 s_waitcnt lgkmcnt(3)
 v_smfmac_f32_16x16x64_bf16 v[16:19], v[28:31], v[32:39], v0
 ds_read_b128 v[32:35], v1 offset:34816
 ds_read_b128 v[36:39], v1 offset:35840
 v_smfmac_f32_16x16x64_bf16 v[8:11], v[28:31], v[136:143], v0
 v_smfmac_f32_16x16x64_bf16 v[12:15], v[28:31], v[128:135], v0
 s_waitcnt lgkmcnt(3)
 v_smfmac_f32_16x16x64_bf16 v[20:23], v[28:31], v[40:47], v0
 ds_read_b128 v[40:43], v1 offset:32768
 ds_read_b128 v[44:47], v1 offset:33792
 ds_read_b128 v[28:31], v1 offset:7168
 s_waitcnt lgkmcnt(5)
 v_smfmac_f32_16x16x64_bf16 v[8:11], v[24:27], a[144:151], v0
 v_smfmac_f32_16x16x64_bf16 v[12:15], v[24:27], a[136:143], v0
 s_waitcnt lgkmcnt(3)
 v_smfmac_f32_16x16x64_bf16 v[16:19], v[24:27], v[32:39], v0
 ds_read_b128 v[32:35], v1 offset:18432
 ds_read_b128 v[36:39], v1 offset:19456
 s_waitcnt vmcnt(2)
 v_smfmac_f32_16x16x64_bf16 v[20:23], v[24:27], v[56:63], v0
 ds_read_b128 v[24:27], v1 offset:8192
 buffer_load_dwordx4 v[56:59], v1, s[4:7], s61 offen offset:0 sc1 nt
 s_waitcnt lgkmcnt(3)
 v_smfmac_f32_16x16x64_bf16 v[8:11], v[28:31], a[96:103], v0
 v_smfmac_f32_16x16x64_bf16 v[16:19], v[28:31], v[40:47], v0
 ds_read_b128 v[40:43], v1 offset:16384
 ds_read_b128 v[44:47], v1 offset:17408
 s_add_u32 s3, s61, 4096
 buffer_load_dwordx4 v[60:63], v1, s[4:7], s3 offen offset:0 sc1 nt
 v_smfmac_f32_16x16x64_bf16 v[12:15], v[28:31], a[88:95], v0
 v_smfmac_f32_16x16x64_bf16 v[20:23], v[28:31], v[208:215], v0
 ds_read_b128 v[28:31], v1 offset:9216
 s_waitcnt lgkmcnt(3)
 v_smfmac_f32_16x16x64_bf16 v[16:19], v[24:27], v[32:39], v0
 v_smfmac_f32_16x16x64_bf16 v[8:11], v[24:27], a[80:87], v0
 s_add_u32 s3, s61, 67108864
 buffer_load_dwordx4 v[32:35], v1, s[4:7], s3 offen offset:0 sc1 nt
 v_smfmac_f32_16x16x64_bf16 v[12:15], v[24:27], a[64:71], v0
 s_waitcnt lgkmcnt(1)
 v_smfmac_f32_16x16x64_bf16 v[20:23], v[24:27], v[40:47], v0
 ds_read_b128 v[40:43], v3 offset:49152
 ds_read_b128 v[44:47], v3 offset:49152
 buffer_load_dwordx4 v[36:39], v1, s[4:7], s3 offen offset:1024 sc1 nt
 s_waitcnt lgkmcnt(2)
 v_smfmac_f32_16x16x64_bf16 v[8:11], v[28:31], a[40:47], v0
 v_smfmac_f32_16x16x64_bf16 v[12:15], v[28:31], a[24:31], v0
 v_smfmac_f32_16x16x64_bf16 v[16:19], v[28:31], v[232:239], v0
 s_waitcnt vmcnt(4)
 v_smfmac_f32_16x16x64_bf16 v[20:23], v[28:31], v[48:55], v0
 ds_read_b128 v[52:55], v1 offset:0
 v_add_f32 v8, v8, v10
 v_add_f32 v11, v9, v11
 v_cvt_pk_bf16_f32 v9, v8, v11
 v_cvt_pk_bf16_f32 v8, v8, v11
 v_add_f32 v12, v12, v14
 v_add_f32 v15, v13, v15
 v_cvt_pk_bf16_f32 v13, v12, v15
 v_cvt_pk_bf16_f32 v12, v12, v15
 v_mfma_f32_16x16x16_bf16 v[8:11], v[8:9], v[4:5], 0
 v_mfma_f32_16x16x16_bf16 v[12:15], v[12:13], v[4:5], 0
 v_add_f32 v16, v16, v18
 v_add_f32 v19, v17, v19
 v_cvt_pk_bf16_f32 v17, v16, v19
 v_cvt_pk_bf16_f32 v16, v16, v19
 v_add_f32 v20, v20, v22
 v_add_f32 v23, v21, v23
 v_cvt_pk_bf16_f32 v21, v20, v23
 v_cvt_pk_bf16_f32 v20, v20, v23
 v_mfma_f32_16x16x16_bf16 v[16:19], v[16:17], v[4:5], 0
 v_mfma_f32_16x16x16_bf16 v[20:23], v[20:21], v[4:5], 0
 s_waitcnt lgkmcnt(2)
 v_smfmac_f32_16x16x64_bf16 v[40:43], v[24:27], v[96:103], v0
 s_waitcnt lgkmcnt(1)
 v_smfmac_f32_16x16x64_bf16 v[44:47], v[24:27], v[104:111], v0
 ds_read_b128 v[24:27], v1 offset:1024
 v_cvt_pk_bf16_f32 v15, v14, v15
 v_cvt_pk_bf16_f32 v14, v12, v13
 v_cvt_pk_bf16_f32 v13, v10, v11
 v_cvt_pk_bf16_f32 v12, v8, v9
 s_waitcnt vmcnt(3)
 s_nop 0
 v_mfma_f32_16x16x32_bf16 v[8:11], v[56:59], v[12:15], 0
 v_cvt_pk_bf16_f32 v23, v22, v23
 v_cvt_pk_bf16_f32 v22, v20, v21
 v_cvt_pk_bf16_f32 v21, v18, v19
 v_cvt_pk_bf16_f32 v20, v16, v17
 s_waitcnt vmcnt(2)
 v_mfma_f32_16x16x32_bf16 v[16:19], v[60:63], v[12:15], 0
 v_mfma_f32_16x16x32_bf16 v[48:51], v[20:23], v[12:15], 0
 v_smfmac_f32_16x16x64_bf16 v[40:43], v[28:31], v[112:119], v0
 v_smfmac_f32_16x16x64_bf16 v[44:47], v[28:31], v[120:127], v0
 ds_read_b128 v[28:31], v1 offset:2048
 s_waitcnt lgkmcnt(2)
 v_smfmac_f32_16x16x64_bf16 v[40:43], v[52:55], a[160:167], v0
 v_cndmask_b32 v8, v8, v16, s[70:71]
 v_cndmask_b32 v9, v9, v17, s[70:71]
 v_cndmask_b32 v10, v10, v18, s[70:71]
 v_cndmask_b32 v11, v11, v19, s[70:71]
 ds_write_b128 v1, v[8:11] offset:10240
 ds_write_b64 v1, v[48:49] offset:14336
 v_smfmac_f32_16x16x64_bf16 v[44:47], v[52:55], a[168:175], v0
 ds_read_b128 v[52:55], v1 offset:3072
 s_waitcnt lgkmcnt(4)
 v_smfmac_f32_16x16x64_bf16 v[40:43], v[24:27], a[176:183], v0
 v_smfmac_f32_16x16x64_bf16 v[44:47], v[24:27], a[184:191], v0
 ds_read_b128 v[24:27], v1 offset:4096
 s_waitcnt lgkmcnt(4)
 v_smfmac_f32_16x16x64_bf16 v[40:43], v[28:31], a[192:199], v0
 v_smfmac_f32_16x16x64_bf16 v[44:47], v[28:31], a[200:207], v0
 ds_read_b128 v[28:31], v1 offset:5120
 s_waitcnt lgkmcnt(2)
 v_smfmac_f32_16x16x64_bf16 v[40:43], v[52:55], a[208:215], v0
 v_smfmac_f32_16x16x64_bf16 v[44:47], v[52:55], a[216:223], v0
 ds_read_b128 v[52:55], v1 offset:6144
 s_barrier
 ds_read_b128 v[56:59], v1 offset:11264
 ds_read_b128 v[60:63], v1 offset:12288
 ds_read_b128 v[16:19], v1 offset:13312
 ds_read_b128 v[12:15], v1 offset:14336
 ds_read_b128 v[48:51], v1 offset:15360
 s_waitcnt lgkmcnt(7)
 v_smfmac_f32_16x16x64_bf16 v[40:43], v[24:27], a[224:231], v0
 s_mov_b64 exec, s[68:69]
 buffer_store_dwordx4 v[20:23], v6, s[4:7], s62 offen offset:0 sc1
 s_mov_b64 exec, -1
 v_smfmac_f32_16x16x64_bf16 v[44:47], v[24:27], a[232:239], v0
 ds_read_b128 v[24:27], v1 offset:7168
 s_waitcnt lgkmcnt(7)
 v_smfmac_f32_16x16x64_bf16 v[40:43], v[28:31], a[240:247], v0
 v_smfmac_f32_16x16x64_bf16 v[44:47], v[28:31], a[248:255], v0
 s_waitcnt lgkmcnt(6)
 v_smfmac_f32_16x16x64_bf16 v[40:43], v[52:55], v[64:71], v0
 v_smfmac_f32_16x16x64_bf16 v[44:47], v[52:55], v[72:79], v0
 s_waitcnt lgkmcnt(0)
 v_smfmac_f32_16x16x64_bf16 v[40:43], v[24:27], v[80:87], v0
 v_smfmac_f32_16x16x64_bf16 v[44:47], v[24:27], v[88:95], v0
 v_pk_add_f32 v[8:9], v[8:9], v[56:57]
 v_pk_add_f32 v[10:11], v[10:11], v[58:59]
 v_pk_add_f32 v[60:61], v[60:61], v[16:17]
 v_pk_add_f32 v[62:63], v[62:63], v[18:19]
 v_pk_add_f32 v[12:13], v[12:13], v[14:15]
 v_pk_add_f32 v[48:49], v[48:49], v[50:51]
 v_pk_add_f32 v[8:9], v[8:9], v[60:61]
 v_pk_add_f32 v[10:11], v[10:11], v[62:63]
 v_pk_add_f32 v[48:49], v[12:13], v[48:49]
 v_max3_f32 v50, v8, v9, v10
 v_max3_f32 v50, v50, v11, v48
 v_max_f32 v50, v50, v49
 v_add_f32 v40, v40, v42
 v_add_f32 v41, v41, v43
 v_max_f32_dpp v50, v50, v50 quad_perm:[2,3,0,1] row_mask:0xf bank_mask:0xf
 v_mov_b32 v51, v50
 v_add_f32 v44, v44, v46
 v_add_f32 v45, v45, v47
 v_permlane16_swap_b32 v50, v51
 v_max_f32 v50, v50, v51
 v_mov_b32 v51, v50
 v_cvt_pk_bf16_f32 v40, v40, v41
 v_cvt_pk_bf16_f32 v41, v44, v45
 v_permlane32_swap_b32 v50, v51
 v_max_f32 v50, v50, v51
 v_mul_f32 v50, s56, v50
 v_fma_f32 v48, v48, s56, -v50
 v_fma_f32 v49, v49, s56, -v50
 v_fma_f32 v8, v8, s56, -v50
 v_fma_f32 v9, v9, s56, -v50
 v_fma_f32 v10, v10, s56, -v50
 v_fma_f32 v11, v11, s56, -v50
 v_exp_f32 v48, v48
 v_lshrrev_b32 v51, 1, v1
 v_exp_f32 v49, v49
 ds_read_b128 v[56:59], v3 offset:18432
 ds_read_b128 v[60:63], v3 offset:19456
 v_exp_f32 v8, v8
 v_exp_f32 v9, v9
 ds_read_b128 v[24:27], v2 offset:36864
 ds_read_b128 v[28:31], v2 offset:37888
 v_exp_f32 v10, v10
 buffer_store_dwordx2 v[40:41], v51, s[4:7], s62 offen offset:2048 sc1
 v_exp_f32 v11, v11
 v_cvt_pk_bf16_f32 v14, v48, v49
 v_cvt_pk_bf16_f32 v12, v8, v9
 v_cvt_pk_bf16_f32 v13, v10, v11
 v_cndmask_b32 v52, 0, v14, s[68:69]
 v_cndmask_b32 v53, 0, v14, s[70:71]
 v_cndmask_b32 v22, 0, v12, s[70:71]
 v_cndmask_b32 v23, 0, v13, s[70:71]
 v_mfma_f32_16x16x16_bf16 v[44:47], v[40:41], v[52:53], 0
 v_cndmask_b32 v16, 0, v12, s[68:69]
 v_cndmask_b32 v17, 0, v13, s[68:69]
 v_mov_b32_dpp v18, v22 quad_perm:[2,3,0,1] row_mask:0xf bank_mask:0xf
 v_mov_b32_dpp v19, v23 quad_perm:[2,3,0,1] row_mask:0xf bank_mask:0xf
 v_mov_b32_dpp v20, v16 quad_perm:[2,3,0,1] row_mask:0xf bank_mask:0xf
 v_mov_b32_dpp v21, v17 quad_perm:[2,3,0,1] row_mask:0xf bank_mask:0xf
 s_waitcnt vmcnt(3)
 v_mfma_f32_16x16x32_bf16 v[44:47], v[32:35], v[16:19], v[44:47]
 v_add_f32 v54, v8, v9
 v_add_f32 v55, v48, v49
 s_waitcnt vmcnt(2)
 v_mfma_f32_16x16x32_bf16 v[44:47], v[36:39], v[20:23], v[44:47]
 v_add_f32 v54, v54, v10
 v_fma_f32 v55, v55, 0.5, v11
 v_add_f32 v54, v54, v55
 ds_read_b128 v[16:19], v3 offset:49152
 ds_read_b128 v[20:23], v3 offset:49152
 v_add_f32_dpp v54, v54, v54 quad_perm:[2,3,0,1] row_mask:0xf bank_mask:0xf
 v_mov_b32 v55, v54
 ds_read_b128 v[32:35], v3 offset:49152
 ds_read_b128 v[36:39], v3 offset:49152
 v_permlane16_swap_b32 v54, v55
 v_add_f32 v54, v54, v55
 v_mov_b32 v55, v54
 ds_read_b128 v[8:11], v3 offset:49152
 s_cmp_eq_u32 s54, 63
 v_permlane32_swap_b32 v54, v55
 v_add_f32 v54, v54, v55
 v_rcp_f32 v54, v54
 s_cbranch_scc1 L_ch0_end
 v_mul_f32 v44, v44, v54
 v_mul_f32 v45, v45, v54
 v_cvt_pk_bf16_f32 v42, v44, v45
 v_mul_f32 v46, v46, v54
 v_mul_f32 v47, v47, v54
 v_cvt_pk_bf16_f32 v43, v46, v47
 ds_write_b64 v6, v[42:43] offset:0
 v_and_b32 v40, -9, v6
 v_mov_b32_dpp v12, v42 quad_perm:[0,1,0,1] row_mask:0xf bank_mask:0xf
 v_mov_b32_dpp v14, v42 quad_perm:[2,3,2,3] row_mask:0xf bank_mask:0xf
 v_mov_b32_dpp v13, v43 quad_perm:[0,1,0,1] row_mask:0xf bank_mask:0xf
 v_mov_b32_dpp v15, v43 quad_perm:[2,3,2,3] row_mask:0xf bank_mask:0xf
 s_waitcnt lgkmcnt(5)
 s_nop 0
 v_smfmac_f32_16x16x64_bf16 v[16:19], v[12:15], a[0:7], v0
 s_waitcnt lgkmcnt(4)
 v_smfmac_f32_16x16x64_bf16 v[20:23], v[12:15], a[32:39], v0
 s_waitcnt lgkmcnt(0)
 s_barrier
 ds_read_b128 v[48:51], v40 offset:512
 ds_read_b128 v[52:55], v40 offset:1024
 ds_read_b128 v[44:47], v40 offset:1536
 v_smfmac_f32_16x16x64_bf16 v[32:35], v[12:15], v[56:63], v0
 ds_read_b128 v[56:59], v3 offset:22528
 ds_read_b128 v[60:63], v3 offset:23552
 s_mov_b32 m0, 8192
 v_smfmac_f32_16x16x64_bf16 v[36:39], v[12:15], v[24:31], v0
 ds_read_b128 v[24:27], v3 offset:20480
 ds_read_b128 v[28:31], v3 offset:21504
 buffer_load_dwordx4 v1, s[4:7], s63 offen offset:2048 lds
 v_smfmac_f32_16x16x64_bf16 v[8:11], v[12:15], a[128:135], v0
 s_mov_b32 m0, 8192
 s_waitcnt lgkmcnt(6)
 v_smfmac_f32_16x16x64_bf16 v[16:19], v[48:51], a[8:15], v0
 buffer_load_dwordx4 v1, s[4:7], s63 offen offset:3072 lds
 s_waitcnt lgkmcnt(5)
 v_smfmac_f32_16x16x64_bf16 v[16:19], v[52:55], a[16:23], v0
 s_mov_b32 m0, 14336
 s_waitcnt lgkmcnt(2)
 v_smfmac_f32_16x16x64_bf16 v[16:19], v[44:47], v[56:63], v0
 ds_read_b128 v[56:59], v3 offset:16384
 ds_read_b128 v[60:63], v3 offset:17408
 buffer_load_dwordx4 v1, s[4:7], s81 offen offset:0 lds
 s_waitcnt lgkmcnt(2)
 v_smfmac_f32_16x16x64_bf16 v[20:23], v[48:51], v[24:31], v0
 ds_read_b128 v[24:27], v2 offset:38912
 ds_read_b128 v[28:31], v2 offset:39936
 s_mov_b32 m0, 14336
 v_smfmac_f32_16x16x64_bf16 v[20:23], v[52:55], a[48:55], v0
 buffer_load_dwordx4 v1, s[4:7], s81 offen offset:1024 lds
 v_smfmac_f32_16x16x64_bf16 v[20:23], v[44:47], a[56:63], v0
 v_cvt_pk_bf16_f32 v16, v16, v17
 v_smfmac_f32_16x16x64_bf16 v[32:35], v[48:51], a[72:79], v0
 v_cvt_pk_bf16_f32 v17, v18, v19
 s_waitcnt lgkmcnt(2)
 v_smfmac_f32_16x16x64_bf16 v[32:35], v[52:55], v[56:63], v0
 ds_read_b128 v[56:59], v2 offset:34816
 ds_read_b128 v[60:63], v2 offset:35840
 v_and_or_b32 v16, v16, -2, s55
 s_waitcnt lgkmcnt(2)
 v_smfmac_f32_16x16x64_bf16 v[32:35], v[44:47], v[24:31], v0
 ds_read_b128 v[24:27], v2 offset:32768
 ds_read_b128 v[28:31], v2 offset:33792
 v_cvt_pk_bf16_f32 v18, v20, v21
 v_smfmac_f32_16x16x64_bf16 v[36:39], v[48:51], a[104:111], v0
 v_cvt_pk_bf16_f32 v19, v22, v23
 v_smfmac_f32_16x16x64_bf16 v[36:39], v[52:55], a[112:119], v0
 v_and_or_b32 v18, v18, -2, s55
 buffer_store_dwordx4 v[16:19], v1, s[4:7], s60 offen offset:0 sc1
 v_smfmac_f32_16x16x64_bf16 v[36:39], v[44:47], a[120:127], v0
 v_cvt_pk_bf16_f32 v32, v32, v33
 s_waitcnt lgkmcnt(2)
 v_smfmac_f32_16x16x64_bf16 v[8:11], v[48:51], v[56:63], v0
 v_cvt_pk_bf16_f32 v33, v34, v35
 s_waitcnt lgkmcnt(0)
 v_smfmac_f32_16x16x64_bf16 v[8:11], v[52:55], v[24:31], v0
 v_and_or_b32 v32, v32, -2, s55
 v_smfmac_f32_16x16x64_bf16 v[8:11], v[44:47], a[152:159], v0
 v_cvt_pk_bf16_f32 v34, v36, v37
 v_cvt_pk_bf16_f32 v35, v38, v39
 v_and_or_b32 v34, v34, -2, s55
 buffer_store_dwordx4 v[32:35], v1, s[4:7], s60 offen offset:1024 sc1
 s_nop 3
 v_cvt_pk_bf16_f32 v8, v8, v9
 v_cvt_pk_bf16_f32 v9, v10, v11
 v_and_or_b32 v8, v8, -2, s55
 buffer_store_dwordx2 v[8:9], v1, s[4:7], s16 offen offset:0 sc1
 buffer_load_dwordx4 v[32:35], v1, s[4:7], s63 offen offset:0
 buffer_load_dwordx4 v[36:39], v1, s[4:7], s63 offen offset:1024
 s_add_u32 s54, s54, 1
 s_add_u32 s61, s61, 524288
 s_and_b32 s3, s54, 7
 s_cselect_b32 s3, 1, -7
 s_lshl_b32 s3, s3, 17
 s_add_u32 s62, s62, s3
 s_and_b32 s3, s54, 3
 s_cselect_b32 s3, 1, -3
 s_lshl_b32 s3, s3, 14
 s_add_u32 s57, s57, s3
 s_add_u32 s59, s59, s3
 s_xor_b32 s58, s57, 32768
 v_lshrrev_b32 v56, 7, v1
 v_mul_u32_u24 v56, 10240, v56
 v_and_b32 v60, 112, v1
 v_add_u32 v56, v56, v60
 v_and_b32 v57, 32, v1
 v_and_b32 v60, 64, v1
 v_lshl_add_u32 v57, v60, 2, v57
 v_bfe_u32 v60, v1, 8, 1
 v_lshl_add_u32 v57, v60, 4, v57
 v_bfe_u32 v60, v1, 4, 1
 v_lshl_add_u32 v57, v60, 3, v57
 v_mov_b32 v60, 0x3f80
 v_mov_b32 v28, 0x3f800000
 v_cndmask_b32 v60, v60, v28, s[82:83]
 v_cndmask_b32 v28, 0, v60, s[72:73]
 v_cndmask_b32 v29, 0, v60, s[74:75]
 v_cndmask_b32 v30, 0, v60, s[76:77]
 v_cndmask_b32 v31, 0, v60, s[78:79]
 v_mov_b64 v[58:59], -1
 s_mov_b64 exec, s[84:85]
 buffer_store_dwordx2 v[58:59], v57, s[4:7], s58 offen sc1
 s_mov_b64 exec, -1
 s_nop 15
 s_nop 15
 s_nop 15
 s_nop 15
 s_nop 15
 s_mov_b32 s51, 0
 buffer_load_dwordx4 v[8:11], v56, s[4:7], s64 offen sc1
 buffer_load_dwordx4 v[12:15], v56, s[4:7], s65 offen sc1
 buffer_load_dwordx4 v[16:19], v56, s[4:7], s66 offen sc1
 buffer_load_dwordx4 v[20:23], v56, s[4:7], s67 offen sc1
L_pp_171:
 s_waitcnt vmcnt(3)
 v_mfma_f32_16x16x32_bf16 v[24:27], v[28:31], v[8:11], 0
 v_bitop3_b32 v60, v8, v10, s55 bitop3:0x7e
 s_waitcnt vmcnt(2)
 v_mfma_f32_16x16x32_bf16 v[24:27], v[28:31], v[12:15], v[24:27]
 v_bitop3_b32 v61, v12, v14, s55 bitop3:0x7e
 s_waitcnt vmcnt(1)
 v_mfma_f32_16x16x32_bf16 v[24:27], v[28:31], v[16:19], v[24:27]
 v_bitop3_b32 v62, v16, v18, s55 bitop3:0x7e
 s_waitcnt vmcnt(0)
 v_mfma_f32_16x16x32_bf16 v[24:27], v[28:31], v[20:23], v[24:27]
 v_bitop3_b32 v63, v20, v22, s55 bitop3:0x7e
 v_or3_b32 v7, v60, v61, v62
 v_bitop3_b32 v7, v7, v63, 1 bitop3:0xa8
 v_cmp_ne_u32 vcc, 0, v7
 s_cbranch_vccnz L_rt_172
 s_nop 2
 v_add_f32_dpp v24, v24, v24 row_ror:8 row_mask:0xf bank_mask:0xf
 v_add_f32_dpp v25, v25, v25 row_ror:8 row_mask:0xf bank_mask:0xf
 v_add_f32_dpp v26, v26, v26 row_ror:8 row_mask:0xf bank_mask:0xf
 v_add_f32_dpp v27, v27, v27 row_ror:8 row_mask:0xf bank_mask:0xf
 s_mov_b64 exec, s[84:85]
 v_cvt_pk_bf16_f32 v24, v24, v25
 v_cvt_pk_bf16_f32 v25, v26, v27
 buffer_store_dwordx2 v[24:25], v57, s[4:7], s57 offen sc1
 s_mov_b64 exec, -1
 s_xor_b32 s55, s55, 1
 ds_read_b128 v[40:43], v1 offset:10240
 ds_read_b128 v[44:47], v1 offset:11264
 ds_read_b128 v[48:51], v1 offset:14336
 ds_read_b128 v[52:55], v1 offset:15360
 buffer_load_dwordx4 v[56:59], v1, s[4:7], s81 offen offset:2048
 buffer_load_dwordx4 v[60:63], v1, s[4:7], s81 offen offset:3072
 ds_read_b128 v[8:11], v3 offset:49152
 ds_read_b128 v[12:15], v3 offset:49152
 ds_read_b128 v[16:19], v3 offset:49152
 ds_read_b128 v[20:23], v3 offset:49152
 s_waitcnt lgkmcnt(0)
 s_nop 15
 s_nop 15
 s_nop 7
 s_branch L_ch0_s
L_rt_170:
 s_add_u32 s51, s51, 1
 s_cmp_lt_u32 s51, 131072
 s_cbranch_scc1 L_pm_169
 s_branch L_bail
L_rt_172:
 buffer_load_dwordx4 v[8:11], v56, s[4:7], s64 offen sc1
 buffer_load_dwordx4 v[12:15], v56, s[4:7], s65 offen sc1
 buffer_load_dwordx4 v[16:19], v56, s[4:7], s66 offen sc1
 buffer_load_dwordx4 v[20:23], v56, s[4:7], s67 offen sc1
 s_add_u32 s51, s51, 1
 s_cmp_lt_u32 s51, 131072
 s_cbranch_scc1 L_pp_171
 s_branch L_bail
L_ch0_end:
 s_waitcnt vmcnt(0)
 s_endpgm
L_ch1:
 v_lshrrev_b32 v8, 4, v0
 s_mov_b32 s3, 1280
 v_mul_lo_u32 v8, v8, s3
 v_lshrrev_b32 v7, 3, v0
 v_and_b32 v7, 6, v7
 v_xor_b32 v7, v7, v0
 v_and_b32 v7, 15, v7
 v_lshl_add_u32 v8, v7, 4, v8
 v_xor_b32 v9, 128, v8
 v_lshrrev_b32 v10, 4, v0
 s_mov_b32 s3, 8192
 v_mul_lo_u32 v10, v10, s3
 v_lshrrev_b32 v7, 3, v0
 v_and_b32 v7, 6, v7
 v_xor_b32 v7, v7, v0
 v_and_b32 v7, 15, v7
 v_lshl_add_u32 v10, v7, 4, v10
 v_xor_b32 v11, 128, v10
 s_mov_b32 s8, s26
 s_and_b32 s9, s27, 0xffff
 s_mov_b32 s10, 5242880
 s_mul_i32 s14, s52, 163840
 s_add_u32 s14, s14, 40960
 s_mov_b32 m0, 8192
 s_nop 0
 buffer_load_dwordx4 v8, s[8:11], s14 offen lds
 s_add_u32 s14, s14, 5120
 s_mov_b32 m0, 9216
 s_nop 0
 buffer_load_dwordx4 v8, s[8:11], s14 offen lds
 s_add_u32 s14, s14, 5120
 s_mov_b32 m0, 10240
 s_nop 0
 buffer_load_dwordx4 v8, s[8:11], s14 offen lds
 s_add_u32 s14, s14, 5120
 s_mov_b32 m0, 11264
 s_nop 0
 buffer_load_dwordx4 v8, s[8:11], s14 offen lds
 s_add_u32 s14, s14, 5120
 s_mov_b32 m0, 12288
 s_nop 0
 buffer_load_dwordx4 v9, s[8:11], s14 offen lds
 s_add_u32 s14, s14, 5120
 s_mov_b32 m0, 13312
 s_nop 0
 buffer_load_dwordx4 v9, s[8:11], s14 offen lds
 s_add_u32 s14, s14, 5120
 s_mov_b32 m0, 14336
 s_nop 0
 buffer_load_dwordx4 v9, s[8:11], s14 offen lds
 s_add_u32 s14, s14, 5120
 s_mov_b32 m0, 15360
 s_nop 0
 buffer_load_dwordx4 v9, s[8:11], s14 offen lds
 s_mul_i32 s14, s52, 163840
 s_add_u32 s14, s14, 41216
 s_mov_b32 m0, 40960
 s_nop 0
 buffer_load_dwordx4 v8, s[8:11], s14 offen lds
 s_add_u32 s14, s14, 5120
 s_mov_b32 m0, 41984
 s_nop 0
 buffer_load_dwordx4 v8, s[8:11], s14 offen lds
 s_add_u32 s14, s14, 5120
 s_mov_b32 m0, 43008
 s_nop 0
 buffer_load_dwordx4 v8, s[8:11], s14 offen lds
 s_add_u32 s14, s14, 5120
 s_mov_b32 m0, 44032
 s_nop 0
 buffer_load_dwordx4 v8, s[8:11], s14 offen lds
 s_add_u32 s14, s14, 5120
 s_mov_b32 m0, 45056
 s_nop 0
 buffer_load_dwordx4 v9, s[8:11], s14 offen lds
 s_add_u32 s14, s14, 5120
 s_mov_b32 m0, 46080
 s_nop 0
 buffer_load_dwordx4 v9, s[8:11], s14 offen lds
 s_add_u32 s14, s14, 5120
 s_mov_b32 m0, 47104
 s_nop 0
 buffer_load_dwordx4 v9, s[8:11], s14 offen lds
 s_add_u32 s14, s14, 5120
 s_mov_b32 m0, 48128
 s_nop 0
 buffer_load_dwordx4 v9, s[8:11], s14 offen lds
 s_mul_i32 s14, s52, 163840
 s_add_u32 s14, s14, 41472
 s_mov_b32 m0, 73728
 s_nop 0
 buffer_load_dwordx4 v8, s[8:11], s14 offen lds
 s_add_u32 s14, s14, 5120
 s_mov_b32 m0, 74752
 s_nop 0
 buffer_load_dwordx4 v8, s[8:11], s14 offen lds
 s_add_u32 s14, s14, 5120
 s_mov_b32 m0, 75776
 s_nop 0
 buffer_load_dwordx4 v8, s[8:11], s14 offen lds
 s_add_u32 s14, s14, 5120
 s_mov_b32 m0, 76800
 s_nop 0
 buffer_load_dwordx4 v8, s[8:11], s14 offen lds
 s_add_u32 s14, s14, 5120
 s_mov_b32 m0, 77824
 s_nop 0
 buffer_load_dwordx4 v9, s[8:11], s14 offen lds
 s_add_u32 s14, s14, 5120
 s_mov_b32 m0, 78848
 s_nop 0
 buffer_load_dwordx4 v9, s[8:11], s14 offen lds
 s_add_u32 s14, s14, 5120
 s_mov_b32 m0, 79872
 s_nop 0
 buffer_load_dwordx4 v9, s[8:11], s14 offen lds
 s_add_u32 s14, s14, 5120
 s_mov_b32 m0, 80896
 s_nop 0
 buffer_load_dwordx4 v9, s[8:11], s14 offen lds
 s_mul_i32 s14, s52, 163840
 s_add_u32 s14, s14, 41728
 s_mov_b32 m0, 106496
 s_nop 0
 buffer_load_dwordx4 v8, s[8:11], s14 offen lds
 s_add_u32 s14, s14, 5120
 s_mov_b32 m0, 107520
 s_nop 0
 buffer_load_dwordx4 v8, s[8:11], s14 offen lds
 s_add_u32 s14, s14, 5120
 s_mov_b32 m0, 108544
 s_nop 0
 buffer_load_dwordx4 v8, s[8:11], s14 offen lds
 s_add_u32 s14, s14, 5120
 s_mov_b32 m0, 109568
 s_nop 0
 buffer_load_dwordx4 v8, s[8:11], s14 offen lds
 s_add_u32 s14, s14, 5120
 s_mov_b32 m0, 110592
 s_nop 0
 buffer_load_dwordx4 v9, s[8:11], s14 offen lds
 s_add_u32 s14, s14, 5120
 s_mov_b32 m0, 111616
 s_nop 0
 buffer_load_dwordx4 v9, s[8:11], s14 offen lds
 s_add_u32 s14, s14, 5120
 s_mov_b32 m0, 112640
 s_nop 0
 buffer_load_dwordx4 v9, s[8:11], s14 offen lds
 s_add_u32 s14, s14, 5120
 s_mov_b32 m0, 113664
 s_nop 0
 buffer_load_dwordx4 v9, s[8:11], s14 offen lds
 s_mul_i32 s14, s52, 163840
 s_add_u32 s14, s14, 41984
 s_mov_b32 m0, 139264
 s_nop 0
 buffer_load_dwordx4 v8, s[8:11], s14 offen lds
 s_add_u32 s14, s14, 5120
 s_mov_b32 m0, 140288
 s_nop 0
 buffer_load_dwordx4 v8, s[8:11], s14 offen lds
 s_add_u32 s14, s14, 5120
 s_mov_b32 m0, 141312
 s_nop 0
 buffer_load_dwordx4 v8, s[8:11], s14 offen lds
 s_add_u32 s14, s14, 5120
 s_mov_b32 m0, 142336
 s_nop 0
 buffer_load_dwordx4 v8, s[8:11], s14 offen lds
 s_add_u32 s14, s14, 5120
 s_mov_b32 m0, 143360
 s_nop 0
 buffer_load_dwordx4 v9, s[8:11], s14 offen lds
 s_add_u32 s14, s14, 5120
 s_mov_b32 m0, 144384
 s_nop 0
 buffer_load_dwordx4 v9, s[8:11], s14 offen lds
 s_add_u32 s14, s14, 5120
 s_mov_b32 m0, 145408
 s_nop 0
 buffer_load_dwordx4 v9, s[8:11], s14 offen lds
 s_add_u32 s14, s14, 5120
 s_mov_b32 m0, 146432
 s_nop 0
 buffer_load_dwordx4 v9, s[8:11], s14 offen lds
 v_lshrrev_b32 v20, 4, v0
 v_bfe_u32 v21, v0, 2, 1
 v_bfe_u32 v22, v0, 3, 1
 v_and_b32 v23, 1, v20
 v_lshrrev_b32 v24, 1, v20
 v_and_b32 v25, 3, v0
 v_lshlrev_b32 v25, 3, v25
 v_lshl_add_u32 v26, v22, 1, v23
 v_lshl_add_u32 v27, v21, 2, v26
 v_lshl_add_u32 v26, v24, 2, v26
 v_lshl_add_u32 v26, v21, 4, v26
 v_xor_b32 v27, 2, v27
 v_lshl_add_u32 v27, v27, 5, v25
 v_lshl_add_u32 v12, v26, 8, v27
 v_lshl_add_u32 v26, v24, 2, v21
 v_lshl_add_u32 v26, v23, 4, v26
 v_lshl_add_u32 v27, v23, 2, v21
 v_lshl_add_u32 v27, v22, 1, v27
 v_lshl_add_u32 v27, v27, 5, v25
 v_lshl_add_u32 v14, v26, 8, v27
 v_lshlrev_b32 v1, 4, v0
 v_add_u32 v2, 65536, v1
 v_add_u32 v3, 114688, v1
 s_waitcnt vmcnt(32)
 s_barrier
 s_waitcnt lgkmcnt(0)
 s_barrier
 s_mov_b32 s8, s24
 s_and_b32 s9, s25, 0xffff
 s_mov_b32 s10, 5242880
 s_lshl_b32 s14, s52, 8
 s_add_u32 s14, s14, 262144
 s_mov_b32 m0, 8192
 s_nop 0
 buffer_load_dwordx4 v10, s[8:11], s14 offen lds
 s_add_u32 s14, s14, 32768
 s_mov_b32 m0, 9216
 s_nop 0
 buffer_load_dwordx4 v10, s[8:11], s14 offen lds
 s_add_u32 s14, s14, 32768
 s_mov_b32 m0, 10240
 s_nop 0
 buffer_load_dwordx4 v10, s[8:11], s14 offen lds
 s_add_u32 s14, s14, 32768
 s_mov_b32 m0, 11264
 s_nop 0
 buffer_load_dwordx4 v10, s[8:11], s14 offen lds
 s_add_u32 s14, s14, 32768
 s_mov_b32 m0, 12288
 s_nop 0
 buffer_load_dwordx4 v11, s[8:11], s14 offen lds
 s_add_u32 s14, s14, 32768
 s_mov_b32 m0, 13312
 s_nop 0
 buffer_load_dwordx4 v11, s[8:11], s14 offen lds
 s_add_u32 s14, s14, 32768
 s_mov_b32 m0, 14336
 s_nop 0
 buffer_load_dwordx4 v11, s[8:11], s14 offen lds
 s_add_u32 s14, s14, 32768
 s_mov_b32 m0, 15360
 s_nop 0
 buffer_load_dwordx4 v11, s[8:11], s14 offen lds
 s_waitcnt vmcnt(32)
 s_barrier
 v_xor_b32 v16, 0, v14
 v_add_u32 v16, 32768, v16
 v_xor_b32 v17, 64, v16
 ds_read_b64_tr_b16 a[0:1], v16 offset:0
 ds_read_b64_tr_b16 a[2:3], v17 offset:512
 ds_read_b64_tr_b16 a[4:5], v16 offset:2048
 ds_read_b64_tr_b16 a[6:7], v17 offset:2560
 v_xor_b32 v16, 0, v14
 v_add_u32 v16, 32768, v16
 v_xor_b32 v17, 64, v16
 ds_read_b64_tr_b16 a[8:9], v16 offset:8192
 ds_read_b64_tr_b16 a[10:11], v17 offset:8704
 ds_read_b64_tr_b16 a[12:13], v16 offset:10240
 ds_read_b64_tr_b16 a[14:15], v17 offset:10752
 v_xor_b32 v16, 0, v14
 v_add_u32 v16, 32768, v16
 v_xor_b32 v17, 64, v16
 ds_read_b64_tr_b16 a[16:17], v16 offset:16384
 ds_read_b64_tr_b16 a[18:19], v17 offset:16896
 ds_read_b64_tr_b16 a[20:21], v16 offset:18432
 ds_read_b64_tr_b16 a[22:23], v17 offset:18944
 v_xor_b32 v16, 0, v14
 v_add_u32 v16, 32768, v16
 v_xor_b32 v17, 64, v16
 ds_read_b64_tr_b16 a[24:25], v16 offset:24576
 ds_read_b64_tr_b16 a[26:27], v17 offset:25088
 ds_read_b64_tr_b16 a[28:29], v16 offset:26624
 ds_read_b64_tr_b16 a[30:31], v17 offset:27136
 v_xor_b32 v16, 32, v14
 v_add_u32 v16, 32768, v16
 v_xor_b32 v17, 64, v16
 ds_read_b64_tr_b16 a[32:33], v16 offset:0
 ds_read_b64_tr_b16 a[34:35], v17 offset:512
 ds_read_b64_tr_b16 a[36:37], v16 offset:2048
 ds_read_b64_tr_b16 a[38:39], v17 offset:2560
 v_xor_b32 v16, 32, v14
 v_add_u32 v16, 32768, v16
 v_xor_b32 v17, 64, v16
 ds_read_b64_tr_b16 a[40:41], v16 offset:8192
 ds_read_b64_tr_b16 a[42:43], v17 offset:8704
 ds_read_b64_tr_b16 a[44:45], v16 offset:10240
 ds_read_b64_tr_b16 a[46:47], v17 offset:10752
 v_xor_b32 v16, 32, v14
 v_add_u32 v16, 32768, v16
 v_xor_b32 v17, 64, v16
 ds_read_b64_tr_b16 a[48:49], v16 offset:16384
 ds_read_b64_tr_b16 a[50:51], v17 offset:16896
 ds_read_b64_tr_b16 a[52:53], v16 offset:18432
 ds_read_b64_tr_b16 a[54:55], v17 offset:18944
 v_xor_b32 v16, 32, v14
 v_add_u32 v16, 32768, v16
 v_xor_b32 v17, 64, v16
 ds_read_b64_tr_b16 a[56:57], v16 offset:24576
 ds_read_b64_tr_b16 a[58:59], v17 offset:25088
 ds_read_b64_tr_b16 a[60:61], v16 offset:26624
 ds_read_b64_tr_b16 a[62:63], v17 offset:27136
 v_xor_b32 v16, 128, v14
 v_add_u32 v16, 32768, v16
 v_xor_b32 v17, 64, v16
 ds_read_b64_tr_b16 a[64:65], v16 offset:0
 ds_read_b64_tr_b16 a[66:67], v17 offset:512
 ds_read_b64_tr_b16 a[68:69], v16 offset:2048
 ds_read_b64_tr_b16 a[70:71], v17 offset:2560
 v_xor_b32 v16, 128, v14
 v_add_u32 v16, 32768, v16
 v_xor_b32 v17, 64, v16
 ds_read_b64_tr_b16 a[72:73], v16 offset:8192
 ds_read_b64_tr_b16 a[74:75], v17 offset:8704
 ds_read_b64_tr_b16 a[76:77], v16 offset:10240
 ds_read_b64_tr_b16 a[78:79], v17 offset:10752
 v_xor_b32 v16, 128, v14
 v_add_u32 v16, 32768, v16
 v_xor_b32 v17, 64, v16
 ds_read_b64_tr_b16 a[80:81], v16 offset:16384
 ds_read_b64_tr_b16 a[82:83], v17 offset:16896
 ds_read_b64_tr_b16 a[84:85], v16 offset:18432
 ds_read_b64_tr_b16 a[86:87], v17 offset:18944
 v_xor_b32 v16, 128, v14
 v_add_u32 v16, 32768, v16
 v_xor_b32 v17, 64, v16
 ds_read_b64_tr_b16 a[88:89], v16 offset:24576
 ds_read_b64_tr_b16 a[90:91], v17 offset:25088
 ds_read_b64_tr_b16 a[92:93], v16 offset:26624
 ds_read_b64_tr_b16 a[94:95], v17 offset:27136
 v_xor_b32 v16, 160, v14
 v_add_u32 v16, 32768, v16
 v_xor_b32 v17, 64, v16
 ds_read_b64_tr_b16 a[96:97], v16 offset:0
 ds_read_b64_tr_b16 a[98:99], v17 offset:512
 ds_read_b64_tr_b16 a[100:101], v16 offset:2048
 ds_read_b64_tr_b16 a[102:103], v17 offset:2560
 v_xor_b32 v16, 160, v14
 v_add_u32 v16, 32768, v16
 v_xor_b32 v17, 64, v16
 ds_read_b64_tr_b16 a[104:105], v16 offset:8192
 ds_read_b64_tr_b16 a[106:107], v17 offset:8704
 ds_read_b64_tr_b16 a[108:109], v16 offset:10240
 ds_read_b64_tr_b16 a[110:111], v17 offset:10752
 v_xor_b32 v16, 160, v14
 v_add_u32 v16, 32768, v16
 v_xor_b32 v17, 64, v16
 ds_read_b64_tr_b16 a[112:113], v16 offset:16384
 ds_read_b64_tr_b16 a[114:115], v17 offset:16896
 ds_read_b64_tr_b16 a[116:117], v16 offset:18432
 ds_read_b64_tr_b16 a[118:119], v17 offset:18944
 v_xor_b32 v16, 160, v14
 v_add_u32 v16, 32768, v16
 v_xor_b32 v17, 64, v16
 ds_read_b64_tr_b16 a[120:121], v16 offset:24576
 ds_read_b64_tr_b16 a[122:123], v17 offset:25088
 ds_read_b64_tr_b16 a[124:125], v16 offset:26624
 ds_read_b64_tr_b16 a[126:127], v17 offset:27136
 s_waitcnt lgkmcnt(0)
 s_barrier
 s_lshl_b32 s14, s52, 8
 s_add_u32 s14, s14, 1310720
 s_mov_b32 m0, 40960
 s_nop 0
 buffer_load_dwordx4 v10, s[8:11], s14 offen lds
 s_add_u32 s14, s14, 32768
 s_mov_b32 m0, 41984
 s_nop 0
 buffer_load_dwordx4 v10, s[8:11], s14 offen lds
 s_add_u32 s14, s14, 32768
 s_mov_b32 m0, 43008
 s_nop 0
 buffer_load_dwordx4 v10, s[8:11], s14 offen lds
 s_add_u32 s14, s14, 32768
 s_mov_b32 m0, 44032
 s_nop 0
 buffer_load_dwordx4 v10, s[8:11], s14 offen lds
 s_add_u32 s14, s14, 32768
 s_mov_b32 m0, 45056
 s_nop 0
 buffer_load_dwordx4 v11, s[8:11], s14 offen lds
 s_add_u32 s14, s14, 32768
 s_mov_b32 m0, 46080
 s_nop 0
 buffer_load_dwordx4 v11, s[8:11], s14 offen lds
 s_add_u32 s14, s14, 32768
 s_mov_b32 m0, 47104
 s_nop 0
 buffer_load_dwordx4 v11, s[8:11], s14 offen lds
 s_add_u32 s14, s14, 32768
 s_mov_b32 m0, 48128
 s_nop 0
 buffer_load_dwordx4 v11, s[8:11], s14 offen lds
 s_waitcnt vmcnt(32)
 s_barrier
 s_waitcnt lgkmcnt(0)
 s_barrier
 s_lshl_b32 s14, s52, 8
 s_add_u32 s14, s14, 2359296
 s_mov_b32 m0, 73728
 s_nop 0
 buffer_load_dwordx4 v10, s[8:11], s14 offen lds
 s_add_u32 s14, s14, 32768
 s_mov_b32 m0, 74752
 s_nop 0
 buffer_load_dwordx4 v10, s[8:11], s14 offen lds
 s_add_u32 s14, s14, 32768
 s_mov_b32 m0, 75776
 s_nop 0
 buffer_load_dwordx4 v10, s[8:11], s14 offen lds
 s_add_u32 s14, s14, 32768
 s_mov_b32 m0, 76800
 s_nop 0
 buffer_load_dwordx4 v10, s[8:11], s14 offen lds
 s_add_u32 s14, s14, 32768
 s_mov_b32 m0, 77824
 s_nop 0
 buffer_load_dwordx4 v11, s[8:11], s14 offen lds
 s_add_u32 s14, s14, 32768
 s_mov_b32 m0, 78848
 s_nop 0
 buffer_load_dwordx4 v11, s[8:11], s14 offen lds
 s_add_u32 s14, s14, 32768
 s_mov_b32 m0, 79872
 s_nop 0
 buffer_load_dwordx4 v11, s[8:11], s14 offen lds
 s_add_u32 s14, s14, 32768
 s_mov_b32 m0, 80896
 s_nop 0
 buffer_load_dwordx4 v11, s[8:11], s14 offen lds
 s_waitcnt vmcnt(32)
 s_barrier
 s_waitcnt lgkmcnt(0)
 s_barrier
 s_lshl_b32 s14, s52, 8
 s_add_u32 s14, s14, 3407872
 s_mov_b32 m0, 106496
 s_nop 0
 buffer_load_dwordx4 v10, s[8:11], s14 offen lds
 s_add_u32 s14, s14, 32768
 s_mov_b32 m0, 107520
 s_nop 0
 buffer_load_dwordx4 v10, s[8:11], s14 offen lds
 s_add_u32 s14, s14, 32768
 s_mov_b32 m0, 108544
 s_nop 0
 buffer_load_dwordx4 v10, s[8:11], s14 offen lds
 s_add_u32 s14, s14, 32768
 s_mov_b32 m0, 109568
 s_nop 0
 buffer_load_dwordx4 v10, s[8:11], s14 offen lds
 s_add_u32 s14, s14, 32768
 s_mov_b32 m0, 110592
 s_nop 0
 buffer_load_dwordx4 v11, s[8:11], s14 offen lds
 s_add_u32 s14, s14, 32768
 s_mov_b32 m0, 111616
 s_nop 0
 buffer_load_dwordx4 v11, s[8:11], s14 offen lds
 s_add_u32 s14, s14, 32768
 s_mov_b32 m0, 112640
 s_nop 0
 buffer_load_dwordx4 v11, s[8:11], s14 offen lds
 s_add_u32 s14, s14, 32768
 s_mov_b32 m0, 113664
 s_nop 0
 buffer_load_dwordx4 v11, s[8:11], s14 offen lds
 s_waitcnt vmcnt(32)
 s_barrier
 v_xor_b32 v16, 32, v14
 v_add_u32 v16, 131072, v16
 v_xor_b32 v17, 64, v16
 ds_read_b64_tr_b16 a[128:129], v16 offset:0
 ds_read_b64_tr_b16 a[130:131], v17 offset:512
 ds_read_b64_tr_b16 a[132:133], v16 offset:2048
 ds_read_b64_tr_b16 a[134:135], v17 offset:2560
 v_xor_b32 v16, 32, v14
 v_add_u32 v16, 131072, v16
 v_xor_b32 v17, 64, v16
 ds_read_b64_tr_b16 a[136:137], v16 offset:8192
 ds_read_b64_tr_b16 a[138:139], v17 offset:8704
 ds_read_b64_tr_b16 a[140:141], v16 offset:10240
 ds_read_b64_tr_b16 a[142:143], v17 offset:10752
 v_xor_b32 v16, 32, v14
 v_add_u32 v16, 131072, v16
 v_xor_b32 v17, 64, v16
 ds_read_b64_tr_b16 a[144:145], v16 offset:16384
 ds_read_b64_tr_b16 a[146:147], v17 offset:16896
 ds_read_b64_tr_b16 a[148:149], v16 offset:18432
 ds_read_b64_tr_b16 a[150:151], v17 offset:18944
 v_xor_b32 v16, 32, v14
 v_add_u32 v16, 131072, v16
 v_xor_b32 v17, 64, v16
 ds_read_b64_tr_b16 a[152:153], v16 offset:24576
 ds_read_b64_tr_b16 a[154:155], v17 offset:25088
 ds_read_b64_tr_b16 a[156:157], v16 offset:26624
 ds_read_b64_tr_b16 a[158:159], v17 offset:27136
 s_waitcnt lgkmcnt(0)
 s_barrier
 s_lshl_b32 s14, s52, 8
 s_add_u32 s14, s14, 4456448
 s_mov_b32 m0, 139264
 s_nop 0
 buffer_load_dwordx4 v10, s[8:11], s14 offen lds
 s_add_u32 s14, s14, 32768
 s_mov_b32 m0, 140288
 s_nop 0
 buffer_load_dwordx4 v10, s[8:11], s14 offen lds
 s_add_u32 s14, s14, 32768
 s_mov_b32 m0, 141312
 s_nop 0
 buffer_load_dwordx4 v10, s[8:11], s14 offen lds
 s_add_u32 s14, s14, 32768
 s_mov_b32 m0, 142336
 s_nop 0
 buffer_load_dwordx4 v10, s[8:11], s14 offen lds
 s_add_u32 s14, s14, 32768
 s_mov_b32 m0, 143360
 s_nop 0
 buffer_load_dwordx4 v11, s[8:11], s14 offen lds
 s_add_u32 s14, s14, 32768
 s_mov_b32 m0, 144384
 s_nop 0
 buffer_load_dwordx4 v11, s[8:11], s14 offen lds
 s_add_u32 s14, s14, 32768
 s_mov_b32 m0, 145408
 s_nop 0
 buffer_load_dwordx4 v11, s[8:11], s14 offen lds
 s_add_u32 s14, s14, 32768
 s_mov_b32 m0, 146432
 s_nop 0
 buffer_load_dwordx4 v11, s[8:11], s14 offen lds
 s_waitcnt vmcnt(32)
 s_barrier
 v_xor_b32 v16, 0, v12
 v_add_u32 v16, 0, v16
 ds_read_b64_tr_b16 a[160:161], v16 offset:0
 ds_read_b64_tr_b16 a[162:163], v16 offset:8192
 ds_read_b64_tr_b16 a[164:165], v16 offset:2048
 ds_read_b64_tr_b16 a[166:167], v16 offset:10240
 v_xor_b32 v16, 32, v12
 v_add_u32 v16, 0, v16
 ds_read_b64_tr_b16 a[168:169], v16 offset:0
 ds_read_b64_tr_b16 a[170:171], v16 offset:8192
 ds_read_b64_tr_b16 a[172:173], v16 offset:2048
 ds_read_b64_tr_b16 a[174:175], v16 offset:10240
 v_xor_b32 v16, 0, v12
 v_add_u32 v16, 0, v16
 ds_read_b64_tr_b16 a[176:177], v16 offset:16384
 ds_read_b64_tr_b16 a[178:179], v16 offset:24576
 ds_read_b64_tr_b16 a[180:181], v16 offset:18432
 ds_read_b64_tr_b16 a[182:183], v16 offset:26624
 v_xor_b32 v16, 32, v12
 v_add_u32 v16, 0, v16
 ds_read_b64_tr_b16 a[184:185], v16 offset:16384
 ds_read_b64_tr_b16 a[186:187], v16 offset:24576
 ds_read_b64_tr_b16 a[188:189], v16 offset:18432
 ds_read_b64_tr_b16 a[190:191], v16 offset:26624
 s_waitcnt lgkmcnt(0)
 s_barrier
 s_mov_b32 s8, s22
 s_and_b32 s9, s23, 0xffff
 s_mov_b32 s10, 5242880
 s_lshl_b32 s14, s52, 8
 s_add_u32 s14, s14, 262144
 s_mov_b32 m0, 8192
 s_nop 0
 buffer_load_dwordx4 v10, s[8:11], s14 offen lds
 s_add_u32 s14, s14, 32768
 s_mov_b32 m0, 9216
 s_nop 0
 buffer_load_dwordx4 v10, s[8:11], s14 offen lds
 s_add_u32 s14, s14, 32768
 s_mov_b32 m0, 10240
 s_nop 0
 buffer_load_dwordx4 v10, s[8:11], s14 offen lds
 s_add_u32 s14, s14, 32768
 s_mov_b32 m0, 11264
 s_nop 0
 buffer_load_dwordx4 v10, s[8:11], s14 offen lds
 s_add_u32 s14, s14, 32768
 s_mov_b32 m0, 12288
 s_nop 0
 buffer_load_dwordx4 v11, s[8:11], s14 offen lds
 s_add_u32 s14, s14, 32768
 s_mov_b32 m0, 13312
 s_nop 0
 buffer_load_dwordx4 v11, s[8:11], s14 offen lds
 s_add_u32 s14, s14, 32768
 s_mov_b32 m0, 14336
 s_nop 0
 buffer_load_dwordx4 v11, s[8:11], s14 offen lds
 s_add_u32 s14, s14, 32768
 s_mov_b32 m0, 15360
 s_nop 0
 buffer_load_dwordx4 v11, s[8:11], s14 offen lds
 s_waitcnt vmcnt(32)
 s_barrier
 v_xor_b32 v16, 0, v12
 v_add_u32 v16, 32768, v16
 ds_read_b64_tr_b16 a[192:193], v16 offset:0
 ds_read_b64_tr_b16 a[194:195], v16 offset:8192
 ds_read_b64_tr_b16 a[196:197], v16 offset:2048
 ds_read_b64_tr_b16 a[198:199], v16 offset:10240
 v_xor_b32 v16, 32, v12
 v_add_u32 v16, 32768, v16
 ds_read_b64_tr_b16 a[200:201], v16 offset:0
 ds_read_b64_tr_b16 a[202:203], v16 offset:8192
 ds_read_b64_tr_b16 a[204:205], v16 offset:2048
 ds_read_b64_tr_b16 a[206:207], v16 offset:10240
 v_xor_b32 v16, 0, v12
 v_add_u32 v16, 32768, v16
 ds_read_b64_tr_b16 a[208:209], v16 offset:16384
 ds_read_b64_tr_b16 a[210:211], v16 offset:24576
 ds_read_b64_tr_b16 a[212:213], v16 offset:18432
 ds_read_b64_tr_b16 a[214:215], v16 offset:26624
 v_xor_b32 v16, 32, v12
 v_add_u32 v16, 32768, v16
 ds_read_b64_tr_b16 a[216:217], v16 offset:16384
 ds_read_b64_tr_b16 a[218:219], v16 offset:24576
 ds_read_b64_tr_b16 a[220:221], v16 offset:18432
 ds_read_b64_tr_b16 a[222:223], v16 offset:26624
 s_waitcnt lgkmcnt(0)
 s_barrier
 s_lshl_b32 s14, s52, 8
 s_add_u32 s14, s14, 1310720
 s_mov_b32 m0, 40960
 s_nop 0
 buffer_load_dwordx4 v10, s[8:11], s14 offen lds
 s_add_u32 s14, s14, 32768
 s_mov_b32 m0, 41984
 s_nop 0
 buffer_load_dwordx4 v10, s[8:11], s14 offen lds
 s_add_u32 s14, s14, 32768
 s_mov_b32 m0, 43008
 s_nop 0
 buffer_load_dwordx4 v10, s[8:11], s14 offen lds
 s_add_u32 s14, s14, 32768
 s_mov_b32 m0, 44032
 s_nop 0
 buffer_load_dwordx4 v10, s[8:11], s14 offen lds
 s_add_u32 s14, s14, 32768
 s_mov_b32 m0, 45056
 s_nop 0
 buffer_load_dwordx4 v11, s[8:11], s14 offen lds
 s_add_u32 s14, s14, 32768
 s_mov_b32 m0, 46080
 s_nop 0
 buffer_load_dwordx4 v11, s[8:11], s14 offen lds
 s_add_u32 s14, s14, 32768
 s_mov_b32 m0, 47104
 s_nop 0
 buffer_load_dwordx4 v11, s[8:11], s14 offen lds
 s_add_u32 s14, s14, 32768
 s_mov_b32 m0, 48128
 s_nop 0
 buffer_load_dwordx4 v11, s[8:11], s14 offen lds
 s_waitcnt vmcnt(32)
 s_barrier
 v_xor_b32 v16, 0, v12
 v_add_u32 v16, 65536, v16
 ds_read_b64_tr_b16 a[224:225], v16 offset:0
 ds_read_b64_tr_b16 a[226:227], v16 offset:8192
 ds_read_b64_tr_b16 a[228:229], v16 offset:2048
 ds_read_b64_tr_b16 a[230:231], v16 offset:10240
 v_xor_b32 v16, 32, v12
 v_add_u32 v16, 65536, v16
 ds_read_b64_tr_b16 a[232:233], v16 offset:0
 ds_read_b64_tr_b16 a[234:235], v16 offset:8192
 ds_read_b64_tr_b16 a[236:237], v16 offset:2048
 ds_read_b64_tr_b16 a[238:239], v16 offset:10240
 v_xor_b32 v16, 0, v12
 v_add_u32 v16, 65536, v16
 ds_read_b64_tr_b16 a[240:241], v16 offset:16384
 ds_read_b64_tr_b16 a[242:243], v16 offset:24576
 ds_read_b64_tr_b16 a[244:245], v16 offset:18432
 ds_read_b64_tr_b16 a[246:247], v16 offset:26624
 v_xor_b32 v16, 32, v12
 v_add_u32 v16, 65536, v16
 ds_read_b64_tr_b16 a[248:249], v16 offset:16384
 ds_read_b64_tr_b16 a[250:251], v16 offset:24576
 ds_read_b64_tr_b16 a[252:253], v16 offset:18432
 ds_read_b64_tr_b16 a[254:255], v16 offset:26624
 s_waitcnt lgkmcnt(0)
 s_barrier
 s_lshl_b32 s14, s52, 8
 s_add_u32 s14, s14, 2359296
 s_mov_b32 m0, 73728
 s_nop 0
 buffer_load_dwordx4 v10, s[8:11], s14 offen lds
 s_add_u32 s14, s14, 32768
 s_mov_b32 m0, 74752
 s_nop 0
 buffer_load_dwordx4 v10, s[8:11], s14 offen lds
 s_add_u32 s14, s14, 32768
 s_mov_b32 m0, 75776
 s_nop 0
 buffer_load_dwordx4 v10, s[8:11], s14 offen lds
 s_add_u32 s14, s14, 32768
 s_mov_b32 m0, 76800
 s_nop 0
 buffer_load_dwordx4 v10, s[8:11], s14 offen lds
 s_add_u32 s14, s14, 32768
 s_mov_b32 m0, 77824
 s_nop 0
 buffer_load_dwordx4 v11, s[8:11], s14 offen lds
 s_add_u32 s14, s14, 32768
 s_mov_b32 m0, 78848
 s_nop 0
 buffer_load_dwordx4 v11, s[8:11], s14 offen lds
 s_add_u32 s14, s14, 32768
 s_mov_b32 m0, 79872
 s_nop 0
 buffer_load_dwordx4 v11, s[8:11], s14 offen lds
 s_add_u32 s14, s14, 32768
 s_mov_b32 m0, 80896
 s_nop 0
 buffer_load_dwordx4 v11, s[8:11], s14 offen lds
 s_waitcnt vmcnt(32)
 s_barrier
 v_xor_b32 v16, 0, v12
 v_add_u32 v16, 98304, v16
 ds_read_b64_tr_b16 v[64:65], v16 offset:0
 ds_read_b64_tr_b16 v[66:67], v16 offset:8192
 ds_read_b64_tr_b16 v[68:69], v16 offset:2048
 ds_read_b64_tr_b16 v[70:71], v16 offset:10240
 v_xor_b32 v16, 32, v12
 v_add_u32 v16, 98304, v16
 ds_read_b64_tr_b16 v[72:73], v16 offset:0
 ds_read_b64_tr_b16 v[74:75], v16 offset:8192
 ds_read_b64_tr_b16 v[76:77], v16 offset:2048
 ds_read_b64_tr_b16 v[78:79], v16 offset:10240
 v_xor_b32 v16, 0, v12
 v_add_u32 v16, 98304, v16
 ds_read_b64_tr_b16 v[80:81], v16 offset:16384
 ds_read_b64_tr_b16 v[82:83], v16 offset:24576
 ds_read_b64_tr_b16 v[84:85], v16 offset:18432
 ds_read_b64_tr_b16 v[86:87], v16 offset:26624
 v_xor_b32 v16, 32, v12
 v_add_u32 v16, 98304, v16
 ds_read_b64_tr_b16 v[88:89], v16 offset:16384
 ds_read_b64_tr_b16 v[90:91], v16 offset:24576
 ds_read_b64_tr_b16 v[92:93], v16 offset:18432
 ds_read_b64_tr_b16 v[94:95], v16 offset:26624
 s_waitcnt lgkmcnt(0)
 s_barrier
 s_lshl_b32 s14, s52, 8
 s_add_u32 s14, s14, 3407872
 s_mov_b32 m0, 106496
 s_nop 0
 buffer_load_dwordx4 v10, s[8:11], s14 offen lds
 s_add_u32 s14, s14, 32768
 s_mov_b32 m0, 107520
 s_nop 0
 buffer_load_dwordx4 v10, s[8:11], s14 offen lds
 s_add_u32 s14, s14, 32768
 s_mov_b32 m0, 108544
 s_nop 0
 buffer_load_dwordx4 v10, s[8:11], s14 offen lds
 s_add_u32 s14, s14, 32768
 s_mov_b32 m0, 109568
 s_nop 0
 buffer_load_dwordx4 v10, s[8:11], s14 offen lds
 s_add_u32 s14, s14, 32768
 s_mov_b32 m0, 110592
 s_nop 0
 buffer_load_dwordx4 v11, s[8:11], s14 offen lds
 s_add_u32 s14, s14, 32768
 s_mov_b32 m0, 111616
 s_nop 0
 buffer_load_dwordx4 v11, s[8:11], s14 offen lds
 s_add_u32 s14, s14, 32768
 s_mov_b32 m0, 112640
 s_nop 0
 buffer_load_dwordx4 v11, s[8:11], s14 offen lds
 s_add_u32 s14, s14, 32768
 s_mov_b32 m0, 113664
 s_nop 0
 buffer_load_dwordx4 v11, s[8:11], s14 offen lds
 s_waitcnt vmcnt(32)
 s_barrier
 v_xor_b32 v16, 0, v12
 v_add_u32 v16, 131072, v16
 ds_read_b64_tr_b16 v[96:97], v16 offset:0
 ds_read_b64_tr_b16 v[98:99], v16 offset:8192
 ds_read_b64_tr_b16 v[100:101], v16 offset:2048
 ds_read_b64_tr_b16 v[102:103], v16 offset:10240
 v_xor_b32 v16, 32, v12
 v_add_u32 v16, 131072, v16
 ds_read_b64_tr_b16 v[104:105], v16 offset:0
 ds_read_b64_tr_b16 v[106:107], v16 offset:8192
 ds_read_b64_tr_b16 v[108:109], v16 offset:2048
 ds_read_b64_tr_b16 v[110:111], v16 offset:10240
 v_xor_b32 v16, 0, v12
 v_add_u32 v16, 131072, v16
 ds_read_b64_tr_b16 v[112:113], v16 offset:16384
 ds_read_b64_tr_b16 v[114:115], v16 offset:24576
 ds_read_b64_tr_b16 v[116:117], v16 offset:18432
 ds_read_b64_tr_b16 v[118:119], v16 offset:26624
 v_xor_b32 v16, 32, v12
 v_add_u32 v16, 131072, v16
 ds_read_b64_tr_b16 v[120:121], v16 offset:16384
 ds_read_b64_tr_b16 v[122:123], v16 offset:24576
 ds_read_b64_tr_b16 v[124:125], v16 offset:18432
 ds_read_b64_tr_b16 v[126:127], v16 offset:26624
 s_waitcnt lgkmcnt(0)
 s_barrier
 s_lshl_b32 s14, s52, 8
 s_add_u32 s14, s14, 4456448
 s_mov_b32 m0, 139264
 s_nop 0
 buffer_load_dwordx4 v10, s[8:11], s14 offen lds
 s_add_u32 s14, s14, 32768
 s_mov_b32 m0, 140288
 s_nop 0
 buffer_load_dwordx4 v10, s[8:11], s14 offen lds
 s_add_u32 s14, s14, 32768
 s_mov_b32 m0, 141312
 s_nop 0
 buffer_load_dwordx4 v10, s[8:11], s14 offen lds
 s_add_u32 s14, s14, 32768
 s_mov_b32 m0, 142336
 s_nop 0
 buffer_load_dwordx4 v10, s[8:11], s14 offen lds
 s_add_u32 s14, s14, 32768
 s_mov_b32 m0, 143360
 s_nop 0
 buffer_load_dwordx4 v11, s[8:11], s14 offen lds
 s_add_u32 s14, s14, 32768
 s_mov_b32 m0, 144384
 s_nop 0
 buffer_load_dwordx4 v11, s[8:11], s14 offen lds
 s_add_u32 s14, s14, 32768
 s_mov_b32 m0, 145408
 s_nop 0
 buffer_load_dwordx4 v11, s[8:11], s14 offen lds
 s_add_u32 s14, s14, 32768
 s_mov_b32 m0, 146432
 s_nop 0
 buffer_load_dwordx4 v11, s[8:11], s14 offen lds
 s_waitcnt vmcnt(32)
 s_barrier
 v_xor_b32 v16, 0, v12
 v_add_u32 v16, 0, v16
 ds_read_b64_tr_b16 v[128:129], v16 offset:0
 ds_read_b64_tr_b16 v[130:131], v16 offset:8192
 ds_read_b64_tr_b16 v[132:133], v16 offset:2048
 ds_read_b64_tr_b16 v[134:135], v16 offset:10240
 v_xor_b32 v16, 32, v12
 v_add_u32 v16, 0, v16
 ds_read_b64_tr_b16 v[136:137], v16 offset:0
 ds_read_b64_tr_b16 v[138:139], v16 offset:8192
 ds_read_b64_tr_b16 v[140:141], v16 offset:2048
 ds_read_b64_tr_b16 v[142:143], v16 offset:10240
 v_xor_b32 v16, 0, v12
 v_add_u32 v16, 0, v16
 ds_read_b64_tr_b16 v[144:145], v16 offset:16384
 ds_read_b64_tr_b16 v[146:147], v16 offset:24576
 ds_read_b64_tr_b16 v[148:149], v16 offset:18432
 ds_read_b64_tr_b16 v[150:151], v16 offset:26624
 v_xor_b32 v16, 32, v12
 v_add_u32 v16, 0, v16
 ds_read_b64_tr_b16 v[152:153], v16 offset:16384
 ds_read_b64_tr_b16 v[154:155], v16 offset:24576
 ds_read_b64_tr_b16 v[156:157], v16 offset:18432
 ds_read_b64_tr_b16 v[158:159], v16 offset:26624
 s_waitcnt lgkmcnt(0)
 s_barrier
 s_mov_b32 s8, s20
 s_and_b32 s9, s21, 0xffff
 s_mov_b32 s10, 5242880
 s_lshl_b32 s14, s52, 8
 s_add_u32 s14, s14, 262144
 s_mov_b32 m0, 8192
 s_nop 0
 buffer_load_dwordx4 v10, s[8:11], s14 offen lds
 s_add_u32 s14, s14, 32768
 s_mov_b32 m0, 9216
 s_nop 0
 buffer_load_dwordx4 v10, s[8:11], s14 offen lds
 s_add_u32 s14, s14, 32768
 s_mov_b32 m0, 10240
 s_nop 0
 buffer_load_dwordx4 v10, s[8:11], s14 offen lds
 s_add_u32 s14, s14, 32768
 s_mov_b32 m0, 11264
 s_nop 0
 buffer_load_dwordx4 v10, s[8:11], s14 offen lds
 s_add_u32 s14, s14, 32768
 s_mov_b32 m0, 12288
 s_nop 0
 buffer_load_dwordx4 v11, s[8:11], s14 offen lds
 s_add_u32 s14, s14, 32768
 s_mov_b32 m0, 13312
 s_nop 0
 buffer_load_dwordx4 v11, s[8:11], s14 offen lds
 s_add_u32 s14, s14, 32768
 s_mov_b32 m0, 14336
 s_nop 0
 buffer_load_dwordx4 v11, s[8:11], s14 offen lds
 s_add_u32 s14, s14, 32768
 s_mov_b32 m0, 15360
 s_nop 0
 buffer_load_dwordx4 v11, s[8:11], s14 offen lds
 s_waitcnt vmcnt(32)
 s_barrier
 v_xor_b32 v16, 0, v12
 v_add_u32 v16, 32768, v16
 ds_read_b64_tr_b16 v[32:33], v16 offset:0
 ds_read_b64_tr_b16 v[34:35], v16 offset:8192
 ds_read_b64_tr_b16 v[36:37], v16 offset:2048
 ds_read_b64_tr_b16 v[38:39], v16 offset:10240
 s_add_u32 s3, s63, 0
 s_waitcnt lgkmcnt(2)
 buffer_store_dwordx4 v[32:35], v1, s[4:7], s3 offen offset:0
 s_waitcnt lgkmcnt(0)
 buffer_store_dwordx4 v[36:39], v1, s[4:7], s3 offen offset:1024
 v_xor_b32 v16, 32, v12
 v_add_u32 v16, 32768, v16
 ds_read_b64_tr_b16 v[40:41], v16 offset:0
 ds_read_b64_tr_b16 v[42:43], v16 offset:8192
 ds_read_b64_tr_b16 v[44:45], v16 offset:2048
 ds_read_b64_tr_b16 v[46:47], v16 offset:10240
 s_add_u32 s3, s63, 2048
 s_waitcnt lgkmcnt(2)
 buffer_store_dwordx4 v[40:43], v1, s[4:7], s3 offen offset:0
 s_waitcnt lgkmcnt(0)
 buffer_store_dwordx4 v[44:47], v1, s[4:7], s3 offen offset:1024
 v_xor_b32 v16, 0, v12
 v_add_u32 v16, 32768, v16
 ds_read_b64_tr_b16 v[48:49], v16 offset:16384
 ds_read_b64_tr_b16 v[50:51], v16 offset:24576
 ds_read_b64_tr_b16 v[52:53], v16 offset:18432
 ds_read_b64_tr_b16 v[54:55], v16 offset:26624
 s_add_u32 s3, s63, 4096
 s_waitcnt lgkmcnt(2)
 buffer_store_dwordx4 v[48:51], v1, s[4:7], s3 offen offset:0
 s_waitcnt lgkmcnt(0)
 buffer_store_dwordx4 v[52:55], v1, s[4:7], s3 offen offset:1024
 v_xor_b32 v16, 32, v12
 v_add_u32 v16, 32768, v16
 ds_read_b64_tr_b16 v[56:57], v16 offset:16384
 ds_read_b64_tr_b16 v[58:59], v16 offset:24576
 ds_read_b64_tr_b16 v[60:61], v16 offset:18432
 ds_read_b64_tr_b16 v[62:63], v16 offset:26624
 s_add_u32 s3, s63, 6144
 s_waitcnt lgkmcnt(2)
 buffer_store_dwordx4 v[56:59], v1, s[4:7], s3 offen offset:0
 s_waitcnt lgkmcnt(0)
 buffer_store_dwordx4 v[60:63], v1, s[4:7], s3 offen offset:1024
 s_waitcnt lgkmcnt(0)
 s_barrier
 s_lshl_b32 s14, s52, 8
 s_add_u32 s14, s14, 1310720
 s_mov_b32 m0, 40960
 s_nop 0
 buffer_load_dwordx4 v10, s[8:11], s14 offen lds
 s_add_u32 s14, s14, 32768
 s_mov_b32 m0, 41984
 s_nop 0
 buffer_load_dwordx4 v10, s[8:11], s14 offen lds
 s_add_u32 s14, s14, 32768
 s_mov_b32 m0, 43008
 s_nop 0
 buffer_load_dwordx4 v10, s[8:11], s14 offen lds
 s_add_u32 s14, s14, 32768
 s_mov_b32 m0, 44032
 s_nop 0
 buffer_load_dwordx4 v10, s[8:11], s14 offen lds
 s_add_u32 s14, s14, 32768
 s_mov_b32 m0, 45056
 s_nop 0
 buffer_load_dwordx4 v11, s[8:11], s14 offen lds
 s_add_u32 s14, s14, 32768
 s_mov_b32 m0, 46080
 s_nop 0
 buffer_load_dwordx4 v11, s[8:11], s14 offen lds
 s_add_u32 s14, s14, 32768
 s_mov_b32 m0, 47104
 s_nop 0
 buffer_load_dwordx4 v11, s[8:11], s14 offen lds
 s_add_u32 s14, s14, 32768
 s_mov_b32 m0, 48128
 s_nop 0
 buffer_load_dwordx4 v11, s[8:11], s14 offen lds
 s_waitcnt vmcnt(40)
 s_barrier
 v_xor_b32 v16, 0, v12
 v_add_u32 v16, 65536, v16
 ds_read_b64_tr_b16 v[160:161], v16 offset:0
 ds_read_b64_tr_b16 v[162:163], v16 offset:8192
 ds_read_b64_tr_b16 v[164:165], v16 offset:2048
 ds_read_b64_tr_b16 v[166:167], v16 offset:10240
 v_xor_b32 v16, 32, v12
 v_add_u32 v16, 65536, v16
 ds_read_b64_tr_b16 v[168:169], v16 offset:0
 ds_read_b64_tr_b16 v[170:171], v16 offset:8192
 ds_read_b64_tr_b16 v[172:173], v16 offset:2048
 ds_read_b64_tr_b16 v[174:175], v16 offset:10240
 v_xor_b32 v16, 0, v12
 v_add_u32 v16, 65536, v16
 ds_read_b64_tr_b16 v[176:177], v16 offset:16384
 ds_read_b64_tr_b16 v[178:179], v16 offset:24576
 ds_read_b64_tr_b16 v[180:181], v16 offset:18432
 ds_read_b64_tr_b16 v[182:183], v16 offset:26624
 v_xor_b32 v16, 32, v12
 v_add_u32 v16, 65536, v16
 ds_read_b64_tr_b16 v[184:185], v16 offset:16384
 ds_read_b64_tr_b16 v[186:187], v16 offset:24576
 ds_read_b64_tr_b16 v[188:189], v16 offset:18432
 ds_read_b64_tr_b16 v[190:191], v16 offset:26624
 s_waitcnt lgkmcnt(0)
 s_barrier
 s_lshl_b32 s14, s52, 8
 s_add_u32 s14, s14, 2359296
 s_mov_b32 m0, 73728
 s_nop 0
 buffer_load_dwordx4 v10, s[8:11], s14 offen lds
 s_add_u32 s14, s14, 32768
 s_mov_b32 m0, 74752
 s_nop 0
 buffer_load_dwordx4 v10, s[8:11], s14 offen lds
 s_add_u32 s14, s14, 32768
 s_mov_b32 m0, 75776
 s_nop 0
 buffer_load_dwordx4 v10, s[8:11], s14 offen lds
 s_add_u32 s14, s14, 32768
 s_mov_b32 m0, 76800
 s_nop 0
 buffer_load_dwordx4 v10, s[8:11], s14 offen lds
 s_add_u32 s14, s14, 32768
 s_mov_b32 m0, 77824
 s_nop 0
 buffer_load_dwordx4 v11, s[8:11], s14 offen lds
 s_add_u32 s14, s14, 32768
 s_mov_b32 m0, 78848
 s_nop 0
 buffer_load_dwordx4 v11, s[8:11], s14 offen lds
 s_add_u32 s14, s14, 32768
 s_mov_b32 m0, 79872
 s_nop 0
 buffer_load_dwordx4 v11, s[8:11], s14 offen lds
 s_add_u32 s14, s14, 32768
 s_mov_b32 m0, 80896
 s_nop 0
 buffer_load_dwordx4 v11, s[8:11], s14 offen lds
 s_waitcnt vmcnt(40)
 s_barrier
 v_xor_b32 v16, 0, v12
 v_add_u32 v16, 98304, v16
 ds_read_b64_tr_b16 v[192:193], v16 offset:0
 ds_read_b64_tr_b16 v[194:195], v16 offset:8192
 ds_read_b64_tr_b16 v[196:197], v16 offset:2048
 ds_read_b64_tr_b16 v[198:199], v16 offset:10240
 v_xor_b32 v16, 32, v12
 v_add_u32 v16, 98304, v16
 ds_read_b64_tr_b16 v[32:33], v16 offset:0
 ds_read_b64_tr_b16 v[34:35], v16 offset:8192
 ds_read_b64_tr_b16 v[36:37], v16 offset:2048
 ds_read_b64_tr_b16 v[38:39], v16 offset:10240
 s_add_u32 s3, s63, 8192
 s_waitcnt lgkmcnt(2)
 buffer_store_dwordx4 v[32:35], v1, s[4:7], s3 offen offset:0
 s_waitcnt lgkmcnt(0)
 buffer_store_dwordx4 v[36:39], v1, s[4:7], s3 offen offset:1024
 v_xor_b32 v16, 0, v12
 v_add_u32 v16, 98304, v16
 ds_read_b64_tr_b16 v[200:201], v16 offset:16384
 ds_read_b64_tr_b16 v[202:203], v16 offset:24576
 ds_read_b64_tr_b16 v[204:205], v16 offset:18432
 ds_read_b64_tr_b16 v[206:207], v16 offset:26624
 v_xor_b32 v16, 32, v12
 v_add_u32 v16, 98304, v16
 ds_read_b64_tr_b16 v[208:209], v16 offset:16384
 ds_read_b64_tr_b16 v[210:211], v16 offset:24576
 ds_read_b64_tr_b16 v[212:213], v16 offset:18432
 ds_read_b64_tr_b16 v[214:215], v16 offset:26624
 s_waitcnt lgkmcnt(0)
 s_barrier
 s_lshl_b32 s14, s52, 8
 s_add_u32 s14, s14, 3407872
 s_mov_b32 m0, 106496
 s_nop 0
 buffer_load_dwordx4 v10, s[8:11], s14 offen lds
 s_add_u32 s14, s14, 32768
 s_mov_b32 m0, 107520
 s_nop 0
 buffer_load_dwordx4 v10, s[8:11], s14 offen lds
 s_add_u32 s14, s14, 32768
 s_mov_b32 m0, 108544
 s_nop 0
 buffer_load_dwordx4 v10, s[8:11], s14 offen lds
 s_add_u32 s14, s14, 32768
 s_mov_b32 m0, 109568
 s_nop 0
 buffer_load_dwordx4 v10, s[8:11], s14 offen lds
 s_add_u32 s14, s14, 32768
 s_mov_b32 m0, 110592
 s_nop 0
 buffer_load_dwordx4 v11, s[8:11], s14 offen lds
 s_add_u32 s14, s14, 32768
 s_mov_b32 m0, 111616
 s_nop 0
 buffer_load_dwordx4 v11, s[8:11], s14 offen lds
 s_add_u32 s14, s14, 32768
 s_mov_b32 m0, 112640
 s_nop 0
 buffer_load_dwordx4 v11, s[8:11], s14 offen lds
 s_add_u32 s14, s14, 32768
 s_mov_b32 m0, 113664
 s_nop 0
 buffer_load_dwordx4 v11, s[8:11], s14 offen lds
 s_waitcnt vmcnt(42)
 s_barrier
 v_xor_b32 v16, 0, v12
 v_add_u32 v16, 131072, v16
 ds_read_b64_tr_b16 v[216:217], v16 offset:0
 ds_read_b64_tr_b16 v[218:219], v16 offset:8192
 ds_read_b64_tr_b16 v[220:221], v16 offset:2048
 ds_read_b64_tr_b16 v[222:223], v16 offset:10240
 v_xor_b32 v16, 32, v12
 v_add_u32 v16, 131072, v16
 ds_read_b64_tr_b16 v[224:225], v16 offset:0
 ds_read_b64_tr_b16 v[226:227], v16 offset:8192
 ds_read_b64_tr_b16 v[228:229], v16 offset:2048
 ds_read_b64_tr_b16 v[230:231], v16 offset:10240
 v_xor_b32 v16, 0, v12
 v_add_u32 v16, 131072, v16
 ds_read_b64_tr_b16 v[232:233], v16 offset:16384
 ds_read_b64_tr_b16 v[234:235], v16 offset:24576
 ds_read_b64_tr_b16 v[236:237], v16 offset:18432
 ds_read_b64_tr_b16 v[238:239], v16 offset:26624
 v_xor_b32 v16, 32, v12
 v_add_u32 v16, 131072, v16
 ds_read_b64_tr_b16 v[40:41], v16 offset:16384
 ds_read_b64_tr_b16 v[42:43], v16 offset:24576
 ds_read_b64_tr_b16 v[44:45], v16 offset:18432
 ds_read_b64_tr_b16 v[46:47], v16 offset:26624
 s_add_u32 s3, s63, 10240
 s_waitcnt lgkmcnt(2)
 buffer_store_dwordx4 v[40:43], v1, s[4:7], s3 offen offset:0
 s_waitcnt lgkmcnt(0)
 buffer_store_dwordx4 v[44:47], v1, s[4:7], s3 offen offset:1024
 s_waitcnt lgkmcnt(0)
 s_barrier
 s_lshl_b32 s14, s52, 8
 s_add_u32 s14, s14, 4456448
 s_mov_b32 m0, 139264
 s_nop 0
 buffer_load_dwordx4 v10, s[8:11], s14 offen lds
 s_add_u32 s14, s14, 32768
 s_mov_b32 m0, 140288
 s_nop 0
 buffer_load_dwordx4 v10, s[8:11], s14 offen lds
 s_add_u32 s14, s14, 32768
 s_mov_b32 m0, 141312
 s_nop 0
 buffer_load_dwordx4 v10, s[8:11], s14 offen lds
 s_add_u32 s14, s14, 32768
 s_mov_b32 m0, 142336
 s_nop 0
 buffer_load_dwordx4 v10, s[8:11], s14 offen lds
 s_add_u32 s14, s14, 32768
 s_mov_b32 m0, 143360
 s_nop 0
 buffer_load_dwordx4 v11, s[8:11], s14 offen lds
 s_add_u32 s14, s14, 32768
 s_mov_b32 m0, 144384
 s_nop 0
 buffer_load_dwordx4 v11, s[8:11], s14 offen lds
 s_add_u32 s14, s14, 32768
 s_mov_b32 m0, 145408
 s_nop 0
 buffer_load_dwordx4 v11, s[8:11], s14 offen lds
 s_add_u32 s14, s14, 32768
 s_mov_b32 m0, 146432
 s_nop 0
 buffer_load_dwordx4 v11, s[8:11], s14 offen lds
 s_waitcnt vmcnt(44)
 s_barrier
 v_xor_b32 v16, 0, v12
 v_add_u32 v16, 0, v16
 ds_read_b64_tr_b16 v[240:241], v16 offset:0
 ds_read_b64_tr_b16 v[242:243], v16 offset:8192
 ds_read_b64_tr_b16 v[244:245], v16 offset:2048
 ds_read_b64_tr_b16 v[246:247], v16 offset:10240
 v_xor_b32 v16, 32, v12
 v_add_u32 v16, 0, v16
 ds_read_b64_tr_b16 v[248:249], v16 offset:0
 ds_read_b64_tr_b16 v[250:251], v16 offset:8192
 ds_read_b64_tr_b16 v[252:253], v16 offset:2048
 ds_read_b64_tr_b16 v[254:255], v16 offset:10240
 v_xor_b32 v16, 0, v12
 v_add_u32 v16, 0, v16
 ds_read_b64_tr_b16 v[32:33], v16 offset:16384
 ds_read_b64_tr_b16 v[34:35], v16 offset:24576
 ds_read_b64_tr_b16 v[36:37], v16 offset:18432
 ds_read_b64_tr_b16 v[38:39], v16 offset:26624
 v_xor_b32 v16, 32, v12
 v_add_u32 v16, 0, v16
 ds_read_b64_tr_b16 v[40:41], v16 offset:16384
 ds_read_b64_tr_b16 v[42:43], v16 offset:24576
 ds_read_b64_tr_b16 v[44:45], v16 offset:18432
 ds_read_b64_tr_b16 v[46:47], v16 offset:26624
 s_waitcnt lgkmcnt(0)
 s_barrier
 ds_write_b128 v1, v[224:227] offset:20480
 ds_write_b128 v1, v[228:231] offset:21504
 ds_write_b128 v1, v[216:219] offset:22528
 ds_write_b128 v1, v[220:223] offset:23552
 s_waitcnt lgkmcnt(0)
 v_mov_b32 v224, v32
 v_mov_b32 v225, v33
 v_mov_b32 v226, v34
 v_mov_b32 v227, v35
 v_mov_b32 v228, v36
 v_mov_b32 v229, v37
 v_mov_b32 v230, v38
 v_mov_b32 v231, v39
 v_mov_b32 v216, v40
 v_mov_b32 v217, v41
 v_mov_b32 v218, v42
 v_mov_b32 v219, v43
 v_mov_b32 v220, v44
 v_mov_b32 v221, v45
 v_mov_b32 v222, v46
 v_mov_b32 v223, v47
 s_waitcnt vmcnt(28)
 s_barrier
 v_xor_b32 v16, 0, v12
 v_add_u32 v16, 32768, v16
 ds_read_b64_tr_b16 v[32:33], v16 offset:0
 ds_read_b64_tr_b16 v[34:35], v16 offset:8192
 ds_read_b64_tr_b16 v[36:37], v16 offset:2048
 ds_read_b64_tr_b16 v[38:39], v16 offset:10240
 v_xor_b32 v16, 32, v12
 v_add_u32 v16, 32768, v16
 ds_read_b64_tr_b16 v[40:41], v16 offset:0
 ds_read_b64_tr_b16 v[42:43], v16 offset:8192
 ds_read_b64_tr_b16 v[44:45], v16 offset:2048
 ds_read_b64_tr_b16 v[46:47], v16 offset:10240
 v_xor_b32 v16, 0, v12
 v_add_u32 v16, 32768, v16
 ds_read_b64_tr_b16 v[48:49], v16 offset:16384
 ds_read_b64_tr_b16 v[50:51], v16 offset:24576
 ds_read_b64_tr_b16 v[52:53], v16 offset:18432
 ds_read_b64_tr_b16 v[54:55], v16 offset:26624
 v_xor_b32 v16, 32, v12
 v_add_u32 v16, 32768, v16
 ds_read_b64_tr_b16 v[56:57], v16 offset:16384
 ds_read_b64_tr_b16 v[58:59], v16 offset:24576
 ds_read_b64_tr_b16 v[60:61], v16 offset:18432
 ds_read_b64_tr_b16 v[62:63], v16 offset:26624
 s_waitcnt lgkmcnt(0)
 s_barrier
 ds_write_b128 v1, v[200:203] offset:40960
 ds_write_b128 v1, v[204:207] offset:41984
 ds_write_b128 v1, v[192:195] offset:43008
 ds_write_b128 v1, v[196:199] offset:44032
 ds_write_b128 v1, v[184:187] offset:45056
 ds_write_b128 v1, v[188:191] offset:46080
 ds_write_b128 v1, v[176:179] offset:47104
 ds_write_b128 v1, v[180:183] offset:48128
 s_waitcnt lgkmcnt(0)
 v_mov_b32 v200, v32
 v_mov_b32 v201, v33
 v_mov_b32 v202, v34
 v_mov_b32 v203, v35
 v_mov_b32 v204, v36
 v_mov_b32 v205, v37
 v_mov_b32 v206, v38
 v_mov_b32 v207, v39
 v_mov_b32 v192, v40
 v_mov_b32 v193, v41
 v_mov_b32 v194, v42
 v_mov_b32 v195, v43
 v_mov_b32 v196, v44
 v_mov_b32 v197, v45
 v_mov_b32 v198, v46
 v_mov_b32 v199, v47
 v_mov_b32 v184, v48
 v_mov_b32 v185, v49
 v_mov_b32 v186, v50
 v_mov_b32 v187, v51
 v_mov_b32 v188, v52
 v_mov_b32 v189, v53
 v_mov_b32 v190, v54
 v_mov_b32 v191, v55
 v_mov_b32 v176, v56
 v_mov_b32 v177, v57
 v_mov_b32 v178, v58
 v_mov_b32 v179, v59
 v_mov_b32 v180, v60
 v_mov_b32 v181, v61
 v_mov_b32 v182, v62
 v_mov_b32 v183, v63
 s_waitcnt vmcnt(20)
 s_barrier
 v_xor_b32 v16, 0, v12
 v_add_u32 v16, 65536, v16
 ds_read_b64_tr_b16 v[32:33], v16 offset:0
 ds_read_b64_tr_b16 v[34:35], v16 offset:8192
 ds_read_b64_tr_b16 v[36:37], v16 offset:2048
 ds_read_b64_tr_b16 v[38:39], v16 offset:10240
 v_xor_b32 v16, 32, v12
 v_add_u32 v16, 65536, v16
 ds_read_b64_tr_b16 v[40:41], v16 offset:0
 ds_read_b64_tr_b16 v[42:43], v16 offset:8192
 ds_read_b64_tr_b16 v[44:45], v16 offset:2048
 ds_read_b64_tr_b16 v[46:47], v16 offset:10240
 v_xor_b32 v16, 0, v12
 v_add_u32 v16, 65536, v16
 ds_read_b64_tr_b16 v[48:49], v16 offset:16384
 ds_read_b64_tr_b16 v[50:51], v16 offset:24576
 ds_read_b64_tr_b16 v[52:53], v16 offset:18432
 ds_read_b64_tr_b16 v[54:55], v16 offset:26624
 v_xor_b32 v16, 32, v12
 v_add_u32 v16, 65536, v16
 ds_read_b64_tr_b16 v[56:57], v16 offset:16384
 ds_read_b64_tr_b16 v[58:59], v16 offset:24576
 ds_read_b64_tr_b16 v[60:61], v16 offset:18432
 ds_read_b64_tr_b16 v[62:63], v16 offset:26624
 s_waitcnt lgkmcnt(0)
 s_barrier
 ds_write_b128 v2, v[160:163] offset:8192
 ds_write_b128 v2, v[164:167] offset:9216
 ds_write_b128 v2, v[144:147] offset:10240
 ds_write_b128 v2, v[148:151] offset:11264
 ds_write_b128 v2, v[136:139] offset:12288
 ds_write_b128 v2, v[140:143] offset:13312
 ds_write_b128 v2, v[128:131] offset:14336
 ds_write_b128 v2, v[132:135] offset:15360
 s_waitcnt lgkmcnt(0)
 v_mov_b32 v160, v32
 v_mov_b32 v161, v33
 v_mov_b32 v162, v34
 v_mov_b32 v163, v35
 v_mov_b32 v164, v36
 v_mov_b32 v165, v37
 v_mov_b32 v166, v38
 v_mov_b32 v167, v39
 v_mov_b32 v144, v40
 v_mov_b32 v145, v41
 v_mov_b32 v146, v42
 v_mov_b32 v147, v43
 v_mov_b32 v148, v44
 v_mov_b32 v149, v45
 v_mov_b32 v150, v46
 v_mov_b32 v151, v47
 v_mov_b32 v136, v48
 v_mov_b32 v137, v49
 v_mov_b32 v138, v50
 v_mov_b32 v139, v51
 v_mov_b32 v140, v52
 v_mov_b32 v141, v53
 v_mov_b32 v142, v54
 v_mov_b32 v143, v55
 v_mov_b32 v128, v56
 v_mov_b32 v129, v57
 v_mov_b32 v130, v58
 v_mov_b32 v131, v59
 v_mov_b32 v132, v60
 v_mov_b32 v133, v61
 v_mov_b32 v134, v62
 v_mov_b32 v135, v63
 s_waitcnt vmcnt(10)
 s_barrier
 v_xor_b32 v16, 0, v12
 v_add_u32 v16, 98304, v16
 ds_read_b64_tr_b16 v[32:33], v16 offset:0
 ds_read_b64_tr_b16 v[34:35], v16 offset:8192
 ds_read_b64_tr_b16 v[36:37], v16 offset:2048
 ds_read_b64_tr_b16 v[38:39], v16 offset:10240
 v_xor_b32 v16, 32, v12
 v_add_u32 v16, 98304, v16
 ds_read_b64_tr_b16 v[40:41], v16 offset:0
 ds_read_b64_tr_b16 v[42:43], v16 offset:8192
 ds_read_b64_tr_b16 v[44:45], v16 offset:2048
 ds_read_b64_tr_b16 v[46:47], v16 offset:10240
 v_xor_b32 v16, 0, v12
 v_add_u32 v16, 98304, v16
 ds_read_b64_tr_b16 v[48:49], v16 offset:16384
 ds_read_b64_tr_b16 v[50:51], v16 offset:24576
 ds_read_b64_tr_b16 v[52:53], v16 offset:18432
 ds_read_b64_tr_b16 v[54:55], v16 offset:26624
 v_xor_b32 v16, 32, v12
 v_add_u32 v16, 98304, v16
 ds_read_b64_tr_b16 v[56:57], v16 offset:16384
 ds_read_b64_tr_b16 v[58:59], v16 offset:24576
 ds_read_b64_tr_b16 v[60:61], v16 offset:18432
 ds_read_b64_tr_b16 v[62:63], v16 offset:26624
 s_waitcnt lgkmcnt(0)
 s_barrier
 ds_write_b128 v2, a[144:147] offset:40960
 ds_write_b128 v2, a[148:151] offset:41984
 ds_write_b128 v2, a[128:131] offset:43008
 ds_write_b128 v2, a[132:135] offset:44032
 ds_write_b128 v2, a[104:107] offset:45056
 ds_write_b128 v2, a[108:111] offset:46080
 ds_write_b128 v2, a[88:91] offset:47104
 ds_write_b128 v2, a[92:95] offset:48128
 s_waitcnt lgkmcnt(0)
 v_accvgpr_write_b32 a144, v32
 v_accvgpr_write_b32 a145, v33
 v_accvgpr_write_b32 a146, v34
 v_accvgpr_write_b32 a147, v35
 v_accvgpr_write_b32 a148, v36
 v_accvgpr_write_b32 a149, v37
 v_accvgpr_write_b32 a150, v38
 v_accvgpr_write_b32 a151, v39
 v_accvgpr_write_b32 a128, v40
 v_accvgpr_write_b32 a129, v41
 v_accvgpr_write_b32 a130, v42
 v_accvgpr_write_b32 a131, v43
 v_accvgpr_write_b32 a132, v44
 v_accvgpr_write_b32 a133, v45
 v_accvgpr_write_b32 a134, v46
 v_accvgpr_write_b32 a135, v47
 v_accvgpr_write_b32 a104, v48
 v_accvgpr_write_b32 a105, v49
 v_accvgpr_write_b32 a106, v50
 v_accvgpr_write_b32 a107, v51
 v_accvgpr_write_b32 a108, v52
 v_accvgpr_write_b32 a109, v53
 v_accvgpr_write_b32 a110, v54
 v_accvgpr_write_b32 a111, v55
 v_accvgpr_write_b32 a88, v56
 v_accvgpr_write_b32 a89, v57
 v_accvgpr_write_b32 a90, v58
 v_accvgpr_write_b32 a91, v59
 v_accvgpr_write_b32 a92, v60
 v_accvgpr_write_b32 a93, v61
 v_accvgpr_write_b32 a94, v62
 v_accvgpr_write_b32 a95, v63
 s_waitcnt vmcnt(0)
 s_barrier
 v_xor_b32 v16, 0, v12
 v_add_u32 v16, 131072, v16
 ds_read_b64_tr_b16 v[32:33], v16 offset:0
 ds_read_b64_tr_b16 v[34:35], v16 offset:8192
 ds_read_b64_tr_b16 v[36:37], v16 offset:2048
 ds_read_b64_tr_b16 v[38:39], v16 offset:10240
 v_xor_b32 v16, 32, v12
 v_add_u32 v16, 131072, v16
 ds_read_b64_tr_b16 v[40:41], v16 offset:0
 ds_read_b64_tr_b16 v[42:43], v16 offset:8192
 ds_read_b64_tr_b16 v[44:45], v16 offset:2048
 ds_read_b64_tr_b16 v[46:47], v16 offset:10240
 v_xor_b32 v16, 0, v12
 v_add_u32 v16, 131072, v16
 ds_read_b64_tr_b16 v[48:49], v16 offset:16384
 ds_read_b64_tr_b16 v[50:51], v16 offset:24576
 ds_read_b64_tr_b16 v[52:53], v16 offset:18432
 ds_read_b64_tr_b16 v[54:55], v16 offset:26624
 v_xor_b32 v16, 32, v12
 v_add_u32 v16, 131072, v16
 ds_read_b64_tr_b16 v[56:57], v16 offset:16384
 ds_read_b64_tr_b16 v[58:59], v16 offset:24576
 ds_read_b64_tr_b16 v[60:61], v16 offset:18432
 ds_read_b64_tr_b16 v[62:63], v16 offset:26624
 s_waitcnt lgkmcnt(0)
 s_barrier
 ds_write_b128 v3, a[80:83] offset:24576
 ds_write_b128 v3, a[84:87] offset:25600
 ds_write_b128 v3, a[72:75] offset:26624
 ds_write_b128 v3, a[76:79] offset:27648
 ds_write_b128 v3, a[32:35] offset:28672
 ds_write_b128 v3, a[36:39] offset:29696
 ds_write_b128 v3, a[24:27] offset:30720
 ds_write_b128 v3, a[28:31] offset:31744
 s_waitcnt lgkmcnt(0)
 v_accvgpr_write_b32 a80, v32
 v_accvgpr_write_b32 a81, v33
 v_accvgpr_write_b32 a82, v34
 v_accvgpr_write_b32 a83, v35
 v_accvgpr_write_b32 a84, v36
 v_accvgpr_write_b32 a85, v37
 v_accvgpr_write_b32 a86, v38
 v_accvgpr_write_b32 a87, v39
 v_accvgpr_write_b32 a72, v40
 v_accvgpr_write_b32 a73, v41
 v_accvgpr_write_b32 a74, v42
 v_accvgpr_write_b32 a75, v43
 v_accvgpr_write_b32 a76, v44
 v_accvgpr_write_b32 a77, v45
 v_accvgpr_write_b32 a78, v46
 v_accvgpr_write_b32 a79, v47
 v_accvgpr_write_b32 a32, v48
 v_accvgpr_write_b32 a33, v49
 v_accvgpr_write_b32 a34, v50
 v_accvgpr_write_b32 a35, v51
 v_accvgpr_write_b32 a36, v52
 v_accvgpr_write_b32 a37, v53
 v_accvgpr_write_b32 a38, v54
 v_accvgpr_write_b32 a39, v55
 v_accvgpr_write_b32 a24, v56
 v_accvgpr_write_b32 a25, v57
 v_accvgpr_write_b32 a26, v58
 v_accvgpr_write_b32 a27, v59
 v_accvgpr_write_b32 a28, v60
 v_accvgpr_write_b32 a29, v61
 v_accvgpr_write_b32 a30, v62
 v_accvgpr_write_b32 a31, v63
 v_lshlrev_b32 v5, 3, v0
 v_and_b32 v6, 0x1e0, v5
 v_and_b32 v7, 1, v0
 v_lshl_add_u32 v6, v7, 4, v6
 v_and_b32 v7, 2, v0
 v_lshl_add_u32 v6, v7, 2, v6
 v_bfe_u32 v4, v0, 2, 2
 v_lshrrev_b32 v7, 4, v0
 v_cmp_eq_u32 vcc, v4, v7
 v_and_b32 v7, 16, v1
 v_mov_b32 v5, 0x3f80
 v_lshlrev_b32 v7, v7, v5
 v_cndmask_b32 v4, 0, v7, vcc
 v_mov_b32 v5, 0
 s_lshl_b32 s59, s53, 16
 s_add_u32 s59, s59, 983040
 s_mul_i32 s15, s53, 327680
 s_add_u32 s15, s15, 225280
 s_lshl_b32 s3, s52, 8
 s_add_u32 s15, s15, s3
 s_add_u32 s64, s15, 128
 s_add_u32 s65, s15, 82048
 s_add_u32 s66, s15, 163968
 s_add_u32 s67, s15, 245888
 s_lshr_b32 s14, s52, 2
 s_and_b32 s15, s52, 3
 s_mov_b32 s16, 2
 s_mov_b32 s84, 0x00ff00ff
 s_mov_b32 s85, 0
 s_lshl_b32 s57, s14, 10
 s_lshl_b32 s3, s15, 6
 s_add_u32 s57, s57, s3
 s_lshl_b32 s3, s16, 8
 s_add_u32 s57, s57, s3
 s_add_u32 s57, s57, s59
 s_add_u32 s59, s59, 2048
 s_lshl_b32 s14, s14, 7
 s_mul_i32 s15, s15, 2560
 s_add_u32 s14, s14, s15
 s_lshl_b32 s3, s16, 3
 s_add_u32 s14, s14, s3
 s_mov_b32 s8, s18
 s_and_b32 s9, s19, 0xffff
 s_mov_b32 s10, 10240
 s_mov_b32 s11, 0x00020000
 v_bfe_u32 v40, v0, 4, 1
 v_mul_u32_u24 v40, 1280, v40
 v_and_b32 v41, 7, v0
 v_lshl_add_u32 v40, v41, 1, v40
 buffer_load_ushort v44, v40, s[8:11], s14 offen offset:0
 buffer_load_ushort v45, v40, s[8:11], s14 offen offset:32
 buffer_load_ushort v46, v40, s[8:11], s14 offen offset:64
 buffer_load_ushort v47, v40, s[8:11], s14 offen offset:96
 v_lshrrev_b32 v42, 7, v1
 v_mul_u32_u24 v42, 10240, v42
 v_and_b32 v7, 112, v1
 v_add_u32 v42, v42, v7
 v_and_b32 v43, 32, v1
 v_and_b32 v7, 64, v1
 v_lshl_add_u32 v43, v7, 2, v43
 v_bfe_u32 v7, v1, 8, 1
 v_lshl_add_u32 v43, v7, 4, v43
 v_bfe_u32 v7, v1, 4, 1
 v_lshl_add_u32 v43, v7, 3, v43
 s_waitcnt vmcnt(2)
 v_lshl_or_b32 v44, v45, 16, v44
 s_waitcnt vmcnt(0)
 v_lshl_or_b32 v45, v47, 16, v46
 s_add_u32 s16, s60, 6144
 s_waitcnt vmcnt(0) lgkmcnt(0)
 s_mov_b32 s96, s44
 s_and_b32 s97, s45, 0xffff
 s_mov_b32 s98, 256
 s_mov_b32 s99, 0x00020000
 v_mov_b32 v8, 132
 s_mov_b32 s51, 0
 s_mov_b64 exec, 1
L_wb_173:
 buffer_load_dword v9, v8, s[96:99], 0 offen sc1
 s_waitcnt vmcnt(0)
 v_cmp_eq_u32 vcc, 0, v9
 s_cbranch_vccz L_wbd_174
 s_sleep 2
 s_add_u32 s51, s51, 1
 s_cmp_lt_u32 s51, 131072
 s_cbranch_scc1 L_wb_173
 s_branch L_bail
L_wbd_174:
 s_mov_b64 exec, -1
 s_mov_b32 s96, s44
 s_and_b32 s97, s45, 0xffff
 s_mov_b32 s98, 256
 s_mov_b32 s99, 0x00020000
 v_mov_b32 v8, 212
 s_mov_b32 s51, 0
 s_mov_b64 exec, 1
L_wb_175:
 buffer_load_dword v9, v8, s[96:99], 0 offen sc1
 s_waitcnt vmcnt(0)
 v_cmp_eq_u32 vcc, 0, v9
 s_cbranch_vccz L_wbd_176
 s_sleep 2
 s_add_u32 s51, s51, 1
 s_cmp_lt_u32 s51, 131072
 s_cbranch_scc1 L_wb_175
 s_branch L_bail
L_wbd_176:
 s_mov_b64 exec, -1
 s_mov_b32 s96, s44
 s_and_b32 s97, s45, 0xffff
 s_mov_b32 s98, 256
 s_mov_b32 s99, 0x00020000
 v_lshlrev_b32 v8, 5, v0
 s_mov_b32 s51, 0
L_gl_177:
 buffer_load_dword v9, v8, s[96:99], 0 offen sc1
 s_waitcnt vmcnt(0)
 v_readlane_b32 s3, v9, s48
 s_mov_b32 s80, 0
 s_nop 2
 s_cmp_ge_u32 s3, 32
 s_cbranch_scc1 L_gld_178
 s_mov_b32 s80, 0
 v_readlane_b32 s3, v9, 0
 s_nop 3
 s_add_u32 s80, s80, s3
 v_readlane_b32 s3, v9, 1
 s_nop 3
 s_add_u32 s80, s80, s3
 v_readlane_b32 s3, v9, 2
 s_nop 3
 s_add_u32 s80, s80, s3
 v_readlane_b32 s3, v9, 3
 s_nop 3
 s_add_u32 s80, s80, s3
 v_readlane_b32 s3, v9, 4
 s_nop 3
 s_add_u32 s80, s80, s3
 v_readlane_b32 s3, v9, 5
 s_nop 3
 s_add_u32 s80, s80, s3
 v_readlane_b32 s3, v9, 6
 s_nop 3
 s_add_u32 s80, s80, s3
 v_readlane_b32 s3, v9, 7
 s_nop 3
 s_add_u32 s80, s80, s3
 s_cmp_ge_u32 s80, 256
 s_cbranch_scc1 L_gld_178
 s_sleep 4
 s_add_u32 s51, s51, 1
 s_cmp_lt_u32 s51, 131072
 s_cbranch_scc1 L_gl_177
 s_branch L_bail
L_gld_178:
 s_mov_b64 exec, s[84:85]
 buffer_store_dwordx2 v[44:45], v43, s[4:7], s57 offen sc1
 s_mov_b64 exec, -1
 v_and_b32 v7, 2, v0
 v_mul_u32_u24 v7, 0x5555, v7
 v_add_u32 v0, 0x4444, v7
 s_mov_b32 m0, 2048
 s_waitcnt vmcnt(0) lgkmcnt(0)
 s_barrier
 buffer_load_dwordx4 v[32:35], v1, s[4:7], s63 offen offset:0
 buffer_load_dwordx4 v[36:39], v1, s[4:7], s63 offen offset:1024
 buffer_load_dwordx4 v[40:43], v1, s[4:7], s63 offen offset:2048
 buffer_load_dwordx4 v[44:47], v1, s[4:7], s63 offen offset:3072
 buffer_load_dwordx4 v[48:51], v1, s[4:7], s81 offen offset:0
 buffer_load_dwordx4 v[52:55], v1, s[4:7], s81 offen offset:1024
 buffer_load_dwordx4 v[56:59], v1, s[4:7], s81 offen offset:2048
 buffer_load_dwordx4 v[60:63], v1, s[4:7], s81 offen offset:3072
 ds_read_b128 v[8:11], v3 offset:49152
 ds_read_b128 v[12:15], v3 offset:49152
 ds_read_b128 v[16:19], v3 offset:49152
 ds_read_b128 v[20:23], v3 offset:49152
 s_waitcnt vmcnt(0) lgkmcnt(0)
 s_cmp_lg_u32 s80, 0
 s_cbranch_scc1 L_ch1_s
.p2align 6
L_ch1_f:
 s_mov_b32 s51, 0
L_pm_179:
 buffer_load_dwordx4 v[24:27], v1, s[4:7], s59 offen offset:0 sc1
 buffer_load_dwordx4 v[28:31], v1, s[4:7], s59 offen offset:1024 sc1
 s_waitcnt vmcnt(1)
 ds_write_b128 v1, v[24:27] offset:2048
 v_max_u32 v7, v24, v26
 s_waitcnt vmcnt(0)
 ds_write_b128 v1, v[28:31] offset:3072
 v_max3_u32 v7, v7, v28, v30
 v_cmp_eq_u32 vcc, -1, v7
 s_cbranch_vccnz L_rt_180
 v_smfmac_f32_16x16x64_bf16 v[16:19], v[24:27], v[32:39], v0
 ds_read_b128 v[32:35], v2 offset:14336
 ds_read_b128 v[36:39], v2 offset:15360
 v_smfmac_f32_16x16x64_bf16 v[20:23], v[24:27], v[40:47], v0
 ds_read_b128 v[40:43], v2 offset:12288
 ds_read_b128 v[44:47], v2 offset:13312
 v_smfmac_f32_16x16x64_bf16 v[16:19], v[28:31], v[48:55], v0
 v_smfmac_f32_16x16x64_bf16 v[20:23], v[28:31], v[56:63], v0
 s_waitcnt lgkmcnt(4)
 s_barrier
 buffer_load_dwordx4 v[56:59], v1, s[4:7], s101 offen offset:0
 v_smfmac_f32_16x16x64_bf16 v[8:11], v[24:27], v[200:207], v0
 v_smfmac_f32_16x16x64_bf16 v[12:15], v[24:27], v[192:199], v0
 ds_read_b128 v[24:27], v1 offset:0
 buffer_load_dwordx4 v[60:63], v1, s[4:7], s101 offen offset:1024
 v_smfmac_f32_16x16x64_bf16 v[8:11], v[28:31], v[184:191], v0
 v_smfmac_f32_16x16x64_bf16 v[12:15], v[28:31], v[176:183], v0
 ds_read_b128 v[28:31], v1 offset:1024
 buffer_load_dwordx4 v[48:51], v1, s[4:7], s101 offen offset:2048
 s_waitcnt lgkmcnt(1)
 v_smfmac_f32_16x16x64_bf16 v[16:19], v[24:27], v[32:39], v0
 ds_read_b128 v[32:35], v2 offset:10240
 ds_read_b128 v[36:39], v2 offset:11264
 v_smfmac_f32_16x16x64_bf16 v[8:11], v[24:27], v[240:247], v0
 buffer_load_dwordx4 v[52:55], v1, s[4:7], s101 offen offset:3072
 v_smfmac_f32_16x16x64_bf16 v[12:15], v[24:27], v[248:255], v0
 v_smfmac_f32_16x16x64_bf16 v[20:23], v[24:27], v[40:47], v0
 ds_read_b128 v[40:43], v2 offset:8192
 ds_read_b128 v[44:47], v2 offset:9216
 ds_read_b128 v[24:27], v1 offset:4096
 s_waitcnt lgkmcnt(5)
 v_smfmac_f32_16x16x64_bf16 v[8:11], v[28:31], v[224:231], v0
 v_smfmac_f32_16x16x64_bf16 v[12:15], v[28:31], v[216:223], v0
 s_waitcnt lgkmcnt(3)
 v_smfmac_f32_16x16x64_bf16 v[16:19], v[28:31], v[32:39], v0
 ds_read_b128 v[32:35], v1 offset:47104
 ds_read_b128 v[36:39], v1 offset:48128
 v_smfmac_f32_16x16x64_bf16 v[20:23], v[28:31], v[152:159], v0
 ds_read_b128 v[28:31], v1 offset:5120
 s_waitcnt lgkmcnt(3)
 v_smfmac_f32_16x16x64_bf16 v[8:11], v[24:27], v[160:167], v0
 v_smfmac_f32_16x16x64_bf16 v[16:19], v[24:27], v[40:47], v0
 ds_read_b128 v[40:43], v1 offset:45056
 ds_read_b128 v[44:47], v1 offset:46080
 v_smfmac_f32_16x16x64_bf16 v[12:15], v[24:27], v[144:151], v0
 v_smfmac_f32_16x16x64_bf16 v[20:23], v[24:27], v[168:175], v0
 ds_read_b128 v[24:27], v1 offset:6144
 s_waitcnt lgkmcnt(3)
 v_smfmac_f32_16x16x64_bf16 v[16:19], v[28:31], v[32:39], v0
 ds_read_b128 v[32:35], v1 offset:43008
 ds_read_b128 v[36:39], v1 offset:44032
 v_smfmac_f32_16x16x64_bf16 v[8:11], v[28:31], v[136:143], v0
 v_smfmac_f32_16x16x64_bf16 v[12:15], v[28:31], v[128:135], v0
 s_waitcnt lgkmcnt(3)
 v_smfmac_f32_16x16x64_bf16 v[20:23], v[28:31], v[40:47], v0
 ds_read_b128 v[40:43], v1 offset:40960
 ds_read_b128 v[44:47], v1 offset:41984
 ds_read_b128 v[28:31], v1 offset:7168
 s_waitcnt lgkmcnt(5)
 v_smfmac_f32_16x16x64_bf16 v[8:11], v[24:27], a[144:151], v0
 v_smfmac_f32_16x16x64_bf16 v[12:15], v[24:27], a[128:135], v0
 s_waitcnt lgkmcnt(3)
 v_smfmac_f32_16x16x64_bf16 v[16:19], v[24:27], v[32:39], v0
 ds_read_b128 v[32:35], v1 offset:22528
 ds_read_b128 v[36:39], v1 offset:23552
 s_waitcnt vmcnt(2)
 v_smfmac_f32_16x16x64_bf16 v[20:23], v[24:27], v[56:63], v0
 ds_read_b128 v[24:27], v1 offset:8192
 buffer_load_dwordx4 v[56:59], v1, s[4:7], s61 offen offset:1024 sc1 nt
 s_waitcnt lgkmcnt(3)
 v_smfmac_f32_16x16x64_bf16 v[8:11], v[28:31], a[104:111], v0
 v_smfmac_f32_16x16x64_bf16 v[16:19], v[28:31], v[40:47], v0
 ds_read_b128 v[40:43], v1 offset:20480
 ds_read_b128 v[44:47], v1 offset:21504
 s_add_u32 s3, s61, 4096
 buffer_load_dwordx4 v[60:63], v1, s[4:7], s3 offen offset:1024 sc1 nt
 v_smfmac_f32_16x16x64_bf16 v[12:15], v[28:31], a[88:95], v0
 v_smfmac_f32_16x16x64_bf16 v[20:23], v[28:31], v[208:215], v0
 ds_read_b128 v[28:31], v1 offset:9216
 s_waitcnt lgkmcnt(3)
 v_smfmac_f32_16x16x64_bf16 v[16:19], v[24:27], v[32:39], v0
 v_smfmac_f32_16x16x64_bf16 v[8:11], v[24:27], a[80:87], v0
 s_add_u32 s3, s61, 67110912
 buffer_load_dwordx4 v[32:35], v1, s[4:7], s3 offen offset:0 sc1 nt
 v_smfmac_f32_16x16x64_bf16 v[12:15], v[24:27], a[72:79], v0
 s_waitcnt lgkmcnt(1)
 v_smfmac_f32_16x16x64_bf16 v[20:23], v[24:27], v[40:47], v0
 ds_read_b128 v[40:43], v3 offset:49152
 ds_read_b128 v[44:47], v3 offset:49152
 buffer_load_dwordx4 v[36:39], v1, s[4:7], s3 offen offset:1024 sc1 nt
 s_waitcnt lgkmcnt(2)
 v_smfmac_f32_16x16x64_bf16 v[8:11], v[28:31], a[32:39], v0
 v_smfmac_f32_16x16x64_bf16 v[12:15], v[28:31], a[24:31], v0
 v_lshlrev_b32 v7, 3, v1
 v_smfmac_f32_16x16x64_bf16 v[16:19], v[28:31], v[232:239], v0
 s_waitcnt vmcnt(4)
 v_smfmac_f32_16x16x64_bf16 v[20:23], v[28:31], v[48:55], v0
 s_add_u32 s3, s61, 524288
 buffer_load_dword v7, v7, s[4:7], s3 offen sc1
 ds_read_b128 v[52:55], v1 offset:0
 v_add_f32 v8, v8, v10
 v_add_f32 v11, v9, v11
 v_cvt_pk_bf16_f32 v9, v8, v11
 v_cvt_pk_bf16_f32 v8, v8, v11
 v_add_f32 v12, v12, v14
 v_add_f32 v15, v13, v15
 v_cvt_pk_bf16_f32 v13, v12, v15
 v_cvt_pk_bf16_f32 v12, v12, v15
 v_mfma_f32_16x16x16_bf16 v[8:11], v[8:9], v[4:5], 0
 v_mfma_f32_16x16x16_bf16 v[12:15], v[12:13], v[4:5], 0
 v_add_f32 v16, v16, v18
 v_add_f32 v19, v17, v19
 v_cvt_pk_bf16_f32 v17, v16, v19
 v_cvt_pk_bf16_f32 v16, v16, v19
 v_add_f32 v20, v20, v22
 v_add_f32 v23, v21, v23
 v_cvt_pk_bf16_f32 v21, v20, v23
 v_cvt_pk_bf16_f32 v20, v20, v23
 v_mfma_f32_16x16x16_bf16 v[16:19], v[16:17], v[4:5], 0
 v_mfma_f32_16x16x16_bf16 v[20:23], v[20:21], v[4:5], 0
 s_waitcnt lgkmcnt(2)
 v_smfmac_f32_16x16x64_bf16 v[40:43], v[24:27], v[96:103], v0
 s_waitcnt lgkmcnt(1)
 v_smfmac_f32_16x16x64_bf16 v[44:47], v[24:27], v[104:111], v0
 ds_read_b128 v[24:27], v1 offset:1024
 v_cvt_pk_bf16_f32 v15, v14, v15
 v_cvt_pk_bf16_f32 v14, v12, v13
 v_cvt_pk_bf16_f32 v13, v10, v11
 v_cvt_pk_bf16_f32 v12, v8, v9
 s_waitcnt vmcnt(4)
 s_nop 0
 v_mfma_f32_16x16x32_bf16 v[8:11], v[56:59], v[12:15], 0
 v_cvt_pk_bf16_f32 v23, v22, v23
 v_cvt_pk_bf16_f32 v22, v20, v21
 v_cvt_pk_bf16_f32 v21, v18, v19
 v_cvt_pk_bf16_f32 v20, v16, v17
 s_waitcnt vmcnt(3)
 v_mfma_f32_16x16x32_bf16 v[16:19], v[60:63], v[12:15], 0
 v_mfma_f32_16x16x32_bf16 v[48:51], v[20:23], v[12:15], 0
 v_smfmac_f32_16x16x64_bf16 v[40:43], v[28:31], v[112:119], v0
 v_smfmac_f32_16x16x64_bf16 v[44:47], v[28:31], v[120:127], v0
 ds_read_b128 v[28:31], v1 offset:2048
 s_waitcnt lgkmcnt(2)
 v_smfmac_f32_16x16x64_bf16 v[40:43], v[52:55], a[160:167], v0
 v_cndmask_b32 v8, v8, v16, s[70:71]
 v_cndmask_b32 v9, v9, v17, s[70:71]
 v_cndmask_b32 v10, v10, v18, s[70:71]
 v_cndmask_b32 v11, v11, v19, s[70:71]
 ds_write_b128 v1, v[8:11] offset:11264
 ds_write_b64 v1, v[48:49] offset:14344
 v_smfmac_f32_16x16x64_bf16 v[44:47], v[52:55], a[168:175], v0
 ds_read_b128 v[52:55], v1 offset:3072
 s_waitcnt lgkmcnt(4)
 v_smfmac_f32_16x16x64_bf16 v[40:43], v[24:27], a[176:183], v0
 v_smfmac_f32_16x16x64_bf16 v[44:47], v[24:27], a[184:191], v0
 ds_read_b128 v[24:27], v1 offset:4096
 s_waitcnt lgkmcnt(4)
 v_smfmac_f32_16x16x64_bf16 v[40:43], v[28:31], a[192:199], v0
 v_smfmac_f32_16x16x64_bf16 v[44:47], v[28:31], a[200:207], v0
 ds_read_b128 v[28:31], v1 offset:5120
 s_waitcnt lgkmcnt(2)
 v_smfmac_f32_16x16x64_bf16 v[40:43], v[52:55], a[208:215], v0
 v_smfmac_f32_16x16x64_bf16 v[44:47], v[52:55], a[216:223], v0
 ds_read_b128 v[52:55], v1 offset:6144
 s_barrier
 ds_read_b128 v[56:59], v1 offset:10240
 ds_read_b128 v[60:63], v1 offset:12288
 ds_read_b128 v[16:19], v1 offset:13312
 ds_read_b128 v[12:15], v1 offset:14336
 ds_read_b128 v[48:51], v1 offset:15360
 s_waitcnt lgkmcnt(7)
 v_smfmac_f32_16x16x64_bf16 v[40:43], v[24:27], a[224:231], v0
 s_mov_b64 exec, s[68:69]
 buffer_store_dwordx4 v[20:23], v6, s[4:7], s62 offen offset:512 sc1
 s_mov_b64 exec, -1
 v_smfmac_f32_16x16x64_bf16 v[44:47], v[24:27], a[232:239], v0
 ds_read_b128 v[24:27], v1 offset:7168
 s_waitcnt lgkmcnt(7)
 v_smfmac_f32_16x16x64_bf16 v[40:43], v[28:31], a[240:247], v0
 v_smfmac_f32_16x16x64_bf16 v[44:47], v[28:31], a[248:255], v0
 s_waitcnt lgkmcnt(6)
 v_smfmac_f32_16x16x64_bf16 v[40:43], v[52:55], v[64:71], v0
 v_smfmac_f32_16x16x64_bf16 v[44:47], v[52:55], v[72:79], v0
 s_waitcnt lgkmcnt(0)
 v_smfmac_f32_16x16x64_bf16 v[40:43], v[24:27], v[80:87], v0
 v_smfmac_f32_16x16x64_bf16 v[44:47], v[24:27], v[88:95], v0
 v_pk_add_f32 v[8:9], v[8:9], v[56:57]
 v_pk_add_f32 v[10:11], v[10:11], v[58:59]
 v_pk_add_f32 v[60:61], v[60:61], v[16:17]
 v_pk_add_f32 v[62:63], v[62:63], v[18:19]
 v_pk_add_f32 v[12:13], v[12:13], v[14:15]
 v_pk_add_f32 v[48:49], v[48:49], v[50:51]
 v_pk_add_f32 v[8:9], v[8:9], v[60:61]
 v_pk_add_f32 v[10:11], v[10:11], v[62:63]
 v_pk_add_f32 v[48:49], v[12:13], v[48:49]
 v_max3_f32 v50, v8, v9, v10
 v_max3_f32 v50, v50, v11, v48
 v_max_f32 v50, v50, v49
 v_add_f32 v40, v40, v42
 v_add_f32 v41, v41, v43
 v_max_f32_dpp v50, v50, v50 quad_perm:[2,3,0,1] row_mask:0xf bank_mask:0xf
 v_mov_b32 v51, v50
 v_add_f32 v44, v44, v46
 v_add_f32 v45, v45, v47
 v_permlane16_swap_b32 v50, v51
 v_max_f32 v50, v50, v51
 v_mov_b32 v51, v50
 v_cvt_pk_bf16_f32 v40, v40, v41
 v_cvt_pk_bf16_f32 v41, v44, v45
 v_permlane32_swap_b32 v50, v51
 v_max_f32 v50, v50, v51
 v_mul_f32 v50, s56, v50
 v_fma_f32 v48, v48, s56, -v50
 v_fma_f32 v49, v49, s56, -v50
 v_fma_f32 v8, v8, s56, -v50
 v_fma_f32 v9, v9, s56, -v50
 v_fma_f32 v10, v10, s56, -v50
 v_fma_f32 v11, v11, s56, -v50
 v_exp_f32 v48, v48
 v_lshrrev_b32 v51, 1, v1
 v_exp_f32 v49, v49
 ds_read_b128 v[56:59], v3 offset:26624
 ds_read_b128 v[60:63], v3 offset:27648
 v_exp_f32 v8, v8
 v_exp_f32 v9, v9
 ds_read_b128 v[24:27], v2 offset:45056
 ds_read_b128 v[28:31], v2 offset:46080
 v_exp_f32 v10, v10
 buffer_store_dwordx2 v[40:41], v51, s[4:7], s62 offen offset:2560 sc1
 v_exp_f32 v11, v11
 v_cvt_pk_bf16_f32 v14, v48, v49
 v_cvt_pk_bf16_f32 v12, v8, v9
 v_cvt_pk_bf16_f32 v13, v10, v11
 v_cndmask_b32 v52, 0, v14, s[68:69]
 v_cndmask_b32 v53, 0, v14, s[70:71]
 v_cndmask_b32 v22, 0, v12, s[70:71]
 v_cndmask_b32 v23, 0, v13, s[70:71]
 v_mfma_f32_16x16x16_bf16 v[44:47], v[40:41], v[52:53], 0
 v_cndmask_b32 v16, 0, v12, s[68:69]
 v_cndmask_b32 v17, 0, v13, s[68:69]
 v_mov_b32_dpp v18, v22 quad_perm:[2,3,0,1] row_mask:0xf bank_mask:0xf
 v_mov_b32_dpp v19, v23 quad_perm:[2,3,0,1] row_mask:0xf bank_mask:0xf
 v_mov_b32_dpp v20, v16 quad_perm:[2,3,0,1] row_mask:0xf bank_mask:0xf
 v_mov_b32_dpp v21, v17 quad_perm:[2,3,0,1] row_mask:0xf bank_mask:0xf
 s_waitcnt vmcnt(4)
 v_mfma_f32_16x16x32_bf16 v[44:47], v[32:35], v[16:19], v[44:47]
 v_add_f32 v54, v8, v9
 v_add_f32 v55, v48, v49
 s_waitcnt vmcnt(3)
 v_mfma_f32_16x16x32_bf16 v[44:47], v[36:39], v[20:23], v[44:47]
 v_add_f32 v54, v54, v10
 v_fma_f32 v55, v55, 0.5, v11
 v_add_f32 v54, v54, v55
 ds_read_b128 v[16:19], v3 offset:49152
 ds_read_b128 v[20:23], v3 offset:49152
 v_add_f32_dpp v54, v54, v54 quad_perm:[2,3,0,1] row_mask:0xf bank_mask:0xf
 v_mov_b32 v55, v54
 ds_read_b128 v[32:35], v3 offset:49152
 ds_read_b128 v[36:39], v3 offset:49152
 v_permlane16_swap_b32 v54, v55
 v_add_f32 v54, v54, v55
 v_mov_b32 v55, v54
 ds_read_b128 v[8:11], v3 offset:49152
 s_cmp_eq_u32 s54, 63
 v_permlane32_swap_b32 v54, v55
 v_add_f32 v54, v54, v55
 v_rcp_f32 v54, v54
 s_cbranch_scc1 L_ch1_end
 v_mul_f32 v44, v44, v54
 v_mul_f32 v45, v45, v54
 v_cvt_pk_bf16_f32 v42, v44, v45
 v_mul_f32 v46, v46, v54
 v_mul_f32 v47, v47, v54
 v_cvt_pk_bf16_f32 v43, v46, v47
 ds_write_b64 v6, v[42:43] offset:512
 v_and_b32 v40, -9, v6
 v_mov_b32_dpp v12, v42 quad_perm:[0,1,0,1] row_mask:0xf bank_mask:0xf
 v_mov_b32_dpp v14, v42 quad_perm:[2,3,2,3] row_mask:0xf bank_mask:0xf
 v_mov_b32_dpp v13, v43 quad_perm:[0,1,0,1] row_mask:0xf bank_mask:0xf
 v_mov_b32_dpp v15, v43 quad_perm:[2,3,2,3] row_mask:0xf bank_mask:0xf
 s_waitcnt lgkmcnt(5)
 s_nop 0
 v_smfmac_f32_16x16x64_bf16 v[16:19], v[12:15], a[8:15], v0
 s_waitcnt lgkmcnt(4)
 v_smfmac_f32_16x16x64_bf16 v[20:23], v[12:15], a[40:47], v0
 s_waitcnt lgkmcnt(0)
 s_barrier
 ds_read_b128 v[48:51], v40 offset:0
 ds_read_b128 v[52:55], v40 offset:1024
 ds_read_b128 v[44:47], v40 offset:1536
 v_smfmac_f32_16x16x64_bf16 v[32:35], v[12:15], v[56:63], v0
 ds_read_b128 v[56:59], v3 offset:30720
 ds_read_b128 v[60:63], v3 offset:31744
 s_mov_b32 m0, 10240
 v_smfmac_f32_16x16x64_bf16 v[36:39], v[12:15], v[24:31], v0
 ds_read_b128 v[24:27], v3 offset:28672
 ds_read_b128 v[28:31], v3 offset:29696
 buffer_load_dwordx4 v1, s[4:7], s63 offen offset:2048 lds
 v_smfmac_f32_16x16x64_bf16 v[8:11], v[12:15], a[136:143], v0
 s_mov_b32 m0, 10240
 s_waitcnt lgkmcnt(6)
 v_smfmac_f32_16x16x64_bf16 v[16:19], v[48:51], a[0:7], v0
 buffer_load_dwordx4 v1, s[4:7], s63 offen offset:3072 lds
 s_waitcnt lgkmcnt(5)
 v_smfmac_f32_16x16x64_bf16 v[16:19], v[52:55], a[16:23], v0
 s_mov_b32 m0, 2048
 s_waitcnt lgkmcnt(2)
 v_smfmac_f32_16x16x64_bf16 v[16:19], v[44:47], v[56:63], v0
 ds_read_b128 v[56:59], v3 offset:24576
 ds_read_b128 v[60:63], v3 offset:25600
 buffer_load_dwordx4 v1, s[4:7], s81 offen offset:0 lds
 s_waitcnt lgkmcnt(2)
 v_smfmac_f32_16x16x64_bf16 v[20:23], v[48:51], v[24:31], v0
 ds_read_b128 v[24:27], v2 offset:47104
 ds_read_b128 v[28:31], v2 offset:48128
 s_mov_b32 m0, 2048
 v_smfmac_f32_16x16x64_bf16 v[20:23], v[52:55], a[48:55], v0
 buffer_load_dwordx4 v1, s[4:7], s81 offen offset:1024 lds
 v_smfmac_f32_16x16x64_bf16 v[20:23], v[44:47], a[56:63], v0
 v_cvt_pk_bf16_f32 v16, v16, v17
 v_smfmac_f32_16x16x64_bf16 v[32:35], v[48:51], a[64:71], v0
 v_cvt_pk_bf16_f32 v17, v18, v19
 s_waitcnt lgkmcnt(2)
 v_smfmac_f32_16x16x64_bf16 v[32:35], v[52:55], v[56:63], v0
 ds_read_b128 v[56:59], v2 offset:43008
 ds_read_b128 v[60:63], v2 offset:44032
 v_and_or_b32 v16, v16, -2, s55
 s_waitcnt lgkmcnt(2)
 v_smfmac_f32_16x16x64_bf16 v[32:35], v[44:47], v[24:31], v0
 ds_read_b128 v[24:27], v2 offset:40960
 ds_read_b128 v[28:31], v2 offset:41984
 v_cvt_pk_bf16_f32 v18, v20, v21
 v_smfmac_f32_16x16x64_bf16 v[36:39], v[48:51], a[96:103], v0
 v_cvt_pk_bf16_f32 v19, v22, v23
 v_smfmac_f32_16x16x64_bf16 v[36:39], v[52:55], a[112:119], v0
 v_and_or_b32 v18, v18, -2, s55
 buffer_store_dwordx4 v[16:19], v1, s[4:7], s60 offen offset:0
 v_smfmac_f32_16x16x64_bf16 v[36:39], v[44:47], a[120:127], v0
 v_cvt_pk_bf16_f32 v32, v32, v33
 s_waitcnt lgkmcnt(2)
 v_smfmac_f32_16x16x64_bf16 v[8:11], v[48:51], v[56:63], v0
 v_cvt_pk_bf16_f32 v33, v34, v35
 s_waitcnt lgkmcnt(0)
 v_smfmac_f32_16x16x64_bf16 v[8:11], v[52:55], v[24:31], v0
 v_and_or_b32 v32, v32, -2, s55
 v_smfmac_f32_16x16x64_bf16 v[8:11], v[44:47], a[152:159], v0
 v_cvt_pk_bf16_f32 v34, v36, v37
 v_cvt_pk_bf16_f32 v35, v38, v39
 v_and_or_b32 v34, v34, -2, s55
 buffer_store_dwordx4 v[32:35], v1, s[4:7], s60 offen offset:1024
 s_nop 3
 v_cvt_pk_bf16_f32 v8, v8, v9
 v_cvt_pk_bf16_f32 v9, v10, v11
 v_and_or_b32 v8, v8, -2, s55
 buffer_store_dwordx2 v[8:9], v1, s[4:7], s16 offen offset:8
 buffer_load_dwordx4 v[32:35], v1, s[4:7], s63 offen offset:0
 buffer_load_dwordx4 v[36:39], v1, s[4:7], s63 offen offset:1024
 s_add_u32 s54, s54, 1
 s_add_u32 s61, s61, 524288
 s_and_b32 s3, s54, 7
 s_cselect_b32 s3, 1, -7
 s_lshl_b32 s3, s3, 17
 s_add_u32 s62, s62, s3
 s_and_b32 s3, s54, 3
 s_cselect_b32 s3, 1, -3
 s_lshl_b32 s3, s3, 14
 s_add_u32 s57, s57, s3
 s_add_u32 s59, s59, s3
 s_xor_b32 s58, s57, 32768
 v_lshrrev_b32 v56, 7, v1
 v_mul_u32_u24 v56, 10240, v56
 v_and_b32 v60, 112, v1
 v_add_u32 v56, v56, v60
 v_and_b32 v57, 32, v1
 v_and_b32 v60, 64, v1
 v_lshl_add_u32 v57, v60, 2, v57
 v_bfe_u32 v60, v1, 8, 1
 v_lshl_add_u32 v57, v60, 4, v57
 v_bfe_u32 v60, v1, 4, 1
 v_lshl_add_u32 v57, v60, 3, v57
 v_mov_b32 v60, 0x3f80
 v_mov_b32 v28, 0x3f800000
 v_cndmask_b32 v60, v60, v28, s[82:83]
 v_cndmask_b32 v28, 0, v60, s[72:73]
 v_cndmask_b32 v29, 0, v60, s[74:75]
 v_cndmask_b32 v30, 0, v60, s[76:77]
 v_cndmask_b32 v31, 0, v60, s[78:79]
 v_mov_b64 v[58:59], -1
 s_mov_b64 exec, s[84:85]
 buffer_store_dwordx2 v[58:59], v57, s[4:7], s58 offen
 s_mov_b64 exec, -1
 s_nop 15
 s_nop 15
 s_nop 15
 s_nop 15
 s_nop 15
 s_mov_b32 s51, 0
 buffer_load_dwordx4 v[8:11], v56, s[4:7], s64 offen sc1
 buffer_load_dwordx4 v[12:15], v56, s[4:7], s65 offen sc1
 buffer_load_dwordx4 v[16:19], v56, s[4:7], s66 offen sc1
 buffer_load_dwordx4 v[20:23], v56, s[4:7], s67 offen sc1
L_pp_181:
 s_waitcnt vmcnt(3)
 v_mfma_f32_16x16x32_bf16 v[24:27], v[28:31], v[8:11], 0
 v_bitop3_b32 v60, v8, v10, s55 bitop3:0x7e
 s_waitcnt vmcnt(2)
 v_mfma_f32_16x16x32_bf16 v[24:27], v[28:31], v[12:15], v[24:27]
 v_bitop3_b32 v61, v12, v14, s55 bitop3:0x7e
 s_waitcnt vmcnt(1)
 v_mfma_f32_16x16x32_bf16 v[24:27], v[28:31], v[16:19], v[24:27]
 v_bitop3_b32 v62, v16, v18, s55 bitop3:0x7e
 s_waitcnt vmcnt(0)
 v_mfma_f32_16x16x32_bf16 v[24:27], v[28:31], v[20:23], v[24:27]
 v_bitop3_b32 v63, v20, v22, s55 bitop3:0x7e
 v_or3_b32 v7, v60, v61, v62
 v_bitop3_b32 v7, v7, v63, 1 bitop3:0xa8
 v_cmp_ne_u32 vcc, 0, v7
 s_cbranch_vccnz L_rt_182
 s_nop 2
 v_add_f32_dpp v24, v24, v24 row_ror:8 row_mask:0xf bank_mask:0xf
 v_add_f32_dpp v25, v25, v25 row_ror:8 row_mask:0xf bank_mask:0xf
 v_add_f32_dpp v26, v26, v26 row_ror:8 row_mask:0xf bank_mask:0xf
 v_add_f32_dpp v27, v27, v27 row_ror:8 row_mask:0xf bank_mask:0xf
 s_mov_b64 exec, s[84:85]
 v_cvt_pk_bf16_f32 v24, v24, v25
 v_cvt_pk_bf16_f32 v25, v26, v27
 buffer_store_dwordx2 v[24:25], v57, s[4:7], s57 offen
 s_mov_b64 exec, -1
 s_xor_b32 s55, s55, 1
 ds_read_b128 v[40:43], v1 offset:12288
 ds_read_b128 v[44:47], v1 offset:13312
 ds_read_b128 v[48:51], v1 offset:2048
 ds_read_b128 v[52:55], v1 offset:3072
 buffer_load_dwordx4 v[56:59], v1, s[4:7], s81 offen offset:2048
 buffer_load_dwordx4 v[60:63], v1, s[4:7], s81 offen offset:3072
 ds_read_b128 v[8:11], v3 offset:49152
 ds_read_b128 v[12:15], v3 offset:49152
 ds_read_b128 v[16:19], v3 offset:49152
 ds_read_b128 v[20:23], v3 offset:49152
 s_waitcnt lgkmcnt(0)
 s_nop 15
 s_nop 15
 s_nop 7
 s_branch L_ch1_f
L_rt_180:
 s_add_u32 s51, s51, 1
 s_cmp_lt_u32 s51, 131072
 s_cbranch_scc1 L_pm_179
 s_branch L_bail
L_rt_182:
 buffer_load_dwordx4 v[8:11], v56, s[4:7], s64 offen sc1
 buffer_load_dwordx4 v[12:15], v56, s[4:7], s65 offen sc1
 buffer_load_dwordx4 v[16:19], v56, s[4:7], s66 offen sc1
 buffer_load_dwordx4 v[20:23], v56, s[4:7], s67 offen sc1
 s_add_u32 s51, s51, 1
 s_cmp_lt_u32 s51, 131072
 s_cbranch_scc1 L_pp_181
 s_branch L_bail
.p2align 6
L_ch1_s:
 s_mov_b32 s51, 0
L_pm_183:
 buffer_load_dwordx4 v[24:27], v1, s[4:7], s59 offen offset:0 sc1
 buffer_load_dwordx4 v[28:31], v1, s[4:7], s59 offen offset:1024 sc1
 s_waitcnt vmcnt(1)
 ds_write_b128 v1, v[24:27] offset:2048
 v_max_u32 v7, v24, v26
 s_waitcnt vmcnt(0)
 ds_write_b128 v1, v[28:31] offset:3072
 v_max3_u32 v7, v7, v28, v30
 v_cmp_eq_u32 vcc, -1, v7
 s_cbranch_vccnz L_rt_184
 v_smfmac_f32_16x16x64_bf16 v[16:19], v[24:27], v[32:39], v0
 ds_read_b128 v[32:35], v2 offset:14336
 ds_read_b128 v[36:39], v2 offset:15360
 v_smfmac_f32_16x16x64_bf16 v[20:23], v[24:27], v[40:47], v0
 ds_read_b128 v[40:43], v2 offset:12288
 ds_read_b128 v[44:47], v2 offset:13312
 v_smfmac_f32_16x16x64_bf16 v[16:19], v[28:31], v[48:55], v0
 v_smfmac_f32_16x16x64_bf16 v[20:23], v[28:31], v[56:63], v0
 s_waitcnt lgkmcnt(4)
 s_barrier
 buffer_load_dwordx4 v[56:59], v1, s[4:7], s101 offen offset:0
 v_smfmac_f32_16x16x64_bf16 v[8:11], v[24:27], v[200:207], v0
 v_smfmac_f32_16x16x64_bf16 v[12:15], v[24:27], v[192:199], v0
 ds_read_b128 v[24:27], v1 offset:0
 buffer_load_dwordx4 v[60:63], v1, s[4:7], s101 offen offset:1024
 v_smfmac_f32_16x16x64_bf16 v[8:11], v[28:31], v[184:191], v0
 v_smfmac_f32_16x16x64_bf16 v[12:15], v[28:31], v[176:183], v0
 ds_read_b128 v[28:31], v1 offset:1024
 buffer_load_dwordx4 v[48:51], v1, s[4:7], s101 offen offset:2048
 s_waitcnt lgkmcnt(1)
 v_smfmac_f32_16x16x64_bf16 v[16:19], v[24:27], v[32:39], v0
 ds_read_b128 v[32:35], v2 offset:10240
 ds_read_b128 v[36:39], v2 offset:11264
 v_smfmac_f32_16x16x64_bf16 v[8:11], v[24:27], v[240:247], v0
 buffer_load_dwordx4 v[52:55], v1, s[4:7], s101 offen offset:3072
 v_smfmac_f32_16x16x64_bf16 v[12:15], v[24:27], v[248:255], v0
 v_smfmac_f32_16x16x64_bf16 v[20:23], v[24:27], v[40:47], v0
 ds_read_b128 v[40:43], v2 offset:8192
 ds_read_b128 v[44:47], v2 offset:9216
 ds_read_b128 v[24:27], v1 offset:4096
 s_waitcnt lgkmcnt(5)
 v_smfmac_f32_16x16x64_bf16 v[8:11], v[28:31], v[224:231], v0
 v_smfmac_f32_16x16x64_bf16 v[12:15], v[28:31], v[216:223], v0
 s_waitcnt lgkmcnt(3)
 v_smfmac_f32_16x16x64_bf16 v[16:19], v[28:31], v[32:39], v0
 ds_read_b128 v[32:35], v1 offset:47104
 ds_read_b128 v[36:39], v1 offset:48128
 v_smfmac_f32_16x16x64_bf16 v[20:23], v[28:31], v[152:159], v0
 ds_read_b128 v[28:31], v1 offset:5120
 s_waitcnt lgkmcnt(3)
 v_smfmac_f32_16x16x64_bf16 v[8:11], v[24:27], v[160:167], v0
 v_smfmac_f32_16x16x64_bf16 v[16:19], v[24:27], v[40:47], v0
 ds_read_b128 v[40:43], v1 offset:45056
 ds_read_b128 v[44:47], v1 offset:46080
 v_smfmac_f32_16x16x64_bf16 v[12:15], v[24:27], v[144:151], v0
 v_smfmac_f32_16x16x64_bf16 v[20:23], v[24:27], v[168:175], v0
 ds_read_b128 v[24:27], v1 offset:6144
 s_waitcnt lgkmcnt(3)
 v_smfmac_f32_16x16x64_bf16 v[16:19], v[28:31], v[32:39], v0
 ds_read_b128 v[32:35], v1 offset:43008
 ds_read_b128 v[36:39], v1 offset:44032
 v_smfmac_f32_16x16x64_bf16 v[8:11], v[28:31], v[136:143], v0
 v_smfmac_f32_16x16x64_bf16 v[12:15], v[28:31], v[128:135], v0
 s_waitcnt lgkmcnt(3)
 v_smfmac_f32_16x16x64_bf16 v[20:23], v[28:31], v[40:47], v0
 ds_read_b128 v[40:43], v1 offset:40960
 ds_read_b128 v[44:47], v1 offset:41984
 ds_read_b128 v[28:31], v1 offset:7168
 s_waitcnt lgkmcnt(5)
 v_smfmac_f32_16x16x64_bf16 v[8:11], v[24:27], a[144:151], v0
 v_smfmac_f32_16x16x64_bf16 v[12:15], v[24:27], a[128:135], v0
 s_waitcnt lgkmcnt(3)
 v_smfmac_f32_16x16x64_bf16 v[16:19], v[24:27], v[32:39], v0
 ds_read_b128 v[32:35], v1 offset:22528
 ds_read_b128 v[36:39], v1 offset:23552
 s_waitcnt vmcnt(2)
 v_smfmac_f32_16x16x64_bf16 v[20:23], v[24:27], v[56:63], v0
 ds_read_b128 v[24:27], v1 offset:8192
 buffer_load_dwordx4 v[56:59], v1, s[4:7], s61 offen offset:1024 sc1 nt
 s_waitcnt lgkmcnt(3)
 v_smfmac_f32_16x16x64_bf16 v[8:11], v[28:31], a[104:111], v0
 v_smfmac_f32_16x16x64_bf16 v[16:19], v[28:31], v[40:47], v0
 ds_read_b128 v[40:43], v1 offset:20480
 ds_read_b128 v[44:47], v1 offset:21504
 s_add_u32 s3, s61, 4096
 buffer_load_dwordx4 v[60:63], v1, s[4:7], s3 offen offset:1024 sc1 nt
 v_smfmac_f32_16x16x64_bf16 v[12:15], v[28:31], a[88:95], v0
 v_smfmac_f32_16x16x64_bf16 v[20:23], v[28:31], v[208:215], v0
 ds_read_b128 v[28:31], v1 offset:9216
 s_waitcnt lgkmcnt(3)
 v_smfmac_f32_16x16x64_bf16 v[16:19], v[24:27], v[32:39], v0
 v_smfmac_f32_16x16x64_bf16 v[8:11], v[24:27], a[80:87], v0
 s_add_u32 s3, s61, 67110912
 buffer_load_dwordx4 v[32:35], v1, s[4:7], s3 offen offset:0 sc1 nt
 v_smfmac_f32_16x16x64_bf16 v[12:15], v[24:27], a[72:79], v0
 s_waitcnt lgkmcnt(1)
 v_smfmac_f32_16x16x64_bf16 v[20:23], v[24:27], v[40:47], v0
 ds_read_b128 v[40:43], v3 offset:49152
 ds_read_b128 v[44:47], v3 offset:49152
 buffer_load_dwordx4 v[36:39], v1, s[4:7], s3 offen offset:1024 sc1 nt
 s_waitcnt lgkmcnt(2)
 v_smfmac_f32_16x16x64_bf16 v[8:11], v[28:31], a[32:39], v0
 v_smfmac_f32_16x16x64_bf16 v[12:15], v[28:31], a[24:31], v0
 v_lshlrev_b32 v7, 3, v1
 v_smfmac_f32_16x16x64_bf16 v[16:19], v[28:31], v[232:239], v0
 s_waitcnt vmcnt(4)
 v_smfmac_f32_16x16x64_bf16 v[20:23], v[28:31], v[48:55], v0
 s_add_u32 s3, s61, 524288
 buffer_load_dword v7, v7, s[4:7], s3 offen sc1
 ds_read_b128 v[52:55], v1 offset:0
 v_add_f32 v8, v8, v10
 v_add_f32 v11, v9, v11
 v_cvt_pk_bf16_f32 v9, v8, v11
 v_cvt_pk_bf16_f32 v8, v8, v11
 v_add_f32 v12, v12, v14
 v_add_f32 v15, v13, v15
 v_cvt_pk_bf16_f32 v13, v12, v15
 v_cvt_pk_bf16_f32 v12, v12, v15
 v_mfma_f32_16x16x16_bf16 v[8:11], v[8:9], v[4:5], 0
 v_mfma_f32_16x16x16_bf16 v[12:15], v[12:13], v[4:5], 0
 v_add_f32 v16, v16, v18
 v_add_f32 v19, v17, v19
 v_cvt_pk_bf16_f32 v17, v16, v19
 v_cvt_pk_bf16_f32 v16, v16, v19
 v_add_f32 v20, v20, v22
 v_add_f32 v23, v21, v23
 v_cvt_pk_bf16_f32 v21, v20, v23
 v_cvt_pk_bf16_f32 v20, v20, v23
 v_mfma_f32_16x16x16_bf16 v[16:19], v[16:17], v[4:5], 0
 v_mfma_f32_16x16x16_bf16 v[20:23], v[20:21], v[4:5], 0
 s_waitcnt lgkmcnt(2)
 v_smfmac_f32_16x16x64_bf16 v[40:43], v[24:27], v[96:103], v0
 s_waitcnt lgkmcnt(1)
 v_smfmac_f32_16x16x64_bf16 v[44:47], v[24:27], v[104:111], v0
 ds_read_b128 v[24:27], v1 offset:1024
 v_cvt_pk_bf16_f32 v15, v14, v15
 v_cvt_pk_bf16_f32 v14, v12, v13
 v_cvt_pk_bf16_f32 v13, v10, v11
 v_cvt_pk_bf16_f32 v12, v8, v9
 s_waitcnt vmcnt(4)
 s_nop 0
 v_mfma_f32_16x16x32_bf16 v[8:11], v[56:59], v[12:15], 0
 v_cvt_pk_bf16_f32 v23, v22, v23
 v_cvt_pk_bf16_f32 v22, v20, v21
 v_cvt_pk_bf16_f32 v21, v18, v19
 v_cvt_pk_bf16_f32 v20, v16, v17
 s_waitcnt vmcnt(3)
 v_mfma_f32_16x16x32_bf16 v[16:19], v[60:63], v[12:15], 0
 v_mfma_f32_16x16x32_bf16 v[48:51], v[20:23], v[12:15], 0
 v_smfmac_f32_16x16x64_bf16 v[40:43], v[28:31], v[112:119], v0
 v_smfmac_f32_16x16x64_bf16 v[44:47], v[28:31], v[120:127], v0
 ds_read_b128 v[28:31], v1 offset:2048
 s_waitcnt lgkmcnt(2)
 v_smfmac_f32_16x16x64_bf16 v[40:43], v[52:55], a[160:167], v0
 v_cndmask_b32 v8, v8, v16, s[70:71]
 v_cndmask_b32 v9, v9, v17, s[70:71]
 v_cndmask_b32 v10, v10, v18, s[70:71]
 v_cndmask_b32 v11, v11, v19, s[70:71]
 ds_write_b128 v1, v[8:11] offset:11264
 ds_write_b64 v1, v[48:49] offset:14344
 v_smfmac_f32_16x16x64_bf16 v[44:47], v[52:55], a[168:175], v0
 ds_read_b128 v[52:55], v1 offset:3072
 s_waitcnt lgkmcnt(4)
 v_smfmac_f32_16x16x64_bf16 v[40:43], v[24:27], a[176:183], v0
 v_smfmac_f32_16x16x64_bf16 v[44:47], v[24:27], a[184:191], v0
 ds_read_b128 v[24:27], v1 offset:4096
 s_waitcnt lgkmcnt(4)
 v_smfmac_f32_16x16x64_bf16 v[40:43], v[28:31], a[192:199], v0
 v_smfmac_f32_16x16x64_bf16 v[44:47], v[28:31], a[200:207], v0
 ds_read_b128 v[28:31], v1 offset:5120
 s_waitcnt lgkmcnt(2)
 v_smfmac_f32_16x16x64_bf16 v[40:43], v[52:55], a[208:215], v0
 v_smfmac_f32_16x16x64_bf16 v[44:47], v[52:55], a[216:223], v0
 ds_read_b128 v[52:55], v1 offset:6144
 s_barrier
 ds_read_b128 v[56:59], v1 offset:10240
 ds_read_b128 v[60:63], v1 offset:12288
 ds_read_b128 v[16:19], v1 offset:13312
 ds_read_b128 v[12:15], v1 offset:14336
 ds_read_b128 v[48:51], v1 offset:15360
 s_waitcnt lgkmcnt(7)
 v_smfmac_f32_16x16x64_bf16 v[40:43], v[24:27], a[224:231], v0
 s_mov_b64 exec, s[68:69]
 buffer_store_dwordx4 v[20:23], v6, s[4:7], s62 offen offset:512 sc1
 s_mov_b64 exec, -1
 v_smfmac_f32_16x16x64_bf16 v[44:47], v[24:27], a[232:239], v0
 ds_read_b128 v[24:27], v1 offset:7168
 s_waitcnt lgkmcnt(7)
 v_smfmac_f32_16x16x64_bf16 v[40:43], v[28:31], a[240:247], v0
 v_smfmac_f32_16x16x64_bf16 v[44:47], v[28:31], a[248:255], v0
 s_waitcnt lgkmcnt(6)
 v_smfmac_f32_16x16x64_bf16 v[40:43], v[52:55], v[64:71], v0
 v_smfmac_f32_16x16x64_bf16 v[44:47], v[52:55], v[72:79], v0
 s_waitcnt lgkmcnt(0)
 v_smfmac_f32_16x16x64_bf16 v[40:43], v[24:27], v[80:87], v0
 v_smfmac_f32_16x16x64_bf16 v[44:47], v[24:27], v[88:95], v0
 v_pk_add_f32 v[8:9], v[8:9], v[56:57]
 v_pk_add_f32 v[10:11], v[10:11], v[58:59]
 v_pk_add_f32 v[60:61], v[60:61], v[16:17]
 v_pk_add_f32 v[62:63], v[62:63], v[18:19]
 v_pk_add_f32 v[12:13], v[12:13], v[14:15]
 v_pk_add_f32 v[48:49], v[48:49], v[50:51]
 v_pk_add_f32 v[8:9], v[8:9], v[60:61]
 v_pk_add_f32 v[10:11], v[10:11], v[62:63]
 v_pk_add_f32 v[48:49], v[12:13], v[48:49]
 v_max3_f32 v50, v8, v9, v10
 v_max3_f32 v50, v50, v11, v48
 v_max_f32 v50, v50, v49
 v_add_f32 v40, v40, v42
 v_add_f32 v41, v41, v43
 v_max_f32_dpp v50, v50, v50 quad_perm:[2,3,0,1] row_mask:0xf bank_mask:0xf
 v_mov_b32 v51, v50
 v_add_f32 v44, v44, v46
 v_add_f32 v45, v45, v47
 v_permlane16_swap_b32 v50, v51
 v_max_f32 v50, v50, v51
 v_mov_b32 v51, v50
 v_cvt_pk_bf16_f32 v40, v40, v41
 v_cvt_pk_bf16_f32 v41, v44, v45
 v_permlane32_swap_b32 v50, v51
 v_max_f32 v50, v50, v51
 v_mul_f32 v50, s56, v50
 v_fma_f32 v48, v48, s56, -v50
 v_fma_f32 v49, v49, s56, -v50
 v_fma_f32 v8, v8, s56, -v50
 v_fma_f32 v9, v9, s56, -v50
 v_fma_f32 v10, v10, s56, -v50
 v_fma_f32 v11, v11, s56, -v50
 v_exp_f32 v48, v48
 v_lshrrev_b32 v51, 1, v1
 v_exp_f32 v49, v49
 ds_read_b128 v[56:59], v3 offset:26624
 ds_read_b128 v[60:63], v3 offset:27648
 v_exp_f32 v8, v8
 v_exp_f32 v9, v9
 ds_read_b128 v[24:27], v2 offset:45056
 ds_read_b128 v[28:31], v2 offset:46080
 v_exp_f32 v10, v10
 buffer_store_dwordx2 v[40:41], v51, s[4:7], s62 offen offset:2560 sc1
 v_exp_f32 v11, v11
 v_cvt_pk_bf16_f32 v14, v48, v49
 v_cvt_pk_bf16_f32 v12, v8, v9
 v_cvt_pk_bf16_f32 v13, v10, v11
 v_cndmask_b32 v52, 0, v14, s[68:69]
 v_cndmask_b32 v53, 0, v14, s[70:71]
 v_cndmask_b32 v22, 0, v12, s[70:71]
 v_cndmask_b32 v23, 0, v13, s[70:71]
 v_mfma_f32_16x16x16_bf16 v[44:47], v[40:41], v[52:53], 0
 v_cndmask_b32 v16, 0, v12, s[68:69]
 v_cndmask_b32 v17, 0, v13, s[68:69]
 v_mov_b32_dpp v18, v22 quad_perm:[2,3,0,1] row_mask:0xf bank_mask:0xf
 v_mov_b32_dpp v19, v23 quad_perm:[2,3,0,1] row_mask:0xf bank_mask:0xf
 v_mov_b32_dpp v20, v16 quad_perm:[2,3,0,1] row_mask:0xf bank_mask:0xf
 v_mov_b32_dpp v21, v17 quad_perm:[2,3,0,1] row_mask:0xf bank_mask:0xf
 s_waitcnt vmcnt(4)
 v_mfma_f32_16x16x32_bf16 v[44:47], v[32:35], v[16:19], v[44:47]
 v_add_f32 v54, v8, v9
 v_add_f32 v55, v48, v49
 s_waitcnt vmcnt(3)
 v_mfma_f32_16x16x32_bf16 v[44:47], v[36:39], v[20:23], v[44:47]
 v_add_f32 v54, v54, v10
 v_fma_f32 v55, v55, 0.5, v11
 v_add_f32 v54, v54, v55
 ds_read_b128 v[16:19], v3 offset:49152
 ds_read_b128 v[20:23], v3 offset:49152
 v_add_f32_dpp v54, v54, v54 quad_perm:[2,3,0,1] row_mask:0xf bank_mask:0xf
 v_mov_b32 v55, v54
 ds_read_b128 v[32:35], v3 offset:49152
 ds_read_b128 v[36:39], v3 offset:49152
 v_permlane16_swap_b32 v54, v55
 v_add_f32 v54, v54, v55
 v_mov_b32 v55, v54
 ds_read_b128 v[8:11], v3 offset:49152
 s_cmp_eq_u32 s54, 63
 v_permlane32_swap_b32 v54, v55
 v_add_f32 v54, v54, v55
 v_rcp_f32 v54, v54
 s_cbranch_scc1 L_ch1_end
 v_mul_f32 v44, v44, v54
 v_mul_f32 v45, v45, v54
 v_cvt_pk_bf16_f32 v42, v44, v45
 v_mul_f32 v46, v46, v54
 v_mul_f32 v47, v47, v54
 v_cvt_pk_bf16_f32 v43, v46, v47
 ds_write_b64 v6, v[42:43] offset:512
 v_and_b32 v40, -9, v6
 v_mov_b32_dpp v12, v42 quad_perm:[0,1,0,1] row_mask:0xf bank_mask:0xf
 v_mov_b32_dpp v14, v42 quad_perm:[2,3,2,3] row_mask:0xf bank_mask:0xf
 v_mov_b32_dpp v13, v43 quad_perm:[0,1,0,1] row_mask:0xf bank_mask:0xf
 v_mov_b32_dpp v15, v43 quad_perm:[2,3,2,3] row_mask:0xf bank_mask:0xf
 s_waitcnt lgkmcnt(5)
 s_nop 0
 v_smfmac_f32_16x16x64_bf16 v[16:19], v[12:15], a[8:15], v0
 s_waitcnt lgkmcnt(4)
 v_smfmac_f32_16x16x64_bf16 v[20:23], v[12:15], a[40:47], v0
 s_waitcnt lgkmcnt(0)
 s_barrier
 ds_read_b128 v[48:51], v40 offset:0
 ds_read_b128 v[52:55], v40 offset:1024
 ds_read_b128 v[44:47], v40 offset:1536
 v_smfmac_f32_16x16x64_bf16 v[32:35], v[12:15], v[56:63], v0
 ds_read_b128 v[56:59], v3 offset:30720
 ds_read_b128 v[60:63], v3 offset:31744
 s_mov_b32 m0, 10240
 v_smfmac_f32_16x16x64_bf16 v[36:39], v[12:15], v[24:31], v0
 ds_read_b128 v[24:27], v3 offset:28672
 ds_read_b128 v[28:31], v3 offset:29696
 buffer_load_dwordx4 v1, s[4:7], s63 offen offset:2048 lds
 v_smfmac_f32_16x16x64_bf16 v[8:11], v[12:15], a[136:143], v0
 s_mov_b32 m0, 10240
 s_waitcnt lgkmcnt(6)
 v_smfmac_f32_16x16x64_bf16 v[16:19], v[48:51], a[0:7], v0
 buffer_load_dwordx4 v1, s[4:7], s63 offen offset:3072 lds
 s_waitcnt lgkmcnt(5)
 v_smfmac_f32_16x16x64_bf16 v[16:19], v[52:55], a[16:23], v0
 s_mov_b32 m0, 2048
 s_waitcnt lgkmcnt(2)
 v_smfmac_f32_16x16x64_bf16 v[16:19], v[44:47], v[56:63], v0
 ds_read_b128 v[56:59], v3 offset:24576
 ds_read_b128 v[60:63], v3 offset:25600
 buffer_load_dwordx4 v1, s[4:7], s81 offen offset:0 lds
 s_waitcnt lgkmcnt(2)
 v_smfmac_f32_16x16x64_bf16 v[20:23], v[48:51], v[24:31], v0
 ds_read_b128 v[24:27], v2 offset:47104
 ds_read_b128 v[28:31], v2 offset:48128
 s_mov_b32 m0, 2048
 v_smfmac_f32_16x16x64_bf16 v[20:23], v[52:55], a[48:55], v0
 buffer_load_dwordx4 v1, s[4:7], s81 offen offset:1024 lds
 v_smfmac_f32_16x16x64_bf16 v[20:23], v[44:47], a[56:63], v0
 v_cvt_pk_bf16_f32 v16, v16, v17
 v_smfmac_f32_16x16x64_bf16 v[32:35], v[48:51], a[64:71], v0
 v_cvt_pk_bf16_f32 v17, v18, v19
 s_waitcnt lgkmcnt(2)
 v_smfmac_f32_16x16x64_bf16 v[32:35], v[52:55], v[56:63], v0
 ds_read_b128 v[56:59], v2 offset:43008
 ds_read_b128 v[60:63], v2 offset:44032
 v_and_or_b32 v16, v16, -2, s55
 s_waitcnt lgkmcnt(2)
 v_smfmac_f32_16x16x64_bf16 v[32:35], v[44:47], v[24:31], v0
 ds_read_b128 v[24:27], v2 offset:40960
 ds_read_b128 v[28:31], v2 offset:41984
 v_cvt_pk_bf16_f32 v18, v20, v21
 v_smfmac_f32_16x16x64_bf16 v[36:39], v[48:51], a[96:103], v0
 v_cvt_pk_bf16_f32 v19, v22, v23
 v_smfmac_f32_16x16x64_bf16 v[36:39], v[52:55], a[112:119], v0
 v_and_or_b32 v18, v18, -2, s55
 buffer_store_dwordx4 v[16:19], v1, s[4:7], s60 offen offset:0 sc1
 v_smfmac_f32_16x16x64_bf16 v[36:39], v[44:47], a[120:127], v0
 v_cvt_pk_bf16_f32 v32, v32, v33
 s_waitcnt lgkmcnt(2)
 v_smfmac_f32_16x16x64_bf16 v[8:11], v[48:51], v[56:63], v0
 v_cvt_pk_bf16_f32 v33, v34, v35
 s_waitcnt lgkmcnt(0)
 v_smfmac_f32_16x16x64_bf16 v[8:11], v[52:55], v[24:31], v0
 v_and_or_b32 v32, v32, -2, s55
 v_smfmac_f32_16x16x64_bf16 v[8:11], v[44:47], a[152:159], v0
 v_cvt_pk_bf16_f32 v34, v36, v37
 v_cvt_pk_bf16_f32 v35, v38, v39
 v_and_or_b32 v34, v34, -2, s55
 buffer_store_dwordx4 v[32:35], v1, s[4:7], s60 offen offset:1024 sc1
 s_nop 3
 v_cvt_pk_bf16_f32 v8, v8, v9
 v_cvt_pk_bf16_f32 v9, v10, v11
 v_and_or_b32 v8, v8, -2, s55
 buffer_store_dwordx2 v[8:9], v1, s[4:7], s16 offen offset:8 sc1
 buffer_load_dwordx4 v[32:35], v1, s[4:7], s63 offen offset:0
 buffer_load_dwordx4 v[36:39], v1, s[4:7], s63 offen offset:1024
 s_add_u32 s54, s54, 1
 s_add_u32 s61, s61, 524288
 s_and_b32 s3, s54, 7
 s_cselect_b32 s3, 1, -7
 s_lshl_b32 s3, s3, 17
 s_add_u32 s62, s62, s3
 s_and_b32 s3, s54, 3
 s_cselect_b32 s3, 1, -3
 s_lshl_b32 s3, s3, 14
 s_add_u32 s57, s57, s3
 s_add_u32 s59, s59, s3
 s_xor_b32 s58, s57, 32768
 v_lshrrev_b32 v56, 7, v1
 v_mul_u32_u24 v56, 10240, v56
 v_and_b32 v60, 112, v1
 v_add_u32 v56, v56, v60
 v_and_b32 v57, 32, v1
 v_and_b32 v60, 64, v1
 v_lshl_add_u32 v57, v60, 2, v57
 v_bfe_u32 v60, v1, 8, 1
 v_lshl_add_u32 v57, v60, 4, v57
 v_bfe_u32 v60, v1, 4, 1
 v_lshl_add_u32 v57, v60, 3, v57
 v_mov_b32 v60, 0x3f80
 v_mov_b32 v28, 0x3f800000
 v_cndmask_b32 v60, v60, v28, s[82:83]
 v_cndmask_b32 v28, 0, v60, s[72:73]
 v_cndmask_b32 v29, 0, v60, s[74:75]
 v_cndmask_b32 v30, 0, v60, s[76:77]
 v_cndmask_b32 v31, 0, v60, s[78:79]
 v_mov_b64 v[58:59], -1
 s_mov_b64 exec, s[84:85]
 buffer_store_dwordx2 v[58:59], v57, s[4:7], s58 offen sc1
 s_mov_b64 exec, -1
 s_nop 15
 s_nop 15
 s_nop 15
 s_nop 15
 s_nop 15
 s_mov_b32 s51, 0
 buffer_load_dwordx4 v[8:11], v56, s[4:7], s64 offen sc1
 buffer_load_dwordx4 v[12:15], v56, s[4:7], s65 offen sc1
 buffer_load_dwordx4 v[16:19], v56, s[4:7], s66 offen sc1
 buffer_load_dwordx4 v[20:23], v56, s[4:7], s67 offen sc1
L_pp_185:
 s_waitcnt vmcnt(3)
 v_mfma_f32_16x16x32_bf16 v[24:27], v[28:31], v[8:11], 0
 v_bitop3_b32 v60, v8, v10, s55 bitop3:0x7e
 s_waitcnt vmcnt(2)
 v_mfma_f32_16x16x32_bf16 v[24:27], v[28:31], v[12:15], v[24:27]
 v_bitop3_b32 v61, v12, v14, s55 bitop3:0x7e
 s_waitcnt vmcnt(1)
 v_mfma_f32_16x16x32_bf16 v[24:27], v[28:31], v[16:19], v[24:27]
 v_bitop3_b32 v62, v16, v18, s55 bitop3:0x7e
 s_waitcnt vmcnt(0)
 v_mfma_f32_16x16x32_bf16 v[24:27], v[28:31], v[20:23], v[24:27]
 v_bitop3_b32 v63, v20, v22, s55 bitop3:0x7e
 v_or3_b32 v7, v60, v61, v62
 v_bitop3_b32 v7, v7, v63, 1 bitop3:0xa8
 v_cmp_ne_u32 vcc, 0, v7
 s_cbranch_vccnz L_rt_186
 s_nop 2
 v_add_f32_dpp v24, v24, v24 row_ror:8 row_mask:0xf bank_mask:0xf
 v_add_f32_dpp v25, v25, v25 row_ror:8 row_mask:0xf bank_mask:0xf
 v_add_f32_dpp v26, v26, v26 row_ror:8 row_mask:0xf bank_mask:0xf
 v_add_f32_dpp v27, v27, v27 row_ror:8 row_mask:0xf bank_mask:0xf
 s_mov_b64 exec, s[84:85]
 v_cvt_pk_bf16_f32 v24, v24, v25
 v_cvt_pk_bf16_f32 v25, v26, v27
 buffer_store_dwordx2 v[24:25], v57, s[4:7], s57 offen sc1
 s_mov_b64 exec, -1
 s_xor_b32 s55, s55, 1
 ds_read_b128 v[40:43], v1 offset:12288
 ds_read_b128 v[44:47], v1 offset:13312
 ds_read_b128 v[48:51], v1 offset:2048
 ds_read_b128 v[52:55], v1 offset:3072
 buffer_load_dwordx4 v[56:59], v1, s[4:7], s81 offen offset:2048
 buffer_load_dwordx4 v[60:63], v1, s[4:7], s81 offen offset:3072
 ds_read_b128 v[8:11], v3 offset:49152
 ds_read_b128 v[12:15], v3 offset:49152
 ds_read_b128 v[16:19], v3 offset:49152
 ds_read_b128 v[20:23], v3 offset:49152
 s_waitcnt lgkmcnt(0)
 s_nop 15
 s_nop 15
 s_nop 7
 s_branch L_ch1_s
L_rt_184:
 s_add_u32 s51, s51, 1
 s_cmp_lt_u32 s51, 131072
 s_cbranch_scc1 L_pm_183
 s_branch L_bail
L_rt_186:
 buffer_load_dwordx4 v[8:11], v56, s[4:7], s64 offen sc1
 buffer_load_dwordx4 v[12:15], v56, s[4:7], s65 offen sc1
 buffer_load_dwordx4 v[16:19], v56, s[4:7], s66 offen sc1
 buffer_load_dwordx4 v[20:23], v56, s[4:7], s67 offen sc1
 s_add_u32 s51, s51, 1
 s_cmp_lt_u32 s51, 131072
 s_cbranch_scc1 L_pp_185
 s_branch L_bail
L_ch1_end:
 s_waitcnt vmcnt(0)
 s_endpgm
L_ch2:
 v_lshrrev_b32 v8, 4, v0
 s_mov_b32 s3, 1280
 v_mul_lo_u32 v8, v8, s3
 v_lshrrev_b32 v7, 3, v0
 v_and_b32 v7, 6, v7
 v_xor_b32 v7, v7, v0
 v_and_b32 v7, 15, v7
 v_lshl_add_u32 v8, v7, 4, v8
 v_xor_b32 v9, 128, v8
 v_lshrrev_b32 v10, 4, v0
 s_mov_b32 s3, 8192
 v_mul_lo_u32 v10, v10, s3
 v_lshrrev_b32 v7, 3, v0
 v_and_b32 v7, 6, v7
 v_xor_b32 v7, v7, v0
 v_and_b32 v7, 15, v7
 v_lshl_add_u32 v10, v7, 4, v10
 v_xor_b32 v11, 128, v10
 s_mov_b32 s8, s26
 s_and_b32 s9, s27, 0xffff
 s_mov_b32 s10, 5242880
 s_mul_i32 s14, s52, 163840
 s_add_u32 s14, s14, 81920
 s_mov_b32 m0, 16384
 s_nop 0
 buffer_load_dwordx4 v8, s[8:11], s14 offen lds
 s_add_u32 s14, s14, 5120
 s_mov_b32 m0, 17408
 s_nop 0
 buffer_load_dwordx4 v8, s[8:11], s14 offen lds
 s_add_u32 s14, s14, 5120
 s_mov_b32 m0, 18432
 s_nop 0
 buffer_load_dwordx4 v8, s[8:11], s14 offen lds
 s_add_u32 s14, s14, 5120
 s_mov_b32 m0, 19456
 s_nop 0
 buffer_load_dwordx4 v8, s[8:11], s14 offen lds
 s_add_u32 s14, s14, 5120
 s_mov_b32 m0, 20480
 s_nop 0
 buffer_load_dwordx4 v9, s[8:11], s14 offen lds
 s_add_u32 s14, s14, 5120
 s_mov_b32 m0, 21504
 s_nop 0
 buffer_load_dwordx4 v9, s[8:11], s14 offen lds
 s_add_u32 s14, s14, 5120
 s_mov_b32 m0, 22528
 s_nop 0
 buffer_load_dwordx4 v9, s[8:11], s14 offen lds
 s_add_u32 s14, s14, 5120
 s_mov_b32 m0, 23552
 s_nop 0
 buffer_load_dwordx4 v9, s[8:11], s14 offen lds
 s_mul_i32 s14, s52, 163840
 s_add_u32 s14, s14, 82176
 s_mov_b32 m0, 49152
 s_nop 0
 buffer_load_dwordx4 v8, s[8:11], s14 offen lds
 s_add_u32 s14, s14, 5120
 s_mov_b32 m0, 50176
 s_nop 0
 buffer_load_dwordx4 v8, s[8:11], s14 offen lds
 s_add_u32 s14, s14, 5120
 s_mov_b32 m0, 51200
 s_nop 0
 buffer_load_dwordx4 v8, s[8:11], s14 offen lds
 s_add_u32 s14, s14, 5120
 s_mov_b32 m0, 52224
 s_nop 0
 buffer_load_dwordx4 v8, s[8:11], s14 offen lds
 s_add_u32 s14, s14, 5120
 s_mov_b32 m0, 53248
 s_nop 0
 buffer_load_dwordx4 v9, s[8:11], s14 offen lds
 s_add_u32 s14, s14, 5120
 s_mov_b32 m0, 54272
 s_nop 0
 buffer_load_dwordx4 v9, s[8:11], s14 offen lds
 s_add_u32 s14, s14, 5120
 s_mov_b32 m0, 55296
 s_nop 0
 buffer_load_dwordx4 v9, s[8:11], s14 offen lds
 s_add_u32 s14, s14, 5120
 s_mov_b32 m0, 56320
 s_nop 0
 buffer_load_dwordx4 v9, s[8:11], s14 offen lds
 s_mul_i32 s14, s52, 163840
 s_add_u32 s14, s14, 82432
 s_mov_b32 m0, 81920
 s_nop 0
 buffer_load_dwordx4 v8, s[8:11], s14 offen lds
 s_add_u32 s14, s14, 5120
 s_mov_b32 m0, 82944
 s_nop 0
 buffer_load_dwordx4 v8, s[8:11], s14 offen lds
 s_add_u32 s14, s14, 5120
 s_mov_b32 m0, 83968
 s_nop 0
 buffer_load_dwordx4 v8, s[8:11], s14 offen lds
 s_add_u32 s14, s14, 5120
 s_mov_b32 m0, 84992
 s_nop 0
 buffer_load_dwordx4 v8, s[8:11], s14 offen lds
 s_add_u32 s14, s14, 5120
 s_mov_b32 m0, 86016
 s_nop 0
 buffer_load_dwordx4 v9, s[8:11], s14 offen lds
 s_add_u32 s14, s14, 5120
 s_mov_b32 m0, 87040
 s_nop 0
 buffer_load_dwordx4 v9, s[8:11], s14 offen lds
 s_add_u32 s14, s14, 5120
 s_mov_b32 m0, 88064
 s_nop 0
 buffer_load_dwordx4 v9, s[8:11], s14 offen lds
 s_add_u32 s14, s14, 5120
 s_mov_b32 m0, 89088
 s_nop 0
 buffer_load_dwordx4 v9, s[8:11], s14 offen lds
 s_mul_i32 s14, s52, 163840
 s_add_u32 s14, s14, 82688
 s_mov_b32 m0, 114688
 s_nop 0
 buffer_load_dwordx4 v8, s[8:11], s14 offen lds
 s_add_u32 s14, s14, 5120
 s_mov_b32 m0, 115712
 s_nop 0
 buffer_load_dwordx4 v8, s[8:11], s14 offen lds
 s_add_u32 s14, s14, 5120
 s_mov_b32 m0, 116736
 s_nop 0
 buffer_load_dwordx4 v8, s[8:11], s14 offen lds
 s_add_u32 s14, s14, 5120
 s_mov_b32 m0, 117760
 s_nop 0
 buffer_load_dwordx4 v8, s[8:11], s14 offen lds
 s_add_u32 s14, s14, 5120
 s_mov_b32 m0, 118784
 s_nop 0
 buffer_load_dwordx4 v9, s[8:11], s14 offen lds
 s_add_u32 s14, s14, 5120
 s_mov_b32 m0, 119808
 s_nop 0
 buffer_load_dwordx4 v9, s[8:11], s14 offen lds
 s_add_u32 s14, s14, 5120
 s_mov_b32 m0, 120832
 s_nop 0
 buffer_load_dwordx4 v9, s[8:11], s14 offen lds
 s_add_u32 s14, s14, 5120
 s_mov_b32 m0, 121856
 s_nop 0
 buffer_load_dwordx4 v9, s[8:11], s14 offen lds
 s_mul_i32 s14, s52, 163840
 s_add_u32 s14, s14, 82944
 s_mov_b32 m0, 147456
 s_nop 0
 buffer_load_dwordx4 v8, s[8:11], s14 offen lds
 s_add_u32 s14, s14, 5120
 s_mov_b32 m0, 148480
 s_nop 0
 buffer_load_dwordx4 v8, s[8:11], s14 offen lds
 s_add_u32 s14, s14, 5120
 s_mov_b32 m0, 149504
 s_nop 0
 buffer_load_dwordx4 v8, s[8:11], s14 offen lds
 s_add_u32 s14, s14, 5120
 s_mov_b32 m0, 150528
 s_nop 0
 buffer_load_dwordx4 v8, s[8:11], s14 offen lds
 s_add_u32 s14, s14, 5120
 s_mov_b32 m0, 151552
 s_nop 0
 buffer_load_dwordx4 v9, s[8:11], s14 offen lds
 s_add_u32 s14, s14, 5120
 s_mov_b32 m0, 152576
 s_nop 0
 buffer_load_dwordx4 v9, s[8:11], s14 offen lds
 s_add_u32 s14, s14, 5120
 s_mov_b32 m0, 153600
 s_nop 0
 buffer_load_dwordx4 v9, s[8:11], s14 offen lds
 s_add_u32 s14, s14, 5120
 s_mov_b32 m0, 154624
 s_nop 0
 buffer_load_dwordx4 v9, s[8:11], s14 offen lds
 v_lshrrev_b32 v20, 4, v0
 v_bfe_u32 v21, v0, 2, 1
 v_bfe_u32 v22, v0, 3, 1
 v_and_b32 v23, 1, v20
 v_lshrrev_b32 v24, 1, v20
 v_and_b32 v25, 3, v0
 v_lshlrev_b32 v25, 3, v25
 v_lshl_add_u32 v26, v22, 1, v23
 v_lshl_add_u32 v27, v21, 2, v26
 v_lshl_add_u32 v26, v24, 2, v26
 v_lshl_add_u32 v26, v21, 4, v26
 v_xor_b32 v27, 4, v27
 v_lshl_add_u32 v27, v27, 5, v25
 v_lshl_add_u32 v12, v26, 8, v27
 v_lshl_add_u32 v26, v24, 2, v21
 v_lshl_add_u32 v26, v23, 4, v26
 v_lshl_add_u32 v27, v23, 2, v21
 v_lshl_add_u32 v27, v22, 1, v27
 v_lshl_add_u32 v27, v27, 5, v25
 v_lshl_add_u32 v14, v26, 8, v27
 v_lshlrev_b32 v1, 4, v0
 v_add_u32 v2, 65536, v1
 v_add_u32 v3, 114688, v1
 s_waitcnt vmcnt(32)
 s_barrier
 s_waitcnt lgkmcnt(0)
 s_barrier
 s_mov_b32 s8, s24
 s_and_b32 s9, s25, 0xffff
 s_mov_b32 s10, 5242880
 s_lshl_b32 s14, s52, 8
 s_add_u32 s14, s14, 524288
 s_mov_b32 m0, 16384
 s_nop 0
 buffer_load_dwordx4 v10, s[8:11], s14 offen lds
 s_add_u32 s14, s14, 32768
 s_mov_b32 m0, 17408
 s_nop 0
 buffer_load_dwordx4 v10, s[8:11], s14 offen lds
 s_add_u32 s14, s14, 32768
 s_mov_b32 m0, 18432
 s_nop 0
 buffer_load_dwordx4 v10, s[8:11], s14 offen lds
 s_add_u32 s14, s14, 32768
 s_mov_b32 m0, 19456
 s_nop 0
 buffer_load_dwordx4 v10, s[8:11], s14 offen lds
 s_add_u32 s14, s14, 32768
 s_mov_b32 m0, 20480
 s_nop 0
 buffer_load_dwordx4 v11, s[8:11], s14 offen lds
 s_add_u32 s14, s14, 32768
 s_mov_b32 m0, 21504
 s_nop 0
 buffer_load_dwordx4 v11, s[8:11], s14 offen lds
 s_add_u32 s14, s14, 32768
 s_mov_b32 m0, 22528
 s_nop 0
 buffer_load_dwordx4 v11, s[8:11], s14 offen lds
 s_add_u32 s14, s14, 32768
 s_mov_b32 m0, 23552
 s_nop 0
 buffer_load_dwordx4 v11, s[8:11], s14 offen lds
 s_waitcnt vmcnt(32)
 s_barrier
 s_waitcnt lgkmcnt(0)
 s_barrier
 s_lshl_b32 s14, s52, 8
 s_add_u32 s14, s14, 1572864
 s_mov_b32 m0, 49152
 s_nop 0
 buffer_load_dwordx4 v10, s[8:11], s14 offen lds
 s_add_u32 s14, s14, 32768
 s_mov_b32 m0, 50176
 s_nop 0
 buffer_load_dwordx4 v10, s[8:11], s14 offen lds
 s_add_u32 s14, s14, 32768
 s_mov_b32 m0, 51200
 s_nop 0
 buffer_load_dwordx4 v10, s[8:11], s14 offen lds
 s_add_u32 s14, s14, 32768
 s_mov_b32 m0, 52224
 s_nop 0
 buffer_load_dwordx4 v10, s[8:11], s14 offen lds
 s_add_u32 s14, s14, 32768
 s_mov_b32 m0, 53248
 s_nop 0
 buffer_load_dwordx4 v11, s[8:11], s14 offen lds
 s_add_u32 s14, s14, 32768
 s_mov_b32 m0, 54272
 s_nop 0
 buffer_load_dwordx4 v11, s[8:11], s14 offen lds
 s_add_u32 s14, s14, 32768
 s_mov_b32 m0, 55296
 s_nop 0
 buffer_load_dwordx4 v11, s[8:11], s14 offen lds
 s_add_u32 s14, s14, 32768
 s_mov_b32 m0, 56320
 s_nop 0
 buffer_load_dwordx4 v11, s[8:11], s14 offen lds
 s_waitcnt vmcnt(32)
 s_barrier
 v_xor_b32 v16, 0, v14
 v_add_u32 v16, 65536, v16
 v_xor_b32 v17, 64, v16
 ds_read_b64_tr_b16 a[0:1], v16 offset:0
 ds_read_b64_tr_b16 a[2:3], v17 offset:512
 ds_read_b64_tr_b16 a[4:5], v16 offset:2048
 ds_read_b64_tr_b16 a[6:7], v17 offset:2560
 v_xor_b32 v16, 0, v14
 v_add_u32 v16, 65536, v16
 v_xor_b32 v17, 64, v16
 ds_read_b64_tr_b16 a[8:9], v16 offset:8192
 ds_read_b64_tr_b16 a[10:11], v17 offset:8704
 ds_read_b64_tr_b16 a[12:13], v16 offset:10240
 ds_read_b64_tr_b16 a[14:15], v17 offset:10752
 v_xor_b32 v16, 0, v14
 v_add_u32 v16, 65536, v16
 v_xor_b32 v17, 64, v16
 ds_read_b64_tr_b16 a[16:17], v16 offset:16384
 ds_read_b64_tr_b16 a[18:19], v17 offset:16896
 ds_read_b64_tr_b16 a[20:21], v16 offset:18432
 ds_read_b64_tr_b16 a[22:23], v17 offset:18944
 v_xor_b32 v16, 0, v14
 v_add_u32 v16, 65536, v16
 v_xor_b32 v17, 64, v16
 ds_read_b64_tr_b16 a[24:25], v16 offset:24576
 ds_read_b64_tr_b16 a[26:27], v17 offset:25088
 ds_read_b64_tr_b16 a[28:29], v16 offset:26624
 ds_read_b64_tr_b16 a[30:31], v17 offset:27136
 v_xor_b32 v16, 32, v14
 v_add_u32 v16, 65536, v16
 v_xor_b32 v17, 64, v16
 ds_read_b64_tr_b16 a[32:33], v16 offset:0
 ds_read_b64_tr_b16 a[34:35], v17 offset:512
 ds_read_b64_tr_b16 a[36:37], v16 offset:2048
 ds_read_b64_tr_b16 a[38:39], v17 offset:2560
 v_xor_b32 v16, 32, v14
 v_add_u32 v16, 65536, v16
 v_xor_b32 v17, 64, v16
 ds_read_b64_tr_b16 a[40:41], v16 offset:8192
 ds_read_b64_tr_b16 a[42:43], v17 offset:8704
 ds_read_b64_tr_b16 a[44:45], v16 offset:10240
 ds_read_b64_tr_b16 a[46:47], v17 offset:10752
 v_xor_b32 v16, 32, v14
 v_add_u32 v16, 65536, v16
 v_xor_b32 v17, 64, v16
 ds_read_b64_tr_b16 a[48:49], v16 offset:16384
 ds_read_b64_tr_b16 a[50:51], v17 offset:16896
 ds_read_b64_tr_b16 a[52:53], v16 offset:18432
 ds_read_b64_tr_b16 a[54:55], v17 offset:18944
 v_xor_b32 v16, 32, v14
 v_add_u32 v16, 65536, v16
 v_xor_b32 v17, 64, v16
 ds_read_b64_tr_b16 a[56:57], v16 offset:24576
 ds_read_b64_tr_b16 a[58:59], v17 offset:25088
 ds_read_b64_tr_b16 a[60:61], v16 offset:26624
 ds_read_b64_tr_b16 a[62:63], v17 offset:27136
 v_xor_b32 v16, 128, v14
 v_add_u32 v16, 65536, v16
 v_xor_b32 v17, 64, v16
 ds_read_b64_tr_b16 a[64:65], v16 offset:0
 ds_read_b64_tr_b16 a[66:67], v17 offset:512
 ds_read_b64_tr_b16 a[68:69], v16 offset:2048
 ds_read_b64_tr_b16 a[70:71], v17 offset:2560
 v_xor_b32 v16, 128, v14
 v_add_u32 v16, 65536, v16
 v_xor_b32 v17, 64, v16
 ds_read_b64_tr_b16 a[72:73], v16 offset:8192
 ds_read_b64_tr_b16 a[74:75], v17 offset:8704
 ds_read_b64_tr_b16 a[76:77], v16 offset:10240
 ds_read_b64_tr_b16 a[78:79], v17 offset:10752
 v_xor_b32 v16, 128, v14
 v_add_u32 v16, 65536, v16
 v_xor_b32 v17, 64, v16
 ds_read_b64_tr_b16 a[80:81], v16 offset:16384
 ds_read_b64_tr_b16 a[82:83], v17 offset:16896
 ds_read_b64_tr_b16 a[84:85], v16 offset:18432
 ds_read_b64_tr_b16 a[86:87], v17 offset:18944
 v_xor_b32 v16, 128, v14
 v_add_u32 v16, 65536, v16
 v_xor_b32 v17, 64, v16
 ds_read_b64_tr_b16 a[88:89], v16 offset:24576
 ds_read_b64_tr_b16 a[90:91], v17 offset:25088
 ds_read_b64_tr_b16 a[92:93], v16 offset:26624
 ds_read_b64_tr_b16 a[94:95], v17 offset:27136
 v_xor_b32 v16, 160, v14
 v_add_u32 v16, 65536, v16
 v_xor_b32 v17, 64, v16
 ds_read_b64_tr_b16 a[96:97], v16 offset:0
 ds_read_b64_tr_b16 a[98:99], v17 offset:512
 ds_read_b64_tr_b16 a[100:101], v16 offset:2048
 ds_read_b64_tr_b16 a[102:103], v17 offset:2560
 v_xor_b32 v16, 160, v14
 v_add_u32 v16, 65536, v16
 v_xor_b32 v17, 64, v16
 ds_read_b64_tr_b16 a[104:105], v16 offset:8192
 ds_read_b64_tr_b16 a[106:107], v17 offset:8704
 ds_read_b64_tr_b16 a[108:109], v16 offset:10240
 ds_read_b64_tr_b16 a[110:111], v17 offset:10752
 v_xor_b32 v16, 160, v14
 v_add_u32 v16, 65536, v16
 v_xor_b32 v17, 64, v16
 ds_read_b64_tr_b16 a[112:113], v16 offset:16384
 ds_read_b64_tr_b16 a[114:115], v17 offset:16896
 ds_read_b64_tr_b16 a[116:117], v16 offset:18432
 ds_read_b64_tr_b16 a[118:119], v17 offset:18944
 v_xor_b32 v16, 160, v14
 v_add_u32 v16, 65536, v16
 v_xor_b32 v17, 64, v16
 ds_read_b64_tr_b16 a[120:121], v16 offset:24576
 ds_read_b64_tr_b16 a[122:123], v17 offset:25088
 ds_read_b64_tr_b16 a[124:125], v16 offset:26624
 ds_read_b64_tr_b16 a[126:127], v17 offset:27136
 s_waitcnt lgkmcnt(0)
 s_barrier
 s_lshl_b32 s14, s52, 8
 s_add_u32 s14, s14, 2621440
 s_mov_b32 m0, 81920
 s_nop 0
 buffer_load_dwordx4 v10, s[8:11], s14 offen lds
 s_add_u32 s14, s14, 32768
 s_mov_b32 m0, 82944
 s_nop 0
 buffer_load_dwordx4 v10, s[8:11], s14 offen lds
 s_add_u32 s14, s14, 32768
 s_mov_b32 m0, 83968
 s_nop 0
 buffer_load_dwordx4 v10, s[8:11], s14 offen lds
 s_add_u32 s14, s14, 32768
 s_mov_b32 m0, 84992
 s_nop 0
 buffer_load_dwordx4 v10, s[8:11], s14 offen lds
 s_add_u32 s14, s14, 32768
 s_mov_b32 m0, 86016
 s_nop 0
 buffer_load_dwordx4 v11, s[8:11], s14 offen lds
 s_add_u32 s14, s14, 32768
 s_mov_b32 m0, 87040
 s_nop 0
 buffer_load_dwordx4 v11, s[8:11], s14 offen lds
 s_add_u32 s14, s14, 32768
 s_mov_b32 m0, 88064
 s_nop 0
 buffer_load_dwordx4 v11, s[8:11], s14 offen lds
 s_add_u32 s14, s14, 32768
 s_mov_b32 m0, 89088
 s_nop 0
 buffer_load_dwordx4 v11, s[8:11], s14 offen lds
 s_waitcnt vmcnt(32)
 s_barrier
 s_waitcnt lgkmcnt(0)
 s_barrier
 s_lshl_b32 s14, s52, 8
 s_add_u32 s14, s14, 3670016
 s_mov_b32 m0, 114688
 s_nop 0
 buffer_load_dwordx4 v10, s[8:11], s14 offen lds
 s_add_u32 s14, s14, 32768
 s_mov_b32 m0, 115712
 s_nop 0
 buffer_load_dwordx4 v10, s[8:11], s14 offen lds
 s_add_u32 s14, s14, 32768
 s_mov_b32 m0, 116736
 s_nop 0
 buffer_load_dwordx4 v10, s[8:11], s14 offen lds
 s_add_u32 s14, s14, 32768
 s_mov_b32 m0, 117760
 s_nop 0
 buffer_load_dwordx4 v10, s[8:11], s14 offen lds
 s_add_u32 s14, s14, 32768
 s_mov_b32 m0, 118784
 s_nop 0
 buffer_load_dwordx4 v11, s[8:11], s14 offen lds
 s_add_u32 s14, s14, 32768
 s_mov_b32 m0, 119808
 s_nop 0
 buffer_load_dwordx4 v11, s[8:11], s14 offen lds
 s_add_u32 s14, s14, 32768
 s_mov_b32 m0, 120832
 s_nop 0
 buffer_load_dwordx4 v11, s[8:11], s14 offen lds
 s_add_u32 s14, s14, 32768
 s_mov_b32 m0, 121856
 s_nop 0
 buffer_load_dwordx4 v11, s[8:11], s14 offen lds
 s_waitcnt vmcnt(32)
 s_barrier
 v_xor_b32 v16, 128, v14
 v_add_u32 v16, 131072, v16
 v_xor_b32 v17, 64, v16
 ds_read_b64_tr_b16 a[128:129], v16 offset:0
 ds_read_b64_tr_b16 a[130:131], v17 offset:512
 ds_read_b64_tr_b16 a[132:133], v16 offset:2048
 ds_read_b64_tr_b16 a[134:135], v17 offset:2560
 v_xor_b32 v16, 128, v14
 v_add_u32 v16, 131072, v16
 v_xor_b32 v17, 64, v16
 ds_read_b64_tr_b16 a[136:137], v16 offset:8192
 ds_read_b64_tr_b16 a[138:139], v17 offset:8704
 ds_read_b64_tr_b16 a[140:141], v16 offset:10240
 ds_read_b64_tr_b16 a[142:143], v17 offset:10752
 v_xor_b32 v16, 128, v14
 v_add_u32 v16, 131072, v16
 v_xor_b32 v17, 64, v16
 ds_read_b64_tr_b16 a[144:145], v16 offset:16384
 ds_read_b64_tr_b16 a[146:147], v17 offset:16896
 ds_read_b64_tr_b16 a[148:149], v16 offset:18432
 ds_read_b64_tr_b16 a[150:151], v17 offset:18944
 v_xor_b32 v16, 128, v14
 v_add_u32 v16, 131072, v16
 v_xor_b32 v17, 64, v16
 ds_read_b64_tr_b16 a[152:153], v16 offset:24576
 ds_read_b64_tr_b16 a[154:155], v17 offset:25088
 ds_read_b64_tr_b16 a[156:157], v16 offset:26624
 ds_read_b64_tr_b16 a[158:159], v17 offset:27136
 s_waitcnt lgkmcnt(0)
 s_barrier
 s_lshl_b32 s14, s52, 8
 s_add_u32 s14, s14, 4718592
 s_mov_b32 m0, 147456
 s_nop 0
 buffer_load_dwordx4 v10, s[8:11], s14 offen lds
 s_add_u32 s14, s14, 32768
 s_mov_b32 m0, 148480
 s_nop 0
 buffer_load_dwordx4 v10, s[8:11], s14 offen lds
 s_add_u32 s14, s14, 32768
 s_mov_b32 m0, 149504
 s_nop 0
 buffer_load_dwordx4 v10, s[8:11], s14 offen lds
 s_add_u32 s14, s14, 32768
 s_mov_b32 m0, 150528
 s_nop 0
 buffer_load_dwordx4 v10, s[8:11], s14 offen lds
 s_add_u32 s14, s14, 32768
 s_mov_b32 m0, 151552
 s_nop 0
 buffer_load_dwordx4 v11, s[8:11], s14 offen lds
 s_add_u32 s14, s14, 32768
 s_mov_b32 m0, 152576
 s_nop 0
 buffer_load_dwordx4 v11, s[8:11], s14 offen lds
 s_add_u32 s14, s14, 32768
 s_mov_b32 m0, 153600
 s_nop 0
 buffer_load_dwordx4 v11, s[8:11], s14 offen lds
 s_add_u32 s14, s14, 32768
 s_mov_b32 m0, 154624
 s_nop 0
 buffer_load_dwordx4 v11, s[8:11], s14 offen lds
 s_waitcnt vmcnt(32)
 s_barrier
 v_xor_b32 v16, 0, v12
 v_add_u32 v16, 0, v16
 ds_read_b64_tr_b16 a[160:161], v16 offset:0
 ds_read_b64_tr_b16 a[162:163], v16 offset:8192
 ds_read_b64_tr_b16 a[164:165], v16 offset:2048
 ds_read_b64_tr_b16 a[166:167], v16 offset:10240
 v_xor_b32 v16, 32, v12
 v_add_u32 v16, 0, v16
 ds_read_b64_tr_b16 a[168:169], v16 offset:0
 ds_read_b64_tr_b16 a[170:171], v16 offset:8192
 ds_read_b64_tr_b16 a[172:173], v16 offset:2048
 ds_read_b64_tr_b16 a[174:175], v16 offset:10240
 v_xor_b32 v16, 0, v12
 v_add_u32 v16, 0, v16
 ds_read_b64_tr_b16 a[176:177], v16 offset:16384
 ds_read_b64_tr_b16 a[178:179], v16 offset:24576
 ds_read_b64_tr_b16 a[180:181], v16 offset:18432
 ds_read_b64_tr_b16 a[182:183], v16 offset:26624
 v_xor_b32 v16, 32, v12
 v_add_u32 v16, 0, v16
 ds_read_b64_tr_b16 a[184:185], v16 offset:16384
 ds_read_b64_tr_b16 a[186:187], v16 offset:24576
 ds_read_b64_tr_b16 a[188:189], v16 offset:18432
 ds_read_b64_tr_b16 a[190:191], v16 offset:26624
 s_waitcnt lgkmcnt(0)
 s_barrier
 s_mov_b32 s8, s22
 s_and_b32 s9, s23, 0xffff
 s_mov_b32 s10, 5242880
 s_lshl_b32 s14, s52, 8
 s_add_u32 s14, s14, 524288
 s_mov_b32 m0, 16384
 s_nop 0
 buffer_load_dwordx4 v10, s[8:11], s14 offen lds
 s_add_u32 s14, s14, 32768
 s_mov_b32 m0, 17408
 s_nop 0
 buffer_load_dwordx4 v10, s[8:11], s14 offen lds
 s_add_u32 s14, s14, 32768
 s_mov_b32 m0, 18432
 s_nop 0
 buffer_load_dwordx4 v10, s[8:11], s14 offen lds
 s_add_u32 s14, s14, 32768
 s_mov_b32 m0, 19456
 s_nop 0
 buffer_load_dwordx4 v10, s[8:11], s14 offen lds
 s_add_u32 s14, s14, 32768
 s_mov_b32 m0, 20480
 s_nop 0
 buffer_load_dwordx4 v11, s[8:11], s14 offen lds
 s_add_u32 s14, s14, 32768
 s_mov_b32 m0, 21504
 s_nop 0
 buffer_load_dwordx4 v11, s[8:11], s14 offen lds
 s_add_u32 s14, s14, 32768
 s_mov_b32 m0, 22528
 s_nop 0
 buffer_load_dwordx4 v11, s[8:11], s14 offen lds
 s_add_u32 s14, s14, 32768
 s_mov_b32 m0, 23552
 s_nop 0
 buffer_load_dwordx4 v11, s[8:11], s14 offen lds
 s_waitcnt vmcnt(32)
 s_barrier
 v_xor_b32 v16, 0, v12
 v_add_u32 v16, 32768, v16
 ds_read_b64_tr_b16 a[192:193], v16 offset:0
 ds_read_b64_tr_b16 a[194:195], v16 offset:8192
 ds_read_b64_tr_b16 a[196:197], v16 offset:2048
 ds_read_b64_tr_b16 a[198:199], v16 offset:10240
 v_xor_b32 v16, 32, v12
 v_add_u32 v16, 32768, v16
 ds_read_b64_tr_b16 a[200:201], v16 offset:0
 ds_read_b64_tr_b16 a[202:203], v16 offset:8192
 ds_read_b64_tr_b16 a[204:205], v16 offset:2048
 ds_read_b64_tr_b16 a[206:207], v16 offset:10240
 v_xor_b32 v16, 0, v12
 v_add_u32 v16, 32768, v16
 ds_read_b64_tr_b16 a[208:209], v16 offset:16384
 ds_read_b64_tr_b16 a[210:211], v16 offset:24576
 ds_read_b64_tr_b16 a[212:213], v16 offset:18432
 ds_read_b64_tr_b16 a[214:215], v16 offset:26624
 v_xor_b32 v16, 32, v12
 v_add_u32 v16, 32768, v16
 ds_read_b64_tr_b16 a[216:217], v16 offset:16384
 ds_read_b64_tr_b16 a[218:219], v16 offset:24576
 ds_read_b64_tr_b16 a[220:221], v16 offset:18432
 ds_read_b64_tr_b16 a[222:223], v16 offset:26624
 s_waitcnt lgkmcnt(0)
 s_barrier
 s_lshl_b32 s14, s52, 8
 s_add_u32 s14, s14, 1572864
 s_mov_b32 m0, 49152
 s_nop 0
 buffer_load_dwordx4 v10, s[8:11], s14 offen lds
 s_add_u32 s14, s14, 32768
 s_mov_b32 m0, 50176
 s_nop 0
 buffer_load_dwordx4 v10, s[8:11], s14 offen lds
 s_add_u32 s14, s14, 32768
 s_mov_b32 m0, 51200
 s_nop 0
 buffer_load_dwordx4 v10, s[8:11], s14 offen lds
 s_add_u32 s14, s14, 32768
 s_mov_b32 m0, 52224
 s_nop 0
 buffer_load_dwordx4 v10, s[8:11], s14 offen lds
 s_add_u32 s14, s14, 32768
 s_mov_b32 m0, 53248
 s_nop 0
 buffer_load_dwordx4 v11, s[8:11], s14 offen lds
 s_add_u32 s14, s14, 32768
 s_mov_b32 m0, 54272
 s_nop 0
 buffer_load_dwordx4 v11, s[8:11], s14 offen lds
 s_add_u32 s14, s14, 32768
 s_mov_b32 m0, 55296
 s_nop 0
 buffer_load_dwordx4 v11, s[8:11], s14 offen lds
 s_add_u32 s14, s14, 32768
 s_mov_b32 m0, 56320
 s_nop 0
 buffer_load_dwordx4 v11, s[8:11], s14 offen lds
 s_waitcnt vmcnt(32)
 s_barrier
 v_xor_b32 v16, 0, v12
 v_add_u32 v16, 65536, v16
 ds_read_b64_tr_b16 a[224:225], v16 offset:0
 ds_read_b64_tr_b16 a[226:227], v16 offset:8192
 ds_read_b64_tr_b16 a[228:229], v16 offset:2048
 ds_read_b64_tr_b16 a[230:231], v16 offset:10240
 v_xor_b32 v16, 32, v12
 v_add_u32 v16, 65536, v16
 ds_read_b64_tr_b16 a[232:233], v16 offset:0
 ds_read_b64_tr_b16 a[234:235], v16 offset:8192
 ds_read_b64_tr_b16 a[236:237], v16 offset:2048
 ds_read_b64_tr_b16 a[238:239], v16 offset:10240
 v_xor_b32 v16, 0, v12
 v_add_u32 v16, 65536, v16
 ds_read_b64_tr_b16 a[240:241], v16 offset:16384
 ds_read_b64_tr_b16 a[242:243], v16 offset:24576
 ds_read_b64_tr_b16 a[244:245], v16 offset:18432
 ds_read_b64_tr_b16 a[246:247], v16 offset:26624
 v_xor_b32 v16, 32, v12
 v_add_u32 v16, 65536, v16
 ds_read_b64_tr_b16 a[248:249], v16 offset:16384
 ds_read_b64_tr_b16 a[250:251], v16 offset:24576
 ds_read_b64_tr_b16 a[252:253], v16 offset:18432
 ds_read_b64_tr_b16 a[254:255], v16 offset:26624
 s_waitcnt lgkmcnt(0)
 s_barrier
 s_lshl_b32 s14, s52, 8
 s_add_u32 s14, s14, 2621440
 s_mov_b32 m0, 81920
 s_nop 0
 buffer_load_dwordx4 v10, s[8:11], s14 offen lds
 s_add_u32 s14, s14, 32768
 s_mov_b32 m0, 82944
 s_nop 0
 buffer_load_dwordx4 v10, s[8:11], s14 offen lds
 s_add_u32 s14, s14, 32768
 s_mov_b32 m0, 83968
 s_nop 0
 buffer_load_dwordx4 v10, s[8:11], s14 offen lds
 s_add_u32 s14, s14, 32768
 s_mov_b32 m0, 84992
 s_nop 0
 buffer_load_dwordx4 v10, s[8:11], s14 offen lds
 s_add_u32 s14, s14, 32768
 s_mov_b32 m0, 86016
 s_nop 0
 buffer_load_dwordx4 v11, s[8:11], s14 offen lds
 s_add_u32 s14, s14, 32768
 s_mov_b32 m0, 87040
 s_nop 0
 buffer_load_dwordx4 v11, s[8:11], s14 offen lds
 s_add_u32 s14, s14, 32768
 s_mov_b32 m0, 88064
 s_nop 0
 buffer_load_dwordx4 v11, s[8:11], s14 offen lds
 s_add_u32 s14, s14, 32768
 s_mov_b32 m0, 89088
 s_nop 0
 buffer_load_dwordx4 v11, s[8:11], s14 offen lds
 s_waitcnt vmcnt(32)
 s_barrier
 v_xor_b32 v16, 0, v12
 v_add_u32 v16, 98304, v16
 ds_read_b64_tr_b16 v[64:65], v16 offset:0
 ds_read_b64_tr_b16 v[66:67], v16 offset:8192
 ds_read_b64_tr_b16 v[68:69], v16 offset:2048
 ds_read_b64_tr_b16 v[70:71], v16 offset:10240
 v_xor_b32 v16, 32, v12
 v_add_u32 v16, 98304, v16
 ds_read_b64_tr_b16 v[72:73], v16 offset:0
 ds_read_b64_tr_b16 v[74:75], v16 offset:8192
 ds_read_b64_tr_b16 v[76:77], v16 offset:2048
 ds_read_b64_tr_b16 v[78:79], v16 offset:10240
 v_xor_b32 v16, 0, v12
 v_add_u32 v16, 98304, v16
 ds_read_b64_tr_b16 v[80:81], v16 offset:16384
 ds_read_b64_tr_b16 v[82:83], v16 offset:24576
 ds_read_b64_tr_b16 v[84:85], v16 offset:18432
 ds_read_b64_tr_b16 v[86:87], v16 offset:26624
 v_xor_b32 v16, 32, v12
 v_add_u32 v16, 98304, v16
 ds_read_b64_tr_b16 v[88:89], v16 offset:16384
 ds_read_b64_tr_b16 v[90:91], v16 offset:24576
 ds_read_b64_tr_b16 v[92:93], v16 offset:18432
 ds_read_b64_tr_b16 v[94:95], v16 offset:26624
 s_waitcnt lgkmcnt(0)
 s_barrier
 s_lshl_b32 s14, s52, 8
 s_add_u32 s14, s14, 3670016
 s_mov_b32 m0, 114688
 s_nop 0
 buffer_load_dwordx4 v10, s[8:11], s14 offen lds
 s_add_u32 s14, s14, 32768
 s_mov_b32 m0, 115712
 s_nop 0
 buffer_load_dwordx4 v10, s[8:11], s14 offen lds
 s_add_u32 s14, s14, 32768
 s_mov_b32 m0, 116736
 s_nop 0
 buffer_load_dwordx4 v10, s[8:11], s14 offen lds
 s_add_u32 s14, s14, 32768
 s_mov_b32 m0, 117760
 s_nop 0
 buffer_load_dwordx4 v10, s[8:11], s14 offen lds
 s_add_u32 s14, s14, 32768
 s_mov_b32 m0, 118784
 s_nop 0
 buffer_load_dwordx4 v11, s[8:11], s14 offen lds
 s_add_u32 s14, s14, 32768
 s_mov_b32 m0, 119808
 s_nop 0
 buffer_load_dwordx4 v11, s[8:11], s14 offen lds
 s_add_u32 s14, s14, 32768
 s_mov_b32 m0, 120832
 s_nop 0
 buffer_load_dwordx4 v11, s[8:11], s14 offen lds
 s_add_u32 s14, s14, 32768
 s_mov_b32 m0, 121856
 s_nop 0
 buffer_load_dwordx4 v11, s[8:11], s14 offen lds
 s_waitcnt vmcnt(32)
 s_barrier
 v_xor_b32 v16, 0, v12
 v_add_u32 v16, 131072, v16
 ds_read_b64_tr_b16 v[96:97], v16 offset:0
 ds_read_b64_tr_b16 v[98:99], v16 offset:8192
 ds_read_b64_tr_b16 v[100:101], v16 offset:2048
 ds_read_b64_tr_b16 v[102:103], v16 offset:10240
 v_xor_b32 v16, 32, v12
 v_add_u32 v16, 131072, v16
 ds_read_b64_tr_b16 v[104:105], v16 offset:0
 ds_read_b64_tr_b16 v[106:107], v16 offset:8192
 ds_read_b64_tr_b16 v[108:109], v16 offset:2048
 ds_read_b64_tr_b16 v[110:111], v16 offset:10240
 v_xor_b32 v16, 0, v12
 v_add_u32 v16, 131072, v16
 ds_read_b64_tr_b16 v[112:113], v16 offset:16384
 ds_read_b64_tr_b16 v[114:115], v16 offset:24576
 ds_read_b64_tr_b16 v[116:117], v16 offset:18432
 ds_read_b64_tr_b16 v[118:119], v16 offset:26624
 v_xor_b32 v16, 32, v12
 v_add_u32 v16, 131072, v16
 ds_read_b64_tr_b16 v[120:121], v16 offset:16384
 ds_read_b64_tr_b16 v[122:123], v16 offset:24576
 ds_read_b64_tr_b16 v[124:125], v16 offset:18432
 ds_read_b64_tr_b16 v[126:127], v16 offset:26624
 s_waitcnt lgkmcnt(0)
 s_barrier
 s_lshl_b32 s14, s52, 8
 s_add_u32 s14, s14, 4718592
 s_mov_b32 m0, 147456
 s_nop 0
 buffer_load_dwordx4 v10, s[8:11], s14 offen lds
 s_add_u32 s14, s14, 32768
 s_mov_b32 m0, 148480
 s_nop 0
 buffer_load_dwordx4 v10, s[8:11], s14 offen lds
 s_add_u32 s14, s14, 32768
 s_mov_b32 m0, 149504
 s_nop 0
 buffer_load_dwordx4 v10, s[8:11], s14 offen lds
 s_add_u32 s14, s14, 32768
 s_mov_b32 m0, 150528
 s_nop 0
 buffer_load_dwordx4 v10, s[8:11], s14 offen lds
 s_add_u32 s14, s14, 32768
 s_mov_b32 m0, 151552
 s_nop 0
 buffer_load_dwordx4 v11, s[8:11], s14 offen lds
 s_add_u32 s14, s14, 32768
 s_mov_b32 m0, 152576
 s_nop 0
 buffer_load_dwordx4 v11, s[8:11], s14 offen lds
 s_add_u32 s14, s14, 32768
 s_mov_b32 m0, 153600
 s_nop 0
 buffer_load_dwordx4 v11, s[8:11], s14 offen lds
 s_add_u32 s14, s14, 32768
 s_mov_b32 m0, 154624
 s_nop 0
 buffer_load_dwordx4 v11, s[8:11], s14 offen lds
 s_waitcnt vmcnt(32)
 s_barrier
 v_xor_b32 v16, 0, v12
 v_add_u32 v16, 0, v16
 ds_read_b64_tr_b16 v[128:129], v16 offset:0
 ds_read_b64_tr_b16 v[130:131], v16 offset:8192
 ds_read_b64_tr_b16 v[132:133], v16 offset:2048
 ds_read_b64_tr_b16 v[134:135], v16 offset:10240
 v_xor_b32 v16, 32, v12
 v_add_u32 v16, 0, v16
 ds_read_b64_tr_b16 v[136:137], v16 offset:0
 ds_read_b64_tr_b16 v[138:139], v16 offset:8192
 ds_read_b64_tr_b16 v[140:141], v16 offset:2048
 ds_read_b64_tr_b16 v[142:143], v16 offset:10240
 v_xor_b32 v16, 0, v12
 v_add_u32 v16, 0, v16
 ds_read_b64_tr_b16 v[144:145], v16 offset:16384
 ds_read_b64_tr_b16 v[146:147], v16 offset:24576
 ds_read_b64_tr_b16 v[148:149], v16 offset:18432
 ds_read_b64_tr_b16 v[150:151], v16 offset:26624
 v_xor_b32 v16, 32, v12
 v_add_u32 v16, 0, v16
 ds_read_b64_tr_b16 v[152:153], v16 offset:16384
 ds_read_b64_tr_b16 v[154:155], v16 offset:24576
 ds_read_b64_tr_b16 v[156:157], v16 offset:18432
 ds_read_b64_tr_b16 v[158:159], v16 offset:26624
 s_waitcnt lgkmcnt(0)
 s_barrier
 s_mov_b32 s8, s20
 s_and_b32 s9, s21, 0xffff
 s_mov_b32 s10, 5242880
 s_lshl_b32 s14, s52, 8
 s_add_u32 s14, s14, 524288
 s_mov_b32 m0, 16384
 s_nop 0
 buffer_load_dwordx4 v10, s[8:11], s14 offen lds
 s_add_u32 s14, s14, 32768
 s_mov_b32 m0, 17408
 s_nop 0
 buffer_load_dwordx4 v10, s[8:11], s14 offen lds
 s_add_u32 s14, s14, 32768
 s_mov_b32 m0, 18432
 s_nop 0
 buffer_load_dwordx4 v10, s[8:11], s14 offen lds
 s_add_u32 s14, s14, 32768
 s_mov_b32 m0, 19456
 s_nop 0
 buffer_load_dwordx4 v10, s[8:11], s14 offen lds
 s_add_u32 s14, s14, 32768
 s_mov_b32 m0, 20480
 s_nop 0
 buffer_load_dwordx4 v11, s[8:11], s14 offen lds
 s_add_u32 s14, s14, 32768
 s_mov_b32 m0, 21504
 s_nop 0
 buffer_load_dwordx4 v11, s[8:11], s14 offen lds
 s_add_u32 s14, s14, 32768
 s_mov_b32 m0, 22528
 s_nop 0
 buffer_load_dwordx4 v11, s[8:11], s14 offen lds
 s_add_u32 s14, s14, 32768
 s_mov_b32 m0, 23552
 s_nop 0
 buffer_load_dwordx4 v11, s[8:11], s14 offen lds
 s_waitcnt vmcnt(32)
 s_barrier
 v_xor_b32 v16, 0, v12
 v_add_u32 v16, 32768, v16
 ds_read_b64_tr_b16 v[160:161], v16 offset:0
 ds_read_b64_tr_b16 v[162:163], v16 offset:8192
 ds_read_b64_tr_b16 v[164:165], v16 offset:2048
 ds_read_b64_tr_b16 v[166:167], v16 offset:10240
 v_xor_b32 v16, 32, v12
 v_add_u32 v16, 32768, v16
 ds_read_b64_tr_b16 v[168:169], v16 offset:0
 ds_read_b64_tr_b16 v[170:171], v16 offset:8192
 ds_read_b64_tr_b16 v[172:173], v16 offset:2048
 ds_read_b64_tr_b16 v[174:175], v16 offset:10240
 v_xor_b32 v16, 0, v12
 v_add_u32 v16, 32768, v16
 ds_read_b64_tr_b16 v[176:177], v16 offset:16384
 ds_read_b64_tr_b16 v[178:179], v16 offset:24576
 ds_read_b64_tr_b16 v[180:181], v16 offset:18432
 ds_read_b64_tr_b16 v[182:183], v16 offset:26624
 v_xor_b32 v16, 32, v12
 v_add_u32 v16, 32768, v16
 ds_read_b64_tr_b16 v[32:33], v16 offset:16384
 ds_read_b64_tr_b16 v[34:35], v16 offset:24576
 ds_read_b64_tr_b16 v[36:37], v16 offset:18432
 ds_read_b64_tr_b16 v[38:39], v16 offset:26624
 s_add_u32 s3, s63, 0
 s_waitcnt lgkmcnt(2)
 buffer_store_dwordx4 v[32:35], v1, s[4:7], s3 offen offset:0
 s_waitcnt lgkmcnt(0)
 buffer_store_dwordx4 v[36:39], v1, s[4:7], s3 offen offset:1024
 s_waitcnt lgkmcnt(0)
 s_barrier
 s_lshl_b32 s14, s52, 8
 s_add_u32 s14, s14, 1572864
 s_mov_b32 m0, 49152
 s_nop 0
 buffer_load_dwordx4 v10, s[8:11], s14 offen lds
 s_add_u32 s14, s14, 32768
 s_mov_b32 m0, 50176
 s_nop 0
 buffer_load_dwordx4 v10, s[8:11], s14 offen lds
 s_add_u32 s14, s14, 32768
 s_mov_b32 m0, 51200
 s_nop 0
 buffer_load_dwordx4 v10, s[8:11], s14 offen lds
 s_add_u32 s14, s14, 32768
 s_mov_b32 m0, 52224
 s_nop 0
 buffer_load_dwordx4 v10, s[8:11], s14 offen lds
 s_add_u32 s14, s14, 32768
 s_mov_b32 m0, 53248
 s_nop 0
 buffer_load_dwordx4 v11, s[8:11], s14 offen lds
 s_add_u32 s14, s14, 32768
 s_mov_b32 m0, 54272
 s_nop 0
 buffer_load_dwordx4 v11, s[8:11], s14 offen lds
 s_add_u32 s14, s14, 32768
 s_mov_b32 m0, 55296
 s_nop 0
 buffer_load_dwordx4 v11, s[8:11], s14 offen lds
 s_add_u32 s14, s14, 32768
 s_mov_b32 m0, 56320
 s_nop 0
 buffer_load_dwordx4 v11, s[8:11], s14 offen lds
 s_waitcnt vmcnt(34)
 s_barrier
 v_xor_b32 v16, 0, v12
 v_add_u32 v16, 65536, v16
 ds_read_b64_tr_b16 v[40:41], v16 offset:0
 ds_read_b64_tr_b16 v[42:43], v16 offset:8192
 ds_read_b64_tr_b16 v[44:45], v16 offset:2048
 ds_read_b64_tr_b16 v[46:47], v16 offset:10240
 s_add_u32 s3, s63, 2048
 s_waitcnt lgkmcnt(2)
 buffer_store_dwordx4 v[40:43], v1, s[4:7], s3 offen offset:0
 s_waitcnt lgkmcnt(0)
 buffer_store_dwordx4 v[44:47], v1, s[4:7], s3 offen offset:1024
 v_xor_b32 v16, 32, v12
 v_add_u32 v16, 65536, v16
 ds_read_b64_tr_b16 v[48:49], v16 offset:0
 ds_read_b64_tr_b16 v[50:51], v16 offset:8192
 ds_read_b64_tr_b16 v[52:53], v16 offset:2048
 ds_read_b64_tr_b16 v[54:55], v16 offset:10240
 s_add_u32 s3, s63, 4096
 s_waitcnt lgkmcnt(2)
 buffer_store_dwordx4 v[48:51], v1, s[4:7], s3 offen offset:0
 s_waitcnt lgkmcnt(0)
 buffer_store_dwordx4 v[52:55], v1, s[4:7], s3 offen offset:1024
 v_xor_b32 v16, 0, v12
 v_add_u32 v16, 65536, v16
 ds_read_b64_tr_b16 v[56:57], v16 offset:16384
 ds_read_b64_tr_b16 v[58:59], v16 offset:24576
 ds_read_b64_tr_b16 v[60:61], v16 offset:18432
 ds_read_b64_tr_b16 v[62:63], v16 offset:26624
 s_add_u32 s3, s63, 6144
 s_waitcnt lgkmcnt(2)
 buffer_store_dwordx4 v[56:59], v1, s[4:7], s3 offen offset:0
 s_waitcnt lgkmcnt(0)
 buffer_store_dwordx4 v[60:63], v1, s[4:7], s3 offen offset:1024
 v_xor_b32 v16, 32, v12
 v_add_u32 v16, 65536, v16
 ds_read_b64_tr_b16 v[32:33], v16 offset:16384
 ds_read_b64_tr_b16 v[34:35], v16 offset:24576
 ds_read_b64_tr_b16 v[36:37], v16 offset:18432
 ds_read_b64_tr_b16 v[38:39], v16 offset:26624
 s_add_u32 s3, s63, 8192
 s_waitcnt lgkmcnt(2)
 buffer_store_dwordx4 v[32:35], v1, s[4:7], s3 offen offset:0
 s_waitcnt lgkmcnt(0)
 buffer_store_dwordx4 v[36:39], v1, s[4:7], s3 offen offset:1024
 s_waitcnt lgkmcnt(0)
 s_barrier
 s_lshl_b32 s14, s52, 8
 s_add_u32 s14, s14, 2621440
 s_mov_b32 m0, 81920
 s_nop 0
 buffer_load_dwordx4 v10, s[8:11], s14 offen lds
 s_add_u32 s14, s14, 32768
 s_mov_b32 m0, 82944
 s_nop 0
 buffer_load_dwordx4 v10, s[8:11], s14 offen lds
 s_add_u32 s14, s14, 32768
 s_mov_b32 m0, 83968
 s_nop 0
 buffer_load_dwordx4 v10, s[8:11], s14 offen lds
 s_add_u32 s14, s14, 32768
 s_mov_b32 m0, 84992
 s_nop 0
 buffer_load_dwordx4 v10, s[8:11], s14 offen lds
 s_add_u32 s14, s14, 32768
 s_mov_b32 m0, 86016
 s_nop 0
 buffer_load_dwordx4 v11, s[8:11], s14 offen lds
 s_add_u32 s14, s14, 32768
 s_mov_b32 m0, 87040
 s_nop 0
 buffer_load_dwordx4 v11, s[8:11], s14 offen lds
 s_add_u32 s14, s14, 32768
 s_mov_b32 m0, 88064
 s_nop 0
 buffer_load_dwordx4 v11, s[8:11], s14 offen lds
 s_add_u32 s14, s14, 32768
 s_mov_b32 m0, 89088
 s_nop 0
 buffer_load_dwordx4 v11, s[8:11], s14 offen lds
 s_waitcnt vmcnt(42)
 s_barrier
 v_xor_b32 v16, 0, v12
 v_add_u32 v16, 98304, v16
 ds_read_b64_tr_b16 v[184:185], v16 offset:0
 ds_read_b64_tr_b16 v[186:187], v16 offset:8192
 ds_read_b64_tr_b16 v[188:189], v16 offset:2048
 ds_read_b64_tr_b16 v[190:191], v16 offset:10240
 v_xor_b32 v16, 32, v12
 v_add_u32 v16, 98304, v16
 ds_read_b64_tr_b16 v[192:193], v16 offset:0
 ds_read_b64_tr_b16 v[194:195], v16 offset:8192
 ds_read_b64_tr_b16 v[196:197], v16 offset:2048
 ds_read_b64_tr_b16 v[198:199], v16 offset:10240
 v_xor_b32 v16, 0, v12
 v_add_u32 v16, 98304, v16
 ds_read_b64_tr_b16 v[200:201], v16 offset:16384
 ds_read_b64_tr_b16 v[202:203], v16 offset:24576
 ds_read_b64_tr_b16 v[204:205], v16 offset:18432
 ds_read_b64_tr_b16 v[206:207], v16 offset:26624
 v_xor_b32 v16, 32, v12
 v_add_u32 v16, 98304, v16
 ds_read_b64_tr_b16 v[208:209], v16 offset:16384
 ds_read_b64_tr_b16 v[210:211], v16 offset:24576
 ds_read_b64_tr_b16 v[212:213], v16 offset:18432
 ds_read_b64_tr_b16 v[214:215], v16 offset:26624
 s_waitcnt lgkmcnt(0)
 s_barrier
 s_lshl_b32 s14, s52, 8
 s_add_u32 s14, s14, 3670016
 s_mov_b32 m0, 114688
 s_nop 0
 buffer_load_dwordx4 v10, s[8:11], s14 offen lds
 s_add_u32 s14, s14, 32768
 s_mov_b32 m0, 115712
 s_nop 0
 buffer_load_dwordx4 v10, s[8:11], s14 offen lds
 s_add_u32 s14, s14, 32768
 s_mov_b32 m0, 116736
 s_nop 0
 buffer_load_dwordx4 v10, s[8:11], s14 offen lds
 s_add_u32 s14, s14, 32768
 s_mov_b32 m0, 117760
 s_nop 0
 buffer_load_dwordx4 v10, s[8:11], s14 offen lds
 s_add_u32 s14, s14, 32768
 s_mov_b32 m0, 118784
 s_nop 0
 buffer_load_dwordx4 v11, s[8:11], s14 offen lds
 s_add_u32 s14, s14, 32768
 s_mov_b32 m0, 119808
 s_nop 0
 buffer_load_dwordx4 v11, s[8:11], s14 offen lds
 s_add_u32 s14, s14, 32768
 s_mov_b32 m0, 120832
 s_nop 0
 buffer_load_dwordx4 v11, s[8:11], s14 offen lds
 s_add_u32 s14, s14, 32768
 s_mov_b32 m0, 121856
 s_nop 0
 buffer_load_dwordx4 v11, s[8:11], s14 offen lds
 s_waitcnt vmcnt(42)
 s_barrier
 v_xor_b32 v16, 0, v12
 v_add_u32 v16, 131072, v16
 ds_read_b64_tr_b16 v[216:217], v16 offset:0
 ds_read_b64_tr_b16 v[218:219], v16 offset:8192
 ds_read_b64_tr_b16 v[220:221], v16 offset:2048
 ds_read_b64_tr_b16 v[222:223], v16 offset:10240
 v_xor_b32 v16, 32, v12
 v_add_u32 v16, 131072, v16
 ds_read_b64_tr_b16 v[224:225], v16 offset:0
 ds_read_b64_tr_b16 v[226:227], v16 offset:8192
 ds_read_b64_tr_b16 v[228:229], v16 offset:2048
 ds_read_b64_tr_b16 v[230:231], v16 offset:10240
 v_xor_b32 v16, 0, v12
 v_add_u32 v16, 131072, v16
 ds_read_b64_tr_b16 v[232:233], v16 offset:16384
 ds_read_b64_tr_b16 v[234:235], v16 offset:24576
 ds_read_b64_tr_b16 v[236:237], v16 offset:18432
 ds_read_b64_tr_b16 v[238:239], v16 offset:26624
 v_xor_b32 v16, 32, v12
 v_add_u32 v16, 131072, v16
 ds_read_b64_tr_b16 v[40:41], v16 offset:16384
 ds_read_b64_tr_b16 v[42:43], v16 offset:24576
 ds_read_b64_tr_b16 v[44:45], v16 offset:18432
 ds_read_b64_tr_b16 v[46:47], v16 offset:26624
 s_add_u32 s3, s63, 10240
 s_waitcnt lgkmcnt(2)
 buffer_store_dwordx4 v[40:43], v1, s[4:7], s3 offen offset:0
 s_waitcnt lgkmcnt(0)
 buffer_store_dwordx4 v[44:47], v1, s[4:7], s3 offen offset:1024
 s_waitcnt lgkmcnt(0)
 s_barrier
 s_lshl_b32 s14, s52, 8
 s_add_u32 s14, s14, 4718592
 s_mov_b32 m0, 147456
 s_nop 0
 buffer_load_dwordx4 v10, s[8:11], s14 offen lds
 s_add_u32 s14, s14, 32768
 s_mov_b32 m0, 148480
 s_nop 0
 buffer_load_dwordx4 v10, s[8:11], s14 offen lds
 s_add_u32 s14, s14, 32768
 s_mov_b32 m0, 149504
 s_nop 0
 buffer_load_dwordx4 v10, s[8:11], s14 offen lds
 s_add_u32 s14, s14, 32768
 s_mov_b32 m0, 150528
 s_nop 0
 buffer_load_dwordx4 v10, s[8:11], s14 offen lds
 s_add_u32 s14, s14, 32768
 s_mov_b32 m0, 151552
 s_nop 0
 buffer_load_dwordx4 v11, s[8:11], s14 offen lds
 s_add_u32 s14, s14, 32768
 s_mov_b32 m0, 152576
 s_nop 0
 buffer_load_dwordx4 v11, s[8:11], s14 offen lds
 s_add_u32 s14, s14, 32768
 s_mov_b32 m0, 153600
 s_nop 0
 buffer_load_dwordx4 v11, s[8:11], s14 offen lds
 s_add_u32 s14, s14, 32768
 s_mov_b32 m0, 154624
 s_nop 0
 buffer_load_dwordx4 v11, s[8:11], s14 offen lds
 s_waitcnt vmcnt(44)
 s_barrier
 v_xor_b32 v16, 0, v12
 v_add_u32 v16, 0, v16
 ds_read_b64_tr_b16 v[240:241], v16 offset:0
 ds_read_b64_tr_b16 v[242:243], v16 offset:8192
 ds_read_b64_tr_b16 v[244:245], v16 offset:2048
 ds_read_b64_tr_b16 v[246:247], v16 offset:10240
 v_xor_b32 v16, 32, v12
 v_add_u32 v16, 0, v16
 ds_read_b64_tr_b16 v[248:249], v16 offset:0
 ds_read_b64_tr_b16 v[250:251], v16 offset:8192
 ds_read_b64_tr_b16 v[252:253], v16 offset:2048
 ds_read_b64_tr_b16 v[254:255], v16 offset:10240
 v_xor_b32 v16, 0, v12
 v_add_u32 v16, 0, v16
 ds_read_b64_tr_b16 v[32:33], v16 offset:16384
 ds_read_b64_tr_b16 v[34:35], v16 offset:24576
 ds_read_b64_tr_b16 v[36:37], v16 offset:18432
 ds_read_b64_tr_b16 v[38:39], v16 offset:26624
 v_xor_b32 v16, 32, v12
 v_add_u32 v16, 0, v16
 ds_read_b64_tr_b16 v[40:41], v16 offset:16384
 ds_read_b64_tr_b16 v[42:43], v16 offset:24576
 ds_read_b64_tr_b16 v[44:45], v16 offset:18432
 ds_read_b64_tr_b16 v[46:47], v16 offset:26624
 s_waitcnt lgkmcnt(0)
 s_barrier
 ds_write_b128 v1, v[224:227] offset:24576
 ds_write_b128 v1, v[228:231] offset:25600
 ds_write_b128 v1, v[216:219] offset:26624
 ds_write_b128 v1, v[220:223] offset:27648
 s_waitcnt lgkmcnt(0)
 v_mov_b32 v224, v32
 v_mov_b32 v225, v33
 v_mov_b32 v226, v34
 v_mov_b32 v227, v35
 v_mov_b32 v228, v36
 v_mov_b32 v229, v37
 v_mov_b32 v230, v38
 v_mov_b32 v231, v39
 v_mov_b32 v216, v40
 v_mov_b32 v217, v41
 v_mov_b32 v218, v42
 v_mov_b32 v219, v43
 v_mov_b32 v220, v44
 v_mov_b32 v221, v45
 v_mov_b32 v222, v46
 v_mov_b32 v223, v47
 s_waitcnt vmcnt(34)
 s_barrier
 v_xor_b32 v16, 0, v12
 v_add_u32 v16, 32768, v16
 ds_read_b64_tr_b16 v[32:33], v16 offset:0
 ds_read_b64_tr_b16 v[34:35], v16 offset:8192
 ds_read_b64_tr_b16 v[36:37], v16 offset:2048
 ds_read_b64_tr_b16 v[38:39], v16 offset:10240
 v_xor_b32 v16, 32, v12
 v_add_u32 v16, 32768, v16
 ds_read_b64_tr_b16 v[40:41], v16 offset:0
 ds_read_b64_tr_b16 v[42:43], v16 offset:8192
 ds_read_b64_tr_b16 v[44:45], v16 offset:2048
 ds_read_b64_tr_b16 v[46:47], v16 offset:10240
 v_xor_b32 v16, 0, v12
 v_add_u32 v16, 32768, v16
 ds_read_b64_tr_b16 v[48:49], v16 offset:16384
 ds_read_b64_tr_b16 v[50:51], v16 offset:24576
 ds_read_b64_tr_b16 v[52:53], v16 offset:18432
 ds_read_b64_tr_b16 v[54:55], v16 offset:26624
 v_xor_b32 v16, 32, v12
 v_add_u32 v16, 32768, v16
 ds_read_b64_tr_b16 v[56:57], v16 offset:16384
 ds_read_b64_tr_b16 v[58:59], v16 offset:24576
 ds_read_b64_tr_b16 v[60:61], v16 offset:18432
 ds_read_b64_tr_b16 v[62:63], v16 offset:26624
 s_waitcnt lgkmcnt(0)
 s_barrier
 ds_write_b128 v1, v[208:211] offset:49152
 ds_write_b128 v1, v[212:215] offset:50176
 ds_write_b128 v1, v[200:203] offset:51200
 ds_write_b128 v1, v[204:207] offset:52224
 ds_write_b128 v1, v[184:187] offset:53248
 ds_write_b128 v1, v[188:191] offset:54272
 ds_write_b128 v1, v[176:179] offset:55296
 ds_write_b128 v1, v[180:183] offset:56320
 s_waitcnt lgkmcnt(0)
 v_mov_b32 v208, v32
 v_mov_b32 v209, v33
 v_mov_b32 v210, v34
 v_mov_b32 v211, v35
 v_mov_b32 v212, v36
 v_mov_b32 v213, v37
 v_mov_b32 v214, v38
 v_mov_b32 v215, v39
 v_mov_b32 v200, v40
 v_mov_b32 v201, v41
 v_mov_b32 v202, v42
 v_mov_b32 v203, v43
 v_mov_b32 v204, v44
 v_mov_b32 v205, v45
 v_mov_b32 v206, v46
 v_mov_b32 v207, v47
 v_mov_b32 v184, v48
 v_mov_b32 v185, v49
 v_mov_b32 v186, v50
 v_mov_b32 v187, v51
 v_mov_b32 v188, v52
 v_mov_b32 v189, v53
 v_mov_b32 v190, v54
 v_mov_b32 v191, v55
 v_mov_b32 v176, v56
 v_mov_b32 v177, v57
 v_mov_b32 v178, v58
 v_mov_b32 v179, v59
 v_mov_b32 v180, v60
 v_mov_b32 v181, v61
 v_mov_b32 v182, v62
 v_mov_b32 v183, v63
 s_waitcnt vmcnt(18)
 s_barrier
 v_xor_b32 v16, 0, v12
 v_add_u32 v16, 65536, v16
 ds_read_b64_tr_b16 v[32:33], v16 offset:0
 ds_read_b64_tr_b16 v[34:35], v16 offset:8192
 ds_read_b64_tr_b16 v[36:37], v16 offset:2048
 ds_read_b64_tr_b16 v[38:39], v16 offset:10240
 v_xor_b32 v16, 32, v12
 v_add_u32 v16, 65536, v16
 ds_read_b64_tr_b16 v[40:41], v16 offset:0
 ds_read_b64_tr_b16 v[42:43], v16 offset:8192
 ds_read_b64_tr_b16 v[44:45], v16 offset:2048
 ds_read_b64_tr_b16 v[46:47], v16 offset:10240
 v_xor_b32 v16, 0, v12
 v_add_u32 v16, 65536, v16
 ds_read_b64_tr_b16 v[48:49], v16 offset:16384
 ds_read_b64_tr_b16 v[50:51], v16 offset:24576
 ds_read_b64_tr_b16 v[52:53], v16 offset:18432
 ds_read_b64_tr_b16 v[54:55], v16 offset:26624
 v_xor_b32 v16, 32, v12
 v_add_u32 v16, 65536, v16
 ds_read_b64_tr_b16 v[56:57], v16 offset:16384
 ds_read_b64_tr_b16 v[58:59], v16 offset:24576
 ds_read_b64_tr_b16 v[60:61], v16 offset:18432
 ds_read_b64_tr_b16 v[62:63], v16 offset:26624
 s_waitcnt lgkmcnt(0)
 s_barrier
 ds_write_b128 v2, v[168:171] offset:16384
 ds_write_b128 v2, v[172:175] offset:17408
 ds_write_b128 v2, v[160:163] offset:18432
 ds_write_b128 v2, v[164:167] offset:19456
 ds_write_b128 v2, v[144:147] offset:20480
 ds_write_b128 v2, v[148:151] offset:21504
 ds_write_b128 v2, v[128:131] offset:22528
 ds_write_b128 v2, v[132:135] offset:23552
 s_waitcnt lgkmcnt(0)
 v_mov_b32 v168, v32
 v_mov_b32 v169, v33
 v_mov_b32 v170, v34
 v_mov_b32 v171, v35
 v_mov_b32 v172, v36
 v_mov_b32 v173, v37
 v_mov_b32 v174, v38
 v_mov_b32 v175, v39
 v_mov_b32 v160, v40
 v_mov_b32 v161, v41
 v_mov_b32 v162, v42
 v_mov_b32 v163, v43
 v_mov_b32 v164, v44
 v_mov_b32 v165, v45
 v_mov_b32 v166, v46
 v_mov_b32 v167, v47
 v_mov_b32 v144, v48
 v_mov_b32 v145, v49
 v_mov_b32 v146, v50
 v_mov_b32 v147, v51
 v_mov_b32 v148, v52
 v_mov_b32 v149, v53
 v_mov_b32 v150, v54
 v_mov_b32 v151, v55
 v_mov_b32 v128, v56
 v_mov_b32 v129, v57
 v_mov_b32 v130, v58
 v_mov_b32 v131, v59
 v_mov_b32 v132, v60
 v_mov_b32 v133, v61
 v_mov_b32 v134, v62
 v_mov_b32 v135, v63
 s_waitcnt vmcnt(10)
 s_barrier
 v_xor_b32 v16, 0, v12
 v_add_u32 v16, 98304, v16
 ds_read_b64_tr_b16 v[32:33], v16 offset:0
 ds_read_b64_tr_b16 v[34:35], v16 offset:8192
 ds_read_b64_tr_b16 v[36:37], v16 offset:2048
 ds_read_b64_tr_b16 v[38:39], v16 offset:10240
 v_xor_b32 v16, 32, v12
 v_add_u32 v16, 98304, v16
 ds_read_b64_tr_b16 v[40:41], v16 offset:0
 ds_read_b64_tr_b16 v[42:43], v16 offset:8192
 ds_read_b64_tr_b16 v[44:45], v16 offset:2048
 ds_read_b64_tr_b16 v[46:47], v16 offset:10240
 v_xor_b32 v16, 0, v12
 v_add_u32 v16, 98304, v16
 ds_read_b64_tr_b16 v[48:49], v16 offset:16384
 ds_read_b64_tr_b16 v[50:51], v16 offset:24576
 ds_read_b64_tr_b16 v[52:53], v16 offset:18432
 ds_read_b64_tr_b16 v[54:55], v16 offset:26624
 v_xor_b32 v16, 32, v12
 v_add_u32 v16, 98304, v16
 ds_read_b64_tr_b16 v[56:57], v16 offset:16384
 ds_read_b64_tr_b16 v[58:59], v16 offset:24576
 ds_read_b64_tr_b16 v[60:61], v16 offset:18432
 ds_read_b64_tr_b16 v[62:63], v16 offset:26624
 s_waitcnt lgkmcnt(0)
 s_barrier
 ds_write_b128 v3, a[136:139] offset:0
 ds_write_b128 v3, a[140:143] offset:1024
 ds_write_b128 v3, a[128:131] offset:2048
 ds_write_b128 v3, a[132:135] offset:3072
 ds_write_b128 v3, a[112:115] offset:4096
 ds_write_b128 v3, a[116:119] offset:5120
 ds_write_b128 v3, a[88:91] offset:6144
 ds_write_b128 v3, a[92:95] offset:7168
 s_waitcnt lgkmcnt(0)
 v_accvgpr_write_b32 a136, v32
 v_accvgpr_write_b32 a137, v33
 v_accvgpr_write_b32 a138, v34
 v_accvgpr_write_b32 a139, v35
 v_accvgpr_write_b32 a140, v36
 v_accvgpr_write_b32 a141, v37
 v_accvgpr_write_b32 a142, v38
 v_accvgpr_write_b32 a143, v39
 v_accvgpr_write_b32 a128, v40
 v_accvgpr_write_b32 a129, v41
 v_accvgpr_write_b32 a130, v42
 v_accvgpr_write_b32 a131, v43
 v_accvgpr_write_b32 a132, v44
 v_accvgpr_write_b32 a133, v45
 v_accvgpr_write_b32 a134, v46
 v_accvgpr_write_b32 a135, v47
 v_accvgpr_write_b32 a112, v48
 v_accvgpr_write_b32 a113, v49
 v_accvgpr_write_b32 a114, v50
 v_accvgpr_write_b32 a115, v51
 v_accvgpr_write_b32 a116, v52
 v_accvgpr_write_b32 a117, v53
 v_accvgpr_write_b32 a118, v54
 v_accvgpr_write_b32 a119, v55
 v_accvgpr_write_b32 a88, v56
 v_accvgpr_write_b32 a89, v57
 v_accvgpr_write_b32 a90, v58
 v_accvgpr_write_b32 a91, v59
 v_accvgpr_write_b32 a92, v60
 v_accvgpr_write_b32 a93, v61
 v_accvgpr_write_b32 a94, v62
 v_accvgpr_write_b32 a95, v63
 s_waitcnt vmcnt(0)
 s_barrier
 v_xor_b32 v16, 0, v12
 v_add_u32 v16, 131072, v16
 ds_read_b64_tr_b16 v[32:33], v16 offset:0
 ds_read_b64_tr_b16 v[34:35], v16 offset:8192
 ds_read_b64_tr_b16 v[36:37], v16 offset:2048
 ds_read_b64_tr_b16 v[38:39], v16 offset:10240
 v_xor_b32 v16, 32, v12
 v_add_u32 v16, 131072, v16
 ds_read_b64_tr_b16 v[40:41], v16 offset:0
 ds_read_b64_tr_b16 v[42:43], v16 offset:8192
 ds_read_b64_tr_b16 v[44:45], v16 offset:2048
 ds_read_b64_tr_b16 v[46:47], v16 offset:10240
 v_xor_b32 v16, 0, v12
 v_add_u32 v16, 131072, v16
 ds_read_b64_tr_b16 v[48:49], v16 offset:16384
 ds_read_b64_tr_b16 v[50:51], v16 offset:24576
 ds_read_b64_tr_b16 v[52:53], v16 offset:18432
 ds_read_b64_tr_b16 v[54:55], v16 offset:26624
 v_xor_b32 v16, 32, v12
 v_add_u32 v16, 131072, v16
 ds_read_b64_tr_b16 v[56:57], v16 offset:16384
 ds_read_b64_tr_b16 v[58:59], v16 offset:24576
 ds_read_b64_tr_b16 v[60:61], v16 offset:18432
 ds_read_b64_tr_b16 v[62:63], v16 offset:26624
 s_waitcnt lgkmcnt(0)
 s_barrier
 ds_write_b128 v3, a[80:83] offset:32768
 ds_write_b128 v3, a[84:87] offset:33792
 ds_write_b128 v3, a[72:75] offset:34816
 ds_write_b128 v3, a[76:79] offset:35840
 ds_write_b128 v3, a[32:35] offset:36864
 ds_write_b128 v3, a[36:39] offset:37888
 ds_write_b128 v3, a[24:27] offset:38912
 ds_write_b128 v3, a[28:31] offset:39936
 s_waitcnt lgkmcnt(0)
 v_accvgpr_write_b32 a80, v32
 v_accvgpr_write_b32 a81, v33
 v_accvgpr_write_b32 a82, v34
 v_accvgpr_write_b32 a83, v35
 v_accvgpr_write_b32 a84, v36
 v_accvgpr_write_b32 a85, v37
 v_accvgpr_write_b32 a86, v38
 v_accvgpr_write_b32 a87, v39
 v_accvgpr_write_b32 a72, v40
 v_accvgpr_write_b32 a73, v41
 v_accvgpr_write_b32 a74, v42
 v_accvgpr_write_b32 a75, v43
 v_accvgpr_write_b32 a76, v44
 v_accvgpr_write_b32 a77, v45
 v_accvgpr_write_b32 a78, v46
 v_accvgpr_write_b32 a79, v47
 v_accvgpr_write_b32 a32, v48
 v_accvgpr_write_b32 a33, v49
 v_accvgpr_write_b32 a34, v50
 v_accvgpr_write_b32 a35, v51
 v_accvgpr_write_b32 a36, v52
 v_accvgpr_write_b32 a37, v53
 v_accvgpr_write_b32 a38, v54
 v_accvgpr_write_b32 a39, v55
 v_accvgpr_write_b32 a24, v56
 v_accvgpr_write_b32 a25, v57
 v_accvgpr_write_b32 a26, v58
 v_accvgpr_write_b32 a27, v59
 v_accvgpr_write_b32 a28, v60
 v_accvgpr_write_b32 a29, v61
 v_accvgpr_write_b32 a30, v62
 v_accvgpr_write_b32 a31, v63
 v_lshlrev_b32 v5, 3, v0
 v_and_b32 v6, 0x1e0, v5
 v_and_b32 v7, 1, v0
 v_lshl_add_u32 v6, v7, 4, v6
 v_and_b32 v7, 2, v0
 v_lshl_add_u32 v6, v7, 2, v6
 v_bfe_u32 v4, v0, 2, 2
 v_lshrrev_b32 v7, 4, v0
 v_cmp_eq_u32 vcc, v4, v7
 v_and_b32 v7, 16, v1
 v_mov_b32 v5, 0x3f80
 v_lshlrev_b32 v7, v7, v5
 v_cndmask_b32 v4, 0, v7, vcc
 v_mov_b32 v5, 0
 s_lshl_b32 s59, s53, 16
 s_add_u32 s59, s59, 983040
 s_mul_i32 s15, s53, 327680
 s_add_u32 s15, s15, 225280
 s_lshl_b32 s3, s52, 6
 s_add_u32 s15, s15, s3
 s_add_u32 s64, s15, 8192
 s_add_u32 s65, s15, 172032
 s_lshr_b32 s14, s52, 4
 s_add_u32 s14, s14, 8
 s_bfe_u32 s15, s52, 0x20002
 s_and_b32 s16, s52, 3
 s_mov_b32 s84, 0x000f000f
 s_mov_b32 s85, 0
 s_lshl_b32 s57, s14, 10
 s_lshl_b32 s3, s15, 6
 s_add_u32 s57, s57, s3
 s_lshl_b32 s3, s16, 8
 s_add_u32 s57, s57, s3
 s_add_u32 s57, s57, s59
 s_add_u32 s59, s59, 4096
 s_lshl_b32 s14, s14, 7
 s_mul_i32 s15, s15, 2560
 s_add_u32 s14, s14, s15
 s_lshl_b32 s3, s16, 3
 s_add_u32 s14, s14, s3
 s_mov_b32 s8, s18
 s_and_b32 s9, s19, 0xffff
 s_mov_b32 s10, 10240
 s_mov_b32 s11, 0x00020000
 v_bfe_u32 v40, v0, 4, 1
 v_mul_u32_u24 v40, 1280, v40
 v_and_b32 v41, 7, v0
 v_lshl_add_u32 v40, v41, 1, v40
 buffer_load_ushort v44, v40, s[8:11], s14 offen offset:0
 buffer_load_ushort v45, v40, s[8:11], s14 offen offset:32
 buffer_load_ushort v46, v40, s[8:11], s14 offen offset:64
 buffer_load_ushort v47, v40, s[8:11], s14 offen offset:96
 v_lshrrev_b32 v42, 6, v1
 v_mul_u32_u24 v42, 10240, v42
 v_and_b32 v7, 48, v1
 v_add_u32 v42, v42, v7
 v_and_b32 v43, 32, v1
 v_and_b32 v7, 64, v1
 v_lshl_add_u32 v43, v7, 2, v43
 v_bfe_u32 v7, v1, 8, 1
 v_lshl_add_u32 v43, v7, 4, v43
 v_bfe_u32 v7, v1, 4, 1
 v_lshl_add_u32 v43, v7, 3, v43
 s_waitcnt vmcnt(2)
 v_lshl_or_b32 v44, v45, 16, v44
 s_waitcnt vmcnt(0)
 v_lshl_or_b32 v45, v47, 16, v46
 s_add_u32 s16, s60, 5120
 s_waitcnt vmcnt(0) lgkmcnt(0)
 s_mov_b32 s96, s44
 s_and_b32 s97, s45, 0xffff
 s_mov_b32 s98, 256
 s_mov_b32 s99, 0x00020000
 v_mov_b32 v8, 132
 s_mov_b32 s51, 0
 s_mov_b64 exec, 1
L_wb_187:
 buffer_load_dword v9, v8, s[96:99], 0 offen sc1
 s_waitcnt vmcnt(0)
 v_cmp_eq_u32 vcc, 0, v9
 s_cbranch_vccz L_wbd_188
 s_sleep 2
 s_add_u32 s51, s51, 1
 s_cmp_lt_u32 s51, 131072
 s_cbranch_scc1 L_wb_187
 s_branch L_bail
L_wbd_188:
 s_mov_b64 exec, -1
 s_mov_b32 s96, s44
 s_and_b32 s97, s45, 0xffff
 s_mov_b32 s98, 256
 s_mov_b32 s99, 0x00020000
 v_mov_b32 v8, 212
 s_mov_b32 s51, 0
 s_mov_b64 exec, 1
L_wb_189:
 buffer_load_dword v9, v8, s[96:99], 0 offen sc1
 s_waitcnt vmcnt(0)
 v_cmp_eq_u32 vcc, 0, v9
 s_cbranch_vccz L_wbd_190
 s_sleep 2
 s_add_u32 s51, s51, 1
 s_cmp_lt_u32 s51, 131072
 s_cbranch_scc1 L_wb_189
 s_branch L_bail
L_wbd_190:
 s_mov_b64 exec, -1
 s_mov_b32 s96, s44
 s_and_b32 s97, s45, 0xffff
 s_mov_b32 s98, 256
 s_mov_b32 s99, 0x00020000
 v_lshlrev_b32 v8, 5, v0
 s_mov_b32 s51, 0
L_gl_191:
 buffer_load_dword v9, v8, s[96:99], 0 offen sc1
 s_waitcnt vmcnt(0)
 v_readlane_b32 s3, v9, s48
 s_mov_b32 s80, 0
 s_nop 2
 s_cmp_ge_u32 s3, 32
 s_cbranch_scc1 L_gld_192
 s_mov_b32 s80, 0
 v_readlane_b32 s3, v9, 0
 s_nop 3
 s_add_u32 s80, s80, s3
 v_readlane_b32 s3, v9, 1
 s_nop 3
 s_add_u32 s80, s80, s3
 v_readlane_b32 s3, v9, 2
 s_nop 3
 s_add_u32 s80, s80, s3
 v_readlane_b32 s3, v9, 3
 s_nop 3
 s_add_u32 s80, s80, s3
 v_readlane_b32 s3, v9, 4
 s_nop 3
 s_add_u32 s80, s80, s3
 v_readlane_b32 s3, v9, 5
 s_nop 3
 s_add_u32 s80, s80, s3
 v_readlane_b32 s3, v9, 6
 s_nop 3
 s_add_u32 s80, s80, s3
 v_readlane_b32 s3, v9, 7
 s_nop 3
 s_add_u32 s80, s80, s3
 s_cmp_ge_u32 s80, 256
 s_cbranch_scc1 L_gld_192
 s_sleep 4
 s_add_u32 s51, s51, 1
 s_cmp_lt_u32 s51, 131072
 s_cbranch_scc1 L_gl_191
 s_branch L_bail
L_gld_192:
 s_mov_b64 exec, s[84:85]
 buffer_store_dwordx2 v[44:45], v43, s[4:7], s57 offen sc1
 s_mov_b64 exec, -1
 v_and_b32 v7, 2, v0
 v_mul_u32_u24 v7, 0x5555, v7
 v_add_u32 v0, 0x4444, v7
 s_mov_b32 m0, 2048
 s_waitcnt vmcnt(0) lgkmcnt(0)
 s_barrier
 buffer_load_dwordx4 v[32:35], v1, s[4:7], s63 offen offset:2048
 buffer_load_dwordx4 v[36:39], v1, s[4:7], s63 offen offset:3072
 buffer_load_dwordx4 v[40:43], v1, s[4:7], s81 offen offset:0
 buffer_load_dwordx4 v[44:47], v1, s[4:7], s81 offen offset:1024
 buffer_load_dwordx4 v[48:51], v1, s[4:7], s81 offen offset:2048
 buffer_load_dwordx4 v[52:55], v1, s[4:7], s81 offen offset:3072
 buffer_load_dwordx4 v[56:59], v1, s[4:7], s101 offen offset:0
 buffer_load_dwordx4 v[60:63], v1, s[4:7], s101 offen offset:1024
 ds_read_b128 v[8:11], v3 offset:49152
 ds_read_b128 v[12:15], v3 offset:49152
 ds_read_b128 v[16:19], v3 offset:49152
 ds_read_b128 v[20:23], v3 offset:49152
 s_waitcnt vmcnt(0) lgkmcnt(0)
 s_cmp_lg_u32 s80, 0
 s_cbranch_scc1 L_ch2_s
.p2align 6
L_ch2_f:
 s_mov_b32 s51, 0
L_pm_193:
 buffer_load_dwordx4 v[24:27], v1, s[4:7], s59 offen offset:0 sc1
 buffer_load_dwordx4 v[28:31], v1, s[4:7], s59 offen offset:1024 sc1
 s_add_u32 s3, s59, 4096
 buffer_load_dwordx4 v[12:15], v1, s[4:7], s3 offen offset:0 sc1
 s_waitcnt vmcnt(2)
 ds_write_b128 v1, v[24:27] offset:4096
 v_max_u32 v7, v24, v26
 s_waitcnt vmcnt(1)
 ds_write_b128 v1, v[28:31] offset:5120
 v_max3_u32 v7, v7, v28, v30
 s_waitcnt vmcnt(0)
 ds_write_b128 v1, v[12:15] offset:8192
 v_max3_u32 v7, v7, v12, v14
 v_cmp_eq_u32 vcc, -1, v7
 s_cbranch_vccnz L_rt_194
 ds_read_b128 v[12:15], v3 offset:49152
 v_smfmac_f32_16x16x64_bf16 v[16:19], v[24:27], v[32:39], v0
 ds_read_b128 v[32:35], v1 offset:26624
 ds_read_b128 v[36:39], v1 offset:27648
 v_smfmac_f32_16x16x64_bf16 v[20:23], v[24:27], v[40:47], v0
 ds_read_b128 v[40:43], v1 offset:24576
 ds_read_b128 v[44:47], v1 offset:25600
 v_smfmac_f32_16x16x64_bf16 v[16:19], v[28:31], v[48:55], v0
 v_smfmac_f32_16x16x64_bf16 v[20:23], v[28:31], v[56:63], v0
 s_waitcnt lgkmcnt(5)
 s_barrier
 buffer_load_dwordx4 v[56:59], v1, s[4:7], s63 offen offset:0
 v_smfmac_f32_16x16x64_bf16 v[8:11], v[24:27], v[168:175], v0
 s_waitcnt lgkmcnt(4)
 v_smfmac_f32_16x16x64_bf16 v[12:15], v[24:27], v[160:167], v0
 ds_read_b128 v[24:27], v1 offset:8192
 buffer_load_dwordx4 v[60:63], v1, s[4:7], s63 offen offset:1024
 v_smfmac_f32_16x16x64_bf16 v[8:11], v[28:31], v[144:151], v0
 v_smfmac_f32_16x16x64_bf16 v[12:15], v[28:31], v[128:135], v0
 ds_read_b128 v[28:31], v1 offset:0
 buffer_load_dwordx4 v[48:51], v1, s[4:7], s101 offen offset:2048
 s_waitcnt lgkmcnt(1)
 v_smfmac_f32_16x16x64_bf16 v[16:19], v[24:27], v[32:39], v0
 ds_read_b128 v[32:35], v2 offset:22528
 ds_read_b128 v[36:39], v2 offset:23552
 v_smfmac_f32_16x16x64_bf16 v[8:11], v[24:27], a[80:87], v0
 buffer_load_dwordx4 v[52:55], v1, s[4:7], s101 offen offset:3072
 v_smfmac_f32_16x16x64_bf16 v[12:15], v[24:27], a[72:79], v0
 v_smfmac_f32_16x16x64_bf16 v[20:23], v[24:27], v[40:47], v0
 ds_read_b128 v[40:43], v2 offset:20480
 ds_read_b128 v[44:47], v2 offset:21504
 ds_read_b128 v[24:27], v1 offset:1024
 s_waitcnt lgkmcnt(5)
 v_smfmac_f32_16x16x64_bf16 v[8:11], v[28:31], v[240:247], v0
 v_smfmac_f32_16x16x64_bf16 v[12:15], v[28:31], v[248:255], v0
 s_waitcnt lgkmcnt(3)
 v_smfmac_f32_16x16x64_bf16 v[16:19], v[28:31], v[32:39], v0
 ds_read_b128 v[32:35], v2 offset:18432
 ds_read_b128 v[36:39], v2 offset:19456
 v_smfmac_f32_16x16x64_bf16 v[20:23], v[28:31], v[136:143], v0
 ds_read_b128 v[28:31], v1 offset:2048
 s_waitcnt lgkmcnt(3)
 v_smfmac_f32_16x16x64_bf16 v[8:11], v[24:27], v[224:231], v0
 v_smfmac_f32_16x16x64_bf16 v[16:19], v[24:27], v[40:47], v0
 ds_read_b128 v[40:43], v2 offset:16384
 ds_read_b128 v[44:47], v2 offset:17408
 v_smfmac_f32_16x16x64_bf16 v[12:15], v[24:27], v[216:223], v0
 v_smfmac_f32_16x16x64_bf16 v[20:23], v[24:27], v[152:159], v0
 ds_read_b128 v[24:27], v1 offset:3072
 s_waitcnt lgkmcnt(3)
 v_smfmac_f32_16x16x64_bf16 v[16:19], v[28:31], v[32:39], v0
 ds_read_b128 v[32:35], v1 offset:55296
 ds_read_b128 v[36:39], v1 offset:56320
 v_smfmac_f32_16x16x64_bf16 v[8:11], v[28:31], v[208:215], v0
 v_smfmac_f32_16x16x64_bf16 v[12:15], v[28:31], v[200:207], v0
 s_waitcnt lgkmcnt(3)
 v_smfmac_f32_16x16x64_bf16 v[20:23], v[28:31], v[40:47], v0
 ds_read_b128 v[40:43], v1 offset:53248
 ds_read_b128 v[44:47], v1 offset:54272
 ds_read_b128 v[28:31], v1 offset:6144
 s_waitcnt lgkmcnt(5)
 v_smfmac_f32_16x16x64_bf16 v[8:11], v[24:27], v[184:191], v0
 v_smfmac_f32_16x16x64_bf16 v[12:15], v[24:27], v[176:183], v0
 s_waitcnt lgkmcnt(3)
 v_smfmac_f32_16x16x64_bf16 v[16:19], v[24:27], v[32:39], v0
 ds_read_b128 v[32:35], v1 offset:51200
 ds_read_b128 v[36:39], v1 offset:52224
 s_waitcnt vmcnt(2)
 v_smfmac_f32_16x16x64_bf16 v[20:23], v[24:27], v[56:63], v0
 ds_read_b128 v[24:27], v1 offset:7168
 buffer_load_dwordx4 v[56:59], v1, s[4:7], s61 offen offset:2048 sc1 nt
 s_waitcnt lgkmcnt(3)
 v_smfmac_f32_16x16x64_bf16 v[8:11], v[28:31], a[136:143], v0
 v_smfmac_f32_16x16x64_bf16 v[16:19], v[28:31], v[40:47], v0
 ds_read_b128 v[40:43], v1 offset:49152
 ds_read_b128 v[44:47], v1 offset:50176
 s_add_u32 s3, s61, 4096
 buffer_load_dwordx4 v[60:63], v1, s[4:7], s3 offen offset:2048 sc1 nt
 v_smfmac_f32_16x16x64_bf16 v[12:15], v[28:31], a[128:135], v0
 v_smfmac_f32_16x16x64_bf16 v[20:23], v[28:31], v[192:199], v0
 ds_read_b128 v[28:31], v1 offset:9216
 s_waitcnt lgkmcnt(3)
 v_smfmac_f32_16x16x64_bf16 v[16:19], v[24:27], v[32:39], v0
 v_smfmac_f32_16x16x64_bf16 v[8:11], v[24:27], a[112:119], v0
 s_add_u32 s3, s61, 67112960
 buffer_load_dwordx4 v[32:35], v1, s[4:7], s3 offen offset:0 sc1 nt
 v_smfmac_f32_16x16x64_bf16 v[12:15], v[24:27], a[88:95], v0
 s_waitcnt lgkmcnt(1)
 v_smfmac_f32_16x16x64_bf16 v[20:23], v[24:27], v[40:47], v0
 ds_read_b128 v[40:43], v3 offset:49152
 ds_read_b128 v[44:47], v3 offset:49152
 buffer_load_dwordx4 v[36:39], v1, s[4:7], s3 offen offset:1024 sc1 nt
 s_waitcnt lgkmcnt(2)
 v_smfmac_f32_16x16x64_bf16 v[8:11], v[28:31], a[32:39], v0
 v_smfmac_f32_16x16x64_bf16 v[12:15], v[28:31], a[24:31], v0
 v_lshlrev_b32 v7, 3, v1
 v_smfmac_f32_16x16x64_bf16 v[16:19], v[28:31], v[232:239], v0
 s_waitcnt vmcnt(4)
 v_smfmac_f32_16x16x64_bf16 v[20:23], v[28:31], v[48:55], v0
 s_add_u32 s3, s61, 67633152
 buffer_load_dword v7, v7, s[4:7], s3 offen sc1
 ds_read_b128 v[52:55], v1 offset:0
 v_add_f32 v8, v8, v10
 v_add_f32 v11, v9, v11
 v_cvt_pk_bf16_f32 v9, v8, v11
 v_cvt_pk_bf16_f32 v8, v8, v11
 v_add_f32 v12, v12, v14
 v_add_f32 v15, v13, v15
 v_cvt_pk_bf16_f32 v13, v12, v15
 v_cvt_pk_bf16_f32 v12, v12, v15
 v_mfma_f32_16x16x16_bf16 v[8:11], v[8:9], v[4:5], 0
 v_mfma_f32_16x16x16_bf16 v[12:15], v[12:13], v[4:5], 0
 v_add_f32 v16, v16, v18
 v_add_f32 v19, v17, v19
 v_cvt_pk_bf16_f32 v17, v16, v19
 v_cvt_pk_bf16_f32 v16, v16, v19
 v_add_f32 v20, v20, v22
 v_add_f32 v23, v21, v23
 v_cvt_pk_bf16_f32 v21, v20, v23
 v_cvt_pk_bf16_f32 v20, v20, v23
 v_mfma_f32_16x16x16_bf16 v[16:19], v[16:17], v[4:5], 0
 v_mfma_f32_16x16x16_bf16 v[20:23], v[20:21], v[4:5], 0
 s_waitcnt lgkmcnt(2)
 v_smfmac_f32_16x16x64_bf16 v[40:43], v[24:27], v[80:87], v0
 s_waitcnt lgkmcnt(1)
 v_smfmac_f32_16x16x64_bf16 v[44:47], v[24:27], v[88:95], v0
 ds_read_b128 v[24:27], v1 offset:1024
 v_cvt_pk_bf16_f32 v15, v14, v15
 v_cvt_pk_bf16_f32 v14, v12, v13
 v_cvt_pk_bf16_f32 v13, v10, v11
 v_cvt_pk_bf16_f32 v12, v8, v9
 s_waitcnt vmcnt(4)
 s_nop 0
 v_mfma_f32_16x16x32_bf16 v[8:11], v[56:59], v[12:15], 0
 v_cvt_pk_bf16_f32 v23, v22, v23
 v_cvt_pk_bf16_f32 v22, v20, v21
 v_cvt_pk_bf16_f32 v21, v18, v19
 v_cvt_pk_bf16_f32 v20, v16, v17
 s_waitcnt vmcnt(3)
 v_mfma_f32_16x16x32_bf16 v[16:19], v[60:63], v[12:15], 0
 v_mfma_f32_16x16x32_bf16 v[48:51], v[20:23], v[12:15], 0
 v_smfmac_f32_16x16x64_bf16 v[40:43], v[28:31], v[112:119], v0
 v_smfmac_f32_16x16x64_bf16 v[44:47], v[28:31], v[120:127], v0
 ds_read_b128 v[28:31], v1 offset:2048
 s_waitcnt lgkmcnt(2)
 v_smfmac_f32_16x16x64_bf16 v[40:43], v[52:55], a[160:167], v0
 v_cndmask_b32 v8, v8, v16, s[70:71]
 v_cndmask_b32 v9, v9, v17, s[70:71]
 v_cndmask_b32 v10, v10, v18, s[70:71]
 v_cndmask_b32 v11, v11, v19, s[70:71]
 ds_write_b128 v1, v[8:11] offset:12288
 ds_write_b64 v1, v[48:49] offset:15360
 v_smfmac_f32_16x16x64_bf16 v[44:47], v[52:55], a[168:175], v0
 ds_read_b128 v[52:55], v1 offset:3072
 s_waitcnt lgkmcnt(4)
 v_smfmac_f32_16x16x64_bf16 v[40:43], v[24:27], a[176:183], v0
 v_smfmac_f32_16x16x64_bf16 v[44:47], v[24:27], a[184:191], v0
 ds_read_b128 v[24:27], v1 offset:4096
 s_waitcnt lgkmcnt(4)
 v_smfmac_f32_16x16x64_bf16 v[40:43], v[28:31], a[192:199], v0
 v_smfmac_f32_16x16x64_bf16 v[44:47], v[28:31], a[200:207], v0
 ds_read_b128 v[28:31], v1 offset:5120
 s_waitcnt lgkmcnt(2)
 v_smfmac_f32_16x16x64_bf16 v[40:43], v[52:55], a[208:215], v0
 v_smfmac_f32_16x16x64_bf16 v[44:47], v[52:55], a[216:223], v0
 ds_read_b128 v[52:55], v1 offset:6144
 s_barrier
 ds_read_b128 v[56:59], v1 offset:10240
 ds_read_b128 v[60:63], v1 offset:11264
 ds_read_b128 v[16:19], v1 offset:13312
 ds_read_b128 v[12:15], v1 offset:14336
 ds_read_b128 v[48:51], v1 offset:15360
 s_waitcnt lgkmcnt(7)
 v_smfmac_f32_16x16x64_bf16 v[40:43], v[24:27], a[224:231], v0
 s_mov_b64 exec, s[68:69]
 buffer_store_dwordx4 v[20:23], v6, s[4:7], s62 offen offset:1024 sc1
 s_mov_b64 exec, -1
 v_smfmac_f32_16x16x64_bf16 v[44:47], v[24:27], a[232:239], v0
 ds_read_b128 v[24:27], v1 offset:8192
 s_waitcnt lgkmcnt(7)
 v_smfmac_f32_16x16x64_bf16 v[40:43], v[28:31], a[240:247], v0
 v_smfmac_f32_16x16x64_bf16 v[44:47], v[28:31], a[248:255], v0
 s_waitcnt lgkmcnt(6)
 v_smfmac_f32_16x16x64_bf16 v[40:43], v[52:55], v[64:71], v0
 v_smfmac_f32_16x16x64_bf16 v[44:47], v[52:55], v[72:79], v0
 s_waitcnt lgkmcnt(0)
 v_smfmac_f32_16x16x64_bf16 v[40:43], v[24:27], v[96:103], v0
 v_smfmac_f32_16x16x64_bf16 v[44:47], v[24:27], v[104:111], v0
 v_pk_add_f32 v[8:9], v[8:9], v[56:57]
 v_pk_add_f32 v[10:11], v[10:11], v[58:59]
 v_pk_add_f32 v[60:61], v[60:61], v[16:17]
 v_pk_add_f32 v[62:63], v[62:63], v[18:19]
 v_pk_add_f32 v[12:13], v[12:13], v[14:15]
 v_pk_add_f32 v[48:49], v[48:49], v[50:51]
 v_pk_add_f32 v[8:9], v[8:9], v[60:61]
 v_pk_add_f32 v[10:11], v[10:11], v[62:63]
 v_pk_add_f32 v[48:49], v[12:13], v[48:49]
 v_max3_f32 v50, v8, v9, v10
 v_max3_f32 v50, v50, v11, v48
 v_max_f32 v50, v50, v49
 v_add_f32 v40, v40, v42
 v_add_f32 v41, v41, v43
 v_max_f32_dpp v50, v50, v50 quad_perm:[2,3,0,1] row_mask:0xf bank_mask:0xf
 v_mov_b32 v51, v50
 v_add_f32 v44, v44, v46
 v_add_f32 v45, v45, v47
 v_permlane16_swap_b32 v50, v51
 v_max_f32 v50, v50, v51
 v_mov_b32 v51, v50
 v_cvt_pk_bf16_f32 v40, v40, v41
 v_cvt_pk_bf16_f32 v41, v44, v45
 v_permlane32_swap_b32 v50, v51
 v_max_f32 v50, v50, v51
 v_mul_f32 v50, s56, v50
 v_fma_f32 v48, v48, s56, -v50
 v_fma_f32 v49, v49, s56, -v50
 v_fma_f32 v8, v8, s56, -v50
 v_fma_f32 v9, v9, s56, -v50
 v_fma_f32 v10, v10, s56, -v50
 v_fma_f32 v11, v11, s56, -v50
 v_exp_f32 v48, v48
 v_lshrrev_b32 v51, 1, v1
 v_exp_f32 v49, v49
 ds_read_b128 v[56:59], v3 offset:32768
 ds_read_b128 v[60:63], v3 offset:33792
 v_exp_f32 v8, v8
 v_exp_f32 v9, v9
 ds_read_b128 v[24:27], v3 offset:4096
 ds_read_b128 v[28:31], v3 offset:5120
 v_exp_f32 v10, v10
 buffer_store_dwordx2 v[40:41], v51, s[4:7], s62 offen offset:3072 sc1
 v_exp_f32 v11, v11
 v_cvt_pk_bf16_f32 v14, v48, v49
 v_cvt_pk_bf16_f32 v12, v8, v9
 v_cvt_pk_bf16_f32 v13, v10, v11
 v_cndmask_b32 v52, 0, v14, s[68:69]
 v_cndmask_b32 v53, 0, v14, s[70:71]
 v_cndmask_b32 v22, 0, v12, s[70:71]
 v_cndmask_b32 v23, 0, v13, s[70:71]
 v_mfma_f32_16x16x16_bf16 v[44:47], v[40:41], v[52:53], 0
 v_cndmask_b32 v16, 0, v12, s[68:69]
 v_cndmask_b32 v17, 0, v13, s[68:69]
 v_mov_b32_dpp v18, v22 quad_perm:[2,3,0,1] row_mask:0xf bank_mask:0xf
 v_mov_b32_dpp v19, v23 quad_perm:[2,3,0,1] row_mask:0xf bank_mask:0xf
 v_mov_b32_dpp v20, v16 quad_perm:[2,3,0,1] row_mask:0xf bank_mask:0xf
 v_mov_b32_dpp v21, v17 quad_perm:[2,3,0,1] row_mask:0xf bank_mask:0xf
 s_waitcnt vmcnt(4)
 v_mfma_f32_16x16x32_bf16 v[44:47], v[32:35], v[16:19], v[44:47]
 v_add_f32 v54, v8, v9
 v_add_f32 v55, v48, v49
 s_waitcnt vmcnt(3)
 v_mfma_f32_16x16x32_bf16 v[44:47], v[36:39], v[20:23], v[44:47]
 v_add_f32 v54, v54, v10
 v_fma_f32 v55, v55, 0.5, v11
 v_add_f32 v54, v54, v55
 ds_read_b128 v[16:19], v3 offset:49152
 ds_read_b128 v[20:23], v3 offset:49152
 v_add_f32_dpp v54, v54, v54 quad_perm:[2,3,0,1] row_mask:0xf bank_mask:0xf
 v_mov_b32 v55, v54
 ds_read_b128 v[32:35], v3 offset:49152
 ds_read_b128 v[36:39], v3 offset:49152
 v_permlane16_swap_b32 v54, v55
 v_add_f32 v54, v54, v55
 v_mov_b32 v55, v54
 ds_read_b128 v[8:11], v3 offset:49152
 s_cmp_eq_u32 s54, 63
 v_permlane32_swap_b32 v54, v55
 v_add_f32 v54, v54, v55
 v_rcp_f32 v54, v54
 s_cbranch_scc1 L_ch2_end
 v_mul_f32 v44, v44, v54
 v_mul_f32 v45, v45, v54
 v_cvt_pk_bf16_f32 v42, v44, v45
 v_mul_f32 v46, v46, v54
 v_mul_f32 v47, v47, v54
 v_cvt_pk_bf16_f32 v43, v46, v47
 ds_write_b64 v6, v[42:43] offset:1024
 v_and_b32 v40, -9, v6
 v_mov_b32_dpp v12, v42 quad_perm:[0,1,0,1] row_mask:0xf bank_mask:0xf
 v_mov_b32_dpp v14, v42 quad_perm:[2,3,2,3] row_mask:0xf bank_mask:0xf
 v_mov_b32_dpp v13, v43 quad_perm:[0,1,0,1] row_mask:0xf bank_mask:0xf
 v_mov_b32_dpp v15, v43 quad_perm:[2,3,2,3] row_mask:0xf bank_mask:0xf
 s_waitcnt lgkmcnt(5)
 s_nop 0
 v_smfmac_f32_16x16x64_bf16 v[16:19], v[12:15], a[16:23], v0
 s_waitcnt lgkmcnt(4)
 v_smfmac_f32_16x16x64_bf16 v[20:23], v[12:15], a[48:55], v0
 s_waitcnt lgkmcnt(0)
 s_barrier
 ds_read_b128 v[48:51], v40 offset:0
 ds_read_b128 v[52:55], v40 offset:512
 ds_read_b128 v[44:47], v40 offset:1536
 v_smfmac_f32_16x16x64_bf16 v[32:35], v[12:15], v[56:63], v0
 ds_read_b128 v[56:59], v3 offset:38912
 ds_read_b128 v[60:63], v3 offset:39936
 s_mov_b32 m0, 4096
 v_smfmac_f32_16x16x64_bf16 v[36:39], v[12:15], v[24:31], v0
 ds_read_b128 v[24:27], v3 offset:36864
 ds_read_b128 v[28:31], v3 offset:37888
 buffer_load_dwordx4 v1, s[4:7], s81 offen offset:0 lds
 v_smfmac_f32_16x16x64_bf16 v[8:11], v[12:15], a[144:151], v0
 s_mov_b32 m0, 4096
 s_waitcnt lgkmcnt(6)
 v_smfmac_f32_16x16x64_bf16 v[16:19], v[48:51], a[0:7], v0
 buffer_load_dwordx4 v1, s[4:7], s81 offen offset:1024 lds
 s_waitcnt lgkmcnt(5)
 v_smfmac_f32_16x16x64_bf16 v[16:19], v[52:55], a[8:15], v0
 s_mov_b32 m0, 6144
 s_waitcnt lgkmcnt(2)
 v_smfmac_f32_16x16x64_bf16 v[16:19], v[44:47], v[56:63], v0
 ds_read_b128 v[56:59], v3 offset:34816
 ds_read_b128 v[60:63], v3 offset:35840
 buffer_load_dwordx4 v1, s[4:7], s81 offen offset:2048 lds
 s_waitcnt lgkmcnt(2)
 v_smfmac_f32_16x16x64_bf16 v[20:23], v[48:51], v[24:31], v0
 ds_read_b128 v[24:27], v3 offset:6144
 ds_read_b128 v[28:31], v3 offset:7168
 v_smfmac_f32_16x16x64_bf16 v[20:23], v[52:55], a[40:47], v0
 v_smfmac_f32_16x16x64_bf16 v[20:23], v[44:47], a[56:63], v0
 v_cvt_pk_bf16_f32 v16, v16, v17
 v_smfmac_f32_16x16x64_bf16 v[32:35], v[48:51], a[64:71], v0
 v_cvt_pk_bf16_f32 v17, v18, v19
 s_waitcnt lgkmcnt(2)
 v_smfmac_f32_16x16x64_bf16 v[32:35], v[52:55], v[56:63], v0
 ds_read_b128 v[56:59], v3 offset:2048
 ds_read_b128 v[60:63], v3 offset:3072
 v_and_or_b32 v16, v16, -2, s55
 s_waitcnt lgkmcnt(2)
 v_smfmac_f32_16x16x64_bf16 v[32:35], v[44:47], v[24:31], v0
 ds_read_b128 v[24:27], v3 offset:0
 ds_read_b128 v[28:31], v3 offset:1024
 v_cvt_pk_bf16_f32 v18, v20, v21
 v_smfmac_f32_16x16x64_bf16 v[36:39], v[48:51], a[96:103], v0
 v_cvt_pk_bf16_f32 v19, v22, v23
 v_smfmac_f32_16x16x64_bf16 v[36:39], v[52:55], a[104:111], v0
 v_and_or_b32 v18, v18, -2, s55
 buffer_store_dwordx4 v[16:19], v1, s[4:7], s60 offen offset:0
 v_smfmac_f32_16x16x64_bf16 v[36:39], v[44:47], a[120:127], v0
 v_cvt_pk_bf16_f32 v32, v32, v33
 s_waitcnt lgkmcnt(2)
 v_smfmac_f32_16x16x64_bf16 v[8:11], v[48:51], v[56:63], v0
 v_cvt_pk_bf16_f32 v33, v34, v35
 s_waitcnt lgkmcnt(0)
 v_smfmac_f32_16x16x64_bf16 v[8:11], v[52:55], v[24:31], v0
 v_and_or_b32 v32, v32, -2, s55
 v_smfmac_f32_16x16x64_bf16 v[8:11], v[44:47], a[152:159], v0
 v_cvt_pk_bf16_f32 v34, v36, v37
 v_cvt_pk_bf16_f32 v35, v38, v39
 v_and_or_b32 v34, v34, -2, s55
 buffer_store_dwordx4 v[32:35], v1, s[4:7], s60 offen offset:1024
 s_nop 3
 v_cvt_pk_bf16_f32 v8, v8, v9
 v_cvt_pk_bf16_f32 v9, v10, v11
 v_and_or_b32 v8, v8, -2, s55
 buffer_store_dwordx2 v[8:9], v1, s[4:7], s16 offen offset:0
 buffer_load_dwordx4 v[32:35], v1, s[4:7], s63 offen offset:2048
 buffer_load_dwordx4 v[36:39], v1, s[4:7], s63 offen offset:3072
 s_add_u32 s54, s54, 1
 s_add_u32 s61, s61, 524288
 s_and_b32 s3, s54, 7
 s_cselect_b32 s3, 1, -7
 s_lshl_b32 s3, s3, 17
 s_add_u32 s62, s62, s3
 s_and_b32 s3, s54, 3
 s_cselect_b32 s3, 1, -3
 s_lshl_b32 s3, s3, 14
 s_add_u32 s57, s57, s3
 s_add_u32 s59, s59, s3
 s_xor_b32 s58, s57, 32768
 v_lshrrev_b32 v56, 6, v1
 v_mul_u32_u24 v56, 10240, v56
 v_and_b32 v60, 48, v1
 v_add_u32 v56, v56, v60
 v_and_b32 v57, 32, v1
 v_and_b32 v60, 64, v1
 v_lshl_add_u32 v57, v60, 2, v57
 v_bfe_u32 v60, v1, 8, 1
 v_lshl_add_u32 v57, v60, 4, v57
 v_bfe_u32 v60, v1, 4, 1
 v_lshl_add_u32 v57, v60, 3, v57
 v_mov_b32 v60, 0x3f80
 v_mov_b32 v28, 0x3f800000
 v_cndmask_b32 v60, v60, v28, s[82:83]
 v_cndmask_b32 v28, 0, v60, s[72:73]
 v_cndmask_b32 v29, 0, v60, s[74:75]
 v_cndmask_b32 v30, 0, v60, s[76:77]
 v_cndmask_b32 v31, 0, v60, s[78:79]
 v_mov_b64 v[58:59], -1
 s_mov_b64 exec, s[84:85]
 buffer_store_dwordx2 v[58:59], v57, s[4:7], s58 offen
 s_mov_b64 exec, -1
 s_nop 15
 s_nop 15
 s_nop 15
 s_nop 15
 s_nop 15
 s_mov_b32 s51, 0
 buffer_load_dwordx4 v[8:11], v56, s[4:7], s64 offen sc1
 buffer_load_dwordx4 v[12:15], v56, s[4:7], s65 offen sc1
L_pp_195:
 s_waitcnt vmcnt(1)
 v_mfma_f32_16x16x32_bf16 v[24:27], v[28:31], v[8:11], 0
 v_bitop3_b32 v60, v8, v10, s55 bitop3:0x7e
 s_waitcnt vmcnt(0)
 v_mfma_f32_16x16x32_bf16 v[24:27], v[28:31], v[12:15], v[24:27]
 v_bitop3_b32 v61, v12, v14, s55 bitop3:0x7e
 v_bitop3_b32 v7, v60, v61, 1 bitop3:0xa8
 v_cmp_ne_u32 vcc, 0, v7
 s_cbranch_vccnz L_rt_196
 s_nop 3
 v_add_f32_dpp v24, v24, v24 row_ror:8 row_mask:0xf bank_mask:0xf
 v_add_f32_dpp v25, v25, v25 row_ror:8 row_mask:0xf bank_mask:0xf
 v_add_f32_dpp v26, v26, v26 row_ror:8 row_mask:0xf bank_mask:0xf
 v_add_f32_dpp v27, v27, v27 row_ror:8 row_mask:0xf bank_mask:0xf
 v_add_f32_dpp v24, v24, v24 row_ror:4 row_mask:0xf bank_mask:0xf
 v_add_f32_dpp v25, v25, v25 row_ror:4 row_mask:0xf bank_mask:0xf
 v_add_f32_dpp v26, v26, v26 row_ror:4 row_mask:0xf bank_mask:0xf
 v_add_f32_dpp v27, v27, v27 row_ror:4 row_mask:0xf bank_mask:0xf
 s_mov_b64 exec, s[84:85]
 v_cvt_pk_bf16_f32 v24, v24, v25
 v_cvt_pk_bf16_f32 v25, v26, v27
 buffer_store_dwordx2 v[24:25], v57, s[4:7], s57 offen
 s_mov_b64 exec, -1
 s_xor_b32 s55, s55, 1
 ds_read_b128 v[40:43], v1 offset:4096
 ds_read_b128 v[44:47], v1 offset:5120
 ds_read_b128 v[48:51], v1 offset:8192
 buffer_load_dwordx4 v[52:55], v1, s[4:7], s81 offen offset:3072
 buffer_load_dwordx4 v[56:59], v1, s[4:7], s101 offen offset:0
 buffer_load_dwordx4 v[60:63], v1, s[4:7], s101 offen offset:1024
 ds_read_b128 v[8:11], v3 offset:49152
 ds_read_b128 v[16:19], v3 offset:49152
 ds_read_b128 v[20:23], v3 offset:49152
 s_waitcnt lgkmcnt(0)
 s_nop 15
 s_nop 15
 s_nop 7
 s_branch L_ch2_f
L_rt_194:
 s_add_u32 s51, s51, 1
 s_cmp_lt_u32 s51, 131072
 s_cbranch_scc1 L_pm_193
 s_branch L_bail
L_rt_196:
 buffer_load_dwordx4 v[8:11], v56, s[4:7], s64 offen sc1
 buffer_load_dwordx4 v[12:15], v56, s[4:7], s65 offen sc1
 s_add_u32 s51, s51, 1
 s_cmp_lt_u32 s51, 131072
 s_cbranch_scc1 L_pp_195
 s_branch L_bail
.p2align 6
L_ch2_s:
 s_mov_b32 s51, 0
L_pm_197:
 buffer_load_dwordx4 v[24:27], v1, s[4:7], s59 offen offset:0 sc1
 buffer_load_dwordx4 v[28:31], v1, s[4:7], s59 offen offset:1024 sc1
 s_add_u32 s3, s59, 4096
 buffer_load_dwordx4 v[12:15], v1, s[4:7], s3 offen offset:0 sc1
 s_waitcnt vmcnt(2)
 ds_write_b128 v1, v[24:27] offset:4096
 v_max_u32 v7, v24, v26
 s_waitcnt vmcnt(1)
 ds_write_b128 v1, v[28:31] offset:5120
 v_max3_u32 v7, v7, v28, v30
 s_waitcnt vmcnt(0)
 ds_write_b128 v1, v[12:15] offset:8192
 v_max3_u32 v7, v7, v12, v14
 v_cmp_eq_u32 vcc, -1, v7
 s_cbranch_vccnz L_rt_198
 ds_read_b128 v[12:15], v3 offset:49152
 v_smfmac_f32_16x16x64_bf16 v[16:19], v[24:27], v[32:39], v0
 ds_read_b128 v[32:35], v1 offset:26624
 ds_read_b128 v[36:39], v1 offset:27648
 v_smfmac_f32_16x16x64_bf16 v[20:23], v[24:27], v[40:47], v0
 ds_read_b128 v[40:43], v1 offset:24576
 ds_read_b128 v[44:47], v1 offset:25600
 v_smfmac_f32_16x16x64_bf16 v[16:19], v[28:31], v[48:55], v0
 v_smfmac_f32_16x16x64_bf16 v[20:23], v[28:31], v[56:63], v0
 s_waitcnt lgkmcnt(5)
 s_barrier
 buffer_load_dwordx4 v[56:59], v1, s[4:7], s63 offen offset:0
 v_smfmac_f32_16x16x64_bf16 v[8:11], v[24:27], v[168:175], v0
 s_waitcnt lgkmcnt(4)
 v_smfmac_f32_16x16x64_bf16 v[12:15], v[24:27], v[160:167], v0
 ds_read_b128 v[24:27], v1 offset:8192
 buffer_load_dwordx4 v[60:63], v1, s[4:7], s63 offen offset:1024
 v_smfmac_f32_16x16x64_bf16 v[8:11], v[28:31], v[144:151], v0
 v_smfmac_f32_16x16x64_bf16 v[12:15], v[28:31], v[128:135], v0
 ds_read_b128 v[28:31], v1 offset:0
 buffer_load_dwordx4 v[48:51], v1, s[4:7], s101 offen offset:2048
 s_waitcnt lgkmcnt(1)
 v_smfmac_f32_16x16x64_bf16 v[16:19], v[24:27], v[32:39], v0
 ds_read_b128 v[32:35], v2 offset:22528
 ds_read_b128 v[36:39], v2 offset:23552
 v_smfmac_f32_16x16x64_bf16 v[8:11], v[24:27], a[80:87], v0
 buffer_load_dwordx4 v[52:55], v1, s[4:7], s101 offen offset:3072
 v_smfmac_f32_16x16x64_bf16 v[12:15], v[24:27], a[72:79], v0
 v_smfmac_f32_16x16x64_bf16 v[20:23], v[24:27], v[40:47], v0
 ds_read_b128 v[40:43], v2 offset:20480
 ds_read_b128 v[44:47], v2 offset:21504
 ds_read_b128 v[24:27], v1 offset:1024
 s_waitcnt lgkmcnt(5)
 v_smfmac_f32_16x16x64_bf16 v[8:11], v[28:31], v[240:247], v0
 v_smfmac_f32_16x16x64_bf16 v[12:15], v[28:31], v[248:255], v0
 s_waitcnt lgkmcnt(3)
 v_smfmac_f32_16x16x64_bf16 v[16:19], v[28:31], v[32:39], v0
 ds_read_b128 v[32:35], v2 offset:18432
 ds_read_b128 v[36:39], v2 offset:19456
 v_smfmac_f32_16x16x64_bf16 v[20:23], v[28:31], v[136:143], v0
 ds_read_b128 v[28:31], v1 offset:2048
 s_waitcnt lgkmcnt(3)
 v_smfmac_f32_16x16x64_bf16 v[8:11], v[24:27], v[224:231], v0
 v_smfmac_f32_16x16x64_bf16 v[16:19], v[24:27], v[40:47], v0
 ds_read_b128 v[40:43], v2 offset:16384
 ds_read_b128 v[44:47], v2 offset:17408
 v_smfmac_f32_16x16x64_bf16 v[12:15], v[24:27], v[216:223], v0
 v_smfmac_f32_16x16x64_bf16 v[20:23], v[24:27], v[152:159], v0
 ds_read_b128 v[24:27], v1 offset:3072
 s_waitcnt lgkmcnt(3)
 v_smfmac_f32_16x16x64_bf16 v[16:19], v[28:31], v[32:39], v0
 ds_read_b128 v[32:35], v1 offset:55296
 ds_read_b128 v[36:39], v1 offset:56320
 v_smfmac_f32_16x16x64_bf16 v[8:11], v[28:31], v[208:215], v0
 v_smfmac_f32_16x16x64_bf16 v[12:15], v[28:31], v[200:207], v0
 s_waitcnt lgkmcnt(3)
 v_smfmac_f32_16x16x64_bf16 v[20:23], v[28:31], v[40:47], v0
 ds_read_b128 v[40:43], v1 offset:53248
 ds_read_b128 v[44:47], v1 offset:54272
 ds_read_b128 v[28:31], v1 offset:6144
 s_waitcnt lgkmcnt(5)
 v_smfmac_f32_16x16x64_bf16 v[8:11], v[24:27], v[184:191], v0
 v_smfmac_f32_16x16x64_bf16 v[12:15], v[24:27], v[176:183], v0
 s_waitcnt lgkmcnt(3)
 v_smfmac_f32_16x16x64_bf16 v[16:19], v[24:27], v[32:39], v0
 ds_read_b128 v[32:35], v1 offset:51200
 ds_read_b128 v[36:39], v1 offset:52224
 s_waitcnt vmcnt(2)
 v_smfmac_f32_16x16x64_bf16 v[20:23], v[24:27], v[56:63], v0
 ds_read_b128 v[24:27], v1 offset:7168
 buffer_load_dwordx4 v[56:59], v1, s[4:7], s61 offen offset:2048 sc1 nt
 s_waitcnt lgkmcnt(3)
 v_smfmac_f32_16x16x64_bf16 v[8:11], v[28:31], a[136:143], v0
 v_smfmac_f32_16x16x64_bf16 v[16:19], v[28:31], v[40:47], v0
 ds_read_b128 v[40:43], v1 offset:49152
 ds_read_b128 v[44:47], v1 offset:50176
 s_add_u32 s3, s61, 4096
 buffer_load_dwordx4 v[60:63], v1, s[4:7], s3 offen offset:2048 sc1 nt
 v_smfmac_f32_16x16x64_bf16 v[12:15], v[28:31], a[128:135], v0
 v_smfmac_f32_16x16x64_bf16 v[20:23], v[28:31], v[192:199], v0
 ds_read_b128 v[28:31], v1 offset:9216
 s_waitcnt lgkmcnt(3)
 v_smfmac_f32_16x16x64_bf16 v[16:19], v[24:27], v[32:39], v0
 v_smfmac_f32_16x16x64_bf16 v[8:11], v[24:27], a[112:119], v0
 s_add_u32 s3, s61, 67112960
 buffer_load_dwordx4 v[32:35], v1, s[4:7], s3 offen offset:0 sc1 nt
 v_smfmac_f32_16x16x64_bf16 v[12:15], v[24:27], a[88:95], v0
 s_waitcnt lgkmcnt(1)
 v_smfmac_f32_16x16x64_bf16 v[20:23], v[24:27], v[40:47], v0
 ds_read_b128 v[40:43], v3 offset:49152
 ds_read_b128 v[44:47], v3 offset:49152
 buffer_load_dwordx4 v[36:39], v1, s[4:7], s3 offen offset:1024 sc1 nt
 s_waitcnt lgkmcnt(2)
 v_smfmac_f32_16x16x64_bf16 v[8:11], v[28:31], a[32:39], v0
 v_smfmac_f32_16x16x64_bf16 v[12:15], v[28:31], a[24:31], v0
 v_lshlrev_b32 v7, 3, v1
 v_smfmac_f32_16x16x64_bf16 v[16:19], v[28:31], v[232:239], v0
 s_waitcnt vmcnt(4)
 v_smfmac_f32_16x16x64_bf16 v[20:23], v[28:31], v[48:55], v0
 s_add_u32 s3, s61, 67633152
 buffer_load_dword v7, v7, s[4:7], s3 offen sc1
 ds_read_b128 v[52:55], v1 offset:0
 v_add_f32 v8, v8, v10
 v_add_f32 v11, v9, v11
 v_cvt_pk_bf16_f32 v9, v8, v11
 v_cvt_pk_bf16_f32 v8, v8, v11
 v_add_f32 v12, v12, v14
 v_add_f32 v15, v13, v15
 v_cvt_pk_bf16_f32 v13, v12, v15
 v_cvt_pk_bf16_f32 v12, v12, v15
 v_mfma_f32_16x16x16_bf16 v[8:11], v[8:9], v[4:5], 0
 v_mfma_f32_16x16x16_bf16 v[12:15], v[12:13], v[4:5], 0
 v_add_f32 v16, v16, v18
 v_add_f32 v19, v17, v19
 v_cvt_pk_bf16_f32 v17, v16, v19
 v_cvt_pk_bf16_f32 v16, v16, v19
 v_add_f32 v20, v20, v22
 v_add_f32 v23, v21, v23
 v_cvt_pk_bf16_f32 v21, v20, v23
 v_cvt_pk_bf16_f32 v20, v20, v23
 v_mfma_f32_16x16x16_bf16 v[16:19], v[16:17], v[4:5], 0
 v_mfma_f32_16x16x16_bf16 v[20:23], v[20:21], v[4:5], 0
 s_waitcnt lgkmcnt(2)
 v_smfmac_f32_16x16x64_bf16 v[40:43], v[24:27], v[80:87], v0
 s_waitcnt lgkmcnt(1)
 v_smfmac_f32_16x16x64_bf16 v[44:47], v[24:27], v[88:95], v0
 ds_read_b128 v[24:27], v1 offset:1024
 v_cvt_pk_bf16_f32 v15, v14, v15
 v_cvt_pk_bf16_f32 v14, v12, v13
 v_cvt_pk_bf16_f32 v13, v10, v11
 v_cvt_pk_bf16_f32 v12, v8, v9
 s_waitcnt vmcnt(4)
 s_nop 0
 v_mfma_f32_16x16x32_bf16 v[8:11], v[56:59], v[12:15], 0
 v_cvt_pk_bf16_f32 v23, v22, v23
 v_cvt_pk_bf16_f32 v22, v20, v21
 v_cvt_pk_bf16_f32 v21, v18, v19
 v_cvt_pk_bf16_f32 v20, v16, v17
 s_waitcnt vmcnt(3)
 v_mfma_f32_16x16x32_bf16 v[16:19], v[60:63], v[12:15], 0
 v_mfma_f32_16x16x32_bf16 v[48:51], v[20:23], v[12:15], 0
 v_smfmac_f32_16x16x64_bf16 v[40:43], v[28:31], v[112:119], v0
 v_smfmac_f32_16x16x64_bf16 v[44:47], v[28:31], v[120:127], v0
 ds_read_b128 v[28:31], v1 offset:2048
 s_waitcnt lgkmcnt(2)
 v_smfmac_f32_16x16x64_bf16 v[40:43], v[52:55], a[160:167], v0
 v_cndmask_b32 v8, v8, v16, s[70:71]
 v_cndmask_b32 v9, v9, v17, s[70:71]
 v_cndmask_b32 v10, v10, v18, s[70:71]
 v_cndmask_b32 v11, v11, v19, s[70:71]
 ds_write_b128 v1, v[8:11] offset:12288
 ds_write_b64 v1, v[48:49] offset:15360
 v_smfmac_f32_16x16x64_bf16 v[44:47], v[52:55], a[168:175], v0
 ds_read_b128 v[52:55], v1 offset:3072
 s_waitcnt lgkmcnt(4)
 v_smfmac_f32_16x16x64_bf16 v[40:43], v[24:27], a[176:183], v0
 v_smfmac_f32_16x16x64_bf16 v[44:47], v[24:27], a[184:191], v0
 ds_read_b128 v[24:27], v1 offset:4096
 s_waitcnt lgkmcnt(4)
 v_smfmac_f32_16x16x64_bf16 v[40:43], v[28:31], a[192:199], v0
 v_smfmac_f32_16x16x64_bf16 v[44:47], v[28:31], a[200:207], v0
 ds_read_b128 v[28:31], v1 offset:5120
 s_waitcnt lgkmcnt(2)
 v_smfmac_f32_16x16x64_bf16 v[40:43], v[52:55], a[208:215], v0
 v_smfmac_f32_16x16x64_bf16 v[44:47], v[52:55], a[216:223], v0
 ds_read_b128 v[52:55], v1 offset:6144
 s_barrier
 ds_read_b128 v[56:59], v1 offset:10240
 ds_read_b128 v[60:63], v1 offset:11264
 ds_read_b128 v[16:19], v1 offset:13312
 ds_read_b128 v[12:15], v1 offset:14336
 ds_read_b128 v[48:51], v1 offset:15360
 s_waitcnt lgkmcnt(7)
 v_smfmac_f32_16x16x64_bf16 v[40:43], v[24:27], a[224:231], v0
 s_mov_b64 exec, s[68:69]
 buffer_store_dwordx4 v[20:23], v6, s[4:7], s62 offen offset:1024 sc1
 s_mov_b64 exec, -1
 v_smfmac_f32_16x16x64_bf16 v[44:47], v[24:27], a[232:239], v0
 ds_read_b128 v[24:27], v1 offset:8192
 s_waitcnt lgkmcnt(7)
 v_smfmac_f32_16x16x64_bf16 v[40:43], v[28:31], a[240:247], v0
 v_smfmac_f32_16x16x64_bf16 v[44:47], v[28:31], a[248:255], v0
 s_waitcnt lgkmcnt(6)
 v_smfmac_f32_16x16x64_bf16 v[40:43], v[52:55], v[64:71], v0
 v_smfmac_f32_16x16x64_bf16 v[44:47], v[52:55], v[72:79], v0
 s_waitcnt lgkmcnt(0)
 v_smfmac_f32_16x16x64_bf16 v[40:43], v[24:27], v[96:103], v0
 v_smfmac_f32_16x16x64_bf16 v[44:47], v[24:27], v[104:111], v0
 v_pk_add_f32 v[8:9], v[8:9], v[56:57]
 v_pk_add_f32 v[10:11], v[10:11], v[58:59]
 v_pk_add_f32 v[60:61], v[60:61], v[16:17]
 v_pk_add_f32 v[62:63], v[62:63], v[18:19]
 v_pk_add_f32 v[12:13], v[12:13], v[14:15]
 v_pk_add_f32 v[48:49], v[48:49], v[50:51]
 v_pk_add_f32 v[8:9], v[8:9], v[60:61]
 v_pk_add_f32 v[10:11], v[10:11], v[62:63]
 v_pk_add_f32 v[48:49], v[12:13], v[48:49]
 v_max3_f32 v50, v8, v9, v10
 v_max3_f32 v50, v50, v11, v48
 v_max_f32 v50, v50, v49
 v_add_f32 v40, v40, v42
 v_add_f32 v41, v41, v43
 v_max_f32_dpp v50, v50, v50 quad_perm:[2,3,0,1] row_mask:0xf bank_mask:0xf
 v_mov_b32 v51, v50
 v_add_f32 v44, v44, v46
 v_add_f32 v45, v45, v47
 v_permlane16_swap_b32 v50, v51
 v_max_f32 v50, v50, v51
 v_mov_b32 v51, v50
 v_cvt_pk_bf16_f32 v40, v40, v41
 v_cvt_pk_bf16_f32 v41, v44, v45
 v_permlane32_swap_b32 v50, v51
 v_max_f32 v50, v50, v51
 v_mul_f32 v50, s56, v50
 v_fma_f32 v48, v48, s56, -v50
 v_fma_f32 v49, v49, s56, -v50
 v_fma_f32 v8, v8, s56, -v50
 v_fma_f32 v9, v9, s56, -v50
 v_fma_f32 v10, v10, s56, -v50
 v_fma_f32 v11, v11, s56, -v50
 v_exp_f32 v48, v48
 v_lshrrev_b32 v51, 1, v1
 v_exp_f32 v49, v49
 ds_read_b128 v[56:59], v3 offset:32768
 ds_read_b128 v[60:63], v3 offset:33792
 v_exp_f32 v8, v8
 v_exp_f32 v9, v9
 ds_read_b128 v[24:27], v3 offset:4096
 ds_read_b128 v[28:31], v3 offset:5120
 v_exp_f32 v10, v10
 buffer_store_dwordx2 v[40:41], v51, s[4:7], s62 offen offset:3072 sc1
 v_exp_f32 v11, v11
 v_cvt_pk_bf16_f32 v14, v48, v49
 v_cvt_pk_bf16_f32 v12, v8, v9
 v_cvt_pk_bf16_f32 v13, v10, v11
 v_cndmask_b32 v52, 0, v14, s[68:69]
 v_cndmask_b32 v53, 0, v14, s[70:71]
 v_cndmask_b32 v22, 0, v12, s[70:71]
 v_cndmask_b32 v23, 0, v13, s[70:71]
 v_mfma_f32_16x16x16_bf16 v[44:47], v[40:41], v[52:53], 0
 v_cndmask_b32 v16, 0, v12, s[68:69]
 v_cndmask_b32 v17, 0, v13, s[68:69]
 v_mov_b32_dpp v18, v22 quad_perm:[2,3,0,1] row_mask:0xf bank_mask:0xf
 v_mov_b32_dpp v19, v23 quad_perm:[2,3,0,1] row_mask:0xf bank_mask:0xf
 v_mov_b32_dpp v20, v16 quad_perm:[2,3,0,1] row_mask:0xf bank_mask:0xf
 v_mov_b32_dpp v21, v17 quad_perm:[2,3,0,1] row_mask:0xf bank_mask:0xf
 s_waitcnt vmcnt(4)
 v_mfma_f32_16x16x32_bf16 v[44:47], v[32:35], v[16:19], v[44:47]
 v_add_f32 v54, v8, v9
 v_add_f32 v55, v48, v49
 s_waitcnt vmcnt(3)
 v_mfma_f32_16x16x32_bf16 v[44:47], v[36:39], v[20:23], v[44:47]
 v_add_f32 v54, v54, v10
 v_fma_f32 v55, v55, 0.5, v11
 v_add_f32 v54, v54, v55
 ds_read_b128 v[16:19], v3 offset:49152
 ds_read_b128 v[20:23], v3 offset:49152
 v_add_f32_dpp v54, v54, v54 quad_perm:[2,3,0,1] row_mask:0xf bank_mask:0xf
 v_mov_b32 v55, v54
 ds_read_b128 v[32:35], v3 offset:49152
 ds_read_b128 v[36:39], v3 offset:49152
 v_permlane16_swap_b32 v54, v55
 v_add_f32 v54, v54, v55
 v_mov_b32 v55, v54
 ds_read_b128 v[8:11], v3 offset:49152
 s_cmp_eq_u32 s54, 63
 v_permlane32_swap_b32 v54, v55
 v_add_f32 v54, v54, v55
 v_rcp_f32 v54, v54
 s_cbranch_scc1 L_ch2_end
 v_mul_f32 v44, v44, v54
 v_mul_f32 v45, v45, v54
 v_cvt_pk_bf16_f32 v42, v44, v45
 v_mul_f32 v46, v46, v54
 v_mul_f32 v47, v47, v54
 v_cvt_pk_bf16_f32 v43, v46, v47
 ds_write_b64 v6, v[42:43] offset:1024
 v_and_b32 v40, -9, v6
 v_mov_b32_dpp v12, v42 quad_perm:[0,1,0,1] row_mask:0xf bank_mask:0xf
 v_mov_b32_dpp v14, v42 quad_perm:[2,3,2,3] row_mask:0xf bank_mask:0xf
 v_mov_b32_dpp v13, v43 quad_perm:[0,1,0,1] row_mask:0xf bank_mask:0xf
 v_mov_b32_dpp v15, v43 quad_perm:[2,3,2,3] row_mask:0xf bank_mask:0xf
 s_waitcnt lgkmcnt(5)
 s_nop 0
 v_smfmac_f32_16x16x64_bf16 v[16:19], v[12:15], a[16:23], v0
 s_waitcnt lgkmcnt(4)
 v_smfmac_f32_16x16x64_bf16 v[20:23], v[12:15], a[48:55], v0
 s_waitcnt lgkmcnt(0)
 s_barrier
 ds_read_b128 v[48:51], v40 offset:0
 ds_read_b128 v[52:55], v40 offset:512
 ds_read_b128 v[44:47], v40 offset:1536
 v_smfmac_f32_16x16x64_bf16 v[32:35], v[12:15], v[56:63], v0
 ds_read_b128 v[56:59], v3 offset:38912
 ds_read_b128 v[60:63], v3 offset:39936
 s_mov_b32 m0, 4096
 v_smfmac_f32_16x16x64_bf16 v[36:39], v[12:15], v[24:31], v0
 ds_read_b128 v[24:27], v3 offset:36864
 ds_read_b128 v[28:31], v3 offset:37888
 buffer_load_dwordx4 v1, s[4:7], s81 offen offset:0 lds
 v_smfmac_f32_16x16x64_bf16 v[8:11], v[12:15], a[144:151], v0
 s_mov_b32 m0, 4096
 s_waitcnt lgkmcnt(6)
 v_smfmac_f32_16x16x64_bf16 v[16:19], v[48:51], a[0:7], v0
 buffer_load_dwordx4 v1, s[4:7], s81 offen offset:1024 lds
 s_waitcnt lgkmcnt(5)
 v_smfmac_f32_16x16x64_bf16 v[16:19], v[52:55], a[8:15], v0
 s_mov_b32 m0, 6144
 s_waitcnt lgkmcnt(2)
 v_smfmac_f32_16x16x64_bf16 v[16:19], v[44:47], v[56:63], v0
 ds_read_b128 v[56:59], v3 offset:34816
 ds_read_b128 v[60:63], v3 offset:35840
 buffer_load_dwordx4 v1, s[4:7], s81 offen offset:2048 lds
 s_waitcnt lgkmcnt(2)
 v_smfmac_f32_16x16x64_bf16 v[20:23], v[48:51], v[24:31], v0
 ds_read_b128 v[24:27], v3 offset:6144
 ds_read_b128 v[28:31], v3 offset:7168
 v_smfmac_f32_16x16x64_bf16 v[20:23], v[52:55], a[40:47], v0
 v_smfmac_f32_16x16x64_bf16 v[20:23], v[44:47], a[56:63], v0
 v_cvt_pk_bf16_f32 v16, v16, v17
 v_smfmac_f32_16x16x64_bf16 v[32:35], v[48:51], a[64:71], v0
 v_cvt_pk_bf16_f32 v17, v18, v19
 s_waitcnt lgkmcnt(2)
 v_smfmac_f32_16x16x64_bf16 v[32:35], v[52:55], v[56:63], v0
 ds_read_b128 v[56:59], v3 offset:2048
 ds_read_b128 v[60:63], v3 offset:3072
 v_and_or_b32 v16, v16, -2, s55
 s_waitcnt lgkmcnt(2)
 v_smfmac_f32_16x16x64_bf16 v[32:35], v[44:47], v[24:31], v0
 ds_read_b128 v[24:27], v3 offset:0
 ds_read_b128 v[28:31], v3 offset:1024
 v_cvt_pk_bf16_f32 v18, v20, v21
 v_smfmac_f32_16x16x64_bf16 v[36:39], v[48:51], a[96:103], v0
 v_cvt_pk_bf16_f32 v19, v22, v23
 v_smfmac_f32_16x16x64_bf16 v[36:39], v[52:55], a[104:111], v0
 v_and_or_b32 v18, v18, -2, s55
 buffer_store_dwordx4 v[16:19], v1, s[4:7], s60 offen offset:0 sc1
 v_smfmac_f32_16x16x64_bf16 v[36:39], v[44:47], a[120:127], v0
 v_cvt_pk_bf16_f32 v32, v32, v33
 s_waitcnt lgkmcnt(2)
 v_smfmac_f32_16x16x64_bf16 v[8:11], v[48:51], v[56:63], v0
 v_cvt_pk_bf16_f32 v33, v34, v35
 s_waitcnt lgkmcnt(0)
 v_smfmac_f32_16x16x64_bf16 v[8:11], v[52:55], v[24:31], v0
 v_and_or_b32 v32, v32, -2, s55
 v_smfmac_f32_16x16x64_bf16 v[8:11], v[44:47], a[152:159], v0
 v_cvt_pk_bf16_f32 v34, v36, v37
 v_cvt_pk_bf16_f32 v35, v38, v39
 v_and_or_b32 v34, v34, -2, s55
 buffer_store_dwordx4 v[32:35], v1, s[4:7], s60 offen offset:1024 sc1
 s_nop 3
 v_cvt_pk_bf16_f32 v8, v8, v9
 v_cvt_pk_bf16_f32 v9, v10, v11
 v_and_or_b32 v8, v8, -2, s55
 buffer_store_dwordx2 v[8:9], v1, s[4:7], s16 offen offset:0 sc1
 buffer_load_dwordx4 v[32:35], v1, s[4:7], s63 offen offset:2048
 buffer_load_dwordx4 v[36:39], v1, s[4:7], s63 offen offset:3072
 s_add_u32 s54, s54, 1
 s_add_u32 s61, s61, 524288
 s_and_b32 s3, s54, 7
 s_cselect_b32 s3, 1, -7
 s_lshl_b32 s3, s3, 17
 s_add_u32 s62, s62, s3
 s_and_b32 s3, s54, 3
 s_cselect_b32 s3, 1, -3
 s_lshl_b32 s3, s3, 14
 s_add_u32 s57, s57, s3
 s_add_u32 s59, s59, s3
 s_xor_b32 s58, s57, 32768
 v_lshrrev_b32 v56, 6, v1
 v_mul_u32_u24 v56, 10240, v56
 v_and_b32 v60, 48, v1
 v_add_u32 v56, v56, v60
 v_and_b32 v57, 32, v1
 v_and_b32 v60, 64, v1
 v_lshl_add_u32 v57, v60, 2, v57
 v_bfe_u32 v60, v1, 8, 1
 v_lshl_add_u32 v57, v60, 4, v57
 v_bfe_u32 v60, v1, 4, 1
 v_lshl_add_u32 v57, v60, 3, v57
 v_mov_b32 v60, 0x3f80
 v_mov_b32 v28, 0x3f800000
 v_cndmask_b32 v60, v60, v28, s[82:83]
 v_cndmask_b32 v28, 0, v60, s[72:73]
 v_cndmask_b32 v29, 0, v60, s[74:75]
 v_cndmask_b32 v30, 0, v60, s[76:77]
 v_cndmask_b32 v31, 0, v60, s[78:79]
 v_mov_b64 v[58:59], -1
 s_mov_b64 exec, s[84:85]
 buffer_store_dwordx2 v[58:59], v57, s[4:7], s58 offen sc1
 s_mov_b64 exec, -1
 s_nop 15
 s_nop 15
 s_nop 15
 s_nop 15
 s_nop 15
 s_mov_b32 s51, 0
 buffer_load_dwordx4 v[8:11], v56, s[4:7], s64 offen sc1
 buffer_load_dwordx4 v[12:15], v56, s[4:7], s65 offen sc1
L_pp_199:
 s_waitcnt vmcnt(1)
 v_mfma_f32_16x16x32_bf16 v[24:27], v[28:31], v[8:11], 0
 v_bitop3_b32 v60, v8, v10, s55 bitop3:0x7e
 s_waitcnt vmcnt(0)
 v_mfma_f32_16x16x32_bf16 v[24:27], v[28:31], v[12:15], v[24:27]
 v_bitop3_b32 v61, v12, v14, s55 bitop3:0x7e
 v_bitop3_b32 v7, v60, v61, 1 bitop3:0xa8
 v_cmp_ne_u32 vcc, 0, v7
 s_cbranch_vccnz L_rt_200
 s_nop 3
 v_add_f32_dpp v24, v24, v24 row_ror:8 row_mask:0xf bank_mask:0xf
 v_add_f32_dpp v25, v25, v25 row_ror:8 row_mask:0xf bank_mask:0xf
 v_add_f32_dpp v26, v26, v26 row_ror:8 row_mask:0xf bank_mask:0xf
 v_add_f32_dpp v27, v27, v27 row_ror:8 row_mask:0xf bank_mask:0xf
 v_add_f32_dpp v24, v24, v24 row_ror:4 row_mask:0xf bank_mask:0xf
 v_add_f32_dpp v25, v25, v25 row_ror:4 row_mask:0xf bank_mask:0xf
 v_add_f32_dpp v26, v26, v26 row_ror:4 row_mask:0xf bank_mask:0xf
 v_add_f32_dpp v27, v27, v27 row_ror:4 row_mask:0xf bank_mask:0xf
 s_mov_b64 exec, s[84:85]
 v_cvt_pk_bf16_f32 v24, v24, v25
 v_cvt_pk_bf16_f32 v25, v26, v27
 buffer_store_dwordx2 v[24:25], v57, s[4:7], s57 offen sc1
 s_mov_b64 exec, -1
 s_xor_b32 s55, s55, 1
 ds_read_b128 v[40:43], v1 offset:4096
 ds_read_b128 v[44:47], v1 offset:5120
 ds_read_b128 v[48:51], v1 offset:8192
 buffer_load_dwordx4 v[52:55], v1, s[4:7], s81 offen offset:3072
 buffer_load_dwordx4 v[56:59], v1, s[4:7], s101 offen offset:0
 buffer_load_dwordx4 v[60:63], v1, s[4:7], s101 offen offset:1024
 ds_read_b128 v[8:11], v3 offset:49152
 ds_read_b128 v[16:19], v3 offset:49152
 ds_read_b128 v[20:23], v3 offset:49152
 s_waitcnt lgkmcnt(0)
 s_nop 15
 s_nop 15
 s_nop 7
 s_branch L_ch2_s
L_rt_198:
 s_add_u32 s51, s51, 1
 s_cmp_lt_u32 s51, 131072
 s_cbranch_scc1 L_pm_197
 s_branch L_bail
L_rt_200:
 buffer_load_dwordx4 v[8:11], v56, s[4:7], s64 offen sc1
 buffer_load_dwordx4 v[12:15], v56, s[4:7], s65 offen sc1
 s_add_u32 s51, s51, 1
 s_cmp_lt_u32 s51, 131072
 s_cbranch_scc1 L_pp_199
 s_branch L_bail
L_ch2_end:
 s_waitcnt vmcnt(0)
 s_endpgm
L_ch3:
 v_lshrrev_b32 v8, 4, v0
 s_mov_b32 s3, 1280
 v_mul_lo_u32 v8, v8, s3
 v_lshrrev_b32 v7, 3, v0
 v_and_b32 v7, 6, v7
 v_xor_b32 v7, v7, v0
 v_and_b32 v7, 15, v7
 v_lshl_add_u32 v8, v7, 4, v8
 v_xor_b32 v9, 128, v8
 v_lshrrev_b32 v10, 4, v0
 s_mov_b32 s3, 8192
 v_mul_lo_u32 v10, v10, s3
 v_lshrrev_b32 v7, 3, v0
 v_and_b32 v7, 6, v7
 v_xor_b32 v7, v7, v0
 v_and_b32 v7, 15, v7
 v_lshl_add_u32 v10, v7, 4, v10
 v_xor_b32 v11, 128, v10
 s_mov_b32 s8, s26
 s_and_b32 s9, s27, 0xffff
 s_mov_b32 s10, 5242880
 s_mul_i32 s14, s52, 163840
 s_add_u32 s14, s14, 122880
 s_mov_b32 m0, 24576
 s_nop 0
 buffer_load_dwordx4 v8, s[8:11], s14 offen lds
 s_add_u32 s14, s14, 5120
 s_mov_b32 m0, 25600
 s_nop 0
 buffer_load_dwordx4 v8, s[8:11], s14 offen lds
 s_add_u32 s14, s14, 5120
 s_mov_b32 m0, 26624
 s_nop 0
 buffer_load_dwordx4 v8, s[8:11], s14 offen lds
 s_add_u32 s14, s14, 5120
 s_mov_b32 m0, 27648
 s_nop 0
 buffer_load_dwordx4 v8, s[8:11], s14 offen lds
 s_add_u32 s14, s14, 5120
 s_mov_b32 m0, 28672
 s_nop 0
 buffer_load_dwordx4 v9, s[8:11], s14 offen lds
 s_add_u32 s14, s14, 5120
 s_mov_b32 m0, 29696
 s_nop 0
 buffer_load_dwordx4 v9, s[8:11], s14 offen lds
 s_add_u32 s14, s14, 5120
 s_mov_b32 m0, 30720
 s_nop 0
 buffer_load_dwordx4 v9, s[8:11], s14 offen lds
 s_add_u32 s14, s14, 5120
 s_mov_b32 m0, 31744
 s_nop 0
 buffer_load_dwordx4 v9, s[8:11], s14 offen lds
 s_mul_i32 s14, s52, 163840
 s_add_u32 s14, s14, 123136
 s_mov_b32 m0, 57344
 s_nop 0
 buffer_load_dwordx4 v8, s[8:11], s14 offen lds
 s_add_u32 s14, s14, 5120
 s_mov_b32 m0, 58368
 s_nop 0
 buffer_load_dwordx4 v8, s[8:11], s14 offen lds
 s_add_u32 s14, s14, 5120
 s_mov_b32 m0, 59392
 s_nop 0
 buffer_load_dwordx4 v8, s[8:11], s14 offen lds
 s_add_u32 s14, s14, 5120
 s_mov_b32 m0, 60416
 s_nop 0
 buffer_load_dwordx4 v8, s[8:11], s14 offen lds
 s_add_u32 s14, s14, 5120
 s_mov_b32 m0, 61440
 s_nop 0
 buffer_load_dwordx4 v9, s[8:11], s14 offen lds
 s_add_u32 s14, s14, 5120
 s_mov_b32 m0, 62464
 s_nop 0
 buffer_load_dwordx4 v9, s[8:11], s14 offen lds
 s_add_u32 s14, s14, 5120
 s_mov_b32 m0, 63488
 s_nop 0
 buffer_load_dwordx4 v9, s[8:11], s14 offen lds
 s_add_u32 s14, s14, 5120
 s_mov_b32 m0, 64512
 s_nop 0
 buffer_load_dwordx4 v9, s[8:11], s14 offen lds
 s_mul_i32 s14, s52, 163840
 s_add_u32 s14, s14, 123392
 s_mov_b32 m0, 90112
 s_nop 0
 buffer_load_dwordx4 v8, s[8:11], s14 offen lds
 s_add_u32 s14, s14, 5120
 s_mov_b32 m0, 91136
 s_nop 0
 buffer_load_dwordx4 v8, s[8:11], s14 offen lds
 s_add_u32 s14, s14, 5120
 s_mov_b32 m0, 92160
 s_nop 0
 buffer_load_dwordx4 v8, s[8:11], s14 offen lds
 s_add_u32 s14, s14, 5120
 s_mov_b32 m0, 93184
 s_nop 0
 buffer_load_dwordx4 v8, s[8:11], s14 offen lds
 s_add_u32 s14, s14, 5120
 s_mov_b32 m0, 94208
 s_nop 0
 buffer_load_dwordx4 v9, s[8:11], s14 offen lds
 s_add_u32 s14, s14, 5120
 s_mov_b32 m0, 95232
 s_nop 0
 buffer_load_dwordx4 v9, s[8:11], s14 offen lds
 s_add_u32 s14, s14, 5120
 s_mov_b32 m0, 96256
 s_nop 0
 buffer_load_dwordx4 v9, s[8:11], s14 offen lds
 s_add_u32 s14, s14, 5120
 s_mov_b32 m0, 97280
 s_nop 0
 buffer_load_dwordx4 v9, s[8:11], s14 offen lds
 s_mul_i32 s14, s52, 163840
 s_add_u32 s14, s14, 123648
 s_mov_b32 m0, 122880
 s_nop 0
 buffer_load_dwordx4 v8, s[8:11], s14 offen lds
 s_add_u32 s14, s14, 5120
 s_mov_b32 m0, 123904
 s_nop 0
 buffer_load_dwordx4 v8, s[8:11], s14 offen lds
 s_add_u32 s14, s14, 5120
 s_mov_b32 m0, 124928
 s_nop 0
 buffer_load_dwordx4 v8, s[8:11], s14 offen lds
 s_add_u32 s14, s14, 5120
 s_mov_b32 m0, 125952
 s_nop 0
 buffer_load_dwordx4 v8, s[8:11], s14 offen lds
 s_add_u32 s14, s14, 5120
 s_mov_b32 m0, 126976
 s_nop 0
 buffer_load_dwordx4 v9, s[8:11], s14 offen lds
 s_add_u32 s14, s14, 5120
 s_mov_b32 m0, 128000
 s_nop 0
 buffer_load_dwordx4 v9, s[8:11], s14 offen lds
 s_add_u32 s14, s14, 5120
 s_mov_b32 m0, 129024
 s_nop 0
 buffer_load_dwordx4 v9, s[8:11], s14 offen lds
 s_add_u32 s14, s14, 5120
 s_mov_b32 m0, 130048
 s_nop 0
 buffer_load_dwordx4 v9, s[8:11], s14 offen lds
 s_mul_i32 s14, s52, 163840
 s_add_u32 s14, s14, 123904
 s_mov_b32 m0, 155648
 s_nop 0
 buffer_load_dwordx4 v8, s[8:11], s14 offen lds
 s_add_u32 s14, s14, 5120
 s_mov_b32 m0, 156672
 s_nop 0
 buffer_load_dwordx4 v8, s[8:11], s14 offen lds
 s_add_u32 s14, s14, 5120
 s_mov_b32 m0, 157696
 s_nop 0
 buffer_load_dwordx4 v8, s[8:11], s14 offen lds
 s_add_u32 s14, s14, 5120
 s_mov_b32 m0, 158720
 s_nop 0
 buffer_load_dwordx4 v8, s[8:11], s14 offen lds
 s_add_u32 s14, s14, 5120
 s_mov_b32 m0, 159744
 s_nop 0
 buffer_load_dwordx4 v9, s[8:11], s14 offen lds
 s_add_u32 s14, s14, 5120
 s_mov_b32 m0, 160768
 s_nop 0
 buffer_load_dwordx4 v9, s[8:11], s14 offen lds
 s_add_u32 s14, s14, 5120
 s_mov_b32 m0, 161792
 s_nop 0
 buffer_load_dwordx4 v9, s[8:11], s14 offen lds
 s_add_u32 s14, s14, 5120
 s_mov_b32 m0, 162816
 s_nop 0
 buffer_load_dwordx4 v9, s[8:11], s14 offen lds
 v_lshrrev_b32 v20, 4, v0
 v_bfe_u32 v21, v0, 2, 1
 v_bfe_u32 v22, v0, 3, 1
 v_and_b32 v23, 1, v20
 v_lshrrev_b32 v24, 1, v20
 v_and_b32 v25, 3, v0
 v_lshlrev_b32 v25, 3, v25
 v_lshl_add_u32 v26, v22, 1, v23
 v_lshl_add_u32 v27, v21, 2, v26
 v_lshl_add_u32 v26, v24, 2, v26
 v_lshl_add_u32 v26, v21, 4, v26
 v_xor_b32 v27, 6, v27
 v_lshl_add_u32 v27, v27, 5, v25
 v_lshl_add_u32 v12, v26, 8, v27
 v_lshl_add_u32 v26, v24, 2, v21
 v_lshl_add_u32 v26, v23, 4, v26
 v_lshl_add_u32 v27, v23, 2, v21
 v_lshl_add_u32 v27, v22, 1, v27
 v_lshl_add_u32 v27, v27, 5, v25
 v_lshl_add_u32 v14, v26, 8, v27
 v_lshlrev_b32 v1, 4, v0
 v_add_u32 v2, 65536, v1
 v_add_u32 v3, 114688, v1
 s_waitcnt vmcnt(32)
 s_barrier
 s_waitcnt lgkmcnt(0)
 s_barrier
 s_mov_b32 s8, s24
 s_and_b32 s9, s25, 0xffff
 s_mov_b32 s10, 5242880
 s_lshl_b32 s14, s52, 8
 s_add_u32 s14, s14, 786432
 s_mov_b32 m0, 24576
 s_nop 0
 buffer_load_dwordx4 v10, s[8:11], s14 offen lds
 s_add_u32 s14, s14, 32768
 s_mov_b32 m0, 25600
 s_nop 0
 buffer_load_dwordx4 v10, s[8:11], s14 offen lds
 s_add_u32 s14, s14, 32768
 s_mov_b32 m0, 26624
 s_nop 0
 buffer_load_dwordx4 v10, s[8:11], s14 offen lds
 s_add_u32 s14, s14, 32768
 s_mov_b32 m0, 27648
 s_nop 0
 buffer_load_dwordx4 v10, s[8:11], s14 offen lds
 s_add_u32 s14, s14, 32768
 s_mov_b32 m0, 28672
 s_nop 0
 buffer_load_dwordx4 v11, s[8:11], s14 offen lds
 s_add_u32 s14, s14, 32768
 s_mov_b32 m0, 29696
 s_nop 0
 buffer_load_dwordx4 v11, s[8:11], s14 offen lds
 s_add_u32 s14, s14, 32768
 s_mov_b32 m0, 30720
 s_nop 0
 buffer_load_dwordx4 v11, s[8:11], s14 offen lds
 s_add_u32 s14, s14, 32768
 s_mov_b32 m0, 31744
 s_nop 0
 buffer_load_dwordx4 v11, s[8:11], s14 offen lds
 s_waitcnt vmcnt(32)
 s_barrier
 s_waitcnt lgkmcnt(0)
 s_barrier
 s_lshl_b32 s14, s52, 8
 s_add_u32 s14, s14, 1835008
 s_mov_b32 m0, 57344
 s_nop 0
 buffer_load_dwordx4 v10, s[8:11], s14 offen lds
 s_add_u32 s14, s14, 32768
 s_mov_b32 m0, 58368
 s_nop 0
 buffer_load_dwordx4 v10, s[8:11], s14 offen lds
 s_add_u32 s14, s14, 32768
 s_mov_b32 m0, 59392
 s_nop 0
 buffer_load_dwordx4 v10, s[8:11], s14 offen lds
 s_add_u32 s14, s14, 32768
 s_mov_b32 m0, 60416
 s_nop 0
 buffer_load_dwordx4 v10, s[8:11], s14 offen lds
 s_add_u32 s14, s14, 32768
 s_mov_b32 m0, 61440
 s_nop 0
 buffer_load_dwordx4 v11, s[8:11], s14 offen lds
 s_add_u32 s14, s14, 32768
 s_mov_b32 m0, 62464
 s_nop 0
 buffer_load_dwordx4 v11, s[8:11], s14 offen lds
 s_add_u32 s14, s14, 32768
 s_mov_b32 m0, 63488
 s_nop 0
 buffer_load_dwordx4 v11, s[8:11], s14 offen lds
 s_add_u32 s14, s14, 32768
 s_mov_b32 m0, 64512
 s_nop 0
 buffer_load_dwordx4 v11, s[8:11], s14 offen lds
 s_waitcnt vmcnt(32)
 s_barrier
 s_waitcnt lgkmcnt(0)
 s_barrier
 s_lshl_b32 s14, s52, 8
 s_add_u32 s14, s14, 2883584
 s_mov_b32 m0, 90112
 s_nop 0
 buffer_load_dwordx4 v10, s[8:11], s14 offen lds
 s_add_u32 s14, s14, 32768
 s_mov_b32 m0, 91136
 s_nop 0
 buffer_load_dwordx4 v10, s[8:11], s14 offen lds
 s_add_u32 s14, s14, 32768
 s_mov_b32 m0, 92160
 s_nop 0
 buffer_load_dwordx4 v10, s[8:11], s14 offen lds
 s_add_u32 s14, s14, 32768
 s_mov_b32 m0, 93184
 s_nop 0
 buffer_load_dwordx4 v10, s[8:11], s14 offen lds
 s_add_u32 s14, s14, 32768
 s_mov_b32 m0, 94208
 s_nop 0
 buffer_load_dwordx4 v11, s[8:11], s14 offen lds
 s_add_u32 s14, s14, 32768
 s_mov_b32 m0, 95232
 s_nop 0
 buffer_load_dwordx4 v11, s[8:11], s14 offen lds
 s_add_u32 s14, s14, 32768
 s_mov_b32 m0, 96256
 s_nop 0
 buffer_load_dwordx4 v11, s[8:11], s14 offen lds
 s_add_u32 s14, s14, 32768
 s_mov_b32 m0, 97280
 s_nop 0
 buffer_load_dwordx4 v11, s[8:11], s14 offen lds
 s_waitcnt vmcnt(32)
 s_barrier
 v_xor_b32 v16, 0, v14
 v_add_u32 v16, 98304, v16
 v_xor_b32 v17, 64, v16
 ds_read_b64_tr_b16 a[0:1], v16 offset:0
 ds_read_b64_tr_b16 a[2:3], v17 offset:512
 ds_read_b64_tr_b16 a[4:5], v16 offset:2048
 ds_read_b64_tr_b16 a[6:7], v17 offset:2560
 v_xor_b32 v16, 0, v14
 v_add_u32 v16, 98304, v16
 v_xor_b32 v17, 64, v16
 ds_read_b64_tr_b16 a[8:9], v16 offset:8192
 ds_read_b64_tr_b16 a[10:11], v17 offset:8704
 ds_read_b64_tr_b16 a[12:13], v16 offset:10240
 ds_read_b64_tr_b16 a[14:15], v17 offset:10752
 v_xor_b32 v16, 0, v14
 v_add_u32 v16, 98304, v16
 v_xor_b32 v17, 64, v16
 ds_read_b64_tr_b16 a[16:17], v16 offset:16384
 ds_read_b64_tr_b16 a[18:19], v17 offset:16896
 ds_read_b64_tr_b16 a[20:21], v16 offset:18432
 ds_read_b64_tr_b16 a[22:23], v17 offset:18944
 v_xor_b32 v16, 0, v14
 v_add_u32 v16, 98304, v16
 v_xor_b32 v17, 64, v16
 ds_read_b64_tr_b16 a[24:25], v16 offset:24576
 ds_read_b64_tr_b16 a[26:27], v17 offset:25088
 ds_read_b64_tr_b16 a[28:29], v16 offset:26624
 ds_read_b64_tr_b16 a[30:31], v17 offset:27136
 v_xor_b32 v16, 32, v14
 v_add_u32 v16, 98304, v16
 v_xor_b32 v17, 64, v16
 ds_read_b64_tr_b16 a[32:33], v16 offset:0
 ds_read_b64_tr_b16 a[34:35], v17 offset:512
 ds_read_b64_tr_b16 a[36:37], v16 offset:2048
 ds_read_b64_tr_b16 a[38:39], v17 offset:2560
 v_xor_b32 v16, 32, v14
 v_add_u32 v16, 98304, v16
 v_xor_b32 v17, 64, v16
 ds_read_b64_tr_b16 a[40:41], v16 offset:8192
 ds_read_b64_tr_b16 a[42:43], v17 offset:8704
 ds_read_b64_tr_b16 a[44:45], v16 offset:10240
 ds_read_b64_tr_b16 a[46:47], v17 offset:10752
 v_xor_b32 v16, 32, v14
 v_add_u32 v16, 98304, v16
 v_xor_b32 v17, 64, v16
 ds_read_b64_tr_b16 a[48:49], v16 offset:16384
 ds_read_b64_tr_b16 a[50:51], v17 offset:16896
 ds_read_b64_tr_b16 a[52:53], v16 offset:18432
 ds_read_b64_tr_b16 a[54:55], v17 offset:18944
 v_xor_b32 v16, 32, v14
 v_add_u32 v16, 98304, v16
 v_xor_b32 v17, 64, v16
 ds_read_b64_tr_b16 a[56:57], v16 offset:24576
 ds_read_b64_tr_b16 a[58:59], v17 offset:25088
 ds_read_b64_tr_b16 a[60:61], v16 offset:26624
 ds_read_b64_tr_b16 a[62:63], v17 offset:27136
 v_xor_b32 v16, 128, v14
 v_add_u32 v16, 98304, v16
 v_xor_b32 v17, 64, v16
 ds_read_b64_tr_b16 a[64:65], v16 offset:0
 ds_read_b64_tr_b16 a[66:67], v17 offset:512
 ds_read_b64_tr_b16 a[68:69], v16 offset:2048
 ds_read_b64_tr_b16 a[70:71], v17 offset:2560
 v_xor_b32 v16, 128, v14
 v_add_u32 v16, 98304, v16
 v_xor_b32 v17, 64, v16
 ds_read_b64_tr_b16 a[72:73], v16 offset:8192
 ds_read_b64_tr_b16 a[74:75], v17 offset:8704
 ds_read_b64_tr_b16 a[76:77], v16 offset:10240
 ds_read_b64_tr_b16 a[78:79], v17 offset:10752
 v_xor_b32 v16, 128, v14
 v_add_u32 v16, 98304, v16
 v_xor_b32 v17, 64, v16
 ds_read_b64_tr_b16 a[80:81], v16 offset:16384
 ds_read_b64_tr_b16 a[82:83], v17 offset:16896
 ds_read_b64_tr_b16 a[84:85], v16 offset:18432
 ds_read_b64_tr_b16 a[86:87], v17 offset:18944
 v_xor_b32 v16, 128, v14
 v_add_u32 v16, 98304, v16
 v_xor_b32 v17, 64, v16
 ds_read_b64_tr_b16 a[88:89], v16 offset:24576
 ds_read_b64_tr_b16 a[90:91], v17 offset:25088
 ds_read_b64_tr_b16 a[92:93], v16 offset:26624
 ds_read_b64_tr_b16 a[94:95], v17 offset:27136
 v_xor_b32 v16, 160, v14
 v_add_u32 v16, 98304, v16
 v_xor_b32 v17, 64, v16
 ds_read_b64_tr_b16 a[96:97], v16 offset:0
 ds_read_b64_tr_b16 a[98:99], v17 offset:512
 ds_read_b64_tr_b16 a[100:101], v16 offset:2048
 ds_read_b64_tr_b16 a[102:103], v17 offset:2560
 v_xor_b32 v16, 160, v14
 v_add_u32 v16, 98304, v16
 v_xor_b32 v17, 64, v16
 ds_read_b64_tr_b16 a[104:105], v16 offset:8192
 ds_read_b64_tr_b16 a[106:107], v17 offset:8704
 ds_read_b64_tr_b16 a[108:109], v16 offset:10240
 ds_read_b64_tr_b16 a[110:111], v17 offset:10752
 v_xor_b32 v16, 160, v14
 v_add_u32 v16, 98304, v16
 v_xor_b32 v17, 64, v16
 ds_read_b64_tr_b16 a[112:113], v16 offset:16384
 ds_read_b64_tr_b16 a[114:115], v17 offset:16896
 ds_read_b64_tr_b16 a[116:117], v16 offset:18432
 ds_read_b64_tr_b16 a[118:119], v17 offset:18944
 v_xor_b32 v16, 160, v14
 v_add_u32 v16, 98304, v16
 v_xor_b32 v17, 64, v16
 ds_read_b64_tr_b16 a[120:121], v16 offset:24576
 ds_read_b64_tr_b16 a[122:123], v17 offset:25088
 ds_read_b64_tr_b16 a[124:125], v16 offset:26624
 ds_read_b64_tr_b16 a[126:127], v17 offset:27136
 s_waitcnt lgkmcnt(0)
 s_barrier
 s_lshl_b32 s14, s52, 8
 s_add_u32 s14, s14, 3932160
 s_mov_b32 m0, 122880
 s_nop 0
 buffer_load_dwordx4 v10, s[8:11], s14 offen lds
 s_add_u32 s14, s14, 32768
 s_mov_b32 m0, 123904
 s_nop 0
 buffer_load_dwordx4 v10, s[8:11], s14 offen lds
 s_add_u32 s14, s14, 32768
 s_mov_b32 m0, 124928
 s_nop 0
 buffer_load_dwordx4 v10, s[8:11], s14 offen lds
 s_add_u32 s14, s14, 32768
 s_mov_b32 m0, 125952
 s_nop 0
 buffer_load_dwordx4 v10, s[8:11], s14 offen lds
 s_add_u32 s14, s14, 32768
 s_mov_b32 m0, 126976
 s_nop 0
 buffer_load_dwordx4 v11, s[8:11], s14 offen lds
 s_add_u32 s14, s14, 32768
 s_mov_b32 m0, 128000
 s_nop 0
 buffer_load_dwordx4 v11, s[8:11], s14 offen lds
 s_add_u32 s14, s14, 32768
 s_mov_b32 m0, 129024
 s_nop 0
 buffer_load_dwordx4 v11, s[8:11], s14 offen lds
 s_add_u32 s14, s14, 32768
 s_mov_b32 m0, 130048
 s_nop 0
 buffer_load_dwordx4 v11, s[8:11], s14 offen lds
 s_waitcnt vmcnt(32)
 s_barrier
 v_xor_b32 v16, 160, v14
 v_add_u32 v16, 131072, v16
 v_xor_b32 v17, 64, v16
 ds_read_b64_tr_b16 a[128:129], v16 offset:0
 ds_read_b64_tr_b16 a[130:131], v17 offset:512
 ds_read_b64_tr_b16 a[132:133], v16 offset:2048
 ds_read_b64_tr_b16 a[134:135], v17 offset:2560
 v_xor_b32 v16, 160, v14
 v_add_u32 v16, 131072, v16
 v_xor_b32 v17, 64, v16
 ds_read_b64_tr_b16 a[136:137], v16 offset:8192
 ds_read_b64_tr_b16 a[138:139], v17 offset:8704
 ds_read_b64_tr_b16 a[140:141], v16 offset:10240
 ds_read_b64_tr_b16 a[142:143], v17 offset:10752
 v_xor_b32 v16, 160, v14
 v_add_u32 v16, 131072, v16
 v_xor_b32 v17, 64, v16
 ds_read_b64_tr_b16 a[144:145], v16 offset:16384
 ds_read_b64_tr_b16 a[146:147], v17 offset:16896
 ds_read_b64_tr_b16 a[148:149], v16 offset:18432
 ds_read_b64_tr_b16 a[150:151], v17 offset:18944
 v_xor_b32 v16, 160, v14
 v_add_u32 v16, 131072, v16
 v_xor_b32 v17, 64, v16
 ds_read_b64_tr_b16 a[152:153], v16 offset:24576
 ds_read_b64_tr_b16 a[154:155], v17 offset:25088
 ds_read_b64_tr_b16 a[156:157], v16 offset:26624
 ds_read_b64_tr_b16 a[158:159], v17 offset:27136
 s_waitcnt lgkmcnt(0)
 s_barrier
 s_lshl_b32 s14, s52, 8
 s_add_u32 s14, s14, 4980736
 s_mov_b32 m0, 155648
 s_nop 0
 buffer_load_dwordx4 v10, s[8:11], s14 offen lds
 s_add_u32 s14, s14, 32768
 s_mov_b32 m0, 156672
 s_nop 0
 buffer_load_dwordx4 v10, s[8:11], s14 offen lds
 s_add_u32 s14, s14, 32768
 s_mov_b32 m0, 157696
 s_nop 0
 buffer_load_dwordx4 v10, s[8:11], s14 offen lds
 s_add_u32 s14, s14, 32768
 s_mov_b32 m0, 158720
 s_nop 0
 buffer_load_dwordx4 v10, s[8:11], s14 offen lds
 s_add_u32 s14, s14, 32768
 s_mov_b32 m0, 159744
 s_nop 0
 buffer_load_dwordx4 v11, s[8:11], s14 offen lds
 s_add_u32 s14, s14, 32768
 s_mov_b32 m0, 160768
 s_nop 0
 buffer_load_dwordx4 v11, s[8:11], s14 offen lds
 s_add_u32 s14, s14, 32768
 s_mov_b32 m0, 161792
 s_nop 0
 buffer_load_dwordx4 v11, s[8:11], s14 offen lds
 s_add_u32 s14, s14, 32768
 s_mov_b32 m0, 162816
 s_nop 0
 buffer_load_dwordx4 v11, s[8:11], s14 offen lds
 s_waitcnt vmcnt(32)
 s_barrier
 v_xor_b32 v16, 0, v12
 v_add_u32 v16, 0, v16
 ds_read_b64_tr_b16 a[160:161], v16 offset:0
 ds_read_b64_tr_b16 a[162:163], v16 offset:8192
 ds_read_b64_tr_b16 a[164:165], v16 offset:2048
 ds_read_b64_tr_b16 a[166:167], v16 offset:10240
 v_xor_b32 v16, 32, v12
 v_add_u32 v16, 0, v16
 ds_read_b64_tr_b16 a[168:169], v16 offset:0
 ds_read_b64_tr_b16 a[170:171], v16 offset:8192
 ds_read_b64_tr_b16 a[172:173], v16 offset:2048
 ds_read_b64_tr_b16 a[174:175], v16 offset:10240
 v_xor_b32 v16, 0, v12
 v_add_u32 v16, 0, v16
 ds_read_b64_tr_b16 a[176:177], v16 offset:16384
 ds_read_b64_tr_b16 a[178:179], v16 offset:24576
 ds_read_b64_tr_b16 a[180:181], v16 offset:18432
 ds_read_b64_tr_b16 a[182:183], v16 offset:26624
 v_xor_b32 v16, 32, v12
 v_add_u32 v16, 0, v16
 ds_read_b64_tr_b16 a[184:185], v16 offset:16384
 ds_read_b64_tr_b16 a[186:187], v16 offset:24576
 ds_read_b64_tr_b16 a[188:189], v16 offset:18432
 ds_read_b64_tr_b16 a[190:191], v16 offset:26624
 s_waitcnt lgkmcnt(0)
 s_barrier
 s_mov_b32 s8, s22
 s_and_b32 s9, s23, 0xffff
 s_mov_b32 s10, 5242880
 s_lshl_b32 s14, s52, 8
 s_add_u32 s14, s14, 786432
 s_mov_b32 m0, 24576
 s_nop 0
 buffer_load_dwordx4 v10, s[8:11], s14 offen lds
 s_add_u32 s14, s14, 32768
 s_mov_b32 m0, 25600
 s_nop 0
 buffer_load_dwordx4 v10, s[8:11], s14 offen lds
 s_add_u32 s14, s14, 32768
 s_mov_b32 m0, 26624
 s_nop 0
 buffer_load_dwordx4 v10, s[8:11], s14 offen lds
 s_add_u32 s14, s14, 32768
 s_mov_b32 m0, 27648
 s_nop 0
 buffer_load_dwordx4 v10, s[8:11], s14 offen lds
 s_add_u32 s14, s14, 32768
 s_mov_b32 m0, 28672
 s_nop 0
 buffer_load_dwordx4 v11, s[8:11], s14 offen lds
 s_add_u32 s14, s14, 32768
 s_mov_b32 m0, 29696
 s_nop 0
 buffer_load_dwordx4 v11, s[8:11], s14 offen lds
 s_add_u32 s14, s14, 32768
 s_mov_b32 m0, 30720
 s_nop 0
 buffer_load_dwordx4 v11, s[8:11], s14 offen lds
 s_add_u32 s14, s14, 32768
 s_mov_b32 m0, 31744
 s_nop 0
 buffer_load_dwordx4 v11, s[8:11], s14 offen lds
 s_waitcnt vmcnt(32)
 s_barrier
 v_xor_b32 v16, 0, v12
 v_add_u32 v16, 32768, v16
 ds_read_b64_tr_b16 a[192:193], v16 offset:0
 ds_read_b64_tr_b16 a[194:195], v16 offset:8192
 ds_read_b64_tr_b16 a[196:197], v16 offset:2048
 ds_read_b64_tr_b16 a[198:199], v16 offset:10240
 v_xor_b32 v16, 32, v12
 v_add_u32 v16, 32768, v16
 ds_read_b64_tr_b16 a[200:201], v16 offset:0
 ds_read_b64_tr_b16 a[202:203], v16 offset:8192
 ds_read_b64_tr_b16 a[204:205], v16 offset:2048
 ds_read_b64_tr_b16 a[206:207], v16 offset:10240
 v_xor_b32 v16, 0, v12
 v_add_u32 v16, 32768, v16
 ds_read_b64_tr_b16 a[208:209], v16 offset:16384
 ds_read_b64_tr_b16 a[210:211], v16 offset:24576
 ds_read_b64_tr_b16 a[212:213], v16 offset:18432
 ds_read_b64_tr_b16 a[214:215], v16 offset:26624
 v_xor_b32 v16, 32, v12
 v_add_u32 v16, 32768, v16
 ds_read_b64_tr_b16 a[216:217], v16 offset:16384
 ds_read_b64_tr_b16 a[218:219], v16 offset:24576
 ds_read_b64_tr_b16 a[220:221], v16 offset:18432
 ds_read_b64_tr_b16 a[222:223], v16 offset:26624
 s_waitcnt lgkmcnt(0)
 s_barrier
 s_lshl_b32 s14, s52, 8
 s_add_u32 s14, s14, 1835008
 s_mov_b32 m0, 57344
 s_nop 0
 buffer_load_dwordx4 v10, s[8:11], s14 offen lds
 s_add_u32 s14, s14, 32768
 s_mov_b32 m0, 58368
 s_nop 0
 buffer_load_dwordx4 v10, s[8:11], s14 offen lds
 s_add_u32 s14, s14, 32768
 s_mov_b32 m0, 59392
 s_nop 0
 buffer_load_dwordx4 v10, s[8:11], s14 offen lds
 s_add_u32 s14, s14, 32768
 s_mov_b32 m0, 60416
 s_nop 0
 buffer_load_dwordx4 v10, s[8:11], s14 offen lds
 s_add_u32 s14, s14, 32768
 s_mov_b32 m0, 61440
 s_nop 0
 buffer_load_dwordx4 v11, s[8:11], s14 offen lds
 s_add_u32 s14, s14, 32768
 s_mov_b32 m0, 62464
 s_nop 0
 buffer_load_dwordx4 v11, s[8:11], s14 offen lds
 s_add_u32 s14, s14, 32768
 s_mov_b32 m0, 63488
 s_nop 0
 buffer_load_dwordx4 v11, s[8:11], s14 offen lds
 s_add_u32 s14, s14, 32768
 s_mov_b32 m0, 64512
 s_nop 0
 buffer_load_dwordx4 v11, s[8:11], s14 offen lds
 s_waitcnt vmcnt(32)
 s_barrier
 v_xor_b32 v16, 0, v12
 v_add_u32 v16, 65536, v16
 ds_read_b64_tr_b16 a[224:225], v16 offset:0
 ds_read_b64_tr_b16 a[226:227], v16 offset:8192
 ds_read_b64_tr_b16 a[228:229], v16 offset:2048
 ds_read_b64_tr_b16 a[230:231], v16 offset:10240
 v_xor_b32 v16, 32, v12
 v_add_u32 v16, 65536, v16
 ds_read_b64_tr_b16 a[232:233], v16 offset:0
 ds_read_b64_tr_b16 a[234:235], v16 offset:8192
 ds_read_b64_tr_b16 a[236:237], v16 offset:2048
 ds_read_b64_tr_b16 a[238:239], v16 offset:10240
 v_xor_b32 v16, 0, v12
 v_add_u32 v16, 65536, v16
 ds_read_b64_tr_b16 a[240:241], v16 offset:16384
 ds_read_b64_tr_b16 a[242:243], v16 offset:24576
 ds_read_b64_tr_b16 a[244:245], v16 offset:18432
 ds_read_b64_tr_b16 a[246:247], v16 offset:26624
 v_xor_b32 v16, 32, v12
 v_add_u32 v16, 65536, v16
 ds_read_b64_tr_b16 a[248:249], v16 offset:16384
 ds_read_b64_tr_b16 a[250:251], v16 offset:24576
 ds_read_b64_tr_b16 a[252:253], v16 offset:18432
 ds_read_b64_tr_b16 a[254:255], v16 offset:26624
 s_waitcnt lgkmcnt(0)
 s_barrier
 s_lshl_b32 s14, s52, 8
 s_add_u32 s14, s14, 2883584
 s_mov_b32 m0, 90112
 s_nop 0
 buffer_load_dwordx4 v10, s[8:11], s14 offen lds
 s_add_u32 s14, s14, 32768
 s_mov_b32 m0, 91136
 s_nop 0
 buffer_load_dwordx4 v10, s[8:11], s14 offen lds
 s_add_u32 s14, s14, 32768
 s_mov_b32 m0, 92160
 s_nop 0
 buffer_load_dwordx4 v10, s[8:11], s14 offen lds
 s_add_u32 s14, s14, 32768
 s_mov_b32 m0, 93184
 s_nop 0
 buffer_load_dwordx4 v10, s[8:11], s14 offen lds
 s_add_u32 s14, s14, 32768
 s_mov_b32 m0, 94208
 s_nop 0
 buffer_load_dwordx4 v11, s[8:11], s14 offen lds
 s_add_u32 s14, s14, 32768
 s_mov_b32 m0, 95232
 s_nop 0
 buffer_load_dwordx4 v11, s[8:11], s14 offen lds
 s_add_u32 s14, s14, 32768
 s_mov_b32 m0, 96256
 s_nop 0
 buffer_load_dwordx4 v11, s[8:11], s14 offen lds
 s_add_u32 s14, s14, 32768
 s_mov_b32 m0, 97280
 s_nop 0
 buffer_load_dwordx4 v11, s[8:11], s14 offen lds
 s_waitcnt vmcnt(32)
 s_barrier
 v_xor_b32 v16, 0, v12
 v_add_u32 v16, 98304, v16
 ds_read_b64_tr_b16 v[64:65], v16 offset:0
 ds_read_b64_tr_b16 v[66:67], v16 offset:8192
 ds_read_b64_tr_b16 v[68:69], v16 offset:2048
 ds_read_b64_tr_b16 v[70:71], v16 offset:10240
 v_xor_b32 v16, 32, v12
 v_add_u32 v16, 98304, v16
 ds_read_b64_tr_b16 v[72:73], v16 offset:0
 ds_read_b64_tr_b16 v[74:75], v16 offset:8192
 ds_read_b64_tr_b16 v[76:77], v16 offset:2048
 ds_read_b64_tr_b16 v[78:79], v16 offset:10240
 v_xor_b32 v16, 0, v12
 v_add_u32 v16, 98304, v16
 ds_read_b64_tr_b16 v[80:81], v16 offset:16384
 ds_read_b64_tr_b16 v[82:83], v16 offset:24576
 ds_read_b64_tr_b16 v[84:85], v16 offset:18432
 ds_read_b64_tr_b16 v[86:87], v16 offset:26624
 v_xor_b32 v16, 32, v12
 v_add_u32 v16, 98304, v16
 ds_read_b64_tr_b16 v[88:89], v16 offset:16384
 ds_read_b64_tr_b16 v[90:91], v16 offset:24576
 ds_read_b64_tr_b16 v[92:93], v16 offset:18432
 ds_read_b64_tr_b16 v[94:95], v16 offset:26624
 s_waitcnt lgkmcnt(0)
 s_barrier
 s_lshl_b32 s14, s52, 8
 s_add_u32 s14, s14, 3932160
 s_mov_b32 m0, 122880
 s_nop 0
 buffer_load_dwordx4 v10, s[8:11], s14 offen lds
 s_add_u32 s14, s14, 32768
 s_mov_b32 m0, 123904
 s_nop 0
 buffer_load_dwordx4 v10, s[8:11], s14 offen lds
 s_add_u32 s14, s14, 32768
 s_mov_b32 m0, 124928
 s_nop 0
 buffer_load_dwordx4 v10, s[8:11], s14 offen lds
 s_add_u32 s14, s14, 32768
 s_mov_b32 m0, 125952
 s_nop 0
 buffer_load_dwordx4 v10, s[8:11], s14 offen lds
 s_add_u32 s14, s14, 32768
 s_mov_b32 m0, 126976
 s_nop 0
 buffer_load_dwordx4 v11, s[8:11], s14 offen lds
 s_add_u32 s14, s14, 32768
 s_mov_b32 m0, 128000
 s_nop 0
 buffer_load_dwordx4 v11, s[8:11], s14 offen lds
 s_add_u32 s14, s14, 32768
 s_mov_b32 m0, 129024
 s_nop 0
 buffer_load_dwordx4 v11, s[8:11], s14 offen lds
 s_add_u32 s14, s14, 32768
 s_mov_b32 m0, 130048
 s_nop 0
 buffer_load_dwordx4 v11, s[8:11], s14 offen lds
 s_waitcnt vmcnt(32)
 s_barrier
 v_xor_b32 v16, 0, v12
 v_add_u32 v16, 131072, v16
 ds_read_b64_tr_b16 v[96:97], v16 offset:0
 ds_read_b64_tr_b16 v[98:99], v16 offset:8192
 ds_read_b64_tr_b16 v[100:101], v16 offset:2048
 ds_read_b64_tr_b16 v[102:103], v16 offset:10240
 v_xor_b32 v16, 32, v12
 v_add_u32 v16, 131072, v16
 ds_read_b64_tr_b16 v[104:105], v16 offset:0
 ds_read_b64_tr_b16 v[106:107], v16 offset:8192
 ds_read_b64_tr_b16 v[108:109], v16 offset:2048
 ds_read_b64_tr_b16 v[110:111], v16 offset:10240
 v_xor_b32 v16, 0, v12
 v_add_u32 v16, 131072, v16
 ds_read_b64_tr_b16 v[112:113], v16 offset:16384
 ds_read_b64_tr_b16 v[114:115], v16 offset:24576
 ds_read_b64_tr_b16 v[116:117], v16 offset:18432
 ds_read_b64_tr_b16 v[118:119], v16 offset:26624
 v_xor_b32 v16, 32, v12
 v_add_u32 v16, 131072, v16
 ds_read_b64_tr_b16 v[120:121], v16 offset:16384
 ds_read_b64_tr_b16 v[122:123], v16 offset:24576
 ds_read_b64_tr_b16 v[124:125], v16 offset:18432
 ds_read_b64_tr_b16 v[126:127], v16 offset:26624
 s_waitcnt lgkmcnt(0)
 s_barrier
 s_lshl_b32 s14, s52, 8
 s_add_u32 s14, s14, 4980736
 s_mov_b32 m0, 155648
 s_nop 0
 buffer_load_dwordx4 v10, s[8:11], s14 offen lds
 s_add_u32 s14, s14, 32768
 s_mov_b32 m0, 156672
 s_nop 0
 buffer_load_dwordx4 v10, s[8:11], s14 offen lds
 s_add_u32 s14, s14, 32768
 s_mov_b32 m0, 157696
 s_nop 0
 buffer_load_dwordx4 v10, s[8:11], s14 offen lds
 s_add_u32 s14, s14, 32768
 s_mov_b32 m0, 158720
 s_nop 0
 buffer_load_dwordx4 v10, s[8:11], s14 offen lds
 s_add_u32 s14, s14, 32768
 s_mov_b32 m0, 159744
 s_nop 0
 buffer_load_dwordx4 v11, s[8:11], s14 offen lds
 s_add_u32 s14, s14, 32768
 s_mov_b32 m0, 160768
 s_nop 0
 buffer_load_dwordx4 v11, s[8:11], s14 offen lds
 s_add_u32 s14, s14, 32768
 s_mov_b32 m0, 161792
 s_nop 0
 buffer_load_dwordx4 v11, s[8:11], s14 offen lds
 s_add_u32 s14, s14, 32768
 s_mov_b32 m0, 162816
 s_nop 0
 buffer_load_dwordx4 v11, s[8:11], s14 offen lds
 s_waitcnt vmcnt(32)
 s_barrier
 v_xor_b32 v16, 0, v12
 v_add_u32 v16, 0, v16
 ds_read_b64_tr_b16 v[128:129], v16 offset:0
 ds_read_b64_tr_b16 v[130:131], v16 offset:8192
 ds_read_b64_tr_b16 v[132:133], v16 offset:2048
 ds_read_b64_tr_b16 v[134:135], v16 offset:10240
 v_xor_b32 v16, 32, v12
 v_add_u32 v16, 0, v16
 ds_read_b64_tr_b16 v[136:137], v16 offset:0
 ds_read_b64_tr_b16 v[138:139], v16 offset:8192
 ds_read_b64_tr_b16 v[140:141], v16 offset:2048
 ds_read_b64_tr_b16 v[142:143], v16 offset:10240
 v_xor_b32 v16, 0, v12
 v_add_u32 v16, 0, v16
 ds_read_b64_tr_b16 v[144:145], v16 offset:16384
 ds_read_b64_tr_b16 v[146:147], v16 offset:24576
 ds_read_b64_tr_b16 v[148:149], v16 offset:18432
 ds_read_b64_tr_b16 v[150:151], v16 offset:26624
 v_xor_b32 v16, 32, v12
 v_add_u32 v16, 0, v16
 ds_read_b64_tr_b16 v[152:153], v16 offset:16384
 ds_read_b64_tr_b16 v[154:155], v16 offset:24576
 ds_read_b64_tr_b16 v[156:157], v16 offset:18432
 ds_read_b64_tr_b16 v[158:159], v16 offset:26624
 s_waitcnt lgkmcnt(0)
 s_barrier
 s_mov_b32 s8, s20
 s_and_b32 s9, s21, 0xffff
 s_mov_b32 s10, 5242880
 s_lshl_b32 s14, s52, 8
 s_add_u32 s14, s14, 786432
 s_mov_b32 m0, 24576
 s_nop 0
 buffer_load_dwordx4 v10, s[8:11], s14 offen lds
 s_add_u32 s14, s14, 32768
 s_mov_b32 m0, 25600
 s_nop 0
 buffer_load_dwordx4 v10, s[8:11], s14 offen lds
 s_add_u32 s14, s14, 32768
 s_mov_b32 m0, 26624
 s_nop 0
 buffer_load_dwordx4 v10, s[8:11], s14 offen lds
 s_add_u32 s14, s14, 32768
 s_mov_b32 m0, 27648
 s_nop 0
 buffer_load_dwordx4 v10, s[8:11], s14 offen lds
 s_add_u32 s14, s14, 32768
 s_mov_b32 m0, 28672
 s_nop 0
 buffer_load_dwordx4 v11, s[8:11], s14 offen lds
 s_add_u32 s14, s14, 32768
 s_mov_b32 m0, 29696
 s_nop 0
 buffer_load_dwordx4 v11, s[8:11], s14 offen lds
 s_add_u32 s14, s14, 32768
 s_mov_b32 m0, 30720
 s_nop 0
 buffer_load_dwordx4 v11, s[8:11], s14 offen lds
 s_add_u32 s14, s14, 32768
 s_mov_b32 m0, 31744
 s_nop 0
 buffer_load_dwordx4 v11, s[8:11], s14 offen lds
 s_waitcnt vmcnt(32)
 s_barrier
 v_xor_b32 v16, 0, v12
 v_add_u32 v16, 32768, v16
 ds_read_b64_tr_b16 v[160:161], v16 offset:0
 ds_read_b64_tr_b16 v[162:163], v16 offset:8192
 ds_read_b64_tr_b16 v[164:165], v16 offset:2048
 ds_read_b64_tr_b16 v[166:167], v16 offset:10240
 v_xor_b32 v16, 32, v12
 v_add_u32 v16, 32768, v16
 ds_read_b64_tr_b16 v[168:169], v16 offset:0
 ds_read_b64_tr_b16 v[170:171], v16 offset:8192
 ds_read_b64_tr_b16 v[172:173], v16 offset:2048
 ds_read_b64_tr_b16 v[174:175], v16 offset:10240
 v_xor_b32 v16, 0, v12
 v_add_u32 v16, 32768, v16
 ds_read_b64_tr_b16 v[176:177], v16 offset:16384
 ds_read_b64_tr_b16 v[178:179], v16 offset:24576
 ds_read_b64_tr_b16 v[180:181], v16 offset:18432
 ds_read_b64_tr_b16 v[182:183], v16 offset:26624
 v_xor_b32 v16, 32, v12
 v_add_u32 v16, 32768, v16
 ds_read_b64_tr_b16 v[32:33], v16 offset:16384
 ds_read_b64_tr_b16 v[34:35], v16 offset:24576
 ds_read_b64_tr_b16 v[36:37], v16 offset:18432
 ds_read_b64_tr_b16 v[38:39], v16 offset:26624
 s_add_u32 s3, s63, 0
 s_waitcnt lgkmcnt(2)
 buffer_store_dwordx4 v[32:35], v1, s[4:7], s3 offen offset:0
 s_waitcnt lgkmcnt(0)
 buffer_store_dwordx4 v[36:39], v1, s[4:7], s3 offen offset:1024
 s_waitcnt lgkmcnt(0)
 s_barrier
 s_lshl_b32 s14, s52, 8
 s_add_u32 s14, s14, 1835008
 s_mov_b32 m0, 57344
 s_nop 0
 buffer_load_dwordx4 v10, s[8:11], s14 offen lds
 s_add_u32 s14, s14, 32768
 s_mov_b32 m0, 58368
 s_nop 0
 buffer_load_dwordx4 v10, s[8:11], s14 offen lds
 s_add_u32 s14, s14, 32768
 s_mov_b32 m0, 59392
 s_nop 0
 buffer_load_dwordx4 v10, s[8:11], s14 offen lds
 s_add_u32 s14, s14, 32768
 s_mov_b32 m0, 60416
 s_nop 0
 buffer_load_dwordx4 v10, s[8:11], s14 offen lds
 s_add_u32 s14, s14, 32768
 s_mov_b32 m0, 61440
 s_nop 0
 buffer_load_dwordx4 v11, s[8:11], s14 offen lds
 s_add_u32 s14, s14, 32768
 s_mov_b32 m0, 62464
 s_nop 0
 buffer_load_dwordx4 v11, s[8:11], s14 offen lds
 s_add_u32 s14, s14, 32768
 s_mov_b32 m0, 63488
 s_nop 0
 buffer_load_dwordx4 v11, s[8:11], s14 offen lds
 s_add_u32 s14, s14, 32768
 s_mov_b32 m0, 64512
 s_nop 0
 buffer_load_dwordx4 v11, s[8:11], s14 offen lds
 s_waitcnt vmcnt(34)
 s_barrier
 v_xor_b32 v16, 0, v12
 v_add_u32 v16, 65536, v16
 ds_read_b64_tr_b16 v[184:185], v16 offset:0
 ds_read_b64_tr_b16 v[186:187], v16 offset:8192
 ds_read_b64_tr_b16 v[188:189], v16 offset:2048
 ds_read_b64_tr_b16 v[190:191], v16 offset:10240
 v_xor_b32 v16, 32, v12
 v_add_u32 v16, 65536, v16
 ds_read_b64_tr_b16 v[192:193], v16 offset:0
 ds_read_b64_tr_b16 v[194:195], v16 offset:8192
 ds_read_b64_tr_b16 v[196:197], v16 offset:2048
 ds_read_b64_tr_b16 v[198:199], v16 offset:10240
 v_xor_b32 v16, 0, v12
 v_add_u32 v16, 65536, v16
 ds_read_b64_tr_b16 v[200:201], v16 offset:16384
 ds_read_b64_tr_b16 v[202:203], v16 offset:24576
 ds_read_b64_tr_b16 v[204:205], v16 offset:18432
 ds_read_b64_tr_b16 v[206:207], v16 offset:26624
 v_xor_b32 v16, 32, v12
 v_add_u32 v16, 65536, v16
 ds_read_b64_tr_b16 v[208:209], v16 offset:16384
 ds_read_b64_tr_b16 v[210:211], v16 offset:24576
 ds_read_b64_tr_b16 v[212:213], v16 offset:18432
 ds_read_b64_tr_b16 v[214:215], v16 offset:26624
 s_waitcnt lgkmcnt(0)
 s_barrier
 s_lshl_b32 s14, s52, 8
 s_add_u32 s14, s14, 2883584
 s_mov_b32 m0, 90112
 s_nop 0
 buffer_load_dwordx4 v10, s[8:11], s14 offen lds
 s_add_u32 s14, s14, 32768
 s_mov_b32 m0, 91136
 s_nop 0
 buffer_load_dwordx4 v10, s[8:11], s14 offen lds
 s_add_u32 s14, s14, 32768
 s_mov_b32 m0, 92160
 s_nop 0
 buffer_load_dwordx4 v10, s[8:11], s14 offen lds
 s_add_u32 s14, s14, 32768
 s_mov_b32 m0, 93184
 s_nop 0
 buffer_load_dwordx4 v10, s[8:11], s14 offen lds
 s_add_u32 s14, s14, 32768
 s_mov_b32 m0, 94208
 s_nop 0
 buffer_load_dwordx4 v11, s[8:11], s14 offen lds
 s_add_u32 s14, s14, 32768
 s_mov_b32 m0, 95232
 s_nop 0
 buffer_load_dwordx4 v11, s[8:11], s14 offen lds
 s_add_u32 s14, s14, 32768
 s_mov_b32 m0, 96256
 s_nop 0
 buffer_load_dwordx4 v11, s[8:11], s14 offen lds
 s_add_u32 s14, s14, 32768
 s_mov_b32 m0, 97280
 s_nop 0
 buffer_load_dwordx4 v11, s[8:11], s14 offen lds
 s_waitcnt vmcnt(34)
 s_barrier
 v_xor_b32 v16, 0, v12
 v_add_u32 v16, 98304, v16
 ds_read_b64_tr_b16 v[40:41], v16 offset:0
 ds_read_b64_tr_b16 v[42:43], v16 offset:8192
 ds_read_b64_tr_b16 v[44:45], v16 offset:2048
 ds_read_b64_tr_b16 v[46:47], v16 offset:10240
 s_add_u32 s3, s63, 2048
 s_waitcnt lgkmcnt(2)
 buffer_store_dwordx4 v[40:43], v1, s[4:7], s3 offen offset:0
 s_waitcnt lgkmcnt(0)
 buffer_store_dwordx4 v[44:47], v1, s[4:7], s3 offen offset:1024
 v_xor_b32 v16, 32, v12
 v_add_u32 v16, 98304, v16
 ds_read_b64_tr_b16 v[48:49], v16 offset:0
 ds_read_b64_tr_b16 v[50:51], v16 offset:8192
 ds_read_b64_tr_b16 v[52:53], v16 offset:2048
 ds_read_b64_tr_b16 v[54:55], v16 offset:10240
 s_add_u32 s3, s63, 4096
 s_waitcnt lgkmcnt(2)
 buffer_store_dwordx4 v[48:51], v1, s[4:7], s3 offen offset:0
 s_waitcnt lgkmcnt(0)
 buffer_store_dwordx4 v[52:55], v1, s[4:7], s3 offen offset:1024
 v_xor_b32 v16, 0, v12
 v_add_u32 v16, 98304, v16
 ds_read_b64_tr_b16 v[56:57], v16 offset:16384
 ds_read_b64_tr_b16 v[58:59], v16 offset:24576
 ds_read_b64_tr_b16 v[60:61], v16 offset:18432
 ds_read_b64_tr_b16 v[62:63], v16 offset:26624
 s_add_u32 s3, s63, 6144
 s_waitcnt lgkmcnt(2)
 buffer_store_dwordx4 v[56:59], v1, s[4:7], s3 offen offset:0
 s_waitcnt lgkmcnt(0)
 buffer_store_dwordx4 v[60:63], v1, s[4:7], s3 offen offset:1024
 v_xor_b32 v16, 32, v12
 v_add_u32 v16, 98304, v16
 ds_read_b64_tr_b16 v[32:33], v16 offset:16384
 ds_read_b64_tr_b16 v[34:35], v16 offset:24576
 ds_read_b64_tr_b16 v[36:37], v16 offset:18432
 ds_read_b64_tr_b16 v[38:39], v16 offset:26624
 s_add_u32 s3, s63, 8192
 s_waitcnt lgkmcnt(2)
 buffer_store_dwordx4 v[32:35], v1, s[4:7], s3 offen offset:0
 s_waitcnt lgkmcnt(0)
 buffer_store_dwordx4 v[36:39], v1, s[4:7], s3 offen offset:1024
 s_waitcnt lgkmcnt(0)
 s_barrier
 s_lshl_b32 s14, s52, 8
 s_add_u32 s14, s14, 3932160
 s_mov_b32 m0, 122880
 s_nop 0
 buffer_load_dwordx4 v10, s[8:11], s14 offen lds
 s_add_u32 s14, s14, 32768
 s_mov_b32 m0, 123904
 s_nop 0
 buffer_load_dwordx4 v10, s[8:11], s14 offen lds
 s_add_u32 s14, s14, 32768
 s_mov_b32 m0, 124928
 s_nop 0
 buffer_load_dwordx4 v10, s[8:11], s14 offen lds
 s_add_u32 s14, s14, 32768
 s_mov_b32 m0, 125952
 s_nop 0
 buffer_load_dwordx4 v10, s[8:11], s14 offen lds
 s_add_u32 s14, s14, 32768
 s_mov_b32 m0, 126976
 s_nop 0
 buffer_load_dwordx4 v11, s[8:11], s14 offen lds
 s_add_u32 s14, s14, 32768
 s_mov_b32 m0, 128000
 s_nop 0
 buffer_load_dwordx4 v11, s[8:11], s14 offen lds
 s_add_u32 s14, s14, 32768
 s_mov_b32 m0, 129024
 s_nop 0
 buffer_load_dwordx4 v11, s[8:11], s14 offen lds
 s_add_u32 s14, s14, 32768
 s_mov_b32 m0, 130048
 s_nop 0
 buffer_load_dwordx4 v11, s[8:11], s14 offen lds
 s_waitcnt vmcnt(42)
 s_barrier
 v_xor_b32 v16, 0, v12
 v_add_u32 v16, 131072, v16
 ds_read_b64_tr_b16 v[216:217], v16 offset:0
 ds_read_b64_tr_b16 v[218:219], v16 offset:8192
 ds_read_b64_tr_b16 v[220:221], v16 offset:2048
 ds_read_b64_tr_b16 v[222:223], v16 offset:10240
 v_xor_b32 v16, 32, v12
 v_add_u32 v16, 131072, v16
 ds_read_b64_tr_b16 v[40:41], v16 offset:0
 ds_read_b64_tr_b16 v[42:43], v16 offset:8192
 ds_read_b64_tr_b16 v[44:45], v16 offset:2048
 ds_read_b64_tr_b16 v[46:47], v16 offset:10240
 s_add_u32 s3, s63, 10240
 s_waitcnt lgkmcnt(2)
 buffer_store_dwordx4 v[40:43], v1, s[4:7], s3 offen offset:0
 s_waitcnt lgkmcnt(0)
 buffer_store_dwordx4 v[44:47], v1, s[4:7], s3 offen offset:1024
 v_xor_b32 v16, 0, v12
 v_add_u32 v16, 131072, v16
 ds_read_b64_tr_b16 v[224:225], v16 offset:16384
 ds_read_b64_tr_b16 v[226:227], v16 offset:24576
 ds_read_b64_tr_b16 v[228:229], v16 offset:18432
 ds_read_b64_tr_b16 v[230:231], v16 offset:26624
 v_xor_b32 v16, 32, v12
 v_add_u32 v16, 131072, v16
 ds_read_b64_tr_b16 v[232:233], v16 offset:16384
 ds_read_b64_tr_b16 v[234:235], v16 offset:24576
 ds_read_b64_tr_b16 v[236:237], v16 offset:18432
 ds_read_b64_tr_b16 v[238:239], v16 offset:26624
 s_waitcnt lgkmcnt(0)
 s_barrier
 s_lshl_b32 s14, s52, 8
 s_add_u32 s14, s14, 4980736
 s_mov_b32 m0, 155648
 s_nop 0
 buffer_load_dwordx4 v10, s[8:11], s14 offen lds
 s_add_u32 s14, s14, 32768
 s_mov_b32 m0, 156672
 s_nop 0
 buffer_load_dwordx4 v10, s[8:11], s14 offen lds
 s_add_u32 s14, s14, 32768
 s_mov_b32 m0, 157696
 s_nop 0
 buffer_load_dwordx4 v10, s[8:11], s14 offen lds
 s_add_u32 s14, s14, 32768
 s_mov_b32 m0, 158720
 s_nop 0
 buffer_load_dwordx4 v10, s[8:11], s14 offen lds
 s_add_u32 s14, s14, 32768
 s_mov_b32 m0, 159744
 s_nop 0
 buffer_load_dwordx4 v11, s[8:11], s14 offen lds
 s_add_u32 s14, s14, 32768
 s_mov_b32 m0, 160768
 s_nop 0
 buffer_load_dwordx4 v11, s[8:11], s14 offen lds
 s_add_u32 s14, s14, 32768
 s_mov_b32 m0, 161792
 s_nop 0
 buffer_load_dwordx4 v11, s[8:11], s14 offen lds
 s_add_u32 s14, s14, 32768
 s_mov_b32 m0, 162816
 s_nop 0
 buffer_load_dwordx4 v11, s[8:11], s14 offen lds
 s_waitcnt vmcnt(44)
 s_barrier
 v_xor_b32 v16, 0, v12
 v_add_u32 v16, 0, v16
 ds_read_b64_tr_b16 v[240:241], v16 offset:0
 ds_read_b64_tr_b16 v[242:243], v16 offset:8192
 ds_read_b64_tr_b16 v[244:245], v16 offset:2048
 ds_read_b64_tr_b16 v[246:247], v16 offset:10240
 v_xor_b32 v16, 32, v12
 v_add_u32 v16, 0, v16
 ds_read_b64_tr_b16 v[248:249], v16 offset:0
 ds_read_b64_tr_b16 v[250:251], v16 offset:8192
 ds_read_b64_tr_b16 v[252:253], v16 offset:2048
 ds_read_b64_tr_b16 v[254:255], v16 offset:10240
 v_xor_b32 v16, 0, v12
 v_add_u32 v16, 0, v16
 ds_read_b64_tr_b16 v[32:33], v16 offset:16384
 ds_read_b64_tr_b16 v[34:35], v16 offset:24576
 ds_read_b64_tr_b16 v[36:37], v16 offset:18432
 ds_read_b64_tr_b16 v[38:39], v16 offset:26624
 v_xor_b32 v16, 32, v12
 v_add_u32 v16, 0, v16
 ds_read_b64_tr_b16 v[40:41], v16 offset:16384
 ds_read_b64_tr_b16 v[42:43], v16 offset:24576
 ds_read_b64_tr_b16 v[44:45], v16 offset:18432
 ds_read_b64_tr_b16 v[46:47], v16 offset:26624
 s_waitcnt lgkmcnt(0)
 s_barrier
 ds_write_b128 v1, v[232:235] offset:28672
 ds_write_b128 v1, v[236:239] offset:29696
 ds_write_b128 v1, v[224:227] offset:30720
 ds_write_b128 v1, v[228:231] offset:31744
 s_waitcnt lgkmcnt(0)
 v_mov_b32 v232, v32
 v_mov_b32 v233, v33
 v_mov_b32 v234, v34
 v_mov_b32 v235, v35
 v_mov_b32 v236, v36
 v_mov_b32 v237, v37
 v_mov_b32 v238, v38
 v_mov_b32 v239, v39
 v_mov_b32 v224, v40
 v_mov_b32 v225, v41
 v_mov_b32 v226, v42
 v_mov_b32 v227, v43
 v_mov_b32 v228, v44
 v_mov_b32 v229, v45
 v_mov_b32 v230, v46
 v_mov_b32 v231, v47
 s_waitcnt vmcnt(34)
 s_barrier
 v_xor_b32 v16, 0, v12
 v_add_u32 v16, 32768, v16
 ds_read_b64_tr_b16 v[32:33], v16 offset:0
 ds_read_b64_tr_b16 v[34:35], v16 offset:8192
 ds_read_b64_tr_b16 v[36:37], v16 offset:2048
 ds_read_b64_tr_b16 v[38:39], v16 offset:10240
 v_xor_b32 v16, 32, v12
 v_add_u32 v16, 32768, v16
 ds_read_b64_tr_b16 v[40:41], v16 offset:0
 ds_read_b64_tr_b16 v[42:43], v16 offset:8192
 ds_read_b64_tr_b16 v[44:45], v16 offset:2048
 ds_read_b64_tr_b16 v[46:47], v16 offset:10240
 v_xor_b32 v16, 0, v12
 v_add_u32 v16, 32768, v16
 ds_read_b64_tr_b16 v[48:49], v16 offset:16384
 ds_read_b64_tr_b16 v[50:51], v16 offset:24576
 ds_read_b64_tr_b16 v[52:53], v16 offset:18432
 ds_read_b64_tr_b16 v[54:55], v16 offset:26624
 v_xor_b32 v16, 32, v12
 v_add_u32 v16, 32768, v16
 ds_read_b64_tr_b16 v[56:57], v16 offset:16384
 ds_read_b64_tr_b16 v[58:59], v16 offset:24576
 ds_read_b64_tr_b16 v[60:61], v16 offset:18432
 ds_read_b64_tr_b16 v[62:63], v16 offset:26624
 s_waitcnt lgkmcnt(0)
 s_barrier
 ds_write_b128 v1, v[208:211] offset:57344
 ds_write_b128 v1, v[212:215] offset:58368
 ds_write_b128 v1, v[200:203] offset:59392
 ds_write_b128 v1, v[204:207] offset:60416
 ds_write_b128 v1, v[184:187] offset:61440
 ds_write_b128 v1, v[188:191] offset:62464
 ds_write_b128 v1, v[176:179] offset:63488
 ds_write_b128 v1, v[180:183] offset:64512
 s_waitcnt lgkmcnt(0)
 v_mov_b32 v208, v32
 v_mov_b32 v209, v33
 v_mov_b32 v210, v34
 v_mov_b32 v211, v35
 v_mov_b32 v212, v36
 v_mov_b32 v213, v37
 v_mov_b32 v214, v38
 v_mov_b32 v215, v39
 v_mov_b32 v200, v40
 v_mov_b32 v201, v41
 v_mov_b32 v202, v42
 v_mov_b32 v203, v43
 v_mov_b32 v204, v44
 v_mov_b32 v205, v45
 v_mov_b32 v206, v46
 v_mov_b32 v207, v47
 v_mov_b32 v184, v48
 v_mov_b32 v185, v49
 v_mov_b32 v186, v50
 v_mov_b32 v187, v51
 v_mov_b32 v188, v52
 v_mov_b32 v189, v53
 v_mov_b32 v190, v54
 v_mov_b32 v191, v55
 v_mov_b32 v176, v56
 v_mov_b32 v177, v57
 v_mov_b32 v178, v58
 v_mov_b32 v179, v59
 v_mov_b32 v180, v60
 v_mov_b32 v181, v61
 v_mov_b32 v182, v62
 v_mov_b32 v183, v63
 s_waitcnt vmcnt(26)
 s_barrier
 v_xor_b32 v16, 0, v12
 v_add_u32 v16, 65536, v16
 ds_read_b64_tr_b16 v[32:33], v16 offset:0
 ds_read_b64_tr_b16 v[34:35], v16 offset:8192
 ds_read_b64_tr_b16 v[36:37], v16 offset:2048
 ds_read_b64_tr_b16 v[38:39], v16 offset:10240
 v_xor_b32 v16, 32, v12
 v_add_u32 v16, 65536, v16
 ds_read_b64_tr_b16 v[40:41], v16 offset:0
 ds_read_b64_tr_b16 v[42:43], v16 offset:8192
 ds_read_b64_tr_b16 v[44:45], v16 offset:2048
 ds_read_b64_tr_b16 v[46:47], v16 offset:10240
 v_xor_b32 v16, 0, v12
 v_add_u32 v16, 65536, v16
 ds_read_b64_tr_b16 v[48:49], v16 offset:16384
 ds_read_b64_tr_b16 v[50:51], v16 offset:24576
 ds_read_b64_tr_b16 v[52:53], v16 offset:18432
 ds_read_b64_tr_b16 v[54:55], v16 offset:26624
 v_xor_b32 v16, 32, v12
 v_add_u32 v16, 65536, v16
 ds_read_b64_tr_b16 v[56:57], v16 offset:16384
 ds_read_b64_tr_b16 v[58:59], v16 offset:24576
 ds_read_b64_tr_b16 v[60:61], v16 offset:18432
 ds_read_b64_tr_b16 v[62:63], v16 offset:26624
 s_waitcnt lgkmcnt(0)
 s_barrier
 ds_write_b128 v2, v[168:171] offset:24576
 ds_write_b128 v2, v[172:175] offset:25600
 ds_write_b128 v2, v[160:163] offset:26624
 ds_write_b128 v2, v[164:167] offset:27648
 ds_write_b128 v2, v[144:147] offset:28672
 ds_write_b128 v2, v[148:151] offset:29696
 ds_write_b128 v2, v[128:131] offset:30720
 ds_write_b128 v2, v[132:135] offset:31744
 s_waitcnt lgkmcnt(0)
 v_mov_b32 v168, v32
 v_mov_b32 v169, v33
 v_mov_b32 v170, v34
 v_mov_b32 v171, v35
 v_mov_b32 v172, v36
 v_mov_b32 v173, v37
 v_mov_b32 v174, v38
 v_mov_b32 v175, v39
 v_mov_b32 v160, v40
 v_mov_b32 v161, v41
 v_mov_b32 v162, v42
 v_mov_b32 v163, v43
 v_mov_b32 v164, v44
 v_mov_b32 v165, v45
 v_mov_b32 v166, v46
 v_mov_b32 v167, v47
 v_mov_b32 v144, v48
 v_mov_b32 v145, v49
 v_mov_b32 v146, v50
 v_mov_b32 v147, v51
 v_mov_b32 v148, v52
 v_mov_b32 v149, v53
 v_mov_b32 v150, v54
 v_mov_b32 v151, v55
 v_mov_b32 v128, v56
 v_mov_b32 v129, v57
 v_mov_b32 v130, v58
 v_mov_b32 v131, v59
 v_mov_b32 v132, v60
 v_mov_b32 v133, v61
 v_mov_b32 v134, v62
 v_mov_b32 v135, v63
 s_waitcnt vmcnt(10)
 s_barrier
 v_xor_b32 v16, 0, v12
 v_add_u32 v16, 98304, v16
 ds_read_b64_tr_b16 v[32:33], v16 offset:0
 ds_read_b64_tr_b16 v[34:35], v16 offset:8192
 ds_read_b64_tr_b16 v[36:37], v16 offset:2048
 ds_read_b64_tr_b16 v[38:39], v16 offset:10240
 v_xor_b32 v16, 32, v12
 v_add_u32 v16, 98304, v16
 ds_read_b64_tr_b16 v[40:41], v16 offset:0
 ds_read_b64_tr_b16 v[42:43], v16 offset:8192
 ds_read_b64_tr_b16 v[44:45], v16 offset:2048
 ds_read_b64_tr_b16 v[46:47], v16 offset:10240
 v_xor_b32 v16, 0, v12
 v_add_u32 v16, 98304, v16
 ds_read_b64_tr_b16 v[48:49], v16 offset:16384
 ds_read_b64_tr_b16 v[50:51], v16 offset:24576
 ds_read_b64_tr_b16 v[52:53], v16 offset:18432
 ds_read_b64_tr_b16 v[54:55], v16 offset:26624
 v_xor_b32 v16, 32, v12
 v_add_u32 v16, 98304, v16
 ds_read_b64_tr_b16 v[56:57], v16 offset:16384
 ds_read_b64_tr_b16 v[58:59], v16 offset:24576
 ds_read_b64_tr_b16 v[60:61], v16 offset:18432
 ds_read_b64_tr_b16 v[62:63], v16 offset:26624
 s_waitcnt lgkmcnt(0)
 s_barrier
 ds_write_b128 v3, a[136:139] offset:8192
 ds_write_b128 v3, a[140:143] offset:9216
 ds_write_b128 v3, a[128:131] offset:10240
 ds_write_b128 v3, a[132:135] offset:11264
 ds_write_b128 v3, a[120:123] offset:12288
 ds_write_b128 v3, a[124:127] offset:13312
 ds_write_b128 v3, a[88:91] offset:14336
 ds_write_b128 v3, a[92:95] offset:15360
 s_waitcnt lgkmcnt(0)
 v_accvgpr_write_b32 a136, v32
 v_accvgpr_write_b32 a137, v33
 v_accvgpr_write_b32 a138, v34
 v_accvgpr_write_b32 a139, v35
 v_accvgpr_write_b32 a140, v36
 v_accvgpr_write_b32 a141, v37
 v_accvgpr_write_b32 a142, v38
 v_accvgpr_write_b32 a143, v39
 v_accvgpr_write_b32 a128, v40
 v_accvgpr_write_b32 a129, v41
 v_accvgpr_write_b32 a130, v42
 v_accvgpr_write_b32 a131, v43
 v_accvgpr_write_b32 a132, v44
 v_accvgpr_write_b32 a133, v45
 v_accvgpr_write_b32 a134, v46
 v_accvgpr_write_b32 a135, v47
 v_accvgpr_write_b32 a120, v48
 v_accvgpr_write_b32 a121, v49
 v_accvgpr_write_b32 a122, v50
 v_accvgpr_write_b32 a123, v51
 v_accvgpr_write_b32 a124, v52
 v_accvgpr_write_b32 a125, v53
 v_accvgpr_write_b32 a126, v54
 v_accvgpr_write_b32 a127, v55
 v_accvgpr_write_b32 a88, v56
 v_accvgpr_write_b32 a89, v57
 v_accvgpr_write_b32 a90, v58
 v_accvgpr_write_b32 a91, v59
 v_accvgpr_write_b32 a92, v60
 v_accvgpr_write_b32 a93, v61
 v_accvgpr_write_b32 a94, v62
 v_accvgpr_write_b32 a95, v63
 s_waitcnt vmcnt(0)
 s_barrier
 v_xor_b32 v16, 0, v12
 v_add_u32 v16, 131072, v16
 ds_read_b64_tr_b16 v[32:33], v16 offset:0
 ds_read_b64_tr_b16 v[34:35], v16 offset:8192
 ds_read_b64_tr_b16 v[36:37], v16 offset:2048
 ds_read_b64_tr_b16 v[38:39], v16 offset:10240
 v_xor_b32 v16, 32, v12
 v_add_u32 v16, 131072, v16
 ds_read_b64_tr_b16 v[40:41], v16 offset:0
 ds_read_b64_tr_b16 v[42:43], v16 offset:8192
 ds_read_b64_tr_b16 v[44:45], v16 offset:2048
 ds_read_b64_tr_b16 v[46:47], v16 offset:10240
 v_xor_b32 v16, 0, v12
 v_add_u32 v16, 131072, v16
 ds_read_b64_tr_b16 v[48:49], v16 offset:16384
 ds_read_b64_tr_b16 v[50:51], v16 offset:24576
 ds_read_b64_tr_b16 v[52:53], v16 offset:18432
 ds_read_b64_tr_b16 v[54:55], v16 offset:26624
 v_xor_b32 v16, 32, v12
 v_add_u32 v16, 131072, v16
 ds_read_b64_tr_b16 v[56:57], v16 offset:16384
 ds_read_b64_tr_b16 v[58:59], v16 offset:24576
 ds_read_b64_tr_b16 v[60:61], v16 offset:18432
 ds_read_b64_tr_b16 v[62:63], v16 offset:26624
 s_waitcnt lgkmcnt(0)
 s_barrier
 ds_write_b128 v3, a[80:83] offset:40960
 ds_write_b128 v3, a[84:87] offset:41984
 ds_write_b128 v3, a[72:75] offset:43008
 ds_write_b128 v3, a[76:79] offset:44032
 ds_write_b128 v3, a[32:35] offset:45056
 ds_write_b128 v3, a[36:39] offset:46080
 ds_write_b128 v3, a[16:19] offset:47104
 ds_write_b128 v3, a[20:23] offset:48128
 s_waitcnt lgkmcnt(0)
 v_accvgpr_write_b32 a80, v32
 v_accvgpr_write_b32 a81, v33
 v_accvgpr_write_b32 a82, v34
 v_accvgpr_write_b32 a83, v35
 v_accvgpr_write_b32 a84, v36
 v_accvgpr_write_b32 a85, v37
 v_accvgpr_write_b32 a86, v38
 v_accvgpr_write_b32 a87, v39
 v_accvgpr_write_b32 a72, v40
 v_accvgpr_write_b32 a73, v41
 v_accvgpr_write_b32 a74, v42
 v_accvgpr_write_b32 a75, v43
 v_accvgpr_write_b32 a76, v44
 v_accvgpr_write_b32 a77, v45
 v_accvgpr_write_b32 a78, v46
 v_accvgpr_write_b32 a79, v47
 v_accvgpr_write_b32 a32, v48
 v_accvgpr_write_b32 a33, v49
 v_accvgpr_write_b32 a34, v50
 v_accvgpr_write_b32 a35, v51
 v_accvgpr_write_b32 a36, v52
 v_accvgpr_write_b32 a37, v53
 v_accvgpr_write_b32 a38, v54
 v_accvgpr_write_b32 a39, v55
 v_accvgpr_write_b32 a16, v56
 v_accvgpr_write_b32 a17, v57
 v_accvgpr_write_b32 a18, v58
 v_accvgpr_write_b32 a19, v59
 v_accvgpr_write_b32 a20, v60
 v_accvgpr_write_b32 a21, v61
 v_accvgpr_write_b32 a22, v62
 v_accvgpr_write_b32 a23, v63
 v_lshlrev_b32 v5, 3, v0
 v_and_b32 v6, 0x1e0, v5
 v_and_b32 v7, 1, v0
 v_lshl_add_u32 v6, v7, 4, v6
 v_and_b32 v7, 2, v0
 v_lshl_add_u32 v6, v7, 2, v6
 v_bfe_u32 v4, v0, 2, 2
 v_lshrrev_b32 v7, 4, v0
 v_cmp_eq_u32 vcc, v4, v7
 v_and_b32 v7, 16, v1
 v_mov_b32 v5, 0x3f80
 v_lshlrev_b32 v7, v7, v5
 v_cndmask_b32 v4, 0, v7, vcc
 v_mov_b32 v5, 0
 s_lshl_b32 s59, s53, 16
 s_add_u32 s59, s59, 983040
 s_mul_i32 s15, s53, 327680
 s_add_u32 s15, s15, 225280
 s_lshl_b32 s3, s52, 6
 s_add_u32 s15, s15, s3
 s_add_u32 s64, s15, 8192
 s_add_u32 s65, s15, 172032
 s_lshr_b32 s14, s52, 4
 s_add_u32 s14, s14, 8
 s_bfe_u32 s15, s52, 0x20002
 s_and_b32 s16, s52, 3
 s_mov_b32 s84, 0x000f000f
 s_mov_b32 s85, 0
 s_lshl_b32 s57, s14, 10
 s_lshl_b32 s3, s15, 6
 s_add_u32 s57, s57, s3
 s_lshl_b32 s3, s16, 8
 s_add_u32 s57, s57, s3
 s_add_u32 s57, s57, s59
 s_add_u32 s59, s59, 6144
 s_add_u32 s16, s60, 3072
 s_waitcnt vmcnt(0) lgkmcnt(0)
 s_mov_b32 s96, s44
 s_and_b32 s97, s45, 0xffff
 s_mov_b32 s98, 256
 s_mov_b32 s99, 0x00020000
 v_mov_b32 v8, 132
 s_mov_b32 s51, 0
 s_mov_b64 exec, 1
L_wb_201:
 buffer_load_dword v9, v8, s[96:99], 0 offen sc1
 s_waitcnt vmcnt(0)
 v_cmp_eq_u32 vcc, 0, v9
 s_cbranch_vccz L_wbd_202
 s_sleep 2
 s_add_u32 s51, s51, 1
 s_cmp_lt_u32 s51, 131072
 s_cbranch_scc1 L_wb_201
 s_branch L_bail
L_wbd_202:
 s_mov_b64 exec, -1
 s_mov_b32 s96, s44
 s_and_b32 s97, s45, 0xffff
 s_mov_b32 s98, 256
 s_mov_b32 s99, 0x00020000
 v_mov_b32 v8, 212
 s_mov_b32 s51, 0
 s_mov_b64 exec, 1
L_wb_203:
 buffer_load_dword v9, v8, s[96:99], 0 offen sc1
 s_waitcnt vmcnt(0)
 v_cmp_eq_u32 vcc, 0, v9
 s_cbranch_vccz L_wbd_204
 s_sleep 2
 s_add_u32 s51, s51, 1
 s_cmp_lt_u32 s51, 131072
 s_cbranch_scc1 L_wb_203
 s_branch L_bail
L_wbd_204:
 s_mov_b64 exec, -1
 s_mov_b32 s96, s44
 s_and_b32 s97, s45, 0xffff
 s_mov_b32 s98, 256
 s_mov_b32 s99, 0x00020000
 v_lshlrev_b32 v8, 5, v0
 s_mov_b32 s51, 0
L_gl_205:
 buffer_load_dword v9, v8, s[96:99], 0 offen sc1
 s_waitcnt vmcnt(0)
 v_readlane_b32 s3, v9, s48
 s_mov_b32 s80, 0
 s_nop 2
 s_cmp_ge_u32 s3, 32
 s_cbranch_scc1 L_gld_206
 s_mov_b32 s80, 0
 v_readlane_b32 s3, v9, 0
 s_nop 3
 s_add_u32 s80, s80, s3
 v_readlane_b32 s3, v9, 1
 s_nop 3
 s_add_u32 s80, s80, s3
 v_readlane_b32 s3, v9, 2
 s_nop 3
 s_add_u32 s80, s80, s3
 v_readlane_b32 s3, v9, 3
 s_nop 3
 s_add_u32 s80, s80, s3
 v_readlane_b32 s3, v9, 4
 s_nop 3
 s_add_u32 s80, s80, s3
 v_readlane_b32 s3, v9, 5
 s_nop 3
 s_add_u32 s80, s80, s3
 v_readlane_b32 s3, v9, 6
 s_nop 3
 s_add_u32 s80, s80, s3
 v_readlane_b32 s3, v9, 7
 s_nop 3
 s_add_u32 s80, s80, s3
 s_cmp_ge_u32 s80, 256
 s_cbranch_scc1 L_gld_206
 s_sleep 4
 s_add_u32 s51, s51, 1
 s_cmp_lt_u32 s51, 131072
 s_cbranch_scc1 L_gl_205
 s_branch L_bail
L_gld_206:
 s_mov_b32 s51, 0
L_f0_207:
 v_mov_b32 v7, 0
 s_mov_b64 exec, 1
 buffer_atomic_add v7, off, s[4:7], s12 sc0
 s_mov_b64 exec, -1
 s_waitcnt vmcnt(0)
 v_readfirstlane_b32 s3, v7
 s_nop 3
 s_cmp_ge_u32 s3, 8
 s_cbranch_scc1 L_f0d_208
 s_sleep 8
 s_add_u32 s51, s51, 1
 s_cmp_lt_u32 s51, 131072
 s_cbranch_scc1 L_f0_207
 s_branch L_bail
L_f0d_208:
 s_add_u32 s12, s12, 4
 v_and_b32 v7, 2, v0
 v_mul_u32_u24 v7, 0x5555, v7
 v_add_u32 v0, 0x4444, v7
 s_mov_b32 m0, 2048
 s_waitcnt vmcnt(0) lgkmcnt(0)
 s_barrier
 buffer_load_dwordx4 v[32:35], v1, s[4:7], s63 offen offset:2048
 buffer_load_dwordx4 v[36:39], v1, s[4:7], s63 offen offset:3072
 buffer_load_dwordx4 v[40:43], v1, s[4:7], s81 offen offset:0
 buffer_load_dwordx4 v[44:47], v1, s[4:7], s81 offen offset:1024
 buffer_load_dwordx4 v[48:51], v1, s[4:7], s81 offen offset:2048
 buffer_load_dwordx4 v[52:55], v1, s[4:7], s81 offen offset:3072
 buffer_load_dwordx4 v[56:59], v1, s[4:7], s101 offen offset:0
 buffer_load_dwordx4 v[60:63], v1, s[4:7], s101 offen offset:1024
 ds_read_b128 v[8:11], v3 offset:49152
 ds_read_b128 v[12:15], v3 offset:49152
 ds_read_b128 v[16:19], v3 offset:49152
 ds_read_b128 v[20:23], v3 offset:49152
 s_waitcnt vmcnt(0) lgkmcnt(0)
 s_cmp_lg_u32 s80, 0
 s_cbranch_scc1 L_ch3_s
.p2align 6
L_ch3_f:
 s_mov_b32 s51, 0
L_pm_209:
 buffer_load_dwordx4 v[24:27], v1, s[4:7], s59 offen offset:0 sc1
 buffer_load_dwordx4 v[28:31], v1, s[4:7], s59 offen offset:1024 sc1
 s_add_u32 s3, s59, 3072
 buffer_load_dwordx4 v[12:15], v1, s[4:7], s3 offen offset:0 sc1
 s_waitcnt vmcnt(2)
 ds_write_b128 v1, v[24:27] offset:6144
 v_max_u32 v7, v24, v26
 s_waitcnt vmcnt(1)
 ds_write_b128 v1, v[28:31] offset:7168
 v_max3_u32 v7, v7, v28, v30
 s_waitcnt vmcnt(0)
 ds_write_b128 v1, v[12:15] offset:9216
 v_max3_u32 v7, v7, v12, v14
 v_cmp_eq_u32 vcc, -1, v7
 s_cbranch_vccnz L_rt_210
 ds_read_b128 v[12:15], v3 offset:49152
 v_smfmac_f32_16x16x64_bf16 v[16:19], v[24:27], v[32:39], v0
 ds_read_b128 v[32:35], v1 offset:30720
 ds_read_b128 v[36:39], v1 offset:31744
 v_smfmac_f32_16x16x64_bf16 v[20:23], v[24:27], v[40:47], v0
 ds_read_b128 v[40:43], v1 offset:28672
 ds_read_b128 v[44:47], v1 offset:29696
 v_smfmac_f32_16x16x64_bf16 v[16:19], v[28:31], v[48:55], v0
 v_smfmac_f32_16x16x64_bf16 v[20:23], v[28:31], v[56:63], v0
 s_waitcnt lgkmcnt(5)
 s_barrier
 buffer_load_dwordx4 v[56:59], v1, s[4:7], s63 offen offset:0
 v_smfmac_f32_16x16x64_bf16 v[8:11], v[24:27], a[136:143], v0
 s_waitcnt lgkmcnt(4)
 v_smfmac_f32_16x16x64_bf16 v[12:15], v[24:27], a[128:135], v0
 ds_read_b128 v[24:27], v1 offset:9216
 buffer_load_dwordx4 v[60:63], v1, s[4:7], s63 offen offset:1024
 v_smfmac_f32_16x16x64_bf16 v[8:11], v[28:31], a[120:127], v0
 v_smfmac_f32_16x16x64_bf16 v[12:15], v[28:31], a[88:95], v0
 ds_read_b128 v[28:31], v1 offset:0
 buffer_load_dwordx4 v[48:51], v1, s[4:7], s101 offen offset:2048
 s_waitcnt lgkmcnt(1)
 v_smfmac_f32_16x16x64_bf16 v[16:19], v[24:27], v[32:39], v0
 ds_read_b128 v[32:35], v2 offset:30720
 ds_read_b128 v[36:39], v2 offset:31744
 v_smfmac_f32_16x16x64_bf16 v[8:11], v[24:27], a[32:39], v0
 buffer_load_dwordx4 v[52:55], v1, s[4:7], s101 offen offset:3072
 v_smfmac_f32_16x16x64_bf16 v[12:15], v[24:27], a[16:23], v0
 v_smfmac_f32_16x16x64_bf16 v[20:23], v[24:27], v[40:47], v0
 ds_read_b128 v[40:43], v2 offset:28672
 ds_read_b128 v[44:47], v2 offset:29696
 ds_read_b128 v[24:27], v1 offset:1024
 s_waitcnt lgkmcnt(5)
 v_smfmac_f32_16x16x64_bf16 v[8:11], v[28:31], v[240:247], v0
 v_smfmac_f32_16x16x64_bf16 v[12:15], v[28:31], v[248:255], v0
 s_waitcnt lgkmcnt(3)
 v_smfmac_f32_16x16x64_bf16 v[16:19], v[28:31], v[32:39], v0
 ds_read_b128 v[32:35], v2 offset:26624
 ds_read_b128 v[36:39], v2 offset:27648
 v_smfmac_f32_16x16x64_bf16 v[20:23], v[28:31], v[136:143], v0
 ds_read_b128 v[28:31], v1 offset:2048
 s_waitcnt lgkmcnt(3)
 v_smfmac_f32_16x16x64_bf16 v[8:11], v[24:27], v[232:239], v0
 v_smfmac_f32_16x16x64_bf16 v[16:19], v[24:27], v[40:47], v0
 ds_read_b128 v[40:43], v2 offset:24576
 ds_read_b128 v[44:47], v2 offset:25600
 v_smfmac_f32_16x16x64_bf16 v[12:15], v[24:27], v[224:231], v0
 v_smfmac_f32_16x16x64_bf16 v[20:23], v[24:27], v[152:159], v0
 ds_read_b128 v[24:27], v1 offset:3072
 s_waitcnt lgkmcnt(3)
 v_smfmac_f32_16x16x64_bf16 v[16:19], v[28:31], v[32:39], v0
 ds_read_b128 v[32:35], v1 offset:63488
 ds_read_b128 v[36:39], v1 offset:64512
 v_smfmac_f32_16x16x64_bf16 v[8:11], v[28:31], v[208:215], v0
 v_smfmac_f32_16x16x64_bf16 v[12:15], v[28:31], v[200:207], v0
 s_waitcnt lgkmcnt(3)
 v_smfmac_f32_16x16x64_bf16 v[20:23], v[28:31], v[40:47], v0
 ds_read_b128 v[40:43], v1 offset:61440
 ds_read_b128 v[44:47], v1 offset:62464
 ds_read_b128 v[28:31], v1 offset:4096
 s_waitcnt lgkmcnt(5)
 v_smfmac_f32_16x16x64_bf16 v[8:11], v[24:27], v[184:191], v0
 v_smfmac_f32_16x16x64_bf16 v[12:15], v[24:27], v[176:183], v0
 s_waitcnt lgkmcnt(3)
 v_smfmac_f32_16x16x64_bf16 v[16:19], v[24:27], v[32:39], v0
 ds_read_b128 v[32:35], v1 offset:59392
 ds_read_b128 v[36:39], v1 offset:60416
 s_waitcnt vmcnt(2)
 v_smfmac_f32_16x16x64_bf16 v[20:23], v[24:27], v[56:63], v0
 ds_read_b128 v[24:27], v1 offset:5120
 buffer_load_dwordx4 v[56:59], v1, s[4:7], s61 offen offset:3072 sc1 nt
 s_waitcnt lgkmcnt(3)
 v_smfmac_f32_16x16x64_bf16 v[8:11], v[28:31], v[168:175], v0
 v_smfmac_f32_16x16x64_bf16 v[16:19], v[28:31], v[40:47], v0
 ds_read_b128 v[40:43], v1 offset:57344
 ds_read_b128 v[44:47], v1 offset:58368
 s_add_u32 s3, s61, 4096
 buffer_load_dwordx4 v[60:63], v1, s[4:7], s3 offen offset:3072 sc1 nt
 v_smfmac_f32_16x16x64_bf16 v[12:15], v[28:31], v[160:167], v0
 v_smfmac_f32_16x16x64_bf16 v[20:23], v[28:31], v[192:199], v0
 ds_read_b128 v[28:31], v1 offset:8192
 s_waitcnt lgkmcnt(3)
 v_smfmac_f32_16x16x64_bf16 v[16:19], v[24:27], v[32:39], v0
 v_smfmac_f32_16x16x64_bf16 v[8:11], v[24:27], v[144:151], v0
 s_add_u32 s3, s61, 67115008
 buffer_load_dwordx4 v[32:35], v1, s[4:7], s3 offen offset:0 sc1 nt
 v_smfmac_f32_16x16x64_bf16 v[12:15], v[24:27], v[128:135], v0
 s_waitcnt lgkmcnt(1)
 v_smfmac_f32_16x16x64_bf16 v[20:23], v[24:27], v[40:47], v0
 ds_read_b128 v[40:43], v3 offset:49152
 ds_read_b128 v[44:47], v3 offset:49152
 buffer_load_dwordx4 v[36:39], v1, s[4:7], s3 offen offset:1024 sc1 nt
 s_waitcnt lgkmcnt(2)
 v_smfmac_f32_16x16x64_bf16 v[8:11], v[28:31], a[80:87], v0
 v_smfmac_f32_16x16x64_bf16 v[12:15], v[28:31], a[72:79], v0
 v_smfmac_f32_16x16x64_bf16 v[16:19], v[28:31], v[216:223], v0
 s_waitcnt vmcnt(4)
 v_smfmac_f32_16x16x64_bf16 v[20:23], v[28:31], v[48:55], v0
 ds_read_b128 v[52:55], v1 offset:0
 v_add_f32 v8, v8, v10
 v_add_f32 v11, v9, v11
 v_cvt_pk_bf16_f32 v9, v8, v11
 v_cvt_pk_bf16_f32 v8, v8, v11
 v_add_f32 v12, v12, v14
 v_add_f32 v15, v13, v15
 v_cvt_pk_bf16_f32 v13, v12, v15
 v_cvt_pk_bf16_f32 v12, v12, v15
 v_mfma_f32_16x16x16_bf16 v[8:11], v[8:9], v[4:5], 0
 v_mfma_f32_16x16x16_bf16 v[12:15], v[12:13], v[4:5], 0
 v_add_f32 v16, v16, v18
 v_add_f32 v19, v17, v19
 v_cvt_pk_bf16_f32 v17, v16, v19
 v_cvt_pk_bf16_f32 v16, v16, v19
 v_add_f32 v20, v20, v22
 v_add_f32 v23, v21, v23
 v_cvt_pk_bf16_f32 v21, v20, v23
 v_cvt_pk_bf16_f32 v20, v20, v23
 v_mfma_f32_16x16x16_bf16 v[16:19], v[16:17], v[4:5], 0
 v_mfma_f32_16x16x16_bf16 v[20:23], v[20:21], v[4:5], 0
 s_waitcnt lgkmcnt(2)
 v_smfmac_f32_16x16x64_bf16 v[40:43], v[24:27], a[240:247], v0
 s_waitcnt lgkmcnt(1)
 v_smfmac_f32_16x16x64_bf16 v[44:47], v[24:27], a[248:255], v0
 ds_read_b128 v[24:27], v1 offset:1024
 v_cvt_pk_bf16_f32 v15, v14, v15
 v_cvt_pk_bf16_f32 v14, v12, v13
 v_cvt_pk_bf16_f32 v13, v10, v11
 v_cvt_pk_bf16_f32 v12, v8, v9
 s_waitcnt vmcnt(3)
 s_nop 0
 v_mfma_f32_16x16x32_bf16 v[8:11], v[56:59], v[12:15], 0
 v_cvt_pk_bf16_f32 v23, v22, v23
 v_cvt_pk_bf16_f32 v22, v20, v21
 v_cvt_pk_bf16_f32 v21, v18, v19
 v_cvt_pk_bf16_f32 v20, v16, v17
 s_waitcnt vmcnt(2)
 v_mfma_f32_16x16x32_bf16 v[16:19], v[60:63], v[12:15], 0
 v_mfma_f32_16x16x32_bf16 v[48:51], v[20:23], v[12:15], 0
 v_smfmac_f32_16x16x64_bf16 v[40:43], v[28:31], v[96:103], v0
 v_smfmac_f32_16x16x64_bf16 v[44:47], v[28:31], v[104:111], v0
 ds_read_b128 v[28:31], v1 offset:2048
 s_waitcnt lgkmcnt(2)
 v_smfmac_f32_16x16x64_bf16 v[40:43], v[52:55], a[160:167], v0
 v_cndmask_b32 v8, v8, v16, s[70:71]
 v_cndmask_b32 v9, v9, v17, s[70:71]
 v_cndmask_b32 v10, v10, v18, s[70:71]
 v_cndmask_b32 v11, v11, v19, s[70:71]
 ds_write_b128 v1, v[8:11] offset:13312
 ds_write_b64 v1, v[48:49] offset:15368
 v_smfmac_f32_16x16x64_bf16 v[44:47], v[52:55], a[168:175], v0
 ds_read_b128 v[52:55], v1 offset:3072
 s_waitcnt lgkmcnt(4)
 v_smfmac_f32_16x16x64_bf16 v[40:43], v[24:27], a[176:183], v0
 v_smfmac_f32_16x16x64_bf16 v[44:47], v[24:27], a[184:191], v0
 ds_read_b128 v[24:27], v1 offset:4096
 s_waitcnt lgkmcnt(4)
 v_smfmac_f32_16x16x64_bf16 v[40:43], v[28:31], a[192:199], v0
 v_smfmac_f32_16x16x64_bf16 v[44:47], v[28:31], a[200:207], v0
 ds_read_b128 v[28:31], v1 offset:6144
 s_waitcnt lgkmcnt(2)
 v_smfmac_f32_16x16x64_bf16 v[40:43], v[52:55], a[208:215], v0
 v_smfmac_f32_16x16x64_bf16 v[44:47], v[52:55], a[216:223], v0
 ds_read_b128 v[52:55], v1 offset:7168
 s_barrier
 ds_read_b128 v[56:59], v1 offset:10240
 ds_read_b128 v[60:63], v1 offset:11264
 ds_read_b128 v[16:19], v1 offset:12288
 ds_read_b128 v[12:15], v1 offset:14336
 ds_read_b128 v[48:51], v1 offset:15360
 s_waitcnt lgkmcnt(7)
 v_smfmac_f32_16x16x64_bf16 v[40:43], v[24:27], a[224:231], v0
 s_mov_b64 exec, s[68:69]
 buffer_store_dwordx4 v[20:23], v6, s[4:7], s62 offen offset:1536 sc1
 s_mov_b64 exec, -1
 v_smfmac_f32_16x16x64_bf16 v[44:47], v[24:27], a[232:239], v0
 ds_read_b128 v[24:27], v1 offset:9216
 v_mov_b32 v7, 0
 s_waitcnt lgkmcnt(7)
 v_smfmac_f32_16x16x64_bf16 v[40:43], v[28:31], v[64:71], v0
 s_mov_b64 exec, 1
 buffer_atomic_add v7, off, s[4:7], s12 sc0
 s_mov_b64 exec, 2
 buffer_atomic_add v7, off, s[4:7], s13 sc0
 s_mov_b64 exec, -1
 v_smfmac_f32_16x16x64_bf16 v[44:47], v[28:31], v[72:79], v0
 s_waitcnt lgkmcnt(6)
 v_smfmac_f32_16x16x64_bf16 v[40:43], v[52:55], v[80:87], v0
 v_smfmac_f32_16x16x64_bf16 v[44:47], v[52:55], v[88:95], v0
 s_waitcnt lgkmcnt(0)
 v_smfmac_f32_16x16x64_bf16 v[40:43], v[24:27], v[112:119], v0
 v_smfmac_f32_16x16x64_bf16 v[44:47], v[24:27], v[120:127], v0
 v_pk_add_f32 v[8:9], v[8:9], v[56:57]
 v_pk_add_f32 v[10:11], v[10:11], v[58:59]
 v_pk_add_f32 v[60:61], v[60:61], v[16:17]
 v_pk_add_f32 v[62:63], v[62:63], v[18:19]
 v_pk_add_f32 v[12:13], v[12:13], v[14:15]
 v_pk_add_f32 v[48:49], v[48:49], v[50:51]
 v_pk_add_f32 v[8:9], v[8:9], v[60:61]
 v_pk_add_f32 v[10:11], v[10:11], v[62:63]
 v_pk_add_f32 v[48:49], v[12:13], v[48:49]
 v_max3_f32 v50, v8, v9, v10
 v_max3_f32 v50, v50, v11, v48
 v_max_f32 v50, v50, v49
 v_add_f32 v40, v40, v42
 v_add_f32 v41, v41, v43
 v_max_f32_dpp v50, v50, v50 quad_perm:[2,3,0,1] row_mask:0xf bank_mask:0xf
 v_mov_b32 v51, v50
 v_add_f32 v44, v44, v46
 v_add_f32 v45, v45, v47
 v_permlane16_swap_b32 v50, v51
 v_max_f32 v50, v50, v51
 v_mov_b32 v51, v50
 v_cvt_pk_bf16_f32 v40, v40, v41
 v_cvt_pk_bf16_f32 v41, v44, v45
 v_permlane32_swap_b32 v50, v51
 v_max_f32 v50, v50, v51
 v_mul_f32 v50, s56, v50
 v_fma_f32 v48, v48, s56, -v50
 v_fma_f32 v49, v49, s56, -v50
 v_fma_f32 v8, v8, s56, -v50
 v_fma_f32 v9, v9, s56, -v50
 v_fma_f32 v10, v10, s56, -v50
 v_fma_f32 v11, v11, s56, -v50
 v_exp_f32 v48, v48
 v_lshrrev_b32 v51, 1, v1
 v_exp_f32 v49, v49
 ds_read_b128 v[56:59], v3 offset:14336
 ds_read_b128 v[60:63], v3 offset:15360
 v_exp_f32 v8, v8
 v_exp_f32 v9, v9
 ds_read_b128 v[24:27], v3 offset:12288
 ds_read_b128 v[28:31], v3 offset:13312
 v_exp_f32 v10, v10
 buffer_store_dwordx2 v[40:41], v51, s[4:7], s62 offen offset:3584 sc1
 v_exp_f32 v11, v11
 v_cvt_pk_bf16_f32 v14, v48, v49
 v_cvt_pk_bf16_f32 v12, v8, v9
 v_cvt_pk_bf16_f32 v13, v10, v11
 v_cndmask_b32 v52, 0, v14, s[68:69]
 v_cndmask_b32 v53, 0, v14, s[70:71]
 v_cndmask_b32 v22, 0, v12, s[70:71]
 v_cndmask_b32 v23, 0, v13, s[70:71]
 v_mfma_f32_16x16x16_bf16 v[44:47], v[40:41], v[52:53], 0
 v_cndmask_b32 v16, 0, v12, s[68:69]
 v_cndmask_b32 v17, 0, v13, s[68:69]
 v_mov_b32_dpp v18, v22 quad_perm:[2,3,0,1] row_mask:0xf bank_mask:0xf
 v_mov_b32_dpp v19, v23 quad_perm:[2,3,0,1] row_mask:0xf bank_mask:0xf
 v_mov_b32_dpp v20, v16 quad_perm:[2,3,0,1] row_mask:0xf bank_mask:0xf
 v_mov_b32_dpp v21, v17 quad_perm:[2,3,0,1] row_mask:0xf bank_mask:0xf
 s_waitcnt vmcnt(5)
 v_mfma_f32_16x16x32_bf16 v[44:47], v[32:35], v[16:19], v[44:47]
 v_add_f32 v54, v8, v9
 v_add_f32 v55, v48, v49
 s_waitcnt vmcnt(4)
 v_mfma_f32_16x16x32_bf16 v[44:47], v[36:39], v[20:23], v[44:47]
 v_add_f32 v54, v54, v10
 v_fma_f32 v55, v55, 0.5, v11
 v_add_f32 v54, v54, v55
 ds_read_b128 v[16:19], v3 offset:49152
 ds_read_b128 v[20:23], v3 offset:49152
 v_add_f32_dpp v54, v54, v54 quad_perm:[2,3,0,1] row_mask:0xf bank_mask:0xf
 v_mov_b32 v55, v54
 ds_read_b128 v[32:35], v3 offset:49152
 ds_read_b128 v[36:39], v3 offset:49152
 v_permlane16_swap_b32 v54, v55
 v_add_f32 v54, v54, v55
 v_mov_b32 v55, v54
 ds_read_b128 v[8:11], v3 offset:49152
 s_cmp_eq_u32 s54, 63
 v_permlane32_swap_b32 v54, v55
 v_add_f32 v54, v54, v55
 v_rcp_f32 v54, v54
 s_cbranch_scc1 L_ch3_end
 v_mul_f32 v44, v44, v54
 v_mul_f32 v45, v45, v54
 v_cvt_pk_bf16_f32 v42, v44, v45
 v_mul_f32 v46, v46, v54
 v_mul_f32 v47, v47, v54
 v_cvt_pk_bf16_f32 v43, v46, v47
 ds_write_b64 v6, v[42:43] offset:1536
 v_and_b32 v40, -9, v6
 v_mov_b32_dpp v12, v42 quad_perm:[0,1,0,1] row_mask:0xf bank_mask:0xf
 v_mov_b32_dpp v14, v42 quad_perm:[2,3,2,3] row_mask:0xf bank_mask:0xf
 v_mov_b32_dpp v13, v43 quad_perm:[0,1,0,1] row_mask:0xf bank_mask:0xf
 v_mov_b32_dpp v15, v43 quad_perm:[2,3,2,3] row_mask:0xf bank_mask:0xf
 s_waitcnt lgkmcnt(5)
 s_nop 0
 v_smfmac_f32_16x16x64_bf16 v[16:19], v[12:15], a[24:31], v0
 s_waitcnt lgkmcnt(4)
 v_smfmac_f32_16x16x64_bf16 v[20:23], v[12:15], a[56:63], v0
 s_waitcnt lgkmcnt(0)
 s_barrier
 ds_read_b128 v[48:51], v40 offset:0
 ds_read_b128 v[52:55], v40 offset:512
 ds_read_b128 v[44:47], v40 offset:1024
 v_smfmac_f32_16x16x64_bf16 v[32:35], v[12:15], v[56:63], v0
 ds_read_b128 v[56:59], v3 offset:47104
 ds_read_b128 v[60:63], v3 offset:48128
 s_mov_b32 m0, 6144
 v_smfmac_f32_16x16x64_bf16 v[36:39], v[12:15], v[24:31], v0
 ds_read_b128 v[24:27], v3 offset:45056
 ds_read_b128 v[28:31], v3 offset:46080
 buffer_load_dwordx4 v1, s[4:7], s81 offen offset:0 lds
 v_smfmac_f32_16x16x64_bf16 v[8:11], v[12:15], a[152:159], v0
 s_mov_b32 m0, 6144
 s_waitcnt lgkmcnt(6)
 v_smfmac_f32_16x16x64_bf16 v[16:19], v[48:51], a[0:7], v0
 buffer_load_dwordx4 v1, s[4:7], s81 offen offset:1024 lds
 s_waitcnt lgkmcnt(5)
 v_smfmac_f32_16x16x64_bf16 v[16:19], v[52:55], a[8:15], v0
 s_mov_b32 m0, 7168
 s_waitcnt lgkmcnt(2)
 v_smfmac_f32_16x16x64_bf16 v[16:19], v[44:47], v[56:63], v0
 ds_read_b128 v[56:59], v3 offset:43008
 ds_read_b128 v[60:63], v3 offset:44032
 buffer_load_dwordx4 v1, s[4:7], s81 offen offset:2048 lds
 s_waitcnt lgkmcnt(2)
 v_smfmac_f32_16x16x64_bf16 v[20:23], v[48:51], v[24:31], v0
 ds_read_b128 v[24:27], v3 offset:40960
 ds_read_b128 v[28:31], v3 offset:41984
 v_smfmac_f32_16x16x64_bf16 v[20:23], v[52:55], a[40:47], v0
 v_smfmac_f32_16x16x64_bf16 v[20:23], v[44:47], a[48:55], v0
 v_cvt_pk_bf16_f32 v16, v16, v17
 v_smfmac_f32_16x16x64_bf16 v[32:35], v[48:51], a[64:71], v0
 v_cvt_pk_bf16_f32 v17, v18, v19
 s_waitcnt lgkmcnt(2)
 v_smfmac_f32_16x16x64_bf16 v[32:35], v[52:55], v[56:63], v0
 ds_read_b128 v[56:59], v3 offset:10240
 ds_read_b128 v[60:63], v3 offset:11264
 v_and_or_b32 v16, v16, -2, s55
 s_waitcnt lgkmcnt(2)
 v_smfmac_f32_16x16x64_bf16 v[32:35], v[44:47], v[24:31], v0
 ds_read_b128 v[24:27], v3 offset:8192
 ds_read_b128 v[28:31], v3 offset:9216
 v_cvt_pk_bf16_f32 v18, v20, v21
 v_smfmac_f32_16x16x64_bf16 v[36:39], v[48:51], a[96:103], v0
 v_cvt_pk_bf16_f32 v19, v22, v23
 v_smfmac_f32_16x16x64_bf16 v[36:39], v[52:55], a[104:111], v0
 v_and_or_b32 v18, v18, -2, s55
 buffer_store_dwordx4 v[16:19], v1, s[4:7], s60 offen offset:0
 v_smfmac_f32_16x16x64_bf16 v[36:39], v[44:47], a[112:119], v0
 v_cvt_pk_bf16_f32 v32, v32, v33
 s_waitcnt lgkmcnt(2)
 v_smfmac_f32_16x16x64_bf16 v[8:11], v[48:51], v[56:63], v0
 v_cvt_pk_bf16_f32 v33, v34, v35
 s_waitcnt lgkmcnt(0)
 v_smfmac_f32_16x16x64_bf16 v[8:11], v[52:55], v[24:31], v0
 v_and_or_b32 v32, v32, -2, s55
 v_smfmac_f32_16x16x64_bf16 v[8:11], v[44:47], a[144:151], v0
 v_cvt_pk_bf16_f32 v34, v36, v37
 v_cvt_pk_bf16_f32 v35, v38, v39
 v_and_or_b32 v34, v34, -2, s55
 buffer_store_dwordx4 v[32:35], v1, s[4:7], s60 offen offset:1024
 s_nop 3
 v_cvt_pk_bf16_f32 v8, v8, v9
 v_cvt_pk_bf16_f32 v9, v10, v11
 v_and_or_b32 v8, v8, -2, s55
 buffer_store_dwordx2 v[8:9], v1, s[4:7], s16 offen offset:8
 buffer_load_dwordx4 v[32:35], v1, s[4:7], s63 offen offset:2048
 buffer_load_dwordx4 v[36:39], v1, s[4:7], s63 offen offset:3072
 s_add_u32 s54, s54, 1
 s_add_u32 s61, s61, 524288
 s_and_b32 s3, s54, 7
 s_cselect_b32 s3, 1, -7
 s_lshl_b32 s3, s3, 17
 s_add_u32 s62, s62, s3
 s_and_b32 s3, s54, 3
 s_cselect_b32 s3, 1, -3
 s_lshl_b32 s3, s3, 14
 s_add_u32 s57, s57, s3
 s_add_u32 s59, s59, s3
 s_xor_b32 s58, s57, 32768
 s_mov_b32 s51, 0
L_fl_211:
 s_waitcnt vmcnt(9)
 v_readlane_b32 s14, v7, 0
 v_readlane_b32 s15, v7, 1
 s_nop 3
 s_cmp_lt_u32 s14, 8
 s_cbranch_scc1 L_fr_212
 s_add_u32 s15, s15, 8
 s_cmp_le_u32 s15, s54
 s_cbranch_scc1 L_fr_212
 s_add_u32 s12, s12, 4
 s_nop 15
 s_nop 15
 s_nop 15
 s_nop 15
 s_nop 15
 s_nop 15
 s_nop 15
 s_nop 15
 s_nop 15
 s_nop 15
 s_nop 15
 s_nop 15
 s_nop 15
 s_nop 11
 s_xor_b32 s55, s55, 1
 s_waitcnt vmcnt(5)
 ds_read_b128 v[40:43], v1 offset:6144
 ds_read_b128 v[44:47], v1 offset:7168
 ds_read_b128 v[48:51], v1 offset:9216
 buffer_load_dwordx4 v[52:55], v1, s[4:7], s81 offen offset:3072
 buffer_load_dwordx4 v[56:59], v1, s[4:7], s101 offen offset:0
 buffer_load_dwordx4 v[60:63], v1, s[4:7], s101 offen offset:1024
 ds_read_b128 v[8:11], v3 offset:49152
 ds_read_b128 v[16:19], v3 offset:49152
 ds_read_b128 v[20:23], v3 offset:49152
 s_waitcnt lgkmcnt(0)
 s_nop 15
 s_nop 15
 s_nop 7
 s_branch L_ch3_f
L_rt_210:
 s_add_u32 s51, s51, 1
 s_cmp_lt_u32 s51, 131072
 s_cbranch_scc1 L_pm_209
 s_branch L_bail
L_fr_212:
 s_sleep 4
 v_mov_b32 v7, 0
 s_mov_b64 exec, 1
 buffer_atomic_add v7, off, s[4:7], s12 sc0
 s_mov_b64 exec, 2
 buffer_atomic_add v7, off, s[4:7], s13 sc0
 s_mov_b64 exec, -1
 s_waitcnt vmcnt(0)
 s_add_u32 s51, s51, 1
 s_cmp_lt_u32 s51, 131072
 s_cbranch_scc1 L_fl_211
 s_branch L_bail
.p2align 6
L_ch3_s:
 s_mov_b32 s51, 0
L_pm_213:
 buffer_load_dwordx4 v[24:27], v1, s[4:7], s59 offen offset:0 sc1
 buffer_load_dwordx4 v[28:31], v1, s[4:7], s59 offen offset:1024 sc1
 s_add_u32 s3, s59, 3072
 buffer_load_dwordx4 v[12:15], v1, s[4:7], s3 offen offset:0 sc1
 s_waitcnt vmcnt(2)
 ds_write_b128 v1, v[24:27] offset:6144
 v_max_u32 v7, v24, v26
 s_waitcnt vmcnt(1)
 ds_write_b128 v1, v[28:31] offset:7168
 v_max3_u32 v7, v7, v28, v30
 s_waitcnt vmcnt(0)
 ds_write_b128 v1, v[12:15] offset:9216
 v_max3_u32 v7, v7, v12, v14
 v_cmp_eq_u32 vcc, -1, v7
 s_cbranch_vccnz L_rt_214
 ds_read_b128 v[12:15], v3 offset:49152
 v_smfmac_f32_16x16x64_bf16 v[16:19], v[24:27], v[32:39], v0
 ds_read_b128 v[32:35], v1 offset:30720
 ds_read_b128 v[36:39], v1 offset:31744
 v_smfmac_f32_16x16x64_bf16 v[20:23], v[24:27], v[40:47], v0
 ds_read_b128 v[40:43], v1 offset:28672
 ds_read_b128 v[44:47], v1 offset:29696
 v_smfmac_f32_16x16x64_bf16 v[16:19], v[28:31], v[48:55], v0
 v_smfmac_f32_16x16x64_bf16 v[20:23], v[28:31], v[56:63], v0
 s_waitcnt lgkmcnt(5)
 s_barrier
 buffer_load_dwordx4 v[56:59], v1, s[4:7], s63 offen offset:0
 v_smfmac_f32_16x16x64_bf16 v[8:11], v[24:27], a[136:143], v0
 s_waitcnt lgkmcnt(4)
 v_smfmac_f32_16x16x64_bf16 v[12:15], v[24:27], a[128:135], v0
 ds_read_b128 v[24:27], v1 offset:9216
 buffer_load_dwordx4 v[60:63], v1, s[4:7], s63 offen offset:1024
 v_smfmac_f32_16x16x64_bf16 v[8:11], v[28:31], a[120:127], v0
 v_smfmac_f32_16x16x64_bf16 v[12:15], v[28:31], a[88:95], v0
 ds_read_b128 v[28:31], v1 offset:0
 buffer_load_dwordx4 v[48:51], v1, s[4:7], s101 offen offset:2048
 s_waitcnt lgkmcnt(1)
 v_smfmac_f32_16x16x64_bf16 v[16:19], v[24:27], v[32:39], v0
 ds_read_b128 v[32:35], v2 offset:30720
 ds_read_b128 v[36:39], v2 offset:31744
 v_smfmac_f32_16x16x64_bf16 v[8:11], v[24:27], a[32:39], v0
 buffer_load_dwordx4 v[52:55], v1, s[4:7], s101 offen offset:3072
 v_smfmac_f32_16x16x64_bf16 v[12:15], v[24:27], a[16:23], v0
 v_smfmac_f32_16x16x64_bf16 v[20:23], v[24:27], v[40:47], v0
 ds_read_b128 v[40:43], v2 offset:28672
 ds_read_b128 v[44:47], v2 offset:29696
 ds_read_b128 v[24:27], v1 offset:1024
 s_waitcnt lgkmcnt(5)
 v_smfmac_f32_16x16x64_bf16 v[8:11], v[28:31], v[240:247], v0
 v_smfmac_f32_16x16x64_bf16 v[12:15], v[28:31], v[248:255], v0
 s_waitcnt lgkmcnt(3)
 v_smfmac_f32_16x16x64_bf16 v[16:19], v[28:31], v[32:39], v0
 ds_read_b128 v[32:35], v2 offset:26624
 ds_read_b128 v[36:39], v2 offset:27648
 v_smfmac_f32_16x16x64_bf16 v[20:23], v[28:31], v[136:143], v0
 ds_read_b128 v[28:31], v1 offset:2048
 s_waitcnt lgkmcnt(3)
 v_smfmac_f32_16x16x64_bf16 v[8:11], v[24:27], v[232:239], v0
 v_smfmac_f32_16x16x64_bf16 v[16:19], v[24:27], v[40:47], v0
 ds_read_b128 v[40:43], v2 offset:24576
 ds_read_b128 v[44:47], v2 offset:25600
 v_smfmac_f32_16x16x64_bf16 v[12:15], v[24:27], v[224:231], v0
 v_smfmac_f32_16x16x64_bf16 v[20:23], v[24:27], v[152:159], v0
 ds_read_b128 v[24:27], v1 offset:3072
 s_waitcnt lgkmcnt(3)
 v_smfmac_f32_16x16x64_bf16 v[16:19], v[28:31], v[32:39], v0
 ds_read_b128 v[32:35], v1 offset:63488
 ds_read_b128 v[36:39], v1 offset:64512
 v_smfmac_f32_16x16x64_bf16 v[8:11], v[28:31], v[208:215], v0
 v_smfmac_f32_16x16x64_bf16 v[12:15], v[28:31], v[200:207], v0
 s_waitcnt lgkmcnt(3)
 v_smfmac_f32_16x16x64_bf16 v[20:23], v[28:31], v[40:47], v0
 ds_read_b128 v[40:43], v1 offset:61440
 ds_read_b128 v[44:47], v1 offset:62464
 ds_read_b128 v[28:31], v1 offset:4096
 s_waitcnt lgkmcnt(5)
 v_smfmac_f32_16x16x64_bf16 v[8:11], v[24:27], v[184:191], v0
 v_smfmac_f32_16x16x64_bf16 v[12:15], v[24:27], v[176:183], v0
 s_waitcnt lgkmcnt(3)
 v_smfmac_f32_16x16x64_bf16 v[16:19], v[24:27], v[32:39], v0
 ds_read_b128 v[32:35], v1 offset:59392
 ds_read_b128 v[36:39], v1 offset:60416
 s_waitcnt vmcnt(2)
 v_smfmac_f32_16x16x64_bf16 v[20:23], v[24:27], v[56:63], v0
 ds_read_b128 v[24:27], v1 offset:5120
 buffer_load_dwordx4 v[56:59], v1, s[4:7], s61 offen offset:3072 sc1 nt
 s_waitcnt lgkmcnt(3)
 v_smfmac_f32_16x16x64_bf16 v[8:11], v[28:31], v[168:175], v0
 v_smfmac_f32_16x16x64_bf16 v[16:19], v[28:31], v[40:47], v0
 ds_read_b128 v[40:43], v1 offset:57344
 ds_read_b128 v[44:47], v1 offset:58368
 s_add_u32 s3, s61, 4096
 buffer_load_dwordx4 v[60:63], v1, s[4:7], s3 offen offset:3072 sc1 nt
 v_smfmac_f32_16x16x64_bf16 v[12:15], v[28:31], v[160:167], v0
 v_smfmac_f32_16x16x64_bf16 v[20:23], v[28:31], v[192:199], v0
 ds_read_b128 v[28:31], v1 offset:8192
 s_waitcnt lgkmcnt(3)
 v_smfmac_f32_16x16x64_bf16 v[16:19], v[24:27], v[32:39], v0
 v_smfmac_f32_16x16x64_bf16 v[8:11], v[24:27], v[144:151], v0
 s_add_u32 s3, s61, 67115008
 buffer_load_dwordx4 v[32:35], v1, s[4:7], s3 offen offset:0 sc1 nt
 v_smfmac_f32_16x16x64_bf16 v[12:15], v[24:27], v[128:135], v0
 s_waitcnt lgkmcnt(1)
 v_smfmac_f32_16x16x64_bf16 v[20:23], v[24:27], v[40:47], v0
 ds_read_b128 v[40:43], v3 offset:49152
 ds_read_b128 v[44:47], v3 offset:49152
 buffer_load_dwordx4 v[36:39], v1, s[4:7], s3 offen offset:1024 sc1 nt
 s_waitcnt lgkmcnt(2)
 v_smfmac_f32_16x16x64_bf16 v[8:11], v[28:31], a[80:87], v0
 v_smfmac_f32_16x16x64_bf16 v[12:15], v[28:31], a[72:79], v0
 v_smfmac_f32_16x16x64_bf16 v[16:19], v[28:31], v[216:223], v0
 s_waitcnt vmcnt(4)
 v_smfmac_f32_16x16x64_bf16 v[20:23], v[28:31], v[48:55], v0
 ds_read_b128 v[52:55], v1 offset:0
 v_add_f32 v8, v8, v10
 v_add_f32 v11, v9, v11
 v_cvt_pk_bf16_f32 v9, v8, v11
 v_cvt_pk_bf16_f32 v8, v8, v11
 v_add_f32 v12, v12, v14
 v_add_f32 v15, v13, v15
 v_cvt_pk_bf16_f32 v13, v12, v15
 v_cvt_pk_bf16_f32 v12, v12, v15
 v_mfma_f32_16x16x16_bf16 v[8:11], v[8:9], v[4:5], 0
 v_mfma_f32_16x16x16_bf16 v[12:15], v[12:13], v[4:5], 0
 v_add_f32 v16, v16, v18
 v_add_f32 v19, v17, v19
 v_cvt_pk_bf16_f32 v17, v16, v19
 v_cvt_pk_bf16_f32 v16, v16, v19
 v_add_f32 v20, v20, v22
 v_add_f32 v23, v21, v23
 v_cvt_pk_bf16_f32 v21, v20, v23
 v_cvt_pk_bf16_f32 v20, v20, v23
 v_mfma_f32_16x16x16_bf16 v[16:19], v[16:17], v[4:5], 0
 v_mfma_f32_16x16x16_bf16 v[20:23], v[20:21], v[4:5], 0
 s_waitcnt lgkmcnt(2)
 v_smfmac_f32_16x16x64_bf16 v[40:43], v[24:27], a[240:247], v0
 s_waitcnt lgkmcnt(1)
 v_smfmac_f32_16x16x64_bf16 v[44:47], v[24:27], a[248:255], v0
 ds_read_b128 v[24:27], v1 offset:1024
 v_cvt_pk_bf16_f32 v15, v14, v15
 v_cvt_pk_bf16_f32 v14, v12, v13
 v_cvt_pk_bf16_f32 v13, v10, v11
 v_cvt_pk_bf16_f32 v12, v8, v9
 s_waitcnt vmcnt(3)
 s_nop 0
 v_mfma_f32_16x16x32_bf16 v[8:11], v[56:59], v[12:15], 0
 v_cvt_pk_bf16_f32 v23, v22, v23
 v_cvt_pk_bf16_f32 v22, v20, v21
 v_cvt_pk_bf16_f32 v21, v18, v19
 v_cvt_pk_bf16_f32 v20, v16, v17
 s_waitcnt vmcnt(2)
 v_mfma_f32_16x16x32_bf16 v[16:19], v[60:63], v[12:15], 0
 v_mfma_f32_16x16x32_bf16 v[48:51], v[20:23], v[12:15], 0
 v_smfmac_f32_16x16x64_bf16 v[40:43], v[28:31], v[96:103], v0
 v_smfmac_f32_16x16x64_bf16 v[44:47], v[28:31], v[104:111], v0
 ds_read_b128 v[28:31], v1 offset:2048
 s_waitcnt lgkmcnt(2)
 v_smfmac_f32_16x16x64_bf16 v[40:43], v[52:55], a[160:167], v0
 v_cndmask_b32 v8, v8, v16, s[70:71]
 v_cndmask_b32 v9, v9, v17, s[70:71]
 v_cndmask_b32 v10, v10, v18, s[70:71]
 v_cndmask_b32 v11, v11, v19, s[70:71]
 ds_write_b128 v1, v[8:11] offset:13312
 ds_write_b64 v1, v[48:49] offset:15368
 v_smfmac_f32_16x16x64_bf16 v[44:47], v[52:55], a[168:175], v0
 ds_read_b128 v[52:55], v1 offset:3072
 s_waitcnt lgkmcnt(4)
 v_smfmac_f32_16x16x64_bf16 v[40:43], v[24:27], a[176:183], v0
 v_smfmac_f32_16x16x64_bf16 v[44:47], v[24:27], a[184:191], v0
 ds_read_b128 v[24:27], v1 offset:4096
 s_waitcnt lgkmcnt(4)
 v_smfmac_f32_16x16x64_bf16 v[40:43], v[28:31], a[192:199], v0
 v_smfmac_f32_16x16x64_bf16 v[44:47], v[28:31], a[200:207], v0
 ds_read_b128 v[28:31], v1 offset:6144
 s_waitcnt lgkmcnt(2)
 v_smfmac_f32_16x16x64_bf16 v[40:43], v[52:55], a[208:215], v0
 v_smfmac_f32_16x16x64_bf16 v[44:47], v[52:55], a[216:223], v0
 ds_read_b128 v[52:55], v1 offset:7168
 s_barrier
 ds_read_b128 v[56:59], v1 offset:10240
 ds_read_b128 v[60:63], v1 offset:11264
 ds_read_b128 v[16:19], v1 offset:12288
 ds_read_b128 v[12:15], v1 offset:14336
 ds_read_b128 v[48:51], v1 offset:15360
 s_waitcnt lgkmcnt(7)
 v_smfmac_f32_16x16x64_bf16 v[40:43], v[24:27], a[224:231], v0
 s_mov_b64 exec, s[68:69]
 buffer_store_dwordx4 v[20:23], v6, s[4:7], s62 offen offset:1536 sc1
 s_mov_b64 exec, -1
 v_smfmac_f32_16x16x64_bf16 v[44:47], v[24:27], a[232:239], v0
 ds_read_b128 v[24:27], v1 offset:9216
 v_mov_b32 v7, 0
 s_waitcnt lgkmcnt(7)
 v_smfmac_f32_16x16x64_bf16 v[40:43], v[28:31], v[64:71], v0
 s_mov_b64 exec, 1
 buffer_atomic_add v7, off, s[4:7], s12 sc0
 s_mov_b64 exec, 2
 buffer_atomic_add v7, off, s[4:7], s13 sc0
 s_mov_b64 exec, -1
 v_smfmac_f32_16x16x64_bf16 v[44:47], v[28:31], v[72:79], v0
 s_waitcnt lgkmcnt(6)
 v_smfmac_f32_16x16x64_bf16 v[40:43], v[52:55], v[80:87], v0
 v_smfmac_f32_16x16x64_bf16 v[44:47], v[52:55], v[88:95], v0
 s_waitcnt lgkmcnt(0)
 v_smfmac_f32_16x16x64_bf16 v[40:43], v[24:27], v[112:119], v0
 v_smfmac_f32_16x16x64_bf16 v[44:47], v[24:27], v[120:127], v0
 v_pk_add_f32 v[8:9], v[8:9], v[56:57]
 v_pk_add_f32 v[10:11], v[10:11], v[58:59]
 v_pk_add_f32 v[60:61], v[60:61], v[16:17]
 v_pk_add_f32 v[62:63], v[62:63], v[18:19]
 v_pk_add_f32 v[12:13], v[12:13], v[14:15]
 v_pk_add_f32 v[48:49], v[48:49], v[50:51]
 v_pk_add_f32 v[8:9], v[8:9], v[60:61]
 v_pk_add_f32 v[10:11], v[10:11], v[62:63]
 v_pk_add_f32 v[48:49], v[12:13], v[48:49]
 v_max3_f32 v50, v8, v9, v10
 v_max3_f32 v50, v50, v11, v48
 v_max_f32 v50, v50, v49
 v_add_f32 v40, v40, v42
 v_add_f32 v41, v41, v43
 v_max_f32_dpp v50, v50, v50 quad_perm:[2,3,0,1] row_mask:0xf bank_mask:0xf
 v_mov_b32 v51, v50
 v_add_f32 v44, v44, v46
 v_add_f32 v45, v45, v47
 v_permlane16_swap_b32 v50, v51
 v_max_f32 v50, v50, v51
 v_mov_b32 v51, v50
 v_cvt_pk_bf16_f32 v40, v40, v41
 v_cvt_pk_bf16_f32 v41, v44, v45
 v_permlane32_swap_b32 v50, v51
 v_max_f32 v50, v50, v51
 v_mul_f32 v50, s56, v50
 v_fma_f32 v48, v48, s56, -v50
 v_fma_f32 v49, v49, s56, -v50
 v_fma_f32 v8, v8, s56, -v50
 v_fma_f32 v9, v9, s56, -v50
 v_fma_f32 v10, v10, s56, -v50
 v_fma_f32 v11, v11, s56, -v50
 v_exp_f32 v48, v48
 v_lshrrev_b32 v51, 1, v1
 v_exp_f32 v49, v49
 ds_read_b128 v[56:59], v3 offset:14336
 ds_read_b128 v[60:63], v3 offset:15360
 v_exp_f32 v8, v8
 v_exp_f32 v9, v9
 ds_read_b128 v[24:27], v3 offset:12288
 ds_read_b128 v[28:31], v3 offset:13312
 v_exp_f32 v10, v10
 buffer_store_dwordx2 v[40:41], v51, s[4:7], s62 offen offset:3584 sc1
 v_exp_f32 v11, v11
 v_cvt_pk_bf16_f32 v14, v48, v49
 v_cvt_pk_bf16_f32 v12, v8, v9
 v_cvt_pk_bf16_f32 v13, v10, v11
 v_cndmask_b32 v52, 0, v14, s[68:69]
 v_cndmask_b32 v53, 0, v14, s[70:71]
 v_cndmask_b32 v22, 0, v12, s[70:71]
 v_cndmask_b32 v23, 0, v13, s[70:71]
 v_mfma_f32_16x16x16_bf16 v[44:47], v[40:41], v[52:53], 0
 v_cndmask_b32 v16, 0, v12, s[68:69]
 v_cndmask_b32 v17, 0, v13, s[68:69]
 v_mov_b32_dpp v18, v22 quad_perm:[2,3,0,1] row_mask:0xf bank_mask:0xf
 v_mov_b32_dpp v19, v23 quad_perm:[2,3,0,1] row_mask:0xf bank_mask:0xf
 v_mov_b32_dpp v20, v16 quad_perm:[2,3,0,1] row_mask:0xf bank_mask:0xf
 v_mov_b32_dpp v21, v17 quad_perm:[2,3,0,1] row_mask:0xf bank_mask:0xf
 s_waitcnt vmcnt(5)
 v_mfma_f32_16x16x32_bf16 v[44:47], v[32:35], v[16:19], v[44:47]
 v_add_f32 v54, v8, v9
 v_add_f32 v55, v48, v49
 s_waitcnt vmcnt(4)
 v_mfma_f32_16x16x32_bf16 v[44:47], v[36:39], v[20:23], v[44:47]
 v_add_f32 v54, v54, v10
 v_fma_f32 v55, v55, 0.5, v11
 v_add_f32 v54, v54, v55
 ds_read_b128 v[16:19], v3 offset:49152
 ds_read_b128 v[20:23], v3 offset:49152
 v_add_f32_dpp v54, v54, v54 quad_perm:[2,3,0,1] row_mask:0xf bank_mask:0xf
 v_mov_b32 v55, v54
 ds_read_b128 v[32:35], v3 offset:49152
 ds_read_b128 v[36:39], v3 offset:49152
 v_permlane16_swap_b32 v54, v55
 v_add_f32 v54, v54, v55
 v_mov_b32 v55, v54
 ds_read_b128 v[8:11], v3 offset:49152
 s_cmp_eq_u32 s54, 63
 v_permlane32_swap_b32 v54, v55
 v_add_f32 v54, v54, v55
 v_rcp_f32 v54, v54
 s_cbranch_scc1 L_ch3_end
 v_mul_f32 v44, v44, v54
 v_mul_f32 v45, v45, v54
 v_cvt_pk_bf16_f32 v42, v44, v45
 v_mul_f32 v46, v46, v54
 v_mul_f32 v47, v47, v54
 v_cvt_pk_bf16_f32 v43, v46, v47
 ds_write_b64 v6, v[42:43] offset:1536
 v_and_b32 v40, -9, v6
 v_mov_b32_dpp v12, v42 quad_perm:[0,1,0,1] row_mask:0xf bank_mask:0xf
 v_mov_b32_dpp v14, v42 quad_perm:[2,3,2,3] row_mask:0xf bank_mask:0xf
 v_mov_b32_dpp v13, v43 quad_perm:[0,1,0,1] row_mask:0xf bank_mask:0xf
 v_mov_b32_dpp v15, v43 quad_perm:[2,3,2,3] row_mask:0xf bank_mask:0xf
 s_waitcnt lgkmcnt(5)
 s_nop 0
 v_smfmac_f32_16x16x64_bf16 v[16:19], v[12:15], a[24:31], v0
 s_waitcnt lgkmcnt(4)
 v_smfmac_f32_16x16x64_bf16 v[20:23], v[12:15], a[56:63], v0
 s_waitcnt lgkmcnt(0)
 s_barrier
 ds_read_b128 v[48:51], v40 offset:0
 ds_read_b128 v[52:55], v40 offset:512
 ds_read_b128 v[44:47], v40 offset:1024
 v_smfmac_f32_16x16x64_bf16 v[32:35], v[12:15], v[56:63], v0
 ds_read_b128 v[56:59], v3 offset:47104
 ds_read_b128 v[60:63], v3 offset:48128
 s_mov_b32 m0, 6144
 v_smfmac_f32_16x16x64_bf16 v[36:39], v[12:15], v[24:31], v0
 ds_read_b128 v[24:27], v3 offset:45056
 ds_read_b128 v[28:31], v3 offset:46080
 buffer_load_dwordx4 v1, s[4:7], s81 offen offset:0 lds
 v_smfmac_f32_16x16x64_bf16 v[8:11], v[12:15], a[152:159], v0
 s_mov_b32 m0, 6144
 s_waitcnt lgkmcnt(6)
 v_smfmac_f32_16x16x64_bf16 v[16:19], v[48:51], a[0:7], v0
 buffer_load_dwordx4 v1, s[4:7], s81 offen offset:1024 lds
 s_waitcnt lgkmcnt(5)
 v_smfmac_f32_16x16x64_bf16 v[16:19], v[52:55], a[8:15], v0
 s_mov_b32 m0, 7168
 s_waitcnt lgkmcnt(2)
 v_smfmac_f32_16x16x64_bf16 v[16:19], v[44:47], v[56:63], v0
 ds_read_b128 v[56:59], v3 offset:43008
 ds_read_b128 v[60:63], v3 offset:44032
 buffer_load_dwordx4 v1, s[4:7], s81 offen offset:2048 lds
 s_waitcnt lgkmcnt(2)
 v_smfmac_f32_16x16x64_bf16 v[20:23], v[48:51], v[24:31], v0
 ds_read_b128 v[24:27], v3 offset:40960
 ds_read_b128 v[28:31], v3 offset:41984
 v_smfmac_f32_16x16x64_bf16 v[20:23], v[52:55], a[40:47], v0
 v_smfmac_f32_16x16x64_bf16 v[20:23], v[44:47], a[48:55], v0
 v_cvt_pk_bf16_f32 v16, v16, v17
 v_smfmac_f32_16x16x64_bf16 v[32:35], v[48:51], a[64:71], v0
 v_cvt_pk_bf16_f32 v17, v18, v19
 s_waitcnt lgkmcnt(2)
 v_smfmac_f32_16x16x64_bf16 v[32:35], v[52:55], v[56:63], v0
 ds_read_b128 v[56:59], v3 offset:10240
 ds_read_b128 v[60:63], v3 offset:11264
 v_and_or_b32 v16, v16, -2, s55
 s_waitcnt lgkmcnt(2)
 v_smfmac_f32_16x16x64_bf16 v[32:35], v[44:47], v[24:31], v0
 ds_read_b128 v[24:27], v3 offset:8192
 ds_read_b128 v[28:31], v3 offset:9216
 v_cvt_pk_bf16_f32 v18, v20, v21
 v_smfmac_f32_16x16x64_bf16 v[36:39], v[48:51], a[96:103], v0
 v_cvt_pk_bf16_f32 v19, v22, v23
 v_smfmac_f32_16x16x64_bf16 v[36:39], v[52:55], a[104:111], v0
 v_and_or_b32 v18, v18, -2, s55
 buffer_store_dwordx4 v[16:19], v1, s[4:7], s60 offen offset:0 sc1
 v_smfmac_f32_16x16x64_bf16 v[36:39], v[44:47], a[112:119], v0
 v_cvt_pk_bf16_f32 v32, v32, v33
 s_waitcnt lgkmcnt(2)
 v_smfmac_f32_16x16x64_bf16 v[8:11], v[48:51], v[56:63], v0
 v_cvt_pk_bf16_f32 v33, v34, v35
 s_waitcnt lgkmcnt(0)
 v_smfmac_f32_16x16x64_bf16 v[8:11], v[52:55], v[24:31], v0
 v_and_or_b32 v32, v32, -2, s55
 v_smfmac_f32_16x16x64_bf16 v[8:11], v[44:47], a[144:151], v0
 v_cvt_pk_bf16_f32 v34, v36, v37
 v_cvt_pk_bf16_f32 v35, v38, v39
 v_and_or_b32 v34, v34, -2, s55
 buffer_store_dwordx4 v[32:35], v1, s[4:7], s60 offen offset:1024 sc1
 s_nop 3
 v_cvt_pk_bf16_f32 v8, v8, v9
 v_cvt_pk_bf16_f32 v9, v10, v11
 v_and_or_b32 v8, v8, -2, s55
 buffer_store_dwordx2 v[8:9], v1, s[4:7], s16 offen offset:8 sc1
 buffer_load_dwordx4 v[32:35], v1, s[4:7], s63 offen offset:2048
 buffer_load_dwordx4 v[36:39], v1, s[4:7], s63 offen offset:3072
 s_add_u32 s54, s54, 1
 s_add_u32 s61, s61, 524288
 s_and_b32 s3, s54, 7
 s_cselect_b32 s3, 1, -7
 s_lshl_b32 s3, s3, 17
 s_add_u32 s62, s62, s3
 s_and_b32 s3, s54, 3
 s_cselect_b32 s3, 1, -3
 s_lshl_b32 s3, s3, 14
 s_add_u32 s57, s57, s3
 s_add_u32 s59, s59, s3
 s_xor_b32 s58, s57, 32768
 s_mov_b32 s51, 0
L_fl_215:
 s_waitcnt vmcnt(9)
 v_readlane_b32 s14, v7, 0
 v_readlane_b32 s15, v7, 1
 s_nop 3
 s_cmp_lt_u32 s14, 8
 s_cbranch_scc1 L_fr_216
 s_add_u32 s15, s15, 8
 s_cmp_le_u32 s15, s54
 s_cbranch_scc1 L_fr_216
 s_add_u32 s12, s12, 4
 s_nop 15
 s_nop 15
 s_nop 15
 s_nop 15
 s_nop 15
 s_nop 15
 s_nop 15
 s_nop 15
 s_nop 15
 s_nop 15
 s_nop 15
 s_nop 15
 s_nop 15
 s_nop 11
 s_xor_b32 s55, s55, 1
 s_waitcnt vmcnt(5)
 ds_read_b128 v[40:43], v1 offset:6144
 ds_read_b128 v[44:47], v1 offset:7168
 ds_read_b128 v[48:51], v1 offset:9216
 buffer_load_dwordx4 v[52:55], v1, s[4:7], s81 offen offset:3072
 buffer_load_dwordx4 v[56:59], v1, s[4:7], s101 offen offset:0
 buffer_load_dwordx4 v[60:63], v1, s[4:7], s101 offen offset:1024
 ds_read_b128 v[8:11], v3 offset:49152
 ds_read_b128 v[16:19], v3 offset:49152
 ds_read_b128 v[20:23], v3 offset:49152
 s_waitcnt lgkmcnt(0)
 s_nop 15
 s_nop 15
 s_nop 7
 s_branch L_ch3_s
L_rt_214:
 s_add_u32 s51, s51, 1
 s_cmp_lt_u32 s51, 131072
 s_cbranch_scc1 L_pm_213
 s_branch L_bail
L_fr_216:
 s_sleep 4
 v_mov_b32 v7, 0
 s_mov_b64 exec, 1
 buffer_atomic_add v7, off, s[4:7], s12 sc0
 s_mov_b64 exec, 2
 buffer_atomic_add v7, off, s[4:7], s13 sc0
 s_mov_b64 exec, -1
 s_waitcnt vmcnt(0)
 s_add_u32 s51, s51, 1
 s_cmp_lt_u32 s51, 131072
 s_cbranch_scc1 L_fl_215
 s_branch L_bail
L_ch3_end:
 s_waitcnt vmcnt(0)
 s_endpgm
L_code_end:
 s_endpgm
.section .rodata,"a"
.p2align 6
.amdhsa_kernel interleave_layers__memory_aug_recurrent_mem_tr__ssm_conv_h3__prompt_kernel
  .amdhsa_next_free_vgpr 512
  .amdhsa_next_free_sgpr 102
  .amdhsa_accum_offset 256
  .amdhsa_group_segment_fixed_size 0
  .amdhsa_kernarg_size 128
  .amdhsa_user_sgpr_count 2
  .amdhsa_user_sgpr_kernarg_segment_ptr 1
  .amdhsa_system_sgpr_workgroup_id_x 1
  .amdhsa_float_denorm_mode_32 3
.end_amdhsa_kernel
.text
```

```asm
; @launch grid=(256,1,1) block=(256,1,1) lds=163840
.amdgcn_target "amdgcn-amd-amdhsa--gfx950"
.text
.globl interleave_layers__memory_aug_recurrent_mem_tr__ssm_conv_h3__prompt_kernel
.p2align 8
.type interleave_layers__memory_aug_recurrent_mem_tr__ssm_conv_h3__prompt_kernel,@function
interleave_layers__memory_aug_recurrent_mem_tr__ssm_conv_h3__prompt_kernel:
 s_cmp_ge_u32 s2, 256
 s_cbranch_scc1 L_bail
 s_load_dwordx16 s[16:31], s[0:1], 0
 s_load_dwordx16 s[32:47], s[0:1], 64
 s_getreg_b32 s48, hwreg(HW_REG_XCC_ID, 0, 3)
 v_lshrrev_b32 v1, 6, v0
 v_and_b32 v0, 63, v0
 s_nop 0
 v_readfirstlane_b32 s50, v1
 s_waitcnt lgkmcnt(0)
 s_mov_b32 s4, s46
 s_and_b32 s5, s47, 0xffff
 s_mov_b32 s6, 268435456
 s_mov_b32 s7, 0x00020000
 s_mov_b32 s8, s46
 s_and_b32 s9, s47, 0xffff
 s_mov_b32 s10, 268435456
 s_mov_b32 s11, 0x00020000
 s_mov_b32 s12, s46
 s_and_b32 s13, s47, 0xffff
 s_mov_b32 s14, 268435456
 s_mov_b32 s15, 0x00020000
 s_mov_b32 s96, s44
 s_and_b32 s97, s45, 0xffff
 s_mov_b32 s98, 256
 s_mov_b32 s99, 0x00020000
 s_cmp_lg_u32 s50, 0
 s_cbranch_scc1 L_tk_wait
 s_mov_b32 s96, s44
 s_and_b32 s97, s45, 0xffff
 s_mov_b32 s98, 256
 s_mov_b32 s99, 0x00020000
 s_lshl_b32 s3, s48, 5
 v_mov_b32 v1, 1
 v_mov_b32 v2, 0
 s_mov_b64 exec, 1
 buffer_atomic_add v1, off, s[96:99], s3 sc0
 s_waitcnt vmcnt(0)
 s_mov_b64 exec, -1
 v_readfirstlane_b32 s60, v1
 s_nop 3
 s_cmp_lt_u32 s60, 32
 s_cbranch_scc1 L_tk_ok
 v_lshlrev_b32 v3, 5, v0
 s_mov_b32 s51, 0
L_tk_lp:
 buffer_load_dword v4, v3, s[96:99], 0 offen sc1
 s_waitcnt vmcnt(0)
 s_mov_b32 s61, 0
 v_readlane_b32 s64, v4, 0
 s_nop 3
 s_add_u32 s61, s61, s64
 v_readlane_b32 s65, v4, 1
 s_nop 3
 s_add_u32 s61, s61, s65
 v_readlane_b32 s66, v4, 2
 s_nop 3
 s_add_u32 s61, s61, s66
 v_readlane_b32 s67, v4, 3
 s_nop 3
 s_add_u32 s61, s61, s67
 v_readlane_b32 s68, v4, 4
 s_nop 3
 s_add_u32 s61, s61, s68
 v_readlane_b32 s69, v4, 5
 s_nop 3
 s_add_u32 s61, s61, s69
 v_readlane_b32 s70, v4, 6
 s_nop 3
 s_add_u32 s61, s61, s70
 v_readlane_b32 s71, v4, 7
 s_nop 3
 s_add_u32 s61, s61, s71
 s_cmp_ge_u32 s61, 256
 s_cbranch_scc1 L_tk_all
 s_sleep 4
 s_add_u32 s51, s51, 1
 s_cmp_lt_u32 s51, 131072
 s_cbranch_scc1 L_tk_lp
 s_branch L_bail
L_tk_all:
 v_mov_b32 v1, 1
 s_mov_b64 exec, 1
 buffer_atomic_add v1, off, s[96:99], 0 offset:20 sc0
 s_waitcnt vmcnt(0)
 s_mov_b64 exec, -1
 v_readfirstlane_b32 s61, v1
 s_nop 3
 s_min_u32 s62, s64, 32
 s_add_u32 s60, s62, s61
 s_mov_b32 s48, 0
 s_cmp_lt_u32 s60, 32
 s_cbranch_scc1 L_tk_ok
 s_sub_u32 s61, s60, 32
 s_min_u32 s62, s65, 32
 s_add_u32 s60, s62, s61
 s_mov_b32 s48, 1
 s_cmp_lt_u32 s60, 32
 s_cbranch_scc1 L_tk_ok
 s_sub_u32 s61, s60, 32
 s_min_u32 s62, s66, 32
 s_add_u32 s60, s62, s61
 s_mov_b32 s48, 2
 s_cmp_lt_u32 s60, 32
 s_cbranch_scc1 L_tk_ok
 s_sub_u32 s61, s60, 32
 s_min_u32 s62, s67, 32
 s_add_u32 s60, s62, s61
 s_mov_b32 s48, 3
 s_cmp_lt_u32 s60, 32
 s_cbranch_scc1 L_tk_ok
 s_sub_u32 s61, s60, 32
 s_min_u32 s62, s68, 32
 s_add_u32 s60, s62, s61
 s_mov_b32 s48, 4
 s_cmp_lt_u32 s60, 32
 s_cbranch_scc1 L_tk_ok
 s_sub_u32 s61, s60, 32
 s_min_u32 s62, s69, 32
 s_add_u32 s60, s62, s61
 s_mov_b32 s48, 5
 s_cmp_lt_u32 s60, 32
 s_cbranch_scc1 L_tk_ok
 s_sub_u32 s61, s60, 32
 s_min_u32 s62, s70, 32
 s_add_u32 s60, s62, s61
 s_mov_b32 s48, 6
 s_cmp_lt_u32 s60, 32
 s_cbranch_scc1 L_tk_ok
 s_sub_u32 s61, s60, 32
 s_min_u32 s62, s71, 32
 s_add_u32 s60, s62, s61
 s_mov_b32 s48, 7
 s_cmp_lt_u32 s60, 32
 s_cbranch_scc1 L_tk_ok
 s_sub_u32 s61, s60, 32
 s_mov_b32 s48, 8
 s_mov_b32 s60, 0
L_tk_ok:
 s_lshl_b32 s3, s48, 5
 s_add_u32 s3, s3, s60
 v_mov_b32 v1, s3
 ds_write_b32 v2, v1
 s_waitcnt lgkmcnt(0)
L_tk_wait:
 s_barrier
 v_mov_b32 v2, 0
 ds_read_b32 v1, v2
 s_waitcnt lgkmcnt(0)
 v_readfirstlane_b32 s101, v1
 s_barrier
 s_mov_b32 s51, 0
 s_cmp_ge_u32 s101, 256
 s_cbranch_scc1 L_bail
 s_lshr_b32 s48, s101, 5
 s_and_b32 s48, s48, 7
 s_and_b32 s49, s101, 31
 s_mov_b32 s53, 0
 s_cmp_eq_u32 s48, 0
 s_cbranch_scc1 L_ch
 s_mov_b32 s53, 1
 s_cmp_eq_u32 s48, 4
 s_cbranch_scc1 L_ch
 s_cmp_gt_u32 s48, 4
 s_cselect_b32 s60, 2, 1
 s_sub_u32 s60, s48, s60
 s_lshl_b32 s3, s60, 4
 s_add_u32 s3, s3, s49
 s_cmp_lt_u32 s49, 16
 s_cbranch_scc1 L_qkv_idx
 s_lshl_b32 s82, s60, 2
 s_add_u32 s82, s82, s49
 s_add_u32 s82, s82, 56
 s_mov_b32 s83, 2
 s_cmp_lt_u32 s49, 20
 s_cbranch_scc1 L_helper
 s_min_u32 s61, s60, 2
 s_add_u32 s62, s61, s60
 s_mul_i32 s62, s62, 5
 s_mul_i32 s63, s60, 12
 s_sub_u32 s63, s63, s62
 s_cmp_lt_u32 s60, 2
 s_cselect_b32 s61, 30, 25
 s_sub_u32 s52, s49, s61
 s_add_u32 s52, s52, s63
 s_mov_b32 s82, s52
 s_mov_b32 s83, 0
 s_cmp_ge_u32 s49, s61
 s_cbranch_scc1 L_helper
 s_add_u32 s3, s62, s49
 s_sub_u32 s3, s3, 20
 s_mul_i32 s52, s3, 13108
 s_lshr_b32 s52, s52, 16
 s_mul_i32 s53, s52, 5
 s_sub_u32 s53, s3, s53
 s_add_u32 s82, s3, 32
 s_mov_b32 s83, 1
 s_branch L_helper
L_qkv_idx:
 s_mul_i32 s52, s3, 21846
 s_lshr_b32 s52, s52, 16
 s_mul_i32 s53, s52, 3
 s_sub_u32 s53, s3, s53
 s_mov_b32 s8, s24
 s_and_b32 s9, s25, 0xffff
 s_mov_b32 s10, 5242880
 s_mov_b32 s11, 0x00020000
 s_cmp_eq_u32 s53, 2
 s_cbranch_scc1 L_qkvv
 s_cmp_eq_u32 s53, 0
 s_cselect_b32 s8, s20, s22
 s_cselect_b32 s9, s21, s23
 s_and_b32 s9, s9, 0xffff
 s_branch L_qkvq
L_conv0:
 s_mov_b32 s8, s38
 s_and_b32 s9, s39, 0xffff
 s_mov_b32 s10, 2621440
 s_mov_b32 s11, 0x00020000
 s_mov_b32 s12, s40
 s_and_b32 s13, s41, 0xffff
 s_mov_b32 s14, 1280
 s_mov_b32 s15, 0x00020000
 v_lshlrev_b32 v130, 4, v0
 v_add_u32 v7, s71, v130
 v_mov_b32 v8, 0
 v_mov_b32 v9, 0
 v_mov_b32 v10, 0
 v_mov_b32 v11, 0
 s_mov_b32 exec_hi, 0
 ds_write_b128 v7, v[8:11] offset:0
 s_mov_b32 exec_lo, 3
 ds_write_b128 v7, v[8:11] offset:4608
 ds_write_b128 v7, v[8:11] offset:8768
 s_mov_b64 exec, -1
 v_and_b32 v8, 15, v0
 v_lshrrev_b32 v9, 5, v0
 v_sub_u32 v10, v8, v9
 v_lshlrev_b32 v10, 5, v10
 v_and_b32 v11, 16, v0
 v_add_u32 v10, v10, v11
 s_add_u32 s3, s71, 64
 v_add_u32 v14, s3, v10
 v_lshlrev_b32 v10, 5, v9
 v_lshl_add_u32 v10, v8, 1, v10
 v_sub_u32 v10, v10, v11
 v_and_b32 v11, 1, v0
 v_cmp_eq_u32 vcc, 1, v11
 v_mov_b32 v12, 8784
 v_mov_b32 v11, 4626
 s_nop 0
 v_cndmask_b32 v11, v12, v11, vcc
 v_add3_u32 v16, v10, v11, s71
 v_add_u32 v17, 512, v16
 v_add_u32 v18, 1024, v16
 v_add_u32 v19, 1536, v16
 v_lshlrev_b32 v10, 5, v8
 v_lshl_add_u32 v10, v9, 4, v10
 v_and_b32 v11, 16, v0
 v_lshrrev_b32 v11, 1, v11
 v_xor_b32 v11, 8, v11
 s_add_u32 s3, s71, 512
 v_add3_u32 v15, v10, v11, s3
 v_and_b32 v10, 1, v0
 v_lshlrev_b32 v10, 4, v10
 v_lshrrev_b32 v11, 4, v0
 v_lshl_add_u32 v10, v11, 2, v10
 s_mov_b32 s3, 40960
 v_mul_lo_u32 v13, v10, s3
 v_lshrrev_b32 v11, 1, v8
 v_lshl_add_u32 v13, v11, 3, v13
 s_cmp_lg_u32 s50, 0
 s_cbranch_scc1 L_ww_1
 s_mov_b32 s96, s44
 s_and_b32 s97, s45, 0xffff
 s_mov_b32 s98, 256
 s_mov_b32 s99, 0x00020000
 v_mov_b32 v24, 196
 s_mov_b32 s51, 0
 s_mov_b64 exec, 1
L_wb_2:
 buffer_load_dword v25, v24, s[96:99], 0 offen sc1
 s_waitcnt vmcnt(0)
 v_cmp_eq_u32 vcc, 0, v25
 s_cbranch_vccz L_wbd_3
 s_sleep 2
 s_add_u32 s51, s51, 1
 s_cmp_lt_u32 s51, 131072
 s_cbranch_scc1 L_wb_2
 s_branch L_bail
L_wbd_3:
 s_mov_b64 exec, -1
L_ww_1:
 s_barrier
 s_lshl_b32 s3, s70, 12
 s_add_u32 s3, s3, 231735296
 buffer_load_dwordx4 v[104:107], v130, s[4:7], s3 offen offset:0 sc1
 buffer_load_dwordx4 v[108:111], v130, s[4:7], s3 offen offset:1024 sc1
 s_waitcnt vmcnt(0)
L_cv_4:
 s_waitcnt vmcnt(4)
 ds_write_b128 v7, v[104:107] offset:512
 ds_write_b128 v7, v[96:99] offset:4640
 ds_write_b128 v7, v[112:115] offset:8800
 ds_write_b128 v7, v[108:111] offset:1536
 ds_write_b128 v7, v[100:103] offset:5664
 ds_write_b128 v7, v[116:119] offset:9824
 v_lshlrev_b32 v8, 16, v96
 v_lshlrev_b32 v12, 16, v128
 s_mov_b64 exec, 1
 ds_write_b32 v7, v8 offset:8796
 s_mov_b64 exec, -1
 s_lshl_b32 s72, s70, 6
 s_add_u32 s72, s72, 234356736
 s_add_u32 s70, s70, s69
 s_waitcnt lgkmcnt(0)
 s_lshl_b32 s73, s70, 12
 s_add_u32 s74, s73, 2
 buffer_load_dwordx4 v[96:99], v130, s[8:11], s73 offen offset:0
 buffer_load_dwordx4 v[100:103], v130, s[8:11], s73 offen offset:1024
 buffer_load_dwordx4 v[112:115], v130, s[8:11], s74 offen offset:0
 buffer_load_dwordx4 v[116:119], v130, s[8:11], s74 offen offset:1024
 s_lshl_b32 s3, s70, 1
 buffer_load_ushort v128, off, s[12:15], s3
 s_lshl_b32 s3, s70, 12
 s_add_u32 s3, s3, 231735296
 buffer_load_dwordx4 v[104:107], v130, s[4:7], s3 offen offset:0 sc1
 buffer_load_dwordx4 v[108:111], v130, s[4:7], s3 offen offset:1024 sc1
 ds_read_b128 v[32:35], v14 offset:448
 ds_read2_b32 v[64:65], v16 offset0:0 offset1:1
 ds_read2_b32 v[66:67], v16 offset0:2 offset1:3
 ds_read_b128 v[36:39], v14 offset:960
 ds_read2_b32 v[68:69], v17 offset0:0 offset1:1
 ds_read2_b32 v[70:71], v17 offset0:2 offset1:3
 ds_read_b128 v[40:43], v14 offset:1472
 ds_read2_b32 v[72:73], v18 offset0:0 offset1:1
 ds_read2_b32 v[74:75], v18 offset0:2 offset1:3
 ds_read_b128 v[44:47], v14 offset:1984
 ds_read2_b32 v[76:77], v19 offset0:0 offset1:1
 ds_read2_b32 v[78:79], v19 offset0:2 offset1:3
 s_waitcnt lgkmcnt(0)
 v_mfma_f32_16x16x32_bf16 v[144:147], v[64:67], v[32:35], 0
 ds_read_b128 v[176:179], v14 offset:384
 ds_read2_b32 v[208:209], v16 offset0:16 offset1:17
 v_mfma_f32_16x16x32_bf16 v[148:151], v[64:67], v[36:39], 0
 ds_read2_b32 v[210:211], v16 offset0:18 offset1:19
 ds_read_b128 v[180:183], v14 offset:896
 v_mfma_f32_16x16x32_bf16 v[152:155], v[64:67], v[40:43], 0
 ds_read2_b32 v[212:213], v17 offset0:16 offset1:17
 ds_read2_b32 v[214:215], v17 offset0:18 offset1:19
 v_mfma_f32_16x16x32_bf16 v[156:159], v[64:67], v[44:47], 0
 ds_read_b128 v[184:187], v14 offset:1408
 ds_read2_b32 v[216:217], v18 offset0:16 offset1:17
 v_mfma_f32_16x16x32_bf16 v[148:151], v[68:71], v[32:35], v[148:151]
 ds_read2_b32 v[218:219], v18 offset0:18 offset1:19
 ds_read_b128 v[188:191], v14 offset:1920
 v_mfma_f32_16x16x32_bf16 v[152:155], v[68:71], v[36:39], v[152:155]
 ds_read2_b32 v[220:221], v19 offset0:16 offset1:17
 ds_read2_b32 v[222:223], v19 offset0:18 offset1:19
 v_mfma_f32_16x16x32_bf16 v[156:159], v[68:71], v[40:43], v[156:159]
 v_mfma_f32_16x16x32_bf16 v[152:155], v[72:75], v[32:35], v[152:155]
 v_mfma_f32_16x16x32_bf16 v[156:159], v[72:75], v[36:39], v[156:159]
 v_mfma_f32_16x16x32_bf16 v[156:159], v[76:79], v[32:35], v[156:159]
 s_waitcnt lgkmcnt(0)
 v_mfma_f32_16x16x32_bf16 v[144:147], v[208:211], v[176:179], v[144:147]
 ds_read_b128 v[32:35], v14 offset:320
 ds_read2_b32 v[64:65], v16 offset0:32 offset1:33
 v_mfma_f32_16x16x32_bf16 v[148:151], v[208:211], v[180:183], v[148:151]
 ds_read2_b32 v[66:67], v16 offset0:34 offset1:35
 ds_read_b128 v[36:39], v14 offset:832
 v_mfma_f32_16x16x32_bf16 v[152:155], v[208:211], v[184:187], v[152:155]
 ds_read2_b32 v[68:69], v17 offset0:32 offset1:33
 ds_read2_b32 v[70:71], v17 offset0:34 offset1:35
 v_mfma_f32_16x16x32_bf16 v[156:159], v[208:211], v[188:191], v[156:159]
 ds_read_b128 v[40:43], v14 offset:1344
 ds_read2_b32 v[72:73], v18 offset0:32 offset1:33
 v_mfma_f32_16x16x32_bf16 v[148:151], v[212:215], v[176:179], v[148:151]
 ds_read2_b32 v[74:75], v18 offset0:34 offset1:35
 ds_read_b128 v[44:47], v14 offset:1856
 v_mfma_f32_16x16x32_bf16 v[152:155], v[212:215], v[180:183], v[152:155]
 ds_read2_b32 v[76:77], v19 offset0:32 offset1:33
 ds_read2_b32 v[78:79], v19 offset0:34 offset1:35
 v_mfma_f32_16x16x32_bf16 v[156:159], v[212:215], v[184:187], v[156:159]
 v_mfma_f32_16x16x32_bf16 v[152:155], v[216:219], v[176:179], v[152:155]
 v_mfma_f32_16x16x32_bf16 v[156:159], v[216:219], v[180:183], v[156:159]
 v_mfma_f32_16x16x32_bf16 v[156:159], v[220:223], v[176:179], v[156:159]
 s_waitcnt lgkmcnt(0)
 v_mfma_f32_16x16x32_bf16 v[144:147], v[64:67], v[32:35], v[144:147]
 ds_read_b128 v[176:179], v14 offset:256
 ds_read2_b32 v[208:209], v16 offset0:48 offset1:49
 v_mfma_f32_16x16x32_bf16 v[148:151], v[64:67], v[36:39], v[148:151]
 ds_read2_b32 v[210:211], v16 offset0:50 offset1:51
 ds_read_b128 v[180:183], v14 offset:768
 v_mfma_f32_16x16x32_bf16 v[152:155], v[64:67], v[40:43], v[152:155]
 ds_read2_b32 v[212:213], v17 offset0:48 offset1:49
 ds_read2_b32 v[214:215], v17 offset0:50 offset1:51
 v_mfma_f32_16x16x32_bf16 v[156:159], v[64:67], v[44:47], v[156:159]
 ds_read_b128 v[184:187], v14 offset:1280
 ds_read2_b32 v[216:217], v18 offset0:48 offset1:49
 v_mfma_f32_16x16x32_bf16 v[148:151], v[68:71], v[32:35], v[148:151]
 ds_read2_b32 v[218:219], v18 offset0:50 offset1:51
 ds_read_b128 v[188:191], v14 offset:1792
 v_mfma_f32_16x16x32_bf16 v[152:155], v[68:71], v[36:39], v[152:155]
 ds_read2_b32 v[220:221], v19 offset0:48 offset1:49
 ds_read2_b32 v[222:223], v19 offset0:50 offset1:51
 v_mfma_f32_16x16x32_bf16 v[156:159], v[68:71], v[40:43], v[156:159]
 v_mfma_f32_16x16x32_bf16 v[152:155], v[72:75], v[32:35], v[152:155]
 v_mfma_f32_16x16x32_bf16 v[156:159], v[72:75], v[36:39], v[156:159]
 v_mfma_f32_16x16x32_bf16 v[156:159], v[76:79], v[32:35], v[156:159]
 s_waitcnt lgkmcnt(0)
 v_mfma_f32_16x16x32_bf16 v[144:147], v[208:211], v[176:179], v[144:147]
 ds_read_b128 v[32:35], v14 offset:192
 ds_read2_b32 v[64:65], v16 offset0:64 offset1:65
 v_mfma_f32_16x16x32_bf16 v[148:151], v[208:211], v[180:183], v[148:151]
 ds_read2_b32 v[66:67], v16 offset0:66 offset1:67
 ds_read_b128 v[36:39], v14 offset:704
 v_mfma_f32_16x16x32_bf16 v[152:155], v[208:211], v[184:187], v[152:155]
 ds_read2_b32 v[68:69], v17 offset0:64 offset1:65
 ds_read2_b32 v[70:71], v17 offset0:66 offset1:67
 v_mfma_f32_16x16x32_bf16 v[156:159], v[208:211], v[188:191], v[156:159]
 ds_read_b128 v[40:43], v14 offset:1216
 ds_read2_b32 v[72:73], v18 offset0:64 offset1:65
 v_mfma_f32_16x16x32_bf16 v[148:151], v[212:215], v[176:179], v[148:151]
 ds_read2_b32 v[74:75], v18 offset0:66 offset1:67
 ds_read_b128 v[44:47], v14 offset:1728
 v_mfma_f32_16x16x32_bf16 v[152:155], v[212:215], v[180:183], v[152:155]
 ds_read2_b32 v[76:77], v19 offset0:64 offset1:65
 ds_read2_b32 v[78:79], v19 offset0:66 offset1:67
 v_mfma_f32_16x16x32_bf16 v[156:159], v[212:215], v[184:187], v[156:159]
 v_mfma_f32_16x16x32_bf16 v[152:155], v[216:219], v[176:179], v[152:155]
 v_mfma_f32_16x16x32_bf16 v[156:159], v[216:219], v[180:183], v[156:159]
 v_mfma_f32_16x16x32_bf16 v[156:159], v[220:223], v[176:179], v[156:159]
 s_waitcnt lgkmcnt(0)
 v_mfma_f32_16x16x32_bf16 v[144:147], v[64:67], v[32:35], v[144:147]
 ds_read_b128 v[176:179], v14 offset:128
 ds_read2_b32 v[208:209], v16 offset0:80 offset1:81
 v_mfma_f32_16x16x32_bf16 v[148:151], v[64:67], v[36:39], v[148:151]
 ds_read2_b32 v[210:211], v16 offset0:82 offset1:83
 ds_read_b128 v[180:183], v14 offset:640
 v_mfma_f32_16x16x32_bf16 v[152:155], v[64:67], v[40:43], v[152:155]
 ds_read2_b32 v[212:213], v17 offset0:80 offset1:81
 ds_read2_b32 v[214:215], v17 offset0:82 offset1:83
 v_mfma_f32_16x16x32_bf16 v[156:159], v[64:67], v[44:47], v[156:159]
 ds_read_b128 v[184:187], v14 offset:1152
 ds_read2_b32 v[216:217], v18 offset0:80 offset1:81
 v_mfma_f32_16x16x32_bf16 v[148:151], v[68:71], v[32:35], v[148:151]
 ds_read2_b32 v[218:219], v18 offset0:82 offset1:83
 ds_read_b128 v[188:191], v14 offset:1664
 v_mfma_f32_16x16x32_bf16 v[152:155], v[68:71], v[36:39], v[152:155]
 ds_read2_b32 v[220:221], v19 offset0:80 offset1:81
 ds_read2_b32 v[222:223], v19 offset0:82 offset1:83
 v_mfma_f32_16x16x32_bf16 v[156:159], v[68:71], v[40:43], v[156:159]
 v_mfma_f32_16x16x32_bf16 v[152:155], v[72:75], v[32:35], v[152:155]
 v_mfma_f32_16x16x32_bf16 v[156:159], v[72:75], v[36:39], v[156:159]
 v_mfma_f32_16x16x32_bf16 v[156:159], v[76:79], v[32:35], v[156:159]
 s_waitcnt lgkmcnt(0)
 v_mfma_f32_16x16x32_bf16 v[144:147], v[208:211], v[176:179], v[144:147]
 ds_read_b128 v[32:35], v14 offset:64
 ds_read2_b32 v[64:65], v16 offset0:96 offset1:97
 v_mfma_f32_16x16x32_bf16 v[148:151], v[208:211], v[180:183], v[148:151]
 ds_read2_b32 v[66:67], v16 offset0:98 offset1:99
 ds_read_b128 v[36:39], v14 offset:576
 v_mfma_f32_16x16x32_bf16 v[152:155], v[208:211], v[184:187], v[152:155]
 ds_read2_b32 v[68:69], v17 offset0:96 offset1:97
 ds_read2_b32 v[70:71], v17 offset0:98 offset1:99
 v_mfma_f32_16x16x32_bf16 v[156:159], v[208:211], v[188:191], v[156:159]
 ds_read_b128 v[40:43], v14 offset:1088
 ds_read2_b32 v[72:73], v18 offset0:96 offset1:97
 v_mfma_f32_16x16x32_bf16 v[148:151], v[212:215], v[176:179], v[148:151]
 ds_read2_b32 v[74:75], v18 offset0:98 offset1:99
 ds_read_b128 v[44:47], v14 offset:1600
 v_mfma_f32_16x16x32_bf16 v[152:155], v[212:215], v[180:183], v[152:155]
 ds_read2_b32 v[76:77], v19 offset0:96 offset1:97
 ds_read2_b32 v[78:79], v19 offset0:98 offset1:99
 v_mfma_f32_16x16x32_bf16 v[156:159], v[212:215], v[184:187], v[156:159]
 v_mfma_f32_16x16x32_bf16 v[152:155], v[216:219], v[176:179], v[152:155]
 v_mfma_f32_16x16x32_bf16 v[156:159], v[216:219], v[180:183], v[156:159]
 v_mfma_f32_16x16x32_bf16 v[156:159], v[220:223], v[176:179], v[156:159]
 s_waitcnt lgkmcnt(0)
 v_mfma_f32_16x16x32_bf16 v[144:147], v[64:67], v[32:35], v[144:147]
 ds_read_b128 v[176:179], v14 offset:0
 ds_read2_b32 v[208:209], v16 offset0:112 offset1:113
 v_mfma_f32_16x16x32_bf16 v[148:151], v[64:67], v[36:39], v[148:151]
 ds_read2_b32 v[210:211], v16 offset0:114 offset1:115
 ds_read_b128 v[180:183], v14 offset:512
 v_mfma_f32_16x16x32_bf16 v[152:155], v[64:67], v[40:43], v[152:155]
 ds_read2_b32 v[212:213], v17 offset0:112 offset1:113
 ds_read2_b32 v[214:215], v17 offset0:114 offset1:115
 v_mfma_f32_16x16x32_bf16 v[156:159], v[64:67], v[44:47], v[156:159]
 ds_read_b128 v[184:187], v14 offset:1024
 ds_read2_b32 v[216:217], v18 offset0:112 offset1:113
 v_mfma_f32_16x16x32_bf16 v[148:151], v[68:71], v[32:35], v[148:151]
 ds_read2_b32 v[218:219], v18 offset0:114 offset1:115
 ds_read_b128 v[188:191], v14 offset:1536
 v_mfma_f32_16x16x32_bf16 v[152:155], v[68:71], v[36:39], v[152:155]
 ds_read2_b32 v[220:221], v19 offset0:112 offset1:113
 ds_read2_b32 v[222:223], v19 offset0:114 offset1:115
 v_mfma_f32_16x16x32_bf16 v[156:159], v[68:71], v[40:43], v[156:159]
 v_mfma_f32_16x16x32_bf16 v[152:155], v[72:75], v[32:35], v[152:155]
 v_mfma_f32_16x16x32_bf16 v[156:159], v[72:75], v[36:39], v[156:159]
 v_mfma_f32_16x16x32_bf16 v[156:159], v[76:79], v[32:35], v[156:159]
 s_waitcnt lgkmcnt(0)
 v_mfma_f32_16x16x32_bf16 v[144:147], v[208:211], v[176:179], v[144:147]
 ds_read_b64 v[32:33], v15 offset:0
 ds_read_b64 v[34:35], v15 offset:512
 v_mfma_f32_16x16x32_bf16 v[148:151], v[208:211], v[180:183], v[148:151]
 ds_read_b64 v[36:37], v15 offset:1024
 ds_read_b64 v[38:39], v15 offset:1536
 v_mfma_f32_16x16x32_bf16 v[152:155], v[208:211], v[184:187], v[152:155]
 v_mfma_f32_16x16x32_bf16 v[156:159], v[208:211], v[188:191], v[156:159]
 v_mfma_f32_16x16x32_bf16 v[148:151], v[212:215], v[176:179], v[148:151]
 v_mfma_f32_16x16x32_bf16 v[152:155], v[212:215], v[180:183], v[152:155]
 v_mfma_f32_16x16x32_bf16 v[156:159], v[212:215], v[184:187], v[156:159]
 v_mfma_f32_16x16x32_bf16 v[152:155], v[216:219], v[176:179], v[152:155]
 v_mfma_f32_16x16x32_bf16 v[156:159], v[216:219], v[180:183], v[156:159]
 v_mfma_f32_16x16x32_bf16 v[156:159], v[220:223], v[176:179], v[156:159]
 s_waitcnt lgkmcnt(0)
 v_and_b32 v64, 0xffff0000, v33
 v_lshlrev_b32 v65, 16, v33
 v_and_b32 v66, 0xffff0000, v32
 v_lshlrev_b32 v67, 16, v32
 v_mul_f32 v64, v64, v12
 v_mul_f32 v65, v65, v12
 v_mul_f32 v66, v66, v12
 v_mul_f32 v67, v67, v12
 v_and_b32 v68, 0xffff0000, v35
 v_lshlrev_b32 v69, 16, v35
 v_and_b32 v70, 0xffff0000, v34
 v_lshlrev_b32 v71, 16, v34
 v_mul_f32 v68, v68, v12
 v_mul_f32 v69, v69, v12
 v_mul_f32 v70, v70, v12
 v_mul_f32 v71, v71, v12
 v_and_b32 v72, 0xffff0000, v37
 v_lshlrev_b32 v73, 16, v37
 v_and_b32 v74, 0xffff0000, v36
 v_lshlrev_b32 v75, 16, v36
 v_mul_f32 v72, v72, v12
 v_mul_f32 v73, v73, v12
 v_mul_f32 v74, v74, v12
 v_mul_f32 v75, v75, v12
 v_and_b32 v76, 0xffff0000, v39
 v_lshlrev_b32 v77, 16, v39
 v_and_b32 v78, 0xffff0000, v38
 v_lshlrev_b32 v79, 16, v38
 v_mul_f32 v76, v76, v12
 v_mul_f32 v77, v77, v12
 v_mul_f32 v78, v78, v12
 v_mul_f32 v79, v79, v12
 v_cvt_pk_bf16_f32 v8, v64, v65
 v_lshlrev_b32 v64, 16, v8
 v_and_b32 v65, 0xffff0000, v8
 v_cvt_pk_bf16_f32 v8, v66, v67
 v_lshlrev_b32 v66, 16, v8
 v_and_b32 v67, 0xffff0000, v8
 v_cvt_pk_bf16_f32 v8, v68, v69
 v_lshlrev_b32 v68, 16, v8
 v_and_b32 v69, 0xffff0000, v8
 v_cvt_pk_bf16_f32 v8, v70, v71
 v_lshlrev_b32 v70, 16, v8
 v_and_b32 v71, 0xffff0000, v8
 v_cvt_pk_bf16_f32 v8, v72, v73
 v_lshlrev_b32 v72, 16, v8
 v_and_b32 v73, 0xffff0000, v8
 v_cvt_pk_bf16_f32 v8, v74, v75
 v_lshlrev_b32 v74, 16, v8
 v_and_b32 v75, 0xffff0000, v8
 v_cvt_pk_bf16_f32 v8, v76, v77
 v_lshlrev_b32 v76, 16, v8
 v_and_b32 v77, 0xffff0000, v8
 v_cvt_pk_bf16_f32 v8, v78, v79
 v_lshlrev_b32 v78, 16, v8
 v_and_b32 v79, 0xffff0000, v8
 v_cvt_pk_bf16_f32 v8, v144, v145
 v_lshlrev_b32 v144, 16, v8
 v_and_b32 v145, 0xffff0000, v8
 v_cvt_pk_bf16_f32 v8, v146, v147
 v_lshlrev_b32 v146, 16, v8
 v_and_b32 v147, 0xffff0000, v8
 v_cvt_pk_bf16_f32 v8, v148, v149
 v_lshlrev_b32 v148, 16, v8
 v_and_b32 v149, 0xffff0000, v8
 v_cvt_pk_bf16_f32 v8, v150, v151
 v_lshlrev_b32 v150, 16, v8
 v_and_b32 v151, 0xffff0000, v8
 v_cvt_pk_bf16_f32 v8, v152, v153
 v_lshlrev_b32 v152, 16, v8
 v_and_b32 v153, 0xffff0000, v8
 v_cvt_pk_bf16_f32 v8, v154, v155
 v_lshlrev_b32 v154, 16, v8
 v_and_b32 v155, 0xffff0000, v8
 v_cvt_pk_bf16_f32 v8, v156, v157
 v_lshlrev_b32 v156, 16, v8
 v_and_b32 v157, 0xffff0000, v8
 v_cvt_pk_bf16_f32 v8, v158, v159
 v_lshlrev_b32 v158, 16, v8
 v_and_b32 v159, 0xffff0000, v8
 v_pk_add_f32 v[144:145], v[144:145], v[64:65]
 v_pk_add_f32 v[146:147], v[146:147], v[66:67]
 v_pk_add_f32 v[148:149], v[148:149], v[68:69]
 v_pk_add_f32 v[150:151], v[150:151], v[70:71]
 v_pk_add_f32 v[152:153], v[152:153], v[72:73]
 v_pk_add_f32 v[154:155], v[154:155], v[74:75]
 v_pk_add_f32 v[156:157], v[156:157], v[76:77]
 v_pk_add_f32 v[158:159], v[158:159], v[78:79]
 v_cvt_pk_bf16_f32 v160, v144, v148
 v_cvt_pk_bf16_f32 v161, v152, v156
 buffer_store_dwordx2 v[160:161], v13, s[4:7], s72 offen sc1
 s_add_u32 s72, s72, 40960
 v_cvt_pk_bf16_f32 v162, v145, v149
 v_cvt_pk_bf16_f32 v163, v153, v157
 buffer_store_dwordx2 v[162:163], v13, s[4:7], s72 offen sc1
 s_add_u32 s72, s72, 40960
 v_cvt_pk_bf16_f32 v164, v146, v150
 v_cvt_pk_bf16_f32 v165, v154, v158
 buffer_store_dwordx2 v[164:165], v13, s[4:7], s72 offen sc1
 s_add_u32 s72, s72, 40960
 v_cvt_pk_bf16_f32 v166, v147, v151
 v_cvt_pk_bf16_f32 v167, v155, v159
 buffer_store_dwordx2 v[166:167], v13, s[4:7], s72 offen sc1
 s_add_u32 s72, s72, 40960
 s_cmp_lt_u32 s70, 640
 s_cbranch_scc1 L_cv_4
 s_setpc_b64 s[76:77]
L_conv1:
 s_mov_b32 s8, s38
 s_and_b32 s9, s39, 0xffff
 s_mov_b32 s10, 2621440
 s_mov_b32 s11, 0x00020000
 s_mov_b32 s12, s40
 s_and_b32 s13, s41, 0xffff
 s_mov_b32 s14, 1280
 s_mov_b32 s15, 0x00020000
 v_lshlrev_b32 v130, 4, v0
 v_add_u32 v7, s71, v130
 v_mov_b32 v8, 0
 v_mov_b32 v9, 0
 v_mov_b32 v10, 0
 v_mov_b32 v11, 0
 s_mov_b32 exec_hi, 0
 ds_write_b128 v7, v[8:11] offset:0
 s_mov_b32 exec_lo, 3
 ds_write_b128 v7, v[8:11] offset:4608
 ds_write_b128 v7, v[8:11] offset:8768
 s_mov_b64 exec, -1
 v_and_b32 v8, 15, v0
 v_lshrrev_b32 v9, 5, v0
 v_sub_u32 v10, v8, v9
 v_lshlrev_b32 v10, 5, v10
 v_and_b32 v11, 16, v0
 v_add_u32 v10, v10, v11
 s_add_u32 s3, s71, 64
 v_add_u32 v14, s3, v10
 v_lshlrev_b32 v10, 5, v9
 v_lshl_add_u32 v10, v8, 1, v10
 v_sub_u32 v10, v10, v11
 v_and_b32 v11, 1, v0
 v_cmp_eq_u32 vcc, 1, v11
 v_mov_b32 v12, 8784
 v_mov_b32 v11, 4626
 s_nop 0
 v_cndmask_b32 v11, v12, v11, vcc
 v_add3_u32 v16, v10, v11, s71
 v_add_u32 v17, 512, v16
 v_add_u32 v18, 1024, v16
 v_add_u32 v19, 1536, v16
 v_add_u32 v20, 2048, v16
 v_add_u32 v21, 2560, v16
 v_add_u32 v22, 3072, v16
 v_add_u32 v23, 3584, v16
 v_lshlrev_b32 v10, 5, v8
 v_lshl_add_u32 v10, v9, 4, v10
 v_and_b32 v11, 16, v0
 v_lshrrev_b32 v11, 1, v11
 v_xor_b32 v11, 8, v11
 s_add_u32 s3, s71, 512
 v_add3_u32 v15, v10, v11, s3
 v_and_b32 v10, 1, v0
 v_lshlrev_b32 v10, 4, v10
 v_lshrrev_b32 v11, 4, v0
 v_lshl_add_u32 v10, v11, 2, v10
 s_mov_b32 s3, 40960
 v_mul_lo_u32 v13, v10, s3
 v_lshrrev_b32 v11, 1, v8
 v_lshl_add_u32 v13, v11, 3, v13
 s_waitcnt vmcnt(0)
L_cv_5:
 s_waitcnt vmcnt(4)
 ds_write_b128 v7, v[240:243] offset:512
 ds_write_b128 v7, v[96:99] offset:4640
 ds_write_b128 v7, v[112:115] offset:8800
 ds_write_b128 v7, v[244:247] offset:1536
 ds_write_b128 v7, v[100:103] offset:5664
 ds_write_b128 v7, v[116:119] offset:9824
 ds_write_b128 v7, v[248:251] offset:2560
 ds_write_b128 v7, v[104:107] offset:6688
 ds_write_b128 v7, v[120:123] offset:10848
 ds_write_b128 v7, v[252:255] offset:3584
 ds_write_b128 v7, v[108:111] offset:7712
 ds_write_b128 v7, v[124:127] offset:11872
 v_lshlrev_b32 v8, 16, v96
 v_lshlrev_b32 v12, 16, v128
 s_mov_b64 exec, 1
 ds_write_b32 v7, v8 offset:8796
 s_mov_b64 exec, -1
 s_lshl_b32 s72, s70, 6
 s_add_u32 s72, s72, 235667456
 s_add_u32 s70, s70, s69
 s_waitcnt lgkmcnt(0)
 s_lshl_b32 s73, s70, 12
 s_add_u32 s74, s73, 2
 buffer_load_dwordx4 v[96:99], v130, s[8:11], s73 offen offset:0
 buffer_load_dwordx4 v[100:103], v130, s[8:11], s73 offen offset:1024
 buffer_load_dwordx4 v[104:107], v130, s[8:11], s73 offen offset:2048
 buffer_load_dwordx4 v[108:111], v130, s[8:11], s73 offen offset:3072
 buffer_load_dwordx4 v[112:115], v130, s[8:11], s74 offen offset:0
 buffer_load_dwordx4 v[116:119], v130, s[8:11], s74 offen offset:1024
 buffer_load_dwordx4 v[120:123], v130, s[8:11], s74 offen offset:2048
 buffer_load_dwordx4 v[124:127], v130, s[8:11], s74 offen offset:3072
 s_lshl_b32 s3, s70, 1
 buffer_load_ushort v128, off, s[12:15], s3
 s_lshl_b32 s3, s70, 12
 s_add_u32 s3, s3, 231735296
 buffer_load_dwordx4 v[240:243], v130, s[4:7], s3 offen offset:0 sc1
 buffer_load_dwordx4 v[244:247], v130, s[4:7], s3 offen offset:1024 sc1
 buffer_load_dwordx4 v[248:251], v130, s[4:7], s3 offen offset:2048 sc1
 buffer_load_dwordx4 v[252:255], v130, s[4:7], s3 offen offset:3072 sc1
 ds_read_b128 v[32:35], v14 offset:448
 ds_read2_b32 v[64:65], v16 offset0:0 offset1:1
 ds_read2_b32 v[66:67], v16 offset0:2 offset1:3
 ds_read_b128 v[36:39], v14 offset:960
 ds_read2_b32 v[68:69], v17 offset0:0 offset1:1
 ds_read2_b32 v[70:71], v17 offset0:2 offset1:3
 ds_read_b128 v[40:43], v14 offset:1472
 ds_read2_b32 v[72:73], v18 offset0:0 offset1:1
 ds_read2_b32 v[74:75], v18 offset0:2 offset1:3
 ds_read_b128 v[44:47], v14 offset:1984
 ds_read2_b32 v[76:77], v19 offset0:0 offset1:1
 ds_read2_b32 v[78:79], v19 offset0:2 offset1:3
 ds_read_b128 v[48:51], v14 offset:2496
 ds_read2_b32 v[80:81], v20 offset0:0 offset1:1
 ds_read2_b32 v[82:83], v20 offset0:2 offset1:3
 ds_read_b128 v[52:55], v14 offset:3008
 ds_read2_b32 v[84:85], v21 offset0:0 offset1:1
 ds_read2_b32 v[86:87], v21 offset0:2 offset1:3
 ds_read_b128 v[56:59], v14 offset:3520
 ds_read2_b32 v[88:89], v22 offset0:0 offset1:1
 ds_read2_b32 v[90:91], v22 offset0:2 offset1:3
 ds_read_b128 v[60:63], v14 offset:4032
 ds_read2_b32 v[92:93], v23 offset0:0 offset1:1
 ds_read2_b32 v[94:95], v23 offset0:2 offset1:3
 s_waitcnt lgkmcnt(0)
 v_mfma_f32_16x16x32_bf16 v[144:147], v[64:67], v[48:51], 0
 ds_read_b128 v[176:179], v14 offset:384
 v_mfma_f32_16x16x32_bf16 v[148:151], v[64:67], v[52:55], 0
 ds_read2_b32 v[208:209], v16 offset0:16 offset1:17
 v_mfma_f32_16x16x32_bf16 v[152:155], v[64:67], v[56:59], 0
 ds_read2_b32 v[210:211], v16 offset0:18 offset1:19
 v_mfma_f32_16x16x32_bf16 v[156:159], v[64:67], v[60:63], 0
 ds_read_b128 v[180:183], v14 offset:896
 v_mfma_f32_16x16x32_bf16 v[144:147], v[68:71], v[44:47], v[144:147]
 ds_read2_b32 v[212:213], v17 offset0:16 offset1:17
 v_mfma_f32_16x16x32_bf16 v[148:151], v[68:71], v[48:51], v[148:151]
 ds_read2_b32 v[214:215], v17 offset0:18 offset1:19
 v_mfma_f32_16x16x32_bf16 v[152:155], v[68:71], v[52:55], v[152:155]
 ds_read_b128 v[184:187], v14 offset:1408
 v_mfma_f32_16x16x32_bf16 v[156:159], v[68:71], v[56:59], v[156:159]
 ds_read2_b32 v[216:217], v18 offset0:16 offset1:17
 v_mfma_f32_16x16x32_bf16 v[144:147], v[72:75], v[40:43], v[144:147]
 ds_read2_b32 v[218:219], v18 offset0:18 offset1:19
 v_mfma_f32_16x16x32_bf16 v[148:151], v[72:75], v[44:47], v[148:151]
 ds_read_b128 v[188:191], v14 offset:1920
 v_mfma_f32_16x16x32_bf16 v[152:155], v[72:75], v[48:51], v[152:155]
 ds_read2_b32 v[220:221], v19 offset0:16 offset1:17
 v_mfma_f32_16x16x32_bf16 v[156:159], v[72:75], v[52:55], v[156:159]
 ds_read2_b32 v[222:223], v19 offset0:18 offset1:19
 v_mfma_f32_16x16x32_bf16 v[144:147], v[76:79], v[36:39], v[144:147]
 ds_read_b128 v[192:195], v14 offset:2432
 v_mfma_f32_16x16x32_bf16 v[148:151], v[76:79], v[40:43], v[148:151]
 ds_read2_b32 v[224:225], v20 offset0:16 offset1:17
 v_mfma_f32_16x16x32_bf16 v[152:155], v[76:79], v[44:47], v[152:155]
 ds_read2_b32 v[226:227], v20 offset0:18 offset1:19
 v_mfma_f32_16x16x32_bf16 v[156:159], v[76:79], v[48:51], v[156:159]
 ds_read_b128 v[196:199], v14 offset:2944
 v_mfma_f32_16x16x32_bf16 v[144:147], v[80:83], v[32:35], v[144:147]
 ds_read2_b32 v[228:229], v21 offset0:16 offset1:17
 v_mfma_f32_16x16x32_bf16 v[148:151], v[80:83], v[36:39], v[148:151]
 ds_read2_b32 v[230:231], v21 offset0:18 offset1:19
 v_mfma_f32_16x16x32_bf16 v[152:155], v[80:83], v[40:43], v[152:155]
 ds_read_b128 v[200:203], v14 offset:3456
 v_mfma_f32_16x16x32_bf16 v[156:159], v[80:83], v[44:47], v[156:159]
 ds_read2_b32 v[232:233], v22 offset0:16 offset1:17
 v_mfma_f32_16x16x32_bf16 v[148:151], v[84:87], v[32:35], v[148:151]
 ds_read2_b32 v[234:235], v22 offset0:18 offset1:19
 v_mfma_f32_16x16x32_bf16 v[152:155], v[84:87], v[36:39], v[152:155]
 ds_read_b128 v[204:207], v14 offset:3968
 v_mfma_f32_16x16x32_bf16 v[156:159], v[84:87], v[40:43], v[156:159]
 ds_read2_b32 v[236:237], v23 offset0:16 offset1:17
 v_mfma_f32_16x16x32_bf16 v[152:155], v[88:91], v[32:35], v[152:155]
 ds_read2_b32 v[238:239], v23 offset0:18 offset1:19
 v_mfma_f32_16x16x32_bf16 v[156:159], v[88:91], v[36:39], v[156:159]
 v_mfma_f32_16x16x32_bf16 v[156:159], v[92:95], v[32:35], v[156:159]
 s_waitcnt lgkmcnt(0)
 v_mfma_f32_16x16x32_bf16 v[144:147], v[208:211], v[192:195], v[144:147]
 ds_read_b128 v[32:35], v14 offset:320
 v_mfma_f32_16x16x32_bf16 v[148:151], v[208:211], v[196:199], v[148:151]
 ds_read2_b32 v[64:65], v16 offset0:32 offset1:33
 v_mfma_f32_16x16x32_bf16 v[152:155], v[208:211], v[200:203], v[152:155]
 ds_read2_b32 v[66:67], v16 offset0:34 offset1:35
 v_mfma_f32_16x16x32_bf16 v[156:159], v[208:211], v[204:207], v[156:159]
 ds_read_b128 v[36:39], v14 offset:832
 v_mfma_f32_16x16x32_bf16 v[144:147], v[212:215], v[188:191], v[144:147]
 ds_read2_b32 v[68:69], v17 offset0:32 offset1:33
 v_mfma_f32_16x16x32_bf16 v[148:151], v[212:215], v[192:195], v[148:151]
 ds_read2_b32 v[70:71], v17 offset0:34 offset1:35
 v_mfma_f32_16x16x32_bf16 v[152:155], v[212:215], v[196:199], v[152:155]
 ds_read_b128 v[40:43], v14 offset:1344
 v_mfma_f32_16x16x32_bf16 v[156:159], v[212:215], v[200:203], v[156:159]
 ds_read2_b32 v[72:73], v18 offset0:32 offset1:33
 v_mfma_f32_16x16x32_bf16 v[144:147], v[216:219], v[184:187], v[144:147]
 ds_read2_b32 v[74:75], v18 offset0:34 offset1:35
 v_mfma_f32_16x16x32_bf16 v[148:151], v[216:219], v[188:191], v[148:151]
 ds_read_b128 v[44:47], v14 offset:1856
 v_mfma_f32_16x16x32_bf16 v[152:155], v[216:219], v[192:195], v[152:155]
 ds_read2_b32 v[76:77], v19 offset0:32 offset1:33
 v_mfma_f32_16x16x32_bf16 v[156:159], v[216:219], v[196:199], v[156:159]
 ds_read2_b32 v[78:79], v19 offset0:34 offset1:35
 v_mfma_f32_16x16x32_bf16 v[144:147], v[220:223], v[180:183], v[144:147]
 ds_read_b128 v[48:51], v14 offset:2368
 v_mfma_f32_16x16x32_bf16 v[148:151], v[220:223], v[184:187], v[148:151]
 ds_read2_b32 v[80:81], v20 offset0:32 offset1:33
 v_mfma_f32_16x16x32_bf16 v[152:155], v[220:223], v[188:191], v[152:155]
 ds_read2_b32 v[82:83], v20 offset0:34 offset1:35
 v_mfma_f32_16x16x32_bf16 v[156:159], v[220:223], v[192:195], v[156:159]
 ds_read_b128 v[52:55], v14 offset:2880
 v_mfma_f32_16x16x32_bf16 v[144:147], v[224:227], v[176:179], v[144:147]
 ds_read2_b32 v[84:85], v21 offset0:32 offset1:33
 v_mfma_f32_16x16x32_bf16 v[148:151], v[224:227], v[180:183], v[148:151]
 ds_read2_b32 v[86:87], v21 offset0:34 offset1:35
 v_mfma_f32_16x16x32_bf16 v[152:155], v[224:227], v[184:187], v[152:155]
 ds_read_b128 v[56:59], v14 offset:3392
 v_mfma_f32_16x16x32_bf16 v[156:159], v[224:227], v[188:191], v[156:159]
 ds_read2_b32 v[88:89], v22 offset0:32 offset1:33
 v_mfma_f32_16x16x32_bf16 v[148:151], v[228:231], v[176:179], v[148:151]
 ds_read2_b32 v[90:91], v22 offset0:34 offset1:35
 v_mfma_f32_16x16x32_bf16 v[152:155], v[228:231], v[180:183], v[152:155]
 ds_read_b128 v[60:63], v14 offset:3904
 v_mfma_f32_16x16x32_bf16 v[156:159], v[228:231], v[184:187], v[156:159]
 ds_read2_b32 v[92:93], v23 offset0:32 offset1:33
 v_mfma_f32_16x16x32_bf16 v[152:155], v[232:235], v[176:179], v[152:155]
 ds_read2_b32 v[94:95], v23 offset0:34 offset1:35
 v_mfma_f32_16x16x32_bf16 v[156:159], v[232:235], v[180:183], v[156:159]
 v_mfma_f32_16x16x32_bf16 v[156:159], v[236:239], v[176:179], v[156:159]
 s_waitcnt lgkmcnt(0)
 v_mfma_f32_16x16x32_bf16 v[144:147], v[64:67], v[48:51], v[144:147]
 ds_read_b128 v[176:179], v14 offset:256
 v_mfma_f32_16x16x32_bf16 v[148:151], v[64:67], v[52:55], v[148:151]
 ds_read2_b32 v[208:209], v16 offset0:48 offset1:49
 v_mfma_f32_16x16x32_bf16 v[152:155], v[64:67], v[56:59], v[152:155]
 ds_read2_b32 v[210:211], v16 offset0:50 offset1:51
 v_mfma_f32_16x16x32_bf16 v[156:159], v[64:67], v[60:63], v[156:159]
 ds_read_b128 v[180:183], v14 offset:768
 v_mfma_f32_16x16x32_bf16 v[144:147], v[68:71], v[44:47], v[144:147]
 ds_read2_b32 v[212:213], v17 offset0:48 offset1:49
 v_mfma_f32_16x16x32_bf16 v[148:151], v[68:71], v[48:51], v[148:151]
 ds_read2_b32 v[214:215], v17 offset0:50 offset1:51
 v_mfma_f32_16x16x32_bf16 v[152:155], v[68:71], v[52:55], v[152:155]
 ds_read_b128 v[184:187], v14 offset:1280
 v_mfma_f32_16x16x32_bf16 v[156:159], v[68:71], v[56:59], v[156:159]
 ds_read2_b32 v[216:217], v18 offset0:48 offset1:49
 v_mfma_f32_16x16x32_bf16 v[144:147], v[72:75], v[40:43], v[144:147]
 ds_read2_b32 v[218:219], v18 offset0:50 offset1:51
 v_mfma_f32_16x16x32_bf16 v[148:151], v[72:75], v[44:47], v[148:151]
 ds_read_b128 v[188:191], v14 offset:1792
 v_mfma_f32_16x16x32_bf16 v[152:155], v[72:75], v[48:51], v[152:155]
 ds_read2_b32 v[220:221], v19 offset0:48 offset1:49
 v_mfma_f32_16x16x32_bf16 v[156:159], v[72:75], v[52:55], v[156:159]
 ds_read2_b32 v[222:223], v19 offset0:50 offset1:51
 v_mfma_f32_16x16x32_bf16 v[144:147], v[76:79], v[36:39], v[144:147]
 ds_read_b128 v[192:195], v14 offset:2304
 v_mfma_f32_16x16x32_bf16 v[148:151], v[76:79], v[40:43], v[148:151]
 ds_read2_b32 v[224:225], v20 offset0:48 offset1:49
 v_mfma_f32_16x16x32_bf16 v[152:155], v[76:79], v[44:47], v[152:155]
 ds_read2_b32 v[226:227], v20 offset0:50 offset1:51
 v_mfma_f32_16x16x32_bf16 v[156:159], v[76:79], v[48:51], v[156:159]
 ds_read_b128 v[196:199], v14 offset:2816
 v_mfma_f32_16x16x32_bf16 v[144:147], v[80:83], v[32:35], v[144:147]
 ds_read2_b32 v[228:229], v21 offset0:48 offset1:49
 v_mfma_f32_16x16x32_bf16 v[148:151], v[80:83], v[36:39], v[148:151]
 ds_read2_b32 v[230:231], v21 offset0:50 offset1:51
 v_mfma_f32_16x16x32_bf16 v[152:155], v[80:83], v[40:43], v[152:155]
 ds_read_b128 v[200:203], v14 offset:3328
 v_mfma_f32_16x16x32_bf16 v[156:159], v[80:83], v[44:47], v[156:159]
 ds_read2_b32 v[232:233], v22 offset0:48 offset1:49
 v_mfma_f32_16x16x32_bf16 v[148:151], v[84:87], v[32:35], v[148:151]
 ds_read2_b32 v[234:235], v22 offset0:50 offset1:51
 v_mfma_f32_16x16x32_bf16 v[152:155], v[84:87], v[36:39], v[152:155]
 ds_read_b128 v[204:207], v14 offset:3840
 v_mfma_f32_16x16x32_bf16 v[156:159], v[84:87], v[40:43], v[156:159]
 ds_read2_b32 v[236:237], v23 offset0:48 offset1:49
 v_mfma_f32_16x16x32_bf16 v[152:155], v[88:91], v[32:35], v[152:155]
 ds_read2_b32 v[238:239], v23 offset0:50 offset1:51
 v_mfma_f32_16x16x32_bf16 v[156:159], v[88:91], v[36:39], v[156:159]
 v_mfma_f32_16x16x32_bf16 v[156:159], v[92:95], v[32:35], v[156:159]
 s_waitcnt lgkmcnt(0)
 v_mfma_f32_16x16x32_bf16 v[144:147], v[208:211], v[192:195], v[144:147]
 ds_read_b128 v[32:35], v14 offset:192
 v_mfma_f32_16x16x32_bf16 v[148:151], v[208:211], v[196:199], v[148:151]
 ds_read2_b32 v[64:65], v16 offset0:64 offset1:65
 v_mfma_f32_16x16x32_bf16 v[152:155], v[208:211], v[200:203], v[152:155]
 ds_read2_b32 v[66:67], v16 offset0:66 offset1:67
 v_mfma_f32_16x16x32_bf16 v[156:159], v[208:211], v[204:207], v[156:159]
 ds_read_b128 v[36:39], v14 offset:704
 v_mfma_f32_16x16x32_bf16 v[144:147], v[212:215], v[188:191], v[144:147]
 ds_read2_b32 v[68:69], v17 offset0:64 offset1:65
 v_mfma_f32_16x16x32_bf16 v[148:151], v[212:215], v[192:195], v[148:151]
 ds_read2_b32 v[70:71], v17 offset0:66 offset1:67
 v_mfma_f32_16x16x32_bf16 v[152:155], v[212:215], v[196:199], v[152:155]
 ds_read_b128 v[40:43], v14 offset:1216
 v_mfma_f32_16x16x32_bf16 v[156:159], v[212:215], v[200:203], v[156:159]
 ds_read2_b32 v[72:73], v18 offset0:64 offset1:65
 v_mfma_f32_16x16x32_bf16 v[144:147], v[216:219], v[184:187], v[144:147]
 ds_read2_b32 v[74:75], v18 offset0:66 offset1:67
 v_mfma_f32_16x16x32_bf16 v[148:151], v[216:219], v[188:191], v[148:151]
 ds_read_b128 v[44:47], v14 offset:1728
 v_mfma_f32_16x16x32_bf16 v[152:155], v[216:219], v[192:195], v[152:155]
 ds_read2_b32 v[76:77], v19 offset0:64 offset1:65
 v_mfma_f32_16x16x32_bf16 v[156:159], v[216:219], v[196:199], v[156:159]
 ds_read2_b32 v[78:79], v19 offset0:66 offset1:67
 v_mfma_f32_16x16x32_bf16 v[144:147], v[220:223], v[180:183], v[144:147]
 ds_read_b128 v[48:51], v14 offset:2240
 v_mfma_f32_16x16x32_bf16 v[148:151], v[220:223], v[184:187], v[148:151]
 ds_read2_b32 v[80:81], v20 offset0:64 offset1:65
 v_mfma_f32_16x16x32_bf16 v[152:155], v[220:223], v[188:191], v[152:155]
 ds_read2_b32 v[82:83], v20 offset0:66 offset1:67
 v_mfma_f32_16x16x32_bf16 v[156:159], v[220:223], v[192:195], v[156:159]
 ds_read_b128 v[52:55], v14 offset:2752
 v_mfma_f32_16x16x32_bf16 v[144:147], v[224:227], v[176:179], v[144:147]
 ds_read2_b32 v[84:85], v21 offset0:64 offset1:65
 v_mfma_f32_16x16x32_bf16 v[148:151], v[224:227], v[180:183], v[148:151]
 ds_read2_b32 v[86:87], v21 offset0:66 offset1:67
 v_mfma_f32_16x16x32_bf16 v[152:155], v[224:227], v[184:187], v[152:155]
 ds_read_b128 v[56:59], v14 offset:3264
 v_mfma_f32_16x16x32_bf16 v[156:159], v[224:227], v[188:191], v[156:159]
 ds_read2_b32 v[88:89], v22 offset0:64 offset1:65
 v_mfma_f32_16x16x32_bf16 v[148:151], v[228:231], v[176:179], v[148:151]
 ds_read2_b32 v[90:91], v22 offset0:66 offset1:67
 v_mfma_f32_16x16x32_bf16 v[152:155], v[228:231], v[180:183], v[152:155]
 ds_read_b128 v[60:63], v14 offset:3776
 v_mfma_f32_16x16x32_bf16 v[156:159], v[228:231], v[184:187], v[156:159]
 ds_read2_b32 v[92:93], v23 offset0:64 offset1:65
 v_mfma_f32_16x16x32_bf16 v[152:155], v[232:235], v[176:179], v[152:155]
 ds_read2_b32 v[94:95], v23 offset0:66 offset1:67
 v_mfma_f32_16x16x32_bf16 v[156:159], v[232:235], v[180:183], v[156:159]
 v_mfma_f32_16x16x32_bf16 v[156:159], v[236:239], v[176:179], v[156:159]
 s_waitcnt lgkmcnt(0)
 v_mfma_f32_16x16x32_bf16 v[144:147], v[64:67], v[48:51], v[144:147]
 ds_read_b128 v[176:179], v14 offset:128
 v_mfma_f32_16x16x32_bf16 v[148:151], v[64:67], v[52:55], v[148:151]
 ds_read2_b32 v[208:209], v16 offset0:80 offset1:81
 v_mfma_f32_16x16x32_bf16 v[152:155], v[64:67], v[56:59], v[152:155]
 ds_read2_b32 v[210:211], v16 offset0:82 offset1:83
 v_mfma_f32_16x16x32_bf16 v[156:159], v[64:67], v[60:63], v[156:159]
 ds_read_b128 v[180:183], v14 offset:640
 v_mfma_f32_16x16x32_bf16 v[144:147], v[68:71], v[44:47], v[144:147]
 ds_read2_b32 v[212:213], v17 offset0:80 offset1:81
 v_mfma_f32_16x16x32_bf16 v[148:151], v[68:71], v[48:51], v[148:151]
 ds_read2_b32 v[214:215], v17 offset0:82 offset1:83
 v_mfma_f32_16x16x32_bf16 v[152:155], v[68:71], v[52:55], v[152:155]
 ds_read_b128 v[184:187], v14 offset:1152
 v_mfma_f32_16x16x32_bf16 v[156:159], v[68:71], v[56:59], v[156:159]
 ds_read2_b32 v[216:217], v18 offset0:80 offset1:81
 v_mfma_f32_16x16x32_bf16 v[144:147], v[72:75], v[40:43], v[144:147]
 ds_read2_b32 v[218:219], v18 offset0:82 offset1:83
 v_mfma_f32_16x16x32_bf16 v[148:151], v[72:75], v[44:47], v[148:151]
 ds_read_b128 v[188:191], v14 offset:1664
 v_mfma_f32_16x16x32_bf16 v[152:155], v[72:75], v[48:51], v[152:155]
 ds_read2_b32 v[220:221], v19 offset0:80 offset1:81
 v_mfma_f32_16x16x32_bf16 v[156:159], v[72:75], v[52:55], v[156:159]
 ds_read2_b32 v[222:223], v19 offset0:82 offset1:83
 v_mfma_f32_16x16x32_bf16 v[144:147], v[76:79], v[36:39], v[144:147]
 ds_read_b128 v[192:195], v14 offset:2176
 v_mfma_f32_16x16x32_bf16 v[148:151], v[76:79], v[40:43], v[148:151]
 ds_read2_b32 v[224:225], v20 offset0:80 offset1:81
 v_mfma_f32_16x16x32_bf16 v[152:155], v[76:79], v[44:47], v[152:155]
 ds_read2_b32 v[226:227], v20 offset0:82 offset1:83
 v_mfma_f32_16x16x32_bf16 v[156:159], v[76:79], v[48:51], v[156:159]
 ds_read_b128 v[196:199], v14 offset:2688
 v_mfma_f32_16x16x32_bf16 v[144:147], v[80:83], v[32:35], v[144:147]
 ds_read2_b32 v[228:229], v21 offset0:80 offset1:81
 v_mfma_f32_16x16x32_bf16 v[148:151], v[80:83], v[36:39], v[148:151]
 ds_read2_b32 v[230:231], v21 offset0:82 offset1:83
 v_mfma_f32_16x16x32_bf16 v[152:155], v[80:83], v[40:43], v[152:155]
 ds_read_b128 v[200:203], v14 offset:3200
 v_mfma_f32_16x16x32_bf16 v[156:159], v[80:83], v[44:47], v[156:159]
 ds_read2_b32 v[232:233], v22 offset0:80 offset1:81
 v_mfma_f32_16x16x32_bf16 v[148:151], v[84:87], v[32:35], v[148:151]
 ds_read2_b32 v[234:235], v22 offset0:82 offset1:83
 v_mfma_f32_16x16x32_bf16 v[152:155], v[84:87], v[36:39], v[152:155]
 ds_read_b128 v[204:207], v14 offset:3712
 v_mfma_f32_16x16x32_bf16 v[156:159], v[84:87], v[40:43], v[156:159]
 ds_read2_b32 v[236:237], v23 offset0:80 offset1:81
 v_mfma_f32_16x16x32_bf16 v[152:155], v[88:91], v[32:35], v[152:155]
 ds_read2_b32 v[238:239], v23 offset0:82 offset1:83
 v_mfma_f32_16x16x32_bf16 v[156:159], v[88:91], v[36:39], v[156:159]
 v_mfma_f32_16x16x32_bf16 v[156:159], v[92:95], v[32:35], v[156:159]
 s_waitcnt lgkmcnt(0)
 v_mfma_f32_16x16x32_bf16 v[144:147], v[208:211], v[192:195], v[144:147]
 ds_read_b128 v[32:35], v14 offset:64
 v_mfma_f32_16x16x32_bf16 v[148:151], v[208:211], v[196:199], v[148:151]
 ds_read2_b32 v[64:65], v16 offset0:96 offset1:97
 v_mfma_f32_16x16x32_bf16 v[152:155], v[208:211], v[200:203], v[152:155]
 ds_read2_b32 v[66:67], v16 offset0:98 offset1:99
 v_mfma_f32_16x16x32_bf16 v[156:159], v[208:211], v[204:207], v[156:159]
 ds_read_b128 v[36:39], v14 offset:576
 v_mfma_f32_16x16x32_bf16 v[144:147], v[212:215], v[188:191], v[144:147]
 ds_read2_b32 v[68:69], v17 offset0:96 offset1:97
 v_mfma_f32_16x16x32_bf16 v[148:151], v[212:215], v[192:195], v[148:151]
 ds_read2_b32 v[70:71], v17 offset0:98 offset1:99
 v_mfma_f32_16x16x32_bf16 v[152:155], v[212:215], v[196:199], v[152:155]
 ds_read_b128 v[40:43], v14 offset:1088
 v_mfma_f32_16x16x32_bf16 v[156:159], v[212:215], v[200:203], v[156:159]
 ds_read2_b32 v[72:73], v18 offset0:96 offset1:97
 v_mfma_f32_16x16x32_bf16 v[144:147], v[216:219], v[184:187], v[144:147]
 ds_read2_b32 v[74:75], v18 offset0:98 offset1:99
 v_mfma_f32_16x16x32_bf16 v[148:151], v[216:219], v[188:191], v[148:151]
 ds_read_b128 v[44:47], v14 offset:1600
 v_mfma_f32_16x16x32_bf16 v[152:155], v[216:219], v[192:195], v[152:155]
 ds_read2_b32 v[76:77], v19 offset0:96 offset1:97
 v_mfma_f32_16x16x32_bf16 v[156:159], v[216:219], v[196:199], v[156:159]
 ds_read2_b32 v[78:79], v19 offset0:98 offset1:99
 v_mfma_f32_16x16x32_bf16 v[144:147], v[220:223], v[180:183], v[144:147]
 ds_read_b128 v[48:51], v14 offset:2112
 v_mfma_f32_16x16x32_bf16 v[148:151], v[220:223], v[184:187], v[148:151]
 ds_read2_b32 v[80:81], v20 offset0:96 offset1:97
 v_mfma_f32_16x16x32_bf16 v[152:155], v[220:223], v[188:191], v[152:155]
 ds_read2_b32 v[82:83], v20 offset0:98 offset1:99
 v_mfma_f32_16x16x32_bf16 v[156:159], v[220:223], v[192:195], v[156:159]
 ds_read_b128 v[52:55], v14 offset:2624
 v_mfma_f32_16x16x32_bf16 v[144:147], v[224:227], v[176:179], v[144:147]
 ds_read2_b32 v[84:85], v21 offset0:96 offset1:97
 v_mfma_f32_16x16x32_bf16 v[148:151], v[224:227], v[180:183], v[148:151]
 ds_read2_b32 v[86:87], v21 offset0:98 offset1:99
 v_mfma_f32_16x16x32_bf16 v[152:155], v[224:227], v[184:187], v[152:155]
 ds_read_b128 v[56:59], v14 offset:3136
 v_mfma_f32_16x16x32_bf16 v[156:159], v[224:227], v[188:191], v[156:159]
 ds_read2_b32 v[88:89], v22 offset0:96 offset1:97
 v_mfma_f32_16x16x32_bf16 v[148:151], v[228:231], v[176:179], v[148:151]
 ds_read2_b32 v[90:91], v22 offset0:98 offset1:99
 v_mfma_f32_16x16x32_bf16 v[152:155], v[228:231], v[180:183], v[152:155]
 ds_read_b128 v[60:63], v14 offset:3648
 v_mfma_f32_16x16x32_bf16 v[156:159], v[228:231], v[184:187], v[156:159]
 ds_read2_b32 v[92:93], v23 offset0:96 offset1:97
 v_mfma_f32_16x16x32_bf16 v[152:155], v[232:235], v[176:179], v[152:155]
 ds_read2_b32 v[94:95], v23 offset0:98 offset1:99
 v_mfma_f32_16x16x32_bf16 v[156:159], v[232:235], v[180:183], v[156:159]
 v_mfma_f32_16x16x32_bf16 v[156:159], v[236:239], v[176:179], v[156:159]
 s_waitcnt lgkmcnt(0)
 v_mfma_f32_16x16x32_bf16 v[144:147], v[64:67], v[48:51], v[144:147]
 ds_read_b128 v[176:179], v14 offset:0
 v_mfma_f32_16x16x32_bf16 v[148:151], v[64:67], v[52:55], v[148:151]
 ds_read2_b32 v[208:209], v16 offset0:112 offset1:113
 v_mfma_f32_16x16x32_bf16 v[152:155], v[64:67], v[56:59], v[152:155]
 ds_read2_b32 v[210:211], v16 offset0:114 offset1:115
 v_mfma_f32_16x16x32_bf16 v[156:159], v[64:67], v[60:63], v[156:159]
 ds_read_b128 v[180:183], v14 offset:512
 v_mfma_f32_16x16x32_bf16 v[144:147], v[68:71], v[44:47], v[144:147]
 ds_read2_b32 v[212:213], v17 offset0:112 offset1:113
 v_mfma_f32_16x16x32_bf16 v[148:151], v[68:71], v[48:51], v[148:151]
 ds_read2_b32 v[214:215], v17 offset0:114 offset1:115
 v_mfma_f32_16x16x32_bf16 v[152:155], v[68:71], v[52:55], v[152:155]
 ds_read_b128 v[184:187], v14 offset:1024
 v_mfma_f32_16x16x32_bf16 v[156:159], v[68:71], v[56:59], v[156:159]
 ds_read2_b32 v[216:217], v18 offset0:112 offset1:113
 v_mfma_f32_16x16x32_bf16 v[144:147], v[72:75], v[40:43], v[144:147]
 ds_read2_b32 v[218:219], v18 offset0:114 offset1:115
 v_mfma_f32_16x16x32_bf16 v[148:151], v[72:75], v[44:47], v[148:151]
 ds_read_b128 v[188:191], v14 offset:1536
 v_mfma_f32_16x16x32_bf16 v[152:155], v[72:75], v[48:51], v[152:155]
 ds_read2_b32 v[220:221], v19 offset0:112 offset1:113
 v_mfma_f32_16x16x32_bf16 v[156:159], v[72:75], v[52:55], v[156:159]
 ds_read2_b32 v[222:223], v19 offset0:114 offset1:115
 v_mfma_f32_16x16x32_bf16 v[144:147], v[76:79], v[36:39], v[144:147]
 ds_read_b128 v[192:195], v14 offset:2048
 v_mfma_f32_16x16x32_bf16 v[148:151], v[76:79], v[40:43], v[148:151]
 ds_read2_b32 v[224:225], v20 offset0:112 offset1:113
 v_mfma_f32_16x16x32_bf16 v[152:155], v[76:79], v[44:47], v[152:155]
 ds_read2_b32 v[226:227], v20 offset0:114 offset1:115
 v_mfma_f32_16x16x32_bf16 v[156:159], v[76:79], v[48:51], v[156:159]
 ds_read_b128 v[196:199], v14 offset:2560
 v_mfma_f32_16x16x32_bf16 v[144:147], v[80:83], v[32:35], v[144:147]
 ds_read2_b32 v[228:229], v21 offset0:112 offset1:113
 v_mfma_f32_16x16x32_bf16 v[148:151], v[80:83], v[36:39], v[148:151]
 ds_read2_b32 v[230:231], v21 offset0:114 offset1:115
 v_mfma_f32_16x16x32_bf16 v[152:155], v[80:83], v[40:43], v[152:155]
 ds_read_b128 v[200:203], v14 offset:3072
 v_mfma_f32_16x16x32_bf16 v[156:159], v[80:83], v[44:47], v[156:159]
 ds_read2_b32 v[232:233], v22 offset0:112 offset1:113
 v_mfma_f32_16x16x32_bf16 v[148:151], v[84:87], v[32:35], v[148:151]
 ds_read2_b32 v[234:235], v22 offset0:114 offset1:115
 v_mfma_f32_16x16x32_bf16 v[152:155], v[84:87], v[36:39], v[152:155]
 ds_read_b128 v[204:207], v14 offset:3584
 v_mfma_f32_16x16x32_bf16 v[156:159], v[84:87], v[40:43], v[156:159]
 ds_read2_b32 v[236:237], v23 offset0:112 offset1:113
 v_mfma_f32_16x16x32_bf16 v[152:155], v[88:91], v[32:35], v[152:155]
 ds_read2_b32 v[238:239], v23 offset0:114 offset1:115
 v_mfma_f32_16x16x32_bf16 v[156:159], v[88:91], v[36:39], v[156:159]
 v_mfma_f32_16x16x32_bf16 v[156:159], v[92:95], v[32:35], v[156:159]
 s_waitcnt lgkmcnt(0)
 v_mfma_f32_16x16x32_bf16 v[144:147], v[208:211], v[192:195], v[144:147]
 ds_read_b64 v[32:33], v15 offset:2048
 v_mfma_f32_16x16x32_bf16 v[148:151], v[208:211], v[196:199], v[148:151]
 ds_read_b64 v[34:35], v15 offset:2560
 v_mfma_f32_16x16x32_bf16 v[152:155], v[208:211], v[200:203], v[152:155]
 ds_read_b64 v[36:37], v15 offset:3072
 v_mfma_f32_16x16x32_bf16 v[156:159], v[208:211], v[204:207], v[156:159]
 ds_read_b64 v[38:39], v15 offset:3584
 v_mfma_f32_16x16x32_bf16 v[144:147], v[212:215], v[188:191], v[144:147]
 v_mfma_f32_16x16x32_bf16 v[148:151], v[212:215], v[192:195], v[148:151]
 v_mfma_f32_16x16x32_bf16 v[152:155], v[212:215], v[196:199], v[152:155]
 v_mfma_f32_16x16x32_bf16 v[156:159], v[212:215], v[200:203], v[156:159]
 v_mfma_f32_16x16x32_bf16 v[144:147], v[216:219], v[184:187], v[144:147]
 v_mfma_f32_16x16x32_bf16 v[148:151], v[216:219], v[188:191], v[148:151]
 v_mfma_f32_16x16x32_bf16 v[152:155], v[216:219], v[192:195], v[152:155]
 v_mfma_f32_16x16x32_bf16 v[156:159], v[216:219], v[196:199], v[156:159]
 v_mfma_f32_16x16x32_bf16 v[144:147], v[220:223], v[180:183], v[144:147]
 v_mfma_f32_16x16x32_bf16 v[148:151], v[220:223], v[184:187], v[148:151]
 v_mfma_f32_16x16x32_bf16 v[152:155], v[220:223], v[188:191], v[152:155]
 v_mfma_f32_16x16x32_bf16 v[156:159], v[220:223], v[192:195], v[156:159]
 v_mfma_f32_16x16x32_bf16 v[144:147], v[224:227], v[176:179], v[144:147]
 v_mfma_f32_16x16x32_bf16 v[148:151], v[224:227], v[180:183], v[148:151]
 v_mfma_f32_16x16x32_bf16 v[152:155], v[224:227], v[184:187], v[152:155]
 v_mfma_f32_16x16x32_bf16 v[156:159], v[224:227], v[188:191], v[156:159]
 v_mfma_f32_16x16x32_bf16 v[148:151], v[228:231], v[176:179], v[148:151]
 v_mfma_f32_16x16x32_bf16 v[152:155], v[228:231], v[180:183], v[152:155]
 v_mfma_f32_16x16x32_bf16 v[156:159], v[228:231], v[184:187], v[156:159]
 v_mfma_f32_16x16x32_bf16 v[152:155], v[232:235], v[176:179], v[152:155]
 v_mfma_f32_16x16x32_bf16 v[156:159], v[232:235], v[180:183], v[156:159]
 v_mfma_f32_16x16x32_bf16 v[156:159], v[236:239], v[176:179], v[156:159]
 s_waitcnt lgkmcnt(0)
 v_and_b32 v64, 0xffff0000, v33
 v_lshlrev_b32 v65, 16, v33
 v_and_b32 v66, 0xffff0000, v32
 v_lshlrev_b32 v67, 16, v32
 v_mul_f32 v64, v64, v12
 v_mul_f32 v65, v65, v12
 v_mul_f32 v66, v66, v12
 v_mul_f32 v67, v67, v12
 v_and_b32 v68, 0xffff0000, v35
 v_lshlrev_b32 v69, 16, v35
 v_and_b32 v70, 0xffff0000, v34
 v_lshlrev_b32 v71, 16, v34
 v_mul_f32 v68, v68, v12
 v_mul_f32 v69, v69, v12
 v_mul_f32 v70, v70, v12
 v_mul_f32 v71, v71, v12
 v_and_b32 v72, 0xffff0000, v37
 v_lshlrev_b32 v73, 16, v37
 v_and_b32 v74, 0xffff0000, v36
 v_lshlrev_b32 v75, 16, v36
 v_mul_f32 v72, v72, v12
 v_mul_f32 v73, v73, v12
 v_mul_f32 v74, v74, v12
 v_mul_f32 v75, v75, v12
 v_and_b32 v76, 0xffff0000, v39
 v_lshlrev_b32 v77, 16, v39
 v_and_b32 v78, 0xffff0000, v38
 v_lshlrev_b32 v79, 16, v38
 v_mul_f32 v76, v76, v12
 v_mul_f32 v77, v77, v12
 v_mul_f32 v78, v78, v12
 v_mul_f32 v79, v79, v12
 v_cvt_pk_bf16_f32 v8, v64, v65
 v_lshlrev_b32 v64, 16, v8
 v_and_b32 v65, 0xffff0000, v8
 v_cvt_pk_bf16_f32 v8, v66, v67
 v_lshlrev_b32 v66, 16, v8
 v_and_b32 v67, 0xffff0000, v8
 v_cvt_pk_bf16_f32 v8, v68, v69
 v_lshlrev_b32 v68, 16, v8
 v_and_b32 v69, 0xffff0000, v8
 v_cvt_pk_bf16_f32 v8, v70, v71
 v_lshlrev_b32 v70, 16, v8
 v_and_b32 v71, 0xffff0000, v8
 v_cvt_pk_bf16_f32 v8, v72, v73
 v_lshlrev_b32 v72, 16, v8
 v_and_b32 v73, 0xffff0000, v8
 v_cvt_pk_bf16_f32 v8, v74, v75
 v_lshlrev_b32 v74, 16, v8
 v_and_b32 v75, 0xffff0000, v8
 v_cvt_pk_bf16_f32 v8, v76, v77
 v_lshlrev_b32 v76, 16, v8
 v_and_b32 v77, 0xffff0000, v8
 v_cvt_pk_bf16_f32 v8, v78, v79
 v_lshlrev_b32 v78, 16, v8
 v_and_b32 v79, 0xffff0000, v8
 v_cvt_pk_bf16_f32 v8, v144, v145
 v_lshlrev_b32 v144, 16, v8
 v_and_b32 v145, 0xffff0000, v8
 v_cvt_pk_bf16_f32 v8, v146, v147
 v_lshlrev_b32 v146, 16, v8
 v_and_b32 v147, 0xffff0000, v8
 v_cvt_pk_bf16_f32 v8, v148, v149
 v_lshlrev_b32 v148, 16, v8
 v_and_b32 v149, 0xffff0000, v8
 v_cvt_pk_bf16_f32 v8, v150, v151
 v_lshlrev_b32 v150, 16, v8
 v_and_b32 v151, 0xffff0000, v8
 v_cvt_pk_bf16_f32 v8, v152, v153
 v_lshlrev_b32 v152, 16, v8
 v_and_b32 v153, 0xffff0000, v8
 v_cvt_pk_bf16_f32 v8, v154, v155
 v_lshlrev_b32 v154, 16, v8
 v_and_b32 v155, 0xffff0000, v8
 v_cvt_pk_bf16_f32 v8, v156, v157
 v_lshlrev_b32 v156, 16, v8
 v_and_b32 v157, 0xffff0000, v8
 v_cvt_pk_bf16_f32 v8, v158, v159
 v_lshlrev_b32 v158, 16, v8
 v_and_b32 v159, 0xffff0000, v8
 v_pk_add_f32 v[144:145], v[144:145], v[64:65]
 v_pk_add_f32 v[146:147], v[146:147], v[66:67]
 v_pk_add_f32 v[148:149], v[148:149], v[68:69]
 v_pk_add_f32 v[150:151], v[150:151], v[70:71]
 v_pk_add_f32 v[152:153], v[152:153], v[72:73]
 v_pk_add_f32 v[154:155], v[154:155], v[74:75]
 v_pk_add_f32 v[156:157], v[156:157], v[76:77]
 v_pk_add_f32 v[158:159], v[158:159], v[78:79]
 v_cvt_pk_bf16_f32 v160, v144, v148
 v_cvt_pk_bf16_f32 v161, v152, v156
 buffer_store_dwordx2 v[160:161], v13, s[4:7], s72 offen sc1
 s_add_u32 s72, s72, 40960
 v_cvt_pk_bf16_f32 v162, v145, v149
 v_cvt_pk_bf16_f32 v163, v153, v157
 buffer_store_dwordx2 v[162:163], v13, s[4:7], s72 offen sc1
 s_add_u32 s72, s72, 40960
 v_cvt_pk_bf16_f32 v164, v146, v150
 v_cvt_pk_bf16_f32 v165, v154, v158
 buffer_store_dwordx2 v[164:165], v13, s[4:7], s72 offen sc1
 s_add_u32 s72, s72, 40960
 v_cvt_pk_bf16_f32 v166, v147, v151
 v_cvt_pk_bf16_f32 v167, v155, v159
 buffer_store_dwordx2 v[166:167], v13, s[4:7], s72 offen sc1
 s_add_u32 s72, s72, 40960
 s_cmp_lt_u32 s70, 640
 s_cbranch_scc1 L_cv_5
 s_setpc_b64 s[76:77]
L_helper:
 s_lshl_b32 s60, s82, 2
 s_add_u32 s60, s60, s50
 s_mov_b32 s72, s60
 s_mov_b32 s8, s16
 s_and_b32 s9, s17, 0xffff
 s_mov_b32 s10, 2621440
 s_mov_b32 s11, 0x00020000
 v_lshlrev_b32 v1, 4, v0
 v_lshlrev_b32 v2, 3, v0
 v_cmp_lt_u32 vcc, 31, v0
 v_mov_b32 v3, 268435456
 s_nop 1
 v_cndmask_b32 v7, v2, v3, vcc
 s_mov_b32 s63, 0x3acccccd
 s_mov_b32 s68, 0x3727c5ac
 s_add_u32 s3, s72, 0
 s_mul_i32 s3, s3, 1280
 buffer_load_dwordx2 v[48:49], v2, s[8:11], s3 offen offset:0
 buffer_load_dwordx2 v[50:51], v2, s[8:11], s3 offen offset:512
 buffer_load_dwordx2 v[52:53], v7, s[8:11], s3 offen offset:1024
 v_mov_b32 v12, 0
 v_mov_b32 v13, 0
 v_mov_b32 v14, 0
 v_mov_b32 v15, 0
 s_lshl_b32 s73, s60, 10
 s_add_u32 s73, s73, 0
L_cl_6:
 s_cmp_ge_u32 s73, 225280
 s_cbranch_scc1 L_cle_7
 buffer_store_dwordx4 v[12:15], v1, s[4:7], s73 offen sc1
 s_add_u32 s73, s73, 393216
 s_branch L_cl_6
L_cle_7:
 s_nop 1
 s_waitcnt vmcnt(0)
L_ln_8:
 v_lshlrev_b32 v12, 16, v48
 v_and_b32 v13, 0xffff0000, v48
 v_lshlrev_b32 v14, 16, v49
 v_and_b32 v15, 0xffff0000, v49
 v_lshlrev_b32 v16, 16, v50
 v_and_b32 v17, 0xffff0000, v50
 v_lshlrev_b32 v18, 16, v51
 v_and_b32 v19, 0xffff0000, v51
 v_lshlrev_b32 v20, 16, v52
 v_and_b32 v21, 0xffff0000, v52
 v_lshlrev_b32 v22, 16, v53
 v_and_b32 v23, 0xffff0000, v53
 s_and_b32 s3, s72, 15
 v_lshrrev_b32 v4, 3, v0
 v_lshlrev_b32 v4, 2, v4
 v_and_b32 v9, 3, v0
 v_add_u32 v4, v4, v9
 v_xor_b32 v4, s3, v4
 v_lshlrev_b32 v4, 4, v4
 v_and_b32 v9, 4, v0
 v_lshl_add_u32 v4, v9, 1, v4
 v_cndmask_b32 v8, v4, v3, vcc
 v_readfirstlane_b32 s3, v12
 s_nop 1
 v_subrev_f32 v36, s3, v12
 v_subrev_f32 v37, s3, v13
 v_subrev_f32 v38, s3, v14
 v_subrev_f32 v39, s3, v15
 v_subrev_f32 v40, s3, v16
 v_subrev_f32 v41, s3, v17
 v_subrev_f32 v42, s3, v18
 v_subrev_f32 v43, s3, v19
 v_mov_b32 v44, 0
 v_mov_b32 v45, 0
 v_mov_b32 v46, 0
 v_mov_b32 v47, 0
 s_mov_b32 exec_hi, 0
 v_subrev_f32 v44, s3, v20
 v_subrev_f32 v45, s3, v21
 v_subrev_f32 v46, s3, v22
 v_subrev_f32 v47, s3, v23
 s_mov_b32 exec_hi, -1
 v_pk_mul_f32 v[10:11], v[36:37], v[36:37]
 v_pk_fma_f32 v[10:11], v[38:39], v[38:39], v[10:11]
 v_pk_fma_f32 v[10:11], v[40:41], v[40:41], v[10:11]
 v_pk_fma_f32 v[10:11], v[42:43], v[42:43], v[10:11]
 v_pk_fma_f32 v[10:11], v[44:45], v[44:45], v[10:11]
 v_pk_fma_f32 v[10:11], v[46:47], v[46:47], v[10:11]
 v_pk_add_f32 v[36:37], v[36:37], v[38:39]
 v_pk_add_f32 v[36:37], v[36:37], v[40:41]
 v_pk_add_f32 v[36:37], v[36:37], v[42:43]
 v_pk_add_f32 v[36:37], v[36:37], v[44:45]
 v_pk_add_f32 v[36:37], v[36:37], v[46:47]
 v_add_f32 v11, v10, v11
 v_add_f32 v10, v36, v37
 s_nop 0
 v_add_f32_dpp v11, v11, v11 quad_perm:[1,0,3,2] row_mask:0xf bank_mask:0xf
 v_add_f32_dpp v10, v10, v10 quad_perm:[1,0,3,2] row_mask:0xf bank_mask:0xf
 s_nop 0
 v_add_f32_dpp v11, v11, v11 quad_perm:[2,3,0,1] row_mask:0xf bank_mask:0xf
 v_add_f32_dpp v10, v10, v10 quad_perm:[2,3,0,1] row_mask:0xf bank_mask:0xf
 s_nop 0
 v_add_f32_dpp v11, v11, v11 row_half_mirror row_mask:0xf bank_mask:0xf
 v_add_f32_dpp v10, v10, v10 row_half_mirror row_mask:0xf bank_mask:0xf
 s_nop 0
 v_add_f32_dpp v11, v11, v11 row_mirror row_mask:0xf bank_mask:0xf
 v_add_f32_dpp v10, v10, v10 row_mirror row_mask:0xf bank_mask:0xf
 v_mov_b32 v37, v11
 v_mov_b32 v36, v10
 s_nop 0
 v_permlane16_swap_b32 v11, v37
 v_permlane16_swap_b32 v10, v36
 v_pk_add_f32 v[10:11], v[10:11], v[36:37]
 v_mov_b32 v37, v11
 v_mov_b32 v36, v10
 s_nop 0
 v_permlane32_swap_b32 v11, v37
 v_permlane32_swap_b32 v10, v36
 v_pk_add_f32 v[10:11], v[10:11], v[36:37]
 v_mul_f32 v10, s63, v10
 v_mul_f32 v11, s63, v11
 v_fma_f32 v11, -v10, v10, v11
 v_max_f32 v11, 0, v11
 v_add_f32 v10, s3, v10
 v_cvt_pk_bf16_f32 v9, v10, v11
 v_lshlrev_b32 v10, 16, v9
 v_and_b32 v11, 0xffff0000, v9
 v_add_f32 v11, s68, v11
 v_cvt_pk_bf16_f32 v11, v11, v11
 v_and_b32 v11, 0xffff0000, v11
 v_sqrt_f32 v11, v11
 s_nop 0
 v_pk_add_f32 v[36:37], v[12:13], v[10:11] op_sel_hi:[1,0] neg_lo:[0,1] neg_hi:[0,1]
 v_pk_add_f32 v[38:39], v[14:15], v[10:11] op_sel_hi:[1,0] neg_lo:[0,1] neg_hi:[0,1]
 v_pk_add_f32 v[40:41], v[16:17], v[10:11] op_sel_hi:[1,0] neg_lo:[0,1] neg_hi:[0,1]
 v_pk_add_f32 v[42:43], v[18:19], v[10:11] op_sel_hi:[1,0] neg_lo:[0,1] neg_hi:[0,1]
 v_pk_add_f32 v[44:45], v[20:21], v[10:11] op_sel_hi:[1,0] neg_lo:[0,1] neg_hi:[0,1]
 v_pk_add_f32 v[46:47], v[22:23], v[10:11] op_sel_hi:[1,0] neg_lo:[0,1] neg_hi:[0,1]
 v_cvt_pk_bf16_f32 v11, v11, v11
 v_and_b32 v11, 0xffff0000, v11
 v_rcp_f32 v11, v11
 v_cvt_pk_bf16_f32 v9, v36, v37
 v_lshlrev_b32 v36, 16, v9
 v_and_b32 v37, 0xffff0000, v9
 v_cvt_pk_bf16_f32 v9, v38, v39
 v_lshlrev_b32 v38, 16, v9
 v_and_b32 v39, 0xffff0000, v9
 v_cvt_pk_bf16_f32 v9, v40, v41
 v_lshlrev_b32 v40, 16, v9
 v_and_b32 v41, 0xffff0000, v9
 v_cvt_pk_bf16_f32 v9, v42, v43
 v_lshlrev_b32 v42, 16, v9
 v_and_b32 v43, 0xffff0000, v9
 v_cvt_pk_bf16_f32 v9, v44, v45
 v_lshlrev_b32 v44, 16, v9
 v_and_b32 v45, 0xffff0000, v9
 v_cvt_pk_bf16_f32 v9, v46, v47
 v_lshlrev_b32 v46, 16, v9
 v_and_b32 v47, 0xffff0000, v9
 v_pk_mul_f32 v[36:37], v[36:37], v[10:11] op_sel:[0,1] op_sel_hi:[1,1]
 v_pk_mul_f32 v[38:39], v[38:39], v[10:11] op_sel:[0,1] op_sel_hi:[1,1]
 v_pk_mul_f32 v[40:41], v[40:41], v[10:11] op_sel:[0,1] op_sel_hi:[1,1]
 v_pk_mul_f32 v[42:43], v[42:43], v[10:11] op_sel:[0,1] op_sel_hi:[1,1]
 v_pk_mul_f32 v[44:45], v[44:45], v[10:11] op_sel:[0,1] op_sel_hi:[1,1]
 v_pk_mul_f32 v[46:47], v[46:47], v[10:11] op_sel:[0,1] op_sel_hi:[1,1]
 v_cvt_pk_bf16_f32 v24, v36, v37
 v_cvt_pk_bf16_f32 v25, v38, v39
 v_cvt_pk_bf16_f32 v26, v40, v41
 v_cvt_pk_bf16_f32 v27, v42, v43
 v_cvt_pk_bf16_f32 v28, v44, v45
 v_cvt_pk_bf16_f32 v29, v46, v47
 s_mul_i32 s3, s72, 1280
 s_add_u32 s3, s3, 226492416
 buffer_store_dwordx2 v[24:25], v4, s[4:7], s3 offen offset:0 sc1
 buffer_store_dwordx2 v[26:27], v4, s[4:7], s3 offen offset:512 sc1
 buffer_store_dwordx2 v[28:29], v8, s[4:7], s3 offen offset:1024 sc1
 s_waitcnt vmcnt(0)
 s_barrier
 s_cmp_lg_u32 s50, 3
 s_cbranch_scc1 L_ar_9
 s_mov_b32 s96, s44
 s_and_b32 s97, s45, 0xffff
 s_mov_b32 s98, 256
 s_mov_b32 s99, 0x00020000
 v_mov_b32 v1, 1
 s_mov_b64 exec, 1
 buffer_atomic_add v1, off, s[96:99], 0 offset:4 sc0
 s_waitcnt vmcnt(0)
 v_cmp_eq_u32 vcc, 95, v1
 s_cbranch_vccz L_aw_10
 buffer_store_dword v1, off, s[96:99], 0 offset:132 sc1
L_aw_10:
 s_mov_b64 exec, -1
L_ar_9:
 s_cmp_lt_u32 s82, 72
 s_cbranch_scc1 L_np_11
 s_sub_u32 s60, s60, 288
 v_lshlrev_b32 v1, 4, v0
 v_mov_b32 v12, 0
 v_mov_b32 v13, 0
 v_mov_b32 v14, 0
 v_mov_b32 v15, 0
 s_lshl_b32 s73, s60, 10
 s_add_u32 s73, s73, 225280
L_cl_12:
 s_cmp_ge_u32 s73, 946176
 s_cbranch_scc1 L_cle_13
 buffer_store_dwordx4 v[12:15], v1, s[4:7], s73 offen sc1
 s_add_u32 s73, s73, 98304
 s_branch L_cl_12
L_cle_13:
 s_nop 1
 v_mov_b32 v12, -1
 v_mov_b32 v13, -1
 v_mov_b32 v14, -1
 v_mov_b32 v15, -1
 s_lshl_b32 s73, s60, 10
 s_add_u32 s73, s73, 983040
L_cl_14:
 s_cmp_ge_u32 s73, 2162688
 s_cbranch_scc1 L_cle_15
 buffer_store_dwordx4 v[12:15], v1, s[4:7], s73 offen sc1
 s_add_u32 s73, s73, 98304
 s_branch L_cl_14
L_cle_15:
 s_nop 1
 s_waitcnt vmcnt(19)
 s_waitcnt vmcnt(0)
 s_barrier
 s_cmp_lg_u32 s50, 3
 s_cbranch_scc1 L_ar_16
 s_mov_b32 s96, s44
 s_and_b32 s97, s45, 0xffff
 s_mov_b32 s98, 256
 s_mov_b32 s99, 0x00020000
 v_mov_b32 v1, 1
 s_mov_b64 exec, 1
 buffer_atomic_add v1, off, s[96:99], 0 offset:84 sc0
 s_waitcnt vmcnt(0)
 v_cmp_eq_u32 vcc, 23, v1
 s_cbranch_vccz L_aw_17
 buffer_store_dword v1, off, s[96:99], 0 offset:212 sc1
L_aw_17:
 s_mov_b64 exec, -1
L_ar_16:
 s_add_u32 s60, s60, 288
 s_cmp_lt_u32 s82, 80
 s_cbranch_scc1 L_np_11
 s_add_u32 s72, s60, 64
 s_mov_b32 s8, s16
 s_and_b32 s9, s17, 0xffff
 s_mov_b32 s10, 2621440
 s_mov_b32 s11, 0x00020000
 v_lshlrev_b32 v1, 4, v0
 v_lshlrev_b32 v2, 3, v0
 v_cmp_lt_u32 vcc, 31, v0
 v_mov_b32 v3, 268435456
 s_nop 1
 v_cndmask_b32 v7, v2, v3, vcc
 s_mov_b32 s63, 0x3acccccd
 s_mov_b32 s68, 0x3727c5ac
 s_add_u32 s3, s72, 0
 s_mul_i32 s3, s3, 1280
 buffer_load_dwordx2 v[48:49], v2, s[8:11], s3 offen offset:0
 buffer_load_dwordx2 v[50:51], v2, s[8:11], s3 offen offset:512
 buffer_load_dwordx2 v[52:53], v7, s[8:11], s3 offen offset:1024
 s_waitcnt vmcnt(0)
L_ln_18:
 v_lshlrev_b32 v12, 16, v48
 v_and_b32 v13, 0xffff0000, v48
 v_lshlrev_b32 v14, 16, v49
 v_and_b32 v15, 0xffff0000, v49
 v_lshlrev_b32 v16, 16, v50
 v_and_b32 v17, 0xffff0000, v50
 v_lshlrev_b32 v18, 16, v51
 v_and_b32 v19, 0xffff0000, v51
 v_lshlrev_b32 v20, 16, v52
 v_and_b32 v21, 0xffff0000, v52
 v_lshlrev_b32 v22, 16, v53
 v_and_b32 v23, 0xffff0000, v53
 s_add_u32 s3, s72, 64
 s_mul_i32 s3, s3, 1280
 buffer_load_dwordx2 v[48:49], v2, s[8:11], s3 offen offset:0
 buffer_load_dwordx2 v[50:51], v2, s[8:11], s3 offen offset:512
 buffer_load_dwordx2 v[52:53], v7, s[8:11], s3 offen offset:1024
 s_and_b32 s3, s72, 15
 v_lshrrev_b32 v4, 3, v0
 v_lshlrev_b32 v4, 2, v4
 v_and_b32 v9, 3, v0
 v_add_u32 v4, v4, v9
 v_xor_b32 v4, s3, v4
 v_lshlrev_b32 v4, 4, v4
 v_and_b32 v9, 4, v0
 v_lshl_add_u32 v4, v9, 1, v4
 v_cndmask_b32 v8, v4, v3, vcc
 v_readfirstlane_b32 s3, v12
 s_nop 1
 v_subrev_f32 v36, s3, v12
 v_subrev_f32 v37, s3, v13
 v_subrev_f32 v38, s3, v14
 v_subrev_f32 v39, s3, v15
 v_subrev_f32 v40, s3, v16
 v_subrev_f32 v41, s3, v17
 v_subrev_f32 v42, s3, v18
 v_subrev_f32 v43, s3, v19
 v_mov_b32 v44, 0
 v_mov_b32 v45, 0
 v_mov_b32 v46, 0
 v_mov_b32 v47, 0
 s_mov_b32 exec_hi, 0
 v_subrev_f32 v44, s3, v20
 v_subrev_f32 v45, s3, v21
 v_subrev_f32 v46, s3, v22
 v_subrev_f32 v47, s3, v23
 s_mov_b32 exec_hi, -1
 v_pk_mul_f32 v[10:11], v[36:37], v[36:37]
 v_pk_fma_f32 v[10:11], v[38:39], v[38:39], v[10:11]
 v_pk_fma_f32 v[10:11], v[40:41], v[40:41], v[10:11]
 v_pk_fma_f32 v[10:11], v[42:43], v[42:43], v[10:11]
 v_pk_fma_f32 v[10:11], v[44:45], v[44:45], v[10:11]
 v_pk_fma_f32 v[10:11], v[46:47], v[46:47], v[10:11]
 v_pk_add_f32 v[36:37], v[36:37], v[38:39]
 v_pk_add_f32 v[36:37], v[36:37], v[40:41]
 v_pk_add_f32 v[36:37], v[36:37], v[42:43]
 v_pk_add_f32 v[36:37], v[36:37], v[44:45]
 v_pk_add_f32 v[36:37], v[36:37], v[46:47]
 v_add_f32 v11, v10, v11
 v_add_f32 v10, v36, v37
 s_nop 0
 v_add_f32_dpp v11, v11, v11 quad_perm:[1,0,3,2] row_mask:0xf bank_mask:0xf
 v_add_f32_dpp v10, v10, v10 quad_perm:[1,0,3,2] row_mask:0xf bank_mask:0xf
 s_nop 0
 v_add_f32_dpp v11, v11, v11 quad_perm:[2,3,0,1] row_mask:0xf bank_mask:0xf
 v_add_f32_dpp v10, v10, v10 quad_perm:[2,3,0,1] row_mask:0xf bank_mask:0xf
 s_nop 0
 v_add_f32_dpp v11, v11, v11 row_half_mirror row_mask:0xf bank_mask:0xf
 v_add_f32_dpp v10, v10, v10 row_half_mirror row_mask:0xf bank_mask:0xf
 s_nop 0
 v_add_f32_dpp v11, v11, v11 row_mirror row_mask:0xf bank_mask:0xf
 v_add_f32_dpp v10, v10, v10 row_mirror row_mask:0xf bank_mask:0xf
 v_mov_b32 v37, v11
 v_mov_b32 v36, v10
 s_nop 0
 v_permlane16_swap_b32 v11, v37
 v_permlane16_swap_b32 v10, v36
 v_pk_add_f32 v[10:11], v[10:11], v[36:37]
 v_mov_b32 v37, v11
 v_mov_b32 v36, v10
 s_nop 0
 v_permlane32_swap_b32 v11, v37
 v_permlane32_swap_b32 v10, v36
 v_pk_add_f32 v[10:11], v[10:11], v[36:37]
 v_mul_f32 v10, s63, v10
 v_mul_f32 v11, s63, v11
 v_fma_f32 v11, -v10, v10, v11
 v_max_f32 v11, 0, v11
 v_add_f32 v10, s3, v10
 v_cvt_pk_bf16_f32 v9, v10, v11
 v_lshlrev_b32 v10, 16, v9
 v_and_b32 v11, 0xffff0000, v9
 v_add_f32 v11, s68, v11
 v_cvt_pk_bf16_f32 v11, v11, v11
 v_and_b32 v11, 0xffff0000, v11
 v_sqrt_f32 v11, v11
 s_nop 0
 v_pk_add_f32 v[36:37], v[12:13], v[10:11] op_sel_hi:[1,0] neg_lo:[0,1] neg_hi:[0,1]
 v_pk_add_f32 v[38:39], v[14:15], v[10:11] op_sel_hi:[1,0] neg_lo:[0,1] neg_hi:[0,1]
 v_pk_add_f32 v[40:41], v[16:17], v[10:11] op_sel_hi:[1,0] neg_lo:[0,1] neg_hi:[0,1]
 v_pk_add_f32 v[42:43], v[18:19], v[10:11] op_sel_hi:[1,0] neg_lo:[0,1] neg_hi:[0,1]
 v_pk_add_f32 v[44:45], v[20:21], v[10:11] op_sel_hi:[1,0] neg_lo:[0,1] neg_hi:[0,1]
 v_pk_add_f32 v[46:47], v[22:23], v[10:11] op_sel_hi:[1,0] neg_lo:[0,1] neg_hi:[0,1]
 v_cvt_pk_bf16_f32 v11, v11, v11
 v_and_b32 v11, 0xffff0000, v11
 v_rcp_f32 v11, v11
 v_cvt_pk_bf16_f32 v9, v36, v37
 v_lshlrev_b32 v36, 16, v9
 v_and_b32 v37, 0xffff0000, v9
 v_cvt_pk_bf16_f32 v9, v38, v39
 v_lshlrev_b32 v38, 16, v9
 v_and_b32 v39, 0xffff0000, v9
 v_cvt_pk_bf16_f32 v9, v40, v41
 v_lshlrev_b32 v40, 16, v9
 v_and_b32 v41, 0xffff0000, v9
 v_cvt_pk_bf16_f32 v9, v42, v43
 v_lshlrev_b32 v42, 16, v9
 v_and_b32 v43, 0xffff0000, v9
 v_cvt_pk_bf16_f32 v9, v44, v45
 v_lshlrev_b32 v44, 16, v9
 v_and_b32 v45, 0xffff0000, v9
 v_cvt_pk_bf16_f32 v9, v46, v47
 v_lshlrev_b32 v46, 16, v9
 v_and_b32 v47, 0xffff0000, v9
 v_pk_mul_f32 v[36:37], v[36:37], v[10:11] op_sel:[0,1] op_sel_hi:[1,1]
 v_pk_mul_f32 v[38:39], v[38:39], v[10:11] op_sel:[0,1] op_sel_hi:[1,1]
 v_pk_mul_f32 v[40:41], v[40:41], v[10:11] op_sel:[0,1] op_sel_hi:[1,1]
 v_pk_mul_f32 v[42:43], v[42:43], v[10:11] op_sel:[0,1] op_sel_hi:[1,1]
 v_pk_mul_f32 v[44:45], v[44:45], v[10:11] op_sel:[0,1] op_sel_hi:[1,1]
 v_pk_mul_f32 v[46:47], v[46:47], v[10:11] op_sel:[0,1] op_sel_hi:[1,1]
 v_cvt_pk_bf16_f32 v24, v36, v37
 v_cvt_pk_bf16_f32 v25, v38, v39
 v_cvt_pk_bf16_f32 v26, v40, v41
 v_cvt_pk_bf16_f32 v27, v42, v43
 v_cvt_pk_bf16_f32 v28, v44, v45
 v_cvt_pk_bf16_f32 v29, v46, v47
 s_mul_i32 s3, s72, 1280
 s_add_u32 s3, s3, 226492416
 buffer_store_dwordx2 v[24:25], v4, s[4:7], s3 offen offset:0 sc1
 buffer_store_dwordx2 v[26:27], v4, s[4:7], s3 offen offset:512 sc1
 buffer_store_dwordx2 v[28:29], v8, s[4:7], s3 offen offset:1024 sc1
 s_add_u32 s72, s72, 64
 s_waitcnt vmcnt(3)
 s_cmp_lt_u32 s72, 1024
 s_cbranch_scc1 L_ln_18
 s_waitcnt vmcnt(0)
 s_barrier
 s_cmp_lg_u32 s50, 3
 s_cbranch_scc1 L_ar_19
 s_mov_b32 s96, s44
 s_and_b32 s97, s45, 0xffff
 s_mov_b32 s98, 256
 s_mov_b32 s99, 0x00020000
 v_mov_b32 v1, 1
 s_mov_b64 exec, 1
 buffer_atomic_add v1, off, s[96:99], 0 offset:72 sc0
 s_waitcnt vmcnt(0)
 v_cmp_eq_u32 vcc, 15, v1
 s_cbranch_vccz L_aw_20
 buffer_store_dword v1, off, s[96:99], 0 offset:200 sc1
L_aw_20:
 s_mov_b64 exec, -1
L_ar_19:
L_help_ln2:
 s_cmp_lg_u32 s50, 0
 s_cbranch_scc1 L_ww_21
 s_mov_b32 s96, s44
 s_and_b32 s97, s45, 0xffff
 s_mov_b32 s98, 256
 s_mov_b32 s99, 0x00020000
 v_mov_b32 v1, 212
 s_mov_b32 s51, 0
 s_mov_b64 exec, 1
L_wb_22:
 buffer_load_dword v2, v1, s[96:99], 0 offen sc1
 s_waitcnt vmcnt(0)
 v_cmp_eq_u32 vcc, 0, v2
 s_cbranch_vccz L_wbd_23
 s_sleep 2
 s_add_u32 s51, s51, 1
 s_cmp_lt_u32 s51, 131072
 s_cbranch_scc1 L_wb_22
 s_branch L_bail
L_wbd_23:
 s_mov_b64 exec, -1
L_ww_21:
 s_barrier
 s_branch L_help_done
L_np_11:
 s_sub_u32 s60, s60, 128
 s_cmp_eq_u32 s83, 1
 s_cbranch_scc1 L_k2_24
 s_add_u32 s3, s60, 288
 s_add_u32 s60, s60, 128
 s_cmp_eq_u32 s83, 0
 s_cselect_b32 s60, s3, s60
L_k2_24:
 s_mov_b32 s8, s32
 s_and_b32 s9, s33, 0xffff
 s_mov_b32 s10, 2621440
 s_mov_b32 s11, 0x00020000
 s_mov_b32 s12, s34
 s_and_b32 s13, s35, 0xffff
 s_mov_b32 s14, 2621440
 s_mov_b32 s15, 0x00020000
 s_mul_i32 s73, s60, 6554
 s_lshr_b32 s73, s73, 16
 s_mul_i32 s3, s73, 10
 s_sub_u32 s74, s60, s3
 s_mul_i32 s69, s73, 81920
 s_lshl_b32 s3, s74, 7
 s_add_u32 s69, s69, s3
 v_lshrrev_b32 v90, 3, v0
 s_mov_b32 s3, 10240
 v_mul_lo_u32 v91, v90, s3
 v_and_b32 v92, 7, v0
 v_lshl_add_u32 v91, v92, 4, v91
 v_add_u32 v91, s69, v91
 v_subrev_u32 v93, 3840, v91
 v_cmp_gt_i32 vcc, 0, v93
 s_nop 1
 v_cndmask_b32 v93, v93, v3, vcc
 buffer_load_dwordx4 v[100:103], v93, s[8:11], 0 offen offset:0
 buffer_load_dwordx4 v[104:107], v93, s[8:11], 0 offen offset:1280
 buffer_load_dwordx4 v[108:111], v93, s[8:11], 0 offen offset:2560
 s_mov_b32 s3, 0
 buffer_load_dwordx4 v[112:115], v91, s[8:11], s3 offen
 buffer_load_dwordx4 v[144:147], v91, s[12:15], s3 offen
 s_mov_b32 s3, 1280
 buffer_load_dwordx4 v[116:119], v91, s[8:11], s3 offen
 buffer_load_dwordx4 v[148:151], v91, s[12:15], s3 offen
 s_mov_b32 s3, 2560
 buffer_load_dwordx4 v[120:123], v91, s[8:11], s3 offen
 buffer_load_dwordx4 v[152:155], v91, s[12:15], s3 offen
 s_mov_b32 s3, 3840
 buffer_load_dwordx4 v[124:127], v91, s[8:11], s3 offen
 buffer_load_dwordx4 v[156:159], v91, s[12:15], s3 offen
 s_mov_b32 s3, 5120
 buffer_load_dwordx4 v[128:131], v91, s[8:11], s3 offen
 buffer_load_dwordx4 v[160:163], v91, s[12:15], s3 offen
 s_mov_b32 s3, 6400
 buffer_load_dwordx4 v[132:135], v91, s[8:11], s3 offen
 buffer_load_dwordx4 v[164:167], v91, s[12:15], s3 offen
 s_mov_b32 s3, 7680
 buffer_load_dwordx4 v[136:139], v91, s[8:11], s3 offen
 buffer_load_dwordx4 v[168:171], v91, s[12:15], s3 offen
 s_mov_b32 s3, 8960
 buffer_load_dwordx4 v[140:143], v91, s[8:11], s3 offen
 buffer_load_dwordx4 v[172:175], v91, s[12:15], s3 offen
 s_mov_b32 s8, s36
 s_and_b32 s9, s37, 0xffff
 s_mov_b32 s10, 5120
 s_mov_b32 s11, 0x00020000
 v_lshlrev_b32 v93, 6, v92
 s_lshl_b32 s3, s74, 9
 buffer_load_dwordx4 v[176:179], v93, s[8:11], s3 offen offset:0
 buffer_load_dwordx4 v[180:183], v93, s[8:11], s3 offen offset:16
 buffer_load_dwordx4 v[184:187], v93, s[8:11], s3 offen offset:32
 buffer_load_dwordx4 v[188:191], v93, s[8:11], s3 offen offset:48
 v_lshlrev_b32 v94, 15, v92
 v_lshl_add_u32 v94, v90, 4, v94
 s_lshl_b32 s70, s74, 18
 s_lshl_b32 s3, s73, 7
 s_add_u32 s70, s70, s3
 s_add_u32 s70, s70, 231735296
 s_waitcnt vmcnt(0)
 v_lshlrev_b32 v12, 16, v100
 v_and_b32 v13, 0xffff0000, v100
 v_lshlrev_b32 v14, 16, v104
 v_and_b32 v15, 0xffff0000, v104
 v_lshlrev_b32 v16, 16, v108
 v_and_b32 v17, 0xffff0000, v108
 v_lshlrev_b32 v18, 16, v112
 v_and_b32 v19, 0xffff0000, v112
 v_lshlrev_b32 v20, 16, v116
 v_and_b32 v21, 0xffff0000, v116
 v_lshlrev_b32 v22, 16, v120
 v_and_b32 v23, 0xffff0000, v120
 v_lshlrev_b32 v24, 16, v124
 v_and_b32 v25, 0xffff0000, v124
 v_lshlrev_b32 v26, 16, v128
 v_and_b32 v27, 0xffff0000, v128
 v_lshlrev_b32 v28, 16, v132
 v_and_b32 v29, 0xffff0000, v132
 v_lshlrev_b32 v30, 16, v136
 v_and_b32 v31, 0xffff0000, v136
 v_lshlrev_b32 v32, 16, v140
 v_and_b32 v33, 0xffff0000, v140
 v_lshlrev_b32 v68, 16, v176
 v_lshlrev_b32 v69, 16, v178
 v_and_b32 v70, 0xffff0000, v176
 v_and_b32 v71, 0xffff0000, v178
 v_lshlrev_b32 v72, 16, v177
 v_lshlrev_b32 v73, 16, v179
 v_and_b32 v74, 0xffff0000, v177
 v_and_b32 v75, 0xffff0000, v179
 v_pk_mul_f32 v[36:37], v[12:13], v[74:75]
 v_pk_mul_f32 v[38:39], v[14:15], v[74:75]
 v_pk_mul_f32 v[40:41], v[16:17], v[74:75]
 v_pk_mul_f32 v[42:43], v[18:19], v[74:75]
 v_pk_mul_f32 v[44:45], v[20:21], v[74:75]
 v_pk_mul_f32 v[46:47], v[22:23], v[74:75]
 v_pk_mul_f32 v[48:49], v[24:25], v[74:75]
 v_pk_mul_f32 v[50:51], v[26:27], v[74:75]
 v_cvt_pk_bf16_f32 v84, v36, v37
 v_lshlrev_b32 v36, 16, v84
 v_and_b32 v37, 0xffff0000, v84
 v_cvt_pk_bf16_f32 v84, v38, v39
 v_lshlrev_b32 v38, 16, v84
 v_and_b32 v39, 0xffff0000, v84
 v_cvt_pk_bf16_f32 v84, v40, v41
 v_lshlrev_b32 v40, 16, v84
 v_and_b32 v41, 0xffff0000, v84
 v_cvt_pk_bf16_f32 v84, v42, v43
 v_lshlrev_b32 v42, 16, v84
 v_and_b32 v43, 0xffff0000, v84
 v_cvt_pk_bf16_f32 v84, v44, v45
 v_lshlrev_b32 v44, 16, v84
 v_and_b32 v45, 0xffff0000, v84
 v_cvt_pk_bf16_f32 v84, v46, v47
 v_lshlrev_b32 v46, 16, v84
 v_and_b32 v47, 0xffff0000, v84
 v_cvt_pk_bf16_f32 v84, v48, v49
 v_lshlrev_b32 v48, 16, v84
 v_and_b32 v49, 0xffff0000, v84
 v_cvt_pk_bf16_f32 v84, v50, v51
 v_lshlrev_b32 v50, 16, v84
 v_and_b32 v51, 0xffff0000, v84
 v_pk_mul_f32 v[52:53], v[14:15], v[72:73]
 v_pk_mul_f32 v[54:55], v[16:17], v[72:73]
 v_pk_mul_f32 v[56:57], v[18:19], v[72:73]
 v_pk_mul_f32 v[58:59], v[20:21], v[72:73]
 v_pk_mul_f32 v[60:61], v[22:23], v[72:73]
 v_pk_mul_f32 v[62:63], v[24:25], v[72:73]
 v_pk_mul_f32 v[64:65], v[26:27], v[72:73]
 v_pk_mul_f32 v[66:67], v[28:29], v[72:73]
 v_cvt_pk_bf16_f32 v84, v52, v53
 v_lshlrev_b32 v52, 16, v84
 v_and_b32 v53, 0xffff0000, v84
 v_cvt_pk_bf16_f32 v84, v54, v55
 v_lshlrev_b32 v54, 16, v84
 v_and_b32 v55, 0xffff0000, v84
 v_cvt_pk_bf16_f32 v84, v56, v57
 v_lshlrev_b32 v56, 16, v84
 v_and_b32 v57, 0xffff0000, v84
 v_cvt_pk_bf16_f32 v84, v58, v59
 v_lshlrev_b32 v58, 16, v84
 v_and_b32 v59, 0xffff0000, v84
 v_cvt_pk_bf16_f32 v84, v60, v61
 v_lshlrev_b32 v60, 16, v84
 v_and_b32 v61, 0xffff0000, v84
 v_cvt_pk_bf16_f32 v84, v62, v63
 v_lshlrev_b32 v62, 16, v84
 v_and_b32 v63, 0xffff0000, v84
 v_cvt_pk_bf16_f32 v84, v64, v65
 v_lshlrev_b32 v64, 16, v84
 v_and_b32 v65, 0xffff0000, v84
 v_cvt_pk_bf16_f32 v84, v66, v67
 v_lshlrev_b32 v66, 16, v84
 v_and_b32 v67, 0xffff0000, v84
 v_pk_add_f32 v[36:37], v[36:37], v[52:53]
 v_pk_add_f32 v[38:39], v[38:39], v[54:55]
 v_pk_add_f32 v[40:41], v[40:41], v[56:57]
 v_pk_add_f32 v[42:43], v[42:43], v[58:59]
 v_pk_add_f32 v[44:45], v[44:45], v[60:61]
 v_pk_add_f32 v[46:47], v[46:47], v[62:63]
 v_pk_add_f32 v[48:49], v[48:49], v[64:65]
 v_pk_add_f32 v[50:51], v[50:51], v[66:67]
 v_cvt_pk_bf16_f32 v84, v36, v37
 v_lshlrev_b32 v36, 16, v84
 v_and_b32 v37, 0xffff0000, v84
 v_cvt_pk_bf16_f32 v84, v38, v39
 v_lshlrev_b32 v38, 16, v84
 v_and_b32 v39, 0xffff0000, v84
 v_cvt_pk_bf16_f32 v84, v40, v41
 v_lshlrev_b32 v40, 16, v84
 v_and_b32 v41, 0xffff0000, v84
 v_cvt_pk_bf16_f32 v84, v42, v43
 v_lshlrev_b32 v42, 16, v84
 v_and_b32 v43, 0xffff0000, v84
 v_cvt_pk_bf16_f32 v84, v44, v45
 v_lshlrev_b32 v44, 16, v84
 v_and_b32 v45, 0xffff0000, v84
 v_cvt_pk_bf16_f32 v84, v46, v47
 v_lshlrev_b32 v46, 16, v84
 v_and_b32 v47, 0xffff0000, v84
 v_cvt_pk_bf16_f32 v84, v48, v49
 v_lshlrev_b32 v48, 16, v84
 v_and_b32 v49, 0xffff0000, v84
 v_cvt_pk_bf16_f32 v84, v50, v51
 v_lshlrev_b32 v50, 16, v84
 v_and_b32 v51, 0xffff0000, v84
 v_pk_mul_f32 v[52:53], v[16:17], v[70:71]
 v_pk_mul_f32 v[54:55], v[18:19], v[70:71]
 v_pk_mul_f32 v[56:57], v[20:21], v[70:71]
 v_pk_mul_f32 v[58:59], v[22:23], v[70:71]
 v_pk_mul_f32 v[60:61], v[24:25], v[70:71]
 v_pk_mul_f32 v[62:63], v[26:27], v[70:71]
 v_pk_mul_f32 v[64:65], v[28:29], v[70:71]
 v_pk_mul_f32 v[66:67], v[30:31], v[70:71]
 v_cvt_pk_bf16_f32 v84, v52, v53
 v_lshlrev_b32 v52, 16, v84
 v_and_b32 v53, 0xffff0000, v84
 v_cvt_pk_bf16_f32 v84, v54, v55
 v_lshlrev_b32 v54, 16, v84
 v_and_b32 v55, 0xffff0000, v84
 v_cvt_pk_bf16_f32 v84, v56, v57
 v_lshlrev_b32 v56, 16, v84
 v_and_b32 v57, 0xffff0000, v84
 v_cvt_pk_bf16_f32 v84, v58, v59
 v_lshlrev_b32 v58, 16, v84
 v_and_b32 v59, 0xffff0000, v84
 v_cvt_pk_bf16_f32 v84, v60, v61
 v_lshlrev_b32 v60, 16, v84
 v_and_b32 v61, 0xffff0000, v84
 v_cvt_pk_bf16_f32 v84, v62, v63
 v_lshlrev_b32 v62, 16, v84
 v_and_b32 v63, 0xffff0000, v84
 v_cvt_pk_bf16_f32 v84, v64, v65
 v_lshlrev_b32 v64, 16, v84
 v_and_b32 v65, 0xffff0000, v84
 v_cvt_pk_bf16_f32 v84, v66, v67
 v_lshlrev_b32 v66, 16, v84
 v_and_b32 v67, 0xffff0000, v84
 v_pk_add_f32 v[36:37], v[36:37], v[52:53]
 v_pk_add_f32 v[38:39], v[38:39], v[54:55]
 v_pk_add_f32 v[40:41], v[40:41], v[56:57]
 v_pk_add_f32 v[42:43], v[42:43], v[58:59]
 v_pk_add_f32 v[44:45], v[44:45], v[60:61]
 v_pk_add_f32 v[46:47], v[46:47], v[62:63]
 v_pk_add_f32 v[48:49], v[48:49], v[64:65]
 v_pk_add_f32 v[50:51], v[50:51], v[66:67]
 v_cvt_pk_bf16_f32 v84, v36, v37
 v_lshlrev_b32 v36, 16, v84
 v_and_b32 v37, 0xffff0000, v84
 v_cvt_pk_bf16_f32 v84, v38, v39
 v_lshlrev_b32 v38, 16, v84
 v_and_b32 v39, 0xffff0000, v84
 v_cvt_pk_bf16_f32 v84, v40, v41
 v_lshlrev_b32 v40, 16, v84
 v_and_b32 v41, 0xffff0000, v84
 v_cvt_pk_bf16_f32 v84, v42, v43
 v_lshlrev_b32 v42, 16, v84
 v_and_b32 v43, 0xffff0000, v84
 v_cvt_pk_bf16_f32 v84, v44, v45
 v_lshlrev_b32 v44, 16, v84
 v_and_b32 v45, 0xffff0000, v84
 v_cvt_pk_bf16_f32 v84, v46, v47
 v_lshlrev_b32 v46, 16, v84
 v_and_b32 v47, 0xffff0000, v84
 v_cvt_pk_bf16_f32 v84, v48, v49
 v_lshlrev_b32 v48, 16, v84
 v_and_b32 v49, 0xffff0000, v84
 v_cvt_pk_bf16_f32 v84, v50, v51
 v_lshlrev_b32 v50, 16, v84
 v_and_b32 v51, 0xffff0000, v84
 v_pk_mul_f32 v[52:53], v[18:19], v[68:69]
 v_pk_mul_f32 v[54:55], v[20:21], v[68:69]
 v_pk_mul_f32 v[56:57], v[22:23], v[68:69]
 v_pk_mul_f32 v[58:59], v[24:25], v[68:69]
 v_pk_mul_f32 v[60:61], v[26:27], v[68:69]
 v_pk_mul_f32 v[62:63], v[28:29], v[68:69]
 v_pk_mul_f32 v[64:65], v[30:31], v[68:69]
 v_pk_mul_f32 v[66:67], v[32:33], v[68:69]
 v_cvt_pk_bf16_f32 v84, v52, v53
 v_lshlrev_b32 v52, 16, v84
 v_and_b32 v53, 0xffff0000, v84
 v_cvt_pk_bf16_f32 v84, v54, v55
 v_lshlrev_b32 v54, 16, v84
 v_and_b32 v55, 0xffff0000, v84
 v_cvt_pk_bf16_f32 v84, v56, v57
 v_lshlrev_b32 v56, 16, v84
 v_and_b32 v57, 0xffff0000, v84
 v_cvt_pk_bf16_f32 v84, v58, v59
 v_lshlrev_b32 v58, 16, v84
 v_and_b32 v59, 0xffff0000, v84
 v_cvt_pk_bf16_f32 v84, v60, v61
 v_lshlrev_b32 v60, 16, v84
 v_and_b32 v61, 0xffff0000, v84
 v_cvt_pk_bf16_f32 v84, v62, v63
 v_lshlrev_b32 v62, 16, v84
 v_and_b32 v63, 0xffff0000, v84
 v_cvt_pk_bf16_f32 v84, v64, v65
 v_lshlrev_b32 v64, 16, v84
 v_and_b32 v65, 0xffff0000, v84
 v_cvt_pk_bf16_f32 v84, v66, v67
 v_lshlrev_b32 v66, 16, v84
 v_and_b32 v67, 0xffff0000, v84
 v_pk_add_f32 v[36:37], v[36:37], v[52:53]
 v_pk_add_f32 v[38:39], v[38:39], v[54:55]
 v_pk_add_f32 v[40:41], v[40:41], v[56:57]
 v_pk_add_f32 v[42:43], v[42:43], v[58:59]
 v_pk_add_f32 v[44:45], v[44:45], v[60:61]
 v_pk_add_f32 v[46:47], v[46:47], v[62:63]
 v_pk_add_f32 v[48:49], v[48:49], v[64:65]
 v_pk_add_f32 v[50:51], v[50:51], v[66:67]
 v_cvt_pk_bf16_f32 v84, v36, v37
 v_lshlrev_b32 v36, 16, v84
 v_and_b32 v37, 0xffff0000, v84
 v_cvt_pk_bf16_f32 v84, v38, v39
 v_lshlrev_b32 v38, 16, v84
 v_and_b32 v39, 0xffff0000, v84
 v_cvt_pk_bf16_f32 v84, v40, v41
 v_lshlrev_b32 v40, 16, v84
 v_and_b32 v41, 0xffff0000, v84
 v_cvt_pk_bf16_f32 v84, v42, v43
 v_lshlrev_b32 v42, 16, v84
 v_and_b32 v43, 0xffff0000, v84
 v_cvt_pk_bf16_f32 v84, v44, v45
 v_lshlrev_b32 v44, 16, v84
 v_and_b32 v45, 0xffff0000, v84
 v_cvt_pk_bf16_f32 v84, v46, v47
 v_lshlrev_b32 v46, 16, v84
 v_and_b32 v47, 0xffff0000, v84
 v_cvt_pk_bf16_f32 v84, v48, v49
 v_lshlrev_b32 v48, 16, v84
 v_and_b32 v49, 0xffff0000, v84
 v_cvt_pk_bf16_f32 v84, v50, v51
 v_lshlrev_b32 v50, 16, v84
 v_and_b32 v51, 0xffff0000, v84
 v_lshlrev_b32 v12, 16, v144
 v_and_b32 v13, 0xffff0000, v144
 v_lshlrev_b32 v14, 16, v148
 v_and_b32 v15, 0xffff0000, v148
 v_lshlrev_b32 v16, 16, v152
 v_and_b32 v17, 0xffff0000, v152
 v_lshlrev_b32 v18, 16, v156
 v_and_b32 v19, 0xffff0000, v156
 v_lshlrev_b32 v20, 16, v160
 v_and_b32 v21, 0xffff0000, v160
 v_lshlrev_b32 v22, 16, v164
 v_and_b32 v23, 0xffff0000, v164
 v_lshlrev_b32 v24, 16, v168
 v_and_b32 v25, 0xffff0000, v168
 v_lshlrev_b32 v26, 16, v172
 v_and_b32 v27, 0xffff0000, v172
 v_pk_mul_f32 v[36:37], v[36:37], v[12:13]
 v_pk_mul_f32 v[38:39], v[38:39], v[14:15]
 v_pk_mul_f32 v[40:41], v[40:41], v[16:17]
 v_pk_mul_f32 v[42:43], v[42:43], v[18:19]
 v_pk_mul_f32 v[44:45], v[44:45], v[20:21]
 v_pk_mul_f32 v[46:47], v[46:47], v[22:23]
 v_pk_mul_f32 v[48:49], v[48:49], v[24:25]
 v_pk_mul_f32 v[50:51], v[50:51], v[26:27]
 v_cvt_pk_bf16_f32 v76, v50, v48
 v_cvt_pk_bf16_f32 v77, v46, v44
 v_cvt_pk_bf16_f32 v78, v42, v40
 v_cvt_pk_bf16_f32 v79, v38, v36
 s_add_u32 s3, s70, 0
 buffer_store_dwordx4 v[76:79], v94, s[4:7], s3 offen sc1
 v_cvt_pk_bf16_f32 v80, v51, v49
 v_cvt_pk_bf16_f32 v81, v47, v45
 v_cvt_pk_bf16_f32 v82, v43, v41
 v_cvt_pk_bf16_f32 v83, v39, v37
 s_add_u32 s3, s70, 4096
 buffer_store_dwordx4 v[80:83], v94, s[4:7], s3 offen sc1
 v_lshlrev_b32 v12, 16, v101
 v_and_b32 v13, 0xffff0000, v101
 v_lshlrev_b32 v14, 16, v105
 v_and_b32 v15, 0xffff0000, v105
 v_lshlrev_b32 v16, 16, v109
 v_and_b32 v17, 0xffff0000, v109
 v_lshlrev_b32 v18, 16, v113
 v_and_b32 v19, 0xffff0000, v113
 v_lshlrev_b32 v20, 16, v117
 v_and_b32 v21, 0xffff0000, v117
 v_lshlrev_b32 v22, 16, v121
 v_and_b32 v23, 0xffff0000, v121
 v_lshlrev_b32 v24, 16, v125
 v_and_b32 v25, 0xffff0000, v125
 v_lshlrev_b32 v26, 16, v129
 v_and_b32 v27, 0xffff0000, v129
 v_lshlrev_b32 v28, 16, v133
 v_and_b32 v29, 0xffff0000, v133
 v_lshlrev_b32 v30, 16, v137
 v_and_b32 v31, 0xffff0000, v137
 v_lshlrev_b32 v32, 16, v141
 v_and_b32 v33, 0xffff0000, v141
 v_lshlrev_b32 v68, 16, v180
 v_lshlrev_b32 v69, 16, v182
 v_and_b32 v70, 0xffff0000, v180
 v_and_b32 v71, 0xffff0000, v182
 v_lshlrev_b32 v72, 16, v181
 v_lshlrev_b32 v73, 16, v183
 v_and_b32 v74, 0xffff0000, v181
 v_and_b32 v75, 0xffff0000, v183
 v_pk_mul_f32 v[36:37], v[12:13], v[74:75]
 v_pk_mul_f32 v[38:39], v[14:15], v[74:75]
 v_pk_mul_f32 v[40:41], v[16:17], v[74:75]
 v_pk_mul_f32 v[42:43], v[18:19], v[74:75]
 v_pk_mul_f32 v[44:45], v[20:21], v[74:75]
 v_pk_mul_f32 v[46:47], v[22:23], v[74:75]
 v_pk_mul_f32 v[48:49], v[24:25], v[74:75]
 v_pk_mul_f32 v[50:51], v[26:27], v[74:75]
 v_cvt_pk_bf16_f32 v84, v36, v37
 v_lshlrev_b32 v36, 16, v84
 v_and_b32 v37, 0xffff0000, v84
 v_cvt_pk_bf16_f32 v84, v38, v39
 v_lshlrev_b32 v38, 16, v84
 v_and_b32 v39, 0xffff0000, v84
 v_cvt_pk_bf16_f32 v84, v40, v41
 v_lshlrev_b32 v40, 16, v84
 v_and_b32 v41, 0xffff0000, v84
 v_cvt_pk_bf16_f32 v84, v42, v43
 v_lshlrev_b32 v42, 16, v84
 v_and_b32 v43, 0xffff0000, v84
 v_cvt_pk_bf16_f32 v84, v44, v45
 v_lshlrev_b32 v44, 16, v84
 v_and_b32 v45, 0xffff0000, v84
 v_cvt_pk_bf16_f32 v84, v46, v47
 v_lshlrev_b32 v46, 16, v84
 v_and_b32 v47, 0xffff0000, v84
 v_cvt_pk_bf16_f32 v84, v48, v49
 v_lshlrev_b32 v48, 16, v84
 v_and_b32 v49, 0xffff0000, v84
 v_cvt_pk_bf16_f32 v84, v50, v51
 v_lshlrev_b32 v50, 16, v84
 v_and_b32 v51, 0xffff0000, v84
 v_pk_mul_f32 v[52:53], v[14:15], v[72:73]
 v_pk_mul_f32 v[54:55], v[16:17], v[72:73]
 v_pk_mul_f32 v[56:57], v[18:19], v[72:73]
 v_pk_mul_f32 v[58:59], v[20:21], v[72:73]
 v_pk_mul_f32 v[60:61], v[22:23], v[72:73]
 v_pk_mul_f32 v[62:63], v[24:25], v[72:73]
 v_pk_mul_f32 v[64:65], v[26:27], v[72:73]
 v_pk_mul_f32 v[66:67], v[28:29], v[72:73]
 v_cvt_pk_bf16_f32 v84, v52, v53
 v_lshlrev_b32 v52, 16, v84
 v_and_b32 v53, 0xffff0000, v84
 v_cvt_pk_bf16_f32 v84, v54, v55
 v_lshlrev_b32 v54, 16, v84
 v_and_b32 v55, 0xffff0000, v84
 v_cvt_pk_bf16_f32 v84, v56, v57
 v_lshlrev_b32 v56, 16, v84
 v_and_b32 v57, 0xffff0000, v84
 v_cvt_pk_bf16_f32 v84, v58, v59
 v_lshlrev_b32 v58, 16, v84
 v_and_b32 v59, 0xffff0000, v84
 v_cvt_pk_bf16_f32 v84, v60, v61
 v_lshlrev_b32 v60, 16, v84
 v_and_b32 v61, 0xffff0000, v84
 v_cvt_pk_bf16_f32 v84, v62, v63
 v_lshlrev_b32 v62, 16, v84
 v_and_b32 v63, 0xffff0000, v84
 v_cvt_pk_bf16_f32 v84, v64, v65
 v_lshlrev_b32 v64, 16, v84
 v_and_b32 v65, 0xffff0000, v84
 v_cvt_pk_bf16_f32 v84, v66, v67
 v_lshlrev_b32 v66, 16, v84
 v_and_b32 v67, 0xffff0000, v84
 v_pk_add_f32 v[36:37], v[36:37], v[52:53]
 v_pk_add_f32 v[38:39], v[38:39], v[54:55]
 v_pk_add_f32 v[40:41], v[40:41], v[56:57]
 v_pk_add_f32 v[42:43], v[42:43], v[58:59]
 v_pk_add_f32 v[44:45], v[44:45], v[60:61]
 v_pk_add_f32 v[46:47], v[46:47], v[62:63]
 v_pk_add_f32 v[48:49], v[48:49], v[64:65]
 v_pk_add_f32 v[50:51], v[50:51], v[66:67]
 v_cvt_pk_bf16_f32 v84, v36, v37
 v_lshlrev_b32 v36, 16, v84
 v_and_b32 v37, 0xffff0000, v84
 v_cvt_pk_bf16_f32 v84, v38, v39
 v_lshlrev_b32 v38, 16, v84
 v_and_b32 v39, 0xffff0000, v84
 v_cvt_pk_bf16_f32 v84, v40, v41
 v_lshlrev_b32 v40, 16, v84
 v_and_b32 v41, 0xffff0000, v84
 v_cvt_pk_bf16_f32 v84, v42, v43
 v_lshlrev_b32 v42, 16, v84
 v_and_b32 v43, 0xffff0000, v84
 v_cvt_pk_bf16_f32 v84, v44, v45
 v_lshlrev_b32 v44, 16, v84
 v_and_b32 v45, 0xffff0000, v84
 v_cvt_pk_bf16_f32 v84, v46, v47
 v_lshlrev_b32 v46, 16, v84
 v_and_b32 v47, 0xffff0000, v84
 v_cvt_pk_bf16_f32 v84, v48, v49
 v_lshlrev_b32 v48, 16, v84
 v_and_b32 v49, 0xffff0000, v84
 v_cvt_pk_bf16_f32 v84, v50, v51
 v_lshlrev_b32 v50, 16, v84
 v_and_b32 v51, 0xffff0000, v84
 v_pk_mul_f32 v[52:53], v[16:17], v[70:71]
 v_pk_mul_f32 v[54:55], v[18:19], v[70:71]
 v_pk_mul_f32 v[56:57], v[20:21], v[70:71]
 v_pk_mul_f32 v[58:59], v[22:23], v[70:71]
 v_pk_mul_f32 v[60:61], v[24:25], v[70:71]
 v_pk_mul_f32 v[62:63], v[26:27], v[70:71]
 v_pk_mul_f32 v[64:65], v[28:29], v[70:71]
 v_pk_mul_f32 v[66:67], v[30:31], v[70:71]
 v_cvt_pk_bf16_f32 v84, v52, v53
 v_lshlrev_b32 v52, 16, v84
 v_and_b32 v53, 0xffff0000, v84
 v_cvt_pk_bf16_f32 v84, v54, v55
 v_lshlrev_b32 v54, 16, v84
 v_and_b32 v55, 0xffff0000, v84
 v_cvt_pk_bf16_f32 v84, v56, v57
 v_lshlrev_b32 v56, 16, v84
 v_and_b32 v57, 0xffff0000, v84
 v_cvt_pk_bf16_f32 v84, v58, v59
 v_lshlrev_b32 v58, 16, v84
 v_and_b32 v59, 0xffff0000, v84
 v_cvt_pk_bf16_f32 v84, v60, v61
 v_lshlrev_b32 v60, 16, v84
 v_and_b32 v61, 0xffff0000, v84
 v_cvt_pk_bf16_f32 v84, v62, v63
 v_lshlrev_b32 v62, 16, v84
 v_and_b32 v63, 0xffff0000, v84
 v_cvt_pk_bf16_f32 v84, v64, v65
 v_lshlrev_b32 v64, 16, v84
 v_and_b32 v65, 0xffff0000, v84
 v_cvt_pk_bf16_f32 v84, v66, v67
 v_lshlrev_b32 v66, 16, v84
 v_and_b32 v67, 0xffff0000, v84
 v_pk_add_f32 v[36:37], v[36:37], v[52:53]
 v_pk_add_f32 v[38:39], v[38:39], v[54:55]
 v_pk_add_f32 v[40:41], v[40:41], v[56:57]
 v_pk_add_f32 v[42:43], v[42:43], v[58:59]
 v_pk_add_f32 v[44:45], v[44:45], v[60:61]
 v_pk_add_f32 v[46:47], v[46:47], v[62:63]
 v_pk_add_f32 v[48:49], v[48:49], v[64:65]
 v_pk_add_f32 v[50:51], v[50:51], v[66:67]
 v_cvt_pk_bf16_f32 v84, v36, v37
 v_lshlrev_b32 v36, 16, v84
 v_and_b32 v37, 0xffff0000, v84
 v_cvt_pk_bf16_f32 v84, v38, v39
 v_lshlrev_b32 v38, 16, v84
 v_and_b32 v39, 0xffff0000, v84
 v_cvt_pk_bf16_f32 v84, v40, v41
 v_lshlrev_b32 v40, 16, v84
 v_and_b32 v41, 0xffff0000, v84
 v_cvt_pk_bf16_f32 v84, v42, v43
 v_lshlrev_b32 v42, 16, v84
 v_and_b32 v43, 0xffff0000, v84
 v_cvt_pk_bf16_f32 v84, v44, v45
 v_lshlrev_b32 v44, 16, v84
 v_and_b32 v45, 0xffff0000, v84
 v_cvt_pk_bf16_f32 v84, v46, v47
 v_lshlrev_b32 v46, 16, v84
 v_and_b32 v47, 0xffff0000, v84
 v_cvt_pk_bf16_f32 v84, v48, v49
 v_lshlrev_b32 v48, 16, v84
 v_and_b32 v49, 0xffff0000, v84
 v_cvt_pk_bf16_f32 v84, v50, v51
 v_lshlrev_b32 v50, 16, v84
 v_and_b32 v51, 0xffff0000, v84
 v_pk_mul_f32 v[52:53], v[18:19], v[68:69]
 v_pk_mul_f32 v[54:55], v[20:21], v[68:69]
 v_pk_mul_f32 v[56:57], v[22:23], v[68:69]
 v_pk_mul_f32 v[58:59], v[24:25], v[68:69]
 v_pk_mul_f32 v[60:61], v[26:27], v[68:69]
 v_pk_mul_f32 v[62:63], v[28:29], v[68:69]
 v_pk_mul_f32 v[64:65], v[30:31], v[68:69]
 v_pk_mul_f32 v[66:67], v[32:33], v[68:69]
 v_cvt_pk_bf16_f32 v84, v52, v53
 v_lshlrev_b32 v52, 16, v84
 v_and_b32 v53, 0xffff0000, v84
 v_cvt_pk_bf16_f32 v84, v54, v55
 v_lshlrev_b32 v54, 16, v84
 v_and_b32 v55, 0xffff0000, v84
 v_cvt_pk_bf16_f32 v84, v56, v57
 v_lshlrev_b32 v56, 16, v84
 v_and_b32 v57, 0xffff0000, v84
 v_cvt_pk_bf16_f32 v84, v58, v59
 v_lshlrev_b32 v58, 16, v84
 v_and_b32 v59, 0xffff0000, v84
 v_cvt_pk_bf16_f32 v84, v60, v61
 v_lshlrev_b32 v60, 16, v84
 v_and_b32 v61, 0xffff0000, v84
 v_cvt_pk_bf16_f32 v84, v62, v63
 v_lshlrev_b32 v62, 16, v84
 v_and_b32 v63, 0xffff0000, v84
 v_cvt_pk_bf16_f32 v84, v64, v65
 v_lshlrev_b32 v64, 16, v84
 v_and_b32 v65, 0xffff0000, v84
 v_cvt_pk_bf16_f32 v84, v66, v67
 v_lshlrev_b32 v66, 16, v84
 v_and_b32 v67, 0xffff0000, v84
 v_pk_add_f32 v[36:37], v[36:37], v[52:53]
 v_pk_add_f32 v[38:39], v[38:39], v[54:55]
 v_pk_add_f32 v[40:41], v[40:41], v[56:57]
 v_pk_add_f32 v[42:43], v[42:43], v[58:59]
 v_pk_add_f32 v[44:45], v[44:45], v[60:61]
 v_pk_add_f32 v[46:47], v[46:47], v[62:63]
 v_pk_add_f32 v[48:49], v[48:49], v[64:65]
 v_pk_add_f32 v[50:51], v[50:51], v[66:67]
 v_cvt_pk_bf16_f32 v84, v36, v37
 v_lshlrev_b32 v36, 16, v84
 v_and_b32 v37, 0xffff0000, v84
 v_cvt_pk_bf16_f32 v84, v38, v39
 v_lshlrev_b32 v38, 16, v84
 v_and_b32 v39, 0xffff0000, v84
 v_cvt_pk_bf16_f32 v84, v40, v41
 v_lshlrev_b32 v40, 16, v84
 v_and_b32 v41, 0xffff0000, v84
 v_cvt_pk_bf16_f32 v84, v42, v43
 v_lshlrev_b32 v42, 16, v84
 v_and_b32 v43, 0xffff0000, v84
 v_cvt_pk_bf16_f32 v84, v44, v45
 v_lshlrev_b32 v44, 16, v84
 v_and_b32 v45, 0xffff0000, v84
 v_cvt_pk_bf16_f32 v84, v46, v47
 v_lshlrev_b32 v46, 16, v84
 v_and_b32 v47, 0xffff0000, v84
 v_cvt_pk_bf16_f32 v84, v48, v49
 v_lshlrev_b32 v48, 16, v84
 v_and_b32 v49, 0xffff0000, v84
 v_cvt_pk_bf16_f32 v84, v50, v51
 v_lshlrev_b32 v50, 16, v84
 v_and_b32 v51, 0xffff0000, v84
 v_lshlrev_b32 v12, 16, v145
 v_and_b32 v13, 0xffff0000, v145
 v_lshlrev_b32 v14, 16, v149
 v_and_b32 v15, 0xffff0000, v149
 v_lshlrev_b32 v16, 16, v153
 v_and_b32 v17, 0xffff0000, v153
 v_lshlrev_b32 v18, 16, v157
 v_and_b32 v19, 0xffff0000, v157
 v_lshlrev_b32 v20, 16, v161
 v_and_b32 v21, 0xffff0000, v161
 v_lshlrev_b32 v22, 16, v165
 v_and_b32 v23, 0xffff0000, v165
 v_lshlrev_b32 v24, 16, v169
 v_and_b32 v25, 0xffff0000, v169
 v_lshlrev_b32 v26, 16, v173
 v_and_b32 v27, 0xffff0000, v173
 v_pk_mul_f32 v[36:37], v[36:37], v[12:13]
 v_pk_mul_f32 v[38:39], v[38:39], v[14:15]
 v_pk_mul_f32 v[40:41], v[40:41], v[16:17]
 v_pk_mul_f32 v[42:43], v[42:43], v[18:19]
 v_pk_mul_f32 v[44:45], v[44:45], v[20:21]
 v_pk_mul_f32 v[46:47], v[46:47], v[22:23]
 v_pk_mul_f32 v[48:49], v[48:49], v[24:25]
 v_pk_mul_f32 v[50:51], v[50:51], v[26:27]
 v_cvt_pk_bf16_f32 v76, v50, v48
 v_cvt_pk_bf16_f32 v77, v46, v44
 v_cvt_pk_bf16_f32 v78, v42, v40
 v_cvt_pk_bf16_f32 v79, v38, v36
 s_add_u32 s3, s70, 8192
 buffer_store_dwordx4 v[76:79], v94, s[4:7], s3 offen sc1
 v_cvt_pk_bf16_f32 v80, v51, v49
 v_cvt_pk_bf16_f32 v81, v47, v45
 v_cvt_pk_bf16_f32 v82, v43, v41
 v_cvt_pk_bf16_f32 v83, v39, v37
 s_add_u32 s3, s70, 12288
 buffer_store_dwordx4 v[80:83], v94, s[4:7], s3 offen sc1
 v_lshlrev_b32 v12, 16, v102
 v_and_b32 v13, 0xffff0000, v102
 v_lshlrev_b32 v14, 16, v106
 v_and_b32 v15, 0xffff0000, v106
 v_lshlrev_b32 v16, 16, v110
 v_and_b32 v17, 0xffff0000, v110
 v_lshlrev_b32 v18, 16, v114
 v_and_b32 v19, 0xffff0000, v114
 v_lshlrev_b32 v20, 16, v118
 v_and_b32 v21, 0xffff0000, v118
 v_lshlrev_b32 v22, 16, v122
 v_and_b32 v23, 0xffff0000, v122
 v_lshlrev_b32 v24, 16, v126
 v_and_b32 v25, 0xffff0000, v126
 v_lshlrev_b32 v26, 16, v130
 v_and_b32 v27, 0xffff0000, v130
 v_lshlrev_b32 v28, 16, v134
 v_and_b32 v29, 0xffff0000, v134
 v_lshlrev_b32 v30, 16, v138
 v_and_b32 v31, 0xffff0000, v138
 v_lshlrev_b32 v32, 16, v142
 v_and_b32 v33, 0xffff0000, v142
 v_lshlrev_b32 v68, 16, v184
 v_lshlrev_b32 v69, 16, v186
 v_and_b32 v70, 0xffff0000, v184
 v_and_b32 v71, 0xffff0000, v186
 v_lshlrev_b32 v72, 16, v185
 v_lshlrev_b32 v73, 16, v187
 v_and_b32 v74, 0xffff0000, v185
 v_and_b32 v75, 0xffff0000, v187
 v_pk_mul_f32 v[36:37], v[12:13], v[74:75]
 v_pk_mul_f32 v[38:39], v[14:15], v[74:75]
 v_pk_mul_f32 v[40:41], v[16:17], v[74:75]
 v_pk_mul_f32 v[42:43], v[18:19], v[74:75]
 v_pk_mul_f32 v[44:45], v[20:21], v[74:75]
 v_pk_mul_f32 v[46:47], v[22:23], v[74:75]
 v_pk_mul_f32 v[48:49], v[24:25], v[74:75]
 v_pk_mul_f32 v[50:51], v[26:27], v[74:75]
 v_cvt_pk_bf16_f32 v84, v36, v37
 v_lshlrev_b32 v36, 16, v84
 v_and_b32 v37, 0xffff0000, v84
 v_cvt_pk_bf16_f32 v84, v38, v39
 v_lshlrev_b32 v38, 16, v84
 v_and_b32 v39, 0xffff0000, v84
 v_cvt_pk_bf16_f32 v84, v40, v41
 v_lshlrev_b32 v40, 16, v84
 v_and_b32 v41, 0xffff0000, v84
 v_cvt_pk_bf16_f32 v84, v42, v43
 v_lshlrev_b32 v42, 16, v84
 v_and_b32 v43, 0xffff0000, v84
 v_cvt_pk_bf16_f32 v84, v44, v45
 v_lshlrev_b32 v44, 16, v84
 v_and_b32 v45, 0xffff0000, v84
 v_cvt_pk_bf16_f32 v84, v46, v47
 v_lshlrev_b32 v46, 16, v84
 v_and_b32 v47, 0xffff0000, v84
 v_cvt_pk_bf16_f32 v84, v48, v49
 v_lshlrev_b32 v48, 16, v84
 v_and_b32 v49, 0xffff0000, v84
 v_cvt_pk_bf16_f32 v84, v50, v51
 v_lshlrev_b32 v50, 16, v84
 v_and_b32 v51, 0xffff0000, v84
 v_pk_mul_f32 v[52:53], v[14:15], v[72:73]
 v_pk_mul_f32 v[54:55], v[16:17], v[72:73]
 v_pk_mul_f32 v[56:57], v[18:19], v[72:73]
 v_pk_mul_f32 v[58:59], v[20:21], v[72:73]
 v_pk_mul_f32 v[60:61], v[22:23], v[72:73]
 v_pk_mul_f32 v[62:63], v[24:25], v[72:73]
 v_pk_mul_f32 v[64:65], v[26:27], v[72:73]
 v_pk_mul_f32 v[66:67], v[28:29], v[72:73]
 v_cvt_pk_bf16_f32 v84, v52, v53
 v_lshlrev_b32 v52, 16, v84
 v_and_b32 v53, 0xffff0000, v84
 v_cvt_pk_bf16_f32 v84, v54, v55
 v_lshlrev_b32 v54, 16, v84
 v_and_b32 v55, 0xffff0000, v84
 v_cvt_pk_bf16_f32 v84, v56, v57
 v_lshlrev_b32 v56, 16, v84
 v_and_b32 v57, 0xffff0000, v84
 v_cvt_pk_bf16_f32 v84, v58, v59
 v_lshlrev_b32 v58, 16, v84
 v_and_b32 v59, 0xffff0000, v84
 v_cvt_pk_bf16_f32 v84, v60, v61
 v_lshlrev_b32 v60, 16, v84
 v_and_b32 v61, 0xffff0000, v84
 v_cvt_pk_bf16_f32 v84, v62, v63
 v_lshlrev_b32 v62, 16, v84
 v_and_b32 v63, 0xffff0000, v84
 v_cvt_pk_bf16_f32 v84, v64, v65
 v_lshlrev_b32 v64, 16, v84
 v_and_b32 v65, 0xffff0000, v84
 v_cvt_pk_bf16_f32 v84, v66, v67
 v_lshlrev_b32 v66, 16, v84
 v_and_b32 v67, 0xffff0000, v84
 v_pk_add_f32 v[36:37], v[36:37], v[52:53]
 v_pk_add_f32 v[38:39], v[38:39], v[54:55]
 v_pk_add_f32 v[40:41], v[40:41], v[56:57]
 v_pk_add_f32 v[42:43], v[42:43], v[58:59]
 v_pk_add_f32 v[44:45], v[44:45], v[60:61]
 v_pk_add_f32 v[46:47], v[46:47], v[62:63]
 v_pk_add_f32 v[48:49], v[48:49], v[64:65]
 v_pk_add_f32 v[50:51], v[50:51], v[66:67]
 v_cvt_pk_bf16_f32 v84, v36, v37
 v_lshlrev_b32 v36, 16, v84
 v_and_b32 v37, 0xffff0000, v84
 v_cvt_pk_bf16_f32 v84, v38, v39
 v_lshlrev_b32 v38, 16, v84
 v_and_b32 v39, 0xffff0000, v84
 v_cvt_pk_bf16_f32 v84, v40, v41
 v_lshlrev_b32 v40, 16, v84
 v_and_b32 v41, 0xffff0000, v84
 v_cvt_pk_bf16_f32 v84, v42, v43
 v_lshlrev_b32 v42, 16, v84
 v_and_b32 v43, 0xffff0000, v84
 v_cvt_pk_bf16_f32 v84, v44, v45
 v_lshlrev_b32 v44, 16, v84
 v_and_b32 v45, 0xffff0000, v84
 v_cvt_pk_bf16_f32 v84, v46, v47
 v_lshlrev_b32 v46, 16, v84
 v_and_b32 v47, 0xffff0000, v84
 v_cvt_pk_bf16_f32 v84, v48, v49
 v_lshlrev_b32 v48, 16, v84
 v_and_b32 v49, 0xffff0000, v84
 v_cvt_pk_bf16_f32 v84, v50, v51
 v_lshlrev_b32 v50, 16, v84
 v_and_b32 v51, 0xffff0000, v84
 v_pk_mul_f32 v[52:53], v[16:17], v[70:71]
 v_pk_mul_f32 v[54:55], v[18:19], v[70:71]
 v_pk_mul_f32 v[56:57], v[20:21], v[70:71]
 v_pk_mul_f32 v[58:59], v[22:23], v[70:71]
 v_pk_mul_f32 v[60:61], v[24:25], v[70:71]
 v_pk_mul_f32 v[62:63], v[26:27], v[70:71]
 v_pk_mul_f32 v[64:65], v[28:29], v[70:71]
 v_pk_mul_f32 v[66:67], v[30:31], v[70:71]
 v_cvt_pk_bf16_f32 v84, v52, v53
 v_lshlrev_b32 v52, 16, v84
 v_and_b32 v53, 0xffff0000, v84
 v_cvt_pk_bf16_f32 v84, v54, v55
 v_lshlrev_b32 v54, 16, v84
 v_and_b32 v55, 0xffff0000, v84
 v_cvt_pk_bf16_f32 v84, v56, v57
 v_lshlrev_b32 v56, 16, v84
 v_and_b32 v57, 0xffff0000, v84
 v_cvt_pk_bf16_f32 v84, v58, v59
 v_lshlrev_b32 v58, 16, v84
 v_and_b32 v59, 0xffff0000, v84
 v_cvt_pk_bf16_f32 v84, v60, v61
 v_lshlrev_b32 v60, 16, v84
 v_and_b32 v61, 0xffff0000, v84
 v_cvt_pk_bf16_f32 v84, v62, v63
 v_lshlrev_b32 v62, 16, v84
 v_and_b32 v63, 0xffff0000, v84
 v_cvt_pk_bf16_f32 v84, v64, v65
 v_lshlrev_b32 v64, 16, v84
 v_and_b32 v65, 0xffff0000, v84
 v_cvt_pk_bf16_f32 v84, v66, v67
 v_lshlrev_b32 v66, 16, v84
 v_and_b32 v67, 0xffff0000, v84
 v_pk_add_f32 v[36:37], v[36:37], v[52:53]
 v_pk_add_f32 v[38:39], v[38:39], v[54:55]
 v_pk_add_f32 v[40:41], v[40:41], v[56:57]
 v_pk_add_f32 v[42:43], v[42:43], v[58:59]
 v_pk_add_f32 v[44:45], v[44:45], v[60:61]
 v_pk_add_f32 v[46:47], v[46:47], v[62:63]
 v_pk_add_f32 v[48:49], v[48:49], v[64:65]
 v_pk_add_f32 v[50:51], v[50:51], v[66:67]
 v_cvt_pk_bf16_f32 v84, v36, v37
 v_lshlrev_b32 v36, 16, v84
 v_and_b32 v37, 0xffff0000, v84
 v_cvt_pk_bf16_f32 v84, v38, v39
 v_lshlrev_b32 v38, 16, v84
 v_and_b32 v39, 0xffff0000, v84
 v_cvt_pk_bf16_f32 v84, v40, v41
 v_lshlrev_b32 v40, 16, v84
 v_and_b32 v41, 0xffff0000, v84
 v_cvt_pk_bf16_f32 v84, v42, v43
 v_lshlrev_b32 v42, 16, v84
 v_and_b32 v43, 0xffff0000, v84
 v_cvt_pk_bf16_f32 v84, v44, v45
 v_lshlrev_b32 v44, 16, v84
 v_and_b32 v45, 0xffff0000, v84
 v_cvt_pk_bf16_f32 v84, v46, v47
 v_lshlrev_b32 v46, 16, v84
 v_and_b32 v47, 0xffff0000, v84
 v_cvt_pk_bf16_f32 v84, v48, v49
 v_lshlrev_b32 v48, 16, v84
 v_and_b32 v49, 0xffff0000, v84
 v_cvt_pk_bf16_f32 v84, v50, v51
 v_lshlrev_b32 v50, 16, v84
 v_and_b32 v51, 0xffff0000, v84
 v_pk_mul_f32 v[52:53], v[18:19], v[68:69]
 v_pk_mul_f32 v[54:55], v[20:21], v[68:69]
 v_pk_mul_f32 v[56:57], v[22:23], v[68:69]
 v_pk_mul_f32 v[58:59], v[24:25], v[68:69]
 v_pk_mul_f32 v[60:61], v[26:27], v[68:69]
 v_pk_mul_f32 v[62:63], v[28:29], v[68:69]
 v_pk_mul_f32 v[64:65], v[30:31], v[68:69]
 v_pk_mul_f32 v[66:67], v[32:33], v[68:69]
 v_cvt_pk_bf16_f32 v84, v52, v53
 v_lshlrev_b32 v52, 16, v84
 v_and_b32 v53, 0xffff0000, v84
 v_cvt_pk_bf16_f32 v84, v54, v55
 v_lshlrev_b32 v54, 16, v84
 v_and_b32 v55, 0xffff0000, v84
 v_cvt_pk_bf16_f32 v84, v56, v57
 v_lshlrev_b32 v56, 16, v84
 v_and_b32 v57, 0xffff0000, v84
 v_cvt_pk_bf16_f32 v84, v58, v59
 v_lshlrev_b32 v58, 16, v84
 v_and_b32 v59, 0xffff0000, v84
 v_cvt_pk_bf16_f32 v84, v60, v61
 v_lshlrev_b32 v60, 16, v84
 v_and_b32 v61, 0xffff0000, v84
 v_cvt_pk_bf16_f32 v84, v62, v63
 v_lshlrev_b32 v62, 16, v84
 v_and_b32 v63, 0xffff0000, v84
 v_cvt_pk_bf16_f32 v84, v64, v65
 v_lshlrev_b32 v64, 16, v84
 v_and_b32 v65, 0xffff0000, v84
 v_cvt_pk_bf16_f32 v84, v66, v67
 v_lshlrev_b32 v66, 16, v84
 v_and_b32 v67, 0xffff0000, v84
 v_pk_add_f32 v[36:37], v[36:37], v[52:53]
 v_pk_add_f32 v[38:39], v[38:39], v[54:55]
 v_pk_add_f32 v[40:41], v[40:41], v[56:57]
 v_pk_add_f32 v[42:43], v[42:43], v[58:59]
 v_pk_add_f32 v[44:45], v[44:45], v[60:61]
 v_pk_add_f32 v[46:47], v[46:47], v[62:63]
 v_pk_add_f32 v[48:49], v[48:49], v[64:65]
 v_pk_add_f32 v[50:51], v[50:51], v[66:67]
 v_cvt_pk_bf16_f32 v84, v36, v37
 v_lshlrev_b32 v36, 16, v84
 v_and_b32 v37, 0xffff0000, v84
 v_cvt_pk_bf16_f32 v84, v38, v39
 v_lshlrev_b32 v38, 16, v84
 v_and_b32 v39, 0xffff0000, v84
 v_cvt_pk_bf16_f32 v84, v40, v41
 v_lshlrev_b32 v40, 16, v84
 v_and_b32 v41, 0xffff0000, v84
 v_cvt_pk_bf16_f32 v84, v42, v43
 v_lshlrev_b32 v42, 16, v84
 v_and_b32 v43, 0xffff0000, v84
 v_cvt_pk_bf16_f32 v84, v44, v45
 v_lshlrev_b32 v44, 16, v84
 v_and_b32 v45, 0xffff0000, v84
 v_cvt_pk_bf16_f32 v84, v46, v47
 v_lshlrev_b32 v46, 16, v84
 v_and_b32 v47, 0xffff0000, v84
 v_cvt_pk_bf16_f32 v84, v48, v49
 v_lshlrev_b32 v48, 16, v84
 v_and_b32 v49, 0xffff0000, v84
 v_cvt_pk_bf16_f32 v84, v50, v51
 v_lshlrev_b32 v50, 16, v84
 v_and_b32 v51, 0xffff0000, v84
 v_lshlrev_b32 v12, 16, v146
 v_and_b32 v13, 0xffff0000, v146
 v_lshlrev_b32 v14, 16, v150
 v_and_b32 v15, 0xffff0000, v150
 v_lshlrev_b32 v16, 16, v154
 v_and_b32 v17, 0xffff0000, v154
 v_lshlrev_b32 v18, 16, v158
 v_and_b32 v19, 0xffff0000, v158
 v_lshlrev_b32 v20, 16, v162
 v_and_b32 v21, 0xffff0000, v162
 v_lshlrev_b32 v22, 16, v166
 v_and_b32 v23, 0xffff0000, v166
 v_lshlrev_b32 v24, 16, v170
 v_and_b32 v25, 0xffff0000, v170
 v_lshlrev_b32 v26, 16, v174
 v_and_b32 v27, 0xffff0000, v174
 v_pk_mul_f32 v[36:37], v[36:37], v[12:13]
 v_pk_mul_f32 v[38:39], v[38:39], v[14:15]
 v_pk_mul_f32 v[40:41], v[40:41], v[16:17]
 v_pk_mul_f32 v[42:43], v[42:43], v[18:19]
 v_pk_mul_f32 v[44:45], v[44:45], v[20:21]
 v_pk_mul_f32 v[46:47], v[46:47], v[22:23]
 v_pk_mul_f32 v[48:49], v[48:49], v[24:25]
 v_pk_mul_f32 v[50:51], v[50:51], v[26:27]
 v_cvt_pk_bf16_f32 v76, v50, v48
 v_cvt_pk_bf16_f32 v77, v46, v44
 v_cvt_pk_bf16_f32 v78, v42, v40
 v_cvt_pk_bf16_f32 v79, v38, v36
 s_add_u32 s3, s70, 16384
 buffer_store_dwordx4 v[76:79], v94, s[4:7], s3 offen sc1
 v_cvt_pk_bf16_f32 v80, v51, v49
 v_cvt_pk_bf16_f32 v81, v47, v45
 v_cvt_pk_bf16_f32 v82, v43, v41
 v_cvt_pk_bf16_f32 v83, v39, v37
 s_add_u32 s3, s70, 20480
 buffer_store_dwordx4 v[80:83], v94, s[4:7], s3 offen sc1
 v_lshlrev_b32 v12, 16, v103
 v_and_b32 v13, 0xffff0000, v103
 v_lshlrev_b32 v14, 16, v107
 v_and_b32 v15, 0xffff0000, v107
 v_lshlrev_b32 v16, 16, v111
 v_and_b32 v17, 0xffff0000, v111
 v_lshlrev_b32 v18, 16, v115
 v_and_b32 v19, 0xffff0000, v115
 v_lshlrev_b32 v20, 16, v119
 v_and_b32 v21, 0xffff0000, v119
 v_lshlrev_b32 v22, 16, v123
 v_and_b32 v23, 0xffff0000, v123
 v_lshlrev_b32 v24, 16, v127
 v_and_b32 v25, 0xffff0000, v127
 v_lshlrev_b32 v26, 16, v131
 v_and_b32 v27, 0xffff0000, v131
 v_lshlrev_b32 v28, 16, v135
 v_and_b32 v29, 0xffff0000, v135
 v_lshlrev_b32 v30, 16, v139
 v_and_b32 v31, 0xffff0000, v139
 v_lshlrev_b32 v32, 16, v143
 v_and_b32 v33, 0xffff0000, v143
 v_lshlrev_b32 v68, 16, v188
 v_lshlrev_b32 v69, 16, v190
 v_and_b32 v70, 0xffff0000, v188
 v_and_b32 v71, 0xffff0000, v190
 v_lshlrev_b32 v72, 16, v189
 v_lshlrev_b32 v73, 16, v191
 v_and_b32 v74, 0xffff0000, v189
 v_and_b32 v75, 0xffff0000, v191
 v_pk_mul_f32 v[36:37], v[12:13], v[74:75]
 v_pk_mul_f32 v[38:39], v[14:15], v[74:75]
 v_pk_mul_f32 v[40:41], v[16:17], v[74:75]
 v_pk_mul_f32 v[42:43], v[18:19], v[74:75]
 v_pk_mul_f32 v[44:45], v[20:21], v[74:75]
 v_pk_mul_f32 v[46:47], v[22:23], v[74:75]
 v_pk_mul_f32 v[48:49], v[24:25], v[74:75]
 v_pk_mul_f32 v[50:51], v[26:27], v[74:75]
 v_cvt_pk_bf16_f32 v84, v36, v37
 v_lshlrev_b32 v36, 16, v84
 v_and_b32 v37, 0xffff0000, v84
 v_cvt_pk_bf16_f32 v84, v38, v39
 v_lshlrev_b32 v38, 16, v84
 v_and_b32 v39, 0xffff0000, v84
 v_cvt_pk_bf16_f32 v84, v40, v41
 v_lshlrev_b32 v40, 16, v84
 v_and_b32 v41, 0xffff0000, v84
 v_cvt_pk_bf16_f32 v84, v42, v43
 v_lshlrev_b32 v42, 16, v84
 v_and_b32 v43, 0xffff0000, v84
 v_cvt_pk_bf16_f32 v84, v44, v45
 v_lshlrev_b32 v44, 16, v84
 v_and_b32 v45, 0xffff0000, v84
 v_cvt_pk_bf16_f32 v84, v46, v47
 v_lshlrev_b32 v46, 16, v84
 v_and_b32 v47, 0xffff0000, v84
 v_cvt_pk_bf16_f32 v84, v48, v49
 v_lshlrev_b32 v48, 16, v84
 v_and_b32 v49, 0xffff0000, v84
 v_cvt_pk_bf16_f32 v84, v50, v51
 v_lshlrev_b32 v50, 16, v84
 v_and_b32 v51, 0xffff0000, v84
 v_pk_mul_f32 v[52:53], v[14:15], v[72:73]
 v_pk_mul_f32 v[54:55], v[16:17], v[72:73]
 v_pk_mul_f32 v[56:57], v[18:19], v[72:73]
 v_pk_mul_f32 v[58:59], v[20:21], v[72:73]
 v_pk_mul_f32 v[60:61], v[22:23], v[72:73]
 v_pk_mul_f32 v[62:63], v[24:25], v[72:73]
 v_pk_mul_f32 v[64:65], v[26:27], v[72:73]
 v_pk_mul_f32 v[66:67], v[28:29], v[72:73]
 v_cvt_pk_bf16_f32 v84, v52, v53
 v_lshlrev_b32 v52, 16, v84
 v_and_b32 v53, 0xffff0000, v84
 v_cvt_pk_bf16_f32 v84, v54, v55
 v_lshlrev_b32 v54, 16, v84
 v_and_b32 v55, 0xffff0000, v84
 v_cvt_pk_bf16_f32 v84, v56, v57
 v_lshlrev_b32 v56, 16, v84
 v_and_b32 v57, 0xffff0000, v84
 v_cvt_pk_bf16_f32 v84, v58, v59
 v_lshlrev_b32 v58, 16, v84
 v_and_b32 v59, 0xffff0000, v84
 v_cvt_pk_bf16_f32 v84, v60, v61
 v_lshlrev_b32 v60, 16, v84
 v_and_b32 v61, 0xffff0000, v84
 v_cvt_pk_bf16_f32 v84, v62, v63
 v_lshlrev_b32 v62, 16, v84
 v_and_b32 v63, 0xffff0000, v84
 v_cvt_pk_bf16_f32 v84, v64, v65
 v_lshlrev_b32 v64, 16, v84
 v_and_b32 v65, 0xffff0000, v84
 v_cvt_pk_bf16_f32 v84, v66, v67
 v_lshlrev_b32 v66, 16, v84
 v_and_b32 v67, 0xffff0000, v84
 v_pk_add_f32 v[36:37], v[36:37], v[52:53]
 v_pk_add_f32 v[38:39], v[38:39], v[54:55]
 v_pk_add_f32 v[40:41], v[40:41], v[56:57]
 v_pk_add_f32 v[42:43], v[42:43], v[58:59]
 v_pk_add_f32 v[44:45], v[44:45], v[60:61]
 v_pk_add_f32 v[46:47], v[46:47], v[62:63]
 v_pk_add_f32 v[48:49], v[48:49], v[64:65]
 v_pk_add_f32 v[50:51], v[50:51], v[66:67]
 v_cvt_pk_bf16_f32 v84, v36, v37
 v_lshlrev_b32 v36, 16, v84
 v_and_b32 v37, 0xffff0000, v84
 v_cvt_pk_bf16_f32 v84, v38, v39
 v_lshlrev_b32 v38, 16, v84
 v_and_b32 v39, 0xffff0000, v84
 v_cvt_pk_bf16_f32 v84, v40, v41
 v_lshlrev_b32 v40, 16, v84
 v_and_b32 v41, 0xffff0000, v84
 v_cvt_pk_bf16_f32 v84, v42, v43
 v_lshlrev_b32 v42, 16, v84
 v_and_b32 v43, 0xffff0000, v84
 v_cvt_pk_bf16_f32 v84, v44, v45
 v_lshlrev_b32 v44, 16, v84
 v_and_b32 v45, 0xffff0000, v84
 v_cvt_pk_bf16_f32 v84, v46, v47
 v_lshlrev_b32 v46, 16, v84
 v_and_b32 v47, 0xffff0000, v84
 v_cvt_pk_bf16_f32 v84, v48, v49
 v_lshlrev_b32 v48, 16, v84
 v_and_b32 v49, 0xffff0000, v84
 v_cvt_pk_bf16_f32 v84, v50, v51
 v_lshlrev_b32 v50, 16, v84
 v_and_b32 v51, 0xffff0000, v84
 v_pk_mul_f32 v[52:53], v[16:17], v[70:71]
 v_pk_mul_f32 v[54:55], v[18:19], v[70:71]
 v_pk_mul_f32 v[56:57], v[20:21], v[70:71]
 v_pk_mul_f32 v[58:59], v[22:23], v[70:71]
 v_pk_mul_f32 v[60:61], v[24:25], v[70:71]
 v_pk_mul_f32 v[62:63], v[26:27], v[70:71]
 v_pk_mul_f32 v[64:65], v[28:29], v[70:71]
 v_pk_mul_f32 v[66:67], v[30:31], v[70:71]
 v_cvt_pk_bf16_f32 v84, v52, v53
 v_lshlrev_b32 v52, 16, v84
 v_and_b32 v53, 0xffff0000, v84
 v_cvt_pk_bf16_f32 v84, v54, v55
 v_lshlrev_b32 v54, 16, v84
 v_and_b32 v55, 0xffff0000, v84
 v_cvt_pk_bf16_f32 v84, v56, v57
 v_lshlrev_b32 v56, 16, v84
 v_and_b32 v57, 0xffff0000, v84
 v_cvt_pk_bf16_f32 v84, v58, v59
 v_lshlrev_b32 v58, 16, v84
 v_and_b32 v59, 0xffff0000, v84
 v_cvt_pk_bf16_f32 v84, v60, v61
 v_lshlrev_b32 v60, 16, v84
 v_and_b32 v61, 0xffff0000, v84
 v_cvt_pk_bf16_f32 v84, v62, v63
 v_lshlrev_b32 v62, 16, v84
 v_and_b32 v63, 0xffff0000, v84
 v_cvt_pk_bf16_f32 v84, v64, v65
 v_lshlrev_b32 v64, 16, v84
 v_and_b32 v65, 0xffff0000, v84
 v_cvt_pk_bf16_f32 v84, v66, v67
 v_lshlrev_b32 v66, 16, v84
 v_and_b32 v67, 0xffff0000, v84
 v_pk_add_f32 v[36:37], v[36:37], v[52:53]
 v_pk_add_f32 v[38:39], v[38:39], v[54:55]
 v_pk_add_f32 v[40:41], v[40:41], v[56:57]
 v_pk_add_f32 v[42:43], v[42:43], v[58:59]
 v_pk_add_f32 v[44:45], v[44:45], v[60:61]
 v_pk_add_f32 v[46:47], v[46:47], v[62:63]
 v_pk_add_f32 v[48:49], v[48:49], v[64:65]
 v_pk_add_f32 v[50:51], v[50:51], v[66:67]
 v_cvt_pk_bf16_f32 v84, v36, v37
 v_lshlrev_b32 v36, 16, v84
 v_and_b32 v37, 0xffff0000, v84
 v_cvt_pk_bf16_f32 v84, v38, v39
 v_lshlrev_b32 v38, 16, v84
 v_and_b32 v39, 0xffff0000, v84
 v_cvt_pk_bf16_f32 v84, v40, v41
 v_lshlrev_b32 v40, 16, v84
 v_and_b32 v41, 0xffff0000, v84
 v_cvt_pk_bf16_f32 v84, v42, v43
 v_lshlrev_b32 v42, 16, v84
 v_and_b32 v43, 0xffff0000, v84
 v_cvt_pk_bf16_f32 v84, v44, v45
 v_lshlrev_b32 v44, 16, v84
 v_and_b32 v45, 0xffff0000, v84
 v_cvt_pk_bf16_f32 v84, v46, v47
 v_lshlrev_b32 v46, 16, v84
 v_and_b32 v47, 0xffff0000, v84
 v_cvt_pk_bf16_f32 v84, v48, v49
 v_lshlrev_b32 v48, 16, v84
 v_and_b32 v49, 0xffff0000, v84
 v_cvt_pk_bf16_f32 v84, v50, v51
 v_lshlrev_b32 v50, 16, v84
 v_and_b32 v51, 0xffff0000, v84
 v_pk_mul_f32 v[52:53], v[18:19], v[68:69]
 v_pk_mul_f32 v[54:55], v[20:21], v[68:69]
 v_pk_mul_f32 v[56:57], v[22:23], v[68:69]
 v_pk_mul_f32 v[58:59], v[24:25], v[68:69]
 v_pk_mul_f32 v[60:61], v[26:27], v[68:69]
 v_pk_mul_f32 v[62:63], v[28:29], v[68:69]
 v_pk_mul_f32 v[64:65], v[30:31], v[68:69]
 v_pk_mul_f32 v[66:67], v[32:33], v[68:69]
 v_cvt_pk_bf16_f32 v84, v52, v53
 v_lshlrev_b32 v52, 16, v84
 v_and_b32 v53, 0xffff0000, v84
 v_cvt_pk_bf16_f32 v84, v54, v55
 v_lshlrev_b32 v54, 16, v84
 v_and_b32 v55, 0xffff0000, v84
 v_cvt_pk_bf16_f32 v84, v56, v57
 v_lshlrev_b32 v56, 16, v84
 v_and_b32 v57, 0xffff0000, v84
 v_cvt_pk_bf16_f32 v84, v58, v59
 v_lshlrev_b32 v58, 16, v84
 v_and_b32 v59, 0xffff0000, v84
 v_cvt_pk_bf16_f32 v84, v60, v61
 v_lshlrev_b32 v60, 16, v84
 v_and_b32 v61, 0xffff0000, v84
 v_cvt_pk_bf16_f32 v84, v62, v63
 v_lshlrev_b32 v62, 16, v84
 v_and_b32 v63, 0xffff0000, v84
 v_cvt_pk_bf16_f32 v84, v64, v65
 v_lshlrev_b32 v64, 16, v84
 v_and_b32 v65, 0xffff0000, v84
 v_cvt_pk_bf16_f32 v84, v66, v67
 v_lshlrev_b32 v66, 16, v84
 v_and_b32 v67, 0xffff0000, v84
 v_pk_add_f32 v[36:37], v[36:37], v[52:53]
 v_pk_add_f32 v[38:39], v[38:39], v[54:55]
 v_pk_add_f32 v[40:41], v[40:41], v[56:57]
 v_pk_add_f32 v[42:43], v[42:43], v[58:59]
 v_pk_add_f32 v[44:45], v[44:45], v[60:61]
 v_pk_add_f32 v[46:47], v[46:47], v[62:63]
 v_pk_add_f32 v[48:49], v[48:49], v[64:65]
 v_pk_add_f32 v[50:51], v[50:51], v[66:67]
 v_cvt_pk_bf16_f32 v84, v36, v37
 v_lshlrev_b32 v36, 16, v84
 v_and_b32 v37, 0xffff0000, v84
 v_cvt_pk_bf16_f32 v84, v38, v39
 v_lshlrev_b32 v38, 16, v84
 v_and_b32 v39, 0xffff0000, v84
 v_cvt_pk_bf16_f32 v84, v40, v41
 v_lshlrev_b32 v40, 16, v84
 v_and_b32 v41, 0xffff0000, v84
 v_cvt_pk_bf16_f32 v84, v42, v43
 v_lshlrev_b32 v42, 16, v84
 v_and_b32 v43, 0xffff0000, v84
 v_cvt_pk_bf16_f32 v84, v44, v45
 v_lshlrev_b32 v44, 16, v84
 v_and_b32 v45, 0xffff0000, v84
 v_cvt_pk_bf16_f32 v84, v46, v47
 v_lshlrev_b32 v46, 16, v84
 v_and_b32 v47, 0xffff0000, v84
 v_cvt_pk_bf16_f32 v84, v48, v49
 v_lshlrev_b32 v48, 16, v84
 v_and_b32 v49, 0xffff0000, v84
 v_cvt_pk_bf16_f32 v84, v50, v51
 v_lshlrev_b32 v50, 16, v84
 v_and_b32 v51, 0xffff0000, v84
 v_lshlrev_b32 v12, 16, v147
 v_and_b32 v13, 0xffff0000, v147
 v_lshlrev_b32 v14, 16, v151
 v_and_b32 v15, 0xffff0000, v151
 v_lshlrev_b32 v16, 16, v155
 v_and_b32 v17, 0xffff0000, v155
 v_lshlrev_b32 v18, 16, v159
 v_and_b32 v19, 0xffff0000, v159
 v_lshlrev_b32 v20, 16, v163
 v_and_b32 v21, 0xffff0000, v163
 v_lshlrev_b32 v22, 16, v167
 v_and_b32 v23, 0xffff0000, v167
 v_lshlrev_b32 v24, 16, v171
 v_and_b32 v25, 0xffff0000, v171
 v_lshlrev_b32 v26, 16, v175
 v_and_b32 v27, 0xffff0000, v175
 v_pk_mul_f32 v[36:37], v[36:37], v[12:13]
 v_pk_mul_f32 v[38:39], v[38:39], v[14:15]
 v_pk_mul_f32 v[40:41], v[40:41], v[16:17]
 v_pk_mul_f32 v[42:43], v[42:43], v[18:19]
 v_pk_mul_f32 v[44:45], v[44:45], v[20:21]
 v_pk_mul_f32 v[46:47], v[46:47], v[22:23]
 v_pk_mul_f32 v[48:49], v[48:49], v[24:25]
 v_pk_mul_f32 v[50:51], v[50:51], v[26:27]
 v_cvt_pk_bf16_f32 v76, v50, v48
 v_cvt_pk_bf16_f32 v77, v46, v44
 v_cvt_pk_bf16_f32 v78, v42, v40
 v_cvt_pk_bf16_f32 v79, v38, v36
 s_add_u32 s3, s70, 24576
 buffer_store_dwordx4 v[76:79], v94, s[4:7], s3 offen sc1
 v_cvt_pk_bf16_f32 v80, v51, v49
 v_cvt_pk_bf16_f32 v81, v47, v45
 v_cvt_pk_bf16_f32 v82, v43, v41
 v_cvt_pk_bf16_f32 v83, v39, v37
 s_add_u32 s3, s70, 28672
 buffer_store_dwordx4 v[80:83], v94, s[4:7], s3 offen sc1
 s_cmp_eq_u32 s83, 1
 s_cbranch_scc1 L_k3_25
 s_waitcnt vmcnt(0)
 s_barrier
 s_cmp_lg_u32 s50, 3
 s_cbranch_scc1 L_ar_26
 s_mov_b32 s96, s44
 s_and_b32 s97, s45, 0xffff
 s_mov_b32 s98, 256
 s_mov_b32 s99, 0x00020000
 v_mov_b32 v1, 1
 s_mov_b64 exec, 1
 buffer_atomic_add v1, off, s[96:99], 0 offset:80 sc0
 s_waitcnt vmcnt(0)
 v_cmp_eq_u32 vcc, 39, v1
 s_cbranch_vccz L_aw_27
 buffer_store_dword v1, off, s[96:99], 0 offset:208 sc1
L_aw_27:
 s_mov_b64 exec, -1
L_ar_26:
 s_branch L_help_conv
L_k3_25:
 s_waitcnt vmcnt(0)
 s_barrier
 s_cmp_lg_u32 s50, 3
 s_cbranch_scc1 L_ar_28
 s_mov_b32 s96, s44
 s_and_b32 s97, s45, 0xffff
 s_mov_b32 s98, 256
 s_mov_b32 s99, 0x00020000
 v_mov_b32 v1, 1
 s_mov_b64 exec, 1
 buffer_atomic_add v1, off, s[96:99], 0 offset:68 sc0
 s_waitcnt vmcnt(0)
 v_cmp_eq_u32 vcc, 39, v1
 s_cbranch_vccz L_aw_29
 buffer_store_dword v1, off, s[96:99], 0 offset:196 sc1
L_aw_29:
 s_mov_b64 exec, -1
L_ar_28:
 s_mov_b32 s8, s26
 s_and_b32 s9, s27, 0xffff
 s_mov_b32 s10, 5242880
 s_mov_b32 s11, 0x00020000
 s_mul_i32 s57, s50, 40960
 s_and_b32 s55, s53, 3
 s_add_u32 s64, s55, 0
 s_sub_u32 s3, s64, 4
 s_cmp_ge_u32 s64, 4
 s_cselect_b32 s64, s3, s64
 s_add_u32 s65, s55, 1
 s_sub_u32 s3, s65, 4
 s_cmp_ge_u32 s65, 4
 s_cselect_b32 s65, s3, s65
 s_add_u32 s66, s55, 2
 s_sub_u32 s3, s66, 4
 s_cmp_ge_u32 s66, 4
 s_cselect_b32 s66, s3, s66
 s_add_u32 s67, s55, 3
 s_sub_u32 s3, s67, 4
 s_cmp_ge_u32 s67, 4
 s_cselect_b32 s67, s3, s67
 s_mul_i32 s55, s52, 655360
 s_lshl_b32 s3, s53, 8
 s_add_u32 s55, s55, s3
 v_lshrrev_b32 v4, 4, v0
 s_mov_b32 s3, 1280
 v_mul_lo_u32 v4, v4, s3
 v_lshrrev_b32 v3, 3, v0
 v_and_b32 v3, 6, v3
 v_xor_b32 v3, v3, v0
 v_and_b32 v3, 15, v3
 v_lshl_add_u32 v4, v3, 4, v4
 v_xor_b32 v5, 128, v4
 s_lshl_b32 s57, s50, 13
 s_mul_i32 s3, s50, 40960
 s_add_u32 s55, s55, s3
 s_mul_i32 s51, s64, 163840
 s_add_u32 s51, s51, s55
 s_add_u32 m0, s57, 0
 s_nop 0
 buffer_load_dwordx4 v4, s[8:11], s51 offen lds
 s_add_u32 s51, s51, 5120
 s_add_u32 m0, s57, 1024
 s_nop 0
 buffer_load_dwordx4 v5, s[8:11], s51 offen lds
 s_add_u32 s51, s51, 5120
 s_add_u32 m0, s57, 2048
 s_nop 0
 buffer_load_dwordx4 v4, s[8:11], s51 offen lds
 s_add_u32 s51, s51, 5120
 s_add_u32 m0, s57, 3072
 s_nop 0
 buffer_load_dwordx4 v5, s[8:11], s51 offen lds
 s_add_u32 s51, s51, 5120
 s_add_u32 m0, s57, 4096
 s_nop 0
 buffer_load_dwordx4 v4, s[8:11], s51 offen lds
 s_add_u32 s51, s51, 5120
 s_add_u32 m0, s57, 5120
 s_nop 0
 buffer_load_dwordx4 v5, s[8:11], s51 offen lds
 s_add_u32 s51, s51, 5120
 s_add_u32 m0, s57, 6144
 s_nop 0
 buffer_load_dwordx4 v4, s[8:11], s51 offen lds
 s_add_u32 s51, s51, 5120
 s_add_u32 m0, s57, 7168
 s_nop 0
 buffer_load_dwordx4 v5, s[8:11], s51 offen lds
 s_add_u32 s51, s51, 5120
 s_mul_i32 s51, s65, 163840
 s_add_u32 s51, s51, s55
 s_add_u32 m0, s57, 32768
 s_nop 0
 buffer_load_dwordx4 v4, s[8:11], s51 offen lds
 s_add_u32 s51, s51, 5120
 s_add_u32 m0, s57, 33792
 s_nop 0
 buffer_load_dwordx4 v5, s[8:11], s51 offen lds
 s_add_u32 s51, s51, 5120
 s_add_u32 m0, s57, 34816
 s_nop 0
 buffer_load_dwordx4 v4, s[8:11], s51 offen lds
 s_add_u32 s51, s51, 5120
 s_add_u32 m0, s57, 35840
 s_nop 0
 buffer_load_dwordx4 v5, s[8:11], s51 offen lds
 s_add_u32 s51, s51, 5120
 s_add_u32 m0, s57, 36864
 s_nop 0
 buffer_load_dwordx4 v4, s[8:11], s51 offen lds
 s_add_u32 s51, s51, 5120
 s_add_u32 m0, s57, 37888
 s_nop 0
 buffer_load_dwordx4 v5, s[8:11], s51 offen lds
 s_add_u32 s51, s51, 5120
 s_add_u32 m0, s57, 38912
 s_nop 0
 buffer_load_dwordx4 v4, s[8:11], s51 offen lds
 s_add_u32 s51, s51, 5120
 s_add_u32 m0, s57, 39936
 s_nop 0
 buffer_load_dwordx4 v5, s[8:11], s51 offen lds
 s_add_u32 s51, s51, 5120
 s_mul_i32 s51, s66, 163840
 s_add_u32 s51, s51, s55
 s_add_u32 m0, s57, 65536
 s_nop 0
 buffer_load_dwordx4 v4, s[8:11], s51 offen lds
 s_add_u32 s51, s51, 5120
 s_add_u32 m0, s57, 66560
 s_nop 0
 buffer_load_dwordx4 v5, s[8:11], s51 offen lds
 s_add_u32 s51, s51, 5120
 s_add_u32 m0, s57, 67584
 s_nop 0
 buffer_load_dwordx4 v4, s[8:11], s51 offen lds
 s_add_u32 s51, s51, 5120
 s_add_u32 m0, s57, 68608
 s_nop 0
 buffer_load_dwordx4 v5, s[8:11], s51 offen lds
 s_add_u32 s51, s51, 5120
 s_add_u32 m0, s57, 69632
 s_nop 0
 buffer_load_dwordx4 v4, s[8:11], s51 offen lds
 s_add_u32 s51, s51, 5120
 s_add_u32 m0, s57, 70656
 s_nop 0
 buffer_load_dwordx4 v5, s[8:11], s51 offen lds
 s_add_u32 s51, s51, 5120
 s_add_u32 m0, s57, 71680
 s_nop 0
 buffer_load_dwordx4 v4, s[8:11], s51 offen lds
 s_add_u32 s51, s51, 5120
 s_add_u32 m0, s57, 72704
 s_nop 0
 buffer_load_dwordx4 v5, s[8:11], s51 offen lds
 s_add_u32 s51, s51, 5120
 s_mul_i32 s51, s67, 163840
 s_add_u32 s51, s51, s55
 s_add_u32 m0, s57, 98304
 s_nop 0
 buffer_load_dwordx4 v4, s[8:11], s51 offen lds
 s_add_u32 s51, s51, 5120
 s_add_u32 m0, s57, 99328
 s_nop 0
 buffer_load_dwordx4 v5, s[8:11], s51 offen lds
 s_add_u32 s51, s51, 5120
 s_add_u32 m0, s57, 100352
 s_nop 0
 buffer_load_dwordx4 v4, s[8:11], s51 offen lds
 s_add_u32 s51, s51, 5120
 s_add_u32 m0, s57, 101376
 s_nop 0
 buffer_load_dwordx4 v5, s[8:11], s51 offen lds
 s_add_u32 s51, s51, 5120
 s_add_u32 m0, s57, 102400
 s_nop 0
 buffer_load_dwordx4 v4, s[8:11], s51 offen lds
 s_add_u32 s51, s51, 5120
 s_add_u32 m0, s57, 103424
 s_nop 0
 buffer_load_dwordx4 v5, s[8:11], s51 offen lds
 s_add_u32 s51, s51, 5120
 s_add_u32 m0, s57, 104448
 s_nop 0
 buffer_load_dwordx4 v4, s[8:11], s51 offen lds
 s_add_u32 s51, s51, 5120
 s_add_u32 m0, s57, 105472
 s_nop 0
 buffer_load_dwordx4 v5, s[8:11], s51 offen lds
 s_add_u32 s51, s51, 5120
 v_lshrrev_b32 v2, 3, v0
 v_and_b32 v2, 4, v2
 v_bfe_u32 v3, v0, 2, 2
 v_or_b32 v2, v2, v3
 v_bfe_u32 v3, v0, 4, 1
 v_xor_b32 v3, v3, v2
 s_lshl_b32 s3, s50, 1
 v_xor_b32 v3, s3, v3
 v_lshlrev_b32 v2, 8, v2
 v_lshl_add_u32 v2, v3, 5, v2
 v_and_b32 v3, 3, v0
 v_lshl_add_u32 v2, v3, 3, v2
 s_waitcnt vmcnt(24)
 s_barrier
 ds_read_b64_tr_b16 a[0:1], v2 offset:0
 ds_read_b64_tr_b16 a[2:3], v2 offset:4096
 ds_read_b64_tr_b16 a[4:5], v2 offset:2048
 ds_read_b64_tr_b16 a[6:7], v2 offset:6144
 ds_read_b64_tr_b16 a[8:9], v2 offset:8192
 ds_read_b64_tr_b16 a[10:11], v2 offset:12288
 ds_read_b64_tr_b16 a[12:13], v2 offset:10240
 ds_read_b64_tr_b16 a[14:15], v2 offset:14336
 ds_read_b64_tr_b16 a[16:17], v2 offset:16384
 ds_read_b64_tr_b16 a[18:19], v2 offset:20480
 ds_read_b64_tr_b16 a[20:21], v2 offset:18432
 ds_read_b64_tr_b16 a[22:23], v2 offset:22528
 ds_read_b64_tr_b16 a[24:25], v2 offset:24576
 ds_read_b64_tr_b16 a[26:27], v2 offset:28672
 ds_read_b64_tr_b16 a[28:29], v2 offset:26624
 ds_read_b64_tr_b16 a[30:31], v2 offset:30720
 v_add_u32 v2, 0x8000, v2
 s_waitcnt vmcnt(16)
 s_barrier
 ds_read_b64_tr_b16 a[32:33], v2 offset:0
 ds_read_b64_tr_b16 a[34:35], v2 offset:4096
 ds_read_b64_tr_b16 a[36:37], v2 offset:2048
 ds_read_b64_tr_b16 a[38:39], v2 offset:6144
 ds_read_b64_tr_b16 a[40:41], v2 offset:8192
 ds_read_b64_tr_b16 a[42:43], v2 offset:12288
 ds_read_b64_tr_b16 a[44:45], v2 offset:10240
 ds_read_b64_tr_b16 a[46:47], v2 offset:14336
 ds_read_b64_tr_b16 a[48:49], v2 offset:16384
 ds_read_b64_tr_b16 a[50:51], v2 offset:20480
 ds_read_b64_tr_b16 a[52:53], v2 offset:18432
 ds_read_b64_tr_b16 a[54:55], v2 offset:22528
 ds_read_b64_tr_b16 a[56:57], v2 offset:24576
 ds_read_b64_tr_b16 a[58:59], v2 offset:28672
 ds_read_b64_tr_b16 a[60:61], v2 offset:26624
 ds_read_b64_tr_b16 a[62:63], v2 offset:30720
 v_add_u32 v2, 0x8000, v2
 s_waitcnt vmcnt(8)
 s_barrier
 ds_read_b64_tr_b16 a[64:65], v2 offset:0
 ds_read_b64_tr_b16 a[66:67], v2 offset:4096
 ds_read_b64_tr_b16 a[68:69], v2 offset:2048
 ds_read_b64_tr_b16 a[70:71], v2 offset:6144
 ds_read_b64_tr_b16 a[72:73], v2 offset:8192
 ds_read_b64_tr_b16 a[74:75], v2 offset:12288
 ds_read_b64_tr_b16 a[76:77], v2 offset:10240
 ds_read_b64_tr_b16 a[78:79], v2 offset:14336
 ds_read_b64_tr_b16 a[80:81], v2 offset:16384
 ds_read_b64_tr_b16 a[82:83], v2 offset:20480
 ds_read_b64_tr_b16 a[84:85], v2 offset:18432
 ds_read_b64_tr_b16 a[86:87], v2 offset:22528
 ds_read_b64_tr_b16 a[88:89], v2 offset:24576
 ds_read_b64_tr_b16 a[90:91], v2 offset:28672
 ds_read_b64_tr_b16 a[92:93], v2 offset:26624
 ds_read_b64_tr_b16 a[94:95], v2 offset:30720
 v_add_u32 v2, 0x8000, v2
 s_waitcnt vmcnt(0)
 s_barrier
 ds_read_b64_tr_b16 a[96:97], v2 offset:0
 ds_read_b64_tr_b16 a[98:99], v2 offset:4096
 ds_read_b64_tr_b16 a[100:101], v2 offset:2048
 ds_read_b64_tr_b16 a[102:103], v2 offset:6144
 ds_read_b64_tr_b16 a[104:105], v2 offset:8192
 ds_read_b64_tr_b16 a[106:107], v2 offset:12288
 ds_read_b64_tr_b16 a[108:109], v2 offset:10240
 ds_read_b64_tr_b16 a[110:111], v2 offset:14336
 ds_read_b64_tr_b16 a[112:113], v2 offset:16384
 ds_read_b64_tr_b16 a[114:115], v2 offset:20480
 ds_read_b64_tr_b16 a[116:117], v2 offset:18432
 ds_read_b64_tr_b16 a[118:119], v2 offset:22528
 ds_read_b64_tr_b16 a[120:121], v2 offset:24576
 ds_read_b64_tr_b16 a[122:123], v2 offset:28672
 ds_read_b64_tr_b16 a[124:125], v2 offset:26624
 ds_read_b64_tr_b16 a[126:127], v2 offset:30720
 v_add_u32 v2, 0x8000, v2
 s_waitcnt lgkmcnt(0)
 s_barrier
L_help_conv:
 s_cmp_ge_u32 s82, 72
 s_cbranch_scc1 L_help_ln2
 s_cmp_ge_u32 s82, 64
 s_cbranch_scc1 L_help_done
 s_lshl_b32 s70, s82, 2
 s_add_u32 s70, s70, s50
 s_add_u32 s70, s70, 384
 s_mul_i32 s71, s50, 13312
 s_mov_b32 s69, 640
 s_mov_b32 s8, s38
 s_and_b32 s9, s39, 0xffff
 s_mov_b32 s10, 2621440
 s_mov_b32 s11, 0x00020000
 s_mov_b32 s12, s40
 s_and_b32 s13, s41, 0xffff
 s_mov_b32 s14, 1280
 s_mov_b32 s15, 0x00020000
 v_lshlrev_b32 v130, 4, v0
 s_lshl_b32 s73, s70, 12
 s_add_u32 s74, s73, 2
 buffer_load_dwordx4 v[96:99], v130, s[8:11], s73 offen offset:0
 buffer_load_dwordx4 v[100:103], v130, s[8:11], s73 offen offset:1024
 buffer_load_dwordx4 v[112:115], v130, s[8:11], s74 offen offset:0
 buffer_load_dwordx4 v[116:119], v130, s[8:11], s74 offen offset:1024
 s_lshl_b32 s3, s70, 1
 buffer_load_ushort v128, off, s[12:15], s3
 s_getpc_b64 s[76:77]
L_ca_30:
 s_add_u32 s76, s76, L_conv0-L_ca_30
 s_addc_u32 s77, s77, -1
 s_swappc_b64 s[76:77], s[76:77]
 s_waitcnt vmcnt(0)
 s_barrier
 s_cmp_lg_u32 s50, 3
 s_cbranch_scc1 L_ar_31
 s_mov_b32 s96, s44
 s_and_b32 s97, s45, 0xffff
 s_mov_b32 s98, 256
 s_mov_b32 s99, 0x00020000
 v_mov_b32 v1, 1
 s_mov_b64 exec, 1
 buffer_atomic_add v1, off, s[96:99], 0 offset:8 sc0
 s_waitcnt vmcnt(0)
 v_cmp_eq_u32 vcc, 159, v1
 s_cbranch_vccz L_aw_32
 buffer_store_dword v1, off, s[96:99], 0 offset:136 sc1
L_aw_32:
 s_mov_b64 exec, -1
L_ar_31:
L_help_done:
 s_cmp_lg_u32 s50, 0
 s_cbranch_scc1 L_ww_33
 s_mov_b32 s96, s44
 s_and_b32 s97, s45, 0xffff
 s_mov_b32 s98, 256
 s_mov_b32 s99, 0x00020000
 v_mov_b32 v1, 132
 s_mov_b32 s51, 0
 s_mov_b64 exec, 1
L_wb_34:
 buffer_load_dword v2, v1, s[96:99], 0 offen sc1
 s_waitcnt vmcnt(0)
 v_cmp_eq_u32 vcc, 0, v2
 s_cbranch_vccz L_wbd_35
 s_sleep 2
 s_add_u32 s51, s51, 1
 s_cmp_lt_u32 s51, 131072
 s_cbranch_scc1 L_wb_34
 s_branch L_bail
L_wbd_35:
 s_mov_b64 exec, -1
L_ww_33:
 s_barrier
 s_cmp_eq_u32 s83, 0
 s_cbranch_scc1 L_t4
 s_cmp_eq_u32 s83, 1
 s_cbranch_scc1 L_wo
 s_branch L_att
L_qkvq:
 s_mul_i32 s57, s50, 40960
 s_mul_i32 s62, s52, 3
 s_add_u32 s62, s62, s53
 s_mul_i32 s3, s62, 13108
 s_lshr_b32 s3, s3, 16
 s_mul_i32 s3, s3, 5
 s_sub_u32 s55, s62, s3
 s_add_u32 s64, s55, 0
 s_sub_u32 s3, s64, 5
 s_cmp_ge_u32 s64, 5
 s_cselect_b32 s64, s3, s64
 s_add_u32 s65, s55, 1
 s_sub_u32 s3, s65, 5
 s_cmp_ge_u32 s65, 5
 s_cselect_b32 s65, s3, s65
 s_add_u32 s66, s55, 2
 s_sub_u32 s3, s66, 5
 s_cmp_ge_u32 s66, 5
 s_cselect_b32 s66, s3, s66
 s_add_u32 s67, s55, 3
 s_sub_u32 s3, s67, 5
 s_cmp_ge_u32 s67, 5
 s_cselect_b32 s67, s3, s67
 s_add_u32 s68, s55, 4
 s_sub_u32 s3, s68, 5
 s_cmp_ge_u32 s68, 5
 s_cselect_b32 s68, s3, s68
 s_lshl_b32 s55, s52, 8
 v_lshrrev_b32 v4, 4, v0
 s_mov_b32 s3, 8192
 v_mul_lo_u32 v4, v4, s3
 v_lshrrev_b32 v3, 3, v0
 v_and_b32 v3, 6, v3
 v_xor_b32 v3, v3, v0
 v_and_b32 v3, 15, v3
 v_lshl_add_u32 v4, v3, 4, v4
 v_xor_b32 v5, 128, v4
 s_lshl_b32 s57, s50, 13
 s_mul_i32 s3, s50, 262144
 s_add_u32 s55, s55, s3
 s_mul_i32 s51, s64, 1048576
 s_add_u32 s51, s51, s55
 s_add_u32 m0, s57, 0
 s_nop 0
 buffer_load_dwordx4 v4, s[8:11], s51 offen lds
 s_add_u32 s51, s51, 32768
 s_add_u32 m0, s57, 1024
 s_nop 0
 buffer_load_dwordx4 v5, s[8:11], s51 offen lds
 s_add_u32 s51, s51, 32768
 s_add_u32 m0, s57, 2048
 s_nop 0
 buffer_load_dwordx4 v4, s[8:11], s51 offen lds
 s_add_u32 s51, s51, 32768
 s_add_u32 m0, s57, 3072
 s_nop 0
 buffer_load_dwordx4 v5, s[8:11], s51 offen lds
 s_add_u32 s51, s51, 32768
 s_add_u32 m0, s57, 4096
 s_nop 0
 buffer_load_dwordx4 v4, s[8:11], s51 offen lds
 s_add_u32 s51, s51, 32768
 s_add_u32 m0, s57, 5120
 s_nop 0
 buffer_load_dwordx4 v5, s[8:11], s51 offen lds
 s_add_u32 s51, s51, 32768
 s_add_u32 m0, s57, 6144
 s_nop 0
 buffer_load_dwordx4 v4, s[8:11], s51 offen lds
 s_add_u32 s51, s51, 32768
 s_add_u32 m0, s57, 7168
 s_nop 0
 buffer_load_dwordx4 v5, s[8:11], s51 offen lds
 s_add_u32 s51, s51, 32768
 s_mul_i32 s51, s65, 1048576
 s_add_u32 s51, s51, s55
 s_add_u32 m0, s57, 32768
 s_nop 0
 buffer_load_dwordx4 v4, s[8:11], s51 offen lds
 s_add_u32 s51, s51, 32768
 s_add_u32 m0, s57, 33792
 s_nop 0
 buffer_load_dwordx4 v5, s[8:11], s51 offen lds
 s_add_u32 s51, s51, 32768
 s_add_u32 m0, s57, 34816
 s_nop 0
 buffer_load_dwordx4 v4, s[8:11], s51 offen lds
 s_add_u32 s51, s51, 32768
 s_add_u32 m0, s57, 35840
 s_nop 0
 buffer_load_dwordx4 v5, s[8:11], s51 offen lds
 s_add_u32 s51, s51, 32768
 s_add_u32 m0, s57, 36864
 s_nop 0
 buffer_load_dwordx4 v4, s[8:11], s51 offen lds
 s_add_u32 s51, s51, 32768
 s_add_u32 m0, s57, 37888
 s_nop 0
 buffer_load_dwordx4 v5, s[8:11], s51 offen lds
 s_add_u32 s51, s51, 32768
 s_add_u32 m0, s57, 38912
 s_nop 0
 buffer_load_dwordx4 v4, s[8:11], s51 offen lds
 s_add_u32 s51, s51, 32768
 s_add_u32 m0, s57, 39936
 s_nop 0
 buffer_load_dwordx4 v5, s[8:11], s51 offen lds
 s_add_u32 s51, s51, 32768
 s_mul_i32 s51, s66, 1048576
 s_add_u32 s51, s51, s55
 s_add_u32 m0, s57, 65536
 s_nop 0
 buffer_load_dwordx4 v4, s[8:11], s51 offen lds
 s_add_u32 s51, s51, 32768
 s_add_u32 m0, s57, 66560
 s_nop 0
 buffer_load_dwordx4 v5, s[8:11], s51 offen lds
 s_add_u32 s51, s51, 32768
 s_add_u32 m0, s57, 67584
 s_nop 0
 buffer_load_dwordx4 v4, s[8:11], s51 offen lds
 s_add_u32 s51, s51, 32768
 s_add_u32 m0, s57, 68608
 s_nop 0
 buffer_load_dwordx4 v5, s[8:11], s51 offen lds
 s_add_u32 s51, s51, 32768
 s_add_u32 m0, s57, 69632
 s_nop 0
 buffer_load_dwordx4 v4, s[8:11], s51 offen lds
 s_add_u32 s51, s51, 32768
 s_add_u32 m0, s57, 70656
 s_nop 0
 buffer_load_dwordx4 v5, s[8:11], s51 offen lds
 s_add_u32 s51, s51, 32768
 s_add_u32 m0, s57, 71680
 s_nop 0
 buffer_load_dwordx4 v4, s[8:11], s51 offen lds
 s_add_u32 s51, s51, 32768
 s_add_u32 m0, s57, 72704
 s_nop 0
 buffer_load_dwordx4 v5, s[8:11], s51 offen lds
 s_add_u32 s51, s51, 32768
 s_mul_i32 s51, s67, 1048576
 s_add_u32 s51, s51, s55
 s_add_u32 m0, s57, 98304
 s_nop 0
 buffer_load_dwordx4 v4, s[8:11], s51 offen lds
 s_add_u32 s51, s51, 32768
 s_add_u32 m0, s57, 99328
 s_nop 0
 buffer_load_dwordx4 v5, s[8:11], s51 offen lds
 s_add_u32 s51, s51, 32768
 s_add_u32 m0, s57, 100352
 s_nop 0
 buffer_load_dwordx4 v4, s[8:11], s51 offen lds
 s_add_u32 s51, s51, 32768
 s_add_u32 m0, s57, 101376
 s_nop 0
 buffer_load_dwordx4 v5, s[8:11], s51 offen lds
 s_add_u32 s51, s51, 32768
 s_add_u32 m0, s57, 102400
 s_nop 0
 buffer_load_dwordx4 v4, s[8:11], s51 offen lds
 s_add_u32 s51, s51, 32768
 s_add_u32 m0, s57, 103424
 s_nop 0
 buffer_load_dwordx4 v5, s[8:11], s51 offen lds
 s_add_u32 s51, s51, 32768
 s_add_u32 m0, s57, 104448
 s_nop 0
 buffer_load_dwordx4 v4, s[8:11], s51 offen lds
 s_add_u32 s51, s51, 32768
 s_add_u32 m0, s57, 105472
 s_nop 0
 buffer_load_dwordx4 v5, s[8:11], s51 offen lds
 s_add_u32 s51, s51, 32768
 s_mul_i32 s51, s68, 1048576
 s_add_u32 s51, s51, s55
 s_add_u32 m0, s57, 131072
 s_nop 0
 buffer_load_dwordx4 v4, s[8:11], s51 offen lds
 s_add_u32 s51, s51, 32768
 s_add_u32 m0, s57, 132096
 s_nop 0
 buffer_load_dwordx4 v5, s[8:11], s51 offen lds
 s_add_u32 s51, s51, 32768
 s_add_u32 m0, s57, 133120
 s_nop 0
 buffer_load_dwordx4 v4, s[8:11], s51 offen lds
 s_add_u32 s51, s51, 32768
 s_add_u32 m0, s57, 134144
 s_nop 0
 buffer_load_dwordx4 v5, s[8:11], s51 offen lds
 s_add_u32 s51, s51, 32768
 s_add_u32 m0, s57, 135168
 s_nop 0
 buffer_load_dwordx4 v4, s[8:11], s51 offen lds
 s_add_u32 s51, s51, 32768
 s_add_u32 m0, s57, 136192
 s_nop 0
 buffer_load_dwordx4 v5, s[8:11], s51 offen lds
 s_add_u32 s51, s51, 32768
 s_add_u32 m0, s57, 137216
 s_nop 0
 buffer_load_dwordx4 v4, s[8:11], s51 offen lds
 s_add_u32 s51, s51, 32768
 s_add_u32 m0, s57, 138240
 s_nop 0
 buffer_load_dwordx4 v5, s[8:11], s51 offen lds
 s_add_u32 s51, s51, 32768
 s_mov_b32 s96, s44
 s_and_b32 s97, s45, 0xffff
 s_mov_b32 s98, 256
 s_mov_b32 s99, 0x00020000
 buffer_load_dword v30, off, s[96:99], 0 offset:132 sc1
 v_lshrrev_b32 v2, 3, v0
 v_and_b32 v2, 4, v2
 v_bfe_u32 v3, v0, 2, 2
 v_or_b32 v2, v2, v3
 v_bfe_u32 v3, v0, 4, 1
 v_xor_b32 v3, v3, v2
 s_lshl_b32 s3, s50, 1
 v_xor_b32 v3, s3, v3
 v_lshlrev_b32 v2, 8, v2
 v_lshl_add_u32 v2, v3, 5, v2
 v_and_b32 v3, 3, v0
 v_lshl_add_u32 v2, v3, 3, v2
 s_waitcnt vmcnt(32)
 s_barrier
 ds_read_b64_tr_b16 a[0:1], v2 offset:0
 ds_read_b64_tr_b16 a[2:3], v2 offset:4096
 ds_read_b64_tr_b16 a[4:5], v2 offset:2048
 ds_read_b64_tr_b16 a[6:7], v2 offset:6144
 ds_read_b64_tr_b16 a[8:9], v2 offset:8192
 ds_read_b64_tr_b16 a[10:11], v2 offset:12288
 ds_read_b64_tr_b16 a[12:13], v2 offset:10240
 ds_read_b64_tr_b16 a[14:15], v2 offset:14336
 ds_read_b64_tr_b16 a[16:17], v2 offset:16384
 ds_read_b64_tr_b16 a[18:19], v2 offset:20480
 ds_read_b64_tr_b16 a[20:21], v2 offset:18432
 ds_read_b64_tr_b16 a[22:23], v2 offset:22528
 ds_read_b64_tr_b16 a[24:25], v2 offset:24576
 ds_read_b64_tr_b16 a[26:27], v2 offset:28672
 ds_read_b64_tr_b16 a[28:29], v2 offset:26624
 ds_read_b64_tr_b16 a[30:31], v2 offset:30720
 v_add_u32 v2, 0x8000, v2
 s_waitcnt vmcnt(24)
 s_barrier
 ds_read_b64_tr_b16 a[32:33], v2 offset:0
 ds_read_b64_tr_b16 a[34:35], v2 offset:4096
 ds_read_b64_tr_b16 a[36:37], v2 offset:2048
 ds_read_b64_tr_b16 a[38:39], v2 offset:6144
 ds_read_b64_tr_b16 a[40:41], v2 offset:8192
 ds_read_b64_tr_b16 a[42:43], v2 offset:12288
 ds_read_b64_tr_b16 a[44:45], v2 offset:10240
 ds_read_b64_tr_b16 a[46:47], v2 offset:14336
 ds_read_b64_tr_b16 a[48:49], v2 offset:16384
 ds_read_b64_tr_b16 a[50:51], v2 offset:20480
 ds_read_b64_tr_b16 a[52:53], v2 offset:18432
 ds_read_b64_tr_b16 a[54:55], v2 offset:22528
 ds_read_b64_tr_b16 a[56:57], v2 offset:24576
 ds_read_b64_tr_b16 a[58:59], v2 offset:28672
 ds_read_b64_tr_b16 a[60:61], v2 offset:26624
 ds_read_b64_tr_b16 a[62:63], v2 offset:30720
 v_add_u32 v2, 0x8000, v2
 s_waitcnt vmcnt(16)
 s_barrier
 ds_read_b64_tr_b16 a[64:65], v2 offset:0
 ds_read_b64_tr_b16 a[66:67], v2 offset:4096
 ds_read_b64_tr_b16 a[68:69], v2 offset:2048
 ds_read_b64_tr_b16 a[70:71], v2 offset:6144
 ds_read_b64_tr_b16 a[72:73], v2 offset:8192
 ds_read_b64_tr_b16 a[74:75], v2 offset:12288
 ds_read_b64_tr_b16 a[76:77], v2 offset:10240
 ds_read_b64_tr_b16 a[78:79], v2 offset:14336
 ds_read_b64_tr_b16 a[80:81], v2 offset:16384
 ds_read_b64_tr_b16 a[82:83], v2 offset:20480
 ds_read_b64_tr_b16 a[84:85], v2 offset:18432
 ds_read_b64_tr_b16 a[86:87], v2 offset:22528
 ds_read_b64_tr_b16 a[88:89], v2 offset:24576
 ds_read_b64_tr_b16 a[90:91], v2 offset:28672
 ds_read_b64_tr_b16 a[92:93], v2 offset:26624
 ds_read_b64_tr_b16 a[94:95], v2 offset:30720
 v_add_u32 v2, 0x8000, v2
 s_waitcnt vmcnt(8)
 s_barrier
 ds_read_b64_tr_b16 a[96:97], v2 offset:0
 ds_read_b64_tr_b16 a[98:99], v2 offset:4096
 ds_read_b64_tr_b16 a[100:101], v2 offset:2048
 ds_read_b64_tr_b16 a[102:103], v2 offset:6144
 ds_read_b64_tr_b16 a[104:105], v2 offset:8192
 ds_read_b64_tr_b16 a[106:107], v2 offset:12288
 ds_read_b64_tr_b16 a[108:109], v2 offset:10240
 ds_read_b64_tr_b16 a[110:111], v2 offset:14336
 ds_read_b64_tr_b16 a[112:113], v2 offset:16384
 ds_read_b64_tr_b16 a[114:115], v2 offset:20480
 ds_read_b64_tr_b16 a[116:117], v2 offset:18432
 ds_read_b64_tr_b16 a[118:119], v2 offset:22528
 ds_read_b64_tr_b16 a[120:121], v2 offset:24576
 ds_read_b64_tr_b16 a[122:123], v2 offset:28672
 ds_read_b64_tr_b16 a[124:125], v2 offset:26624
 ds_read_b64_tr_b16 a[126:127], v2 offset:30720
 v_add_u32 v2, 0x8000, v2
 s_waitcnt vmcnt(0)
 s_barrier
 ds_read_b64_tr_b16 a[128:129], v2 offset:0
 ds_read_b64_tr_b16 a[130:131], v2 offset:4096
 ds_read_b64_tr_b16 a[132:133], v2 offset:2048
 ds_read_b64_tr_b16 a[134:135], v2 offset:6144
 ds_read_b64_tr_b16 a[136:137], v2 offset:8192
 ds_read_b64_tr_b16 a[138:139], v2 offset:12288
 ds_read_b64_tr_b16 a[140:141], v2 offset:10240
 ds_read_b64_tr_b16 a[142:143], v2 offset:14336
 ds_read_b64_tr_b16 a[144:145], v2 offset:16384
 ds_read_b64_tr_b16 a[146:147], v2 offset:20480
 ds_read_b64_tr_b16 a[148:149], v2 offset:18432
 ds_read_b64_tr_b16 a[150:151], v2 offset:22528
 ds_read_b64_tr_b16 a[152:153], v2 offset:24576
 ds_read_b64_tr_b16 a[154:155], v2 offset:28672
 ds_read_b64_tr_b16 a[156:157], v2 offset:26624
 ds_read_b64_tr_b16 a[158:159], v2 offset:30720
 v_add_u32 v2, 0x8000, v2
 s_waitcnt lgkmcnt(0)
 s_barrier
 v_cmp_eq_u32 vcc, 0, v30
 s_cbranch_vccz L_qa_36
 s_mov_b32 s96, s44
 s_and_b32 s97, s45, 0xffff
 s_mov_b32 s98, 256
 s_mov_b32 s99, 0x00020000
 v_mov_b32 v1, 132
 s_mov_b32 s51, 0
 s_mov_b64 exec, 1
L_wb_37:
 buffer_load_dword v2, v1, s[96:99], 0 offen sc1
 s_waitcnt vmcnt(0)
 v_cmp_eq_u32 vcc, 0, v2
 s_cbranch_vccz L_wbd_38
 s_sleep 2
 s_add_u32 s51, s51, 1
 s_cmp_lt_u32 s51, 131072
 s_cbranch_scc1 L_wb_37
 s_branch L_bail
L_wbd_38:
 s_mov_b64 exec, -1
L_qa_36:
 s_lshl_b32 s64, s64, 8
 s_lshl_b32 s65, s65, 8
 s_lshl_b32 s66, s66, 8
 s_lshl_b32 s67, s67, 8
 s_lshl_b32 s68, s68, 8
 s_cmp_eq_u32 s53, 0
 s_cselect_b32 s78, 2, 3
 s_mov_b32 s79, 0
 v_lshrrev_b32 v1, 4, v0
 s_mov_b32 s3, 1280
 v_mul_lo_u32 v1, v1, s3
 v_and_b32 v3, 15, v0
 v_lshl_add_u32 v1, v3, 4, v1
 v_add_u32 v6, 5120, v1
 v_mov_b32 v24, v6
 v_and_b32 v2, 31, v0
 v_lshlrev_b32 v2, 8, v2
 v_lshrrev_b32 v4, 5, v0
 v_xor_b32 v4, v4, v3
 v_xor_b32 v8, 0, v4
 v_lshl_add_u32 v8, v8, 4, v2
 v_add_u32 v16, 40960, v8
 v_xor_b32 v9, 2, v4
 v_lshl_add_u32 v9, v9, 4, v2
 v_add_u32 v17, 40960, v9
 v_xor_b32 v10, 4, v4
 v_lshl_add_u32 v10, v10, 4, v2
 v_add_u32 v18, 40960, v10
 v_xor_b32 v11, 6, v4
 v_lshl_add_u32 v11, v11, 4, v2
 v_add_u32 v19, 40960, v11
 v_xor_b32 v12, 8, v4
 v_lshl_add_u32 v12, v12, 4, v2
 v_add_u32 v20, 40960, v12
 v_xor_b32 v13, 10, v4
 v_lshl_add_u32 v13, v13, 4, v2
 v_add_u32 v21, 40960, v13
 v_xor_b32 v14, 12, v4
 v_lshl_add_u32 v14, v14, 4, v2
 v_add_u32 v22, 40960, v14
 v_xor_b32 v15, 14, v4
 v_lshl_add_u32 v15, v15, 4, v2
 v_add_u32 v23, 40960, v15
 v_lshrrev_b32 v4, 5, v0
 v_lshlrev_b32 v4, 8, v4
 v_lshl_add_u32 v4, v3, 4, v4
 v_and_b32 v2, 16, v0
 v_lshl_add_u32 v4, v2, 8, v4
 s_lshl_b32 s3, s50, 10
 v_add_u32 v4, s3, v4
 v_mul_u32_u24 v5, 24576, v0
 v_mov_b32 v7, 163776
 v_mul_u32_u24 v30, 16384, v0
 s_lshl_b32 s75, s62, 2
 s_add_u32 s75, s75, s50
 s_and_b32 s100, s52, 1
 s_lshl_b32 s100, s100, 13
 s_lshl_b32 s58, s52, 14
 s_add_u32 s58, s58, s100
 s_add_u32 s58, s58, 8388608
 s_cmp_eq_u32 s53, 0
 s_cselect_b32 s82, 8192, 0
 s_lshl_b32 s59, s52, 8
 s_add_u32 s59, s59, 8192
 s_lshl_b32 s56, s50, 11
 s_mov_b32 s54, 0
 s_mov_b32 s61, 0
 s_mov_b32 s70, s75
 s_mul_i32 s55, s54, 40960
 s_mul_i32 s3, s50, 10240
 s_add_u32 s55, s55, s3
 s_add_u32 s55, s55, 226492416
 s_add_u32 m0, s56, 0
 s_add_u32 s3, s55, s64
 buffer_load_dwordx4 v1, s[4:7], s3 offen sc1 lds
 s_add_u32 m0, s56, 1024
 s_add_u32 s3, s55, s64
 buffer_load_dwordx4 v24, s[4:7], s3 offen sc1 lds
 s_add_u32 m0, s56, 8192
 s_add_u32 s3, s55, s65
 buffer_load_dwordx4 v1, s[4:7], s3 offen sc1 lds
 s_add_u32 m0, s56, 9216
 s_add_u32 s3, s55, s65
 buffer_load_dwordx4 v24, s[4:7], s3 offen sc1 lds
 s_add_u32 m0, s56, 16384
 s_add_u32 s3, s55, s66
 buffer_load_dwordx4 v1, s[4:7], s3 offen sc1 lds
 s_add_u32 m0, s56, 17408
 s_add_u32 s3, s55, s66
 buffer_load_dwordx4 v24, s[4:7], s3 offen sc1 lds
 s_add_u32 m0, s56, 24576
 s_add_u32 s3, s55, s67
 buffer_load_dwordx4 v1, s[4:7], s3 offen sc1 lds
 s_add_u32 m0, s56, 25600
 s_add_u32 s3, s55, s67
 buffer_load_dwordx4 v24, s[4:7], s3 offen sc1 lds
 s_add_u32 m0, s56, 32768
 s_add_u32 s3, s55, s68
 buffer_load_dwordx4 v1, s[4:7], s3 offen sc1 lds
 s_add_u32 m0, s56, 33792
 s_add_u32 s3, s55, s68
 buffer_load_dwordx4 v24, s[4:7], s3 offen sc1 lds
 s_waitcnt vmcnt(0)
L_qkvq_pre:
 s_barrier
 s_mov_b32 s60, s54
 s_add_u32 s54, s54, 1
 s_mul_i32 s55, s54, 40960
 s_mul_i32 s3, s50, 10240
 s_add_u32 s55, s55, s3
 s_add_u32 s55, s55, 226492416
 ds_read_b128 v[32:35], v8 offset:0
 ds_read_b128 v[36:39], v9 offset:0
 ds_read_b128 v[40:43], v10 offset:0
 ds_read_b128 v[44:47], v11 offset:0
 s_waitcnt lgkmcnt(3)
 v_mfma_f32_32x32x16_bf16 v[64:79], a[0:3], v[32:35], 0
 ds_read_b128 v[48:51], v12 offset:0
 s_add_u32 m0, s56, 40960
 s_add_u32 s3, s55, s64
 buffer_load_dwordx4 v1, s[4:7], s3 offen sc1 lds
 s_waitcnt lgkmcnt(3)
 v_mfma_f32_32x32x16_bf16 v[64:79], a[4:7], v[36:39], v[64:79]
 ds_read_b128 v[52:55], v13 offset:0
 s_waitcnt lgkmcnt(3)
 v_mfma_f32_32x32x16_bf16 v[64:79], a[8:11], v[40:43], v[64:79]
 ds_read_b128 v[56:59], v14 offset:0
 s_waitcnt lgkmcnt(3)
 v_mfma_f32_32x32x16_bf16 v[64:79], a[12:15], v[44:47], v[64:79]
 ds_read_b128 v[60:63], v15 offset:0
 s_add_u32 m0, s56, 41984
 s_add_u32 s3, s55, s64
 buffer_load_dwordx4 v24, s[4:7], s3 offen sc1 lds
 s_waitcnt lgkmcnt(3)
 v_mfma_f32_32x32x16_bf16 v[64:79], a[16:19], v[48:51], v[64:79]
 ds_read_b128 v[32:35], v8 offset:8192
 s_waitcnt lgkmcnt(3)
 v_mfma_f32_32x32x16_bf16 v[64:79], a[20:23], v[52:55], v[64:79]
 ds_read_b128 v[36:39], v9 offset:8192
 s_waitcnt lgkmcnt(3)
 v_mfma_f32_32x32x16_bf16 v[64:79], a[24:27], v[56:59], v[64:79]
 ds_read_b128 v[40:43], v10 offset:8192
 s_add_u32 m0, s56, 49152
 s_add_u32 s3, s55, s65
 buffer_load_dwordx4 v1, s[4:7], s3 offen sc1 lds
 s_waitcnt lgkmcnt(3)
 v_mfma_f32_32x32x16_bf16 v[64:79], a[28:31], v[60:63], v[64:79]
 ds_read_b128 v[44:47], v11 offset:8192
 s_waitcnt lgkmcnt(3)
 v_mfma_f32_32x32x16_bf16 v[64:79], a[32:35], v[32:35], v[64:79]
 ds_read_b128 v[48:51], v12 offset:8192
 s_waitcnt lgkmcnt(3)
 v_mfma_f32_32x32x16_bf16 v[64:79], a[36:39], v[36:39], v[64:79]
 ds_read_b128 v[52:55], v13 offset:8192
 s_add_u32 m0, s56, 50176
 s_add_u32 s3, s55, s65
 buffer_load_dwordx4 v24, s[4:7], s3 offen sc1 lds
 s_waitcnt lgkmcnt(3)
 v_mfma_f32_32x32x16_bf16 v[64:79], a[40:43], v[40:43], v[64:79]
 ds_read_b128 v[56:59], v14 offset:8192
 s_waitcnt lgkmcnt(3)
 v_mfma_f32_32x32x16_bf16 v[64:79], a[44:47], v[44:47], v[64:79]
 ds_read_b128 v[60:63], v15 offset:8192
 s_waitcnt lgkmcnt(3)
 v_mfma_f32_32x32x16_bf16 v[64:79], a[48:51], v[48:51], v[64:79]
 ds_read_b128 v[32:35], v8 offset:16384
 s_add_u32 m0, s56, 57344
 s_add_u32 s3, s55, s66
 buffer_load_dwordx4 v1, s[4:7], s3 offen sc1 lds
 s_waitcnt lgkmcnt(3)
 v_mfma_f32_32x32x16_bf16 v[64:79], a[52:55], v[52:55], v[64:79]
 ds_read_b128 v[36:39], v9 offset:16384
 s_waitcnt lgkmcnt(3)
 v_mfma_f32_32x32x16_bf16 v[64:79], a[56:59], v[56:59], v[64:79]
 ds_read_b128 v[40:43], v10 offset:16384
 s_waitcnt lgkmcnt(3)
 v_mfma_f32_32x32x16_bf16 v[64:79], a[60:63], v[60:63], v[64:79]
 ds_read_b128 v[44:47], v11 offset:16384
 s_add_u32 m0, s56, 58368
 s_add_u32 s3, s55, s66
 buffer_load_dwordx4 v24, s[4:7], s3 offen sc1 lds
 s_waitcnt lgkmcnt(3)
 v_mfma_f32_32x32x16_bf16 v[64:79], a[64:67], v[32:35], v[64:79]
 ds_read_b128 v[48:51], v12 offset:16384
 s_waitcnt lgkmcnt(3)
 v_mfma_f32_32x32x16_bf16 v[64:79], a[68:71], v[36:39], v[64:79]
 ds_read_b128 v[52:55], v13 offset:16384
 s_waitcnt lgkmcnt(3)
 v_mfma_f32_32x32x16_bf16 v[64:79], a[72:75], v[40:43], v[64:79]
 ds_read_b128 v[56:59], v14 offset:16384
 s_add_u32 m0, s56, 65536
 s_add_u32 s3, s55, s67
 buffer_load_dwordx4 v1, s[4:7], s3 offen sc1 lds
 s_waitcnt lgkmcnt(3)
 v_mfma_f32_32x32x16_bf16 v[64:79], a[76:79], v[44:47], v[64:79]
 ds_read_b128 v[60:63], v15 offset:16384
 s_waitcnt vmcnt(7)
 s_cmp_eq_u32 s61, 0
 s_cbranch_scc1 L_pf_39
 s_lshl_b32 s3, s61, 2
 s_add_u32 s3, s3, s59
 s_sub_u32 s3, s3, 4
 v_mov_b32 v3, 1
 s_mov_b64 exec, s[78:79]
 buffer_atomic_add v3, v30, s[4:7], s3 offen
 s_mov_b64 exec, -1
 s_mov_b32 s61, 0
L_pf_39:
 s_waitcnt lgkmcnt(3)
 v_mfma_f32_32x32x16_bf16 v[64:79], a[80:83], v[48:51], v[64:79]
 ds_read_b128 v[32:35], v8 offset:24576
 s_waitcnt lgkmcnt(3)
 v_mfma_f32_32x32x16_bf16 v[64:79], a[84:87], v[52:55], v[64:79]
 ds_read_b128 v[36:39], v9 offset:24576
 s_add_u32 m0, s56, 66560
 s_add_u32 s3, s55, s67
 buffer_load_dwordx4 v24, s[4:7], s3 offen sc1 lds
 s_waitcnt lgkmcnt(3)
 v_mfma_f32_32x32x16_bf16 v[64:79], a[88:91], v[56:59], v[64:79]
 ds_read_b128 v[40:43], v10 offset:24576
 s_waitcnt lgkmcnt(3)
 v_mfma_f32_32x32x16_bf16 v[64:79], a[92:95], v[60:63], v[64:79]
 ds_read_b128 v[44:47], v11 offset:24576
 s_waitcnt lgkmcnt(3)
 v_mfma_f32_32x32x16_bf16 v[64:79], a[96:99], v[32:35], v[64:79]
 ds_read_b128 v[48:51], v12 offset:24576
 s_add_u32 m0, s56, 73728
 s_add_u32 s3, s55, s68
 buffer_load_dwordx4 v1, s[4:7], s3 offen sc1 lds
 s_waitcnt lgkmcnt(3)
 v_mfma_f32_32x32x16_bf16 v[64:79], a[100:103], v[36:39], v[64:79]
 ds_read_b128 v[52:55], v13 offset:24576
 s_waitcnt lgkmcnt(3)
 v_mfma_f32_32x32x16_bf16 v[64:79], a[104:107], v[40:43], v[64:79]
 ds_read_b128 v[56:59], v14 offset:24576
 s_waitcnt lgkmcnt(3)
 v_mfma_f32_32x32x16_bf16 v[64:79], a[108:111], v[44:47], v[64:79]
 ds_read_b128 v[60:63], v15 offset:24576
 s_add_u32 m0, s56, 74752
 s_add_u32 s3, s55, s68
 buffer_load_dwordx4 v24, s[4:7], s3 offen sc1 lds
 s_waitcnt lgkmcnt(3)
 v_mfma_f32_32x32x16_bf16 v[64:79], a[112:115], v[48:51], v[64:79]
 ds_read_b128 v[32:35], v8 offset:32768
 s_waitcnt lgkmcnt(3)
 v_mfma_f32_32x32x16_bf16 v[64:79], a[116:119], v[52:55], v[64:79]
 ds_read_b128 v[36:39], v9 offset:32768
 s_waitcnt lgkmcnt(3)
 v_mfma_f32_32x32x16_bf16 v[64:79], a[120:123], v[56:59], v[64:79]
 ds_read_b128 v[40:43], v10 offset:32768
 s_waitcnt lgkmcnt(3)
 v_mfma_f32_32x32x16_bf16 v[64:79], a[124:127], v[60:63], v[64:79]
 ds_read_b128 v[44:47], v11 offset:32768
 s_waitcnt lgkmcnt(3)
 v_mfma_f32_32x32x16_bf16 v[64:79], a[128:131], v[32:35], v[64:79]
 ds_read_b128 v[48:51], v12 offset:32768
 s_waitcnt lgkmcnt(3)
 v_mfma_f32_32x32x16_bf16 v[64:79], a[132:135], v[36:39], v[64:79]
 ds_read_b128 v[52:55], v13 offset:32768
 s_waitcnt lgkmcnt(3)
 v_mfma_f32_32x32x16_bf16 v[64:79], a[136:139], v[40:43], v[64:79]
 ds_read_b128 v[56:59], v14 offset:32768
 s_waitcnt lgkmcnt(3)
 v_mfma_f32_32x32x16_bf16 v[64:79], a[140:143], v[44:47], v[64:79]
 ds_read_b128 v[60:63], v15 offset:32768
 s_waitcnt lgkmcnt(3)
 v_mfma_f32_32x32x16_bf16 v[64:79], a[144:147], v[48:51], v[64:79]
 s_waitcnt lgkmcnt(2)
 v_mfma_f32_32x32x16_bf16 v[64:79], a[148:151], v[52:55], v[64:79]
 s_waitcnt lgkmcnt(1)
 v_mfma_f32_32x32x16_bf16 v[64:79], a[152:155], v[56:59], v[64:79]
 s_waitcnt lgkmcnt(0)
 v_mfma_f32_32x32x16_bf16 v[64:79], a[156:159], v[60:63], v[64:79]
 s_lshl_b32 s3, s60, 19
 s_add_u32 s3, s3, s58
 s_xor_b32 s3, s3, s82
 s_nop 8
 v_cvt_pk_bf16_f32 v80, v64, v65
 v_cvt_pk_bf16_f32 v81, v66, v67
 v_cvt_pk_bf16_f32 v82, v72, v73
 v_cvt_pk_bf16_f32 v83, v74, v75
 buffer_store_dwordx4 v[80:83], v4, s[4:7], s3 offen offset:0 sc1
 v_cvt_pk_bf16_f32 v84, v68, v69
 v_cvt_pk_bf16_f32 v85, v70, v71
 v_cvt_pk_bf16_f32 v86, v76, v77
 v_cvt_pk_bf16_f32 v87, v78, v79
 buffer_store_dwordx4 v[84:87], v4, s[4:7], s3 offen offset:512 sc1
 s_mov_b32 s61, s54
 s_cmp_lg_u32 s54, 1
 s_cbranch_scc1 L_f1_40
 s_waitcnt vmcnt(0)
 s_cmp_eq_u32 s61, 0
 s_cbranch_scc1 L_pf_41
 s_lshl_b32 s3, s61, 2
 s_add_u32 s3, s3, s59
 s_sub_u32 s3, s3, 4
 v_mov_b32 v3, 1
 s_mov_b64 exec, s[78:79]
 buffer_atomic_add v3, v30, s[4:7], s3 offen
 s_mov_b64 exec, -1
 s_mov_b32 s61, 0
L_pf_41:
 s_mov_b32 s8, s38
 s_and_b32 s9, s39, 0xffff
 s_mov_b32 s10, 2621440
 s_mov_b32 s11, 0x00020000
 s_mov_b32 s12, s40
 s_and_b32 s13, s41, 0xffff
 s_mov_b32 s14, 1280
 s_mov_b32 s15, 0x00020000
 v_lshlrev_b32 v130, 4, v0
 s_lshl_b32 s73, s70, 12
 s_add_u32 s74, s73, 2
 buffer_load_dwordx4 v[96:99], v130, s[8:11], s73 offen offset:0
 buffer_load_dwordx4 v[100:103], v130, s[8:11], s73 offen offset:1024
 buffer_load_dwordx4 v[112:115], v130, s[8:11], s74 offen offset:0
 buffer_load_dwordx4 v[116:119], v130, s[8:11], s74 offen offset:1024
 s_lshl_b32 s3, s70, 1
 buffer_load_ushort v128, off, s[12:15], s3
 s_branch L_f2_42
L_f1_40:
 s_waitcnt vmcnt(2)
L_f2_42:
 s_barrier
 s_mov_b32 s60, s54
 s_add_u32 s54, s54, 1
 s_mul_i32 s55, s54, 40960
 s_mul_i32 s3, s50, 10240
 s_add_u32 s55, s55, s3
 s_add_u32 s55, s55, 226492416
 ds_read_b128 v[32:35], v16 offset:0
 ds_read_b128 v[36:39], v17 offset:0
 ds_read_b128 v[40:43], v18 offset:0
 ds_read_b128 v[44:47], v19 offset:0
 s_waitcnt lgkmcnt(3)
 v_mfma_f32_32x32x16_bf16 v[64:79], a[0:3], v[32:35], 0
 ds_read_b128 v[48:51], v20 offset:0
 s_add_u32 m0, s56, 0
 s_add_u32 s3, s55, s64
 buffer_load_dwordx4 v1, s[4:7], s3 offen sc1 lds
 s_waitcnt lgkmcnt(3)
 v_mfma_f32_32x32x16_bf16 v[64:79], a[4:7], v[36:39], v[64:79]
 ds_read_b128 v[52:55], v21 offset:0
 s_waitcnt lgkmcnt(3)
 v_mfma_f32_32x32x16_bf16 v[64:79], a[8:11], v[40:43], v[64:79]
 ds_read_b128 v[56:59], v22 offset:0
 s_waitcnt lgkmcnt(3)
 v_mfma_f32_32x32x16_bf16 v[64:79], a[12:15], v[44:47], v[64:79]
 ds_read_b128 v[60:63], v23 offset:0
 s_add_u32 m0, s56, 1024
 s_add_u32 s3, s55, s64
 buffer_load_dwordx4 v24, s[4:7], s3 offen sc1 lds
 s_waitcnt lgkmcnt(3)
 v_mfma_f32_32x32x16_bf16 v[64:79], a[16:19], v[48:51], v[64:79]
 ds_read_b128 v[32:35], v16 offset:8192
 s_waitcnt lgkmcnt(3)
 v_mfma_f32_32x32x16_bf16 v[64:79], a[20:23], v[52:55], v[64:79]
 ds_read_b128 v[36:39], v17 offset:8192
 s_waitcnt lgkmcnt(3)
 v_mfma_f32_32x32x16_bf16 v[64:79], a[24:27], v[56:59], v[64:79]
 ds_read_b128 v[40:43], v18 offset:8192
 s_add_u32 m0, s56, 8192
 s_add_u32 s3, s55, s65
 buffer_load_dwordx4 v1, s[4:7], s3 offen sc1 lds
 s_waitcnt lgkmcnt(3)
 v_mfma_f32_32x32x16_bf16 v[64:79], a[28:31], v[60:63], v[64:79]
 ds_read_b128 v[44:47], v19 offset:8192
 s_waitcnt lgkmcnt(3)
 v_mfma_f32_32x32x16_bf16 v[64:79], a[32:35], v[32:35], v[64:79]
 ds_read_b128 v[48:51], v20 offset:8192
 s_waitcnt lgkmcnt(3)
 v_mfma_f32_32x32x16_bf16 v[64:79], a[36:39], v[36:39], v[64:79]
 ds_read_b128 v[52:55], v21 offset:8192
 s_add_u32 m0, s56, 9216
 s_add_u32 s3, s55, s65
 buffer_load_dwordx4 v24, s[4:7], s3 offen sc1 lds
 s_waitcnt lgkmcnt(3)
 v_mfma_f32_32x32x16_bf16 v[64:79], a[40:43], v[40:43], v[64:79]
 ds_read_b128 v[56:59], v22 offset:8192
 s_waitcnt lgkmcnt(3)
 v_mfma_f32_32x32x16_bf16 v[64:79], a[44:47], v[44:47], v[64:79]
 ds_read_b128 v[60:63], v23 offset:8192
 s_waitcnt lgkmcnt(3)
 v_mfma_f32_32x32x16_bf16 v[64:79], a[48:51], v[48:51], v[64:79]
 ds_read_b128 v[32:35], v16 offset:16384
 s_add_u32 m0, s56, 16384
 s_add_u32 s3, s55, s66
 buffer_load_dwordx4 v1, s[4:7], s3 offen sc1 lds
 s_waitcnt lgkmcnt(3)
 v_mfma_f32_32x32x16_bf16 v[64:79], a[52:55], v[52:55], v[64:79]
 ds_read_b128 v[36:39], v17 offset:16384
 s_waitcnt lgkmcnt(3)
 v_mfma_f32_32x32x16_bf16 v[64:79], a[56:59], v[56:59], v[64:79]
 ds_read_b128 v[40:43], v18 offset:16384
 s_waitcnt lgkmcnt(3)
 v_mfma_f32_32x32x16_bf16 v[64:79], a[60:63], v[60:63], v[64:79]
 ds_read_b128 v[44:47], v19 offset:16384
 s_add_u32 m0, s56, 17408
 s_add_u32 s3, s55, s66
 buffer_load_dwordx4 v24, s[4:7], s3 offen sc1 lds
 s_waitcnt lgkmcnt(3)
 v_mfma_f32_32x32x16_bf16 v[64:79], a[64:67], v[32:35], v[64:79]
 ds_read_b128 v[48:51], v20 offset:16384
 s_waitcnt lgkmcnt(3)
 v_mfma_f32_32x32x16_bf16 v[64:79], a[68:71], v[36:39], v[64:79]
 ds_read_b128 v[52:55], v21 offset:16384
 s_waitcnt lgkmcnt(3)
 v_mfma_f32_32x32x16_bf16 v[64:79], a[72:75], v[40:43], v[64:79]
 ds_read_b128 v[56:59], v22 offset:16384
 s_add_u32 m0, s56, 24576
 s_add_u32 s3, s55, s67
 buffer_load_dwordx4 v1, s[4:7], s3 offen sc1 lds
 s_waitcnt lgkmcnt(3)
 v_mfma_f32_32x32x16_bf16 v[64:79], a[76:79], v[44:47], v[64:79]
 ds_read_b128 v[60:63], v23 offset:16384
 s_waitcnt vmcnt(7)
 s_cmp_eq_u32 s61, 0
 s_cbranch_scc1 L_pf_43
 s_lshl_b32 s3, s61, 2
 s_add_u32 s3, s3, s59
 s_sub_u32 s3, s3, 4
 v_mov_b32 v3, 1
 s_mov_b64 exec, s[78:79]
 buffer_atomic_add v3, v30, s[4:7], s3 offen
 s_mov_b64 exec, -1
 s_mov_b32 s61, 0
L_pf_43:
 s_waitcnt lgkmcnt(3)
 v_mfma_f32_32x32x16_bf16 v[64:79], a[80:83], v[48:51], v[64:79]
 ds_read_b128 v[32:35], v16 offset:24576
 s_waitcnt lgkmcnt(3)
 v_mfma_f32_32x32x16_bf16 v[64:79], a[84:87], v[52:55], v[64:79]
 ds_read_b128 v[36:39], v17 offset:24576
 s_add_u32 m0, s56, 25600
 s_add_u32 s3, s55, s67
 buffer_load_dwordx4 v24, s[4:7], s3 offen sc1 lds
 s_waitcnt lgkmcnt(3)
 v_mfma_f32_32x32x16_bf16 v[64:79], a[88:91], v[56:59], v[64:79]
 ds_read_b128 v[40:43], v18 offset:24576
 s_waitcnt lgkmcnt(3)
 v_mfma_f32_32x32x16_bf16 v[64:79], a[92:95], v[60:63], v[64:79]
 ds_read_b128 v[44:47], v19 offset:24576
 s_waitcnt lgkmcnt(3)
 v_mfma_f32_32x32x16_bf16 v[64:79], a[96:99], v[32:35], v[64:79]
 ds_read_b128 v[48:51], v20 offset:24576
 s_add_u32 m0, s56, 32768
 s_add_u32 s3, s55, s68
 buffer_load_dwordx4 v1, s[4:7], s3 offen sc1 lds
 s_waitcnt lgkmcnt(3)
 v_mfma_f32_32x32x16_bf16 v[64:79], a[100:103], v[36:39], v[64:79]
 ds_read_b128 v[52:55], v21 offset:24576
 s_waitcnt lgkmcnt(3)
 v_mfma_f32_32x32x16_bf16 v[64:79], a[104:107], v[40:43], v[64:79]
 ds_read_b128 v[56:59], v22 offset:24576
 s_waitcnt lgkmcnt(3)
 v_mfma_f32_32x32x16_bf16 v[64:79], a[108:111], v[44:47], v[64:79]
 ds_read_b128 v[60:63], v23 offset:24576
 s_add_u32 m0, s56, 33792
 s_add_u32 s3, s55, s68
 buffer_load_dwordx4 v24, s[4:7], s3 offen sc1 lds
 s_waitcnt lgkmcnt(3)
 v_mfma_f32_32x32x16_bf16 v[64:79], a[112:115], v[48:51], v[64:79]
 ds_read_b128 v[32:35], v16 offset:32768
 s_waitcnt lgkmcnt(3)
 v_mfma_f32_32x32x16_bf16 v[64:79], a[116:119], v[52:55], v[64:79]
 ds_read_b128 v[36:39], v17 offset:32768
 s_waitcnt lgkmcnt(3)
 v_mfma_f32_32x32x16_bf16 v[64:79], a[120:123], v[56:59], v[64:79]
 ds_read_b128 v[40:43], v18 offset:32768
 s_waitcnt lgkmcnt(3)
 v_mfma_f32_32x32x16_bf16 v[64:79], a[124:127], v[60:63], v[64:79]
 ds_read_b128 v[44:47], v19 offset:32768
 s_waitcnt lgkmcnt(3)
 v_mfma_f32_32x32x16_bf16 v[64:79], a[128:131], v[32:35], v[64:79]
 ds_read_b128 v[48:51], v20 offset:32768
 s_waitcnt lgkmcnt(3)
 v_mfma_f32_32x32x16_bf16 v[64:79], a[132:135], v[36:39], v[64:79]
 ds_read_b128 v[52:55], v21 offset:32768
 s_waitcnt lgkmcnt(3)
 v_mfma_f32_32x32x16_bf16 v[64:79], a[136:139], v[40:43], v[64:79]
 ds_read_b128 v[56:59], v22 offset:32768
 s_waitcnt lgkmcnt(3)
 v_mfma_f32_32x32x16_bf16 v[64:79], a[140:143], v[44:47], v[64:79]
 ds_read_b128 v[60:63], v23 offset:32768
 s_waitcnt lgkmcnt(3)
 v_mfma_f32_32x32x16_bf16 v[64:79], a[144:147], v[48:51], v[64:79]
 s_waitcnt lgkmcnt(2)
 v_mfma_f32_32x32x16_bf16 v[64:79], a[148:151], v[52:55], v[64:79]
 s_waitcnt lgkmcnt(1)
 v_mfma_f32_32x32x16_bf16 v[64:79], a[152:155], v[56:59], v[64:79]
 s_waitcnt lgkmcnt(0)
 v_mfma_f32_32x32x16_bf16 v[64:79], a[156:159], v[60:63], v[64:79]
 s_lshl_b32 s3, s60, 19
 s_add_u32 s3, s3, s58
 s_xor_b32 s3, s3, s82
 s_nop 8
 v_cvt_pk_bf16_f32 v88, v64, v65
 v_cvt_pk_bf16_f32 v89, v66, v67
 v_cvt_pk_bf16_f32 v90, v72, v73
 v_cvt_pk_bf16_f32 v91, v74, v75
 buffer_store_dwordx4 v[88:91], v4, s[4:7], s3 offen offset:0 sc1
 v_cvt_pk_bf16_f32 v92, v68, v69
 v_cvt_pk_bf16_f32 v93, v70, v71
 v_cvt_pk_bf16_f32 v94, v76, v77
 v_cvt_pk_bf16_f32 v95, v78, v79
 buffer_store_dwordx4 v[92:95], v4, s[4:7], s3 offen offset:512 sc1
 s_mov_b32 s61, s54
 s_waitcnt vmcnt(2)
 s_cmp_lg_u32 s54, 4
 s_cbranch_scc1 L_cv_44
 s_waitcnt vmcnt(0)
 s_cmp_eq_u32 s61, 0
 s_cbranch_scc1 L_pf_45
 s_lshl_b32 s3, s61, 2
 s_add_u32 s3, s3, s59
 s_sub_u32 s3, s3, 4
 v_mov_b32 v3, 1
 s_mov_b64 exec, s[78:79]
 buffer_atomic_add v3, v30, s[4:7], s3 offen
 s_mov_b64 exec, -1
 s_mov_b32 s61, 0
L_pf_45:
 s_mul_i32 s71, s50, 13312
 s_add_u32 s71, s71, 81920
 s_mov_b32 s70, s75
 s_mov_b32 s69, 640
 s_getpc_b64 s[76:77]
L_ca_46:
 s_add_u32 s76, s76, L_conv0-L_ca_46
 s_addc_u32 s77, s77, -1
 s_swappc_b64 s[76:77], s[76:77]
 s_waitcnt vmcnt(0)
 s_barrier
 s_cmp_lg_u32 s50, 3
 s_cbranch_scc1 L_ar_47
 s_mov_b32 s96, s44
 s_and_b32 s97, s45, 0xffff
 s_mov_b32 s98, 256
 s_mov_b32 s99, 0x00020000
 v_mov_b32 v1, 1
 s_mov_b64 exec, 1
 buffer_atomic_add v1, off, s[96:99], 0 offset:8 sc0
 s_waitcnt vmcnt(0)
 v_cmp_eq_u32 vcc, 159, v1
 s_cbranch_vccz L_aw_48
 buffer_store_dword v1, off, s[96:99], 0 offset:136 sc1
L_aw_48:
 s_mov_b64 exec, -1
L_ar_47:
 v_lshrrev_b32 v1, 4, v0
 s_mov_b32 s3, 1280
 v_mul_lo_u32 v1, v1, s3
 v_and_b32 v3, 15, v0
 v_lshl_add_u32 v1, v3, 4, v1
 v_add_u32 v6, 5120, v1
 v_mov_b32 v24, v6
 v_and_b32 v2, 31, v0
 v_lshlrev_b32 v2, 8, v2
 v_lshrrev_b32 v4, 5, v0
 v_xor_b32 v4, v4, v3
 v_xor_b32 v8, 0, v4
 v_lshl_add_u32 v8, v8, 4, v2
 v_add_u32 v16, 40960, v8
 v_xor_b32 v9, 2, v4
 v_lshl_add_u32 v9, v9, 4, v2
 v_add_u32 v17, 40960, v9
 v_xor_b32 v10, 4, v4
 v_lshl_add_u32 v10, v10, 4, v2
 v_add_u32 v18, 40960, v10
 v_xor_b32 v11, 6, v4
 v_lshl_add_u32 v11, v11, 4, v2
 v_add_u32 v19, 40960, v11
 v_xor_b32 v12, 8, v4
 v_lshl_add_u32 v12, v12, 4, v2
 v_add_u32 v20, 40960, v12
 v_xor_b32 v13, 10, v4
 v_lshl_add_u32 v13, v13, 4, v2
 v_add_u32 v21, 40960, v13
 v_xor_b32 v14, 12, v4
 v_lshl_add_u32 v14, v14, 4, v2
 v_add_u32 v22, 40960, v14
 v_xor_b32 v15, 14, v4
 v_lshl_add_u32 v15, v15, 4, v2
 v_add_u32 v23, 40960, v15
 v_lshrrev_b32 v4, 5, v0
 v_lshlrev_b32 v4, 8, v4
 v_lshl_add_u32 v4, v3, 4, v4
 v_and_b32 v2, 16, v0
 v_lshl_add_u32 v4, v2, 8, v4
 s_lshl_b32 s3, s50, 10
 v_add_u32 v4, s3, v4
 v_mul_u32_u24 v5, 24576, v0
 v_mov_b32 v7, 163776
 v_mul_u32_u24 v30, 16384, v0
L_cv_44:
 s_cmp_lg_u32 s54, 10
 s_cbranch_scc1 L_cb_49
 s_cmp_lg_u32 s50, 0
 s_cbranch_scc1 L_ww_50
 s_mov_b32 s96, s44
 s_and_b32 s97, s45, 0xffff
 s_mov_b32 s98, 256
 s_mov_b32 s99, 0x00020000
 v_mov_b32 v25, 200
 s_mov_b32 s51, 0
 s_mov_b64 exec, 1
L_wb_51:
 buffer_load_dword v26, v25, s[96:99], 0 offen sc1
 s_waitcnt vmcnt(0)
 v_cmp_eq_u32 vcc, 0, v26
 s_cbranch_vccz L_wbd_52
 s_sleep 2
 s_add_u32 s51, s51, 1
 s_cmp_lt_u32 s51, 131072
 s_cbranch_scc1 L_wb_51
 s_branch L_bail
L_wbd_52:
 s_mov_b64 exec, -1
L_ww_50:
 s_barrier
L_cb_49:
 s_cmp_lt_u32 s54, 16
 s_cbranch_scc1 L_qkvq_pre
 s_waitcnt vmcnt(0)
 s_cmp_eq_u32 s61, 0
 s_cbranch_scc1 L_pf_54
 s_lshl_b32 s3, s61, 2
 s_add_u32 s3, s3, s59
 s_sub_u32 s3, s3, 4
 v_mov_b32 v3, 1
 s_mov_b64 exec, s[78:79]
 buffer_atomic_add v3, v30, s[4:7], s3 offen
 s_mov_b64 exec, -1
 s_mov_b32 s61, 0
L_pf_54:
 s_lshl_b32 s62, s62, 8
 s_add_u32 s62, s62, 126976
 s_add_u32 s63, s59, 8128
L_qkvq_block:
 s_lshl_b32 s55, s54, 2
 s_add_u32 s55, s55, s62
 s_sub_u32 s55, s55, 64
 s_cmp_lg_u32 s50, 0
 s_cselect_b32 s3, 268435456, s55
 v_mov_b32 v6, 8
 s_mov_b64 exec, 15
 v_mov_b32 v6, 0
 buffer_atomic_add v6, v5, s[4:7], s3 offen sc0
 s_mov_b64 exec, -1
 s_waitcnt vmcnt(0)
 s_cmp_eq_u32 s61, 0
 s_cbranch_scc1 L_pf_57
 s_lshl_b32 s3, s61, 2
 s_add_u32 s3, s3, s59
 s_sub_u32 s3, s3, 4
 v_mov_b32 v3, 1
 s_mov_b64 exec, s[78:79]
 buffer_atomic_add v3, v30, s[4:7], s3 offen
 s_mov_b64 exec, -1
 s_mov_b32 s61, 0
L_pf_57:
 s_cmp_lg_u32 s50, 0
 s_cbranch_scc1 L_w_55
 v_cmp_gt_u32 vcc, 8, v6
 s_cbranch_vccz L_w_55
 s_mov_b32 s51, 0
 s_mov_b64 exec, 15
 v_mov_b32 v28, 0
 buffer_atomic_add v28, v5, s[4:7], s55 offen sc0
 s_sleep 5
L_wc_58:
 v_mov_b32 v29, 0
 buffer_atomic_add v29, v5, s[4:7], s55 offen sc0
 s_waitcnt vmcnt(1)
 v_cmp_gt_u32 vcc, 8, v28
 s_cbranch_vccz L_wcd_59
 v_mov_b32 v28, 0
 buffer_atomic_add v28, v5, s[4:7], s55 offen sc0
 s_waitcnt vmcnt(1)
 v_cmp_gt_u32 vcc, 8, v29
 s_cbranch_vccz L_wcd_59
 s_add_u32 s51, s51, 1
 s_cmp_lt_u32 s51, 131072
 s_cbranch_scc1 L_wc_58
 s_branch L_bail
L_wcd_59:
 s_mov_b64 exec, -1
L_w_55:
 s_barrier
 s_branch L_qkvq_loop
L_qkvq_fast:
 s_cmp_lg_u32 s54, 32
 s_cbranch_scc1 L_c2_61
 s_cmp_lg_u32 s50, 0
 s_cbranch_scc1 L_ww_62
 s_mov_b32 s96, s44
 s_and_b32 s97, s45, 0xffff
 s_mov_b32 s98, 256
 s_mov_b32 s99, 0x00020000
 v_mov_b32 v25, 140
 s_mov_b32 s51, 0
 s_mov_b64 exec, 1
L_wb_63:
 buffer_load_dword v26, v25, s[96:99], 0 offen sc1
 s_waitcnt vmcnt(0)
 v_cmp_eq_u32 vcc, 0, v26
 s_cbranch_vccz L_wbd_64
 s_sleep 2
 s_add_u32 s51, s51, 1
 s_cmp_lt_u32 s51, 131072
 s_cbranch_scc1 L_wb_63
 s_branch L_bail
L_wbd_64:
 s_mov_b64 exec, -1
L_ww_62:
 s_barrier
L_c2_61:
 s_sub_u32 s60, s54, 16
 s_lshl_b32 s70, s54, 2
 s_add_u32 s70, s70, s62
 s_sub_u32 s70, s70, 60
 s_cmp_lg_u32 s50, 0
 s_cselect_b32 s70, 268435456, s70
 s_min_u32 s51, s54, 63
 s_mul_i32 s55, s51, 40960
 s_mul_i32 s3, s50, 10240
 s_add_u32 s55, s55, s3
 s_add_u32 s55, s55, 226492416
 ds_read_b128 v[32:35], v16 offset:0
 ds_read_b128 v[36:39], v17 offset:0
 ds_read_b128 v[40:43], v18 offset:0
 ds_read_b128 v[44:47], v19 offset:0
 s_waitcnt lgkmcnt(3)
 v_mfma_f32_32x32x16_bf16 v[64:79], a[0:3], v[32:35], 0
 ds_read_b128 v[48:51], v20 offset:0
 s_add_u32 m0, s56, 0
 s_add_u32 s3, s55, s64
 buffer_load_dwordx4 v1, s[4:7], s3 offen sc1 lds
 s_waitcnt lgkmcnt(3)
 v_mfma_f32_32x32x16_bf16 v[64:79], a[4:7], v[36:39], v[64:79]
 ds_read_b128 v[52:55], v21 offset:0
 s_waitcnt lgkmcnt(3)
 v_mfma_f32_32x32x16_bf16 v[64:79], a[8:11], v[40:43], v[64:79]
 ds_read_b128 v[56:59], v22 offset:0
 s_waitcnt lgkmcnt(3)
 v_mfma_f32_32x32x16_bf16 v[64:79], a[12:15], v[44:47], v[64:79]
 ds_read_b128 v[60:63], v23 offset:0
 s_add_u32 m0, s56, 1024
 s_add_u32 s3, s55, s64
 buffer_load_dwordx4 v24, s[4:7], s3 offen sc1 lds
 s_waitcnt lgkmcnt(3)
 v_mfma_f32_32x32x16_bf16 v[64:79], a[16:19], v[48:51], v[64:79]
 ds_read_b128 v[32:35], v16 offset:8192
 s_waitcnt lgkmcnt(3)
 v_mfma_f32_32x32x16_bf16 v[64:79], a[20:23], v[52:55], v[64:79]
 ds_read_b128 v[36:39], v17 offset:8192
 s_waitcnt lgkmcnt(3)
 v_mfma_f32_32x32x16_bf16 v[64:79], a[24:27], v[56:59], v[64:79]
 ds_read_b128 v[40:43], v18 offset:8192
 s_add_u32 m0, s56, 8192
 s_add_u32 s3, s55, s65
 buffer_load_dwordx4 v1, s[4:7], s3 offen sc1 lds
 s_waitcnt lgkmcnt(3)
 v_mfma_f32_32x32x16_bf16 v[64:79], a[28:31], v[60:63], v[64:79]
 ds_read_b128 v[44:47], v19 offset:8192
 s_waitcnt lgkmcnt(3)
 v_mfma_f32_32x32x16_bf16 v[64:79], a[32:35], v[32:35], v[64:79]
 ds_read_b128 v[48:51], v20 offset:8192
 s_waitcnt lgkmcnt(3)
 v_mfma_f32_32x32x16_bf16 v[64:79], a[36:39], v[36:39], v[64:79]
 ds_read_b128 v[52:55], v21 offset:8192
 s_add_u32 m0, s56, 9216
 s_add_u32 s3, s55, s65
 buffer_load_dwordx4 v24, s[4:7], s3 offen sc1 lds
 s_waitcnt lgkmcnt(3)
 v_mfma_f32_32x32x16_bf16 v[64:79], a[40:43], v[40:43], v[64:79]
 ds_read_b128 v[56:59], v22 offset:8192
 s_waitcnt lgkmcnt(3)
 v_mfma_f32_32x32x16_bf16 v[64:79], a[44:47], v[44:47], v[64:79]
 ds_read_b128 v[60:63], v23 offset:8192
 s_waitcnt lgkmcnt(3)
 v_mfma_f32_32x32x16_bf16 v[64:79], a[48:51], v[48:51], v[64:79]
 ds_read_b128 v[32:35], v16 offset:16384
 s_add_u32 m0, s56, 16384
 s_add_u32 s3, s55, s66
 buffer_load_dwordx4 v1, s[4:7], s3 offen sc1 lds
 s_waitcnt lgkmcnt(3)
 v_mfma_f32_32x32x16_bf16 v[64:79], a[52:55], v[52:55], v[64:79]
 ds_read_b128 v[36:39], v17 offset:16384
 s_waitcnt lgkmcnt(3)
 v_mfma_f32_32x32x16_bf16 v[64:79], a[56:59], v[56:59], v[64:79]
 ds_read_b128 v[40:43], v18 offset:16384
 s_waitcnt lgkmcnt(3)
 v_mfma_f32_32x32x16_bf16 v[64:79], a[60:63], v[60:63], v[64:79]
 ds_read_b128 v[44:47], v19 offset:16384
 s_add_u32 m0, s56, 17408
 s_add_u32 s3, s55, s66
 buffer_load_dwordx4 v24, s[4:7], s3 offen sc1 lds
 s_waitcnt lgkmcnt(3)
 v_mfma_f32_32x32x16_bf16 v[64:79], a[64:67], v[32:35], v[64:79]
 ds_read_b128 v[48:51], v20 offset:16384
 s_waitcnt lgkmcnt(3)
 v_mfma_f32_32x32x16_bf16 v[64:79], a[68:71], v[36:39], v[64:79]
 ds_read_b128 v[52:55], v21 offset:16384
 s_waitcnt lgkmcnt(3)
 v_mfma_f32_32x32x16_bf16 v[64:79], a[72:75], v[40:43], v[64:79]
 ds_read_b128 v[56:59], v22 offset:16384
 s_add_u32 m0, s56, 24576
 s_add_u32 s3, s55, s67
 buffer_load_dwordx4 v1, s[4:7], s3 offen sc1 lds
 s_waitcnt lgkmcnt(3)
 v_mfma_f32_32x32x16_bf16 v[64:79], a[76:79], v[44:47], v[64:79]
 ds_read_b128 v[60:63], v23 offset:16384
 s_waitcnt lgkmcnt(3)
 v_mfma_f32_32x32x16_bf16 v[64:79], a[80:83], v[48:51], v[64:79]
 ds_read_b128 v[32:35], v16 offset:24576
 s_waitcnt lgkmcnt(3)
 v_mfma_f32_32x32x16_bf16 v[64:79], a[84:87], v[52:55], v[64:79]
 ds_read_b128 v[36:39], v17 offset:24576
 s_add_u32 m0, s56, 25600
 s_add_u32 s3, s55, s67
 buffer_load_dwordx4 v24, s[4:7], s3 offen sc1 lds
 s_waitcnt lgkmcnt(3)
 v_mfma_f32_32x32x16_bf16 v[64:79], a[88:91], v[56:59], v[64:79]
 ds_read_b128 v[40:43], v18 offset:24576
 s_waitcnt lgkmcnt(3)
 v_mfma_f32_32x32x16_bf16 v[64:79], a[92:95], v[60:63], v[64:79]
 ds_read_b128 v[44:47], v19 offset:24576
 s_waitcnt lgkmcnt(3)
 v_mfma_f32_32x32x16_bf16 v[64:79], a[96:99], v[32:35], v[64:79]
 ds_read_b128 v[48:51], v20 offset:24576
 s_add_u32 m0, s56, 32768
 s_add_u32 s3, s55, s68
 buffer_load_dwordx4 v1, s[4:7], s3 offen sc1 lds
 s_waitcnt lgkmcnt(3)
 v_mfma_f32_32x32x16_bf16 v[64:79], a[100:103], v[36:39], v[64:79]
 ds_read_b128 v[52:55], v21 offset:24576
 s_waitcnt lgkmcnt(3)
 v_mfma_f32_32x32x16_bf16 v[64:79], a[104:107], v[40:43], v[64:79]
 ds_read_b128 v[56:59], v22 offset:24576
 s_waitcnt lgkmcnt(3)
 v_mfma_f32_32x32x16_bf16 v[64:79], a[108:111], v[44:47], v[64:79]
 ds_read_b128 v[60:63], v23 offset:24576
 s_add_u32 m0, s56, 33792
 s_add_u32 s3, s55, s68
 buffer_load_dwordx4 v24, s[4:7], s3 offen sc1 lds
 s_waitcnt lgkmcnt(3)
 v_mfma_f32_32x32x16_bf16 v[64:79], a[112:115], v[48:51], v[64:79]
 ds_read_b128 v[32:35], v16 offset:32768
 s_waitcnt lgkmcnt(3)
 v_mfma_f32_32x32x16_bf16 v[64:79], a[116:119], v[52:55], v[64:79]
 ds_read_b128 v[36:39], v17 offset:32768
 v_mov_b32 v6, 8
 s_mov_b64 exec, 15
 v_mov_b32 v6, 0
 buffer_atomic_add v6, v5, s[4:7], s70 offen sc0
 s_mov_b64 exec, -1
 s_waitcnt lgkmcnt(3)
 v_mfma_f32_32x32x16_bf16 v[64:79], a[120:123], v[56:59], v[64:79]
 ds_read_b128 v[40:43], v18 offset:32768
 s_waitcnt lgkmcnt(3)
 v_mfma_f32_32x32x16_bf16 v[64:79], a[124:127], v[60:63], v[64:79]
 ds_read_b128 v[44:47], v19 offset:32768
 s_waitcnt lgkmcnt(3)
 v_mfma_f32_32x32x16_bf16 v[64:79], a[128:131], v[32:35], v[64:79]
 ds_read_b128 v[48:51], v20 offset:32768
 s_waitcnt lgkmcnt(3)
 v_mfma_f32_32x32x16_bf16 v[64:79], a[132:135], v[36:39], v[64:79]
 ds_read_b128 v[52:55], v21 offset:32768
 s_waitcnt lgkmcnt(3)
 v_mfma_f32_32x32x16_bf16 v[64:79], a[136:139], v[40:43], v[64:79]
 ds_read_b128 v[56:59], v22 offset:32768
 s_waitcnt lgkmcnt(3)
 v_mfma_f32_32x32x16_bf16 v[64:79], a[140:143], v[44:47], v[64:79]
 ds_read_b128 v[60:63], v23 offset:32768
 s_waitcnt lgkmcnt(3)
 v_mfma_f32_32x32x16_bf16 v[64:79], a[144:147], v[48:51], v[64:79]
 s_waitcnt lgkmcnt(2)
 v_mfma_f32_32x32x16_bf16 v[64:79], a[148:151], v[52:55], v[64:79]
 s_waitcnt lgkmcnt(1)
 v_mfma_f32_32x32x16_bf16 v[64:79], a[152:155], v[56:59], v[64:79]
 s_waitcnt lgkmcnt(0)
 v_mfma_f32_32x32x16_bf16 v[64:79], a[156:159], v[60:63], v[64:79]
 s_lshl_b32 s3, s60, 19
 s_add_u32 s3, s3, s58
 s_xor_b32 s3, s3, s82
 s_add_u32 s3, s3, 33554432
 s_nop 8
 v_cvt_pk_bf16_f32 v88, v64, v65
 v_cvt_pk_bf16_f32 v89, v66, v67
 v_cvt_pk_bf16_f32 v90, v72, v73
 v_cvt_pk_bf16_f32 v91, v74, v75
 buffer_store_dwordx4 v[88:91], v4, s[4:7], s3 offen offset:0 sc1
 v_cvt_pk_bf16_f32 v92, v68, v69
 v_cvt_pk_bf16_f32 v93, v70, v71
 v_cvt_pk_bf16_f32 v94, v76, v77
 v_cvt_pk_bf16_f32 v95, v78, v79
 buffer_store_dwordx4 v[92:95], v4, s[4:7], s3 offen offset:512 sc1
 s_branch L_qkvq_mid
L_qkvq_loop:
 s_cmp_lg_u32 s54, 32
 s_cbranch_scc1 L_c2_65
 s_cmp_lg_u32 s50, 0
 s_cbranch_scc1 L_ww_66
 s_mov_b32 s96, s44
 s_and_b32 s97, s45, 0xffff
 s_mov_b32 s98, 256
 s_mov_b32 s99, 0x00020000
 v_mov_b32 v25, 140
 s_mov_b32 s51, 0
 s_mov_b64 exec, 1
L_wb_67:
 buffer_load_dword v26, v25, s[96:99], 0 offen sc1
 s_waitcnt vmcnt(0)
 v_cmp_eq_u32 vcc, 0, v26
 s_cbranch_vccz L_wbd_68
 s_sleep 2
 s_add_u32 s51, s51, 1
 s_cmp_lt_u32 s51, 131072
 s_cbranch_scc1 L_wb_67
 s_branch L_bail
L_wbd_68:
 s_mov_b64 exec, -1
L_ww_66:
 s_barrier
L_c2_65:
 s_sub_u32 s60, s54, 16
 s_mul_i32 s55, s60, 40960
 s_mul_i32 s3, s50, 10240
 s_add_u32 s55, s55, s3
 s_add_u32 s55, s55, 229113856
 s_add_u32 m0, s56, 40960
 s_add_u32 s3, s55, s64
 buffer_load_dwordx4 v1, s[4:7], s3 offen sc1 lds
 s_add_u32 m0, s56, 41984
 s_add_u32 s3, s55, s64
 buffer_load_dwordx4 v24, s[4:7], s3 offen sc1 lds
 s_add_u32 m0, s56, 49152
 s_add_u32 s3, s55, s65
 buffer_load_dwordx4 v1, s[4:7], s3 offen sc1 lds
 s_add_u32 m0, s56, 50176
 s_add_u32 s3, s55, s65
 buffer_load_dwordx4 v24, s[4:7], s3 offen sc1 lds
 s_add_u32 m0, s56, 57344
 s_add_u32 s3, s55, s66
 buffer_load_dwordx4 v1, s[4:7], s3 offen sc1 lds
 s_add_u32 m0, s56, 58368
 s_add_u32 s3, s55, s66
 buffer_load_dwordx4 v24, s[4:7], s3 offen sc1 lds
 s_add_u32 m0, s56, 65536
 s_add_u32 s3, s55, s67
 buffer_load_dwordx4 v1, s[4:7], s3 offen sc1 lds
 s_add_u32 m0, s56, 66560
 s_add_u32 s3, s55, s67
 buffer_load_dwordx4 v24, s[4:7], s3 offen sc1 lds
 s_add_u32 m0, s56, 73728
 s_add_u32 s3, s55, s68
 buffer_load_dwordx4 v1, s[4:7], s3 offen sc1 lds
 s_add_u32 m0, s56, 74752
 s_add_u32 s3, s55, s68
 buffer_load_dwordx4 v24, s[4:7], s3 offen sc1 lds
 s_lshl_b32 s70, s54, 2
 s_add_u32 s70, s70, s62
 s_sub_u32 s70, s70, 60
 s_cmp_lg_u32 s50, 0
 s_cselect_b32 s70, 268435456, s70
 s_min_u32 s51, s54, 63
 s_mul_i32 s55, s51, 40960
 s_mul_i32 s3, s50, 10240
 s_add_u32 s55, s55, s3
 s_add_u32 s55, s55, 226492416
 s_waitcnt vmcnt(8)
 s_barrier
 ds_read_b128 v[32:35], v16 offset:0
 ds_read_b128 v[36:39], v17 offset:0
 ds_read_b128 v[40:43], v18 offset:0
 ds_read_b128 v[44:47], v19 offset:0
 s_waitcnt lgkmcnt(3)
 v_mfma_f32_32x32x16_bf16 v[64:79], a[0:3], v[32:35], 0
 ds_read_b128 v[48:51], v20 offset:0
 s_add_u32 m0, s56, 0
 s_add_u32 s3, s55, s64
 buffer_load_dwordx4 v1, s[4:7], s3 offen sc1 lds
 s_waitcnt lgkmcnt(3)
 v_mfma_f32_32x32x16_bf16 v[64:79], a[4:7], v[36:39], v[64:79]
 ds_read_b128 v[52:55], v21 offset:0
 s_waitcnt lgkmcnt(3)
 v_mfma_f32_32x32x16_bf16 v[64:79], a[8:11], v[40:43], v[64:79]
 ds_read_b128 v[56:59], v22 offset:0
 s_waitcnt lgkmcnt(3)
 v_mfma_f32_32x32x16_bf16 v[64:79], a[12:15], v[44:47], v[64:79]
 ds_read_b128 v[60:63], v23 offset:0
 s_add_u32 m0, s56, 1024
 s_add_u32 s3, s55, s64
 buffer_load_dwordx4 v24, s[4:7], s3 offen sc1 lds
 s_waitcnt lgkmcnt(3)
 v_mfma_f32_32x32x16_bf16 v[64:79], a[16:19], v[48:51], v[64:79]
 s_waitcnt vmcnt(8)
 s_barrier
 ds_read_b128 v[32:35], v16 offset:8192
 s_waitcnt lgkmcnt(3)
 v_mfma_f32_32x32x16_bf16 v[64:79], a[20:23], v[52:55], v[64:79]
 ds_read_b128 v[36:39], v17 offset:8192
 s_waitcnt lgkmcnt(3)
 v_mfma_f32_32x32x16_bf16 v[64:79], a[24:27], v[56:59], v[64:79]
 ds_read_b128 v[40:43], v18 offset:8192
 s_add_u32 m0, s56, 8192
 s_add_u32 s3, s55, s65
 buffer_load_dwordx4 v1, s[4:7], s3 offen sc1 lds
 s_waitcnt lgkmcnt(3)
 v_mfma_f32_32x32x16_bf16 v[64:79], a[28:31], v[60:63], v[64:79]
 ds_read_b128 v[44:47], v19 offset:8192
 s_waitcnt lgkmcnt(3)
 v_mfma_f32_32x32x16_bf16 v[64:79], a[32:35], v[32:35], v[64:79]
 ds_read_b128 v[48:51], v20 offset:8192
 s_waitcnt lgkmcnt(3)
 v_mfma_f32_32x32x16_bf16 v[64:79], a[36:39], v[36:39], v[64:79]
 ds_read_b128 v[52:55], v21 offset:8192
 s_add_u32 m0, s56, 9216
 s_add_u32 s3, s55, s65
 buffer_load_dwordx4 v24, s[4:7], s3 offen sc1 lds
 s_waitcnt lgkmcnt(3)
 v_mfma_f32_32x32x16_bf16 v[64:79], a[40:43], v[40:43], v[64:79]
 ds_read_b128 v[56:59], v22 offset:8192
 s_waitcnt lgkmcnt(3)
 v_mfma_f32_32x32x16_bf16 v[64:79], a[44:47], v[44:47], v[64:79]
 ds_read_b128 v[60:63], v23 offset:8192
 s_waitcnt lgkmcnt(3)
 v_mfma_f32_32x32x16_bf16 v[64:79], a[48:51], v[48:51], v[64:79]
 s_waitcnt vmcnt(8)
 s_barrier
 ds_read_b128 v[32:35], v16 offset:16384
 s_add_u32 m0, s56, 16384
 s_add_u32 s3, s55, s66
 buffer_load_dwordx4 v1, s[4:7], s3 offen sc1 lds
 s_waitcnt lgkmcnt(3)
 v_mfma_f32_32x32x16_bf16 v[64:79], a[52:55], v[52:55], v[64:79]
 ds_read_b128 v[36:39], v17 offset:16384
 s_waitcnt lgkmcnt(3)
 v_mfma_f32_32x32x16_bf16 v[64:79], a[56:59], v[56:59], v[64:79]
 ds_read_b128 v[40:43], v18 offset:16384
 s_waitcnt lgkmcnt(3)
 v_mfma_f32_32x32x16_bf16 v[64:79], a[60:63], v[60:63], v[64:79]
 ds_read_b128 v[44:47], v19 offset:16384
 s_add_u32 m0, s56, 17408
 s_add_u32 s3, s55, s66
 buffer_load_dwordx4 v24, s[4:7], s3 offen sc1 lds
 s_waitcnt lgkmcnt(3)
 v_mfma_f32_32x32x16_bf16 v[64:79], a[64:67], v[32:35], v[64:79]
 ds_read_b128 v[48:51], v20 offset:16384
 s_waitcnt lgkmcnt(3)
 v_mfma_f32_32x32x16_bf16 v[64:79], a[68:71], v[36:39], v[64:79]
 ds_read_b128 v[52:55], v21 offset:16384
 s_waitcnt lgkmcnt(3)
 v_mfma_f32_32x32x16_bf16 v[64:79], a[72:75], v[40:43], v[64:79]
 ds_read_b128 v[56:59], v22 offset:16384
 s_add_u32 m0, s56, 24576
 s_add_u32 s3, s55, s67
 buffer_load_dwordx4 v1, s[4:7], s3 offen sc1 lds
 s_waitcnt lgkmcnt(3)
 v_mfma_f32_32x32x16_bf16 v[64:79], a[76:79], v[44:47], v[64:79]
 ds_read_b128 v[60:63], v23 offset:16384
 s_waitcnt lgkmcnt(3)
 v_mfma_f32_32x32x16_bf16 v[64:79], a[80:83], v[48:51], v[64:79]
 s_waitcnt vmcnt(9)
 s_barrier
 ds_read_b128 v[32:35], v16 offset:24576
 s_waitcnt lgkmcnt(3)
 v_mfma_f32_32x32x16_bf16 v[64:79], a[84:87], v[52:55], v[64:79]
 ds_read_b128 v[36:39], v17 offset:24576
 s_add_u32 m0, s56, 25600
 s_add_u32 s3, s55, s67
 buffer_load_dwordx4 v24, s[4:7], s3 offen sc1 lds
 s_waitcnt lgkmcnt(3)
 v_mfma_f32_32x32x16_bf16 v[64:79], a[88:91], v[56:59], v[64:79]
 ds_read_b128 v[40:43], v18 offset:24576
 s_waitcnt lgkmcnt(3)
 v_mfma_f32_32x32x16_bf16 v[64:79], a[92:95], v[60:63], v[64:79]
 ds_read_b128 v[44:47], v19 offset:24576
 s_waitcnt lgkmcnt(3)
 v_mfma_f32_32x32x16_bf16 v[64:79], a[96:99], v[32:35], v[64:79]
 ds_read_b128 v[48:51], v20 offset:24576
 s_add_u32 m0, s56, 32768
 s_add_u32 s3, s55, s68
 buffer_load_dwordx4 v1, s[4:7], s3 offen sc1 lds
 s_waitcnt lgkmcnt(3)
 v_mfma_f32_32x32x16_bf16 v[64:79], a[100:103], v[36:39], v[64:79]
 ds_read_b128 v[52:55], v21 offset:24576
 s_waitcnt lgkmcnt(3)
 v_mfma_f32_32x32x16_bf16 v[64:79], a[104:107], v[40:43], v[64:79]
 ds_read_b128 v[56:59], v22 offset:24576
 s_waitcnt lgkmcnt(3)
 v_mfma_f32_32x32x16_bf16 v[64:79], a[108:111], v[44:47], v[64:79]
 ds_read_b128 v[60:63], v23 offset:24576
 s_add_u32 m0, s56, 33792
 s_add_u32 s3, s55, s68
 buffer_load_dwordx4 v24, s[4:7], s3 offen sc1 lds
 s_waitcnt lgkmcnt(3)
 v_mfma_f32_32x32x16_bf16 v[64:79], a[112:115], v[48:51], v[64:79]
 s_waitcnt vmcnt(10)
 s_barrier
 ds_read_b128 v[32:35], v16 offset:32768
 s_waitcnt lgkmcnt(3)
 v_mfma_f32_32x32x16_bf16 v[64:79], a[116:119], v[52:55], v[64:79]
 ds_read_b128 v[36:39], v17 offset:32768
 v_mov_b32 v6, 8
 s_mov_b64 exec, 15
 v_mov_b32 v6, 0
 buffer_atomic_add v6, v5, s[4:7], s70 offen sc0
 s_mov_b64 exec, -1
 s_waitcnt lgkmcnt(3)
 v_mfma_f32_32x32x16_bf16 v[64:79], a[120:123], v[56:59], v[64:79]
 ds_read_b128 v[40:43], v18 offset:32768
 s_waitcnt lgkmcnt(3)
 v_mfma_f32_32x32x16_bf16 v[64:79], a[124:127], v[60:63], v[64:79]
 ds_read_b128 v[44:47], v19 offset:32768
 s_waitcnt lgkmcnt(3)
 v_mfma_f32_32x32x16_bf16 v[64:79], a[128:131], v[32:35], v[64:79]
 ds_read_b128 v[48:51], v20 offset:32768
 s_waitcnt lgkmcnt(3)
 v_mfma_f32_32x32x16_bf16 v[64:79], a[132:135], v[36:39], v[64:79]
 ds_read_b128 v[52:55], v21 offset:32768
 s_waitcnt lgkmcnt(3)
 v_mfma_f32_32x32x16_bf16 v[64:79], a[136:139], v[40:43], v[64:79]
 ds_read_b128 v[56:59], v22 offset:32768
 s_waitcnt lgkmcnt(3)
 v_mfma_f32_32x32x16_bf16 v[64:79], a[140:143], v[44:47], v[64:79]
 ds_read_b128 v[60:63], v23 offset:32768
 s_waitcnt lgkmcnt(3)
 v_mfma_f32_32x32x16_bf16 v[64:79], a[144:147], v[48:51], v[64:79]
 s_waitcnt lgkmcnt(2)
 v_mfma_f32_32x32x16_bf16 v[64:79], a[148:151], v[52:55], v[64:79]
 s_waitcnt lgkmcnt(1)
 v_mfma_f32_32x32x16_bf16 v[64:79], a[152:155], v[56:59], v[64:79]
 s_waitcnt lgkmcnt(0)
 v_mfma_f32_32x32x16_bf16 v[64:79], a[156:159], v[60:63], v[64:79]
 s_lshl_b32 s3, s60, 19
 s_add_u32 s3, s3, s58
 s_xor_b32 s3, s3, s82
 s_add_u32 s3, s3, 33554432
 s_nop 8
 v_cvt_pk_bf16_f32 v88, v64, v65
 v_cvt_pk_bf16_f32 v89, v66, v67
 v_cvt_pk_bf16_f32 v90, v72, v73
 v_cvt_pk_bf16_f32 v91, v74, v75
 buffer_store_dwordx4 v[88:91], v4, s[4:7], s3 offen offset:0 sc1
 v_cvt_pk_bf16_f32 v92, v68, v69
 v_cvt_pk_bf16_f32 v93, v70, v71
 v_cvt_pk_bf16_f32 v94, v76, v77
 v_cvt_pk_bf16_f32 v95, v78, v79
 buffer_store_dwordx4 v[92:95], v4, s[4:7], s3 offen offset:512 sc1
L_qkvq_mid:
 s_cmp_ge_u32 s54, 64
 s_cbranch_scc1 L_n0_60
 s_waitcnt vmcnt(2)
 s_cmp_lg_u32 s50, 0
 s_cbranch_scc1 L_w_69
 v_cmp_gt_u32 vcc, 8, v6
 s_nop 1
 v_mov_b32 v3, vcc_lo
 ds_write_b32 v7, v3
 s_waitcnt lgkmcnt(0)
L_w_69:
 s_barrier
 ds_read_b32 v3, v7
 s_waitcnt lgkmcnt(0)
 v_readfirstlane_b32 s3, v3
 s_mov_b32 s69, s3
 s_add_u32 s51, s60, 1
 s_mov_b32 s60, s54
 s_mul_i32 s55, s51, 40960
 s_mul_i32 s3, s50, 10240
 s_add_u32 s55, s55, s3
 s_add_u32 s55, s55, 229113856
 s_cmp_eq_u32 s69, 0
 s_cselect_b32 s55, s55, 268435456
 ds_read_b128 v[32:35], v8 offset:0
 ds_read_b128 v[36:39], v9 offset:0
 ds_read_b128 v[40:43], v10 offset:0
 ds_read_b128 v[44:47], v11 offset:0
 s_waitcnt lgkmcnt(3)
 v_mfma_f32_32x32x16_bf16 v[64:79], a[0:3], v[32:35], 0
 ds_read_b128 v[48:51], v12 offset:0
 s_add_u32 m0, s56, 40960
 s_add_u32 s3, s55, s64
 buffer_load_dwordx4 v1, s[4:7], s3 offen sc1 lds
 s_waitcnt lgkmcnt(3)
 v_mfma_f32_32x32x16_bf16 v[64:79], a[4:7], v[36:39], v[64:79]
 ds_read_b128 v[52:55], v13 offset:0
 s_waitcnt lgkmcnt(3)
 v_mfma_f32_32x32x16_bf16 v[64:79], a[8:11], v[40:43], v[64:79]
 ds_read_b128 v[56:59], v14 offset:0
 s_waitcnt lgkmcnt(3)
 v_mfma_f32_32x32x16_bf16 v[64:79], a[12:15], v[44:47], v[64:79]
 ds_read_b128 v[60:63], v15 offset:0
 s_add_u32 m0, s56, 41984
 s_add_u32 s3, s55, s64
 buffer_load_dwordx4 v24, s[4:7], s3 offen sc1 lds
 s_waitcnt lgkmcnt(3)
 v_mfma_f32_32x32x16_bf16 v[64:79], a[16:19], v[48:51], v[64:79]
 ds_read_b128 v[32:35], v8 offset:8192
 s_waitcnt lgkmcnt(3)
 v_mfma_f32_32x32x16_bf16 v[64:79], a[20:23], v[52:55], v[64:79]
 ds_read_b128 v[36:39], v9 offset:8192
 s_waitcnt lgkmcnt(3)
 v_mfma_f32_32x32x16_bf16 v[64:79], a[24:27], v[56:59], v[64:79]
 ds_read_b128 v[40:43], v10 offset:8192
 s_add_u32 m0, s56, 49152
 s_add_u32 s3, s55, s65
 buffer_load_dwordx4 v1, s[4:7], s3 offen sc1 lds
 s_waitcnt lgkmcnt(3)
 v_mfma_f32_32x32x16_bf16 v[64:79], a[28:31], v[60:63], v[64:79]
 ds_read_b128 v[44:47], v11 offset:8192
 s_waitcnt lgkmcnt(3)
 v_mfma_f32_32x32x16_bf16 v[64:79], a[32:35], v[32:35], v[64:79]
 ds_read_b128 v[48:51], v12 offset:8192
 s_waitcnt lgkmcnt(3)
 v_mfma_f32_32x32x16_bf16 v[64:79], a[36:39], v[36:39], v[64:79]
 ds_read_b128 v[52:55], v13 offset:8192
 s_add_u32 m0, s56, 50176
 s_add_u32 s3, s55, s65
 buffer_load_dwordx4 v24, s[4:7], s3 offen sc1 lds
 s_waitcnt lgkmcnt(3)
 v_mfma_f32_32x32x16_bf16 v[64:79], a[40:43], v[40:43], v[64:79]
 ds_read_b128 v[56:59], v14 offset:8192
 s_waitcnt lgkmcnt(3)
 v_mfma_f32_32x32x16_bf16 v[64:79], a[44:47], v[44:47], v[64:79]
 ds_read_b128 v[60:63], v15 offset:8192
 s_waitcnt lgkmcnt(3)
 v_mfma_f32_32x32x16_bf16 v[64:79], a[48:51], v[48:51], v[64:79]
 ds_read_b128 v[32:35], v8 offset:16384
 s_add_u32 m0, s56, 57344
 s_add_u32 s3, s55, s66
 buffer_load_dwordx4 v1, s[4:7], s3 offen sc1 lds
 s_waitcnt lgkmcnt(3)
 v_mfma_f32_32x32x16_bf16 v[64:79], a[52:55], v[52:55], v[64:79]
 ds_read_b128 v[36:39], v9 offset:16384
 s_waitcnt lgkmcnt(3)
 v_mfma_f32_32x32x16_bf16 v[64:79], a[56:59], v[56:59], v[64:79]
 ds_read_b128 v[40:43], v10 offset:16384
 s_waitcnt lgkmcnt(3)
 v_mfma_f32_32x32x16_bf16 v[64:79], a[60:63], v[60:63], v[64:79]
 ds_read_b128 v[44:47], v11 offset:16384
 s_add_u32 m0, s56, 58368
 s_add_u32 s3, s55, s66
 buffer_load_dwordx4 v24, s[4:7], s3 offen sc1 lds
 s_waitcnt lgkmcnt(3)
 v_mfma_f32_32x32x16_bf16 v[64:79], a[64:67], v[32:35], v[64:79]
 ds_read_b128 v[48:51], v12 offset:16384
 s_waitcnt lgkmcnt(3)
 v_mfma_f32_32x32x16_bf16 v[64:79], a[68:71], v[36:39], v[64:79]
 ds_read_b128 v[52:55], v13 offset:16384
 s_waitcnt vmcnt(6)
 s_lshl_b32 s3, s54, 2
 s_add_u32 s3, s3, s63
 v_mov_b32 v3, 1
 s_mov_b64 exec, s[78:79]
 buffer_atomic_add v3, v30, s[4:7], s3 offen
 s_mov_b64 exec, -1
 s_cmp_eq_u32 s61, 0
 s_cbranch_scc1 L_pf_70
 s_lshl_b32 s3, s61, 2
 s_add_u32 s3, s3, s59
 s_sub_u32 s3, s3, 4
 v_mov_b32 v3, 1
 s_mov_b64 exec, s[78:79]
 buffer_atomic_add v3, v30, s[4:7], s3 offen
 s_mov_b64 exec, -1
 s_mov_b32 s61, 0
L_pf_70:
 s_waitcnt lgkmcnt(3)
 v_mfma_f32_32x32x16_bf16 v[64:79], a[72:75], v[40:43], v[64:79]
 ds_read_b128 v[56:59], v14 offset:16384
 s_add_u32 m0, s56, 65536
 s_add_u32 s3, s55, s67
 buffer_load_dwordx4 v1, s[4:7], s3 offen sc1 lds
 s_waitcnt lgkmcnt(3)
 v_mfma_f32_32x32x16_bf16 v[64:79], a[76:79], v[44:47], v[64:79]
 ds_read_b128 v[60:63], v15 offset:16384
 s_waitcnt lgkmcnt(3)
 v_mfma_f32_32x32x16_bf16 v[64:79], a[80:83], v[48:51], v[64:79]
 ds_read_b128 v[32:35], v8 offset:24576
 s_waitcnt lgkmcnt(3)
 v_mfma_f32_32x32x16_bf16 v[64:79], a[84:87], v[52:55], v[64:79]
 ds_read_b128 v[36:39], v9 offset:24576
 s_add_u32 m0, s56, 66560
 s_add_u32 s3, s55, s67
 buffer_load_dwordx4 v24, s[4:7], s3 offen sc1 lds
 s_waitcnt lgkmcnt(3)
 v_mfma_f32_32x32x16_bf16 v[64:79], a[88:91], v[56:59], v[64:79]
 ds_read_b128 v[40:43], v10 offset:24576
 s_waitcnt lgkmcnt(3)
 v_mfma_f32_32x32x16_bf16 v[64:79], a[92:95], v[60:63], v[64:79]
 ds_read_b128 v[44:47], v11 offset:24576
 s_waitcnt lgkmcnt(3)
 v_mfma_f32_32x32x16_bf16 v[64:79], a[96:99], v[32:35], v[64:79]
 ds_read_b128 v[48:51], v12 offset:24576
 s_add_u32 m0, s56, 73728
 s_add_u32 s3, s55, s68
 buffer_load_dwordx4 v1, s[4:7], s3 offen sc1 lds
 s_waitcnt lgkmcnt(3)
 v_mfma_f32_32x32x16_bf16 v[64:79], a[100:103], v[36:39], v[64:79]
 ds_read_b128 v[52:55], v13 offset:24576
 s_waitcnt lgkmcnt(3)
 v_mfma_f32_32x32x16_bf16 v[64:79], a[104:107], v[40:43], v[64:79]
 ds_read_b128 v[56:59], v14 offset:24576
 s_waitcnt lgkmcnt(3)
 v_mfma_f32_32x32x16_bf16 v[64:79], a[108:111], v[44:47], v[64:79]
 ds_read_b128 v[60:63], v15 offset:24576
 s_add_u32 m0, s56, 74752
 s_add_u32 s3, s55, s68
 buffer_load_dwordx4 v24, s[4:7], s3 offen sc1 lds
 v_mov_b32 v6, 8
 s_mov_b64 exec, 15
 v_mov_b32 v6, 0
 buffer_atomic_add v6, v5, s[4:7], s70 offen sc0
 s_mov_b64 exec, -1
 s_waitcnt lgkmcnt(3)
 v_mfma_f32_32x32x16_bf16 v[64:79], a[112:115], v[48:51], v[64:79]
 ds_read_b128 v[32:35], v8 offset:32768
 s_waitcnt lgkmcnt(3)
 v_mfma_f32_32x32x16_bf16 v[64:79], a[116:119], v[52:55], v[64:79]
 ds_read_b128 v[36:39], v9 offset:32768
 s_waitcnt lgkmcnt(3)
 v_mfma_f32_32x32x16_bf16 v[64:79], a[120:123], v[56:59], v[64:79]
 ds_read_b128 v[40:43], v10 offset:32768
 s_waitcnt lgkmcnt(3)
 v_mfma_f32_32x32x16_bf16 v[64:79], a[124:127], v[60:63], v[64:79]
 ds_read_b128 v[44:47], v11 offset:32768
 s_waitcnt lgkmcnt(3)
 v_mfma_f32_32x32x16_bf16 v[64:79], a[128:131], v[32:35], v[64:79]
 ds_read_b128 v[48:51], v12 offset:32768
 s_waitcnt lgkmcnt(3)
 v_mfma_f32_32x32x16_bf16 v[64:79], a[132:135], v[36:39], v[64:79]
 ds_read_b128 v[52:55], v13 offset:32768
 s_waitcnt lgkmcnt(3)
 v_mfma_f32_32x32x16_bf16 v[64:79], a[136:139], v[40:43], v[64:79]
 ds_read_b128 v[56:59], v14 offset:32768
 s_waitcnt lgkmcnt(3)
 v_mfma_f32_32x32x16_bf16 v[64:79], a[140:143], v[44:47], v[64:79]
 ds_read_b128 v[60:63], v15 offset:32768
 s_waitcnt lgkmcnt(3)
 v_mfma_f32_32x32x16_bf16 v[64:79], a[144:147], v[48:51], v[64:79]
 s_waitcnt lgkmcnt(2)
 v_mfma_f32_32x32x16_bf16 v[64:79], a[148:151], v[52:55], v[64:79]
 s_waitcnt lgkmcnt(1)
 v_mfma_f32_32x32x16_bf16 v[64:79], a[152:155], v[56:59], v[64:79]
 s_waitcnt lgkmcnt(0)
 v_mfma_f32_32x32x16_bf16 v[64:79], a[156:159], v[60:63], v[64:79]
 s_lshl_b32 s3, s60, 19
 s_add_u32 s3, s3, s58
 s_xor_b32 s3, s3, s82
 s_nop 8
 v_cvt_pk_bf16_f32 v80, v64, v65
 v_cvt_pk_bf16_f32 v81, v66, v67
 v_cvt_pk_bf16_f32 v82, v72, v73
 v_cvt_pk_bf16_f32 v83, v74, v75
 buffer_store_dwordx4 v[80:83], v4, s[4:7], s3 offen offset:0 sc1
 v_cvt_pk_bf16_f32 v84, v68, v69
 v_cvt_pk_bf16_f32 v85, v70, v71
 v_cvt_pk_bf16_f32 v86, v76, v77
 v_cvt_pk_bf16_f32 v87, v78, v79
 buffer_store_dwordx4 v[84:87], v4, s[4:7], s3 offen offset:512 sc1
 s_add_u32 s54, s54, 1
 s_mov_b32 s61, s54
 s_waitcnt vmcnt(2)
 s_cmp_lg_u32 s50, 0
 s_cbranch_scc1 L_w_71
 v_cmp_gt_u32 vcc, 8, v6
 s_nop 1
 v_mov_b32 v3, vcc_lo
 ds_write_b32 v7, v3
 s_waitcnt lgkmcnt(0)
L_w_71:
 s_barrier
 ds_read_b32 v3, v7
 s_waitcnt lgkmcnt(0)
 v_readfirstlane_b32 s3, v3
 s_cmp_eq_u32 s69, 0
 s_cbranch_scc1 L_qkvq_fast
 s_cmp_eq_u32 s3, 0
 s_cbranch_scc1 L_qkvq_loop
 s_branch L_qkvq_block
L_n0_60:
 s_waitcnt vmcnt(0)
 s_lshl_b32 s3, s54, 2
 s_add_u32 s3, s3, s63
 v_mov_b32 v3, 1
 s_mov_b64 exec, s[78:79]
 buffer_atomic_add v3, v30, s[4:7], s3 offen
 s_mov_b64 exec, -1
 s_add_u32 s54, s54, 1
 s_cmp_lt_u32 s54, 80
 s_cbranch_scc1 L_qkvq_block
 s_endpgm
L_qkvv:
 s_mul_i32 s57, s50, 40960
 s_mul_i32 s62, s52, 3
 s_add_u32 s62, s62, s53
 s_mul_i32 s3, s62, 13108
 s_lshr_b32 s3, s3, 16
 s_mul_i32 s3, s3, 5
 s_sub_u32 s55, s62, s3
 s_add_u32 s64, s55, 0
 s_sub_u32 s3, s64, 5
 s_cmp_ge_u32 s64, 5
 s_cselect_b32 s64, s3, s64
 s_add_u32 s65, s55, 1
 s_sub_u32 s3, s65, 5
 s_cmp_ge_u32 s65, 5
 s_cselect_b32 s65, s3, s65
 s_add_u32 s66, s55, 2
 s_sub_u32 s3, s66, 5
 s_cmp_ge_u32 s66, 5
 s_cselect_b32 s66, s3, s66
 s_add_u32 s67, s55, 3
 s_sub_u32 s3, s67, 5
 s_cmp_ge_u32 s67, 5
 s_cselect_b32 s67, s3, s67
 s_add_u32 s68, s55, 4
 s_sub_u32 s3, s68, 5
 s_cmp_ge_u32 s68, 5
 s_cselect_b32 s68, s3, s68
 s_lshl_b32 s55, s52, 8
 v_lshrrev_b32 v4, 4, v0
 s_mov_b32 s3, 8192
 v_mul_lo_u32 v4, v4, s3
 v_lshrrev_b32 v3, 3, v0
 v_and_b32 v3, 6, v3
 v_xor_b32 v3, v3, v0
 v_and_b32 v3, 15, v3
 v_lshl_add_u32 v4, v3, 4, v4
 v_xor_b32 v5, 128, v4
 s_lshl_b32 s57, s50, 13
 s_mul_i32 s3, s50, 262144
 s_add_u32 s55, s55, s3
 s_mul_i32 s51, s64, 1048576
 s_add_u32 s51, s51, s55
 s_add_u32 m0, s57, 0
 s_nop 0
 buffer_load_dwordx4 v4, s[8:11], s51 offen lds
 s_add_u32 s51, s51, 32768
 s_add_u32 m0, s57, 1024
 s_nop 0
 buffer_load_dwordx4 v5, s[8:11], s51 offen lds
 s_add_u32 s51, s51, 32768
 s_add_u32 m0, s57, 2048
 s_nop 0
 buffer_load_dwordx4 v4, s[8:11], s51 offen lds
 s_add_u32 s51, s51, 32768
 s_add_u32 m0, s57, 3072
 s_nop 0
 buffer_load_dwordx4 v5, s[8:11], s51 offen lds
 s_add_u32 s51, s51, 32768
 s_add_u32 m0, s57, 4096
 s_nop 0
 buffer_load_dwordx4 v4, s[8:11], s51 offen lds
 s_add_u32 s51, s51, 32768
 s_add_u32 m0, s57, 5120
 s_nop 0
 buffer_load_dwordx4 v5, s[8:11], s51 offen lds
 s_add_u32 s51, s51, 32768
 s_add_u32 m0, s57, 6144
 s_nop 0
 buffer_load_dwordx4 v4, s[8:11], s51 offen lds
 s_add_u32 s51, s51, 32768
 s_add_u32 m0, s57, 7168
 s_nop 0
 buffer_load_dwordx4 v5, s[8:11], s51 offen lds
 s_add_u32 s51, s51, 32768
 s_mul_i32 s51, s65, 1048576
 s_add_u32 s51, s51, s55
 s_add_u32 m0, s57, 32768
 s_nop 0
 buffer_load_dwordx4 v4, s[8:11], s51 offen lds
 s_add_u32 s51, s51, 32768
 s_add_u32 m0, s57, 33792
 s_nop 0
 buffer_load_dwordx4 v5, s[8:11], s51 offen lds
 s_add_u32 s51, s51, 32768
 s_add_u32 m0, s57, 34816
 s_nop 0
 buffer_load_dwordx4 v4, s[8:11], s51 offen lds
 s_add_u32 s51, s51, 32768
 s_add_u32 m0, s57, 35840
 s_nop 0
 buffer_load_dwordx4 v5, s[8:11], s51 offen lds
 s_add_u32 s51, s51, 32768
 s_add_u32 m0, s57, 36864
 s_nop 0
 buffer_load_dwordx4 v4, s[8:11], s51 offen lds
 s_add_u32 s51, s51, 32768
 s_add_u32 m0, s57, 37888
 s_nop 0
 buffer_load_dwordx4 v5, s[8:11], s51 offen lds
 s_add_u32 s51, s51, 32768
 s_add_u32 m0, s57, 38912
 s_nop 0
 buffer_load_dwordx4 v4, s[8:11], s51 offen lds
 s_add_u32 s51, s51, 32768
 s_add_u32 m0, s57, 39936
 s_nop 0
 buffer_load_dwordx4 v5, s[8:11], s51 offen lds
 s_add_u32 s51, s51, 32768
 s_mul_i32 s51, s66, 1048576
 s_add_u32 s51, s51, s55
 s_add_u32 m0, s57, 65536
 s_nop 0
 buffer_load_dwordx4 v4, s[8:11], s51 offen lds
 s_add_u32 s51, s51, 32768
 s_add_u32 m0, s57, 66560
 s_nop 0
 buffer_load_dwordx4 v5, s[8:11], s51 offen lds
 s_add_u32 s51, s51, 32768
 s_add_u32 m0, s57, 67584
 s_nop 0
 buffer_load_dwordx4 v4, s[8:11], s51 offen lds
 s_add_u32 s51, s51, 32768
 s_add_u32 m0, s57, 68608
 s_nop 0
 buffer_load_dwordx4 v5, s[8:11], s51 offen lds
 s_add_u32 s51, s51, 32768
 s_add_u32 m0, s57, 69632
 s_nop 0
 buffer_load_dwordx4 v4, s[8:11], s51 offen lds
 s_add_u32 s51, s51, 32768
 s_add_u32 m0, s57, 70656
 s_nop 0
 buffer_load_dwordx4 v5, s[8:11], s51 offen lds
 s_add_u32 s51, s51, 32768
 s_add_u32 m0, s57, 71680
 s_nop 0
 buffer_load_dwordx4 v4, s[8:11], s51 offen lds
 s_add_u32 s51, s51, 32768
 s_add_u32 m0, s57, 72704
 s_nop 0
 buffer_load_dwordx4 v5, s[8:11], s51 offen lds
 s_add_u32 s51, s51, 32768
 s_mul_i32 s51, s67, 1048576
 s_add_u32 s51, s51, s55
 s_add_u32 m0, s57, 98304
 s_nop 0
 buffer_load_dwordx4 v4, s[8:11], s51 offen lds
 s_add_u32 s51, s51, 32768
 s_add_u32 m0, s57, 99328
 s_nop 0
 buffer_load_dwordx4 v5, s[8:11], s51 offen lds
 s_add_u32 s51, s51, 32768
 s_add_u32 m0, s57, 100352
 s_nop 0
 buffer_load_dwordx4 v4, s[8:11], s51 offen lds
 s_add_u32 s51, s51, 32768
 s_add_u32 m0, s57, 101376
 s_nop 0
 buffer_load_dwordx4 v5, s[8:11], s51 offen lds
 s_add_u32 s51, s51, 32768
 s_add_u32 m0, s57, 102400
 s_nop 0
 buffer_load_dwordx4 v4, s[8:11], s51 offen lds
 s_add_u32 s51, s51, 32768
 s_add_u32 m0, s57, 103424
 s_nop 0
 buffer_load_dwordx4 v5, s[8:11], s51 offen lds
 s_add_u32 s51, s51, 32768
 s_add_u32 m0, s57, 104448
 s_nop 0
 buffer_load_dwordx4 v4, s[8:11], s51 offen lds
 s_add_u32 s51, s51, 32768
 s_add_u32 m0, s57, 105472
 s_nop 0
 buffer_load_dwordx4 v5, s[8:11], s51 offen lds
 s_add_u32 s51, s51, 32768
 s_mul_i32 s51, s68, 1048576
 s_add_u32 s51, s51, s55
 s_add_u32 m0, s57, 131072
 s_nop 0
 buffer_load_dwordx4 v4, s[8:11], s51 offen lds
 s_add_u32 s51, s51, 32768
 s_add_u32 m0, s57, 132096
 s_nop 0
 buffer_load_dwordx4 v5, s[8:11], s51 offen lds
 s_add_u32 s51, s51, 32768
 s_add_u32 m0, s57, 133120
 s_nop 0
 buffer_load_dwordx4 v4, s[8:11], s51 offen lds
 s_add_u32 s51, s51, 32768
 s_add_u32 m0, s57, 134144
 s_nop 0
 buffer_load_dwordx4 v5, s[8:11], s51 offen lds
 s_add_u32 s51, s51, 32768
 s_add_u32 m0, s57, 135168
 s_nop 0
 buffer_load_dwordx4 v4, s[8:11], s51 offen lds
 s_add_u32 s51, s51, 32768
 s_add_u32 m0, s57, 136192
 s_nop 0
 buffer_load_dwordx4 v5, s[8:11], s51 offen lds
 s_add_u32 s51, s51, 32768
 s_add_u32 m0, s57, 137216
 s_nop 0
 buffer_load_dwordx4 v4, s[8:11], s51 offen lds
 s_add_u32 s51, s51, 32768
 s_add_u32 m0, s57, 138240
 s_nop 0
 buffer_load_dwordx4 v5, s[8:11], s51 offen lds
 s_add_u32 s51, s51, 32768
 s_mov_b32 s96, s44
 s_and_b32 s97, s45, 0xffff
 s_mov_b32 s98, 256
 s_mov_b32 s99, 0x00020000
 buffer_load_dword v30, off, s[96:99], 0 offset:132 sc1
 v_lshrrev_b32 v2, 3, v0
 v_and_b32 v2, 4, v2
 v_bfe_u32 v3, v0, 2, 2
 v_or_b32 v2, v2, v3
 v_bfe_u32 v3, v0, 4, 1
 v_xor_b32 v3, v3, v2
 s_lshl_b32 s3, s50, 1
 v_xor_b32 v3, s3, v3
 v_lshlrev_b32 v2, 8, v2
 v_lshl_add_u32 v2, v3, 5, v2
 v_and_b32 v3, 3, v0
 v_lshl_add_u32 v2, v3, 3, v2
 s_waitcnt vmcnt(32)
 s_barrier
 ds_read_b64_tr_b16 a[0:1], v2 offset:0
 ds_read_b64_tr_b16 a[2:3], v2 offset:4096
 ds_read_b64_tr_b16 a[4:5], v2 offset:2048
 ds_read_b64_tr_b16 a[6:7], v2 offset:6144
 ds_read_b64_tr_b16 a[8:9], v2 offset:8192
 ds_read_b64_tr_b16 a[10:11], v2 offset:12288
 ds_read_b64_tr_b16 a[12:13], v2 offset:10240
 ds_read_b64_tr_b16 a[14:15], v2 offset:14336
 ds_read_b64_tr_b16 a[16:17], v2 offset:16384
 ds_read_b64_tr_b16 a[18:19], v2 offset:20480
 ds_read_b64_tr_b16 a[20:21], v2 offset:18432
 ds_read_b64_tr_b16 a[22:23], v2 offset:22528
 ds_read_b64_tr_b16 a[24:25], v2 offset:24576
 ds_read_b64_tr_b16 a[26:27], v2 offset:28672
 ds_read_b64_tr_b16 a[28:29], v2 offset:26624
 ds_read_b64_tr_b16 a[30:31], v2 offset:30720
 v_add_u32 v2, 0x8000, v2
 s_waitcnt vmcnt(24)
 s_barrier
 ds_read_b64_tr_b16 a[32:33], v2 offset:0
 ds_read_b64_tr_b16 a[34:35], v2 offset:4096
 ds_read_b64_tr_b16 a[36:37], v2 offset:2048
 ds_read_b64_tr_b16 a[38:39], v2 offset:6144
 ds_read_b64_tr_b16 a[40:41], v2 offset:8192
 ds_read_b64_tr_b16 a[42:43], v2 offset:12288
 ds_read_b64_tr_b16 a[44:45], v2 offset:10240
 ds_read_b64_tr_b16 a[46:47], v2 offset:14336
 ds_read_b64_tr_b16 a[48:49], v2 offset:16384
 ds_read_b64_tr_b16 a[50:51], v2 offset:20480
 ds_read_b64_tr_b16 a[52:53], v2 offset:18432
 ds_read_b64_tr_b16 a[54:55], v2 offset:22528
 ds_read_b64_tr_b16 a[56:57], v2 offset:24576
 ds_read_b64_tr_b16 a[58:59], v2 offset:28672
 ds_read_b64_tr_b16 a[60:61], v2 offset:26624
 ds_read_b64_tr_b16 a[62:63], v2 offset:30720
 v_add_u32 v2, 0x8000, v2
 s_waitcnt vmcnt(16)
 s_barrier
 ds_read_b64_tr_b16 a[64:65], v2 offset:0
 ds_read_b64_tr_b16 a[66:67], v2 offset:4096
 ds_read_b64_tr_b16 a[68:69], v2 offset:2048
 ds_read_b64_tr_b16 a[70:71], v2 offset:6144
 ds_read_b64_tr_b16 a[72:73], v2 offset:8192
 ds_read_b64_tr_b16 a[74:75], v2 offset:12288
 ds_read_b64_tr_b16 a[76:77], v2 offset:10240
 ds_read_b64_tr_b16 a[78:79], v2 offset:14336
 ds_read_b64_tr_b16 a[80:81], v2 offset:16384
 ds_read_b64_tr_b16 a[82:83], v2 offset:20480
 ds_read_b64_tr_b16 a[84:85], v2 offset:18432
 ds_read_b64_tr_b16 a[86:87], v2 offset:22528
 ds_read_b64_tr_b16 a[88:89], v2 offset:24576
 ds_read_b64_tr_b16 a[90:91], v2 offset:28672
 ds_read_b64_tr_b16 a[92:93], v2 offset:26624
 ds_read_b64_tr_b16 a[94:95], v2 offset:30720
 v_add_u32 v2, 0x8000, v2
 s_waitcnt vmcnt(8)
 s_barrier
 ds_read_b64_tr_b16 a[96:97], v2 offset:0
 ds_read_b64_tr_b16 a[98:99], v2 offset:4096
 ds_read_b64_tr_b16 a[100:101], v2 offset:2048
 ds_read_b64_tr_b16 a[102:103], v2 offset:6144
 ds_read_b64_tr_b16 a[104:105], v2 offset:8192
 ds_read_b64_tr_b16 a[106:107], v2 offset:12288
 ds_read_b64_tr_b16 a[108:109], v2 offset:10240
 ds_read_b64_tr_b16 a[110:111], v2 offset:14336
 ds_read_b64_tr_b16 a[112:113], v2 offset:16384
 ds_read_b64_tr_b16 a[114:115], v2 offset:20480
 ds_read_b64_tr_b16 a[116:117], v2 offset:18432
 ds_read_b64_tr_b16 a[118:119], v2 offset:22528
 ds_read_b64_tr_b16 a[120:121], v2 offset:24576
 ds_read_b64_tr_b16 a[122:123], v2 offset:28672
 ds_read_b64_tr_b16 a[124:125], v2 offset:26624
 ds_read_b64_tr_b16 a[126:127], v2 offset:30720
 v_add_u32 v2, 0x8000, v2
 s_waitcnt vmcnt(0)
 s_barrier
 ds_read_b64_tr_b16 a[128:129], v2 offset:0
 ds_read_b64_tr_b16 a[130:131], v2 offset:4096
 ds_read_b64_tr_b16 a[132:133], v2 offset:2048
 ds_read_b64_tr_b16 a[134:135], v2 offset:6144
 ds_read_b64_tr_b16 a[136:137], v2 offset:8192
 ds_read_b64_tr_b16 a[138:139], v2 offset:12288
 ds_read_b64_tr_b16 a[140:141], v2 offset:10240
 ds_read_b64_tr_b16 a[142:143], v2 offset:14336
 ds_read_b64_tr_b16 a[144:145], v2 offset:16384
 ds_read_b64_tr_b16 a[146:147], v2 offset:20480
 ds_read_b64_tr_b16 a[148:149], v2 offset:18432
 ds_read_b64_tr_b16 a[150:151], v2 offset:22528
 ds_read_b64_tr_b16 a[152:153], v2 offset:24576
 ds_read_b64_tr_b16 a[154:155], v2 offset:28672
 ds_read_b64_tr_b16 a[156:157], v2 offset:26624
 ds_read_b64_tr_b16 a[158:159], v2 offset:30720
 v_add_u32 v2, 0x8000, v2
 s_waitcnt lgkmcnt(0)
 s_barrier
 v_cmp_eq_u32 vcc, 0, v30
 s_cbranch_vccz L_qa_72
 s_mov_b32 s96, s44
 s_and_b32 s97, s45, 0xffff
 s_mov_b32 s98, 256
 s_mov_b32 s99, 0x00020000
 v_mov_b32 v1, 132
 s_mov_b32 s51, 0
 s_mov_b64 exec, 1
L_wb_73:
 buffer_load_dword v2, v1, s[96:99], 0 offen sc1
 s_waitcnt vmcnt(0)
 v_cmp_eq_u32 vcc, 0, v2
 s_cbranch_vccz L_wbd_74
 s_sleep 2
 s_add_u32 s51, s51, 1
 s_cmp_lt_u32 s51, 131072
 s_cbranch_scc1 L_wb_73
 s_branch L_bail
L_wbd_74:
 s_mov_b64 exec, -1
L_qa_72:
 s_lshl_b32 s64, s64, 8
 s_lshl_b32 s65, s65, 8
 s_lshl_b32 s66, s66, 8
 s_lshl_b32 s67, s67, 8
 s_lshl_b32 s68, s68, 8
 s_cmp_eq_u32 s53, 0
 s_cselect_b32 s78, 2, 3
 s_mov_b32 s79, 0
 v_lshrrev_b32 v1, 4, v0
 s_mov_b32 s3, 1280
 v_mul_lo_u32 v1, v1, s3
 v_and_b32 v3, 15, v0
 v_lshl_add_u32 v1, v3, 4, v1
 v_add_u32 v6, 5120, v1
 v_mov_b32 v24, v6
 v_and_b32 v2, 31, v0
 v_lshlrev_b32 v2, 8, v2
 v_lshrrev_b32 v4, 5, v0
 v_xor_b32 v4, v4, v3
 v_xor_b32 v8, 0, v4
 v_lshl_add_u32 v8, v8, 4, v2
 v_add_u32 v16, 40960, v8
 v_xor_b32 v9, 2, v4
 v_lshl_add_u32 v9, v9, 4, v2
 v_add_u32 v17, 40960, v9
 v_xor_b32 v10, 4, v4
 v_lshl_add_u32 v10, v10, 4, v2
 v_add_u32 v18, 40960, v10
 v_xor_b32 v11, 6, v4
 v_lshl_add_u32 v11, v11, 4, v2
 v_add_u32 v19, 40960, v11
 v_xor_b32 v12, 8, v4
 v_lshl_add_u32 v12, v12, 4, v2
 v_add_u32 v20, 40960, v12
 v_xor_b32 v13, 10, v4
 v_lshl_add_u32 v13, v13, 4, v2
 v_add_u32 v21, 40960, v13
 v_xor_b32 v14, 12, v4
 v_lshl_add_u32 v14, v14, 4, v2
 v_add_u32 v22, 40960, v14
 v_xor_b32 v15, 14, v4
 v_lshl_add_u32 v15, v15, 4, v2
 v_add_u32 v23, 40960, v15
 v_lshrrev_b32 v4, 5, v0
 v_lshlrev_b32 v4, 8, v4
 v_lshl_add_u32 v4, v3, 4, v4
 v_and_b32 v2, 16, v0
 v_lshl_add_u32 v4, v2, 6, v4
 s_lshl_b32 s3, s50, 11
 v_add_u32 v4, s3, v4
 v_mul_u32_u24 v5, 24576, v0
 v_mov_b32 v7, 163776
 v_mul_u32_u24 v30, 16384, v0
 s_lshl_b32 s75, s62, 2
 s_add_u32 s75, s75, s50
 s_and_b32 s100, s52, 1
 s_lshl_b32 s100, s100, 13
 s_lshl_b32 s58, s52, 14
 s_add_u32 s58, s58, s100
 s_add_u32 s58, s58, 75497472
 s_cmp_eq_u32 s53, 0
 s_cselect_b32 s82, 8192, 0
 s_lshl_b32 s59, s52, 8
 s_add_u32 s59, s59, 8192
 s_lshl_b32 s56, s50, 11
 s_mov_b32 s54, 0
 s_mov_b32 s61, 0
 s_mov_b32 s70, s75
 s_mul_i32 s55, s54, 40960
 s_mul_i32 s3, s50, 10240
 s_add_u32 s55, s55, s3
 s_add_u32 s55, s55, 226492416
 s_add_u32 m0, s56, 0
 s_add_u32 s3, s55, s64
 buffer_load_dwordx4 v1, s[4:7], s3 offen sc1 lds
 s_add_u32 m0, s56, 1024
 s_add_u32 s3, s55, s64
 buffer_load_dwordx4 v24, s[4:7], s3 offen sc1 lds
 s_add_u32 m0, s56, 8192
 s_add_u32 s3, s55, s65
 buffer_load_dwordx4 v1, s[4:7], s3 offen sc1 lds
 s_add_u32 m0, s56, 9216
 s_add_u32 s3, s55, s65
 buffer_load_dwordx4 v24, s[4:7], s3 offen sc1 lds
 s_add_u32 m0, s56, 16384
 s_add_u32 s3, s55, s66
 buffer_load_dwordx4 v1, s[4:7], s3 offen sc1 lds
 s_add_u32 m0, s56, 17408
 s_add_u32 s3, s55, s66
 buffer_load_dwordx4 v24, s[4:7], s3 offen sc1 lds
 s_add_u32 m0, s56, 24576
 s_add_u32 s3, s55, s67
 buffer_load_dwordx4 v1, s[4:7], s3 offen sc1 lds
 s_add_u32 m0, s56, 25600
 s_add_u32 s3, s55, s67
 buffer_load_dwordx4 v24, s[4:7], s3 offen sc1 lds
 s_add_u32 m0, s56, 32768
 s_add_u32 s3, s55, s68
 buffer_load_dwordx4 v1, s[4:7], s3 offen sc1 lds
 s_add_u32 m0, s56, 33792
 s_add_u32 s3, s55, s68
 buffer_load_dwordx4 v24, s[4:7], s3 offen sc1 lds
 s_waitcnt vmcnt(0)
L_qkvv_pre:
 s_barrier
 s_mov_b32 s60, s54
 s_add_u32 s54, s54, 1
 s_mul_i32 s55, s54, 40960
 s_mul_i32 s3, s50, 10240
 s_add_u32 s55, s55, s3
 s_add_u32 s55, s55, 226492416
 ds_read_b128 v[32:35], v8 offset:0
 ds_read_b128 v[36:39], v9 offset:0
 ds_read_b128 v[40:43], v10 offset:0
 ds_read_b128 v[44:47], v11 offset:0
 s_waitcnt lgkmcnt(3)
 v_mfma_f32_32x32x16_bf16 v[64:79], v[32:35], a[0:3], 0
 ds_read_b128 v[48:51], v12 offset:0
 s_add_u32 m0, s56, 40960
 s_add_u32 s3, s55, s64
 buffer_load_dwordx4 v1, s[4:7], s3 offen sc1 lds
 s_waitcnt lgkmcnt(3)
 v_mfma_f32_32x32x16_bf16 v[64:79], v[36:39], a[4:7], v[64:79]
 ds_read_b128 v[52:55], v13 offset:0
 s_waitcnt lgkmcnt(3)
 v_mfma_f32_32x32x16_bf16 v[64:79], v[40:43], a[8:11], v[64:79]
 ds_read_b128 v[56:59], v14 offset:0
 s_waitcnt lgkmcnt(3)
 v_mfma_f32_32x32x16_bf16 v[64:79], v[44:47], a[12:15], v[64:79]
 ds_read_b128 v[60:63], v15 offset:0
 s_add_u32 m0, s56, 41984
 s_add_u32 s3, s55, s64
 buffer_load_dwordx4 v24, s[4:7], s3 offen sc1 lds
 s_waitcnt lgkmcnt(3)
 v_mfma_f32_32x32x16_bf16 v[64:79], v[48:51], a[16:19], v[64:79]
 ds_read_b128 v[32:35], v8 offset:8192
 s_waitcnt lgkmcnt(3)
 v_mfma_f32_32x32x16_bf16 v[64:79], v[52:55], a[20:23], v[64:79]
 ds_read_b128 v[36:39], v9 offset:8192
 s_waitcnt lgkmcnt(3)
 v_mfma_f32_32x32x16_bf16 v[64:79], v[56:59], a[24:27], v[64:79]
 ds_read_b128 v[40:43], v10 offset:8192
 s_add_u32 m0, s56, 49152
 s_add_u32 s3, s55, s65
 buffer_load_dwordx4 v1, s[4:7], s3 offen sc1 lds
 s_waitcnt lgkmcnt(3)
 v_mfma_f32_32x32x16_bf16 v[64:79], v[60:63], a[28:31], v[64:79]
 ds_read_b128 v[44:47], v11 offset:8192
 s_waitcnt lgkmcnt(3)
 v_mfma_f32_32x32x16_bf16 v[64:79], v[32:35], a[32:35], v[64:79]
 ds_read_b128 v[48:51], v12 offset:8192
 s_waitcnt lgkmcnt(3)
 v_mfma_f32_32x32x16_bf16 v[64:79], v[36:39], a[36:39], v[64:79]
 ds_read_b128 v[52:55], v13 offset:8192
 s_add_u32 m0, s56, 50176
 s_add_u32 s3, s55, s65
 buffer_load_dwordx4 v24, s[4:7], s3 offen sc1 lds
 s_waitcnt lgkmcnt(3)
 v_mfma_f32_32x32x16_bf16 v[64:79], v[40:43], a[40:43], v[64:79]
 ds_read_b128 v[56:59], v14 offset:8192
 s_waitcnt lgkmcnt(3)
 v_mfma_f32_32x32x16_bf16 v[64:79], v[44:47], a[44:47], v[64:79]
 ds_read_b128 v[60:63], v15 offset:8192
 s_waitcnt lgkmcnt(3)
 v_mfma_f32_32x32x16_bf16 v[64:79], v[48:51], a[48:51], v[64:79]
 ds_read_b128 v[32:35], v8 offset:16384
 s_add_u32 m0, s56, 57344
 s_add_u32 s3, s55, s66
 buffer_load_dwordx4 v1, s[4:7], s3 offen sc1 lds
 s_waitcnt lgkmcnt(3)
 v_mfma_f32_32x32x16_bf16 v[64:79], v[52:55], a[52:55], v[64:79]
 ds_read_b128 v[36:39], v9 offset:16384
 s_waitcnt lgkmcnt(3)
 v_mfma_f32_32x32x16_bf16 v[64:79], v[56:59], a[56:59], v[64:79]
 ds_read_b128 v[40:43], v10 offset:16384
 s_waitcnt lgkmcnt(3)
 v_mfma_f32_32x32x16_bf16 v[64:79], v[60:63], a[60:63], v[64:79]
 ds_read_b128 v[44:47], v11 offset:16384
 s_add_u32 m0, s56, 58368
 s_add_u32 s3, s55, s66
 buffer_load_dwordx4 v24, s[4:7], s3 offen sc1 lds
 s_waitcnt lgkmcnt(3)
 v_mfma_f32_32x32x16_bf16 v[64:79], v[32:35], a[64:67], v[64:79]
 ds_read_b128 v[48:51], v12 offset:16384
 s_waitcnt lgkmcnt(3)
 v_mfma_f32_32x32x16_bf16 v[64:79], v[36:39], a[68:71], v[64:79]
 ds_read_b128 v[52:55], v13 offset:16384
 s_waitcnt lgkmcnt(3)
 v_mfma_f32_32x32x16_bf16 v[64:79], v[40:43], a[72:75], v[64:79]
 ds_read_b128 v[56:59], v14 offset:16384
 s_add_u32 m0, s56, 65536
 s_add_u32 s3, s55, s67
 buffer_load_dwordx4 v1, s[4:7], s3 offen sc1 lds
 s_waitcnt lgkmcnt(3)
 v_mfma_f32_32x32x16_bf16 v[64:79], v[44:47], a[76:79], v[64:79]
 ds_read_b128 v[60:63], v15 offset:16384
 s_waitcnt vmcnt(7)
 s_cmp_eq_u32 s61, 0
 s_cbranch_scc1 L_pf_75
 s_lshl_b32 s3, s61, 2
 s_add_u32 s3, s3, s59
 s_sub_u32 s3, s3, 4
 v_mov_b32 v3, 1
 s_mov_b64 exec, s[78:79]
 buffer_atomic_add v3, v30, s[4:7], s3 offen
 s_mov_b64 exec, -1
 s_mov_b32 s61, 0
L_pf_75:
 s_waitcnt lgkmcnt(3)
 v_mfma_f32_32x32x16_bf16 v[64:79], v[48:51], a[80:83], v[64:79]
 ds_read_b128 v[32:35], v8 offset:24576
 s_waitcnt lgkmcnt(3)
 v_mfma_f32_32x32x16_bf16 v[64:79], v[52:55], a[84:87], v[64:79]
 ds_read_b128 v[36:39], v9 offset:24576
 s_add_u32 m0, s56, 66560
 s_add_u32 s3, s55, s67
 buffer_load_dwordx4 v24, s[4:7], s3 offen sc1 lds
 s_waitcnt lgkmcnt(3)
 v_mfma_f32_32x32x16_bf16 v[64:79], v[56:59], a[88:91], v[64:79]
 ds_read_b128 v[40:43], v10 offset:24576
 s_waitcnt lgkmcnt(3)
 v_mfma_f32_32x32x16_bf16 v[64:79], v[60:63], a[92:95], v[64:79]
 ds_read_b128 v[44:47], v11 offset:24576
 s_waitcnt lgkmcnt(3)
 v_mfma_f32_32x32x16_bf16 v[64:79], v[32:35], a[96:99], v[64:79]
 ds_read_b128 v[48:51], v12 offset:24576
 s_add_u32 m0, s56, 73728
 s_add_u32 s3, s55, s68
 buffer_load_dwordx4 v1, s[4:7], s3 offen sc1 lds
 s_waitcnt lgkmcnt(3)
 v_mfma_f32_32x32x16_bf16 v[64:79], v[36:39], a[100:103], v[64:79]
 ds_read_b128 v[52:55], v13 offset:24576
 s_waitcnt lgkmcnt(3)
 v_mfma_f32_32x32x16_bf16 v[64:79], v[40:43], a[104:107], v[64:79]
 ds_read_b128 v[56:59], v14 offset:24576
 s_waitcnt lgkmcnt(3)
 v_mfma_f32_32x32x16_bf16 v[64:79], v[44:47], a[108:111], v[64:79]
 ds_read_b128 v[60:63], v15 offset:24576
 s_add_u32 m0, s56, 74752
 s_add_u32 s3, s55, s68
 buffer_load_dwordx4 v24, s[4:7], s3 offen sc1 lds
 s_waitcnt lgkmcnt(3)
 v_mfma_f32_32x32x16_bf16 v[64:79], v[48:51], a[112:115], v[64:79]
 ds_read_b128 v[32:35], v8 offset:32768
 s_waitcnt lgkmcnt(3)
 v_mfma_f32_32x32x16_bf16 v[64:79], v[52:55], a[116:119], v[64:79]
 ds_read_b128 v[36:39], v9 offset:32768
 s_waitcnt lgkmcnt(3)
 v_mfma_f32_32x32x16_bf16 v[64:79], v[56:59], a[120:123], v[64:79]
 ds_read_b128 v[40:43], v10 offset:32768
 s_waitcnt lgkmcnt(3)
 v_mfma_f32_32x32x16_bf16 v[64:79], v[60:63], a[124:127], v[64:79]
 ds_read_b128 v[44:47], v11 offset:32768
 s_waitcnt lgkmcnt(3)
 v_mfma_f32_32x32x16_bf16 v[64:79], v[32:35], a[128:131], v[64:79]
 ds_read_b128 v[48:51], v12 offset:32768
 s_waitcnt lgkmcnt(3)
 v_mfma_f32_32x32x16_bf16 v[64:79], v[36:39], a[132:135], v[64:79]
 ds_read_b128 v[52:55], v13 offset:32768
 s_waitcnt lgkmcnt(3)
 v_mfma_f32_32x32x16_bf16 v[64:79], v[40:43], a[136:139], v[64:79]
 ds_read_b128 v[56:59], v14 offset:32768
 s_waitcnt lgkmcnt(3)
 v_mfma_f32_32x32x16_bf16 v[64:79], v[44:47], a[140:143], v[64:79]
 ds_read_b128 v[60:63], v15 offset:32768
 s_waitcnt lgkmcnt(3)
 v_mfma_f32_32x32x16_bf16 v[64:79], v[48:51], a[144:147], v[64:79]
 s_waitcnt lgkmcnt(2)
 v_mfma_f32_32x32x16_bf16 v[64:79], v[52:55], a[148:151], v[64:79]
 s_waitcnt lgkmcnt(1)
 v_mfma_f32_32x32x16_bf16 v[64:79], v[56:59], a[152:155], v[64:79]
 s_waitcnt lgkmcnt(0)
 v_mfma_f32_32x32x16_bf16 v[64:79], v[60:63], a[156:159], v[64:79]
 s_lshl_b32 s3, s60, 19
 s_add_u32 s3, s3, s58
 s_xor_b32 s3, s3, s82
 s_nop 8
 v_cvt_pk_bf16_f32 v80, v64, v65
 v_cvt_pk_bf16_f32 v81, v66, v67
 v_cvt_pk_bf16_f32 v82, v72, v73
 v_cvt_pk_bf16_f32 v83, v74, v75
 buffer_store_dwordx4 v[80:83], v4, s[4:7], s3 offen offset:0 sc1
 v_cvt_pk_bf16_f32 v84, v68, v69
 v_cvt_pk_bf16_f32 v85, v70, v71
 v_cvt_pk_bf16_f32 v86, v76, v77
 v_cvt_pk_bf16_f32 v87, v78, v79
 buffer_store_dwordx4 v[84:87], v4, s[4:7], s3 offen offset:512 sc1
 s_mov_b32 s61, s54
 s_cmp_lg_u32 s54, 1
 s_cbranch_scc1 L_f1_76
 s_waitcnt vmcnt(0)
 s_cmp_eq_u32 s61, 0
 s_cbranch_scc1 L_pf_77
 s_lshl_b32 s3, s61, 2
 s_add_u32 s3, s3, s59
 s_sub_u32 s3, s3, 4
 v_mov_b32 v3, 1
 s_mov_b64 exec, s[78:79]
 buffer_atomic_add v3, v30, s[4:7], s3 offen
 s_mov_b64 exec, -1
 s_mov_b32 s61, 0
L_pf_77:
 s_mov_b32 s8, s38
 s_and_b32 s9, s39, 0xffff
 s_mov_b32 s10, 2621440
 s_mov_b32 s11, 0x00020000
 s_mov_b32 s12, s40
 s_and_b32 s13, s41, 0xffff
 s_mov_b32 s14, 1280
 s_mov_b32 s15, 0x00020000
 v_lshlrev_b32 v130, 4, v0
 s_lshl_b32 s73, s70, 12
 s_add_u32 s74, s73, 2
 buffer_load_dwordx4 v[96:99], v130, s[8:11], s73 offen offset:0
 buffer_load_dwordx4 v[100:103], v130, s[8:11], s73 offen offset:1024
 buffer_load_dwordx4 v[112:115], v130, s[8:11], s74 offen offset:0
 buffer_load_dwordx4 v[116:119], v130, s[8:11], s74 offen offset:1024
 s_lshl_b32 s3, s70, 1
 buffer_load_ushort v128, off, s[12:15], s3
 s_branch L_f2_78
L_f1_76:
 s_waitcnt vmcnt(2)
L_f2_78:
 s_barrier
 s_mov_b32 s60, s54
 s_add_u32 s54, s54, 1
 s_mul_i32 s55, s54, 40960
 s_mul_i32 s3, s50, 10240
 s_add_u32 s55, s55, s3
 s_add_u32 s55, s55, 226492416
 ds_read_b128 v[32:35], v16 offset:0
 ds_read_b128 v[36:39], v17 offset:0
 ds_read_b128 v[40:43], v18 offset:0
 ds_read_b128 v[44:47], v19 offset:0
 s_waitcnt lgkmcnt(3)
 v_mfma_f32_32x32x16_bf16 v[64:79], v[32:35], a[0:3], 0
 ds_read_b128 v[48:51], v20 offset:0
 s_add_u32 m0, s56, 0
 s_add_u32 s3, s55, s64
 buffer_load_dwordx4 v1, s[4:7], s3 offen sc1 lds
 s_waitcnt lgkmcnt(3)
 v_mfma_f32_32x32x16_bf16 v[64:79], v[36:39], a[4:7], v[64:79]
 ds_read_b128 v[52:55], v21 offset:0
 s_waitcnt lgkmcnt(3)
 v_mfma_f32_32x32x16_bf16 v[64:79], v[40:43], a[8:11], v[64:79]
 ds_read_b128 v[56:59], v22 offset:0
 s_waitcnt lgkmcnt(3)
 v_mfma_f32_32x32x16_bf16 v[64:79], v[44:47], a[12:15], v[64:79]
 ds_read_b128 v[60:63], v23 offset:0
 s_add_u32 m0, s56, 1024
 s_add_u32 s3, s55, s64
 buffer_load_dwordx4 v24, s[4:7], s3 offen sc1 lds
 s_waitcnt lgkmcnt(3)
 v_mfma_f32_32x32x16_bf16 v[64:79], v[48:51], a[16:19], v[64:79]
 ds_read_b128 v[32:35], v16 offset:8192
 s_waitcnt lgkmcnt(3)
 v_mfma_f32_32x32x16_bf16 v[64:79], v[52:55], a[20:23], v[64:79]
 ds_read_b128 v[36:39], v17 offset:8192
 s_waitcnt lgkmcnt(3)
 v_mfma_f32_32x32x16_bf16 v[64:79], v[56:59], a[24:27], v[64:79]
 ds_read_b128 v[40:43], v18 offset:8192
 s_add_u32 m0, s56, 8192
 s_add_u32 s3, s55, s65
 buffer_load_dwordx4 v1, s[4:7], s3 offen sc1 lds
 s_waitcnt lgkmcnt(3)
 v_mfma_f32_32x32x16_bf16 v[64:79], v[60:63], a[28:31], v[64:79]
 ds_read_b128 v[44:47], v19 offset:8192
 s_waitcnt lgkmcnt(3)
 v_mfma_f32_32x32x16_bf16 v[64:79], v[32:35], a[32:35], v[64:79]
 ds_read_b128 v[48:51], v20 offset:8192
 s_waitcnt lgkmcnt(3)
 v_mfma_f32_32x32x16_bf16 v[64:79], v[36:39], a[36:39], v[64:79]
 ds_read_b128 v[52:55], v21 offset:8192
 s_add_u32 m0, s56, 9216
 s_add_u32 s3, s55, s65
 buffer_load_dwordx4 v24, s[4:7], s3 offen sc1 lds
 s_waitcnt lgkmcnt(3)
 v_mfma_f32_32x32x16_bf16 v[64:79], v[40:43], a[40:43], v[64:79]
 ds_read_b128 v[56:59], v22 offset:8192
 s_waitcnt lgkmcnt(3)
 v_mfma_f32_32x32x16_bf16 v[64:79], v[44:47], a[44:47], v[64:79]
 ds_read_b128 v[60:63], v23 offset:8192
 s_waitcnt lgkmcnt(3)
 v_mfma_f32_32x32x16_bf16 v[64:79], v[48:51], a[48:51], v[64:79]
 ds_read_b128 v[32:35], v16 offset:16384
 s_add_u32 m0, s56, 16384
 s_add_u32 s3, s55, s66
 buffer_load_dwordx4 v1, s[4:7], s3 offen sc1 lds
 s_waitcnt lgkmcnt(3)
 v_mfma_f32_32x32x16_bf16 v[64:79], v[52:55], a[52:55], v[64:79]
 ds_read_b128 v[36:39], v17 offset:16384
 s_waitcnt lgkmcnt(3)
 v_mfma_f32_32x32x16_bf16 v[64:79], v[56:59], a[56:59], v[64:79]
 ds_read_b128 v[40:43], v18 offset:16384
 s_waitcnt lgkmcnt(3)
 v_mfma_f32_32x32x16_bf16 v[64:79], v[60:63], a[60:63], v[64:79]
 ds_read_b128 v[44:47], v19 offset:16384
 s_add_u32 m0, s56, 17408
 s_add_u32 s3, s55, s66
 buffer_load_dwordx4 v24, s[4:7], s3 offen sc1 lds
 s_waitcnt lgkmcnt(3)
 v_mfma_f32_32x32x16_bf16 v[64:79], v[32:35], a[64:67], v[64:79]
 ds_read_b128 v[48:51], v20 offset:16384
 s_waitcnt lgkmcnt(3)
 v_mfma_f32_32x32x16_bf16 v[64:79], v[36:39], a[68:71], v[64:79]
 ds_read_b128 v[52:55], v21 offset:16384
 s_waitcnt lgkmcnt(3)
 v_mfma_f32_32x32x16_bf16 v[64:79], v[40:43], a[72:75], v[64:79]
 ds_read_b128 v[56:59], v22 offset:16384
 s_add_u32 m0, s56, 24576
 s_add_u32 s3, s55, s67
 buffer_load_dwordx4 v1, s[4:7], s3 offen sc1 lds
 s_waitcnt lgkmcnt(3)
 v_mfma_f32_32x32x16_bf16 v[64:79], v[44:47], a[76:79], v[64:79]
 ds_read_b128 v[60:63], v23 offset:16384
 s_waitcnt vmcnt(7)
 s_cmp_eq_u32 s61, 0
 s_cbranch_scc1 L_pf_79
 s_lshl_b32 s3, s61, 2
 s_add_u32 s3, s3, s59
 s_sub_u32 s3, s3, 4
 v_mov_b32 v3, 1
 s_mov_b64 exec, s[78:79]
 buffer_atomic_add v3, v30, s[4:7], s3 offen
 s_mov_b64 exec, -1
 s_mov_b32 s61, 0
L_pf_79:
 s_waitcnt lgkmcnt(3)
 v_mfma_f32_32x32x16_bf16 v[64:79], v[48:51], a[80:83], v[64:79]
 ds_read_b128 v[32:35], v16 offset:24576
 s_waitcnt lgkmcnt(3)
 v_mfma_f32_32x32x16_bf16 v[64:79], v[52:55], a[84:87], v[64:79]
 ds_read_b128 v[36:39], v17 offset:24576
 s_add_u32 m0, s56, 25600
 s_add_u32 s3, s55, s67
 buffer_load_dwordx4 v24, s[4:7], s3 offen sc1 lds
 s_waitcnt lgkmcnt(3)
 v_mfma_f32_32x32x16_bf16 v[64:79], v[56:59], a[88:91], v[64:79]
 ds_read_b128 v[40:43], v18 offset:24576
 s_waitcnt lgkmcnt(3)
 v_mfma_f32_32x32x16_bf16 v[64:79], v[60:63], a[92:95], v[64:79]
 ds_read_b128 v[44:47], v19 offset:24576
 s_waitcnt lgkmcnt(3)
 v_mfma_f32_32x32x16_bf16 v[64:79], v[32:35], a[96:99], v[64:79]
 ds_read_b128 v[48:51], v20 offset:24576
 s_add_u32 m0, s56, 32768
 s_add_u32 s3, s55, s68
 buffer_load_dwordx4 v1, s[4:7], s3 offen sc1 lds
 s_waitcnt lgkmcnt(3)
 v_mfma_f32_32x32x16_bf16 v[64:79], v[36:39], a[100:103], v[64:79]
 ds_read_b128 v[52:55], v21 offset:24576
 s_waitcnt lgkmcnt(3)
 v_mfma_f32_32x32x16_bf16 v[64:79], v[40:43], a[104:107], v[64:79]
 ds_read_b128 v[56:59], v22 offset:24576
 s_waitcnt lgkmcnt(3)
 v_mfma_f32_32x32x16_bf16 v[64:79], v[44:47], a[108:111], v[64:79]
 ds_read_b128 v[60:63], v23 offset:24576
 s_add_u32 m0, s56, 33792
 s_add_u32 s3, s55, s68
 buffer_load_dwordx4 v24, s[4:7], s3 offen sc1 lds
 s_waitcnt lgkmcnt(3)
 v_mfma_f32_32x32x16_bf16 v[64:79], v[48:51], a[112:115], v[64:79]
 ds_read_b128 v[32:35], v16 offset:32768
 s_waitcnt lgkmcnt(3)
 v_mfma_f32_32x32x16_bf16 v[64:79], v[52:55], a[116:119], v[64:79]
 ds_read_b128 v[36:39], v17 offset:32768
 s_waitcnt lgkmcnt(3)
 v_mfma_f32_32x32x16_bf16 v[64:79], v[56:59], a[120:123], v[64:79]
 ds_read_b128 v[40:43], v18 offset:32768
 s_waitcnt lgkmcnt(3)
 v_mfma_f32_32x32x16_bf16 v[64:79], v[60:63], a[124:127], v[64:79]
 ds_read_b128 v[44:47], v19 offset:32768
 s_waitcnt lgkmcnt(3)
 v_mfma_f32_32x32x16_bf16 v[64:79], v[32:35], a[128:131], v[64:79]
 ds_read_b128 v[48:51], v20 offset:32768
 s_waitcnt lgkmcnt(3)
 v_mfma_f32_32x32x16_bf16 v[64:79], v[36:39], a[132:135], v[64:79]
 ds_read_b128 v[52:55], v21 offset:32768
 s_waitcnt lgkmcnt(3)
 v_mfma_f32_32x32x16_bf16 v[64:79], v[40:43], a[136:139], v[64:79]
 ds_read_b128 v[56:59], v22 offset:32768
 s_waitcnt lgkmcnt(3)
 v_mfma_f32_32x32x16_bf16 v[64:79], v[44:47], a[140:143], v[64:79]
 ds_read_b128 v[60:63], v23 offset:32768
 s_waitcnt lgkmcnt(3)
 v_mfma_f32_32x32x16_bf16 v[64:79], v[48:51], a[144:147], v[64:79]
 s_waitcnt lgkmcnt(2)
 v_mfma_f32_32x32x16_bf16 v[64:79], v[52:55], a[148:151], v[64:79]
 s_waitcnt lgkmcnt(1)
 v_mfma_f32_32x32x16_bf16 v[64:79], v[56:59], a[152:155], v[64:79]
 s_waitcnt lgkmcnt(0)
 v_mfma_f32_32x32x16_bf16 v[64:79], v[60:63], a[156:159], v[64:79]
 s_lshl_b32 s3, s60, 19
 s_add_u32 s3, s3, s58
 s_xor_b32 s3, s3, s82
 s_nop 8
 v_cvt_pk_bf16_f32 v88, v64, v65
 v_cvt_pk_bf16_f32 v89, v66, v67
 v_cvt_pk_bf16_f32 v90, v72, v73
 v_cvt_pk_bf16_f32 v91, v74, v75
 buffer_store_dwordx4 v[88:91], v4, s[4:7], s3 offen offset:0 sc1
 v_cvt_pk_bf16_f32 v92, v68, v69
 v_cvt_pk_bf16_f32 v93, v70, v71
 v_cvt_pk_bf16_f32 v94, v76, v77
 v_cvt_pk_bf16_f32 v95, v78, v79
 buffer_store_dwordx4 v[92:95], v4, s[4:7], s3 offen offset:512 sc1
 s_mov_b32 s61, s54
 s_waitcnt vmcnt(2)
 s_cmp_lg_u32 s54, 4
 s_cbranch_scc1 L_cv_80
 s_waitcnt vmcnt(0)
 s_cmp_eq_u32 s61, 0
 s_cbranch_scc1 L_pf_81
 s_lshl_b32 s3, s61, 2
 s_add_u32 s3, s3, s59
 s_sub_u32 s3, s3, 4
 v_mov_b32 v3, 1
 s_mov_b64 exec, s[78:79]
 buffer_atomic_add v3, v30, s[4:7], s3 offen
 s_mov_b64 exec, -1
 s_mov_b32 s61, 0
L_pf_81:
 s_mul_i32 s71, s50, 13312
 s_add_u32 s71, s71, 81920
 s_mov_b32 s70, s75
 s_mov_b32 s69, 640
 s_getpc_b64 s[76:77]
L_ca_82:
 s_add_u32 s76, s76, L_conv0-L_ca_82
 s_addc_u32 s77, s77, -1
 s_swappc_b64 s[76:77], s[76:77]
 s_waitcnt vmcnt(0)
 s_barrier
 s_cmp_lg_u32 s50, 3
 s_cbranch_scc1 L_ar_83
 s_mov_b32 s96, s44
 s_and_b32 s97, s45, 0xffff
 s_mov_b32 s98, 256
 s_mov_b32 s99, 0x00020000
 v_mov_b32 v1, 1
 s_mov_b64 exec, 1
 buffer_atomic_add v1, off, s[96:99], 0 offset:8 sc0
 s_waitcnt vmcnt(0)
 v_cmp_eq_u32 vcc, 159, v1
 s_cbranch_vccz L_aw_84
 buffer_store_dword v1, off, s[96:99], 0 offset:136 sc1
L_aw_84:
 s_mov_b64 exec, -1
L_ar_83:
 v_lshrrev_b32 v1, 4, v0
 s_mov_b32 s3, 1280
 v_mul_lo_u32 v1, v1, s3
 v_and_b32 v3, 15, v0
 v_lshl_add_u32 v1, v3, 4, v1
 v_add_u32 v6, 5120, v1
 v_mov_b32 v24, v6
 v_and_b32 v2, 31, v0
 v_lshlrev_b32 v2, 8, v2
 v_lshrrev_b32 v4, 5, v0
 v_xor_b32 v4, v4, v3
 v_xor_b32 v8, 0, v4
 v_lshl_add_u32 v8, v8, 4, v2
 v_add_u32 v16, 40960, v8
 v_xor_b32 v9, 2, v4
 v_lshl_add_u32 v9, v9, 4, v2
 v_add_u32 v17, 40960, v9
 v_xor_b32 v10, 4, v4
 v_lshl_add_u32 v10, v10, 4, v2
 v_add_u32 v18, 40960, v10
 v_xor_b32 v11, 6, v4
 v_lshl_add_u32 v11, v11, 4, v2
 v_add_u32 v19, 40960, v11
 v_xor_b32 v12, 8, v4
 v_lshl_add_u32 v12, v12, 4, v2
 v_add_u32 v20, 40960, v12
 v_xor_b32 v13, 10, v4
 v_lshl_add_u32 v13, v13, 4, v2
 v_add_u32 v21, 40960, v13
 v_xor_b32 v14, 12, v4
 v_lshl_add_u32 v14, v14, 4, v2
 v_add_u32 v22, 40960, v14
 v_xor_b32 v15, 14, v4
 v_lshl_add_u32 v15, v15, 4, v2
 v_add_u32 v23, 40960, v15
 v_lshrrev_b32 v4, 5, v0
 v_lshlrev_b32 v4, 8, v4
 v_lshl_add_u32 v4, v3, 4, v4
 v_and_b32 v2, 16, v0
 v_lshl_add_u32 v4, v2, 6, v4
 s_lshl_b32 s3, s50, 11
 v_add_u32 v4, s3, v4
 v_mul_u32_u24 v5, 24576, v0
 v_mov_b32 v7, 163776
 v_mul_u32_u24 v30, 16384, v0
L_cv_80:
 s_cmp_lg_u32 s54, 10
 s_cbranch_scc1 L_cb_85
 s_cmp_lg_u32 s50, 0
 s_cbranch_scc1 L_ww_86
 s_mov_b32 s96, s44
 s_and_b32 s97, s45, 0xffff
 s_mov_b32 s98, 256
 s_mov_b32 s99, 0x00020000
 v_mov_b32 v25, 200
 s_mov_b32 s51, 0
 s_mov_b64 exec, 1
L_wb_87:
 buffer_load_dword v26, v25, s[96:99], 0 offen sc1
 s_waitcnt vmcnt(0)
 v_cmp_eq_u32 vcc, 0, v26
 s_cbranch_vccz L_wbd_88
 s_sleep 2
 s_add_u32 s51, s51, 1
 s_cmp_lt_u32 s51, 131072
 s_cbranch_scc1 L_wb_87
 s_branch L_bail
L_wbd_88:
 s_mov_b64 exec, -1
L_ww_86:
 s_barrier
L_cb_85:
 s_cmp_lt_u32 s54, 16
 s_cbranch_scc1 L_qkvv_pre
 s_waitcnt vmcnt(0)
 s_cmp_eq_u32 s61, 0
 s_cbranch_scc1 L_pf_90
 s_lshl_b32 s3, s61, 2
 s_add_u32 s3, s3, s59
 s_sub_u32 s3, s3, 4
 v_mov_b32 v3, 1
 s_mov_b64 exec, s[78:79]
 buffer_atomic_add v3, v30, s[4:7], s3 offen
 s_mov_b64 exec, -1
 s_mov_b32 s61, 0
L_pf_90:
 s_lshl_b32 s62, s62, 8
 s_add_u32 s62, s62, 126976
 s_add_u32 s63, s59, 8128
L_qkvv_block:
 s_lshl_b32 s55, s54, 2
 s_add_u32 s55, s55, s62
 s_sub_u32 s55, s55, 64
 s_cmp_lg_u32 s50, 0
 s_cselect_b32 s3, 268435456, s55
 v_mov_b32 v6, 8
 s_mov_b64 exec, 15
 v_mov_b32 v6, 0
 buffer_atomic_add v6, v5, s[4:7], s3 offen sc0
 s_mov_b64 exec, -1
 s_waitcnt vmcnt(0)
 s_cmp_eq_u32 s61, 0
 s_cbranch_scc1 L_pf_93
 s_lshl_b32 s3, s61, 2
 s_add_u32 s3, s3, s59
 s_sub_u32 s3, s3, 4
 v_mov_b32 v3, 1
 s_mov_b64 exec, s[78:79]
 buffer_atomic_add v3, v30, s[4:7], s3 offen
 s_mov_b64 exec, -1
 s_mov_b32 s61, 0
L_pf_93:
 s_cmp_lg_u32 s50, 0
 s_cbranch_scc1 L_w_91
 v_cmp_gt_u32 vcc, 8, v6
 s_cbranch_vccz L_w_91
 s_mov_b32 s51, 0
 s_mov_b64 exec, 15
 v_mov_b32 v28, 0
 buffer_atomic_add v28, v5, s[4:7], s55 offen sc0
 s_sleep 5
L_wc_94:
 v_mov_b32 v29, 0
 buffer_atomic_add v29, v5, s[4:7], s55 offen sc0
 s_waitcnt vmcnt(1)
 v_cmp_gt_u32 vcc, 8, v28
 s_cbranch_vccz L_wcd_95
 v_mov_b32 v28, 0
 buffer_atomic_add v28, v5, s[4:7], s55 offen sc0
 s_waitcnt vmcnt(1)
 v_cmp_gt_u32 vcc, 8, v29
 s_cbranch_vccz L_wcd_95
 s_add_u32 s51, s51, 1
 s_cmp_lt_u32 s51, 131072
 s_cbranch_scc1 L_wc_94
 s_branch L_bail
L_wcd_95:
 s_mov_b64 exec, -1
L_w_91:
 s_barrier
 s_branch L_qkvv_loop
L_qkvv_fast:
 s_cmp_lg_u32 s54, 32
 s_cbranch_scc1 L_c2_97
 s_cmp_lg_u32 s50, 0
 s_cbranch_scc1 L_ww_98
 s_mov_b32 s96, s44
 s_and_b32 s97, s45, 0xffff
 s_mov_b32 s98, 256
 s_mov_b32 s99, 0x00020000
 v_mov_b32 v25, 140
 s_mov_b32 s51, 0
 s_mov_b64 exec, 1
L_wb_99:
 buffer_load_dword v26, v25, s[96:99], 0 offen sc1
 s_waitcnt vmcnt(0)
 v_cmp_eq_u32 vcc, 0, v26
 s_cbranch_vccz L_wbd_100
 s_sleep 2
 s_add_u32 s51, s51, 1
 s_cmp_lt_u32 s51, 131072
 s_cbranch_scc1 L_wb_99
 s_branch L_bail
L_wbd_100:
 s_mov_b64 exec, -1
L_ww_98:
 s_barrier
L_c2_97:
 s_sub_u32 s60, s54, 16
 s_lshl_b32 s70, s54, 2
 s_add_u32 s70, s70, s62
 s_sub_u32 s70, s70, 60
 s_cmp_lg_u32 s50, 0
 s_cselect_b32 s70, 268435456, s70
 s_min_u32 s51, s54, 63
 s_mul_i32 s55, s51, 40960
 s_mul_i32 s3, s50, 10240
 s_add_u32 s55, s55, s3
 s_add_u32 s55, s55, 226492416
 ds_read_b128 v[32:35], v16 offset:0
 ds_read_b128 v[36:39], v17 offset:0
 ds_read_b128 v[40:43], v18 offset:0
 ds_read_b128 v[44:47], v19 offset:0
 s_waitcnt lgkmcnt(3)
 v_mfma_f32_32x32x16_bf16 v[64:79], v[32:35], a[0:3], 0
 ds_read_b128 v[48:51], v20 offset:0
 s_add_u32 m0, s56, 0
 s_add_u32 s3, s55, s64
 buffer_load_dwordx4 v1, s[4:7], s3 offen sc1 lds
 s_waitcnt lgkmcnt(3)
 v_mfma_f32_32x32x16_bf16 v[64:79], v[36:39], a[4:7], v[64:79]
 ds_read_b128 v[52:55], v21 offset:0
 s_waitcnt lgkmcnt(3)
 v_mfma_f32_32x32x16_bf16 v[64:79], v[40:43], a[8:11], v[64:79]
 ds_read_b128 v[56:59], v22 offset:0
 s_waitcnt lgkmcnt(3)
 v_mfma_f32_32x32x16_bf16 v[64:79], v[44:47], a[12:15], v[64:79]
 ds_read_b128 v[60:63], v23 offset:0
 s_add_u32 m0, s56, 1024
 s_add_u32 s3, s55, s64
 buffer_load_dwordx4 v24, s[4:7], s3 offen sc1 lds
 s_waitcnt lgkmcnt(3)
 v_mfma_f32_32x32x16_bf16 v[64:79], v[48:51], a[16:19], v[64:79]
 ds_read_b128 v[32:35], v16 offset:8192
 s_waitcnt lgkmcnt(3)
 v_mfma_f32_32x32x16_bf16 v[64:79], v[52:55], a[20:23], v[64:79]
 ds_read_b128 v[36:39], v17 offset:8192
 s_waitcnt lgkmcnt(3)
 v_mfma_f32_32x32x16_bf16 v[64:79], v[56:59], a[24:27], v[64:79]
 ds_read_b128 v[40:43], v18 offset:8192
 s_add_u32 m0, s56, 8192
 s_add_u32 s3, s55, s65
 buffer_load_dwordx4 v1, s[4:7], s3 offen sc1 lds
 s_waitcnt lgkmcnt(3)
 v_mfma_f32_32x32x16_bf16 v[64:79], v[60:63], a[28:31], v[64:79]
 ds_read_b128 v[44:47], v19 offset:8192
 s_waitcnt lgkmcnt(3)
 v_mfma_f32_32x32x16_bf16 v[64:79], v[32:35], a[32:35], v[64:79]
 ds_read_b128 v[48:51], v20 offset:8192
 s_waitcnt lgkmcnt(3)
 v_mfma_f32_32x32x16_bf16 v[64:79], v[36:39], a[36:39], v[64:79]
 ds_read_b128 v[52:55], v21 offset:8192
 s_add_u32 m0, s56, 9216
 s_add_u32 s3, s55, s65
 buffer_load_dwordx4 v24, s[4:7], s3 offen sc1 lds
 s_waitcnt lgkmcnt(3)
 v_mfma_f32_32x32x16_bf16 v[64:79], v[40:43], a[40:43], v[64:79]
 ds_read_b128 v[56:59], v22 offset:8192
 s_waitcnt lgkmcnt(3)
 v_mfma_f32_32x32x16_bf16 v[64:79], v[44:47], a[44:47], v[64:79]
 ds_read_b128 v[60:63], v23 offset:8192
 s_waitcnt lgkmcnt(3)
 v_mfma_f32_32x32x16_bf16 v[64:79], v[48:51], a[48:51], v[64:79]
 ds_read_b128 v[32:35], v16 offset:16384
 s_add_u32 m0, s56, 16384
 s_add_u32 s3, s55, s66
 buffer_load_dwordx4 v1, s[4:7], s3 offen sc1 lds
 s_waitcnt lgkmcnt(3)
 v_mfma_f32_32x32x16_bf16 v[64:79], v[52:55], a[52:55], v[64:79]
 ds_read_b128 v[36:39], v17 offset:16384
 s_waitcnt lgkmcnt(3)
 v_mfma_f32_32x32x16_bf16 v[64:79], v[56:59], a[56:59], v[64:79]
 ds_read_b128 v[40:43], v18 offset:16384
 s_waitcnt lgkmcnt(3)
 v_mfma_f32_32x32x16_bf16 v[64:79], v[60:63], a[60:63], v[64:79]
 ds_read_b128 v[44:47], v19 offset:16384
 s_add_u32 m0, s56, 17408
 s_add_u32 s3, s55, s66
 buffer_load_dwordx4 v24, s[4:7], s3 offen sc1 lds
 s_waitcnt lgkmcnt(3)
 v_mfma_f32_32x32x16_bf16 v[64:79], v[32:35], a[64:67], v[64:79]
 ds_read_b128 v[48:51], v20 offset:16384
 s_waitcnt lgkmcnt(3)
 v_mfma_f32_32x32x16_bf16 v[64:79], v[36:39], a[68:71], v[64:79]
 ds_read_b128 v[52:55], v21 offset:16384
 s_waitcnt lgkmcnt(3)
 v_mfma_f32_32x32x16_bf16 v[64:79], v[40:43], a[72:75], v[64:79]
 ds_read_b128 v[56:59], v22 offset:16384
 s_add_u32 m0, s56, 24576
 s_add_u32 s3, s55, s67
 buffer_load_dwordx4 v1, s[4:7], s3 offen sc1 lds
 s_waitcnt lgkmcnt(3)
 v_mfma_f32_32x32x16_bf16 v[64:79], v[44:47], a[76:79], v[64:79]
 ds_read_b128 v[60:63], v23 offset:16384
 s_waitcnt lgkmcnt(3)
 v_mfma_f32_32x32x16_bf16 v[64:79], v[48:51], a[80:83], v[64:79]
 ds_read_b128 v[32:35], v16 offset:24576
 s_waitcnt lgkmcnt(3)
 v_mfma_f32_32x32x16_bf16 v[64:79], v[52:55], a[84:87], v[64:79]
 ds_read_b128 v[36:39], v17 offset:24576
 s_add_u32 m0, s56, 25600
 s_add_u32 s3, s55, s67
 buffer_load_dwordx4 v24, s[4:7], s3 offen sc1 lds
 s_waitcnt lgkmcnt(3)
 v_mfma_f32_32x32x16_bf16 v[64:79], v[56:59], a[88:91], v[64:79]
 ds_read_b128 v[40:43], v18 offset:24576
 s_waitcnt lgkmcnt(3)
 v_mfma_f32_32x32x16_bf16 v[64:79], v[60:63], a[92:95], v[64:79]
 ds_read_b128 v[44:47], v19 offset:24576
 s_waitcnt lgkmcnt(3)
 v_mfma_f32_32x32x16_bf16 v[64:79], v[32:35], a[96:99], v[64:79]
 ds_read_b128 v[48:51], v20 offset:24576
 s_add_u32 m0, s56, 32768
 s_add_u32 s3, s55, s68
 buffer_load_dwordx4 v1, s[4:7], s3 offen sc1 lds
 s_waitcnt lgkmcnt(3)
 v_mfma_f32_32x32x16_bf16 v[64:79], v[36:39], a[100:103], v[64:79]
 ds_read_b128 v[52:55], v21 offset:24576
 s_waitcnt lgkmcnt(3)
 v_mfma_f32_32x32x16_bf16 v[64:79], v[40:43], a[104:107], v[64:79]
 ds_read_b128 v[56:59], v22 offset:24576
 s_waitcnt lgkmcnt(3)
 v_mfma_f32_32x32x16_bf16 v[64:79], v[44:47], a[108:111], v[64:79]
 ds_read_b128 v[60:63], v23 offset:24576
 s_add_u32 m0, s56, 33792
 s_add_u32 s3, s55, s68
 buffer_load_dwordx4 v24, s[4:7], s3 offen sc1 lds
 s_waitcnt lgkmcnt(3)
 v_mfma_f32_32x32x16_bf16 v[64:79], v[48:51], a[112:115], v[64:79]
 ds_read_b128 v[32:35], v16 offset:32768
 s_waitcnt lgkmcnt(3)
 v_mfma_f32_32x32x16_bf16 v[64:79], v[52:55], a[116:119], v[64:79]
 ds_read_b128 v[36:39], v17 offset:32768
 v_mov_b32 v6, 8
 s_mov_b64 exec, 15
 v_mov_b32 v6, 0
 buffer_atomic_add v6, v5, s[4:7], s70 offen sc0
 s_mov_b64 exec, -1
 s_waitcnt lgkmcnt(3)
 v_mfma_f32_32x32x16_bf16 v[64:79], v[56:59], a[120:123], v[64:79]
 ds_read_b128 v[40:43], v18 offset:32768
 s_waitcnt lgkmcnt(3)
 v_mfma_f32_32x32x16_bf16 v[64:79], v[60:63], a[124:127], v[64:79]
 ds_read_b128 v[44:47], v19 offset:32768
 s_waitcnt lgkmcnt(3)
 v_mfma_f32_32x32x16_bf16 v[64:79], v[32:35], a[128:131], v[64:79]
 ds_read_b128 v[48:51], v20 offset:32768
 s_waitcnt lgkmcnt(3)
 v_mfma_f32_32x32x16_bf16 v[64:79], v[36:39], a[132:135], v[64:79]
 ds_read_b128 v[52:55], v21 offset:32768
 s_waitcnt lgkmcnt(3)
 v_mfma_f32_32x32x16_bf16 v[64:79], v[40:43], a[136:139], v[64:79]
 ds_read_b128 v[56:59], v22 offset:32768
 s_waitcnt lgkmcnt(3)
 v_mfma_f32_32x32x16_bf16 v[64:79], v[44:47], a[140:143], v[64:79]
 ds_read_b128 v[60:63], v23 offset:32768
 s_waitcnt lgkmcnt(3)
 v_mfma_f32_32x32x16_bf16 v[64:79], v[48:51], a[144:147], v[64:79]
 s_waitcnt lgkmcnt(2)
 v_mfma_f32_32x32x16_bf16 v[64:79], v[52:55], a[148:151], v[64:79]
 s_waitcnt lgkmcnt(1)
 v_mfma_f32_32x32x16_bf16 v[64:79], v[56:59], a[152:155], v[64:79]
 s_waitcnt lgkmcnt(0)
 v_mfma_f32_32x32x16_bf16 v[64:79], v[60:63], a[156:159], v[64:79]
 s_lshl_b32 s3, s60, 19
 s_add_u32 s3, s3, s58
 s_xor_b32 s3, s3, s82
 s_add_u32 s3, s3, 33554432
 s_nop 8
 v_cvt_pk_bf16_f32 v88, v64, v65
 v_cvt_pk_bf16_f32 v89, v66, v67
 v_cvt_pk_bf16_f32 v90, v72, v73
 v_cvt_pk_bf16_f32 v91, v74, v75
 buffer_store_dwordx4 v[88:91], v4, s[4:7], s3 offen offset:0 sc1
 v_cvt_pk_bf16_f32 v92, v68, v69
 v_cvt_pk_bf16_f32 v93, v70, v71
 v_cvt_pk_bf16_f32 v94, v76, v77
 v_cvt_pk_bf16_f32 v95, v78, v79
 buffer_store_dwordx4 v[92:95], v4, s[4:7], s3 offen offset:512 sc1
 s_branch L_qkvv_mid
L_qkvv_loop:
 s_cmp_lg_u32 s54, 32
 s_cbranch_scc1 L_c2_101
 s_cmp_lg_u32 s50, 0
 s_cbranch_scc1 L_ww_102
 s_mov_b32 s96, s44
 s_and_b32 s97, s45, 0xffff
 s_mov_b32 s98, 256
 s_mov_b32 s99, 0x00020000
 v_mov_b32 v25, 140
 s_mov_b32 s51, 0
 s_mov_b64 exec, 1
L_wb_103:
 buffer_load_dword v26, v25, s[96:99], 0 offen sc1
 s_waitcnt vmcnt(0)
 v_cmp_eq_u32 vcc, 0, v26
 s_cbranch_vccz L_wbd_104
 s_sleep 2
 s_add_u32 s51, s51, 1
 s_cmp_lt_u32 s51, 131072
 s_cbranch_scc1 L_wb_103
 s_branch L_bail
L_wbd_104:
 s_mov_b64 exec, -1
L_ww_102:
 s_barrier
L_c2_101:
 s_sub_u32 s60, s54, 16
 s_mul_i32 s55, s60, 40960
 s_mul_i32 s3, s50, 10240
 s_add_u32 s55, s55, s3
 s_add_u32 s55, s55, 229113856
 s_add_u32 m0, s56, 40960
 s_add_u32 s3, s55, s64
 buffer_load_dwordx4 v1, s[4:7], s3 offen sc1 lds
 s_add_u32 m0, s56, 41984
 s_add_u32 s3, s55, s64
 buffer_load_dwordx4 v24, s[4:7], s3 offen sc1 lds
 s_add_u32 m0, s56, 49152
 s_add_u32 s3, s55, s65
 buffer_load_dwordx4 v1, s[4:7], s3 offen sc1 lds
 s_add_u32 m0, s56, 50176
 s_add_u32 s3, s55, s65
 buffer_load_dwordx4 v24, s[4:7], s3 offen sc1 lds
 s_add_u32 m0, s56, 57344
 s_add_u32 s3, s55, s66
 buffer_load_dwordx4 v1, s[4:7], s3 offen sc1 lds
 s_add_u32 m0, s56, 58368
 s_add_u32 s3, s55, s66
 buffer_load_dwordx4 v24, s[4:7], s3 offen sc1 lds
 s_add_u32 m0, s56, 65536
 s_add_u32 s3, s55, s67
 buffer_load_dwordx4 v1, s[4:7], s3 offen sc1 lds
 s_add_u32 m0, s56, 66560
 s_add_u32 s3, s55, s67
 buffer_load_dwordx4 v24, s[4:7], s3 offen sc1 lds
 s_add_u32 m0, s56, 73728
 s_add_u32 s3, s55, s68
 buffer_load_dwordx4 v1, s[4:7], s3 offen sc1 lds
 s_add_u32 m0, s56, 74752
 s_add_u32 s3, s55, s68
 buffer_load_dwordx4 v24, s[4:7], s3 offen sc1 lds
 s_lshl_b32 s70, s54, 2
 s_add_u32 s70, s70, s62
 s_sub_u32 s70, s70, 60
 s_cmp_lg_u32 s50, 0
 s_cselect_b32 s70, 268435456, s70
 s_min_u32 s51, s54, 63
 s_mul_i32 s55, s51, 40960
 s_mul_i32 s3, s50, 10240
 s_add_u32 s55, s55, s3
 s_add_u32 s55, s55, 226492416
 s_waitcnt vmcnt(8)
 s_barrier
 ds_read_b128 v[32:35], v16 offset:0
 ds_read_b128 v[36:39], v17 offset:0
 ds_read_b128 v[40:43], v18 offset:0
 ds_read_b128 v[44:47], v19 offset:0
 s_waitcnt lgkmcnt(3)
 v_mfma_f32_32x32x16_bf16 v[64:79], v[32:35], a[0:3], 0
 ds_read_b128 v[48:51], v20 offset:0
 s_add_u32 m0, s56, 0
 s_add_u32 s3, s55, s64
 buffer_load_dwordx4 v1, s[4:7], s3 offen sc1 lds
 s_waitcnt lgkmcnt(3)
 v_mfma_f32_32x32x16_bf16 v[64:79], v[36:39], a[4:7], v[64:79]
 ds_read_b128 v[52:55], v21 offset:0
 s_waitcnt lgkmcnt(3)
 v_mfma_f32_32x32x16_bf16 v[64:79], v[40:43], a[8:11], v[64:79]
 ds_read_b128 v[56:59], v22 offset:0
 s_waitcnt lgkmcnt(3)
 v_mfma_f32_32x32x16_bf16 v[64:79], v[44:47], a[12:15], v[64:79]
 ds_read_b128 v[60:63], v23 offset:0
 s_add_u32 m0, s56, 1024
 s_add_u32 s3, s55, s64
 buffer_load_dwordx4 v24, s[4:7], s3 offen sc1 lds
 s_waitcnt lgkmcnt(3)
 v_mfma_f32_32x32x16_bf16 v[64:79], v[48:51], a[16:19], v[64:79]
 s_waitcnt vmcnt(8)
 s_barrier
 ds_read_b128 v[32:35], v16 offset:8192
 s_waitcnt lgkmcnt(3)
 v_mfma_f32_32x32x16_bf16 v[64:79], v[52:55], a[20:23], v[64:79]
 ds_read_b128 v[36:39], v17 offset:8192
 s_waitcnt lgkmcnt(3)
 v_mfma_f32_32x32x16_bf16 v[64:79], v[56:59], a[24:27], v[64:79]
 ds_read_b128 v[40:43], v18 offset:8192
 s_add_u32 m0, s56, 8192
 s_add_u32 s3, s55, s65
 buffer_load_dwordx4 v1, s[4:7], s3 offen sc1 lds
 s_waitcnt lgkmcnt(3)
 v_mfma_f32_32x32x16_bf16 v[64:79], v[60:63], a[28:31], v[64:79]
 ds_read_b128 v[44:47], v19 offset:8192
 s_waitcnt lgkmcnt(3)
 v_mfma_f32_32x32x16_bf16 v[64:79], v[32:35], a[32:35], v[64:79]
 ds_read_b128 v[48:51], v20 offset:8192
 s_waitcnt lgkmcnt(3)
 v_mfma_f32_32x32x16_bf16 v[64:79], v[36:39], a[36:39], v[64:79]
 ds_read_b128 v[52:55], v21 offset:8192
 s_add_u32 m0, s56, 9216
 s_add_u32 s3, s55, s65
 buffer_load_dwordx4 v24, s[4:7], s3 offen sc1 lds
 s_waitcnt lgkmcnt(3)
 v_mfma_f32_32x32x16_bf16 v[64:79], v[40:43], a[40:43], v[64:79]
 ds_read_b128 v[56:59], v22 offset:8192
 s_waitcnt lgkmcnt(3)
 v_mfma_f32_32x32x16_bf16 v[64:79], v[44:47], a[44:47], v[64:79]
 ds_read_b128 v[60:63], v23 offset:8192
 s_waitcnt lgkmcnt(3)
 v_mfma_f32_32x32x16_bf16 v[64:79], v[48:51], a[48:51], v[64:79]
 s_waitcnt vmcnt(8)
 s_barrier
 ds_read_b128 v[32:35], v16 offset:16384
 s_add_u32 m0, s56, 16384
 s_add_u32 s3, s55, s66
 buffer_load_dwordx4 v1, s[4:7], s3 offen sc1 lds
 s_waitcnt lgkmcnt(3)
 v_mfma_f32_32x32x16_bf16 v[64:79], v[52:55], a[52:55], v[64:79]
 ds_read_b128 v[36:39], v17 offset:16384
 s_waitcnt lgkmcnt(3)
 v_mfma_f32_32x32x16_bf16 v[64:79], v[56:59], a[56:59], v[64:79]
 ds_read_b128 v[40:43], v18 offset:16384
 s_waitcnt lgkmcnt(3)
 v_mfma_f32_32x32x16_bf16 v[64:79], v[60:63], a[60:63], v[64:79]
 ds_read_b128 v[44:47], v19 offset:16384
 s_add_u32 m0, s56, 17408
 s_add_u32 s3, s55, s66
 buffer_load_dwordx4 v24, s[4:7], s3 offen sc1 lds
 s_waitcnt lgkmcnt(3)
 v_mfma_f32_32x32x16_bf16 v[64:79], v[32:35], a[64:67], v[64:79]
 ds_read_b128 v[48:51], v20 offset:16384
 s_waitcnt lgkmcnt(3)
 v_mfma_f32_32x32x16_bf16 v[64:79], v[36:39], a[68:71], v[64:79]
 ds_read_b128 v[52:55], v21 offset:16384
 s_waitcnt lgkmcnt(3)
 v_mfma_f32_32x32x16_bf16 v[64:79], v[40:43], a[72:75], v[64:79]
 ds_read_b128 v[56:59], v22 offset:16384
 s_add_u32 m0, s56, 24576
 s_add_u32 s3, s55, s67
 buffer_load_dwordx4 v1, s[4:7], s3 offen sc1 lds
 s_waitcnt lgkmcnt(3)
 v_mfma_f32_32x32x16_bf16 v[64:79], v[44:47], a[76:79], v[64:79]
 ds_read_b128 v[60:63], v23 offset:16384
 s_waitcnt lgkmcnt(3)
 v_mfma_f32_32x32x16_bf16 v[64:79], v[48:51], a[80:83], v[64:79]
 s_waitcnt vmcnt(9)
 s_barrier
 ds_read_b128 v[32:35], v16 offset:24576
 s_waitcnt lgkmcnt(3)
 v_mfma_f32_32x32x16_bf16 v[64:79], v[52:55], a[84:87], v[64:79]
 ds_read_b128 v[36:39], v17 offset:24576
 s_add_u32 m0, s56, 25600
 s_add_u32 s3, s55, s67
 buffer_load_dwordx4 v24, s[4:7], s3 offen sc1 lds
 s_waitcnt lgkmcnt(3)
 v_mfma_f32_32x32x16_bf16 v[64:79], v[56:59], a[88:91], v[64:79]
 ds_read_b128 v[40:43], v18 offset:24576
 s_waitcnt lgkmcnt(3)
 v_mfma_f32_32x32x16_bf16 v[64:79], v[60:63], a[92:95], v[64:79]
 ds_read_b128 v[44:47], v19 offset:24576
 s_waitcnt lgkmcnt(3)
 v_mfma_f32_32x32x16_bf16 v[64:79], v[32:35], a[96:99], v[64:79]
 ds_read_b128 v[48:51], v20 offset:24576
 s_add_u32 m0, s56, 32768
 s_add_u32 s3, s55, s68
 buffer_load_dwordx4 v1, s[4:7], s3 offen sc1 lds
 s_waitcnt lgkmcnt(3)
 v_mfma_f32_32x32x16_bf16 v[64:79], v[36:39], a[100:103], v[64:79]
 ds_read_b128 v[52:55], v21 offset:24576
 s_waitcnt lgkmcnt(3)
 v_mfma_f32_32x32x16_bf16 v[64:79], v[40:43], a[104:107], v[64:79]
 ds_read_b128 v[56:59], v22 offset:24576
 s_waitcnt lgkmcnt(3)
 v_mfma_f32_32x32x16_bf16 v[64:79], v[44:47], a[108:111], v[64:79]
 ds_read_b128 v[60:63], v23 offset:24576
 s_add_u32 m0, s56, 33792
 s_add_u32 s3, s55, s68
 buffer_load_dwordx4 v24, s[4:7], s3 offen sc1 lds
 s_waitcnt lgkmcnt(3)
 v_mfma_f32_32x32x16_bf16 v[64:79], v[48:51], a[112:115], v[64:79]
 s_waitcnt vmcnt(10)
 s_barrier
 ds_read_b128 v[32:35], v16 offset:32768
 s_waitcnt lgkmcnt(3)
 v_mfma_f32_32x32x16_bf16 v[64:79], v[52:55], a[116:119], v[64:79]
 ds_read_b128 v[36:39], v17 offset:32768
 v_mov_b32 v6, 8
 s_mov_b64 exec, 15
 v_mov_b32 v6, 0
 buffer_atomic_add v6, v5, s[4:7], s70 offen sc0
 s_mov_b64 exec, -1
 s_waitcnt lgkmcnt(3)
 v_mfma_f32_32x32x16_bf16 v[64:79], v[56:59], a[120:123], v[64:79]
 ds_read_b128 v[40:43], v18 offset:32768
 s_waitcnt lgkmcnt(3)
 v_mfma_f32_32x32x16_bf16 v[64:79], v[60:63], a[124:127], v[64:79]
 ds_read_b128 v[44:47], v19 offset:32768
 s_waitcnt lgkmcnt(3)
 v_mfma_f32_32x32x16_bf16 v[64:79], v[32:35], a[128:131], v[64:79]
 ds_read_b128 v[48:51], v20 offset:32768
 s_waitcnt lgkmcnt(3)
 v_mfma_f32_32x32x16_bf16 v[64:79], v[36:39], a[132:135], v[64:79]
 ds_read_b128 v[52:55], v21 offset:32768
 s_waitcnt lgkmcnt(3)
 v_mfma_f32_32x32x16_bf16 v[64:79], v[40:43], a[136:139], v[64:79]
 ds_read_b128 v[56:59], v22 offset:32768
 s_waitcnt lgkmcnt(3)
 v_mfma_f32_32x32x16_bf16 v[64:79], v[44:47], a[140:143], v[64:79]
 ds_read_b128 v[60:63], v23 offset:32768
 s_waitcnt lgkmcnt(3)
 v_mfma_f32_32x32x16_bf16 v[64:79], v[48:51], a[144:147], v[64:79]
 s_waitcnt lgkmcnt(2)
 v_mfma_f32_32x32x16_bf16 v[64:79], v[52:55], a[148:151], v[64:79]
 s_waitcnt lgkmcnt(1)
 v_mfma_f32_32x32x16_bf16 v[64:79], v[56:59], a[152:155], v[64:79]
 s_waitcnt lgkmcnt(0)
 v_mfma_f32_32x32x16_bf16 v[64:79], v[60:63], a[156:159], v[64:79]
 s_lshl_b32 s3, s60, 19
 s_add_u32 s3, s3, s58
 s_xor_b32 s3, s3, s82
 s_add_u32 s3, s3, 33554432
 s_nop 8
 v_cvt_pk_bf16_f32 v88, v64, v65
 v_cvt_pk_bf16_f32 v89, v66, v67
 v_cvt_pk_bf16_f32 v90, v72, v73
 v_cvt_pk_bf16_f32 v91, v74, v75
 buffer_store_dwordx4 v[88:91], v4, s[4:7], s3 offen offset:0 sc1
 v_cvt_pk_bf16_f32 v92, v68, v69
 v_cvt_pk_bf16_f32 v93, v70, v71
 v_cvt_pk_bf16_f32 v94, v76, v77
 v_cvt_pk_bf16_f32 v95, v78, v79
 buffer_store_dwordx4 v[92:95], v4, s[4:7], s3 offen offset:512 sc1
L_qkvv_mid:
 s_cmp_ge_u32 s54, 64
 s_cbranch_scc1 L_n0_96
 s_waitcnt vmcnt(2)
 s_cmp_lg_u32 s50, 0
 s_cbranch_scc1 L_w_105
 v_cmp_gt_u32 vcc, 8, v6
 s_nop 1
 v_mov_b32 v3, vcc_lo
 ds_write_b32 v7, v3
 s_waitcnt lgkmcnt(0)
L_w_105:
 s_barrier
 ds_read_b32 v3, v7
 s_waitcnt lgkmcnt(0)
 v_readfirstlane_b32 s3, v3
 s_mov_b32 s69, s3
 s_add_u32 s51, s60, 1
 s_mov_b32 s60, s54
 s_mul_i32 s55, s51, 40960
 s_mul_i32 s3, s50, 10240
 s_add_u32 s55, s55, s3
 s_add_u32 s55, s55, 229113856
 s_cmp_eq_u32 s69, 0
 s_cselect_b32 s55, s55, 268435456
 ds_read_b128 v[32:35], v8 offset:0
 ds_read_b128 v[36:39], v9 offset:0
 ds_read_b128 v[40:43], v10 offset:0
 ds_read_b128 v[44:47], v11 offset:0
 s_waitcnt lgkmcnt(3)
 v_mfma_f32_32x32x16_bf16 v[64:79], v[32:35], a[0:3], 0
 ds_read_b128 v[48:51], v12 offset:0
 s_add_u32 m0, s56, 40960
 s_add_u32 s3, s55, s64
 buffer_load_dwordx4 v1, s[4:7], s3 offen sc1 lds
 s_waitcnt lgkmcnt(3)
 v_mfma_f32_32x32x16_bf16 v[64:79], v[36:39], a[4:7], v[64:79]
 ds_read_b128 v[52:55], v13 offset:0
 s_waitcnt lgkmcnt(3)
 v_mfma_f32_32x32x16_bf16 v[64:79], v[40:43], a[8:11], v[64:79]
 ds_read_b128 v[56:59], v14 offset:0
 s_waitcnt lgkmcnt(3)
 v_mfma_f32_32x32x16_bf16 v[64:79], v[44:47], a[12:15], v[64:79]
 ds_read_b128 v[60:63], v15 offset:0
 s_add_u32 m0, s56, 41984
 s_add_u32 s3, s55, s64
 buffer_load_dwordx4 v24, s[4:7], s3 offen sc1 lds
 s_waitcnt lgkmcnt(3)
 v_mfma_f32_32x32x16_bf16 v[64:79], v[48:51], a[16:19], v[64:79]
 ds_read_b128 v[32:35], v8 offset:8192
 s_waitcnt lgkmcnt(3)
 v_mfma_f32_32x32x16_bf16 v[64:79], v[52:55], a[20:23], v[64:79]
 ds_read_b128 v[36:39], v9 offset:8192
 s_waitcnt lgkmcnt(3)
 v_mfma_f32_32x32x16_bf16 v[64:79], v[56:59], a[24:27], v[64:79]
 ds_read_b128 v[40:43], v10 offset:8192
 s_add_u32 m0, s56, 49152
 s_add_u32 s3, s55, s65
 buffer_load_dwordx4 v1, s[4:7], s3 offen sc1 lds
 s_waitcnt lgkmcnt(3)
 v_mfma_f32_32x32x16_bf16 v[64:79], v[60:63], a[28:31], v[64:79]
 ds_read_b128 v[44:47], v11 offset:8192
 s_waitcnt lgkmcnt(3)
 v_mfma_f32_32x32x16_bf16 v[64:79], v[32:35], a[32:35], v[64:79]
 ds_read_b128 v[48:51], v12 offset:8192
 s_waitcnt lgkmcnt(3)
 v_mfma_f32_32x32x16_bf16 v[64:79], v[36:39], a[36:39], v[64:79]
 ds_read_b128 v[52:55], v13 offset:8192
 s_add_u32 m0, s56, 50176
 s_add_u32 s3, s55, s65
 buffer_load_dwordx4 v24, s[4:7], s3 offen sc1 lds
 s_waitcnt lgkmcnt(3)
 v_mfma_f32_32x32x16_bf16 v[64:79], v[40:43], a[40:43], v[64:79]
 ds_read_b128 v[56:59], v14 offset:8192
 s_waitcnt lgkmcnt(3)
 v_mfma_f32_32x32x16_bf16 v[64:79], v[44:47], a[44:47], v[64:79]
 ds_read_b128 v[60:63], v15 offset:8192
 s_waitcnt lgkmcnt(3)
 v_mfma_f32_32x32x16_bf16 v[64:79], v[48:51], a[48:51], v[64:79]
 ds_read_b128 v[32:35], v8 offset:16384
 s_add_u32 m0, s56, 57344
 s_add_u32 s3, s55, s66
 buffer_load_dwordx4 v1, s[4:7], s3 offen sc1 lds
 s_waitcnt lgkmcnt(3)
 v_mfma_f32_32x32x16_bf16 v[64:79], v[52:55], a[52:55], v[64:79]
 ds_read_b128 v[36:39], v9 offset:16384
 s_waitcnt lgkmcnt(3)
 v_mfma_f32_32x32x16_bf16 v[64:79], v[56:59], a[56:59], v[64:79]
 ds_read_b128 v[40:43], v10 offset:16384
 s_waitcnt lgkmcnt(3)
 v_mfma_f32_32x32x16_bf16 v[64:79], v[60:63], a[60:63], v[64:79]
 ds_read_b128 v[44:47], v11 offset:16384
 s_add_u32 m0, s56, 58368
 s_add_u32 s3, s55, s66
 buffer_load_dwordx4 v24, s[4:7], s3 offen sc1 lds
 s_waitcnt lgkmcnt(3)
 v_mfma_f32_32x32x16_bf16 v[64:79], v[32:35], a[64:67], v[64:79]
 ds_read_b128 v[48:51], v12 offset:16384
 s_waitcnt lgkmcnt(3)
 v_mfma_f32_32x32x16_bf16 v[64:79], v[36:39], a[68:71], v[64:79]
 ds_read_b128 v[52:55], v13 offset:16384
 s_waitcnt vmcnt(6)
 s_lshl_b32 s3, s54, 2
 s_add_u32 s3, s3, s63
 v_mov_b32 v3, 1
 s_mov_b64 exec, s[78:79]
 buffer_atomic_add v3, v30, s[4:7], s3 offen
 s_mov_b64 exec, -1
 s_cmp_eq_u32 s61, 0
 s_cbranch_scc1 L_pf_106
 s_lshl_b32 s3, s61, 2
 s_add_u32 s3, s3, s59
 s_sub_u32 s3, s3, 4
 v_mov_b32 v3, 1
 s_mov_b64 exec, s[78:79]
 buffer_atomic_add v3, v30, s[4:7], s3 offen
 s_mov_b64 exec, -1
 s_mov_b32 s61, 0
L_pf_106:
 s_waitcnt lgkmcnt(3)
 v_mfma_f32_32x32x16_bf16 v[64:79], v[40:43], a[72:75], v[64:79]
 ds_read_b128 v[56:59], v14 offset:16384
 s_add_u32 m0, s56, 65536
 s_add_u32 s3, s55, s67
 buffer_load_dwordx4 v1, s[4:7], s3 offen sc1 lds
 s_waitcnt lgkmcnt(3)
 v_mfma_f32_32x32x16_bf16 v[64:79], v[44:47], a[76:79], v[64:79]
 ds_read_b128 v[60:63], v15 offset:16384
 s_waitcnt lgkmcnt(3)
 v_mfma_f32_32x32x16_bf16 v[64:79], v[48:51], a[80:83], v[64:79]
 ds_read_b128 v[32:35], v8 offset:24576
 s_waitcnt lgkmcnt(3)
 v_mfma_f32_32x32x16_bf16 v[64:79], v[52:55], a[84:87], v[64:79]
 ds_read_b128 v[36:39], v9 offset:24576
 s_add_u32 m0, s56, 66560
 s_add_u32 s3, s55, s67
 buffer_load_dwordx4 v24, s[4:7], s3 offen sc1 lds
 s_waitcnt lgkmcnt(3)
 v_mfma_f32_32x32x16_bf16 v[64:79], v[56:59], a[88:91], v[64:79]
 ds_read_b128 v[40:43], v10 offset:24576
 s_waitcnt lgkmcnt(3)
 v_mfma_f32_32x32x16_bf16 v[64:79], v[60:63], a[92:95], v[64:79]
 ds_read_b128 v[44:47], v11 offset:24576
 s_waitcnt lgkmcnt(3)
 v_mfma_f32_32x32x16_bf16 v[64:79], v[32:35], a[96:99], v[64:79]
 ds_read_b128 v[48:51], v12 offset:24576
 s_add_u32 m0, s56, 73728
 s_add_u32 s3, s55, s68
 buffer_load_dwordx4 v1, s[4:7], s3 offen sc1 lds
 s_waitcnt lgkmcnt(3)
 v_mfma_f32_32x32x16_bf16 v[64:79], v[36:39], a[100:103], v[64:79]
 ds_read_b128 v[52:55], v13 offset:24576
 s_waitcnt lgkmcnt(3)
 v_mfma_f32_32x32x16_bf16 v[64:79], v[40:43], a[104:107], v[64:79]
 ds_read_b128 v[56:59], v14 offset:24576
 s_waitcnt lgkmcnt(3)
 v_mfma_f32_32x32x16_bf16 v[64:79], v[44:47], a[108:111], v[64:79]
 ds_read_b128 v[60:63], v15 offset:24576
 s_add_u32 m0, s56, 74752
 s_add_u32 s3, s55, s68
 buffer_load_dwordx4 v24, s[4:7], s3 offen sc1 lds
 v_mov_b32 v6, 8
 s_mov_b64 exec, 15
 v_mov_b32 v6, 0
 buffer_atomic_add v6, v5, s[4:7], s70 offen sc0
 s_mov_b64 exec, -1
 s_waitcnt lgkmcnt(3)
 v_mfma_f32_32x32x16_bf16 v[64:79], v[48:51], a[112:115], v[64:79]
 ds_read_b128 v[32:35], v8 offset:32768
 s_waitcnt lgkmcnt(3)
 v_mfma_f32_32x32x16_bf16 v[64:79], v[52:55], a[116:119], v[64:79]
 ds_read_b128 v[36:39], v9 offset:32768
 s_waitcnt lgkmcnt(3)
 v_mfma_f32_32x32x16_bf16 v[64:79], v[56:59], a[120:123], v[64:79]
 ds_read_b128 v[40:43], v10 offset:32768
 s_waitcnt lgkmcnt(3)
 v_mfma_f32_32x32x16_bf16 v[64:79], v[60:63], a[124:127], v[64:79]
 ds_read_b128 v[44:47], v11 offset:32768
 s_waitcnt lgkmcnt(3)
 v_mfma_f32_32x32x16_bf16 v[64:79], v[32:35], a[128:131], v[64:79]
 ds_read_b128 v[48:51], v12 offset:32768
 s_waitcnt lgkmcnt(3)
 v_mfma_f32_32x32x16_bf16 v[64:79], v[36:39], a[132:135], v[64:79]
 ds_read_b128 v[52:55], v13 offset:32768
 s_waitcnt lgkmcnt(3)
 v_mfma_f32_32x32x16_bf16 v[64:79], v[40:43], a[136:139], v[64:79]
 ds_read_b128 v[56:59], v14 offset:32768
 s_waitcnt lgkmcnt(3)
 v_mfma_f32_32x32x16_bf16 v[64:79], v[44:47], a[140:143], v[64:79]
 ds_read_b128 v[60:63], v15 offset:32768
 s_waitcnt lgkmcnt(3)
 v_mfma_f32_32x32x16_bf16 v[64:79], v[48:51], a[144:147], v[64:79]
 s_waitcnt lgkmcnt(2)
 v_mfma_f32_32x32x16_bf16 v[64:79], v[52:55], a[148:151], v[64:79]
 s_waitcnt lgkmcnt(1)
 v_mfma_f32_32x32x16_bf16 v[64:79], v[56:59], a[152:155], v[64:79]
 s_waitcnt lgkmcnt(0)
 v_mfma_f32_32x32x16_bf16 v[64:79], v[60:63], a[156:159], v[64:79]
 s_lshl_b32 s3, s60, 19
 s_add_u32 s3, s3, s58
 s_xor_b32 s3, s3, s82
 s_nop 8
 v_cvt_pk_bf16_f32 v80, v64, v65
 v_cvt_pk_bf16_f32 v81, v66, v67
 v_cvt_pk_bf16_f32 v82, v72, v73
 v_cvt_pk_bf16_f32 v83, v74, v75
 buffer_store_dwordx4 v[80:83], v4, s[4:7], s3 offen offset:0 sc1
 v_cvt_pk_bf16_f32 v84, v68, v69
 v_cvt_pk_bf16_f32 v85, v70, v71
 v_cvt_pk_bf16_f32 v86, v76, v77
 v_cvt_pk_bf16_f32 v87, v78, v79
 buffer_store_dwordx4 v[84:87], v4, s[4:7], s3 offen offset:512 sc1
 s_add_u32 s54, s54, 1
 s_mov_b32 s61, s54
 s_waitcnt vmcnt(2)
 s_cmp_lg_u32 s50, 0
 s_cbranch_scc1 L_w_107
 v_cmp_gt_u32 vcc, 8, v6
 s_nop 1
 v_mov_b32 v3, vcc_lo
 ds_write_b32 v7, v3
 s_waitcnt lgkmcnt(0)
L_w_107:
 s_barrier
 ds_read_b32 v3, v7
 s_waitcnt lgkmcnt(0)
 v_readfirstlane_b32 s3, v3
 s_cmp_eq_u32 s69, 0
 s_cbranch_scc1 L_qkvv_fast
 s_cmp_eq_u32 s3, 0
 s_cbranch_scc1 L_qkvv_loop
 s_branch L_qkvv_block
L_n0_96:
 s_waitcnt vmcnt(0)
 s_lshl_b32 s3, s54, 2
 s_add_u32 s3, s3, s63
 v_mov_b32 v3, 1
 s_mov_b64 exec, s[78:79]
 buffer_atomic_add v3, v30, s[4:7], s3 offen
 s_mov_b64 exec, -1
 s_add_u32 s54, s54, 1
 s_cmp_lt_u32 s54, 80
 s_cbranch_scc1 L_qkvv_block
 s_endpgm
L_att:
 s_mul_i32 s3, s50, 24
 s_add_u32 s3, s3, s82
 s_sub_u32 s3, s3, 72
 s_cmp_lt_u32 s3, 64
 s_cbranch_scc1 L_att_go
 s_mov_b32 s60, s3
 s_mul_i32 s71, s50, 13312
 s_mov_b32 s70, s60
 s_mov_b32 s69, 96
 s_mov_b32 s96, s44
 s_and_b32 s97, s45, 0xffff
 s_mov_b32 s98, 256
 s_mov_b32 s99, 0x00020000
 v_mov_b32 v1, 196
 s_mov_b32 s51, 0
 s_mov_b64 exec, 1
L_wb_108:
 buffer_load_dword v2, v1, s[96:99], 0 offen sc1
 s_waitcnt vmcnt(0)
 v_cmp_eq_u32 vcc, 0, v2
 s_cbranch_vccz L_wbd_109
 s_sleep 2
 s_add_u32 s51, s51, 1
 s_cmp_lt_u32 s51, 131072
 s_cbranch_scc1 L_wb_108
 s_branch L_bail
L_wbd_109:
 s_mov_b64 exec, -1
 s_mov_b32 s96, s44
 s_and_b32 s97, s45, 0xffff
 s_mov_b32 s98, 256
 s_mov_b32 s99, 0x00020000
 v_mov_b32 v1, 208
 s_mov_b32 s51, 0
 s_mov_b64 exec, 1
L_wb_110:
 buffer_load_dword v2, v1, s[96:99], 0 offen sc1
 s_waitcnt vmcnt(0)
 v_cmp_eq_u32 vcc, 0, v2
 s_cbranch_vccz L_wbd_111
 s_sleep 2
 s_add_u32 s51, s51, 1
 s_cmp_lt_u32 s51, 131072
 s_cbranch_scc1 L_wb_110
 s_branch L_bail
L_wbd_111:
 s_mov_b64 exec, -1
 s_mov_b32 s8, s38
 s_and_b32 s9, s39, 0xffff
 s_mov_b32 s10, 2621440
 s_mov_b32 s11, 0x00020000
 s_mov_b32 s12, s40
 s_and_b32 s13, s41, 0xffff
 s_mov_b32 s14, 1280
 s_mov_b32 s15, 0x00020000
 v_lshlrev_b32 v130, 4, v0
 s_lshl_b32 s73, s70, 12
 s_add_u32 s74, s73, 2
 buffer_load_dwordx4 v[96:99], v130, s[8:11], s73 offen offset:0
 buffer_load_dwordx4 v[100:103], v130, s[8:11], s73 offen offset:1024
 buffer_load_dwordx4 v[104:107], v130, s[8:11], s73 offen offset:2048
 buffer_load_dwordx4 v[108:111], v130, s[8:11], s73 offen offset:3072
 buffer_load_dwordx4 v[112:115], v130, s[8:11], s74 offen offset:0
 buffer_load_dwordx4 v[116:119], v130, s[8:11], s74 offen offset:1024
 buffer_load_dwordx4 v[120:123], v130, s[8:11], s74 offen offset:2048
 buffer_load_dwordx4 v[124:127], v130, s[8:11], s74 offen offset:3072
 s_lshl_b32 s3, s70, 1
 buffer_load_ushort v128, off, s[12:15], s3
 s_lshl_b32 s3, s70, 12
 s_add_u32 s3, s3, 231735296
 buffer_load_dwordx4 v[240:243], v130, s[4:7], s3 offen offset:0 sc1
 buffer_load_dwordx4 v[244:247], v130, s[4:7], s3 offen offset:1024 sc1
 buffer_load_dwordx4 v[248:251], v130, s[4:7], s3 offen offset:2048 sc1
 buffer_load_dwordx4 v[252:255], v130, s[4:7], s3 offen offset:3072 sc1
 s_getpc_b64 s[76:77]
L_ca_112:
 s_add_u32 s76, s76, L_conv1-L_ca_112
 s_addc_u32 s77, s77, -1
 s_swappc_b64 s[76:77], s[76:77]
 s_waitcnt vmcnt(0)
 s_mov_b32 s96, s44
 s_and_b32 s97, s45, 0xffff
 s_mov_b32 s98, 256
 s_mov_b32 s99, 0x00020000
 v_mov_b32 v1, 1
 s_mov_b64 exec, 1
 buffer_atomic_add v1, off, s[96:99], 0 offset:76 sc0
 s_waitcnt vmcnt(0)
 v_cmp_eq_u32 vcc, 95, v1
 s_cbranch_vccz L_aw_113
 buffer_store_dword v1, off, s[96:99], 0 offset:204 sc1
L_aw_113:
 s_mov_b64 exec, -1
 s_endpgm
L_att_go:
 s_and_b32 s53, s3, 1
 s_lshr_b32 s52, s3, 1
 v_lshlrev_b32 v1, 4, v0
 v_add_u32 v2, 4096, v1
 v_mov_b32 v5, 0
 v_lshlrev_b32 v30, 3, v0
 v_and_b32 v6, 0x1e0, v30
 v_and_b32 v3, 16, v1
 v_add_u32 v6, v6, v3
 s_lshl_b32 s3, s53, 5
 s_add_u32 s3, s3, s52
 s_lshl_b32 s61, s3, 8
 s_add_u32 s61, s61, 24576
 s_lshl_b32 s66, s3, 7
 s_add_u32 s66, s66, 0
 s_lshl_b32 s57, s53, 11
 s_add_u32 s57, s57, s52
 s_and_b32 s100, s57, 1
 s_lshl_b32 s100, s100, 13
 s_lshl_b32 s57, s57, 14
 s_add_u32 s57, s57, s100
 s_add_u32 s57, s57, 8388608
 s_mul_i32 s58, s53, 524288
 s_lshl_b32 s3, s52, 12
 s_add_u32 s58, s58, s3
 s_add_u32 s58, s58, 1114112
 s_add_u32 s59, s57, 67108864
 s_lshl_b32 s60, s53, 8
 s_add_u32 s60, s60, 40960
 s_lshr_b32 s3, s52, 2
 s_mul_i32 s3, s3, 2560
 v_lshl_add_u32 v31, v0, 9, s3
 v_mov_b32 v208, -1
 v_mov_b32 v209, -1
 v_mov_b32 v210, -1
 v_mov_b32 v211, -1
 v_lshrrev_b32 v3, 4, v0
 v_lshlrev_b32 v7, 9, v3
 v_and_b32 v4, 15, v0
 v_lshl_add_u32 v7, v4, 4, v7
 v_mov_b32 v88, 0xff61b1e6
 v_lshlrev_b32 v3, 2, v3
 v_add_u32 v89, 0, v3
 v_cmp_gt_u32 vcc, v89, v4
 s_nop 1
 v_cndmask_b32 v12, 0, v88, vcc
 v_add_u32 v89, 1, v3
 v_cmp_gt_u32 vcc, v89, v4
 s_nop 1
 v_cndmask_b32 v13, 0, v88, vcc
 v_add_u32 v89, 2, v3
 v_cmp_gt_u32 vcc, v89, v4
 s_nop 1
 v_cndmask_b32 v14, 0, v88, vcc
 v_add_u32 v89, 3, v3
 v_cmp_gt_u32 vcc, v89, v4
 s_nop 1
 v_cndmask_b32 v15, 0, v88, vcc
 v_mov_b32 v152, 0
 v_mov_b32 v153, 0
 v_mov_b32 v154, 0
 v_mov_b32 v155, 0
 v_mov_b32 v156, 0
 v_mov_b32 v157, 0
 v_mov_b32 v158, 0
 v_mov_b32 v159, 0
 v_mov_b32 v160, 0
 v_mov_b32 v161, 0
 v_mov_b32 v162, 0
 v_mov_b32 v163, 0
 v_mov_b32 v164, 0
 v_mov_b32 v165, 0
 v_mov_b32 v166, 0
 v_mov_b32 v167, 0
 v_mov_b32 v168, 0
 v_mov_b32 v169, 0
 v_mov_b32 v170, 0
 v_mov_b32 v171, 0
 v_mov_b32 v172, 0
 v_mov_b32 v173, 0
 v_mov_b32 v174, 0
 v_mov_b32 v175, 0
 s_mov_b32 s62, 0x3db504f3
 s_mov_b32 s63, 0x3fb8aa3b
 s_mov_b32 s54, 0
 s_mov_b32 s51, 0
 s_mov_b64 exec, 1
L_wc_114:
 v_mov_b32 v3, 0
 buffer_atomic_add v3, v5, s[4:7], s61 offen sc0
 s_waitcnt vmcnt(0)
 v_cmp_gt_u32 vcc, 12, v3
 s_cbranch_vccz L_wcd_115
 s_sleep 16
 s_add_u32 s51, s51, 1
 s_cmp_lt_u32 s51, 131072
 s_cbranch_scc1 L_wc_114
 s_branch L_bail
L_wcd_115:
 s_mov_b64 exec, -1
 s_lshl_b32 s56, s54, 19
 s_add_u32 s56, s56, s57
 s_cmp_lt_u32 s54, 64
 s_cselect_b32 s56, s56, 268435456
 s_xor_b32 s3, s56, 8192
 buffer_load_dwordx4 a[0:3], v1, s[4:7], s3 offen offset:0 sc1
 buffer_load_dwordx4 a[4:7], v1, s[4:7], s3 offen offset:1024 sc1
 buffer_load_dwordx4 a[8:11], v1, s[4:7], s3 offen offset:2048 sc1
 buffer_load_dwordx4 a[12:15], v1, s[4:7], s3 offen offset:3072 sc1
 buffer_load_dwordx4 a[16:19], v2, s[4:7], s3 offen offset:0 sc1
 buffer_load_dwordx4 a[20:23], v2, s[4:7], s3 offen offset:1024 sc1
 buffer_load_dwordx4 a[24:27], v2, s[4:7], s3 offen offset:2048 sc1
 buffer_load_dwordx4 a[28:31], v2, s[4:7], s3 offen offset:3072 sc1
 s_mov_b32 s3, s56
 buffer_load_dwordx4 a[32:35], v1, s[4:7], s3 offen offset:0 sc1
 buffer_load_dwordx4 a[36:39], v1, s[4:7], s3 offen offset:1024 sc1
 buffer_load_dwordx4 a[40:43], v1, s[4:7], s3 offen offset:2048 sc1
 buffer_load_dwordx4 a[44:47], v1, s[4:7], s3 offen offset:3072 sc1
 buffer_load_dwordx4 a[48:51], v2, s[4:7], s3 offen offset:0 sc1
 buffer_load_dwordx4 a[52:55], v2, s[4:7], s3 offen offset:1024 sc1
 buffer_load_dwordx4 a[56:59], v2, s[4:7], s3 offen offset:2048 sc1
 buffer_load_dwordx4 a[60:63], v2, s[4:7], s3 offen offset:3072 sc1
 s_add_u32 s3, s56, 67108864
 buffer_load_dwordx4 a[64:67], v1, s[4:7], s3 offen offset:0 sc1
 buffer_load_dwordx4 a[68:71], v1, s[4:7], s3 offen offset:1024 sc1
 buffer_load_dwordx4 a[72:75], v1, s[4:7], s3 offen offset:2048 sc1
 buffer_load_dwordx4 a[76:79], v1, s[4:7], s3 offen offset:3072 sc1
 buffer_load_dwordx4 a[80:83], v2, s[4:7], s3 offen offset:0 sc1
 buffer_load_dwordx4 a[84:87], v2, s[4:7], s3 offen offset:1024 sc1
 buffer_load_dwordx4 a[88:91], v2, s[4:7], s3 offen offset:2048 sc1
 buffer_load_dwordx4 a[92:95], v2, s[4:7], s3 offen offset:3072 sc1
L_att_loop:
 s_and_b32 s3, s54, 3
 s_lshl_b32 s65, s3, 17
 s_add_u32 s65, s65, s58
 buffer_load_dwordx4 v[32:35], v6, s[4:7], s65 offen offset:0 sc1
 buffer_load_dwordx4 v[36:39], v6, s[4:7], s65 offen offset:512 sc1
 buffer_load_dwordx4 v[40:43], v6, s[4:7], s65 offen offset:1024 sc1
 buffer_load_dwordx4 v[44:47], v6, s[4:7], s65 offen offset:1536 sc1
 buffer_load_dwordx2 v[48:49], v30, s[4:7], s65 offen offset:2048 sc1
 buffer_load_dwordx2 v[50:51], v30, s[4:7], s65 offen offset:2560 sc1
 buffer_load_dwordx2 v[52:53], v30, s[4:7], s65 offen offset:3072 sc1
 buffer_load_dwordx2 v[54:55], v30, s[4:7], s65 offen offset:3584 sc1
 s_lshl_b32 s55, s54, 19
 s_add_u32 s55, s55, s59
 s_xor_b32 s55, s55, 8192
 s_waitcnt vmcnt(16)
 v_mfma_f32_16x16x32_bf16 v[68:71], a[32:35], a[0:3], v[12:15]
 v_mfma_f32_16x16x32_bf16 v[68:71], a[36:39], a[4:7], v[68:71]
 v_mfma_f32_16x16x32_bf16 v[68:71], a[40:43], a[8:11], v[68:71]
 v_mfma_f32_16x16x32_bf16 v[68:71], a[44:47], a[12:15], v[68:71]
 v_mfma_f32_16x16x32_bf16 v[80:83], a[32:35], a[16:19], 0
 v_mfma_f32_16x16x32_bf16 v[80:83], a[36:39], a[20:23], v[80:83]
 v_mfma_f32_16x16x32_bf16 v[80:83], a[40:43], a[24:27], v[80:83]
 v_mfma_f32_16x16x32_bf16 v[80:83], a[44:47], a[28:31], v[80:83]
 v_mfma_f32_16x16x32_bf16 v[84:87], a[48:51], a[16:19], v[12:15]
 v_mfma_f32_16x16x32_bf16 v[84:87], a[52:55], a[20:23], v[84:87]
 v_mfma_f32_16x16x32_bf16 v[84:87], a[56:59], a[24:27], v[84:87]
 v_mfma_f32_16x16x32_bf16 v[84:87], a[60:63], a[28:31], v[84:87]
 s_nop 7
 v_cvt_pk_bf16_f32 v3, v68, v69
 v_lshlrev_b32 v68, 16, v3
 v_and_b32 v69, 0xffff0000, v3
 v_cvt_pk_bf16_f32 v3, v70, v71
 v_lshlrev_b32 v70, 16, v3
 v_and_b32 v71, 0xffff0000, v3
 v_cvt_pk_bf16_f32 v3, v80, v81
 v_lshlrev_b32 v80, 16, v3
 v_and_b32 v81, 0xffff0000, v3
 v_cvt_pk_bf16_f32 v3, v82, v83
 v_lshlrev_b32 v82, 16, v3
 v_and_b32 v83, 0xffff0000, v3
 v_cvt_pk_bf16_f32 v3, v84, v85
 v_lshlrev_b32 v84, 16, v3
 v_and_b32 v85, 0xffff0000, v3
 v_cvt_pk_bf16_f32 v3, v86, v87
 v_lshlrev_b32 v86, 16, v3
 v_and_b32 v87, 0xffff0000, v3
 v_mul_f32 v68, s62, v68
 v_mul_f32 v69, s62, v69
 v_mul_f32 v70, s62, v70
 v_mul_f32 v71, s62, v71
 v_mul_f32 v80, s62, v80
 v_mul_f32 v81, s62, v81
 v_mul_f32 v82, s62, v82
 v_mul_f32 v83, s62, v83
 v_mul_f32 v84, s62, v84
 v_mul_f32 v85, s62, v85
 v_mul_f32 v86, s62, v86
 v_mul_f32 v87, s62, v87
 v_cvt_pk_bf16_f32 v3, v68, v69
 v_lshlrev_b32 v68, 16, v3
 v_and_b32 v69, 0xffff0000, v3
 v_cvt_pk_bf16_f32 v3, v70, v71
 v_lshlrev_b32 v70, 16, v3
 v_and_b32 v71, 0xffff0000, v3
 v_cvt_pk_bf16_f32 v3, v80, v81
 v_lshlrev_b32 v80, 16, v3
 v_and_b32 v81, 0xffff0000, v3
 v_cvt_pk_bf16_f32 v3, v82, v83
 v_lshlrev_b32 v82, 16, v3
 v_and_b32 v83, 0xffff0000, v3
 v_cvt_pk_bf16_f32 v3, v84, v85
 v_lshlrev_b32 v84, 16, v3
 v_and_b32 v85, 0xffff0000, v3
 v_cvt_pk_bf16_f32 v3, v86, v87
 v_lshlrev_b32 v86, 16, v3
 v_and_b32 v87, 0xffff0000, v3
 v_max3_f32 v16, v68, v69, v70
 v_max_f32 v16, v16, v71
 v_max3_f32 v17, v80, v81, v82
 v_max3_f32 v17, v17, v83, v84
 v_max3_f32 v17, v17, v85, v86
 v_max_f32 v17, v17, v87
 v_mov_b32 v22, v16
 v_mov_b32 v23, v17
 s_nop 0
 v_permlane16_swap_b32 v16, v22
 v_permlane16_swap_b32 v17, v23
 v_max_f32 v16, v16, v22
 v_max_f32 v17, v17, v23
 v_mov_b32 v22, v16
 v_mov_b32 v23, v17
 s_nop 0
 v_permlane32_swap_b32 v16, v22
 v_permlane32_swap_b32 v17, v23
 v_max_f32 v16, v16, v22
 v_max_f32 v17, v17, v23
 v_mul_f32 v22, s63, v16
 v_fma_f32 v68, v68, s63, -v22
 v_fma_f32 v69, v69, s63, -v22
 v_fma_f32 v70, v70, s63, -v22
 v_fma_f32 v71, v71, s63, -v22
 v_mul_f32 v23, s63, v17
 v_fma_f32 v80, v80, s63, -v23
 v_fma_f32 v81, v81, s63, -v23
 v_fma_f32 v82, v82, s63, -v23
 v_fma_f32 v83, v83, s63, -v23
 v_fma_f32 v84, v84, s63, -v23
 v_fma_f32 v85, v85, s63, -v23
 v_fma_f32 v86, v86, s63, -v23
 v_fma_f32 v87, v87, s63, -v23
 v_exp_f32 v68, v68
 v_exp_f32 v69, v69
 v_exp_f32 v70, v70
 v_exp_f32 v71, v71
 v_exp_f32 v80, v80
 v_exp_f32 v81, v81
 v_exp_f32 v82, v82
 v_exp_f32 v83, v83
 v_exp_f32 v84, v84
 v_exp_f32 v85, v85
 v_exp_f32 v86, v86
 v_exp_f32 v87, v87
 v_add_f32 v18, v68, v69
 v_add_f32 v18, v18, v70
 v_add_f32 v18, v18, v71
 v_add_f32 v19, v80, v81
 v_add_f32 v19, v19, v82
 v_add_f32 v19, v19, v83
 v_add_f32 v19, v19, v84
 v_add_f32 v19, v19, v85
 v_add_f32 v19, v19, v86
 v_add_f32 v19, v19, v87
 s_mov_b32 s51, 0
 s_waitcnt vmcnt(4)
 v_max_u32 v3, v32, v34
 v_max3_u32 v3, v3, v36, v38
 v_max3_u32 v3, v3, v40, v42
 v_max3_u32 v3, v3, v44, v46
 v_cmp_eq_u32 vcc, -1, v3
 s_cbranch_vccz L_pkd_117
L_pk_116:
 s_sleep 2
 buffer_load_dwordx4 v[32:35], v6, s[4:7], s65 offen offset:0 sc1
 buffer_load_dwordx4 v[36:39], v6, s[4:7], s65 offen offset:512 sc1
 buffer_load_dwordx4 v[40:43], v6, s[4:7], s65 offen offset:1024 sc1
 buffer_load_dwordx4 v[44:47], v6, s[4:7], s65 offen offset:1536 sc1
 s_waitcnt vmcnt(0)
 v_max_u32 v3, v32, v34
 v_max3_u32 v3, v3, v36, v38
 v_max3_u32 v3, v3, v40, v42
 v_max3_u32 v3, v3, v44, v46
 v_cmp_eq_u32 vcc, -1, v3
 s_cbranch_vccz L_pke_118
 s_add_u32 s51, s51, 1
 s_cmp_lt_u32 s51, 131072
 s_cbranch_scc1 L_pk_116
 s_branch L_bail
L_pke_118:
 s_mov_b32 s51, 1
L_pkd_117:
 v_mfma_f32_16x16x32_bf16 v[64:67], v[32:35], a[0:3], 0
 v_mfma_f32_16x16x32_bf16 v[64:67], v[36:39], a[4:7], v[64:67]
 v_mfma_f32_16x16x32_bf16 v[64:67], v[40:43], a[8:11], v[64:67]
 v_mfma_f32_16x16x32_bf16 v[64:67], v[44:47], a[12:15], v[64:67]
 v_mfma_f32_16x16x32_bf16 v[76:79], v[32:35], a[16:19], 0
 v_mfma_f32_16x16x32_bf16 v[76:79], v[36:39], a[20:23], v[76:79]
 v_mfma_f32_16x16x32_bf16 v[76:79], v[40:43], a[24:27], v[76:79]
 v_mfma_f32_16x16x32_bf16 v[76:79], v[44:47], a[28:31], v[76:79]
 v_mov_b32 v29, 0
 s_nop 6
 v_cvt_pk_bf16_f32 v3, v64, v65
 v_lshlrev_b32 v64, 16, v3
 v_and_b32 v65, 0xffff0000, v3
 v_cvt_pk_bf16_f32 v3, v76, v77
 v_lshlrev_b32 v76, 16, v3
 v_and_b32 v77, 0xffff0000, v3
 v_mul_f32 v64, s62, v64
 v_mul_f32 v65, s62, v65
 v_mul_f32 v76, s62, v76
 v_mul_f32 v77, s62, v77
 v_cvt_pk_bf16_f32 v3, v64, v65
 v_lshlrev_b32 v64, 16, v3
 v_and_b32 v65, 0xffff0000, v3
 v_cvt_pk_bf16_f32 v3, v76, v77
 v_lshlrev_b32 v76, 16, v3
 v_and_b32 v77, 0xffff0000, v3
 s_cmp_eq_u32 s51, 0
 s_cbranch_scc1 L_nv_119
 buffer_load_dwordx2 v[48:49], v30, s[4:7], s65 offen offset:2048 sc1
 buffer_load_dwordx2 v[50:51], v30, s[4:7], s65 offen offset:2560 sc1
 buffer_load_dwordx2 v[52:53], v30, s[4:7], s65 offen offset:3072 sc1
 buffer_load_dwordx2 v[54:55], v30, s[4:7], s65 offen offset:3584 sc1
L_nv_119:
 s_mov_b64 exec, 1
 buffer_atomic_add v29, off, s[4:7], s61 offset:4 sc0
 s_mov_b64 exec, -1
 v_max3_f32 v20, v64, v65, v16
 v_max3_f32 v21, v76, v77, v17
 v_mov_b32 v22, v20
 v_mov_b32 v23, v21
 s_nop 0
 v_permlane16_swap_b32 v20, v22
 v_permlane16_swap_b32 v21, v23
 v_max_f32 v20, v20, v22
 v_max_f32 v21, v21, v23
 v_mov_b32 v22, v20
 v_mov_b32 v23, v21
 s_nop 0
 v_permlane32_swap_b32 v20, v22
 v_permlane32_swap_b32 v21, v23
 v_max_f32 v20, v20, v22
 v_max_f32 v21, v21, v23
 v_mul_f32 v20, s63, v20
 v_fma_f32 v24, v16, s63, -v20
 v_fma_f32 v64, v64, s63, -v20
 v_fma_f32 v65, v65, s63, -v20
 v_mul_f32 v21, s63, v21
 v_fma_f32 v26, v17, s63, -v21
 v_fma_f32 v76, v76, s63, -v21
 v_fma_f32 v77, v77, s63, -v21
 v_exp_f32 v24, v24
 v_exp_f32 v64, v64
 v_exp_f32 v65, v65
 v_exp_f32 v26, v26
 v_exp_f32 v76, v76
 v_exp_f32 v77, v77
 s_nop 0
 v_fma_f32 v18, v18, v24, v64
 v_add_f32 v18, v18, v65
 v_fma_f32 v19, v19, v26, v76
 v_add_f32 v19, v19, v77
 v_mov_b32 v22, v18
 v_mov_b32 v23, v19
 s_nop 0
 v_permlane16_swap_b32 v18, v22
 v_permlane16_swap_b32 v19, v23
 v_add_f32 v18, v18, v22
 v_add_f32 v19, v19, v23
 v_mov_b32 v22, v18
 v_mov_b32 v23, v19
 s_nop 0
 v_permlane32_swap_b32 v18, v22
 v_permlane32_swap_b32 v19, v23
 v_add_f32 v18, v18, v22
 v_add_f32 v19, v19, v23
 v_rcp_f32 v18, v18
 v_rcp_f32 v19, v19
 v_mul_f32 v24, v24, v18
 v_mul_f32 v26, v26, v19
 v_pk_mul_f32 v[68:69], v[68:69], v[24:25] op_sel_hi:[1,0]
 v_cvt_pk_bf16_f32 v168, v68, v69
 v_pk_mul_f32 v[70:71], v[70:71], v[24:25] op_sel_hi:[1,0]
 v_cvt_pk_bf16_f32 v169, v70, v71
 v_mul_f32 v64, v64, v18
 v_mul_f32 v65, v65, v18
 v_cvt_pk_bf16_f32 v152, v64, v65
 v_cvt_pk_bf16_f32 v155, v64, v65
 v_mfma_f32_16x16x32_bf16 v[88:91], a[64:67], v[168:171], 0
 v_pk_mul_f32 v[80:81], v[80:81], v[26:27] op_sel_hi:[1,0]
 v_cvt_pk_bf16_f32 v172, v80, v81
 v_mfma_f32_16x16x32_bf16 v[92:95], a[68:71], v[168:171], 0
 v_pk_mul_f32 v[82:83], v[82:83], v[26:27] op_sel_hi:[1,0]
 v_cvt_pk_bf16_f32 v173, v82, v83
 v_mfma_f32_16x16x32_bf16 v[96:99], a[72:75], v[168:171], 0
 v_pk_mul_f32 v[84:85], v[84:85], v[26:27] op_sel_hi:[1,0]
 v_cvt_pk_bf16_f32 v174, v84, v85
 v_mfma_f32_16x16x32_bf16 v[100:103], a[76:79], v[168:171], 0
 v_pk_mul_f32 v[86:87], v[86:87], v[26:27] op_sel_hi:[1,0]
 v_cvt_pk_bf16_f32 v175, v86, v87
 v_mfma_f32_16x16x32_bf16 v[104:107], a[80:83], v[168:171], 0
 v_mul_f32 v76, v76, v19
 v_mul_f32 v77, v77, v19
 v_mfma_f32_16x16x32_bf16 v[108:111], a[84:87], v[168:171], 0
 v_cvt_pk_bf16_f32 v160, v76, v77
 v_cvt_pk_bf16_f32 v163, v76, v77
 v_mfma_f32_16x16x32_bf16 v[112:115], a[88:91], v[168:171], 0
 v_mfma_f32_16x16x32_bf16 v[116:119], a[92:95], v[168:171], 0
 v_mfma_f32_16x16x32_bf16 v[120:123], a[64:67], v[172:175], 0
 v_mfma_f32_16x16x32_bf16 v[124:127], a[68:71], v[172:175], 0
 v_mfma_f32_16x16x32_bf16 v[128:131], a[72:75], v[172:175], 0
 v_mfma_f32_16x16x32_bf16 v[132:135], a[76:79], v[172:175], 0
 v_mfma_f32_16x16x32_bf16 v[136:139], a[80:83], v[172:175], 0
 v_mfma_f32_16x16x32_bf16 v[140:143], a[84:87], v[172:175], 0
 v_mfma_f32_16x16x32_bf16 v[144:147], a[88:91], v[172:175], 0
 v_mfma_f32_16x16x32_bf16 v[148:151], a[92:95], v[172:175], 0
 s_waitcnt vmcnt(1)
L_pv_120:
 v_max_u32 v3, v48, v50
 v_max3_u32 v3, v3, v52, v54
 v_cmp_eq_u32 vcc, -1, v3
 s_cbranch_vccz L_pvd_121
 buffer_load_dwordx2 v[48:49], v30, s[4:7], s65 offen offset:2048 sc1
 buffer_load_dwordx2 v[50:51], v30, s[4:7], s65 offen offset:2560 sc1
 buffer_load_dwordx2 v[52:53], v30, s[4:7], s65 offen offset:3072 sc1
 buffer_load_dwordx2 v[54:55], v30, s[4:7], s65 offen offset:3584 sc1
 s_waitcnt vmcnt(0)
 s_add_u32 s51, s51, 1
 s_cmp_lt_u32 s51, 131072
 s_cbranch_scc1 L_pv_120
 s_branch L_bail
L_pvd_121:
 v_mfma_f32_16x16x16_bf16 v[88:91], v[48:49], v[152:153], v[88:91]
 v_mfma_f32_16x16x16_bf16 v[92:95], v[48:49], v[154:155], v[92:95]
 v_mfma_f32_16x16x16_bf16 v[96:99], v[50:51], v[152:153], v[96:99]
 v_mfma_f32_16x16x16_bf16 v[100:103], v[50:51], v[154:155], v[100:103]
 v_mfma_f32_16x16x16_bf16 v[104:107], v[52:53], v[152:153], v[104:107]
 v_mfma_f32_16x16x16_bf16 v[108:111], v[52:53], v[154:155], v[108:111]
 v_mfma_f32_16x16x16_bf16 v[112:115], v[54:55], v[152:153], v[112:115]
 v_mfma_f32_16x16x16_bf16 v[116:119], v[54:55], v[154:155], v[116:119]
 v_mfma_f32_16x16x16_bf16 v[120:123], v[48:49], v[160:161], v[120:123]
 v_mfma_f32_16x16x16_bf16 v[124:127], v[48:49], v[162:163], v[124:127]
 v_cvt_pk_bf16_f32 v176, v88, v89
 v_cvt_pk_bf16_f32 v177, v90, v91
 v_mfma_f32_16x16x16_bf16 v[128:131], v[50:51], v[160:161], v[128:131]
 v_cvt_pk_bf16_f32 v178, v92, v93
 v_cvt_pk_bf16_f32 v179, v94, v95
 v_mfma_f32_16x16x16_bf16 v[132:135], v[50:51], v[162:163], v[132:135]
 s_add_u32 s3, s55, 0
 buffer_store_dwordx4 v[176:179], v7, s[4:7], s3 offen offset:0 sc1
 v_cvt_pk_bf16_f32 v180, v96, v97
 v_mfma_f32_16x16x16_bf16 v[136:139], v[52:53], v[160:161], v[136:139]
 v_cvt_pk_bf16_f32 v181, v98, v99
 v_cvt_pk_bf16_f32 v182, v100, v101
 v_mfma_f32_16x16x16_bf16 v[140:143], v[52:53], v[162:163], v[140:143]
 v_cvt_pk_bf16_f32 v183, v102, v103
 s_add_u32 s3, s55, 2048
 buffer_store_dwordx4 v[180:183], v7, s[4:7], s3 offen offset:0 sc1
 v_mfma_f32_16x16x16_bf16 v[144:147], v[54:55], v[160:161], v[144:147]
 v_cvt_pk_bf16_f32 v184, v104, v105
 v_cvt_pk_bf16_f32 v185, v106, v107
 v_mfma_f32_16x16x16_bf16 v[148:151], v[54:55], v[162:163], v[148:151]
 v_cvt_pk_bf16_f32 v186, v108, v109
 v_cvt_pk_bf16_f32 v187, v110, v111
 s_add_u32 s3, s55, 4096
 buffer_store_dwordx4 v[184:187], v7, s[4:7], s3 offen offset:0 sc1
 v_cvt_pk_bf16_f32 v188, v112, v113
 v_cvt_pk_bf16_f32 v189, v114, v115
 v_cvt_pk_bf16_f32 v190, v116, v117
 v_cvt_pk_bf16_f32 v191, v118, v119
 s_add_u32 s3, s55, 6144
 buffer_store_dwordx4 v[188:191], v7, s[4:7], s3 offen offset:0 sc1
 v_cvt_pk_bf16_f32 v192, v120, v121
 v_cvt_pk_bf16_f32 v193, v122, v123
 v_cvt_pk_bf16_f32 v194, v124, v125
 v_cvt_pk_bf16_f32 v195, v126, v127
 s_add_u32 s3, s55, 0
 buffer_store_dwordx4 v[192:195], v7, s[4:7], s3 offen offset:256 sc1
 v_cvt_pk_bf16_f32 v196, v128, v129
 v_cvt_pk_bf16_f32 v197, v130, v131
 v_cvt_pk_bf16_f32 v198, v132, v133
 v_cvt_pk_bf16_f32 v199, v134, v135
 s_add_u32 s3, s55, 2048
 buffer_store_dwordx4 v[196:199], v7, s[4:7], s3 offen offset:256 sc1
 v_cvt_pk_bf16_f32 v200, v136, v137
 v_cvt_pk_bf16_f32 v201, v138, v139
 v_cvt_pk_bf16_f32 v202, v140, v141
 v_cvt_pk_bf16_f32 v203, v142, v143
 s_add_u32 s3, s55, 4096
 buffer_store_dwordx4 v[200:203], v7, s[4:7], s3 offen offset:256 sc1
 v_cvt_pk_bf16_f32 v204, v144, v145
 v_cvt_pk_bf16_f32 v205, v146, v147
 v_cvt_pk_bf16_f32 v206, v148, v149
 v_cvt_pk_bf16_f32 v207, v150, v151
 s_add_u32 s3, s55, 6144
 buffer_store_dwordx4 v[204:207], v7, s[4:7], s3 offen offset:256 sc1
 buffer_store_dwordx4 v[208:211], v1, s[4:7], s65 offen offset:0 sc1
 buffer_store_dwordx4 v[208:211], v1, s[4:7], s65 offen offset:1024 sc1
 buffer_store_dwordx4 v[208:211], v1, s[4:7], s65 offen offset:2048 sc1
 buffer_store_dwordx4 v[208:211], v1, s[4:7], s65 offen offset:3072 sc1
 s_add_u32 s54, s54, 1
 s_add_u32 s61, s61, 4
 s_cmp_lt_u32 s54, 64
 s_cselect_b32 s64, 12, 0
 s_waitcnt vmcnt(12)
 v_readfirstlane_b32 s3, v29
 s_nop 3
 s_cmp_ge_u32 s3, s64
 s_cbranch_scc1 L_aj_122
 s_waitcnt vmcnt(4)
 v_mov_b32 v3, 1
 s_mov_b64 exec, 31
 buffer_atomic_add v3, v31, s[4:7], s60 offen
 s_mov_b64 exec, -1
 s_waitcnt vmcnt(1)
 v_mov_b32 v3, 1
 s_mov_b64 exec, 1
 buffer_atomic_add v3, v5, s[4:7], s66 offen
 s_mov_b64 exec, -1
 s_mov_b32 s51, 0
 s_mov_b64 exec, 1
L_wc_124:
 v_mov_b32 v3, 0
 buffer_atomic_add v3, v5, s[4:7], s61 offen sc0
 s_waitcnt vmcnt(0)
 v_cmp_gt_u32 vcc, s64, v3
 s_cbranch_vccz L_wcd_125
 s_sleep 4
 s_add_u32 s51, s51, 1
 s_cmp_lt_u32 s51, 131072
 s_cbranch_scc1 L_wc_124
 s_branch L_bail
L_wcd_125:
 s_mov_b64 exec, -1
 s_lshl_b32 s56, s54, 19
 s_add_u32 s56, s56, s57
 s_cmp_lt_u32 s54, 64
 s_cselect_b32 s56, s56, 268435456
 s_xor_b32 s3, s56, 8192
 buffer_load_dwordx4 a[0:3], v1, s[4:7], s3 offen offset:0 sc1
 buffer_load_dwordx4 a[4:7], v1, s[4:7], s3 offen offset:1024 sc1
 buffer_load_dwordx4 a[8:11], v1, s[4:7], s3 offen offset:2048 sc1
 buffer_load_dwordx4 a[12:15], v1, s[4:7], s3 offen offset:3072 sc1
 buffer_load_dwordx4 a[16:19], v2, s[4:7], s3 offen offset:0 sc1
 buffer_load_dwordx4 a[20:23], v2, s[4:7], s3 offen offset:1024 sc1
 buffer_load_dwordx4 a[24:27], v2, s[4:7], s3 offen offset:2048 sc1
 buffer_load_dwordx4 a[28:31], v2, s[4:7], s3 offen offset:3072 sc1
 s_mov_b32 s3, s56
 buffer_load_dwordx4 a[32:35], v1, s[4:7], s3 offen offset:0 sc1
 buffer_load_dwordx4 a[36:39], v1, s[4:7], s3 offen offset:1024 sc1
 buffer_load_dwordx4 a[40:43], v1, s[4:7], s3 offen offset:2048 sc1
 buffer_load_dwordx4 a[44:47], v1, s[4:7], s3 offen offset:3072 sc1
 buffer_load_dwordx4 a[48:51], v2, s[4:7], s3 offen offset:0 sc1
 buffer_load_dwordx4 a[52:55], v2, s[4:7], s3 offen offset:1024 sc1
 buffer_load_dwordx4 a[56:59], v2, s[4:7], s3 offen offset:2048 sc1
 buffer_load_dwordx4 a[60:63], v2, s[4:7], s3 offen offset:3072 sc1
 s_add_u32 s3, s56, 67108864
 buffer_load_dwordx4 a[64:67], v1, s[4:7], s3 offen offset:0 sc1
 buffer_load_dwordx4 a[68:71], v1, s[4:7], s3 offen offset:1024 sc1
 buffer_load_dwordx4 a[72:75], v1, s[4:7], s3 offen offset:2048 sc1
 buffer_load_dwordx4 a[76:79], v1, s[4:7], s3 offen offset:3072 sc1
 buffer_load_dwordx4 a[80:83], v2, s[4:7], s3 offen offset:0 sc1
 buffer_load_dwordx4 a[84:87], v2, s[4:7], s3 offen offset:1024 sc1
 buffer_load_dwordx4 a[88:91], v2, s[4:7], s3 offen offset:2048 sc1
 buffer_load_dwordx4 a[92:95], v2, s[4:7], s3 offen offset:3072 sc1
 s_branch L_ak_123
L_aj_122:
 s_lshl_b32 s56, s54, 19
 s_add_u32 s56, s56, s57
 s_cmp_lt_u32 s54, 64
 s_cselect_b32 s56, s56, 268435456
 s_xor_b32 s3, s56, 8192
 buffer_load_dwordx4 a[0:3], v1, s[4:7], s3 offen offset:0 sc1
 buffer_load_dwordx4 a[4:7], v1, s[4:7], s3 offen offset:1024 sc1
 buffer_load_dwordx4 a[8:11], v1, s[4:7], s3 offen offset:2048 sc1
 buffer_load_dwordx4 a[12:15], v1, s[4:7], s3 offen offset:3072 sc1
 buffer_load_dwordx4 a[16:19], v2, s[4:7], s3 offen offset:0 sc1
 buffer_load_dwordx4 a[20:23], v2, s[4:7], s3 offen offset:1024 sc1
 buffer_load_dwordx4 a[24:27], v2, s[4:7], s3 offen offset:2048 sc1
 buffer_load_dwordx4 a[28:31], v2, s[4:7], s3 offen offset:3072 sc1
 s_mov_b32 s3, s56
 buffer_load_dwordx4 a[32:35], v1, s[4:7], s3 offen offset:0 sc1
 buffer_load_dwordx4 a[36:39], v1, s[4:7], s3 offen offset:1024 sc1
 buffer_load_dwordx4 a[40:43], v1, s[4:7], s3 offen offset:2048 sc1
 buffer_load_dwordx4 a[44:47], v1, s[4:7], s3 offen offset:3072 sc1
 buffer_load_dwordx4 a[48:51], v2, s[4:7], s3 offen offset:0 sc1
 buffer_load_dwordx4 a[52:55], v2, s[4:7], s3 offen offset:1024 sc1
 buffer_load_dwordx4 a[56:59], v2, s[4:7], s3 offen offset:2048 sc1
 buffer_load_dwordx4 a[60:63], v2, s[4:7], s3 offen offset:3072 sc1
 s_add_u32 s3, s56, 67108864
 buffer_load_dwordx4 a[64:67], v1, s[4:7], s3 offen offset:0 sc1
 buffer_load_dwordx4 a[68:71], v1, s[4:7], s3 offen offset:1024 sc1
 buffer_load_dwordx4 a[72:75], v1, s[4:7], s3 offen offset:2048 sc1
 buffer_load_dwordx4 a[76:79], v1, s[4:7], s3 offen offset:3072 sc1
 buffer_load_dwordx4 a[80:83], v2, s[4:7], s3 offen offset:0 sc1
 buffer_load_dwordx4 a[84:87], v2, s[4:7], s3 offen offset:1024 sc1
 buffer_load_dwordx4 a[88:91], v2, s[4:7], s3 offen offset:2048 sc1
 buffer_load_dwordx4 a[92:95], v2, s[4:7], s3 offen offset:3072 sc1
 s_waitcnt vmcnt(28)
 v_mov_b32 v3, 1
 s_mov_b64 exec, 31
 buffer_atomic_add v3, v31, s[4:7], s60 offen
 s_mov_b64 exec, -1
 s_waitcnt vmcnt(25)
 v_mov_b32 v3, 1
 s_mov_b64 exec, 1
 buffer_atomic_add v3, v5, s[4:7], s66 offen
 s_mov_b64 exec, -1
L_ak_123:
 s_add_u32 s60, s60, 4
 s_cmp_lt_u32 s54, 64
 s_cbranch_scc1 L_att_loop
 s_endpgm
L_wo:
 s_and_b32 s100, s64, 1
 s_lshl_b32 s100, s100, 13
 s_lshl_b32 s64, s64, 14
 s_add_u32 s64, s64, s100
 s_xor_b32 s64, s64, 8192
 s_and_b32 s100, s65, 1
 s_lshl_b32 s100, s100, 13
 s_lshl_b32 s65, s65, 14
 s_add_u32 s65, s65, s100
 s_xor_b32 s65, s65, 8192
 s_and_b32 s100, s66, 1
 s_lshl_b32 s100, s100, 13
 s_lshl_b32 s66, s66, 14
 s_add_u32 s66, s66, s100
 s_xor_b32 s66, s66, 8192
 s_and_b32 s100, s67, 1
 s_lshl_b32 s100, s100, 13
 s_lshl_b32 s67, s67, 14
 s_add_u32 s67, s67, s100
 s_xor_b32 s67, s67, 8192
 v_lshlrev_b32 v7, 4, v0
 v_lshrrev_b32 v4, 5, v0
 s_mov_b32 s3, 10240
 v_mul_lo_u32 v4, v4, s3
 v_and_b32 v3, 31, v0
 v_lshl_add_u32 v4, v3, 2, v4
 s_lshl_b32 s3, s53, 9
 s_lshl_b32 s55, s50, 7
 s_add_u32 s3, s3, s55
 v_add_u32 v4, s3, v4
 s_mul_i32 s58, s52, 81920
 s_add_u32 s58, s58, 142606336
 v_lshlrev_b32 v8, 9, v0
 s_mul_i32 s3, s52, 5
 s_add_u32 s3, s3, s53
 s_and_b32 s55, s3, 3
 s_mul_i32 s55, s55, 16384
 v_add_u32 v8, s55, v8
 s_lshl_b32 s3, s3, 9
 s_add_u32 s3, s3, 40960
 v_mul_u32_u24 v5, 224, v0
 v_add_u32 v5, s3, v5
 v_mov_b32 v6, 0
 v_mov_b32 v10, 163776
 s_lshl_b32 s56, s50, 11
 s_mov_b32 s54, 0
 s_mov_b32 s61, -1
L_wo_loop:
 s_cmp_lt_u32 s54, 64
 s_cselect_b32 s3, 4, 0
 v_writelane_b32 v6, s3, 0
 s_cmp_ge_u32 s54, 8
 s_cselect_b32 s3, 4, 0
 v_writelane_b32 v6, s3, 1
 s_lshl_b32 s55, s54, 2
 s_cmp_lg_u32 s50, 0
 s_cselect_b32 s3, 268435456, s55
 v_mov_b32 v9, 0
 s_mov_b64 exec, 3
 buffer_atomic_add v9, v5, s[4:7], s3 offen sc0
 s_mov_b64 exec, -1
 s_waitcnt vmcnt(1)
 s_barrier
 s_cmp_lg_u32 s50, 1
 s_cbranch_scc1 L_sg_126
 s_cmp_ge_u32 s61, 64
 s_cbranch_scc1 L_sg_126
 s_lshl_b32 s3, s61, 2
 s_add_u32 s3, s3, 61696
 v_mov_b32 v3, 1
 s_mov_b32 exec_hi, 0
 buffer_atomic_add v3, v8, s[4:7], s3 offen
 s_mov_b64 exec, -1
L_sg_126:
 s_cmp_ge_u32 s54, 72
 s_cbranch_scc1 L_bail
 s_cmp_lg_u32 s50, 0
 s_cbranch_scc1 L_w_127
 s_waitcnt vmcnt(0)
 v_cmp_gt_u32 vcc, v6, v9
 s_cbranch_vccz L_w_127
 s_mov_b32 s51, 0
 s_mov_b64 exec, 3
 v_mov_b32 v12, 0
 buffer_atomic_add v12, v5, s[4:7], s55 offen sc0
 s_sleep 5
L_wc_128:
 v_mov_b32 v13, 0
 buffer_atomic_add v13, v5, s[4:7], s55 offen sc0
 s_waitcnt vmcnt(1)
 v_cmp_gt_u32 vcc, v6, v12
 s_cbranch_vccz L_wcd_129
 v_mov_b32 v12, 0
 buffer_atomic_add v12, v5, s[4:7], s55 offen sc0
 s_waitcnt vmcnt(1)
 v_cmp_gt_u32 vcc, v6, v13
 s_cbranch_vccz L_wcd_129
 s_add_u32 s51, s51, 1
 s_cmp_lt_u32 s51, 131072
 s_cbranch_scc1 L_wc_128
 s_branch L_bail
L_wcd_129:
 s_mov_b64 exec, -1
L_w_127:
 s_barrier
 s_sub_u32 s61, s54, 8
 s_cmp_ge_u32 s54, 64
 s_cbranch_scc1 L_tail_130
 s_lshl_b32 s3, s52, 16
 s_add_u32 s3, s3, s56
 s_add_u32 s3, s3, 75497472
 s_lshl_b32 s55, s54, 19
 s_add_u32 s55, s55, s3
 s_cmp_lt_u32 s54, 64
 s_cselect_b32 s55, s55, 268435456
 s_add_u32 m0, s56, 0
 s_add_u32 s3, s55, s64
 buffer_load_dwordx4 v7, s[4:7], s3 offen offset:0 sc1 lds
 s_add_u32 m0, s56, 0
 s_add_u32 s3, s55, s64
 buffer_load_dwordx4 v7, s[4:7], s3 offen offset:1024 sc1 lds
 s_add_u32 m0, s56, 8192
 s_add_u32 s3, s55, s65
 buffer_load_dwordx4 v7, s[4:7], s3 offen offset:0 sc1 lds
 s_add_u32 m0, s56, 8192
 s_add_u32 s3, s55, s65
 buffer_load_dwordx4 v7, s[4:7], s3 offen offset:1024 sc1 lds
 s_add_u32 m0, s56, 16384
 s_add_u32 s3, s55, s66
 buffer_load_dwordx4 v7, s[4:7], s3 offen offset:0 sc1 lds
 s_add_u32 m0, s56, 16384
 s_add_u32 s3, s55, s66
 buffer_load_dwordx4 v7, s[4:7], s3 offen offset:1024 sc1 lds
 s_add_u32 m0, s56, 24576
 s_add_u32 s3, s55, s67
 buffer_load_dwordx4 v7, s[4:7], s3 offen offset:0 sc1 lds
 s_add_u32 m0, s56, 24576
 s_add_u32 s3, s55, s67
 buffer_load_dwordx4 v7, s[4:7], s3 offen offset:1024 sc1 lds
 s_mov_b32 s60, s54
 s_lshl_b32 s3, s52, 16
 s_add_u32 s3, s3, s56
 s_add_u32 s3, s3, 109051904
 s_lshl_b32 s55, s61, 19
 s_add_u32 s55, s55, s3
 s_cmp_lt_u32 s61, 64
 s_cselect_b32 s55, s55, 268435456
 s_waitcnt vmcnt(6)
 s_barrier
 ds_read_b128 v[32:35], v7 offset:0
 ds_read_b128 v[36:39], v7 offset:1024
 ds_read_b128 v[40:43], v7 offset:2048
 ds_read_b128 v[44:47], v7 offset:3072
 s_waitcnt lgkmcnt(3)
 v_mfma_f32_32x32x16_bf16 v[64:79], v[32:35], a[0:3], 0
 ds_read_b128 v[48:51], v7 offset:4096
 s_add_u32 m0, s56, 32768
 s_add_u32 s3, s55, s64
 buffer_load_dwordx4 v7, s[4:7], s3 offen offset:0 sc1 lds
 s_waitcnt lgkmcnt(3)
 v_mfma_f32_32x32x16_bf16 v[64:79], v[36:39], a[4:7], v[64:79]
 ds_read_b128 v[52:55], v7 offset:5120
 s_waitcnt lgkmcnt(3)
 v_mfma_f32_32x32x16_bf16 v[64:79], v[40:43], a[8:11], v[64:79]
 ds_read_b128 v[56:59], v7 offset:6144
 s_waitcnt lgkmcnt(3)
 v_mfma_f32_32x32x16_bf16 v[64:79], v[44:47], a[12:15], v[64:79]
 ds_read_b128 v[60:63], v7 offset:7168
 s_add_u32 m0, s56, 32768
 s_add_u32 s3, s55, s64
 buffer_load_dwordx4 v7, s[4:7], s3 offen offset:1024 sc1 lds
 s_waitcnt lgkmcnt(3)
 v_mfma_f32_32x32x16_bf16 v[64:79], v[48:51], a[16:19], v[64:79]
 s_waitcnt vmcnt(6)
 s_barrier
 ds_read_b128 v[32:35], v7 offset:8192
 s_waitcnt lgkmcnt(3)
 v_mfma_f32_32x32x16_bf16 v[64:79], v[52:55], a[20:23], v[64:79]
 ds_read_b128 v[36:39], v7 offset:9216
 s_waitcnt lgkmcnt(3)
 v_mfma_f32_32x32x16_bf16 v[64:79], v[56:59], a[24:27], v[64:79]
 ds_read_b128 v[40:43], v7 offset:10240
 s_add_u32 m0, s56, 40960
 s_add_u32 s3, s55, s65
 buffer_load_dwordx4 v7, s[4:7], s3 offen offset:0 sc1 lds
 s_waitcnt lgkmcnt(3)
 v_mfma_f32_32x32x16_bf16 v[64:79], v[60:63], a[28:31], v[64:79]
 ds_read_b128 v[44:47], v7 offset:11264
 s_waitcnt lgkmcnt(3)
 v_mfma_f32_32x32x16_bf16 v[64:79], v[32:35], a[32:35], v[64:79]
 ds_read_b128 v[48:51], v7 offset:12288
 s_waitcnt lgkmcnt(3)
 v_mfma_f32_32x32x16_bf16 v[64:79], v[36:39], a[36:39], v[64:79]
 ds_read_b128 v[52:55], v7 offset:13312
 s_add_u32 m0, s56, 40960
 s_add_u32 s3, s55, s65
 buffer_load_dwordx4 v7, s[4:7], s3 offen offset:1024 sc1 lds
 s_waitcnt lgkmcnt(3)
 v_mfma_f32_32x32x16_bf16 v[64:79], v[40:43], a[40:43], v[64:79]
 ds_read_b128 v[56:59], v7 offset:14336
 s_waitcnt lgkmcnt(3)
 v_mfma_f32_32x32x16_bf16 v[64:79], v[44:47], a[44:47], v[64:79]
 ds_read_b128 v[60:63], v7 offset:15360
 s_waitcnt lgkmcnt(3)
 v_mfma_f32_32x32x16_bf16 v[64:79], v[48:51], a[48:51], v[64:79]
 s_waitcnt vmcnt(6)
 s_barrier
 ds_read_b128 v[32:35], v7 offset:16384
 s_add_u32 m0, s56, 49152
 s_add_u32 s3, s55, s66
 buffer_load_dwordx4 v7, s[4:7], s3 offen offset:0 sc1 lds
 s_waitcnt lgkmcnt(3)
 v_mfma_f32_32x32x16_bf16 v[64:79], v[52:55], a[52:55], v[64:79]
 ds_read_b128 v[36:39], v7 offset:17408
 s_waitcnt lgkmcnt(3)
 v_mfma_f32_32x32x16_bf16 v[64:79], v[56:59], a[56:59], v[64:79]
 ds_read_b128 v[40:43], v7 offset:18432
 s_waitcnt lgkmcnt(3)
 v_mfma_f32_32x32x16_bf16 v[64:79], v[60:63], a[60:63], v[64:79]
 ds_read_b128 v[44:47], v7 offset:19456
 s_add_u32 m0, s56, 49152
 s_add_u32 s3, s55, s66
 buffer_load_dwordx4 v7, s[4:7], s3 offen offset:1024 sc1 lds
 s_waitcnt lgkmcnt(3)
 v_mfma_f32_32x32x16_bf16 v[64:79], v[32:35], a[64:67], v[64:79]
 ds_read_b128 v[48:51], v7 offset:20480
 s_waitcnt lgkmcnt(3)
 v_mfma_f32_32x32x16_bf16 v[64:79], v[36:39], a[68:71], v[64:79]
 ds_read_b128 v[52:55], v7 offset:21504
 s_waitcnt lgkmcnt(3)
 v_mfma_f32_32x32x16_bf16 v[64:79], v[40:43], a[72:75], v[64:79]
 ds_read_b128 v[56:59], v7 offset:22528
 s_add_u32 m0, s56, 57344
 s_add_u32 s3, s55, s67
 buffer_load_dwordx4 v7, s[4:7], s3 offen offset:0 sc1 lds
 s_waitcnt lgkmcnt(3)
 v_mfma_f32_32x32x16_bf16 v[64:79], v[44:47], a[76:79], v[64:79]
 ds_read_b128 v[60:63], v7 offset:23552
 s_waitcnt lgkmcnt(3)
 v_mfma_f32_32x32x16_bf16 v[64:79], v[48:51], a[80:83], v[64:79]
 s_waitcnt vmcnt(7)
 s_barrier
 ds_read_b128 v[32:35], v7 offset:24576
 s_waitcnt lgkmcnt(3)
 v_mfma_f32_32x32x16_bf16 v[64:79], v[52:55], a[84:87], v[64:79]
 ds_read_b128 v[36:39], v7 offset:25600
 s_add_u32 m0, s56, 57344
 s_add_u32 s3, s55, s67
 buffer_load_dwordx4 v7, s[4:7], s3 offen offset:1024 sc1 lds
 s_waitcnt lgkmcnt(3)
 v_mfma_f32_32x32x16_bf16 v[64:79], v[56:59], a[88:91], v[64:79]
 ds_read_b128 v[40:43], v7 offset:26624
 s_waitcnt lgkmcnt(3)
 v_mfma_f32_32x32x16_bf16 v[64:79], v[60:63], a[92:95], v[64:79]
 ds_read_b128 v[44:47], v7 offset:27648
 s_waitcnt lgkmcnt(3)
 v_mfma_f32_32x32x16_bf16 v[64:79], v[32:35], a[96:99], v[64:79]
 ds_read_b128 v[48:51], v7 offset:28672
 s_waitcnt lgkmcnt(3)
 v_mfma_f32_32x32x16_bf16 v[64:79], v[36:39], a[100:103], v[64:79]
 ds_read_b128 v[52:55], v7 offset:29696
 s_waitcnt lgkmcnt(3)
 v_mfma_f32_32x32x16_bf16 v[64:79], v[40:43], a[104:107], v[64:79]
 ds_read_b128 v[56:59], v7 offset:30720
 s_waitcnt lgkmcnt(3)
 v_mfma_f32_32x32x16_bf16 v[64:79], v[44:47], a[108:111], v[64:79]
 ds_read_b128 v[60:63], v7 offset:31744
 s_waitcnt lgkmcnt(3)
 v_mfma_f32_32x32x16_bf16 v[64:79], v[48:51], a[112:115], v[64:79]
 s_waitcnt lgkmcnt(2)
 v_mfma_f32_32x32x16_bf16 v[64:79], v[52:55], a[116:119], v[64:79]
 s_waitcnt lgkmcnt(1)
 v_mfma_f32_32x32x16_bf16 v[64:79], v[56:59], a[120:123], v[64:79]
 s_waitcnt lgkmcnt(0)
 v_mfma_f32_32x32x16_bf16 v[64:79], v[60:63], a[124:127], v[64:79]
 s_mul_i32 s55, s60, 655360
 s_add_u32 s55, s55, s58
 s_cmp_lt_u32 s60, 64
 s_cselect_b32 s55, s55, 268435456
 s_nop 7
 s_add_u32 s3, s55, 0
 buffer_store_dword v64, v4, s[4:7], s3 offen sc1
 s_add_u32 s3, s55, 2560
 buffer_store_dword v65, v4, s[4:7], s3 offen sc1
 s_add_u32 s3, s55, 5120
 buffer_store_dword v66, v4, s[4:7], s3 offen sc1
 s_add_u32 s3, s55, 7680
 buffer_store_dword v67, v4, s[4:7], s3 offen sc1
 s_add_u32 s3, s55, 20480
 buffer_store_dword v68, v4, s[4:7], s3 offen sc1
 s_add_u32 s3, s55, 23040
 buffer_store_dword v69, v4, s[4:7], s3 offen sc1
 s_add_u32 s3, s55, 25600
 buffer_store_dword v70, v4, s[4:7], s3 offen sc1
 s_add_u32 s3, s55, 28160
 buffer_store_dword v71, v4, s[4:7], s3 offen sc1
 s_add_u32 s3, s55, 40960
 buffer_store_dword v72, v4, s[4:7], s3 offen sc1
 s_add_u32 s3, s55, 43520
 buffer_store_dword v73, v4, s[4:7], s3 offen sc1
 s_add_u32 s3, s55, 46080
 buffer_store_dword v74, v4, s[4:7], s3 offen sc1
 s_add_u32 s3, s55, 48640
 buffer_store_dword v75, v4, s[4:7], s3 offen sc1
 s_add_u32 s3, s55, 61440
 buffer_store_dword v76, v4, s[4:7], s3 offen sc1
 s_add_u32 s3, s55, 64000
 buffer_store_dword v77, v4, s[4:7], s3 offen sc1
 s_add_u32 s3, s55, 66560
 buffer_store_dword v78, v4, s[4:7], s3 offen sc1
 s_add_u32 s3, s55, 69120
 buffer_store_dword v79, v4, s[4:7], s3 offen sc1
L_wo_mid:
 s_add_u32 s62, s54, 1
 s_cmp_lt_u32 s62, 64
 s_cselect_b32 s3, 4, 0
 v_writelane_b32 v6, s3, 0
 s_cmp_ge_u32 s62, 8
 s_cselect_b32 s3, 4, 0
 v_writelane_b32 v6, s3, 1
 s_lshl_b32 s55, s62, 2
 s_cmp_lg_u32 s50, 0
 s_cselect_b32 s3, 268435456, s55
 v_mov_b32 v9, 0
 s_mov_b64 exec, 3
 buffer_atomic_add v9, v5, s[4:7], s3 offen sc0
 s_mov_b64 exec, -1
 s_waitcnt vmcnt(17)
 s_barrier
 s_mov_b32 s60, s61
 ds_read_b128 v[32:35], v7 offset:32768
 ds_read_b128 v[36:39], v7 offset:33792
 ds_read_b128 v[40:43], v7 offset:34816
 ds_read_b128 v[44:47], v7 offset:35840
 s_waitcnt lgkmcnt(3)
 v_mfma_f32_32x32x16_bf16 v[80:95], v[32:35], a[0:3], 0
 ds_read_b128 v[48:51], v7 offset:36864
 s_waitcnt lgkmcnt(3)
 v_mfma_f32_32x32x16_bf16 v[80:95], v[36:39], a[4:7], v[80:95]
 ds_read_b128 v[52:55], v7 offset:37888
 s_waitcnt lgkmcnt(3)
 v_mfma_f32_32x32x16_bf16 v[80:95], v[40:43], a[8:11], v[80:95]
 ds_read_b128 v[56:59], v7 offset:38912
 s_waitcnt lgkmcnt(3)
 v_mfma_f32_32x32x16_bf16 v[80:95], v[44:47], a[12:15], v[80:95]
 ds_read_b128 v[60:63], v7 offset:39936
 s_waitcnt lgkmcnt(3)
 v_mfma_f32_32x32x16_bf16 v[80:95], v[48:51], a[16:19], v[80:95]
 ds_read_b128 v[32:35], v7 offset:40960
 s_waitcnt lgkmcnt(3)
 v_mfma_f32_32x32x16_bf16 v[80:95], v[52:55], a[20:23], v[80:95]
 ds_read_b128 v[36:39], v7 offset:41984
 s_waitcnt lgkmcnt(3)
 v_mfma_f32_32x32x16_bf16 v[80:95], v[56:59], a[24:27], v[80:95]
 ds_read_b128 v[40:43], v7 offset:43008
 s_waitcnt lgkmcnt(3)
 v_mfma_f32_32x32x16_bf16 v[80:95], v[60:63], a[28:31], v[80:95]
 ds_read_b128 v[44:47], v7 offset:44032
 s_waitcnt lgkmcnt(3)
 v_mfma_f32_32x32x16_bf16 v[80:95], v[32:35], a[32:35], v[80:95]
 ds_read_b128 v[48:51], v7 offset:45056
 s_waitcnt lgkmcnt(3)
 v_mfma_f32_32x32x16_bf16 v[80:95], v[36:39], a[36:39], v[80:95]
 ds_read_b128 v[52:55], v7 offset:46080
 s_waitcnt lgkmcnt(3)
 v_mfma_f32_32x32x16_bf16 v[80:95], v[40:43], a[40:43], v[80:95]
 ds_read_b128 v[56:59], v7 offset:47104
 s_waitcnt lgkmcnt(3)
 v_mfma_f32_32x32x16_bf16 v[80:95], v[44:47], a[44:47], v[80:95]
 ds_read_b128 v[60:63], v7 offset:48128
 s_waitcnt lgkmcnt(3)
 v_mfma_f32_32x32x16_bf16 v[80:95], v[48:51], a[48:51], v[80:95]
 ds_read_b128 v[32:35], v7 offset:49152
 s_waitcnt lgkmcnt(3)
 v_mfma_f32_32x32x16_bf16 v[80:95], v[52:55], a[52:55], v[80:95]
 ds_read_b128 v[36:39], v7 offset:50176
 s_waitcnt lgkmcnt(3)
 v_mfma_f32_32x32x16_bf16 v[80:95], v[56:59], a[56:59], v[80:95]
 ds_read_b128 v[40:43], v7 offset:51200
 s_waitcnt lgkmcnt(3)
 v_mfma_f32_32x32x16_bf16 v[80:95], v[60:63], a[60:63], v[80:95]
 ds_read_b128 v[44:47], v7 offset:52224
 s_waitcnt vmcnt(0)
 s_cmp_lg_u32 s50, 0
 s_cbranch_scc1 L_hs_132
 v_cmp_gt_u32 vcc, v6, v9
 s_nop 1
 v_mov_b32 v3, vcc_lo
 ds_write_b32 v10, v3
 s_waitcnt lgkmcnt(0)
L_hs_132:
 s_barrier
 ds_read_b32 v9, v10
 s_cmp_lg_u32 s50, 1
 s_cbranch_scc1 L_sg_133
 s_cmp_ge_u32 s54, 64
 s_cbranch_scc1 L_sg_133
 s_lshl_b32 s3, s54, 2
 s_add_u32 s3, s3, 61440
 v_mov_b32 v3, 1
 s_mov_b32 exec_hi, 0
 buffer_atomic_add v3, v8, s[4:7], s3 offen
 s_mov_b64 exec, -1
L_sg_133:
 s_waitcnt lgkmcnt(0)
 v_readfirstlane_b32 s3, v9
 s_nop 3
 s_cmp_eq_u32 s3, 0
 s_cselect_b32 s62, s62, 64
 s_lshl_b32 s3, s52, 16
 s_add_u32 s3, s3, s56
 s_add_u32 s3, s3, 75497472
 s_lshl_b32 s55, s62, 19
 s_add_u32 s55, s55, s3
 s_cmp_lt_u32 s62, 64
 s_cselect_b32 s55, s55, 268435456
 s_waitcnt lgkmcnt(3)
 v_mfma_f32_32x32x16_bf16 v[80:95], v[32:35], a[64:67], v[80:95]
 ds_read_b128 v[48:51], v7 offset:53248
 s_add_u32 m0, s56, 0
 s_add_u32 s3, s55, s64
 buffer_load_dwordx4 v7, s[4:7], s3 offen offset:0 sc1 lds
 s_waitcnt lgkmcnt(3)
 v_mfma_f32_32x32x16_bf16 v[80:95], v[36:39], a[68:71], v[80:95]
 ds_read_b128 v[52:55], v7 offset:54272
 s_waitcnt lgkmcnt(3)
 v_mfma_f32_32x32x16_bf16 v[80:95], v[40:43], a[72:75], v[80:95]
 ds_read_b128 v[56:59], v7 offset:55296
 s_add_u32 m0, s56, 0
 s_add_u32 s3, s55, s64
 buffer_load_dwordx4 v7, s[4:7], s3 offen offset:1024 sc1 lds
 s_waitcnt lgkmcnt(3)
 v_mfma_f32_32x32x16_bf16 v[80:95], v[44:47], a[76:79], v[80:95]
 ds_read_b128 v[60:63], v7 offset:56320
 s_waitcnt lgkmcnt(3)
 v_mfma_f32_32x32x16_bf16 v[80:95], v[48:51], a[80:83], v[80:95]
 ds_read_b128 v[32:35], v7 offset:57344
 s_add_u32 m0, s56, 8192
 s_add_u32 s3, s55, s65
 buffer_load_dwordx4 v7, s[4:7], s3 offen offset:0 sc1 lds
 s_waitcnt lgkmcnt(3)
 v_mfma_f32_32x32x16_bf16 v[80:95], v[52:55], a[84:87], v[80:95]
 ds_read_b128 v[36:39], v7 offset:58368
 s_waitcnt lgkmcnt(3)
 v_mfma_f32_32x32x16_bf16 v[80:95], v[56:59], a[88:91], v[80:95]
 ds_read_b128 v[40:43], v7 offset:59392
 s_add_u32 m0, s56, 8192
 s_add_u32 s3, s55, s65
 buffer_load_dwordx4 v7, s[4:7], s3 offen offset:1024 sc1 lds
 s_waitcnt lgkmcnt(3)
 v_mfma_f32_32x32x16_bf16 v[80:95], v[60:63], a[92:95], v[80:95]
 ds_read_b128 v[44:47], v7 offset:60416
 s_waitcnt lgkmcnt(3)
 v_mfma_f32_32x32x16_bf16 v[80:95], v[32:35], a[96:99], v[80:95]
 ds_read_b128 v[48:51], v7 offset:61440
 s_add_u32 m0, s56, 16384
 s_add_u32 s3, s55, s66
 buffer_load_dwordx4 v7, s[4:7], s3 offen offset:0 sc1 lds
 s_waitcnt lgkmcnt(3)
 v_mfma_f32_32x32x16_bf16 v[80:95], v[36:39], a[100:103], v[80:95]
 ds_read_b128 v[52:55], v7 offset:62464
 s_waitcnt lgkmcnt(3)
 v_mfma_f32_32x32x16_bf16 v[80:95], v[40:43], a[104:107], v[80:95]
 ds_read_b128 v[56:59], v7 offset:63488
 s_add_u32 m0, s56, 16384
 s_add_u32 s3, s55, s66
 buffer_load_dwordx4 v7, s[4:7], s3 offen offset:1024 sc1 lds
 s_waitcnt lgkmcnt(3)
 v_mfma_f32_32x32x16_bf16 v[80:95], v[44:47], a[108:111], v[80:95]
 ds_read_b128 v[60:63], v7 offset:64512
 s_waitcnt lgkmcnt(3)
 v_mfma_f32_32x32x16_bf16 v[80:95], v[48:51], a[112:115], v[80:95]
 s_add_u32 m0, s56, 24576
 s_add_u32 s3, s55, s67
 buffer_load_dwordx4 v7, s[4:7], s3 offen offset:0 sc1 lds
 s_waitcnt lgkmcnt(2)
 v_mfma_f32_32x32x16_bf16 v[80:95], v[52:55], a[116:119], v[80:95]
 s_waitcnt lgkmcnt(1)
 v_mfma_f32_32x32x16_bf16 v[80:95], v[56:59], a[120:123], v[80:95]
 s_add_u32 m0, s56, 24576
 s_add_u32 s3, s55, s67
 buffer_load_dwordx4 v7, s[4:7], s3 offen offset:1024 sc1 lds
 s_waitcnt lgkmcnt(0)
 v_mfma_f32_32x32x16_bf16 v[80:95], v[60:63], a[124:127], v[80:95]
 s_mul_i32 s55, s60, 655360
 s_add_u32 s55, s55, s58
 s_add_u32 s55, s55, 41943040
 s_cmp_lt_u32 s60, 64
 s_cselect_b32 s55, s55, 268435456
 s_nop 7
 s_add_u32 s3, s55, 0
 buffer_store_dword v80, v4, s[4:7], s3 offen sc1
 s_add_u32 s3, s55, 2560
 buffer_store_dword v81, v4, s[4:7], s3 offen sc1
 s_add_u32 s3, s55, 5120
 buffer_store_dword v82, v4, s[4:7], s3 offen sc1
 s_add_u32 s3, s55, 7680
 buffer_store_dword v83, v4, s[4:7], s3 offen sc1
 s_add_u32 s3, s55, 20480
 buffer_store_dword v84, v4, s[4:7], s3 offen sc1
 s_add_u32 s3, s55, 23040
 buffer_store_dword v85, v4, s[4:7], s3 offen sc1
 s_add_u32 s3, s55, 25600
 buffer_store_dword v86, v4, s[4:7], s3 offen sc1
 s_add_u32 s3, s55, 28160
 buffer_store_dword v87, v4, s[4:7], s3 offen sc1
 s_add_u32 s3, s55, 40960
 buffer_store_dword v88, v4, s[4:7], s3 offen sc1
 s_add_u32 s3, s55, 43520
 buffer_store_dword v89, v4, s[4:7], s3 offen sc1
 s_add_u32 s3, s55, 46080
 buffer_store_dword v90, v4, s[4:7], s3 offen sc1
 s_add_u32 s3, s55, 48640
 buffer_store_dword v91, v4, s[4:7], s3 offen sc1
 s_add_u32 s3, s55, 61440
 buffer_store_dword v92, v4, s[4:7], s3 offen sc1
 s_add_u32 s3, s55, 64000
 buffer_store_dword v93, v4, s[4:7], s3 offen sc1
 s_add_u32 s3, s55, 66560
 buffer_store_dword v94, v4, s[4:7], s3 offen sc1
 s_add_u32 s3, s55, 69120
 buffer_store_dword v95, v4, s[4:7], s3 offen sc1
 s_cmp_ge_u32 s62, 64
 s_cbranch_scc1 L_e_131
 s_mov_b32 s54, s62
 s_mov_b32 s63, s61
 s_sub_u32 s61, s54, 8
 s_mov_b32 s60, s54
 s_waitcnt vmcnt(16)
 s_barrier
 s_lshl_b32 s3, s52, 16
 s_add_u32 s3, s3, s56
 s_add_u32 s3, s3, 109051904
 s_lshl_b32 s55, s61, 19
 s_add_u32 s55, s55, s3
 s_cmp_lt_u32 s61, 64
 s_cselect_b32 s55, s55, 268435456
 ds_read_b128 v[32:35], v7 offset:0
 ds_read_b128 v[36:39], v7 offset:1024
 ds_read_b128 v[40:43], v7 offset:2048
 ds_read_b128 v[44:47], v7 offset:3072
 s_waitcnt lgkmcnt(3)
 v_mfma_f32_32x32x16_bf16 v[64:79], v[32:35], a[0:3], 0
 ds_read_b128 v[48:51], v7 offset:4096
 s_add_u32 m0, s56, 32768
 s_add_u32 s3, s55, s64
 buffer_load_dwordx4 v7, s[4:7], s3 offen offset:0 sc1 lds
 s_waitcnt lgkmcnt(3)
 v_mfma_f32_32x32x16_bf16 v[64:79], v[36:39], a[4:7], v[64:79]
 ds_read_b128 v[52:55], v7 offset:5120
 s_waitcnt lgkmcnt(3)
 v_mfma_f32_32x32x16_bf16 v[64:79], v[40:43], a[8:11], v[64:79]
 ds_read_b128 v[56:59], v7 offset:6144
 s_waitcnt lgkmcnt(3)
 v_mfma_f32_32x32x16_bf16 v[64:79], v[44:47], a[12:15], v[64:79]
 ds_read_b128 v[60:63], v7 offset:7168
 s_add_u32 m0, s56, 32768
 s_add_u32 s3, s55, s64
 buffer_load_dwordx4 v7, s[4:7], s3 offen offset:1024 sc1 lds
 s_waitcnt lgkmcnt(3)
 v_mfma_f32_32x32x16_bf16 v[64:79], v[48:51], a[16:19], v[64:79]
 ds_read_b128 v[32:35], v7 offset:8192
 s_waitcnt lgkmcnt(3)
 v_mfma_f32_32x32x16_bf16 v[64:79], v[52:55], a[20:23], v[64:79]
 ds_read_b128 v[36:39], v7 offset:9216
 s_waitcnt lgkmcnt(3)
 v_mfma_f32_32x32x16_bf16 v[64:79], v[56:59], a[24:27], v[64:79]
 ds_read_b128 v[40:43], v7 offset:10240
 s_add_u32 m0, s56, 40960
 s_add_u32 s3, s55, s65
 buffer_load_dwordx4 v7, s[4:7], s3 offen offset:0 sc1 lds
 s_waitcnt lgkmcnt(3)
 v_mfma_f32_32x32x16_bf16 v[64:79], v[60:63], a[28:31], v[64:79]
 ds_read_b128 v[44:47], v7 offset:11264
 s_waitcnt lgkmcnt(3)
 v_mfma_f32_32x32x16_bf16 v[64:79], v[32:35], a[32:35], v[64:79]
 ds_read_b128 v[48:51], v7 offset:12288
 s_waitcnt lgkmcnt(3)
 v_mfma_f32_32x32x16_bf16 v[64:79], v[36:39], a[36:39], v[64:79]
 ds_read_b128 v[52:55], v7 offset:13312
 s_add_u32 m0, s56, 40960
 s_add_u32 s3, s55, s65
 buffer_load_dwordx4 v7, s[4:7], s3 offen offset:1024 sc1 lds
 s_waitcnt lgkmcnt(3)
 v_mfma_f32_32x32x16_bf16 v[64:79], v[40:43], a[40:43], v[64:79]
 ds_read_b128 v[56:59], v7 offset:14336
 s_waitcnt lgkmcnt(3)
 v_mfma_f32_32x32x16_bf16 v[64:79], v[44:47], a[44:47], v[64:79]
 ds_read_b128 v[60:63], v7 offset:15360
 s_waitcnt lgkmcnt(3)
 v_mfma_f32_32x32x16_bf16 v[64:79], v[48:51], a[48:51], v[64:79]
 ds_read_b128 v[32:35], v7 offset:16384
 s_add_u32 m0, s56, 49152
 s_add_u32 s3, s55, s66
 buffer_load_dwordx4 v7, s[4:7], s3 offen offset:0 sc1 lds
 s_waitcnt lgkmcnt(3)
 v_mfma_f32_32x32x16_bf16 v[64:79], v[52:55], a[52:55], v[64:79]
 ds_read_b128 v[36:39], v7 offset:17408
 s_waitcnt lgkmcnt(3)
 v_mfma_f32_32x32x16_bf16 v[64:79], v[56:59], a[56:59], v[64:79]
 ds_read_b128 v[40:43], v7 offset:18432
 s_waitcnt lgkmcnt(3)
 v_mfma_f32_32x32x16_bf16 v[64:79], v[60:63], a[60:63], v[64:79]
 ds_read_b128 v[44:47], v7 offset:19456
 s_add_u32 m0, s56, 49152
 s_add_u32 s3, s55, s66
 buffer_load_dwordx4 v7, s[4:7], s3 offen offset:1024 sc1 lds
 s_waitcnt vmcnt(6)
 s_barrier
 s_cmp_lg_u32 s50, 1
 s_cbranch_scc1 L_sg_134
 s_cmp_ge_u32 s63, 64
 s_cbranch_scc1 L_sg_134
 s_lshl_b32 s3, s63, 2
 s_add_u32 s3, s3, 61696
 v_mov_b32 v3, 1
 s_mov_b32 exec_hi, 0
 buffer_atomic_add v3, v8, s[4:7], s3 offen
 s_mov_b64 exec, -1
L_sg_134:
 s_waitcnt lgkmcnt(3)
 v_mfma_f32_32x32x16_bf16 v[64:79], v[32:35], a[64:67], v[64:79]
 ds_read_b128 v[48:51], v7 offset:20480
 s_waitcnt lgkmcnt(3)
 v_mfma_f32_32x32x16_bf16 v[64:79], v[36:39], a[68:71], v[64:79]
 ds_read_b128 v[52:55], v7 offset:21504
 s_waitcnt lgkmcnt(3)
 v_mfma_f32_32x32x16_bf16 v[64:79], v[40:43], a[72:75], v[64:79]
 ds_read_b128 v[56:59], v7 offset:22528
 s_add_u32 m0, s56, 57344
 s_add_u32 s3, s55, s67
 buffer_load_dwordx4 v7, s[4:7], s3 offen offset:0 sc1 lds
 s_waitcnt lgkmcnt(3)
 v_mfma_f32_32x32x16_bf16 v[64:79], v[44:47], a[76:79], v[64:79]
 ds_read_b128 v[60:63], v7 offset:23552
 s_waitcnt lgkmcnt(3)
 v_mfma_f32_32x32x16_bf16 v[64:79], v[48:51], a[80:83], v[64:79]
 ds_read_b128 v[32:35], v7 offset:24576
 s_waitcnt lgkmcnt(3)
 v_mfma_f32_32x32x16_bf16 v[64:79], v[52:55], a[84:87], v[64:79]
 ds_read_b128 v[36:39], v7 offset:25600
 s_add_u32 m0, s56, 57344
 s_add_u32 s3, s55, s67
 buffer_load_dwordx4 v7, s[4:7], s3 offen offset:1024 sc1 lds
 s_waitcnt lgkmcnt(3)
 v_mfma_f32_32x32x16_bf16 v[64:79], v[56:59], a[88:91], v[64:79]
 ds_read_b128 v[40:43], v7 offset:26624
 s_waitcnt lgkmcnt(3)
 v_mfma_f32_32x32x16_bf16 v[64:79], v[60:63], a[92:95], v[64:79]
 ds_read_b128 v[44:47], v7 offset:27648
 s_waitcnt lgkmcnt(3)
 v_mfma_f32_32x32x16_bf16 v[64:79], v[32:35], a[96:99], v[64:79]
 ds_read_b128 v[48:51], v7 offset:28672
 s_waitcnt lgkmcnt(3)
 v_mfma_f32_32x32x16_bf16 v[64:79], v[36:39], a[100:103], v[64:79]
 ds_read_b128 v[52:55], v7 offset:29696
 s_waitcnt lgkmcnt(3)
 v_mfma_f32_32x32x16_bf16 v[64:79], v[40:43], a[104:107], v[64:79]
 ds_read_b128 v[56:59], v7 offset:30720
 s_waitcnt lgkmcnt(3)
 v_mfma_f32_32x32x16_bf16 v[64:79], v[44:47], a[108:111], v[64:79]
 ds_read_b128 v[60:63], v7 offset:31744
 s_waitcnt lgkmcnt(3)
 v_mfma_f32_32x32x16_bf16 v[64:79], v[48:51], a[112:115], v[64:79]
 s_waitcnt lgkmcnt(2)
 v_mfma_f32_32x32x16_bf16 v[64:79], v[52:55], a[116:119], v[64:79]
 s_waitcnt lgkmcnt(1)
 v_mfma_f32_32x32x16_bf16 v[64:79], v[56:59], a[120:123], v[64:79]
 s_waitcnt lgkmcnt(0)
 v_mfma_f32_32x32x16_bf16 v[64:79], v[60:63], a[124:127], v[64:79]
 s_mul_i32 s55, s60, 655360
 s_add_u32 s55, s55, s58
 s_cmp_lt_u32 s60, 64
 s_cselect_b32 s55, s55, 268435456
 s_nop 7
 s_add_u32 s3, s55, 0
 buffer_store_dword v64, v4, s[4:7], s3 offen sc1
 s_add_u32 s3, s55, 2560
 buffer_store_dword v65, v4, s[4:7], s3 offen sc1
 s_add_u32 s3, s55, 5120
 buffer_store_dword v66, v4, s[4:7], s3 offen sc1
 s_add_u32 s3, s55, 7680
 buffer_store_dword v67, v4, s[4:7], s3 offen sc1
 s_add_u32 s3, s55, 20480
 buffer_store_dword v68, v4, s[4:7], s3 offen sc1
 s_add_u32 s3, s55, 23040
 buffer_store_dword v69, v4, s[4:7], s3 offen sc1
 s_add_u32 s3, s55, 25600
 buffer_store_dword v70, v4, s[4:7], s3 offen sc1
 s_add_u32 s3, s55, 28160
 buffer_store_dword v71, v4, s[4:7], s3 offen sc1
 s_add_u32 s3, s55, 40960
 buffer_store_dword v72, v4, s[4:7], s3 offen sc1
 s_add_u32 s3, s55, 43520
 buffer_store_dword v73, v4, s[4:7], s3 offen sc1
 s_add_u32 s3, s55, 46080
 buffer_store_dword v74, v4, s[4:7], s3 offen sc1
 s_add_u32 s3, s55, 48640
 buffer_store_dword v75, v4, s[4:7], s3 offen sc1
 s_add_u32 s3, s55, 61440
 buffer_store_dword v76, v4, s[4:7], s3 offen sc1
 s_add_u32 s3, s55, 64000
 buffer_store_dword v77, v4, s[4:7], s3 offen sc1
 s_add_u32 s3, s55, 66560
 buffer_store_dword v78, v4, s[4:7], s3 offen sc1
 s_add_u32 s3, s55, 69120
 buffer_store_dword v79, v4, s[4:7], s3 offen sc1
 s_branch L_wo_mid
L_tail_130:
 s_lshl_b32 s3, s52, 16
 s_add_u32 s3, s3, s56
 s_add_u32 s3, s3, 109051904
 s_lshl_b32 s55, s61, 19
 s_add_u32 s55, s55, s3
 s_cmp_lt_u32 s61, 64
 s_cselect_b32 s55, s55, 268435456
 s_add_u32 m0, s56, 32768
 s_add_u32 s3, s55, s64
 buffer_load_dwordx4 v7, s[4:7], s3 offen offset:0 sc1 lds
 s_add_u32 m0, s56, 32768
 s_add_u32 s3, s55, s64
 buffer_load_dwordx4 v7, s[4:7], s3 offen offset:1024 sc1 lds
 s_add_u32 m0, s56, 40960
 s_add_u32 s3, s55, s65
 buffer_load_dwordx4 v7, s[4:7], s3 offen offset:0 sc1 lds
 s_add_u32 m0, s56, 40960
 s_add_u32 s3, s55, s65
 buffer_load_dwordx4 v7, s[4:7], s3 offen offset:1024 sc1 lds
 s_add_u32 m0, s56, 49152
 s_add_u32 s3, s55, s66
 buffer_load_dwordx4 v7, s[4:7], s3 offen offset:0 sc1 lds
 s_add_u32 m0, s56, 49152
 s_add_u32 s3, s55, s66
 buffer_load_dwordx4 v7, s[4:7], s3 offen offset:1024 sc1 lds
 s_add_u32 m0, s56, 57344
 s_add_u32 s3, s55, s67
 buffer_load_dwordx4 v7, s[4:7], s3 offen offset:0 sc1 lds
 s_add_u32 m0, s56, 57344
 s_add_u32 s3, s55, s67
 buffer_load_dwordx4 v7, s[4:7], s3 offen offset:1024 sc1 lds
 s_mov_b32 s60, s61
 s_waitcnt vmcnt(6)
 s_barrier
 ds_read_b128 v[32:35], v7 offset:32768
 ds_read_b128 v[36:39], v7 offset:33792
 ds_read_b128 v[40:43], v7 offset:34816
 ds_read_b128 v[44:47], v7 offset:35840
 s_waitcnt lgkmcnt(3)
 v_mfma_f32_32x32x16_bf16 v[80:95], v[32:35], a[0:3], 0
 ds_read_b128 v[48:51], v7 offset:36864
 s_waitcnt lgkmcnt(3)
 v_mfma_f32_32x32x16_bf16 v[80:95], v[36:39], a[4:7], v[80:95]
 ds_read_b128 v[52:55], v7 offset:37888
 s_waitcnt lgkmcnt(3)
 v_mfma_f32_32x32x16_bf16 v[80:95], v[40:43], a[8:11], v[80:95]
 ds_read_b128 v[56:59], v7 offset:38912
 s_waitcnt lgkmcnt(3)
 v_mfma_f32_32x32x16_bf16 v[80:95], v[44:47], a[12:15], v[80:95]
 ds_read_b128 v[60:63], v7 offset:39936
 s_waitcnt lgkmcnt(3)
 v_mfma_f32_32x32x16_bf16 v[80:95], v[48:51], a[16:19], v[80:95]
 s_waitcnt vmcnt(4)
 s_barrier
 ds_read_b128 v[32:35], v7 offset:40960
 s_waitcnt lgkmcnt(3)
 v_mfma_f32_32x32x16_bf16 v[80:95], v[52:55], a[20:23], v[80:95]
 ds_read_b128 v[36:39], v7 offset:41984
 s_waitcnt lgkmcnt(3)
 v_mfma_f32_32x32x16_bf16 v[80:95], v[56:59], a[24:27], v[80:95]
 ds_read_b128 v[40:43], v7 offset:43008
 s_waitcnt lgkmcnt(3)
 v_mfma_f32_32x32x16_bf16 v[80:95], v[60:63], a[28:31], v[80:95]
 ds_read_b128 v[44:47], v7 offset:44032
 s_waitcnt lgkmcnt(3)
 v_mfma_f32_32x32x16_bf16 v[80:95], v[32:35], a[32:35], v[80:95]
 ds_read_b128 v[48:51], v7 offset:45056
 s_waitcnt lgkmcnt(3)
 v_mfma_f32_32x32x16_bf16 v[80:95], v[36:39], a[36:39], v[80:95]
 ds_read_b128 v[52:55], v7 offset:46080
 s_waitcnt lgkmcnt(3)
 v_mfma_f32_32x32x16_bf16 v[80:95], v[40:43], a[40:43], v[80:95]
 ds_read_b128 v[56:59], v7 offset:47104
 s_waitcnt lgkmcnt(3)
 v_mfma_f32_32x32x16_bf16 v[80:95], v[44:47], a[44:47], v[80:95]
 ds_read_b128 v[60:63], v7 offset:48128
 s_waitcnt lgkmcnt(3)
 v_mfma_f32_32x32x16_bf16 v[80:95], v[48:51], a[48:51], v[80:95]
 s_waitcnt vmcnt(2)
 s_barrier
 ds_read_b128 v[32:35], v7 offset:49152
 s_waitcnt lgkmcnt(3)
 v_mfma_f32_32x32x16_bf16 v[80:95], v[52:55], a[52:55], v[80:95]
 ds_read_b128 v[36:39], v7 offset:50176
 s_waitcnt lgkmcnt(3)
 v_mfma_f32_32x32x16_bf16 v[80:95], v[56:59], a[56:59], v[80:95]
 ds_read_b128 v[40:43], v7 offset:51200
 s_waitcnt lgkmcnt(3)
 v_mfma_f32_32x32x16_bf16 v[80:95], v[60:63], a[60:63], v[80:95]
 ds_read_b128 v[44:47], v7 offset:52224
 s_waitcnt lgkmcnt(3)
 v_mfma_f32_32x32x16_bf16 v[80:95], v[32:35], a[64:67], v[80:95]
 ds_read_b128 v[48:51], v7 offset:53248
 s_waitcnt lgkmcnt(3)
 v_mfma_f32_32x32x16_bf16 v[80:95], v[36:39], a[68:71], v[80:95]
 ds_read_b128 v[52:55], v7 offset:54272
 s_waitcnt lgkmcnt(3)
 v_mfma_f32_32x32x16_bf16 v[80:95], v[40:43], a[72:75], v[80:95]
 ds_read_b128 v[56:59], v7 offset:55296
 s_waitcnt lgkmcnt(3)
 v_mfma_f32_32x32x16_bf16 v[80:95], v[44:47], a[76:79], v[80:95]
 ds_read_b128 v[60:63], v7 offset:56320
 s_waitcnt lgkmcnt(3)
 v_mfma_f32_32x32x16_bf16 v[80:95], v[48:51], a[80:83], v[80:95]
 s_waitcnt vmcnt(0)
 s_barrier
 ds_read_b128 v[32:35], v7 offset:57344
 s_waitcnt lgkmcnt(3)
 v_mfma_f32_32x32x16_bf16 v[80:95], v[52:55], a[84:87], v[80:95]
 ds_read_b128 v[36:39], v7 offset:58368
 s_waitcnt lgkmcnt(3)
 v_mfma_f32_32x32x16_bf16 v[80:95], v[56:59], a[88:91], v[80:95]
 ds_read_b128 v[40:43], v7 offset:59392
 s_waitcnt lgkmcnt(3)
 v_mfma_f32_32x32x16_bf16 v[80:95], v[60:63], a[92:95], v[80:95]
 ds_read_b128 v[44:47], v7 offset:60416
 s_waitcnt lgkmcnt(3)
 v_mfma_f32_32x32x16_bf16 v[80:95], v[32:35], a[96:99], v[80:95]
 ds_read_b128 v[48:51], v7 offset:61440
 s_waitcnt lgkmcnt(3)
 v_mfma_f32_32x32x16_bf16 v[80:95], v[36:39], a[100:103], v[80:95]
 ds_read_b128 v[52:55], v7 offset:62464
 s_waitcnt lgkmcnt(3)
 v_mfma_f32_32x32x16_bf16 v[80:95], v[40:43], a[104:107], v[80:95]
 ds_read_b128 v[56:59], v7 offset:63488
 s_waitcnt lgkmcnt(3)
 v_mfma_f32_32x32x16_bf16 v[80:95], v[44:47], a[108:111], v[80:95]
 ds_read_b128 v[60:63], v7 offset:64512
 s_waitcnt lgkmcnt(3)
 v_mfma_f32_32x32x16_bf16 v[80:95], v[48:51], a[112:115], v[80:95]
 s_waitcnt lgkmcnt(2)
 v_mfma_f32_32x32x16_bf16 v[80:95], v[52:55], a[116:119], v[80:95]
 s_waitcnt lgkmcnt(1)
 v_mfma_f32_32x32x16_bf16 v[80:95], v[56:59], a[120:123], v[80:95]
 s_waitcnt lgkmcnt(0)
 v_mfma_f32_32x32x16_bf16 v[80:95], v[60:63], a[124:127], v[80:95]
 s_mul_i32 s55, s60, 655360
 s_add_u32 s55, s55, s58
 s_add_u32 s55, s55, 41943040
 s_cmp_lt_u32 s60, 64
 s_cselect_b32 s55, s55, 268435456
 s_nop 7
 s_add_u32 s3, s55, 0
 buffer_store_dword v80, v4, s[4:7], s3 offen sc1
 s_add_u32 s3, s55, 2560
 buffer_store_dword v81, v4, s[4:7], s3 offen sc1
 s_add_u32 s3, s55, 5120
 buffer_store_dword v82, v4, s[4:7], s3 offen sc1
 s_add_u32 s3, s55, 7680
 buffer_store_dword v83, v4, s[4:7], s3 offen sc1
 s_add_u32 s3, s55, 20480
 buffer_store_dword v84, v4, s[4:7], s3 offen sc1
 s_add_u32 s3, s55, 23040
 buffer_store_dword v85, v4, s[4:7], s3 offen sc1
 s_add_u32 s3, s55, 25600
 buffer_store_dword v86, v4, s[4:7], s3 offen sc1
 s_add_u32 s3, s55, 28160
 buffer_store_dword v87, v4, s[4:7], s3 offen sc1
 s_add_u32 s3, s55, 40960
 buffer_store_dword v88, v4, s[4:7], s3 offen sc1
 s_add_u32 s3, s55, 43520
 buffer_store_dword v89, v4, s[4:7], s3 offen sc1
 s_add_u32 s3, s55, 46080
 buffer_store_dword v90, v4, s[4:7], s3 offen sc1
 s_add_u32 s3, s55, 48640
 buffer_store_dword v91, v4, s[4:7], s3 offen sc1
 s_add_u32 s3, s55, 61440
 buffer_store_dword v92, v4, s[4:7], s3 offen sc1
 s_add_u32 s3, s55, 64000
 buffer_store_dword v93, v4, s[4:7], s3 offen sc1
 s_add_u32 s3, s55, 66560
 buffer_store_dword v94, v4, s[4:7], s3 offen sc1
 s_add_u32 s3, s55, 69120
 buffer_store_dword v95, v4, s[4:7], s3 offen sc1
L_e_131:
 s_add_u32 s54, s54, 1
 s_branch L_wo_loop
L_t4:
 s_lshr_b32 s53, s50, 1
 s_and_b32 s54, s50, 1
 v_lshlrev_b32 v1, 4, v0
 v_mov_b32 v72, 0
 s_lshl_b32 s3, s50, 2
 s_add_u32 s3, s3, 163776
 v_mov_b32 v73, s3
 ds_write_b32 v73, v72
 s_cmp_lg_u32 s50, 0
 s_cbranch_scc1 L_ww_135
 s_mov_b32 s96, s44
 s_and_b32 s97, s45, 0xffff
 s_mov_b32 s98, 256
 s_mov_b32 s99, 0x00020000
 v_mov_b32 v12, 136
 s_mov_b32 s51, 0
 s_mov_b64 exec, 1
L_wb_136:
 buffer_load_dword v13, v12, s[96:99], 0 offen sc1
 s_waitcnt vmcnt(0)
 v_cmp_eq_u32 vcc, 0, v13
 s_cbranch_vccz L_wbd_137
 s_sleep 2
 s_add_u32 s51, s51, 1
 s_cmp_lt_u32 s51, 131072
 s_cbranch_scc1 L_wb_136
 s_branch L_bail
L_wbd_137:
 s_mov_b64 exec, -1
L_ww_135:
 s_barrier
 s_mul_i32 s55, s52, 40960
 s_mul_i32 s56, s50, 10240
 s_add_u32 s55, s55, s56
 s_add_u32 s55, s55, 234356736
 s_add_u32 m0, s56, 0
 s_add_u32 s3, s55, 0
 buffer_load_dwordx4 v1, s[4:7], s3 offen offset:0 sc1 lds
 buffer_load_dwordx4 v1, s[4:7], s3 offen offset:1024 sc1 lds
 s_add_u32 m0, s56, 2048
 s_add_u32 s3, s55, 2048
 buffer_load_dwordx4 v1, s[4:7], s3 offen offset:0 sc1 lds
 buffer_load_dwordx4 v1, s[4:7], s3 offen offset:1024 sc1 lds
 s_add_u32 m0, s56, 4096
 s_add_u32 s3, s55, 4096
 buffer_load_dwordx4 v1, s[4:7], s3 offen offset:0 sc1 lds
 buffer_load_dwordx4 v1, s[4:7], s3 offen offset:1024 sc1 lds
 s_add_u32 m0, s56, 6144
 s_add_u32 s3, s55, 6144
 buffer_load_dwordx4 v1, s[4:7], s3 offen offset:0 sc1 lds
 buffer_load_dwordx4 v1, s[4:7], s3 offen offset:1024 sc1 lds
 s_add_u32 m0, s56, 8192
 s_add_u32 s3, s55, 8192
 buffer_load_dwordx4 v1, s[4:7], s3 offen offset:0 sc1 lds
 buffer_load_dwordx4 v1, s[4:7], s3 offen offset:1024 sc1 lds
 s_waitcnt vmcnt(0) lgkmcnt(0)
 s_barrier
 s_cmp_eq_u32 s53, 0
 s_cbranch_scc1 L_e0_138
 s_lshl_b32 s60, s52, 1
 s_and_b32 s3, s50, 1
 s_add_u32 s60, s60, s3
 s_mul_i32 s71, s3, 13312
 s_add_u32 s71, s71, 131072
 s_add_u32 s72, s60, 1024
 s_mov_b32 s8, s16
 s_and_b32 s9, s17, 0xffff
 s_mov_b32 s10, 2621440
 s_mov_b32 s11, 0x00020000
 v_lshlrev_b32 v1, 4, v0
 v_lshlrev_b32 v2, 3, v0
 v_cmp_lt_u32 vcc, 31, v0
 v_mov_b32 v3, 268435456
 s_nop 1
 v_cndmask_b32 v7, v2, v3, vcc
 s_mov_b32 s63, 0x3acccccd
 s_mov_b32 s68, 0x3727c5ac
 s_add_u32 s3, s72, 0
 s_mul_i32 s3, s3, 1280
 buffer_load_dwordx2 v[48:49], v2, s[8:11], s3 offen offset:0
 buffer_load_dwordx2 v[50:51], v2, s[8:11], s3 offen offset:512
 buffer_load_dwordx2 v[52:53], v7, s[8:11], s3 offen offset:1024
 s_waitcnt vmcnt(0)
L_ln_139:
 v_lshlrev_b32 v12, 16, v48
 v_and_b32 v13, 0xffff0000, v48
 v_lshlrev_b32 v14, 16, v49
 v_and_b32 v15, 0xffff0000, v49
 v_lshlrev_b32 v16, 16, v50
 v_and_b32 v17, 0xffff0000, v50
 v_lshlrev_b32 v18, 16, v51
 v_and_b32 v19, 0xffff0000, v51
 v_lshlrev_b32 v20, 16, v52
 v_and_b32 v21, 0xffff0000, v52
 v_lshlrev_b32 v22, 16, v53
 v_and_b32 v23, 0xffff0000, v53
 s_add_u32 s3, s72, 64
 s_mul_i32 s3, s3, 1280
 buffer_load_dwordx2 v[48:49], v2, s[8:11], s3 offen offset:0
 buffer_load_dwordx2 v[50:51], v2, s[8:11], s3 offen offset:512
 buffer_load_dwordx2 v[52:53], v7, s[8:11], s3 offen offset:1024
 s_and_b32 s3, s72, 15
 v_lshrrev_b32 v4, 3, v0
 v_lshlrev_b32 v4, 2, v4
 v_and_b32 v9, 3, v0
 v_add_u32 v4, v4, v9
 v_xor_b32 v4, s3, v4
 v_lshlrev_b32 v4, 4, v4
 v_and_b32 v9, 4, v0
 v_lshl_add_u32 v4, v9, 1, v4
 v_cndmask_b32 v8, v4, v3, vcc
 v_readfirstlane_b32 s3, v12
 s_nop 1
 v_subrev_f32 v36, s3, v12
 v_subrev_f32 v37, s3, v13
 v_subrev_f32 v38, s3, v14
 v_subrev_f32 v39, s3, v15
 v_subrev_f32 v40, s3, v16
 v_subrev_f32 v41, s3, v17
 v_subrev_f32 v42, s3, v18
 v_subrev_f32 v43, s3, v19
 v_mov_b32 v44, 0
 v_mov_b32 v45, 0
 v_mov_b32 v46, 0
 v_mov_b32 v47, 0
 s_mov_b32 exec_hi, 0
 v_subrev_f32 v44, s3, v20
 v_subrev_f32 v45, s3, v21
 v_subrev_f32 v46, s3, v22
 v_subrev_f32 v47, s3, v23
 s_mov_b32 exec_hi, -1
 v_pk_mul_f32 v[10:11], v[36:37], v[36:37]
 v_pk_fma_f32 v[10:11], v[38:39], v[38:39], v[10:11]
 v_pk_fma_f32 v[10:11], v[40:41], v[40:41], v[10:11]
 v_pk_fma_f32 v[10:11], v[42:43], v[42:43], v[10:11]
 v_pk_fma_f32 v[10:11], v[44:45], v[44:45], v[10:11]
 v_pk_fma_f32 v[10:11], v[46:47], v[46:47], v[10:11]
 v_pk_add_f32 v[36:37], v[36:37], v[38:39]
 v_pk_add_f32 v[36:37], v[36:37], v[40:41]
 v_pk_add_f32 v[36:37], v[36:37], v[42:43]
 v_pk_add_f32 v[36:37], v[36:37], v[44:45]
 v_pk_add_f32 v[36:37], v[36:37], v[46:47]
 v_add_f32 v11, v10, v11
 v_add_f32 v10, v36, v37
 s_nop 0
 v_add_f32_dpp v11, v11, v11 quad_perm:[1,0,3,2] row_mask:0xf bank_mask:0xf
 v_add_f32_dpp v10, v10, v10 quad_perm:[1,0,3,2] row_mask:0xf bank_mask:0xf
 s_nop 0
 v_add_f32_dpp v11, v11, v11 quad_perm:[2,3,0,1] row_mask:0xf bank_mask:0xf
 v_add_f32_dpp v10, v10, v10 quad_perm:[2,3,0,1] row_mask:0xf bank_mask:0xf
 s_nop 0
 v_add_f32_dpp v11, v11, v11 row_half_mirror row_mask:0xf bank_mask:0xf
 v_add_f32_dpp v10, v10, v10 row_half_mirror row_mask:0xf bank_mask:0xf
 s_nop 0
 v_add_f32_dpp v11, v11, v11 row_mirror row_mask:0xf bank_mask:0xf
 v_add_f32_dpp v10, v10, v10 row_mirror row_mask:0xf bank_mask:0xf
 v_mov_b32 v37, v11
 v_mov_b32 v36, v10
 s_nop 0
 v_permlane16_swap_b32 v11, v37
 v_permlane16_swap_b32 v10, v36
 v_pk_add_f32 v[10:11], v[10:11], v[36:37]
 v_mov_b32 v37, v11
 v_mov_b32 v36, v10
 s_nop 0
 v_permlane32_swap_b32 v11, v37
 v_permlane32_swap_b32 v10, v36
 v_pk_add_f32 v[10:11], v[10:11], v[36:37]
 v_mul_f32 v10, s63, v10
 v_mul_f32 v11, s63, v11
 v_fma_f32 v11, -v10, v10, v11
 v_max_f32 v11, 0, v11
 v_add_f32 v10, s3, v10
 v_cvt_pk_bf16_f32 v9, v10, v11
 v_lshlrev_b32 v10, 16, v9
 v_and_b32 v11, 0xffff0000, v9
 v_add_f32 v11, s68, v11
 v_cvt_pk_bf16_f32 v11, v11, v11
 v_and_b32 v11, 0xffff0000, v11
 v_sqrt_f32 v11, v11
 s_nop 0
 v_pk_add_f32 v[36:37], v[12:13], v[10:11] op_sel_hi:[1,0] neg_lo:[0,1] neg_hi:[0,1]
 v_pk_add_f32 v[38:39], v[14:15], v[10:11] op_sel_hi:[1,0] neg_lo:[0,1] neg_hi:[0,1]
 v_pk_add_f32 v[40:41], v[16:17], v[10:11] op_sel_hi:[1,0] neg_lo:[0,1] neg_hi:[0,1]
 v_pk_add_f32 v[42:43], v[18:19], v[10:11] op_sel_hi:[1,0] neg_lo:[0,1] neg_hi:[0,1]
 v_pk_add_f32 v[44:45], v[20:21], v[10:11] op_sel_hi:[1,0] neg_lo:[0,1] neg_hi:[0,1]
 v_pk_add_f32 v[46:47], v[22:23], v[10:11] op_sel_hi:[1,0] neg_lo:[0,1] neg_hi:[0,1]
 v_cvt_pk_bf16_f32 v11, v11, v11
 v_and_b32 v11, 0xffff0000, v11
 v_rcp_f32 v11, v11
 v_cvt_pk_bf16_f32 v9, v36, v37
 v_lshlrev_b32 v36, 16, v9
 v_and_b32 v37, 0xffff0000, v9
 v_cvt_pk_bf16_f32 v9, v38, v39
 v_lshlrev_b32 v38, 16, v9
 v_and_b32 v39, 0xffff0000, v9
 v_cvt_pk_bf16_f32 v9, v40, v41
 v_lshlrev_b32 v40, 16, v9
 v_and_b32 v41, 0xffff0000, v9
 v_cvt_pk_bf16_f32 v9, v42, v43
 v_lshlrev_b32 v42, 16, v9
 v_and_b32 v43, 0xffff0000, v9
 v_cvt_pk_bf16_f32 v9, v44, v45
 v_lshlrev_b32 v44, 16, v9
 v_and_b32 v45, 0xffff0000, v9
 v_cvt_pk_bf16_f32 v9, v46, v47
 v_lshlrev_b32 v46, 16, v9
 v_and_b32 v47, 0xffff0000, v9
 v_pk_mul_f32 v[36:37], v[36:37], v[10:11] op_sel:[0,1] op_sel_hi:[1,1]
 v_pk_mul_f32 v[38:39], v[38:39], v[10:11] op_sel:[0,1] op_sel_hi:[1,1]
 v_pk_mul_f32 v[40:41], v[40:41], v[10:11] op_sel:[0,1] op_sel_hi:[1,1]
 v_pk_mul_f32 v[42:43], v[42:43], v[10:11] op_sel:[0,1] op_sel_hi:[1,1]
 v_pk_mul_f32 v[44:45], v[44:45], v[10:11] op_sel:[0,1] op_sel_hi:[1,1]
 v_pk_mul_f32 v[46:47], v[46:47], v[10:11] op_sel:[0,1] op_sel_hi:[1,1]
 v_cvt_pk_bf16_f32 v24, v36, v37
 v_cvt_pk_bf16_f32 v25, v38, v39
 v_cvt_pk_bf16_f32 v26, v40, v41
 v_cvt_pk_bf16_f32 v27, v42, v43
 v_cvt_pk_bf16_f32 v28, v44, v45
 v_cvt_pk_bf16_f32 v29, v46, v47
 s_mul_i32 s3, s72, 1280
 s_add_u32 s3, s3, 226492416
 buffer_store_dwordx2 v[24:25], v4, s[4:7], s3 offen offset:0 sc1
 buffer_store_dwordx2 v[26:27], v4, s[4:7], s3 offen offset:512 sc1
 buffer_store_dwordx2 v[28:29], v8, s[4:7], s3 offen offset:1024 sc1
 s_add_u32 s72, s72, 64
 s_waitcnt vmcnt(3)
 s_cmp_lt_u32 s72, 2048
 s_cbranch_scc1 L_ln_139
 s_waitcnt vmcnt(0)
 s_mov_b32 s96, s44
 s_and_b32 s97, s45, 0xffff
 s_mov_b32 s98, 256
 s_mov_b32 s99, 0x00020000
 v_mov_b32 v1, 1
 s_mov_b64 exec, 1
 buffer_atomic_add v1, off, s[96:99], 0 offset:12 sc0
 s_waitcnt vmcnt(0)
 v_cmp_eq_u32 vcc, 63, v1
 s_cbranch_vccz L_aw_140
 buffer_store_dword v1, off, s[96:99], 0 offset:140 sc1
L_aw_140:
 s_mov_b64 exec, -1
 s_mov_b32 s70, s60
 s_mov_b32 s69, 96
 s_mov_b32 s96, s44
 s_and_b32 s97, s45, 0xffff
 s_mov_b32 s98, 256
 s_mov_b32 s99, 0x00020000
 v_mov_b32 v1, 196
 s_mov_b32 s51, 0
 s_mov_b64 exec, 1
L_wb_141:
 buffer_load_dword v2, v1, s[96:99], 0 offen sc1
 s_waitcnt vmcnt(0)
 v_cmp_eq_u32 vcc, 0, v2
 s_cbranch_vccz L_wbd_142
 s_sleep 2
 s_add_u32 s51, s51, 1
 s_cmp_lt_u32 s51, 131072
 s_cbranch_scc1 L_wb_141
 s_branch L_bail
L_wbd_142:
 s_mov_b64 exec, -1
 s_mov_b32 s96, s44
 s_and_b32 s97, s45, 0xffff
 s_mov_b32 s98, 256
 s_mov_b32 s99, 0x00020000
 v_mov_b32 v1, 208
 s_mov_b32 s51, 0
 s_mov_b64 exec, 1
L_wb_143:
 buffer_load_dword v2, v1, s[96:99], 0 offen sc1
 s_waitcnt vmcnt(0)
 v_cmp_eq_u32 vcc, 0, v2
 s_cbranch_vccz L_wbd_144
 s_sleep 2
 s_add_u32 s51, s51, 1
 s_cmp_lt_u32 s51, 131072
 s_cbranch_scc1 L_wb_143
 s_branch L_bail
L_wbd_144:
 s_mov_b64 exec, -1
 s_mov_b32 s8, s38
 s_and_b32 s9, s39, 0xffff
 s_mov_b32 s10, 2621440
 s_mov_b32 s11, 0x00020000
 s_mov_b32 s12, s40
 s_and_b32 s13, s41, 0xffff
 s_mov_b32 s14, 1280
 s_mov_b32 s15, 0x00020000
 v_lshlrev_b32 v130, 4, v0
 s_lshl_b32 s73, s70, 12
 s_add_u32 s74, s73, 2
 buffer_load_dwordx4 v[96:99], v130, s[8:11], s73 offen offset:0
 buffer_load_dwordx4 v[100:103], v130, s[8:11], s73 offen offset:1024
 buffer_load_dwordx4 v[104:107], v130, s[8:11], s73 offen offset:2048
 buffer_load_dwordx4 v[108:111], v130, s[8:11], s73 offen offset:3072
 buffer_load_dwordx4 v[112:115], v130, s[8:11], s74 offen offset:0
 buffer_load_dwordx4 v[116:119], v130, s[8:11], s74 offen offset:1024
 buffer_load_dwordx4 v[120:123], v130, s[8:11], s74 offen offset:2048
 buffer_load_dwordx4 v[124:127], v130, s[8:11], s74 offen offset:3072
 s_lshl_b32 s3, s70, 1
 buffer_load_ushort v128, off, s[12:15], s3
 s_lshl_b32 s3, s70, 12
 s_add_u32 s3, s3, 231735296
 buffer_load_dwordx4 v[240:243], v130, s[4:7], s3 offen offset:0 sc1
 buffer_load_dwordx4 v[244:247], v130, s[4:7], s3 offen offset:1024 sc1
 buffer_load_dwordx4 v[248:251], v130, s[4:7], s3 offen offset:2048 sc1
 buffer_load_dwordx4 v[252:255], v130, s[4:7], s3 offen offset:3072 sc1
 s_getpc_b64 s[76:77]
L_ca_145:
 s_add_u32 s76, s76, L_conv1-L_ca_145
 s_addc_u32 s77, s77, -1
 s_swappc_b64 s[76:77], s[76:77]
 s_waitcnt vmcnt(0)
 s_mov_b32 s96, s44
 s_and_b32 s97, s45, 0xffff
 s_mov_b32 s98, 256
 s_mov_b32 s99, 0x00020000
 v_mov_b32 v1, 1
 s_mov_b64 exec, 1
 buffer_atomic_add v1, off, s[96:99], 0 offset:76 sc0
 s_waitcnt vmcnt(0)
 v_cmp_eq_u32 vcc, 95, v1
 s_cbranch_vccz L_aw_146
 buffer_store_dword v1, off, s[96:99], 0 offset:204 sc1
L_aw_146:
 s_mov_b64 exec, -1
 s_mov_b32 s96, s44
 s_and_b32 s97, s45, 0xffff
 s_mov_b32 s98, 256
 s_mov_b32 s99, 0x00020000
 v_mov_b32 v1, 204
 s_mov_b32 s51, 0
 s_mov_b64 exec, 1
L_wb_147:
 buffer_load_dword v2, v1, s[96:99], 0 offen sc1
 s_waitcnt vmcnt(0)
 v_cmp_eq_u32 vcc, 0, v2
 s_cbranch_vccz L_wbd_148
 s_sleep 2
 s_add_u32 s51, s51, 1
 s_cmp_lt_u32 s51, 131072
 s_cbranch_scc1 L_wb_147
 s_branch L_bail
L_wbd_148:
 s_mov_b64 exec, -1
 v_lshlrev_b32 v1, 4, v0
 s_mul_i32 s55, s52, 40960
 s_mul_i32 s56, s54, 20480
 s_add_u32 s55, s55, s56
 s_add_u32 s55, s55, 235667456
 s_add_u32 m0, s56, 40960
 s_add_u32 s3, s55, 0
 buffer_load_dwordx4 v1, s[4:7], s3 offen offset:0 sc1 lds
 buffer_load_dwordx4 v1, s[4:7], s3 offen offset:1024 sc1 lds
 s_add_u32 m0, s56, 43008
 s_add_u32 s3, s55, 2048
 buffer_load_dwordx4 v1, s[4:7], s3 offen offset:0 sc1 lds
 buffer_load_dwordx4 v1, s[4:7], s3 offen offset:1024 sc1 lds
 s_add_u32 m0, s56, 45056
 s_add_u32 s3, s55, 4096
 buffer_load_dwordx4 v1, s[4:7], s3 offen offset:0 sc1 lds
 buffer_load_dwordx4 v1, s[4:7], s3 offen offset:1024 sc1 lds
 s_add_u32 m0, s56, 47104
 s_add_u32 s3, s55, 6144
 buffer_load_dwordx4 v1, s[4:7], s3 offen offset:0 sc1 lds
 buffer_load_dwordx4 v1, s[4:7], s3 offen offset:1024 sc1 lds
 s_add_u32 m0, s56, 49152
 s_add_u32 s3, s55, 8192
 buffer_load_dwordx4 v1, s[4:7], s3 offen offset:0 sc1 lds
 buffer_load_dwordx4 v1, s[4:7], s3 offen offset:1024 sc1 lds
 s_add_u32 m0, s56, 51200
 s_add_u32 s3, s55, 10240
 buffer_load_dwordx4 v1, s[4:7], s3 offen offset:0 sc1 lds
 buffer_load_dwordx4 v1, s[4:7], s3 offen offset:1024 sc1 lds
 s_add_u32 m0, s56, 53248
 s_add_u32 s3, s55, 12288
 buffer_load_dwordx4 v1, s[4:7], s3 offen offset:0 sc1 lds
 buffer_load_dwordx4 v1, s[4:7], s3 offen offset:1024 sc1 lds
 s_add_u32 m0, s56, 55296
 s_add_u32 s3, s55, 14336
 buffer_load_dwordx4 v1, s[4:7], s3 offen offset:0 sc1 lds
 buffer_load_dwordx4 v1, s[4:7], s3 offen offset:1024 sc1 lds
 s_add_u32 m0, s56, 57344
 s_add_u32 s3, s55, 16384
 buffer_load_dwordx4 v1, s[4:7], s3 offen offset:0 sc1 lds
 buffer_load_dwordx4 v1, s[4:7], s3 offen offset:1024 sc1 lds
 s_add_u32 m0, s56, 59392
 s_add_u32 s3, s55, 18432
 buffer_load_dwordx4 v1, s[4:7], s3 offen offset:0 sc1 lds
 buffer_load_dwordx4 v1, s[4:7], s3 offen offset:1024 sc1 lds
 s_waitcnt vmcnt(0) lgkmcnt(0)
 s_lshl_b32 s3, s50, 2
 s_add_u32 s3, s3, 163776
 v_mov_b32 v73, s3
 v_mov_b32 v72, 1
 ds_write_b32 v73, v72
L_e0_138:
 s_lshl_b32 s3, s54, 2
 s_add_u32 s3, s3, 163776
 v_mov_b32 v73, s3
 s_mov_b32 s8, s16
 s_and_b32 s9, s17, 0xffff
 s_mov_b32 s10, 2621440
 s_mov_b32 s11, 0x00020000
 s_mov_b32 s12, s42
 s_and_b32 s13, s43, 0xffff
 s_mov_b32 s14, 2621440
 s_mov_b32 s15, 0x00020000
 v_lshlrev_b32 v1, 4, v0
 v_lshlrev_b32 v2, 3, v0
 v_cmp_lt_u32 vcc, 31, v0
 v_mov_b32 v3, 268435456
 s_nop 1
 v_cndmask_b32 v6, v1, v3, vcc
 v_cndmask_b32 v7, v2, v3, vcc
 s_and_b32 s3, s52, 15
 v_lshrrev_b32 v4, 3, v0
 v_lshlrev_b32 v4, 2, v4
 v_and_b32 v10, 3, v0
 v_add_u32 v4, v4, v10
 v_xor_b32 v4, s3, v4
 v_lshlrev_b32 v4, 4, v4
 v_and_b32 v10, 4, v0
 v_lshl_add_u32 v4, v10, 1, v4
 v_cndmask_b32 v8, v4, v3, vcc
 s_lshl_b32 s3, s52, 9
 s_lshl_b32 s55, s53, 8
 s_add_u32 s3, s3, s55
 s_add_u32 s3, s3, 61440
 v_mul_u32_u24 v5, 16384, v0
 v_add_u32 v5, s3, v5
 s_sub_u32 s3, s3, 4
 v_writelane_b32 v5, s3, 4
 v_lshlrev_b32 v68, 8, v0
 s_mov_b32 s57, 0x3acccccd
 s_mov_b32 s58, 0x3727c5ac
L_t4_loop:
 s_lshl_b32 s60, s54, 5
 s_add_u32 s60, s60, s52
 s_mul_i32 s60, s60, 1280
 s_cmp_eq_u32 s53, 0
 s_cselect_b32 s3, s60, 268435456
 buffer_load_dwordx2 v[48:49], v2, s[8:11], s3 offen offset:0
 buffer_load_dwordx2 v[50:51], v2, s[8:11], s3 offen offset:512
 buffer_load_dwordx2 v[52:53], v7, s[8:11], s3 offen offset:1024
 s_and_b32 s3, s54, 62
 s_cmp_lg_u32 s3, 32
 s_cbranch_scc1 L_yhd_150
 v_mov_b32 v3, 163784
 s_mov_b32 s51, 0
L_yh_149:
 ds_read_b64 v[24:25], v3
 s_waitcnt lgkmcnt(0)
 v_and_b32 v24, v24, v25
 v_cmp_eq_u32 vcc, 0, v24
 s_cbranch_vccz L_yhd_150
 s_sleep 8
 s_add_u32 s51, s51, 1
 s_cmp_lt_u32 s51, 131072
 s_cbranch_scc1 L_yh_149
 s_branch L_bail
L_yhd_150:
 s_and_b32 s3, s54, 7
 s_lshl_b32 s3, s3, 3
 s_bfe_u32 s55, s54, 0x20003
 s_lshl_b32 s55, s55, 1
 s_add_u32 s3, s3, s55
 s_lshr_b32 s55, s54, 5
 s_mul_i32 s55, s55, 40960
 s_add_u32 s3, s3, s55
 v_lshlrev_b32 v72, 8, v0
 v_add_u32 v72, s3, v72
 ds_read_u16 v24, v72 offset:0
 ds_read_u16 v25, v72 offset:64
 ds_read_u16 v26, v72 offset:128
 ds_read_u16 v27, v72 offset:192
 ds_read_u16 v28, v72 offset:16384
 ds_read_u16 v29, v72 offset:16448
 ds_read_u16 v30, v72 offset:16512
 ds_read_u16 v31, v72 offset:16576
 v_mov_b32 v32, 0
 v_mov_b32 v33, 0
 v_mov_b32 v34, 0
 v_mov_b32 v35, 0
 s_mov_b32 exec_hi, 0
 ds_read_u16 v32, v72 offset:32768
 ds_read_u16 v33, v72 offset:32832
 ds_read_u16 v34, v72 offset:32896
 ds_read_u16 v35, v72 offset:32960
 s_mov_b32 exec_hi, -1
 s_waitcnt vmcnt(0) lgkmcnt(0)
 v_lshlrev_b32 v24, 16, v24
 v_lshlrev_b32 v25, 16, v25
 v_lshlrev_b32 v26, 16, v26
 v_lshlrev_b32 v27, 16, v27
 v_lshlrev_b32 v28, 16, v28
 v_lshlrev_b32 v29, 16, v29
 v_lshlrev_b32 v30, 16, v30
 v_lshlrev_b32 v31, 16, v31
 v_lshlrev_b32 v32, 16, v32
 v_lshlrev_b32 v33, 16, v33
 v_lshlrev_b32 v34, 16, v34
 v_lshlrev_b32 v35, 16, v35
 v_lshlrev_b32 v12, 16, v48
 v_and_b32 v13, 0xffff0000, v48
 v_lshlrev_b32 v14, 16, v49
 v_and_b32 v15, 0xffff0000, v49
 v_lshlrev_b32 v16, 16, v50
 v_and_b32 v17, 0xffff0000, v50
 v_lshlrev_b32 v18, 16, v51
 v_and_b32 v19, 0xffff0000, v51
 v_lshlrev_b32 v20, 16, v52
 v_and_b32 v21, 0xffff0000, v52
 v_lshlrev_b32 v22, 16, v53
 v_and_b32 v23, 0xffff0000, v53
 s_lshl_b32 s55, s54, 2
 s_mov_b32 s51, 0
 s_mov_b64 exec, 31
L_tw_151:
 v_mov_b32 v3, 0
 buffer_atomic_add v3, v5, s[4:7], s55 offen sc0
 s_waitcnt vmcnt(0)
 v_cmp_gt_u32 vcc, 10, v3
 s_and_b32 s3, vcc_lo, 15
 s_cbranch_scc0 L_twd_152
 s_bitcmp0_b32 vcc_lo, 4
 s_cbranch_scc1 L_twf_153
 s_cmp_eq_u32 s54, 0
 s_cbranch_scc1 L_twf_153
 s_sleep 24
L_twf_153:
 s_sleep 8
 s_add_u32 s51, s51, 1
 s_cmp_lt_u32 s51, 131072
 s_cbranch_scc1 L_tw_151
 s_branch L_bail
L_twd_152:
 s_mov_b64 exec, -1
 s_lshl_b32 s55, s53, 6
 s_add_u32 s55, s55, s54
 s_mul_i32 s55, s55, 655360
 s_mul_i32 s3, s52, 2560
 s_add_u32 s55, s55, s3
 s_add_u32 s55, s55, 142606336
 buffer_load_dwordx4 v[80:83], v1, s[4:7], s55 offen offset:0 sc1 nt
 buffer_load_dwordx4 v[84:87], v1, s[4:7], s55 offen offset:1024 sc1 nt
 buffer_load_dwordx4 v[88:91], v6, s[4:7], s55 offen offset:2048 sc1 nt
 s_add_u32 s55, s55, 81920
 buffer_load_dwordx4 v[92:95], v1, s[4:7], s55 offen offset:0 sc1 nt
 buffer_load_dwordx4 v[96:99], v1, s[4:7], s55 offen offset:1024 sc1 nt
 buffer_load_dwordx4 v[100:103], v6, s[4:7], s55 offen offset:2048 sc1 nt
 s_add_u32 s55, s55, 81920
 buffer_load_dwordx4 v[104:107], v1, s[4:7], s55 offen offset:0 sc1 nt
 buffer_load_dwordx4 v[108:111], v1, s[4:7], s55 offen offset:1024 sc1 nt
 buffer_load_dwordx4 v[112:115], v6, s[4:7], s55 offen offset:2048 sc1 nt
 s_add_u32 s55, s55, 81920
 buffer_load_dwordx4 v[116:119], v1, s[4:7], s55 offen offset:0 sc1 nt
 buffer_load_dwordx4 v[120:123], v1, s[4:7], s55 offen offset:1024 sc1 nt
 buffer_load_dwordx4 v[124:127], v6, s[4:7], s55 offen offset:2048 sc1 nt
 s_add_u32 s55, s55, 81920
 buffer_load_dwordx4 v[128:131], v1, s[4:7], s55 offen offset:0 sc1 nt
 buffer_load_dwordx4 v[132:135], v1, s[4:7], s55 offen offset:1024 sc1 nt
 buffer_load_dwordx4 v[136:139], v6, s[4:7], s55 offen offset:2048 sc1 nt
 s_add_u32 s55, s55, 81920
 buffer_load_dwordx4 v[140:143], v1, s[4:7], s55 offen offset:0 sc1 nt
 buffer_load_dwordx4 v[144:147], v1, s[4:7], s55 offen offset:1024 sc1 nt
 buffer_load_dwordx4 v[148:151], v6, s[4:7], s55 offen offset:2048 sc1 nt
 s_add_u32 s55, s55, 81920
 buffer_load_dwordx4 v[152:155], v1, s[4:7], s55 offen offset:0 sc1 nt
 buffer_load_dwordx4 v[156:159], v1, s[4:7], s55 offen offset:1024 sc1 nt
 buffer_load_dwordx4 v[160:163], v6, s[4:7], s55 offen offset:2048 sc1 nt
 s_add_u32 s55, s55, 81920
 buffer_load_dwordx4 v[164:167], v1, s[4:7], s55 offen offset:0 sc1 nt
 buffer_load_dwordx4 v[168:171], v1, s[4:7], s55 offen offset:1024 sc1 nt
 buffer_load_dwordx4 v[172:175], v6, s[4:7], s55 offen offset:2048 sc1 nt
 s_add_u32 s55, s55, 81920
 s_and_b32 s56, s54, 31
 s_mul_i32 s56, s56, 1536
 s_add_u32 s56, s56, 81920
 v_add_u32 v3, s56, v2
 s_cmp_eq_u32 s53, 0
 s_cbranch_scc1 L_l0_154
 ds_read_b64 v[48:49], v3 offset:0
 ds_read_b64 v[50:51], v3 offset:512
 ds_read_b64 v[52:53], v3 offset:1024
 s_waitcnt lgkmcnt(0)
 v_lshlrev_b32 v12, 16, v48
 v_and_b32 v13, 0xffff0000, v48
 v_lshlrev_b32 v14, 16, v49
 v_and_b32 v15, 0xffff0000, v49
 v_lshlrev_b32 v16, 16, v50
 v_and_b32 v17, 0xffff0000, v50
 v_lshlrev_b32 v18, 16, v51
 v_and_b32 v19, 0xffff0000, v51
 v_lshlrev_b32 v20, 16, v52
 v_and_b32 v21, 0xffff0000, v52
 v_lshlrev_b32 v22, 16, v53
 v_and_b32 v23, 0xffff0000, v53
 s_add_u32 s3, s54, 1
 v_mov_b32 v10, s3
 ds_write_b32 v73, v10
L_l0_154:
 s_waitcnt vmcnt(18)
 v_pk_add_f32 v[80:81], v[80:81], v[92:93]
 v_pk_add_f32 v[82:83], v[82:83], v[94:95]
 v_pk_add_f32 v[84:85], v[84:85], v[96:97]
 v_pk_add_f32 v[86:87], v[86:87], v[98:99]
 v_pk_add_f32 v[88:89], v[88:89], v[100:101]
 v_pk_add_f32 v[90:91], v[90:91], v[102:103]
 s_waitcnt vmcnt(15)
 v_pk_add_f32 v[80:81], v[80:81], v[104:105]
 v_pk_add_f32 v[82:83], v[82:83], v[106:107]
 v_pk_add_f32 v[84:85], v[84:85], v[108:109]
 v_pk_add_f32 v[86:87], v[86:87], v[110:111]
 v_pk_add_f32 v[88:89], v[88:89], v[112:113]
 v_pk_add_f32 v[90:91], v[90:91], v[114:115]
 s_waitcnt vmcnt(12)
 v_pk_add_f32 v[80:81], v[80:81], v[116:117]
 v_pk_add_f32 v[82:83], v[82:83], v[118:119]
 v_pk_add_f32 v[84:85], v[84:85], v[120:121]
 v_pk_add_f32 v[86:87], v[86:87], v[122:123]
 v_pk_add_f32 v[88:89], v[88:89], v[124:125]
 v_pk_add_f32 v[90:91], v[90:91], v[126:127]
 s_waitcnt vmcnt(9)
 v_pk_add_f32 v[80:81], v[80:81], v[128:129]
 v_pk_add_f32 v[82:83], v[82:83], v[130:131]
 v_pk_add_f32 v[84:85], v[84:85], v[132:133]
 v_pk_add_f32 v[86:87], v[86:87], v[134:135]
 v_pk_add_f32 v[88:89], v[88:89], v[136:137]
 v_pk_add_f32 v[90:91], v[90:91], v[138:139]
 s_waitcnt vmcnt(6)
 v_pk_add_f32 v[80:81], v[80:81], v[140:141]
 v_pk_add_f32 v[82:83], v[82:83], v[142:143]
 v_pk_add_f32 v[84:85], v[84:85], v[144:145]
 v_pk_add_f32 v[86:87], v[86:87], v[146:147]
 v_pk_add_f32 v[88:89], v[88:89], v[148:149]
 v_pk_add_f32 v[90:91], v[90:91], v[150:151]
 s_waitcnt vmcnt(3)
 v_pk_add_f32 v[80:81], v[80:81], v[152:153]
 v_pk_add_f32 v[82:83], v[82:83], v[154:155]
 v_pk_add_f32 v[84:85], v[84:85], v[156:157]
 v_pk_add_f32 v[86:87], v[86:87], v[158:159]
 v_pk_add_f32 v[88:89], v[88:89], v[160:161]
 v_pk_add_f32 v[90:91], v[90:91], v[162:163]
 s_waitcnt vmcnt(0)
 v_pk_add_f32 v[80:81], v[80:81], v[164:165]
 v_pk_add_f32 v[82:83], v[82:83], v[166:167]
 v_pk_add_f32 v[84:85], v[84:85], v[168:169]
 v_pk_add_f32 v[86:87], v[86:87], v[170:171]
 v_pk_add_f32 v[88:89], v[88:89], v[172:173]
 v_pk_add_f32 v[90:91], v[90:91], v[174:175]
 v_cvt_pk_bf16_f32 v9, v80, v81
 v_lshlrev_b32 v80, 16, v9
 v_and_b32 v81, 0xffff0000, v9
 v_cvt_pk_bf16_f32 v9, v82, v83
 v_lshlrev_b32 v82, 16, v9
 v_and_b32 v83, 0xffff0000, v9
 v_cvt_pk_bf16_f32 v9, v84, v85
 v_lshlrev_b32 v84, 16, v9
 v_and_b32 v85, 0xffff0000, v9
 v_cvt_pk_bf16_f32 v9, v86, v87
 v_lshlrev_b32 v86, 16, v9
 v_and_b32 v87, 0xffff0000, v9
 v_cvt_pk_bf16_f32 v9, v88, v89
 v_lshlrev_b32 v88, 16, v9
 v_and_b32 v89, 0xffff0000, v9
 v_cvt_pk_bf16_f32 v9, v90, v91
 v_lshlrev_b32 v90, 16, v9
 v_and_b32 v91, 0xffff0000, v9
 v_pk_add_f32 v[12:13], v[12:13], v[80:81]
 v_pk_add_f32 v[14:15], v[14:15], v[82:83]
 v_pk_add_f32 v[16:17], v[16:17], v[84:85]
 v_pk_add_f32 v[18:19], v[18:19], v[86:87]
 v_pk_add_f32 v[20:21], v[20:21], v[88:89]
 v_pk_add_f32 v[22:23], v[22:23], v[90:91]
 v_cvt_pk_bf16_f32 v9, v12, v13
 v_lshlrev_b32 v12, 16, v9
 v_and_b32 v13, 0xffff0000, v9
 v_cvt_pk_bf16_f32 v9, v14, v15
 v_lshlrev_b32 v14, 16, v9
 v_and_b32 v15, 0xffff0000, v9
 v_cvt_pk_bf16_f32 v9, v16, v17
 v_lshlrev_b32 v16, 16, v9
 v_and_b32 v17, 0xffff0000, v9
 v_cvt_pk_bf16_f32 v9, v18, v19
 v_lshlrev_b32 v18, 16, v9
 v_and_b32 v19, 0xffff0000, v9
 v_cvt_pk_bf16_f32 v9, v20, v21
 v_lshlrev_b32 v20, 16, v9
 v_and_b32 v21, 0xffff0000, v9
 v_cvt_pk_bf16_f32 v9, v22, v23
 v_lshlrev_b32 v22, 16, v9
 v_and_b32 v23, 0xffff0000, v9
 v_readfirstlane_b32 s3, v12
 s_nop 1
 v_subrev_f32 v36, s3, v12
 v_subrev_f32 v37, s3, v13
 v_subrev_f32 v38, s3, v14
 v_subrev_f32 v39, s3, v15
 v_subrev_f32 v40, s3, v16
 v_subrev_f32 v41, s3, v17
 v_subrev_f32 v42, s3, v18
 v_subrev_f32 v43, s3, v19
 v_mov_b32 v44, 0
 v_mov_b32 v45, 0
 v_mov_b32 v46, 0
 v_mov_b32 v47, 0
 s_mov_b32 exec_hi, 0
 v_subrev_f32 v44, s3, v20
 v_subrev_f32 v45, s3, v21
 v_subrev_f32 v46, s3, v22
 v_subrev_f32 v47, s3, v23
 s_mov_b32 exec_hi, -1
 v_pk_mul_f32 v[10:11], v[36:37], v[36:37]
 v_pk_fma_f32 v[10:11], v[38:39], v[38:39], v[10:11]
 v_pk_fma_f32 v[10:11], v[40:41], v[40:41], v[10:11]
 v_pk_fma_f32 v[10:11], v[42:43], v[42:43], v[10:11]
 v_pk_fma_f32 v[10:11], v[44:45], v[44:45], v[10:11]
 v_pk_fma_f32 v[10:11], v[46:47], v[46:47], v[10:11]
 v_pk_add_f32 v[36:37], v[36:37], v[38:39]
 v_pk_add_f32 v[36:37], v[36:37], v[40:41]
 v_pk_add_f32 v[36:37], v[36:37], v[42:43]
 v_pk_add_f32 v[36:37], v[36:37], v[44:45]
 v_pk_add_f32 v[36:37], v[36:37], v[46:47]
 v_add_f32 v11, v10, v11
 v_add_f32 v10, v36, v37
 s_nop 0
 v_add_f32_dpp v11, v11, v11 quad_perm:[1,0,3,2] row_mask:0xf bank_mask:0xf
 v_add_f32_dpp v10, v10, v10 quad_perm:[1,0,3,2] row_mask:0xf bank_mask:0xf
 s_nop 0
 v_add_f32_dpp v11, v11, v11 quad_perm:[2,3,0,1] row_mask:0xf bank_mask:0xf
 v_add_f32_dpp v10, v10, v10 quad_perm:[2,3,0,1] row_mask:0xf bank_mask:0xf
 s_nop 0
 v_add_f32_dpp v11, v11, v11 row_half_mirror row_mask:0xf bank_mask:0xf
 v_add_f32_dpp v10, v10, v10 row_half_mirror row_mask:0xf bank_mask:0xf
 s_nop 0
 v_add_f32_dpp v11, v11, v11 row_mirror row_mask:0xf bank_mask:0xf
 v_add_f32_dpp v10, v10, v10 row_mirror row_mask:0xf bank_mask:0xf
 v_mov_b32 v37, v11
 v_mov_b32 v36, v10
 s_nop 0
 v_permlane16_swap_b32 v11, v37
 v_permlane16_swap_b32 v10, v36
 v_pk_add_f32 v[10:11], v[10:11], v[36:37]
 v_mov_b32 v37, v11
 v_mov_b32 v36, v10
 s_nop 0
 v_permlane32_swap_b32 v11, v37
 v_permlane32_swap_b32 v10, v36
 v_pk_add_f32 v[10:11], v[10:11], v[36:37]
 v_mul_f32 v10, s57, v10
 v_mul_f32 v11, s57, v11
 v_fma_f32 v11, -v10, v10, v11
 v_max_f32 v11, 0, v11
 v_add_f32 v10, s3, v10
 v_cvt_pk_bf16_f32 v9, v10, v11
 v_lshlrev_b32 v10, 16, v9
 v_and_b32 v11, 0xffff0000, v9
 v_add_f32 v11, s58, v11
 v_cvt_pk_bf16_f32 v11, v11, v11
 v_and_b32 v11, 0xffff0000, v11
 v_sqrt_f32 v11, v11
 s_nop 0
 v_pk_add_f32 v[36:37], v[12:13], v[10:11] op_sel_hi:[1,0] neg_lo:[0,1] neg_hi:[0,1]
 v_pk_add_f32 v[38:39], v[14:15], v[10:11] op_sel_hi:[1,0] neg_lo:[0,1] neg_hi:[0,1]
 v_pk_add_f32 v[40:41], v[16:17], v[10:11] op_sel_hi:[1,0] neg_lo:[0,1] neg_hi:[0,1]
 v_pk_add_f32 v[42:43], v[18:19], v[10:11] op_sel_hi:[1,0] neg_lo:[0,1] neg_hi:[0,1]
 v_pk_add_f32 v[44:45], v[20:21], v[10:11] op_sel_hi:[1,0] neg_lo:[0,1] neg_hi:[0,1]
 v_pk_add_f32 v[46:47], v[22:23], v[10:11] op_sel_hi:[1,0] neg_lo:[0,1] neg_hi:[0,1]
 v_cvt_pk_bf16_f32 v11, v11, v11
 v_and_b32 v11, 0xffff0000, v11
 v_rcp_f32 v11, v11
 v_cvt_pk_bf16_f32 v9, v36, v37
 v_lshlrev_b32 v36, 16, v9
 v_and_b32 v37, 0xffff0000, v9
 v_cvt_pk_bf16_f32 v9, v38, v39
 v_lshlrev_b32 v38, 16, v9
 v_and_b32 v39, 0xffff0000, v9
 v_cvt_pk_bf16_f32 v9, v40, v41
 v_lshlrev_b32 v40, 16, v9
 v_and_b32 v41, 0xffff0000, v9
 v_cvt_pk_bf16_f32 v9, v42, v43
 v_lshlrev_b32 v42, 16, v9
 v_and_b32 v43, 0xffff0000, v9
 v_cvt_pk_bf16_f32 v9, v44, v45
 v_lshlrev_b32 v44, 16, v9
 v_and_b32 v45, 0xffff0000, v9
 v_cvt_pk_bf16_f32 v9, v46, v47
 v_lshlrev_b32 v46, 16, v9
 v_and_b32 v47, 0xffff0000, v9
 v_pk_mul_f32 v[36:37], v[36:37], v[10:11] op_sel:[0,1] op_sel_hi:[1,1]
 v_pk_mul_f32 v[38:39], v[38:39], v[10:11] op_sel:[0,1] op_sel_hi:[1,1]
 v_pk_mul_f32 v[40:41], v[40:41], v[10:11] op_sel:[0,1] op_sel_hi:[1,1]
 v_pk_mul_f32 v[42:43], v[42:43], v[10:11] op_sel:[0,1] op_sel_hi:[1,1]
 v_pk_mul_f32 v[44:45], v[44:45], v[10:11] op_sel:[0,1] op_sel_hi:[1,1]
 v_pk_mul_f32 v[46:47], v[46:47], v[10:11] op_sel:[0,1] op_sel_hi:[1,1]
 v_cvt_pk_bf16_f32 v9, v36, v37
 v_lshlrev_b32 v36, 16, v9
 v_and_b32 v37, 0xffff0000, v9
 v_cvt_pk_bf16_f32 v9, v38, v39
 v_lshlrev_b32 v38, 16, v9
 v_and_b32 v39, 0xffff0000, v9
 v_cvt_pk_bf16_f32 v9, v40, v41
 v_lshlrev_b32 v40, 16, v9
 v_and_b32 v41, 0xffff0000, v9
 v_cvt_pk_bf16_f32 v9, v42, v43
 v_lshlrev_b32 v42, 16, v9
 v_and_b32 v43, 0xffff0000, v9
 v_cvt_pk_bf16_f32 v9, v44, v45
 v_lshlrev_b32 v44, 16, v9
 v_and_b32 v45, 0xffff0000, v9
 v_cvt_pk_bf16_f32 v9, v46, v47
 v_lshlrev_b32 v46, 16, v9
 v_and_b32 v47, 0xffff0000, v9
 v_pk_mul_f32 v[36:37], v[36:37], v[24:25]
 v_pk_mul_f32 v[38:39], v[38:39], v[26:27]
 v_pk_mul_f32 v[40:41], v[40:41], v[28:29]
 v_pk_mul_f32 v[42:43], v[42:43], v[30:31]
 v_pk_mul_f32 v[44:45], v[44:45], v[32:33]
 v_pk_mul_f32 v[46:47], v[46:47], v[34:35]
 v_cvt_pk_bf16_f32 v9, v36, v37
 v_lshlrev_b32 v36, 16, v9
 v_and_b32 v37, 0xffff0000, v9
 v_cvt_pk_bf16_f32 v9, v38, v39
 v_lshlrev_b32 v38, 16, v9
 v_and_b32 v39, 0xffff0000, v9
 v_cvt_pk_bf16_f32 v9, v40, v41
 v_lshlrev_b32 v40, 16, v9
 v_and_b32 v41, 0xffff0000, v9
 v_cvt_pk_bf16_f32 v9, v42, v43
 v_lshlrev_b32 v42, 16, v9
 v_and_b32 v43, 0xffff0000, v9
 v_cvt_pk_bf16_f32 v9, v44, v45
 v_lshlrev_b32 v44, 16, v9
 v_and_b32 v45, 0xffff0000, v9
 v_cvt_pk_bf16_f32 v9, v46, v47
 v_lshlrev_b32 v46, 16, v9
 v_and_b32 v47, 0xffff0000, v9
 v_pk_add_f32 v[12:13], v[12:13], v[36:37]
 v_pk_add_f32 v[14:15], v[14:15], v[38:39]
 v_pk_add_f32 v[16:17], v[16:17], v[40:41]
 v_pk_add_f32 v[18:19], v[18:19], v[42:43]
 v_pk_add_f32 v[20:21], v[20:21], v[44:45]
 v_pk_add_f32 v[22:23], v[22:23], v[46:47]
 v_cvt_pk_bf16_f32 v60, v12, v13
 v_cvt_pk_bf16_f32 v61, v14, v15
 v_cvt_pk_bf16_f32 v62, v16, v17
 v_cvt_pk_bf16_f32 v63, v18, v19
 v_cvt_pk_bf16_f32 v64, v20, v21
 v_cvt_pk_bf16_f32 v65, v22, v23
 s_cmp_lg_u32 s53, 0
 s_cbranch_scc1 L_l1_155
 s_cmp_lt_u32 s54, 32
 s_cbranch_scc1 L_rgd_158
 s_sub_u32 s55, s54, 31
 s_mov_b32 s51, 0
L_rg_157:
 ds_read_b32 v10, v73
 s_waitcnt lgkmcnt(0)
 v_cmp_gt_u32 vcc, s55, v10
 s_cbranch_vccz L_rgd_158
 s_sleep 8
 s_add_u32 s51, s51, 1
 s_cmp_lt_u32 s51, 131072
 s_cbranch_scc1 L_rg_157
 s_branch L_bail
L_rgd_158:
 ds_write_b64 v3, v[60:61] offset:0
 ds_write_b64 v3, v[62:63] offset:512
 ds_write_b64 v3, v[64:65] offset:1024
 v_lshlrev_b32 v12, 16, v60
 v_and_b32 v13, 0xffff0000, v60
 v_lshlrev_b32 v14, 16, v61
 v_and_b32 v15, 0xffff0000, v61
 v_lshlrev_b32 v16, 16, v62
 v_and_b32 v17, 0xffff0000, v62
 v_lshlrev_b32 v18, 16, v63
 v_and_b32 v19, 0xffff0000, v63
 v_lshlrev_b32 v20, 16, v64
 v_and_b32 v21, 0xffff0000, v64
 v_lshlrev_b32 v22, 16, v65
 v_and_b32 v23, 0xffff0000, v65
 s_nop 0
 v_readfirstlane_b32 s3, v12
 s_nop 1
 v_subrev_f32 v36, s3, v12
 v_subrev_f32 v37, s3, v13
 v_subrev_f32 v38, s3, v14
 v_subrev_f32 v39, s3, v15
 v_subrev_f32 v40, s3, v16
 v_subrev_f32 v41, s3, v17
 v_subrev_f32 v42, s3, v18
 v_subrev_f32 v43, s3, v19
 v_mov_b32 v44, 0
 v_mov_b32 v45, 0
 v_mov_b32 v46, 0
 v_mov_b32 v47, 0
 s_mov_b32 exec_hi, 0
 v_subrev_f32 v44, s3, v20
 v_subrev_f32 v45, s3, v21
 v_subrev_f32 v46, s3, v22
 v_subrev_f32 v47, s3, v23
 s_mov_b32 exec_hi, -1
 v_pk_mul_f32 v[10:11], v[36:37], v[36:37]
 v_pk_fma_f32 v[10:11], v[38:39], v[38:39], v[10:11]
 v_pk_fma_f32 v[10:11], v[40:41], v[40:41], v[10:11]
 v_pk_fma_f32 v[10:11], v[42:43], v[42:43], v[10:11]
 v_pk_fma_f32 v[10:11], v[44:45], v[44:45], v[10:11]
 v_pk_fma_f32 v[10:11], v[46:47], v[46:47], v[10:11]
 v_pk_add_f32 v[36:37], v[36:37], v[38:39]
 v_pk_add_f32 v[36:37], v[36:37], v[40:41]
 v_pk_add_f32 v[36:37], v[36:37], v[42:43]
 v_pk_add_f32 v[36:37], v[36:37], v[44:45]
 v_pk_add_f32 v[36:37], v[36:37], v[46:47]
 v_add_f32 v11, v10, v11
 v_add_f32 v10, v36, v37
 s_nop 0
 v_add_f32_dpp v11, v11, v11 quad_perm:[1,0,3,2] row_mask:0xf bank_mask:0xf
 v_add_f32_dpp v10, v10, v10 quad_perm:[1,0,3,2] row_mask:0xf bank_mask:0xf
 s_nop 0
 v_add_f32_dpp v11, v11, v11 quad_perm:[2,3,0,1] row_mask:0xf bank_mask:0xf
 v_add_f32_dpp v10, v10, v10 quad_perm:[2,3,0,1] row_mask:0xf bank_mask:0xf
 s_nop 0
 v_add_f32_dpp v11, v11, v11 row_half_mirror row_mask:0xf bank_mask:0xf
 v_add_f32_dpp v10, v10, v10 row_half_mirror row_mask:0xf bank_mask:0xf
 s_nop 0
 v_add_f32_dpp v11, v11, v11 row_mirror row_mask:0xf bank_mask:0xf
 v_add_f32_dpp v10, v10, v10 row_mirror row_mask:0xf bank_mask:0xf
 v_mov_b32 v37, v11
 v_mov_b32 v36, v10
 s_nop 0
 v_permlane16_swap_b32 v11, v37
 v_permlane16_swap_b32 v10, v36
 v_pk_add_f32 v[10:11], v[10:11], v[36:37]
 v_mov_b32 v37, v11
 v_mov_b32 v36, v10
 s_nop 0
 v_permlane32_swap_b32 v11, v37
 v_permlane32_swap_b32 v10, v36
 v_pk_add_f32 v[10:11], v[10:11], v[36:37]
 v_mul_f32 v10, s57, v10
 v_mul_f32 v11, s57, v11
 v_fma_f32 v11, -v10, v10, v11
 v_max_f32 v11, 0, v11
 v_add_f32 v10, s3, v10
 v_cvt_pk_bf16_f32 v9, v10, v11
 v_lshlrev_b32 v10, 16, v9
 v_and_b32 v11, 0xffff0000, v9
 v_add_f32 v11, s58, v11
 v_cvt_pk_bf16_f32 v11, v11, v11
 v_and_b32 v11, 0xffff0000, v11
 v_sqrt_f32 v11, v11
 s_nop 0
 v_pk_add_f32 v[36:37], v[12:13], v[10:11] op_sel_hi:[1,0] neg_lo:[0,1] neg_hi:[0,1]
 v_pk_add_f32 v[38:39], v[14:15], v[10:11] op_sel_hi:[1,0] neg_lo:[0,1] neg_hi:[0,1]
 v_pk_add_f32 v[40:41], v[16:17], v[10:11] op_sel_hi:[1,0] neg_lo:[0,1] neg_hi:[0,1]
 v_pk_add_f32 v[42:43], v[18:19], v[10:11] op_sel_hi:[1,0] neg_lo:[0,1] neg_hi:[0,1]
 v_pk_add_f32 v[44:45], v[20:21], v[10:11] op_sel_hi:[1,0] neg_lo:[0,1] neg_hi:[0,1]
 v_pk_add_f32 v[46:47], v[22:23], v[10:11] op_sel_hi:[1,0] neg_lo:[0,1] neg_hi:[0,1]
 v_cvt_pk_bf16_f32 v11, v11, v11
 v_and_b32 v11, 0xffff0000, v11
 v_rcp_f32 v11, v11
 v_cvt_pk_bf16_f32 v9, v36, v37
 v_lshlrev_b32 v36, 16, v9
 v_and_b32 v37, 0xffff0000, v9
 v_cvt_pk_bf16_f32 v9, v38, v39
 v_lshlrev_b32 v38, 16, v9
 v_and_b32 v39, 0xffff0000, v9
 v_cvt_pk_bf16_f32 v9, v40, v41
 v_lshlrev_b32 v40, 16, v9
 v_and_b32 v41, 0xffff0000, v9
 v_cvt_pk_bf16_f32 v9, v42, v43
 v_lshlrev_b32 v42, 16, v9
 v_and_b32 v43, 0xffff0000, v9
 v_cvt_pk_bf16_f32 v9, v44, v45
 v_lshlrev_b32 v44, 16, v9
 v_and_b32 v45, 0xffff0000, v9
 v_cvt_pk_bf16_f32 v9, v46, v47
 v_lshlrev_b32 v46, 16, v9
 v_and_b32 v47, 0xffff0000, v9
 v_pk_mul_f32 v[36:37], v[36:37], v[10:11] op_sel:[0,1] op_sel_hi:[1,1]
 v_pk_mul_f32 v[38:39], v[38:39], v[10:11] op_sel:[0,1] op_sel_hi:[1,1]
 v_pk_mul_f32 v[40:41], v[40:41], v[10:11] op_sel:[0,1] op_sel_hi:[1,1]
 v_pk_mul_f32 v[42:43], v[42:43], v[10:11] op_sel:[0,1] op_sel_hi:[1,1]
 v_pk_mul_f32 v[44:45], v[44:45], v[10:11] op_sel:[0,1] op_sel_hi:[1,1]
 v_pk_mul_f32 v[46:47], v[46:47], v[10:11] op_sel:[0,1] op_sel_hi:[1,1]
 v_cvt_pk_bf16_f32 v48, v36, v37
 v_cvt_pk_bf16_f32 v49, v38, v39
 v_cvt_pk_bf16_f32 v50, v40, v41
 v_cvt_pk_bf16_f32 v51, v42, v43
 v_cvt_pk_bf16_f32 v52, v44, v45
 v_cvt_pk_bf16_f32 v53, v46, v47
 s_add_u32 s3, s60, 229113856
 buffer_store_dwordx2 v[48:49], v4, s[4:7], s3 offen offset:0 sc1
 buffer_store_dwordx2 v[50:51], v4, s[4:7], s3 offen offset:512 sc1
 buffer_store_dwordx2 v[52:53], v8, s[4:7], s3 offen offset:1024 sc1
 s_waitcnt vmcnt(0) lgkmcnt(0)
 s_and_b32 s55, s52, 3
 s_mul_i32 s55, s55, 24576
 s_lshl_b32 s3, s54, 2
 s_add_u32 s3, s3, s55
 s_add_u32 s3, s3, 126976
 v_mov_b32 v3, 1
 s_mov_b64 exec, -1
 buffer_atomic_add v3, v68, s[4:7], s3 offen
 s_mov_b64 exec, -1
 s_add_u32 s3, s3, 16384
 v_mov_b32 v3, 1
 s_mov_b32 exec_hi, 0
 buffer_atomic_add v3, v68, s[4:7], s3 offen
 s_mov_b64 exec, -1
 s_branch L_le_156
L_l1_155:
 buffer_store_dwordx2 v[60:61], v2, s[12:15], s60 offen offset:0 nt
 buffer_store_dwordx2 v[62:63], v2, s[12:15], s60 offen offset:512 nt
 buffer_store_dwordx2 v[64:65], v7, s[12:15], s60 offen offset:1024 nt
 s_waitcnt vmcnt(0)
L_le_156:
 s_add_u32 s54, s54, 2
 s_cmp_lt_u32 s54, 64
 s_cbranch_scc1 L_t4_loop
 s_cmp_lg_u32 s50, 3
 s_cbranch_scc1 L_bail
 s_endpgm
L_bail:
 s_endpgm
L_ch:
 s_mov_b32 s52, s49
 s_lshl_b32 s14, s53, 5
 s_add_u32 s14, s14, s52
 s_mul_i32 s63, s14, 49152
 s_mul_i32 s3, s50, 12288
 s_add_u32 s63, s63, s3
 s_add_u32 s63, s63, 2162688
 s_add_u32 s81, s63, 4096
 s_add_u32 s101, s63, 8192
 s_mul_i32 s60, s14, 10240
 s_lshl_b32 s3, s50, 11
 s_add_u32 s60, s60, s3
 s_add_u32 s60, s60, 225280
 s_lshl_b32 s12, s14, 8
 s_add_u32 s12, s12, 8192
 s_lshl_b32 s13, s14, 7
 s_add_u32 s13, s13, 0
 s_mul_i32 s62, s53, 524288
 s_lshl_b32 s3, s52, 12
 s_add_u32 s62, s62, s3
 s_add_u32 s62, s62, 1114112
 s_and_b32 s3, s52, 1
 s_lshl_b32 s3, s3, 13
 s_lshl_b32 s61, s52, 14
 s_add_u32 s61, s61, s3
 s_mul_i32 s3, s53, 33554432
 s_add_u32 s61, s61, s3
 s_add_u32 s61, s61, 8388608
 s_mov_b32 s56, 0x3e0293ee
 s_mov_b32 s54, 0
 s_mov_b32 s55, 1
 s_mov_b32 s68, 0x33333333
 s_mov_b32 s69, 0x33333333
 s_mov_b32 s70, 0xcccccccc
 s_mov_b32 s71, 0xcccccccc
 s_mov_b32 s72, 0x11111111
 s_mov_b32 s73, 0x11111111
 s_mov_b32 s74, 0x44444444
 s_mov_b32 s75, 0x44444444
 s_mov_b32 s76, 0x22222222
 s_mov_b32 s77, 0x22222222
 s_mov_b32 s78, 0x88888888
 s_mov_b32 s79, 0x88888888
 s_mov_b32 s82, 0xf0f0f0f0
 s_mov_b32 s83, 0xf0f0f0f0
 s_cmp_eq_u32 s50, 1
 s_cbranch_scc1 L_ch1
 s_cmp_eq_u32 s50, 2
 s_cbranch_scc1 L_ch2
 s_cmp_eq_u32 s50, 3
 s_cbranch_scc1 L_ch3
L_ch0:
 v_lshrrev_b32 v8, 4, v0
 s_mov_b32 s3, 1280
 v_mul_lo_u32 v8, v8, s3
 v_lshrrev_b32 v7, 3, v0
 v_and_b32 v7, 6, v7
 v_xor_b32 v7, v7, v0
 v_and_b32 v7, 15, v7
 v_lshl_add_u32 v8, v7, 4, v8
 v_xor_b32 v9, 128, v8
 v_lshrrev_b32 v10, 4, v0
 s_mov_b32 s3, 8192
 v_mul_lo_u32 v10, v10, s3
 v_lshrrev_b32 v7, 3, v0
 v_and_b32 v7, 6, v7
 v_xor_b32 v7, v7, v0
 v_and_b32 v7, 15, v7
 v_lshl_add_u32 v10, v7, 4, v10
 v_xor_b32 v11, 128, v10
 s_mov_b32 s8, s26
 s_and_b32 s9, s27, 0xffff
 s_mov_b32 s10, 5242880
 s_mul_i32 s14, s52, 163840
 s_add_u32 s14, s14, 0
 s_mov_b32 m0, 0
 s_nop 0
 buffer_load_dwordx4 v8, s[8:11], s14 offen lds
 s_add_u32 s14, s14, 5120
 s_mov_b32 m0, 1024
 s_nop 0
 buffer_load_dwordx4 v8, s[8:11], s14 offen lds
 s_add_u32 s14, s14, 5120
 s_mov_b32 m0, 2048
 s_nop 0
 buffer_load_dwordx4 v8, s[8:11], s14 offen lds
 s_add_u32 s14, s14, 5120
 s_mov_b32 m0, 3072
 s_nop 0
 buffer_load_dwordx4 v8, s[8:11], s14 offen lds
 s_add_u32 s14, s14, 5120
 s_mov_b32 m0, 4096
 s_nop 0
 buffer_load_dwordx4 v9, s[8:11], s14 offen lds
 s_add_u32 s14, s14, 5120
 s_mov_b32 m0, 5120
 s_nop 0
 buffer_load_dwordx4 v9, s[8:11], s14 offen lds
 s_add_u32 s14, s14, 5120
 s_mov_b32 m0, 6144
 s_nop 0
 buffer_load_dwordx4 v9, s[8:11], s14 offen lds
 s_add_u32 s14, s14, 5120
 s_mov_b32 m0, 7168
 s_nop 0
 buffer_load_dwordx4 v9, s[8:11], s14 offen lds
 s_mul_i32 s14, s52, 163840
 s_add_u32 s14, s14, 256
 s_mov_b32 m0, 32768
 s_nop 0
 buffer_load_dwordx4 v8, s[8:11], s14 offen lds
 s_add_u32 s14, s14, 5120
 s_mov_b32 m0, 33792
 s_nop 0
 buffer_load_dwordx4 v8, s[8:11], s14 offen lds
 s_add_u32 s14, s14, 5120
 s_mov_b32 m0, 34816
 s_nop 0
 buffer_load_dwordx4 v8, s[8:11], s14 offen lds
 s_add_u32 s14, s14, 5120
 s_mov_b32 m0, 35840
 s_nop 0
 buffer_load_dwordx4 v8, s[8:11], s14 offen lds
 s_add_u32 s14, s14, 5120
 s_mov_b32 m0, 36864
 s_nop 0
 buffer_load_dwordx4 v9, s[8:11], s14 offen lds
 s_add_u32 s14, s14, 5120
 s_mov_b32 m0, 37888
 s_nop 0
 buffer_load_dwordx4 v9, s[8:11], s14 offen lds
 s_add_u32 s14, s14, 5120
 s_mov_b32 m0, 38912
 s_nop 0
 buffer_load_dwordx4 v9, s[8:11], s14 offen lds
 s_add_u32 s14, s14, 5120
 s_mov_b32 m0, 39936
 s_nop 0
 buffer_load_dwordx4 v9, s[8:11], s14 offen lds
 s_mul_i32 s14, s52, 163840
 s_add_u32 s14, s14, 512
 s_mov_b32 m0, 65536
 s_nop 0
 buffer_load_dwordx4 v8, s[8:11], s14 offen lds
 s_add_u32 s14, s14, 5120
 s_mov_b32 m0, 66560
 s_nop 0
 buffer_load_dwordx4 v8, s[8:11], s14 offen lds
 s_add_u32 s14, s14, 5120
 s_mov_b32 m0, 67584
 s_nop 0
 buffer_load_dwordx4 v8, s[8:11], s14 offen lds
 s_add_u32 s14, s14, 5120
 s_mov_b32 m0, 68608
 s_nop 0
 buffer_load_dwordx4 v8, s[8:11], s14 offen lds
 s_add_u32 s14, s14, 5120
 s_mov_b32 m0, 69632
 s_nop 0
 buffer_load_dwordx4 v9, s[8:11], s14 offen lds
 s_add_u32 s14, s14, 5120
 s_mov_b32 m0, 70656
 s_nop 0
 buffer_load_dwordx4 v9, s[8:11], s14 offen lds
 s_add_u32 s14, s14, 5120
 s_mov_b32 m0, 71680
 s_nop 0
 buffer_load_dwordx4 v9, s[8:11], s14 offen lds
 s_add_u32 s14, s14, 5120
 s_mov_b32 m0, 72704
 s_nop 0
 buffer_load_dwordx4 v9, s[8:11], s14 offen lds
 s_mul_i32 s14, s52, 163840
 s_add_u32 s14, s14, 768
 s_mov_b32 m0, 98304
 s_nop 0
 buffer_load_dwordx4 v8, s[8:11], s14 offen lds
 s_add_u32 s14, s14, 5120
 s_mov_b32 m0, 99328
 s_nop 0
 buffer_load_dwordx4 v8, s[8:11], s14 offen lds
 s_add_u32 s14, s14, 5120
 s_mov_b32 m0, 100352
 s_nop 0
 buffer_load_dwordx4 v8, s[8:11], s14 offen lds
 s_add_u32 s14, s14, 5120
 s_mov_b32 m0, 101376
 s_nop 0
 buffer_load_dwordx4 v8, s[8:11], s14 offen lds
 s_add_u32 s14, s14, 5120
 s_mov_b32 m0, 102400
 s_nop 0
 buffer_load_dwordx4 v9, s[8:11], s14 offen lds
 s_add_u32 s14, s14, 5120
 s_mov_b32 m0, 103424
 s_nop 0
 buffer_load_dwordx4 v9, s[8:11], s14 offen lds
 s_add_u32 s14, s14, 5120
 s_mov_b32 m0, 104448
 s_nop 0
 buffer_load_dwordx4 v9, s[8:11], s14 offen lds
 s_add_u32 s14, s14, 5120
 s_mov_b32 m0, 105472
 s_nop 0
 buffer_load_dwordx4 v9, s[8:11], s14 offen lds
 s_mul_i32 s14, s52, 163840
 s_add_u32 s14, s14, 1024
 s_mov_b32 m0, 131072
 s_nop 0
 buffer_load_dwordx4 v8, s[8:11], s14 offen lds
 s_add_u32 s14, s14, 5120
 s_mov_b32 m0, 132096
 s_nop 0
 buffer_load_dwordx4 v8, s[8:11], s14 offen lds
 s_add_u32 s14, s14, 5120
 s_mov_b32 m0, 133120
 s_nop 0
 buffer_load_dwordx4 v8, s[8:11], s14 offen lds
 s_add_u32 s14, s14, 5120
 s_mov_b32 m0, 134144
 s_nop 0
 buffer_load_dwordx4 v8, s[8:11], s14 offen lds
 s_add_u32 s14, s14, 5120
 s_mov_b32 m0, 135168
 s_nop 0
 buffer_load_dwordx4 v9, s[8:11], s14 offen lds
 s_add_u32 s14, s14, 5120
 s_mov_b32 m0, 136192
 s_nop 0
 buffer_load_dwordx4 v9, s[8:11], s14 offen lds
 s_add_u32 s14, s14, 5120
 s_mov_b32 m0, 137216
 s_nop 0
 buffer_load_dwordx4 v9, s[8:11], s14 offen lds
 s_add_u32 s14, s14, 5120
 s_mov_b32 m0, 138240
 s_nop 0
 buffer_load_dwordx4 v9, s[8:11], s14 offen lds
 v_lshrrev_b32 v20, 4, v0
 v_bfe_u32 v21, v0, 2, 1
 v_bfe_u32 v22, v0, 3, 1
 v_and_b32 v23, 1, v20
 v_lshrrev_b32 v24, 1, v20
 v_and_b32 v25, 3, v0
 v_lshlrev_b32 v25, 3, v25
 v_lshl_add_u32 v26, v22, 1, v23
 v_lshl_add_u32 v27, v21, 2, v26
 v_lshl_add_u32 v26, v24, 2, v26
 v_lshl_add_u32 v26, v21, 4, v26
 v_xor_b32 v27, 0, v27
 v_lshl_add_u32 v27, v27, 5, v25
 v_lshl_add_u32 v12, v26, 8, v27
 v_lshl_add_u32 v26, v24, 2, v21
 v_lshl_add_u32 v26, v23, 4, v26
 v_lshl_add_u32 v27, v23, 2, v21
 v_lshl_add_u32 v27, v22, 1, v27
 v_lshl_add_u32 v27, v27, 5, v25
 v_lshl_add_u32 v14, v26, 8, v27
 v_lshlrev_b32 v1, 4, v0
 v_add_u32 v2, 65536, v1
 v_add_u32 v3, 114688, v1
 s_waitcnt vmcnt(32)
 s_barrier
 v_xor_b32 v16, 0, v14
 v_add_u32 v16, 0, v16
 v_xor_b32 v17, 64, v16
 ds_read_b64_tr_b16 a[0:1], v16 offset:0
 ds_read_b64_tr_b16 a[2:3], v17 offset:512
 ds_read_b64_tr_b16 a[4:5], v16 offset:2048
 ds_read_b64_tr_b16 a[6:7], v17 offset:2560
 v_xor_b32 v16, 0, v14
 v_add_u32 v16, 0, v16
 v_xor_b32 v17, 64, v16
 ds_read_b64_tr_b16 a[8:9], v16 offset:8192
 ds_read_b64_tr_b16 a[10:11], v17 offset:8704
 ds_read_b64_tr_b16 a[12:13], v16 offset:10240
 ds_read_b64_tr_b16 a[14:15], v17 offset:10752
 v_xor_b32 v16, 0, v14
 v_add_u32 v16, 0, v16
 v_xor_b32 v17, 64, v16
 ds_read_b64_tr_b16 a[16:17], v16 offset:16384
 ds_read_b64_tr_b16 a[18:19], v17 offset:16896
 ds_read_b64_tr_b16 a[20:21], v16 offset:18432
 ds_read_b64_tr_b16 a[22:23], v17 offset:18944
 v_xor_b32 v16, 0, v14
 v_add_u32 v16, 0, v16
 v_xor_b32 v17, 64, v16
 ds_read_b64_tr_b16 a[24:25], v16 offset:24576
 ds_read_b64_tr_b16 a[26:27], v17 offset:25088
 ds_read_b64_tr_b16 a[28:29], v16 offset:26624
 ds_read_b64_tr_b16 a[30:31], v17 offset:27136
 v_xor_b32 v16, 32, v14
 v_add_u32 v16, 0, v16
 v_xor_b32 v17, 64, v16
 ds_read_b64_tr_b16 a[32:33], v16 offset:0
 ds_read_b64_tr_b16 a[34:35], v17 offset:512
 ds_read_b64_tr_b16 a[36:37], v16 offset:2048
 ds_read_b64_tr_b16 a[38:39], v17 offset:2560
 v_xor_b32 v16, 32, v14
 v_add_u32 v16, 0, v16
 v_xor_b32 v17, 64, v16
 ds_read_b64_tr_b16 a[40:41], v16 offset:8192
 ds_read_b64_tr_b16 a[42:43], v17 offset:8704
 ds_read_b64_tr_b16 a[44:45], v16 offset:10240
 ds_read_b64_tr_b16 a[46:47], v17 offset:10752
 v_xor_b32 v16, 32, v14
 v_add_u32 v16, 0, v16
 v_xor_b32 v17, 64, v16
 ds_read_b64_tr_b16 a[48:49], v16 offset:16384
 ds_read_b64_tr_b16 a[50:51], v17 offset:16896
 ds_read_b64_tr_b16 a[52:53], v16 offset:18432
 ds_read_b64_tr_b16 a[54:55], v17 offset:18944
 v_xor_b32 v16, 32, v14
 v_add_u32 v16, 0, v16
 v_xor_b32 v17, 64, v16
 ds_read_b64_tr_b16 a[56:57], v16 offset:24576
 ds_read_b64_tr_b16 a[58:59], v17 offset:25088
 ds_read_b64_tr_b16 a[60:61], v16 offset:26624
 ds_read_b64_tr_b16 a[62:63], v17 offset:27136
 v_xor_b32 v16, 128, v14
 v_add_u32 v16, 0, v16
 v_xor_b32 v17, 64, v16
 ds_read_b64_tr_b16 a[64:65], v16 offset:0
 ds_read_b64_tr_b16 a[66:67], v17 offset:512
 ds_read_b64_tr_b16 a[68:69], v16 offset:2048
 ds_read_b64_tr_b16 a[70:71], v17 offset:2560
 v_xor_b32 v16, 128, v14
 v_add_u32 v16, 0, v16
 v_xor_b32 v17, 64, v16
 ds_read_b64_tr_b16 a[72:73], v16 offset:8192
 ds_read_b64_tr_b16 a[74:75], v17 offset:8704
 ds_read_b64_tr_b16 a[76:77], v16 offset:10240
 ds_read_b64_tr_b16 a[78:79], v17 offset:10752
 v_xor_b32 v16, 128, v14
 v_add_u32 v16, 0, v16
 v_xor_b32 v17, 64, v16
 ds_read_b64_tr_b16 a[80:81], v16 offset:16384
 ds_read_b64_tr_b16 a[82:83], v17 offset:16896
 ds_read_b64_tr_b16 a[84:85], v16 offset:18432
 ds_read_b64_tr_b16 a[86:87], v17 offset:18944
 v_xor_b32 v16, 128, v14
 v_add_u32 v16, 0, v16
 v_xor_b32 v17, 64, v16
 ds_read_b64_tr_b16 a[88:89], v16 offset:24576
 ds_read_b64_tr_b16 a[90:91], v17 offset:25088
 ds_read_b64_tr_b16 a[92:93], v16 offset:26624
 ds_read_b64_tr_b16 a[94:95], v17 offset:27136
 v_xor_b32 v16, 160, v14
 v_add_u32 v16, 0, v16
 v_xor_b32 v17, 64, v16
 ds_read_b64_tr_b16 a[96:97], v16 offset:0
 ds_read_b64_tr_b16 a[98:99], v17 offset:512
 ds_read_b64_tr_b16 a[100:101], v16 offset:2048
 ds_read_b64_tr_b16 a[102:103], v17 offset:2560
 v_xor_b32 v16, 160, v14
 v_add_u32 v16, 0, v16
 v_xor_b32 v17, 64, v16
 ds_read_b64_tr_b16 a[104:105], v16 offset:8192
 ds_read_b64_tr_b16 a[106:107], v17 offset:8704
 ds_read_b64_tr_b16 a[108:109], v16 offset:10240
 ds_read_b64_tr_b16 a[110:111], v17 offset:10752
 v_xor_b32 v16, 160, v14
 v_add_u32 v16, 0, v16
 v_xor_b32 v17, 64, v16
 ds_read_b64_tr_b16 a[112:113], v16 offset:16384
 ds_read_b64_tr_b16 a[114:115], v17 offset:16896
 ds_read_b64_tr_b16 a[116:117], v16 offset:18432
 ds_read_b64_tr_b16 a[118:119], v17 offset:18944
 v_xor_b32 v16, 160, v14
 v_add_u32 v16, 0, v16
 v_xor_b32 v17, 64, v16
 ds_read_b64_tr_b16 a[120:121], v16 offset:24576
 ds_read_b64_tr_b16 a[122:123], v17 offset:25088
 ds_read_b64_tr_b16 a[124:125], v16 offset:26624
 ds_read_b64_tr_b16 a[126:127], v17 offset:27136
 s_waitcnt lgkmcnt(0)
 s_barrier
 s_mov_b32 s8, s24
 s_and_b32 s9, s25, 0xffff
 s_mov_b32 s10, 5242880
 s_lshl_b32 s14, s52, 8
 s_add_u32 s14, s14, 0
 s_mov_b32 m0, 0
 s_nop 0
 buffer_load_dwordx4 v10, s[8:11], s14 offen lds
 s_add_u32 s14, s14, 32768
 s_mov_b32 m0, 1024
 s_nop 0
 buffer_load_dwordx4 v10, s[8:11], s14 offen lds
 s_add_u32 s14, s14, 32768
 s_mov_b32 m0, 2048
 s_nop 0
 buffer_load_dwordx4 v10, s[8:11], s14 offen lds
 s_add_u32 s14, s14, 32768
 s_mov_b32 m0, 3072
 s_nop 0
 buffer_load_dwordx4 v10, s[8:11], s14 offen lds
 s_add_u32 s14, s14, 32768
 s_mov_b32 m0, 4096
 s_nop 0
 buffer_load_dwordx4 v11, s[8:11], s14 offen lds
 s_add_u32 s14, s14, 32768
 s_mov_b32 m0, 5120
 s_nop 0
 buffer_load_dwordx4 v11, s[8:11], s14 offen lds
 s_add_u32 s14, s14, 32768
 s_mov_b32 m0, 6144
 s_nop 0
 buffer_load_dwordx4 v11, s[8:11], s14 offen lds
 s_add_u32 s14, s14, 32768
 s_mov_b32 m0, 7168
 s_nop 0
 buffer_load_dwordx4 v11, s[8:11], s14 offen lds
 s_waitcnt vmcnt(32)
 s_barrier
 s_waitcnt lgkmcnt(0)
 s_barrier
 s_lshl_b32 s14, s52, 8
 s_add_u32 s14, s14, 1048576
 s_mov_b32 m0, 32768
 s_nop 0
 buffer_load_dwordx4 v10, s[8:11], s14 offen lds
 s_add_u32 s14, s14, 32768
 s_mov_b32 m0, 33792
 s_nop 0
 buffer_load_dwordx4 v10, s[8:11], s14 offen lds
 s_add_u32 s14, s14, 32768
 s_mov_b32 m0, 34816
 s_nop 0
 buffer_load_dwordx4 v10, s[8:11], s14 offen lds
 s_add_u32 s14, s14, 32768
 s_mov_b32 m0, 35840
 s_nop 0
 buffer_load_dwordx4 v10, s[8:11], s14 offen lds
 s_add_u32 s14, s14, 32768
 s_mov_b32 m0, 36864
 s_nop 0
 buffer_load_dwordx4 v11, s[8:11], s14 offen lds
 s_add_u32 s14, s14, 32768
 s_mov_b32 m0, 37888
 s_nop 0
 buffer_load_dwordx4 v11, s[8:11], s14 offen lds
 s_add_u32 s14, s14, 32768
 s_mov_b32 m0, 38912
 s_nop 0
 buffer_load_dwordx4 v11, s[8:11], s14 offen lds
 s_add_u32 s14, s14, 32768
 s_mov_b32 m0, 39936
 s_nop 0
 buffer_load_dwordx4 v11, s[8:11], s14 offen lds
 s_waitcnt vmcnt(32)
 s_barrier
 s_waitcnt lgkmcnt(0)
 s_barrier
 s_lshl_b32 s14, s52, 8
 s_add_u32 s14, s14, 2097152
 s_mov_b32 m0, 65536
 s_nop 0
 buffer_load_dwordx4 v10, s[8:11], s14 offen lds
 s_add_u32 s14, s14, 32768
 s_mov_b32 m0, 66560
 s_nop 0
 buffer_load_dwordx4 v10, s[8:11], s14 offen lds
 s_add_u32 s14, s14, 32768
 s_mov_b32 m0, 67584
 s_nop 0
 buffer_load_dwordx4 v10, s[8:11], s14 offen lds
 s_add_u32 s14, s14, 32768
 s_mov_b32 m0, 68608
 s_nop 0
 buffer_load_dwordx4 v10, s[8:11], s14 offen lds
 s_add_u32 s14, s14, 32768
 s_mov_b32 m0, 69632
 s_nop 0
 buffer_load_dwordx4 v11, s[8:11], s14 offen lds
 s_add_u32 s14, s14, 32768
 s_mov_b32 m0, 70656
 s_nop 0
 buffer_load_dwordx4 v11, s[8:11], s14 offen lds
 s_add_u32 s14, s14, 32768
 s_mov_b32 m0, 71680
 s_nop 0
 buffer_load_dwordx4 v11, s[8:11], s14 offen lds
 s_add_u32 s14, s14, 32768
 s_mov_b32 m0, 72704
 s_nop 0
 buffer_load_dwordx4 v11, s[8:11], s14 offen lds
 s_waitcnt vmcnt(32)
 s_barrier
 s_waitcnt lgkmcnt(0)
 s_barrier
 s_lshl_b32 s14, s52, 8
 s_add_u32 s14, s14, 3145728
 s_mov_b32 m0, 98304
 s_nop 0
 buffer_load_dwordx4 v10, s[8:11], s14 offen lds
 s_add_u32 s14, s14, 32768
 s_mov_b32 m0, 99328
 s_nop 0
 buffer_load_dwordx4 v10, s[8:11], s14 offen lds
 s_add_u32 s14, s14, 32768
 s_mov_b32 m0, 100352
 s_nop 0
 buffer_load_dwordx4 v10, s[8:11], s14 offen lds
 s_add_u32 s14, s14, 32768
 s_mov_b32 m0, 101376
 s_nop 0
 buffer_load_dwordx4 v10, s[8:11], s14 offen lds
 s_add_u32 s14, s14, 32768
 s_mov_b32 m0, 102400
 s_nop 0
 buffer_load_dwordx4 v11, s[8:11], s14 offen lds
 s_add_u32 s14, s14, 32768
 s_mov_b32 m0, 103424
 s_nop 0
 buffer_load_dwordx4 v11, s[8:11], s14 offen lds
 s_add_u32 s14, s14, 32768
 s_mov_b32 m0, 104448
 s_nop 0
 buffer_load_dwordx4 v11, s[8:11], s14 offen lds
 s_add_u32 s14, s14, 32768
 s_mov_b32 m0, 105472
 s_nop 0
 buffer_load_dwordx4 v11, s[8:11], s14 offen lds
 s_waitcnt vmcnt(32)
 s_barrier
 v_xor_b32 v16, 0, v14
 v_add_u32 v16, 131072, v16
 v_xor_b32 v17, 64, v16
 ds_read_b64_tr_b16 a[128:129], v16 offset:0
 ds_read_b64_tr_b16 a[130:131], v17 offset:512
 ds_read_b64_tr_b16 a[132:133], v16 offset:2048
 ds_read_b64_tr_b16 a[134:135], v17 offset:2560
 v_xor_b32 v16, 0, v14
 v_add_u32 v16, 131072, v16
 v_xor_b32 v17, 64, v16
 ds_read_b64_tr_b16 a[136:137], v16 offset:8192
 ds_read_b64_tr_b16 a[138:139], v17 offset:8704
 ds_read_b64_tr_b16 a[140:141], v16 offset:10240
 ds_read_b64_tr_b16 a[142:143], v17 offset:10752
 v_xor_b32 v16, 0, v14
 v_add_u32 v16, 131072, v16
 v_xor_b32 v17, 64, v16
 ds_read_b64_tr_b16 a[144:145], v16 offset:16384
 ds_read_b64_tr_b16 a[146:147], v17 offset:16896
 ds_read_b64_tr_b16 a[148:149], v16 offset:18432
 ds_read_b64_tr_b16 a[150:151], v17 offset:18944
 v_xor_b32 v16, 0, v14
 v_add_u32 v16, 131072, v16
 v_xor_b32 v17, 64, v16
 ds_read_b64_tr_b16 a[152:153], v16 offset:24576
 ds_read_b64_tr_b16 a[154:155], v17 offset:25088
 ds_read_b64_tr_b16 a[156:157], v16 offset:26624
 ds_read_b64_tr_b16 a[158:159], v17 offset:27136
 s_waitcnt lgkmcnt(0)
 s_barrier
 s_lshl_b32 s14, s52, 8
 s_add_u32 s14, s14, 4194304
 s_mov_b32 m0, 131072
 s_nop 0
 buffer_load_dwordx4 v10, s[8:11], s14 offen lds
 s_add_u32 s14, s14, 32768
 s_mov_b32 m0, 132096
 s_nop 0
 buffer_load_dwordx4 v10, s[8:11], s14 offen lds
 s_add_u32 s14, s14, 32768
 s_mov_b32 m0, 133120
 s_nop 0
 buffer_load_dwordx4 v10, s[8:11], s14 offen lds
 s_add_u32 s14, s14, 32768
 s_mov_b32 m0, 134144
 s_nop 0
 buffer_load_dwordx4 v10, s[8:11], s14 offen lds
 s_add_u32 s14, s14, 32768
 s_mov_b32 m0, 135168
 s_nop 0
 buffer_load_dwordx4 v11, s[8:11], s14 offen lds
 s_add_u32 s14, s14, 32768
 s_mov_b32 m0, 136192
 s_nop 0
 buffer_load_dwordx4 v11, s[8:11], s14 offen lds
 s_add_u32 s14, s14, 32768
 s_mov_b32 m0, 137216
 s_nop 0
 buffer_load_dwordx4 v11, s[8:11], s14 offen lds
 s_add_u32 s14, s14, 32768
 s_mov_b32 m0, 138240
 s_nop 0
 buffer_load_dwordx4 v11, s[8:11], s14 offen lds
 s_waitcnt vmcnt(32)
 s_barrier
 v_xor_b32 v16, 0, v12
 v_add_u32 v16, 0, v16
 ds_read_b64_tr_b16 a[160:161], v16 offset:0
 ds_read_b64_tr_b16 a[162:163], v16 offset:8192
 ds_read_b64_tr_b16 a[164:165], v16 offset:2048
 ds_read_b64_tr_b16 a[166:167], v16 offset:10240
 v_xor_b32 v16, 32, v12
 v_add_u32 v16, 0, v16
 ds_read_b64_tr_b16 a[168:169], v16 offset:0
 ds_read_b64_tr_b16 a[170:171], v16 offset:8192
 ds_read_b64_tr_b16 a[172:173], v16 offset:2048
 ds_read_b64_tr_b16 a[174:175], v16 offset:10240
 v_xor_b32 v16, 0, v12
 v_add_u32 v16, 0, v16
 ds_read_b64_tr_b16 a[176:177], v16 offset:16384
 ds_read_b64_tr_b16 a[178:179], v16 offset:24576
 ds_read_b64_tr_b16 a[180:181], v16 offset:18432
 ds_read_b64_tr_b16 a[182:183], v16 offset:26624
 v_xor_b32 v16, 32, v12
 v_add_u32 v16, 0, v16
 ds_read_b64_tr_b16 a[184:185], v16 offset:16384
 ds_read_b64_tr_b16 a[186:187], v16 offset:24576
 ds_read_b64_tr_b16 a[188:189], v16 offset:18432
 ds_read_b64_tr_b16 a[190:191], v16 offset:26624
 s_waitcnt lgkmcnt(0)
 s_barrier
 s_mov_b32 s8, s22
 s_and_b32 s9, s23, 0xffff
 s_mov_b32 s10, 5242880
 s_lshl_b32 s14, s52, 8
 s_add_u32 s14, s14, 0
 s_mov_b32 m0, 0
 s_nop 0
 buffer_load_dwordx4 v10, s[8:11], s14 offen lds
 s_add_u32 s14, s14, 32768
 s_mov_b32 m0, 1024
 s_nop 0
 buffer_load_dwordx4 v10, s[8:11], s14 offen lds
 s_add_u32 s14, s14, 32768
 s_mov_b32 m0, 2048
 s_nop 0
 buffer_load_dwordx4 v10, s[8:11], s14 offen lds
 s_add_u32 s14, s14, 32768
 s_mov_b32 m0, 3072
 s_nop 0
 buffer_load_dwordx4 v10, s[8:11], s14 offen lds
 s_add_u32 s14, s14, 32768
 s_mov_b32 m0, 4096
 s_nop 0
 buffer_load_dwordx4 v11, s[8:11], s14 offen lds
 s_add_u32 s14, s14, 32768
 s_mov_b32 m0, 5120
 s_nop 0
 buffer_load_dwordx4 v11, s[8:11], s14 offen lds
 s_add_u32 s14, s14, 32768
 s_mov_b32 m0, 6144
 s_nop 0
 buffer_load_dwordx4 v11, s[8:11], s14 offen lds
 s_add_u32 s14, s14, 32768
 s_mov_b32 m0, 7168
 s_nop 0
 buffer_load_dwordx4 v11, s[8:11], s14 offen lds
 s_waitcnt vmcnt(32)
 s_barrier
 v_xor_b32 v16, 0, v12
 v_add_u32 v16, 32768, v16
 ds_read_b64_tr_b16 a[192:193], v16 offset:0
 ds_read_b64_tr_b16 a[194:195], v16 offset:8192
 ds_read_b64_tr_b16 a[196:197], v16 offset:2048
 ds_read_b64_tr_b16 a[198:199], v16 offset:10240
 v_xor_b32 v16, 32, v12
 v_add_u32 v16, 32768, v16
 ds_read_b64_tr_b16 a[200:201], v16 offset:0
 ds_read_b64_tr_b16 a[202:203], v16 offset:8192
 ds_read_b64_tr_b16 a[204:205], v16 offset:2048
 ds_read_b64_tr_b16 a[206:207], v16 offset:10240
 v_xor_b32 v16, 0, v12
 v_add_u32 v16, 32768, v16
 ds_read_b64_tr_b16 a[208:209], v16 offset:16384
 ds_read_b64_tr_b16 a[210:211], v16 offset:24576
 ds_read_b64_tr_b16 a[212:213], v16 offset:18432
 ds_read_b64_tr_b16 a[214:215], v16 offset:26624
 v_xor_b32 v16, 32, v12
 v_add_u32 v16, 32768, v16
 ds_read_b64_tr_b16 a[216:217], v16 offset:16384
 ds_read_b64_tr_b16 a[218:219], v16 offset:24576
 ds_read_b64_tr_b16 a[220:221], v16 offset:18432
 ds_read_b64_tr_b16 a[222:223], v16 offset:26624
 s_waitcnt lgkmcnt(0)
 s_barrier
 s_lshl_b32 s14, s52, 8
 s_add_u32 s14, s14, 1048576
 s_mov_b32 m0, 32768
 s_nop 0
 buffer_load_dwordx4 v10, s[8:11], s14 offen lds
 s_add_u32 s14, s14, 32768
 s_mov_b32 m0, 33792
 s_nop 0
 buffer_load_dwordx4 v10, s[8:11], s14 offen lds
 s_add_u32 s14, s14, 32768
 s_mov_b32 m0, 34816
 s_nop 0
 buffer_load_dwordx4 v10, s[8:11], s14 offen lds
 s_add_u32 s14, s14, 32768
 s_mov_b32 m0, 35840
 s_nop 0
 buffer_load_dwordx4 v10, s[8:11], s14 offen lds
 s_add_u32 s14, s14, 32768
 s_mov_b32 m0, 36864
 s_nop 0
 buffer_load_dwordx4 v11, s[8:11], s14 offen lds
 s_add_u32 s14, s14, 32768
 s_mov_b32 m0, 37888
 s_nop 0
 buffer_load_dwordx4 v11, s[8:11], s14 offen lds
 s_add_u32 s14, s14, 32768
 s_mov_b32 m0, 38912
 s_nop 0
 buffer_load_dwordx4 v11, s[8:11], s14 offen lds
 s_add_u32 s14, s14, 32768
 s_mov_b32 m0, 39936
 s_nop 0
 buffer_load_dwordx4 v11, s[8:11], s14 offen lds
 s_waitcnt vmcnt(32)
 s_barrier
 v_xor_b32 v16, 0, v12
 v_add_u32 v16, 65536, v16
 ds_read_b64_tr_b16 a[224:225], v16 offset:0
 ds_read_b64_tr_b16 a[226:227], v16 offset:8192
 ds_read_b64_tr_b16 a[228:229], v16 offset:2048
 ds_read_b64_tr_b16 a[230:231], v16 offset:10240
 v_xor_b32 v16, 32, v12
 v_add_u32 v16, 65536, v16
 ds_read_b64_tr_b16 a[232:233], v16 offset:0
 ds_read_b64_tr_b16 a[234:235], v16 offset:8192
 ds_read_b64_tr_b16 a[236:237], v16 offset:2048
 ds_read_b64_tr_b16 a[238:239], v16 offset:10240
 v_xor_b32 v16, 0, v12
 v_add_u32 v16, 65536, v16
 ds_read_b64_tr_b16 a[240:241], v16 offset:16384
 ds_read_b64_tr_b16 a[242:243], v16 offset:24576
 ds_read_b64_tr_b16 a[244:245], v16 offset:18432
 ds_read_b64_tr_b16 a[246:247], v16 offset:26624
 v_xor_b32 v16, 32, v12
 v_add_u32 v16, 65536, v16
 ds_read_b64_tr_b16 a[248:249], v16 offset:16384
 ds_read_b64_tr_b16 a[250:251], v16 offset:24576
 ds_read_b64_tr_b16 a[252:253], v16 offset:18432
 ds_read_b64_tr_b16 a[254:255], v16 offset:26624
 s_waitcnt lgkmcnt(0)
 s_barrier
 s_lshl_b32 s14, s52, 8
 s_add_u32 s14, s14, 2097152
 s_mov_b32 m0, 65536
 s_nop 0
 buffer_load_dwordx4 v10, s[8:11], s14 offen lds
 s_add_u32 s14, s14, 32768
 s_mov_b32 m0, 66560
 s_nop 0
 buffer_load_dwordx4 v10, s[8:11], s14 offen lds
 s_add_u32 s14, s14, 32768
 s_mov_b32 m0, 67584
 s_nop 0
 buffer_load_dwordx4 v10, s[8:11], s14 offen lds
 s_add_u32 s14, s14, 32768
 s_mov_b32 m0, 68608
 s_nop 0
 buffer_load_dwordx4 v10, s[8:11], s14 offen lds
 s_add_u32 s14, s14, 32768
 s_mov_b32 m0, 69632
 s_nop 0
 buffer_load_dwordx4 v11, s[8:11], s14 offen lds
 s_add_u32 s14, s14, 32768
 s_mov_b32 m0, 70656
 s_nop 0
 buffer_load_dwordx4 v11, s[8:11], s14 offen lds
 s_add_u32 s14, s14, 32768
 s_mov_b32 m0, 71680
 s_nop 0
 buffer_load_dwordx4 v11, s[8:11], s14 offen lds
 s_add_u32 s14, s14, 32768
 s_mov_b32 m0, 72704
 s_nop 0
 buffer_load_dwordx4 v11, s[8:11], s14 offen lds
 s_waitcnt vmcnt(32)
 s_barrier
 v_xor_b32 v16, 0, v12
 v_add_u32 v16, 98304, v16
 ds_read_b64_tr_b16 v[64:65], v16 offset:0
 ds_read_b64_tr_b16 v[66:67], v16 offset:8192
 ds_read_b64_tr_b16 v[68:69], v16 offset:2048
 ds_read_b64_tr_b16 v[70:71], v16 offset:10240
 v_xor_b32 v16, 32, v12
 v_add_u32 v16, 98304, v16
 ds_read_b64_tr_b16 v[72:73], v16 offset:0
 ds_read_b64_tr_b16 v[74:75], v16 offset:8192
 ds_read_b64_tr_b16 v[76:77], v16 offset:2048
 ds_read_b64_tr_b16 v[78:79], v16 offset:10240
 v_xor_b32 v16, 0, v12
 v_add_u32 v16, 98304, v16
 ds_read_b64_tr_b16 v[80:81], v16 offset:16384
 ds_read_b64_tr_b16 v[82:83], v16 offset:24576
 ds_read_b64_tr_b16 v[84:85], v16 offset:18432
 ds_read_b64_tr_b16 v[86:87], v16 offset:26624
 v_xor_b32 v16, 32, v12
 v_add_u32 v16, 98304, v16
 ds_read_b64_tr_b16 v[88:89], v16 offset:16384
 ds_read_b64_tr_b16 v[90:91], v16 offset:24576
 ds_read_b64_tr_b16 v[92:93], v16 offset:18432
 ds_read_b64_tr_b16 v[94:95], v16 offset:26624
 s_waitcnt lgkmcnt(0)
 s_barrier
 s_lshl_b32 s14, s52, 8
 s_add_u32 s14, s14, 3145728
 s_mov_b32 m0, 98304
 s_nop 0
 buffer_load_dwordx4 v10, s[8:11], s14 offen lds
 s_add_u32 s14, s14, 32768
 s_mov_b32 m0, 99328
 s_nop 0
 buffer_load_dwordx4 v10, s[8:11], s14 offen lds
 s_add_u32 s14, s14, 32768
 s_mov_b32 m0, 100352
 s_nop 0
 buffer_load_dwordx4 v10, s[8:11], s14 offen lds
 s_add_u32 s14, s14, 32768
 s_mov_b32 m0, 101376
 s_nop 0
 buffer_load_dwordx4 v10, s[8:11], s14 offen lds
 s_add_u32 s14, s14, 32768
 s_mov_b32 m0, 102400
 s_nop 0
 buffer_load_dwordx4 v11, s[8:11], s14 offen lds
 s_add_u32 s14, s14, 32768
 s_mov_b32 m0, 103424
 s_nop 0
 buffer_load_dwordx4 v11, s[8:11], s14 offen lds
 s_add_u32 s14, s14, 32768
 s_mov_b32 m0, 104448
 s_nop 0
 buffer_load_dwordx4 v11, s[8:11], s14 offen lds
 s_add_u32 s14, s14, 32768
 s_mov_b32 m0, 105472
 s_nop 0
 buffer_load_dwordx4 v11, s[8:11], s14 offen lds
 s_waitcnt vmcnt(32)
 s_barrier
 v_xor_b32 v16, 0, v12
 v_add_u32 v16, 131072, v16
 ds_read_b64_tr_b16 v[96:97], v16 offset:0
 ds_read_b64_tr_b16 v[98:99], v16 offset:8192
 ds_read_b64_tr_b16 v[100:101], v16 offset:2048
 ds_read_b64_tr_b16 v[102:103], v16 offset:10240
 v_xor_b32 v16, 32, v12
 v_add_u32 v16, 131072, v16
 ds_read_b64_tr_b16 v[104:105], v16 offset:0
 ds_read_b64_tr_b16 v[106:107], v16 offset:8192
 ds_read_b64_tr_b16 v[108:109], v16 offset:2048
 ds_read_b64_tr_b16 v[110:111], v16 offset:10240
 v_xor_b32 v16, 0, v12
 v_add_u32 v16, 131072, v16
 ds_read_b64_tr_b16 v[112:113], v16 offset:16384
 ds_read_b64_tr_b16 v[114:115], v16 offset:24576
 ds_read_b64_tr_b16 v[116:117], v16 offset:18432
 ds_read_b64_tr_b16 v[118:119], v16 offset:26624
 v_xor_b32 v16, 32, v12
 v_add_u32 v16, 131072, v16
 ds_read_b64_tr_b16 v[120:121], v16 offset:16384
 ds_read_b64_tr_b16 v[122:123], v16 offset:24576
 ds_read_b64_tr_b16 v[124:125], v16 offset:18432
 ds_read_b64_tr_b16 v[126:127], v16 offset:26624
 s_waitcnt lgkmcnt(0)
 s_barrier
 s_lshl_b32 s14, s52, 8
 s_add_u32 s14, s14, 4194304
 s_mov_b32 m0, 131072
 s_nop 0
 buffer_load_dwordx4 v10, s[8:11], s14 offen lds
 s_add_u32 s14, s14, 32768
 s_mov_b32 m0, 132096
 s_nop 0
 buffer_load_dwordx4 v10, s[8:11], s14 offen lds
 s_add_u32 s14, s14, 32768
 s_mov_b32 m0, 133120
 s_nop 0
 buffer_load_dwordx4 v10, s[8:11], s14 offen lds
 s_add_u32 s14, s14, 32768
 s_mov_b32 m0, 134144
 s_nop 0
 buffer_load_dwordx4 v10, s[8:11], s14 offen lds
 s_add_u32 s14, s14, 32768
 s_mov_b32 m0, 135168
 s_nop 0
 buffer_load_dwordx4 v11, s[8:11], s14 offen lds
 s_add_u32 s14, s14, 32768
 s_mov_b32 m0, 136192
 s_nop 0
 buffer_load_dwordx4 v11, s[8:11], s14 offen lds
 s_add_u32 s14, s14, 32768
 s_mov_b32 m0, 137216
 s_nop 0
 buffer_load_dwordx4 v11, s[8:11], s14 offen lds
 s_add_u32 s14, s14, 32768
 s_mov_b32 m0, 138240
 s_nop 0
 buffer_load_dwordx4 v11, s[8:11], s14 offen lds
 s_waitcnt vmcnt(32)
 s_barrier
 v_xor_b32 v16, 0, v12
 v_add_u32 v16, 0, v16
 ds_read_b64_tr_b16 v[32:33], v16 offset:0
 ds_read_b64_tr_b16 v[34:35], v16 offset:8192
 ds_read_b64_tr_b16 v[36:37], v16 offset:2048
 ds_read_b64_tr_b16 v[38:39], v16 offset:10240
 s_add_u32 s3, s63, 0
 s_waitcnt lgkmcnt(2)
 buffer_store_dwordx4 v[32:35], v1, s[4:7], s3 offen offset:0
 s_waitcnt lgkmcnt(0)
 buffer_store_dwordx4 v[36:39], v1, s[4:7], s3 offen offset:1024
 v_xor_b32 v16, 32, v12
 v_add_u32 v16, 0, v16
 ds_read_b64_tr_b16 v[40:41], v16 offset:0
 ds_read_b64_tr_b16 v[42:43], v16 offset:8192
 ds_read_b64_tr_b16 v[44:45], v16 offset:2048
 ds_read_b64_tr_b16 v[46:47], v16 offset:10240
 s_add_u32 s3, s63, 2048
 s_waitcnt lgkmcnt(2)
 buffer_store_dwordx4 v[40:43], v1, s[4:7], s3 offen offset:0
 s_waitcnt lgkmcnt(0)
 buffer_store_dwordx4 v[44:47], v1, s[4:7], s3 offen offset:1024
 v_xor_b32 v16, 0, v12
 v_add_u32 v16, 0, v16
 ds_read_b64_tr_b16 v[48:49], v16 offset:16384
 ds_read_b64_tr_b16 v[50:51], v16 offset:24576
 ds_read_b64_tr_b16 v[52:53], v16 offset:18432
 ds_read_b64_tr_b16 v[54:55], v16 offset:26624
 s_add_u32 s3, s63, 4096
 s_waitcnt lgkmcnt(2)
 buffer_store_dwordx4 v[48:51], v1, s[4:7], s3 offen offset:0
 s_waitcnt lgkmcnt(0)
 buffer_store_dwordx4 v[52:55], v1, s[4:7], s3 offen offset:1024
 v_xor_b32 v16, 32, v12
 v_add_u32 v16, 0, v16
 ds_read_b64_tr_b16 v[56:57], v16 offset:16384
 ds_read_b64_tr_b16 v[58:59], v16 offset:24576
 ds_read_b64_tr_b16 v[60:61], v16 offset:18432
 ds_read_b64_tr_b16 v[62:63], v16 offset:26624
 s_add_u32 s3, s63, 6144
 s_waitcnt lgkmcnt(2)
 buffer_store_dwordx4 v[56:59], v1, s[4:7], s3 offen offset:0
 s_waitcnt lgkmcnt(0)
 buffer_store_dwordx4 v[60:63], v1, s[4:7], s3 offen offset:1024
 s_waitcnt lgkmcnt(0)
 s_barrier
 s_mov_b32 s8, s20
 s_and_b32 s9, s21, 0xffff
 s_mov_b32 s10, 5242880
 s_lshl_b32 s14, s52, 8
 s_add_u32 s14, s14, 0
 s_mov_b32 m0, 0
 s_nop 0
 buffer_load_dwordx4 v10, s[8:11], s14 offen lds
 s_add_u32 s14, s14, 32768
 s_mov_b32 m0, 1024
 s_nop 0
 buffer_load_dwordx4 v10, s[8:11], s14 offen lds
 s_add_u32 s14, s14, 32768
 s_mov_b32 m0, 2048
 s_nop 0
 buffer_load_dwordx4 v10, s[8:11], s14 offen lds
 s_add_u32 s14, s14, 32768
 s_mov_b32 m0, 3072
 s_nop 0
 buffer_load_dwordx4 v10, s[8:11], s14 offen lds
 s_add_u32 s14, s14, 32768
 s_mov_b32 m0, 4096
 s_nop 0
 buffer_load_dwordx4 v11, s[8:11], s14 offen lds
 s_add_u32 s14, s14, 32768
 s_mov_b32 m0, 5120
 s_nop 0
 buffer_load_dwordx4 v11, s[8:11], s14 offen lds
 s_add_u32 s14, s14, 32768
 s_mov_b32 m0, 6144
 s_nop 0
 buffer_load_dwordx4 v11, s[8:11], s14 offen lds
 s_add_u32 s14, s14, 32768
 s_mov_b32 m0, 7168
 s_nop 0
 buffer_load_dwordx4 v11, s[8:11], s14 offen lds
 s_waitcnt vmcnt(40)
 s_barrier
 v_xor_b32 v16, 0, v12
 v_add_u32 v16, 32768, v16
 ds_read_b64_tr_b16 v[128:129], v16 offset:0
 ds_read_b64_tr_b16 v[130:131], v16 offset:8192
 ds_read_b64_tr_b16 v[132:133], v16 offset:2048
 ds_read_b64_tr_b16 v[134:135], v16 offset:10240
 v_xor_b32 v16, 32, v12
 v_add_u32 v16, 32768, v16
 ds_read_b64_tr_b16 v[136:137], v16 offset:0
 ds_read_b64_tr_b16 v[138:139], v16 offset:8192
 ds_read_b64_tr_b16 v[140:141], v16 offset:2048
 ds_read_b64_tr_b16 v[142:143], v16 offset:10240
 v_xor_b32 v16, 0, v12
 v_add_u32 v16, 32768, v16
 ds_read_b64_tr_b16 v[144:145], v16 offset:16384
 ds_read_b64_tr_b16 v[146:147], v16 offset:24576
 ds_read_b64_tr_b16 v[148:149], v16 offset:18432
 ds_read_b64_tr_b16 v[150:151], v16 offset:26624
 v_xor_b32 v16, 32, v12
 v_add_u32 v16, 32768, v16
 ds_read_b64_tr_b16 v[152:153], v16 offset:16384
 ds_read_b64_tr_b16 v[154:155], v16 offset:24576
 ds_read_b64_tr_b16 v[156:157], v16 offset:18432
 ds_read_b64_tr_b16 v[158:159], v16 offset:26624
 s_waitcnt lgkmcnt(0)
 s_barrier
 s_lshl_b32 s14, s52, 8
 s_add_u32 s14, s14, 1048576
 s_mov_b32 m0, 32768
 s_nop 0
 buffer_load_dwordx4 v10, s[8:11], s14 offen lds
 s_add_u32 s14, s14, 32768
 s_mov_b32 m0, 33792
 s_nop 0
 buffer_load_dwordx4 v10, s[8:11], s14 offen lds
 s_add_u32 s14, s14, 32768
 s_mov_b32 m0, 34816
 s_nop 0
 buffer_load_dwordx4 v10, s[8:11], s14 offen lds
 s_add_u32 s14, s14, 32768
 s_mov_b32 m0, 35840
 s_nop 0
 buffer_load_dwordx4 v10, s[8:11], s14 offen lds
 s_add_u32 s14, s14, 32768
 s_mov_b32 m0, 36864
 s_nop 0
 buffer_load_dwordx4 v11, s[8:11], s14 offen lds
 s_add_u32 s14, s14, 32768
 s_mov_b32 m0, 37888
 s_nop 0
 buffer_load_dwordx4 v11, s[8:11], s14 offen lds
 s_add_u32 s14, s14, 32768
 s_mov_b32 m0, 38912
 s_nop 0
 buffer_load_dwordx4 v11, s[8:11], s14 offen lds
 s_add_u32 s14, s14, 32768
 s_mov_b32 m0, 39936
 s_nop 0
 buffer_load_dwordx4 v11, s[8:11], s14 offen lds
 s_waitcnt vmcnt(40)
 s_barrier
 v_xor_b32 v16, 0, v12
 v_add_u32 v16, 65536, v16
 ds_read_b64_tr_b16 v[160:161], v16 offset:0
 ds_read_b64_tr_b16 v[162:163], v16 offset:8192
 ds_read_b64_tr_b16 v[164:165], v16 offset:2048
 ds_read_b64_tr_b16 v[166:167], v16 offset:10240
 v_xor_b32 v16, 32, v12
 v_add_u32 v16, 65536, v16
 ds_read_b64_tr_b16 v[168:169], v16 offset:0
 ds_read_b64_tr_b16 v[170:171], v16 offset:8192
 ds_read_b64_tr_b16 v[172:173], v16 offset:2048
 ds_read_b64_tr_b16 v[174:175], v16 offset:10240
 v_xor_b32 v16, 0, v12
 v_add_u32 v16, 65536, v16
 ds_read_b64_tr_b16 v[176:177], v16 offset:16384
 ds_read_b64_tr_b16 v[178:179], v16 offset:24576
 ds_read_b64_tr_b16 v[180:181], v16 offset:18432
 ds_read_b64_tr_b16 v[182:183], v16 offset:26624
 v_xor_b32 v16, 32, v12
 v_add_u32 v16, 65536, v16
 ds_read_b64_tr_b16 v[184:185], v16 offset:16384
 ds_read_b64_tr_b16 v[186:187], v16 offset:24576
 ds_read_b64_tr_b16 v[188:189], v16 offset:18432
 ds_read_b64_tr_b16 v[190:191], v16 offset:26624
 s_waitcnt lgkmcnt(0)
 s_barrier
 s_lshl_b32 s14, s52, 8
 s_add_u32 s14, s14, 2097152
 s_mov_b32 m0, 65536
 s_nop 0
 buffer_load_dwordx4 v10, s[8:11], s14 offen lds
 s_add_u32 s14, s14, 32768
 s_mov_b32 m0, 66560
 s_nop 0
 buffer_load_dwordx4 v10, s[8:11], s14 offen lds
 s_add_u32 s14, s14, 32768
 s_mov_b32 m0, 67584
 s_nop 0
 buffer_load_dwordx4 v10, s[8:11], s14 offen lds
 s_add_u32 s14, s14, 32768
 s_mov_b32 m0, 68608
 s_nop 0
 buffer_load_dwordx4 v10, s[8:11], s14 offen lds
 s_add_u32 s14, s14, 32768
 s_mov_b32 m0, 69632
 s_nop 0
 buffer_load_dwordx4 v11, s[8:11], s14 offen lds
 s_add_u32 s14, s14, 32768
 s_mov_b32 m0, 70656
 s_nop 0
 buffer_load_dwordx4 v11, s[8:11], s14 offen lds
 s_add_u32 s14, s14, 32768
 s_mov_b32 m0, 71680
 s_nop 0
 buffer_load_dwordx4 v11, s[8:11], s14 offen lds
 s_add_u32 s14, s14, 32768
 s_mov_b32 m0, 72704
 s_nop 0
 buffer_load_dwordx4 v11, s[8:11], s14 offen lds
 s_waitcnt vmcnt(40)
 s_barrier
 v_xor_b32 v16, 0, v12
 v_add_u32 v16, 98304, v16
 ds_read_b64_tr_b16 v[192:193], v16 offset:0
 ds_read_b64_tr_b16 v[194:195], v16 offset:8192
 ds_read_b64_tr_b16 v[196:197], v16 offset:2048
 ds_read_b64_tr_b16 v[198:199], v16 offset:10240
 v_xor_b32 v16, 32, v12
 v_add_u32 v16, 98304, v16
 ds_read_b64_tr_b16 v[32:33], v16 offset:0
 ds_read_b64_tr_b16 v[34:35], v16 offset:8192
 ds_read_b64_tr_b16 v[36:37], v16 offset:2048
 ds_read_b64_tr_b16 v[38:39], v16 offset:10240
 s_add_u32 s3, s63, 8192
 s_waitcnt lgkmcnt(2)
 buffer_store_dwordx4 v[32:35], v1, s[4:7], s3 offen offset:0
 s_waitcnt lgkmcnt(0)
 buffer_store_dwordx4 v[36:39], v1, s[4:7], s3 offen offset:1024
 v_xor_b32 v16, 0, v12
 v_add_u32 v16, 98304, v16
 ds_read_b64_tr_b16 v[200:201], v16 offset:16384
 ds_read_b64_tr_b16 v[202:203], v16 offset:24576
 ds_read_b64_tr_b16 v[204:205], v16 offset:18432
 ds_read_b64_tr_b16 v[206:207], v16 offset:26624
 v_xor_b32 v16, 32, v12
 v_add_u32 v16, 98304, v16
 ds_read_b64_tr_b16 v[208:209], v16 offset:16384
 ds_read_b64_tr_b16 v[210:211], v16 offset:24576
 ds_read_b64_tr_b16 v[212:213], v16 offset:18432
 ds_read_b64_tr_b16 v[214:215], v16 offset:26624
 s_waitcnt lgkmcnt(0)
 s_barrier
 s_lshl_b32 s14, s52, 8
 s_add_u32 s14, s14, 3145728
 s_mov_b32 m0, 98304
 s_nop 0
 buffer_load_dwordx4 v10, s[8:11], s14 offen lds
 s_add_u32 s14, s14, 32768
 s_mov_b32 m0, 99328
 s_nop 0
 buffer_load_dwordx4 v10, s[8:11], s14 offen lds
 s_add_u32 s14, s14, 32768
 s_mov_b32 m0, 100352
 s_nop 0
 buffer_load_dwordx4 v10, s[8:11], s14 offen lds
 s_add_u32 s14, s14, 32768
 s_mov_b32 m0, 101376
 s_nop 0
 buffer_load_dwordx4 v10, s[8:11], s14 offen lds
 s_add_u32 s14, s14, 32768
 s_mov_b32 m0, 102400
 s_nop 0
 buffer_load_dwordx4 v11, s[8:11], s14 offen lds
 s_add_u32 s14, s14, 32768
 s_mov_b32 m0, 103424
 s_nop 0
 buffer_load_dwordx4 v11, s[8:11], s14 offen lds
 s_add_u32 s14, s14, 32768
 s_mov_b32 m0, 104448
 s_nop 0
 buffer_load_dwordx4 v11, s[8:11], s14 offen lds
 s_add_u32 s14, s14, 32768
 s_mov_b32 m0, 105472
 s_nop 0
 buffer_load_dwordx4 v11, s[8:11], s14 offen lds
 s_waitcnt vmcnt(42)
 s_barrier
 v_xor_b32 v16, 0, v12
 v_add_u32 v16, 131072, v16
 ds_read_b64_tr_b16 v[216:217], v16 offset:0
 ds_read_b64_tr_b16 v[218:219], v16 offset:8192
 ds_read_b64_tr_b16 v[220:221], v16 offset:2048
 ds_read_b64_tr_b16 v[222:223], v16 offset:10240
 v_xor_b32 v16, 32, v12
 v_add_u32 v16, 131072, v16
 ds_read_b64_tr_b16 v[224:225], v16 offset:0
 ds_read_b64_tr_b16 v[226:227], v16 offset:8192
 ds_read_b64_tr_b16 v[228:229], v16 offset:2048
 ds_read_b64_tr_b16 v[230:231], v16 offset:10240
 v_xor_b32 v16, 0, v12
 v_add_u32 v16, 131072, v16
 ds_read_b64_tr_b16 v[232:233], v16 offset:16384
 ds_read_b64_tr_b16 v[234:235], v16 offset:24576
 ds_read_b64_tr_b16 v[236:237], v16 offset:18432
 ds_read_b64_tr_b16 v[238:239], v16 offset:26624
 v_xor_b32 v16, 32, v12
 v_add_u32 v16, 131072, v16
 ds_read_b64_tr_b16 v[40:41], v16 offset:16384
 ds_read_b64_tr_b16 v[42:43], v16 offset:24576
 ds_read_b64_tr_b16 v[44:45], v16 offset:18432
 ds_read_b64_tr_b16 v[46:47], v16 offset:26624
 s_add_u32 s3, s63, 10240
 s_waitcnt lgkmcnt(2)
 buffer_store_dwordx4 v[40:43], v1, s[4:7], s3 offen offset:0
 s_waitcnt lgkmcnt(0)
 buffer_store_dwordx4 v[44:47], v1, s[4:7], s3 offen offset:1024
 s_waitcnt lgkmcnt(0)
 s_barrier
 s_lshl_b32 s14, s52, 8
 s_add_u32 s14, s14, 4194304
 s_mov_b32 m0, 131072
 s_nop 0
 buffer_load_dwordx4 v10, s[8:11], s14 offen lds
 s_add_u32 s14, s14, 32768
 s_mov_b32 m0, 132096
 s_nop 0
 buffer_load_dwordx4 v10, s[8:11], s14 offen lds
 s_add_u32 s14, s14, 32768
 s_mov_b32 m0, 133120
 s_nop 0
 buffer_load_dwordx4 v10, s[8:11], s14 offen lds
 s_add_u32 s14, s14, 32768
 s_mov_b32 m0, 134144
 s_nop 0
 buffer_load_dwordx4 v10, s[8:11], s14 offen lds
 s_add_u32 s14, s14, 32768
 s_mov_b32 m0, 135168
 s_nop 0
 buffer_load_dwordx4 v11, s[8:11], s14 offen lds
 s_add_u32 s14, s14, 32768
 s_mov_b32 m0, 136192
 s_nop 0
 buffer_load_dwordx4 v11, s[8:11], s14 offen lds
 s_add_u32 s14, s14, 32768
 s_mov_b32 m0, 137216
 s_nop 0
 buffer_load_dwordx4 v11, s[8:11], s14 offen lds
 s_add_u32 s14, s14, 32768
 s_mov_b32 m0, 138240
 s_nop 0
 buffer_load_dwordx4 v11, s[8:11], s14 offen lds
 s_waitcnt vmcnt(36)
 s_barrier
 v_xor_b32 v16, 0, v12
 v_add_u32 v16, 0, v16
 ds_read_b64_tr_b16 v[240:241], v16 offset:0
 ds_read_b64_tr_b16 v[242:243], v16 offset:8192
 ds_read_b64_tr_b16 v[244:245], v16 offset:2048
 ds_read_b64_tr_b16 v[246:247], v16 offset:10240
 v_xor_b32 v16, 32, v12
 v_add_u32 v16, 0, v16
 ds_read_b64_tr_b16 v[248:249], v16 offset:0
 ds_read_b64_tr_b16 v[250:251], v16 offset:8192
 ds_read_b64_tr_b16 v[252:253], v16 offset:2048
 ds_read_b64_tr_b16 v[254:255], v16 offset:10240
 v_xor_b32 v16, 0, v12
 v_add_u32 v16, 0, v16
 ds_read_b64_tr_b16 v[32:33], v16 offset:16384
 ds_read_b64_tr_b16 v[34:35], v16 offset:24576
 ds_read_b64_tr_b16 v[36:37], v16 offset:18432
 ds_read_b64_tr_b16 v[38:39], v16 offset:26624
 v_xor_b32 v16, 32, v12
 v_add_u32 v16, 0, v16
 ds_read_b64_tr_b16 v[40:41], v16 offset:16384
 ds_read_b64_tr_b16 v[42:43], v16 offset:24576
 ds_read_b64_tr_b16 v[44:45], v16 offset:18432
 ds_read_b64_tr_b16 v[46:47], v16 offset:26624
 s_waitcnt lgkmcnt(0)
 s_barrier
 ds_write_b128 v1, v[224:227] offset:16384
 ds_write_b128 v1, v[228:231] offset:17408
 ds_write_b128 v1, v[216:219] offset:18432
 ds_write_b128 v1, v[220:223] offset:19456
 s_waitcnt lgkmcnt(0)
 v_mov_b32 v224, v32
 v_mov_b32 v225, v33
 v_mov_b32 v226, v34
 v_mov_b32 v227, v35
 v_mov_b32 v228, v36
 v_mov_b32 v229, v37
 v_mov_b32 v230, v38
 v_mov_b32 v231, v39
 v_mov_b32 v216, v40
 v_mov_b32 v217, v41
 v_mov_b32 v218, v42
 v_mov_b32 v219, v43
 v_mov_b32 v220, v44
 v_mov_b32 v221, v45
 v_mov_b32 v222, v46
 v_mov_b32 v223, v47
 s_waitcnt vmcnt(28)
 s_barrier
 v_xor_b32 v16, 0, v12
 v_add_u32 v16, 32768, v16
 ds_read_b64_tr_b16 v[32:33], v16 offset:0
 ds_read_b64_tr_b16 v[34:35], v16 offset:8192
 ds_read_b64_tr_b16 v[36:37], v16 offset:2048
 ds_read_b64_tr_b16 v[38:39], v16 offset:10240
 v_xor_b32 v16, 32, v12
 v_add_u32 v16, 32768, v16
 ds_read_b64_tr_b16 v[40:41], v16 offset:0
 ds_read_b64_tr_b16 v[42:43], v16 offset:8192
 ds_read_b64_tr_b16 v[44:45], v16 offset:2048
 ds_read_b64_tr_b16 v[46:47], v16 offset:10240
 v_xor_b32 v16, 0, v12
 v_add_u32 v16, 32768, v16
 ds_read_b64_tr_b16 v[48:49], v16 offset:16384
 ds_read_b64_tr_b16 v[50:51], v16 offset:24576
 ds_read_b64_tr_b16 v[52:53], v16 offset:18432
 ds_read_b64_tr_b16 v[54:55], v16 offset:26624
 v_xor_b32 v16, 32, v12
 v_add_u32 v16, 32768, v16
 ds_read_b64_tr_b16 v[56:57], v16 offset:16384
 ds_read_b64_tr_b16 v[58:59], v16 offset:24576
 ds_read_b64_tr_b16 v[60:61], v16 offset:18432
 ds_read_b64_tr_b16 v[62:63], v16 offset:26624
 s_waitcnt lgkmcnt(0)
 s_barrier
 ds_write_b128 v1, v[200:203] offset:32768
 ds_write_b128 v1, v[204:207] offset:33792
 ds_write_b128 v1, v[192:195] offset:34816
 ds_write_b128 v1, v[196:199] offset:35840
 ds_write_b128 v1, v[184:187] offset:36864
 ds_write_b128 v1, v[188:191] offset:37888
 ds_write_b128 v1, v[176:179] offset:38912
 ds_write_b128 v1, v[180:183] offset:39936
 s_waitcnt lgkmcnt(0)
 v_mov_b32 v200, v32
 v_mov_b32 v201, v33
 v_mov_b32 v202, v34
 v_mov_b32 v203, v35
 v_mov_b32 v204, v36
 v_mov_b32 v205, v37
 v_mov_b32 v206, v38
 v_mov_b32 v207, v39
 v_mov_b32 v192, v40
 v_mov_b32 v193, v41
 v_mov_b32 v194, v42
 v_mov_b32 v195, v43
 v_mov_b32 v196, v44
 v_mov_b32 v197, v45
 v_mov_b32 v198, v46
 v_mov_b32 v199, v47
 v_mov_b32 v184, v48
 v_mov_b32 v185, v49
 v_mov_b32 v186, v50
 v_mov_b32 v187, v51
 v_mov_b32 v188, v52
 v_mov_b32 v189, v53
 v_mov_b32 v190, v54
 v_mov_b32 v191, v55
 v_mov_b32 v176, v56
 v_mov_b32 v177, v57
 v_mov_b32 v178, v58
 v_mov_b32 v179, v59
 v_mov_b32 v180, v60
 v_mov_b32 v181, v61
 v_mov_b32 v182, v62
 v_mov_b32 v183, v63
 s_waitcnt vmcnt(20)
 s_barrier
 v_xor_b32 v16, 0, v12
 v_add_u32 v16, 65536, v16
 ds_read_b64_tr_b16 v[32:33], v16 offset:0
 ds_read_b64_tr_b16 v[34:35], v16 offset:8192
 ds_read_b64_tr_b16 v[36:37], v16 offset:2048
 ds_read_b64_tr_b16 v[38:39], v16 offset:10240
 v_xor_b32 v16, 32, v12
 v_add_u32 v16, 65536, v16
 ds_read_b64_tr_b16 v[40:41], v16 offset:0
 ds_read_b64_tr_b16 v[42:43], v16 offset:8192
 ds_read_b64_tr_b16 v[44:45], v16 offset:2048
 ds_read_b64_tr_b16 v[46:47], v16 offset:10240
 v_xor_b32 v16, 0, v12
 v_add_u32 v16, 65536, v16
 ds_read_b64_tr_b16 v[48:49], v16 offset:16384
 ds_read_b64_tr_b16 v[50:51], v16 offset:24576
 ds_read_b64_tr_b16 v[52:53], v16 offset:18432
 ds_read_b64_tr_b16 v[54:55], v16 offset:26624
 v_xor_b32 v16, 32, v12
 v_add_u32 v16, 65536, v16
 ds_read_b64_tr_b16 v[56:57], v16 offset:16384
 ds_read_b64_tr_b16 v[58:59], v16 offset:24576
 ds_read_b64_tr_b16 v[60:61], v16 offset:18432
 ds_read_b64_tr_b16 v[62:63], v16 offset:26624
 s_waitcnt lgkmcnt(0)
 s_barrier
 ds_write_b128 v2, v[160:163] offset:0
 ds_write_b128 v2, v[164:167] offset:1024
 ds_write_b128 v2, v[144:147] offset:2048
 ds_write_b128 v2, v[148:151] offset:3072
 ds_write_b128 v2, v[136:139] offset:4096
 ds_write_b128 v2, v[140:143] offset:5120
 ds_write_b128 v2, v[128:131] offset:6144
 ds_write_b128 v2, v[132:135] offset:7168
 s_waitcnt lgkmcnt(0)
 v_mov_b32 v160, v32
 v_mov_b32 v161, v33
 v_mov_b32 v162, v34
 v_mov_b32 v163, v35
 v_mov_b32 v164, v36
 v_mov_b32 v165, v37
 v_mov_b32 v166, v38
 v_mov_b32 v167, v39
 v_mov_b32 v144, v40
 v_mov_b32 v145, v41
 v_mov_b32 v146, v42
 v_mov_b32 v147, v43
 v_mov_b32 v148, v44
 v_mov_b32 v149, v45
 v_mov_b32 v150, v46
 v_mov_b32 v151, v47
 v_mov_b32 v136, v48
 v_mov_b32 v137, v49
 v_mov_b32 v138, v50
 v_mov_b32 v139, v51
 v_mov_b32 v140, v52
 v_mov_b32 v141, v53
 v_mov_b32 v142, v54
 v_mov_b32 v143, v55
 v_mov_b32 v128, v56
 v_mov_b32 v129, v57
 v_mov_b32 v130, v58
 v_mov_b32 v131, v59
 v_mov_b32 v132, v60
 v_mov_b32 v133, v61
 v_mov_b32 v134, v62
 v_mov_b32 v135, v63
 s_waitcnt vmcnt(10)
 s_barrier
 v_xor_b32 v16, 0, v12
 v_add_u32 v16, 98304, v16
 ds_read_b64_tr_b16 v[32:33], v16 offset:0
 ds_read_b64_tr_b16 v[34:35], v16 offset:8192
 ds_read_b64_tr_b16 v[36:37], v16 offset:2048
 ds_read_b64_tr_b16 v[38:39], v16 offset:10240
 v_xor_b32 v16, 32, v12
 v_add_u32 v16, 98304, v16
 ds_read_b64_tr_b16 v[40:41], v16 offset:0
 ds_read_b64_tr_b16 v[42:43], v16 offset:8192
 ds_read_b64_tr_b16 v[44:45], v16 offset:2048
 ds_read_b64_tr_b16 v[46:47], v16 offset:10240
 v_xor_b32 v16, 0, v12
 v_add_u32 v16, 98304, v16
 ds_read_b64_tr_b16 v[48:49], v16 offset:16384
 ds_read_b64_tr_b16 v[50:51], v16 offset:24576
 ds_read_b64_tr_b16 v[52:53], v16 offset:18432
 ds_read_b64_tr_b16 v[54:55], v16 offset:26624
 v_xor_b32 v16, 32, v12
 v_add_u32 v16, 98304, v16
 ds_read_b64_tr_b16 v[56:57], v16 offset:16384
 ds_read_b64_tr_b16 v[58:59], v16 offset:24576
 ds_read_b64_tr_b16 v[60:61], v16 offset:18432
 ds_read_b64_tr_b16 v[62:63], v16 offset:26624
 s_waitcnt lgkmcnt(0)
 s_barrier
 ds_write_b128 v2, a[144:147] offset:32768
 ds_write_b128 v2, a[148:151] offset:33792
 ds_write_b128 v2, a[136:139] offset:34816
 ds_write_b128 v2, a[140:143] offset:35840
 ds_write_b128 v2, a[96:99] offset:36864
 ds_write_b128 v2, a[100:103] offset:37888
 ds_write_b128 v2, a[88:91] offset:38912
 ds_write_b128 v2, a[92:95] offset:39936
 s_waitcnt lgkmcnt(0)
 v_accvgpr_write_b32 a144, v32
 v_accvgpr_write_b32 a145, v33
 v_accvgpr_write_b32 a146, v34
 v_accvgpr_write_b32 a147, v35
 v_accvgpr_write_b32 a148, v36
 v_accvgpr_write_b32 a149, v37
 v_accvgpr_write_b32 a150, v38
 v_accvgpr_write_b32 a151, v39
 v_accvgpr_write_b32 a136, v40
 v_accvgpr_write_b32 a137, v41
 v_accvgpr_write_b32 a138, v42
 v_accvgpr_write_b32 a139, v43
 v_accvgpr_write_b32 a140, v44
 v_accvgpr_write_b32 a141, v45
 v_accvgpr_write_b32 a142, v46
 v_accvgpr_write_b32 a143, v47
 v_accvgpr_write_b32 a96, v48
 v_accvgpr_write_b32 a97, v49
 v_accvgpr_write_b32 a98, v50
 v_accvgpr_write_b32 a99, v51
 v_accvgpr_write_b32 a100, v52
 v_accvgpr_write_b32 a101, v53
 v_accvgpr_write_b32 a102, v54
 v_accvgpr_write_b32 a103, v55
 v_accvgpr_write_b32 a88, v56
 v_accvgpr_write_b32 a89, v57
 v_accvgpr_write_b32 a90, v58
 v_accvgpr_write_b32 a91, v59
 v_accvgpr_write_b32 a92, v60
 v_accvgpr_write_b32 a93, v61
 v_accvgpr_write_b32 a94, v62
 v_accvgpr_write_b32 a95, v63
 s_waitcnt vmcnt(0)
 s_barrier
 v_xor_b32 v16, 0, v12
 v_add_u32 v16, 131072, v16
 ds_read_b64_tr_b16 v[32:33], v16 offset:0
 ds_read_b64_tr_b16 v[34:35], v16 offset:8192
 ds_read_b64_tr_b16 v[36:37], v16 offset:2048
 ds_read_b64_tr_b16 v[38:39], v16 offset:10240
 v_xor_b32 v16, 32, v12
 v_add_u32 v16, 131072, v16
 ds_read_b64_tr_b16 v[40:41], v16 offset:0
 ds_read_b64_tr_b16 v[42:43], v16 offset:8192
 ds_read_b64_tr_b16 v[44:45], v16 offset:2048
 ds_read_b64_tr_b16 v[46:47], v16 offset:10240
 v_xor_b32 v16, 0, v12
 v_add_u32 v16, 131072, v16
 ds_read_b64_tr_b16 v[48:49], v16 offset:16384
 ds_read_b64_tr_b16 v[50:51], v16 offset:24576
 ds_read_b64_tr_b16 v[52:53], v16 offset:18432
 ds_read_b64_tr_b16 v[54:55], v16 offset:26624
 v_xor_b32 v16, 32, v12
 v_add_u32 v16, 131072, v16
 ds_read_b64_tr_b16 v[56:57], v16 offset:16384
 ds_read_b64_tr_b16 v[58:59], v16 offset:24576
 ds_read_b64_tr_b16 v[60:61], v16 offset:18432
 ds_read_b64_tr_b16 v[62:63], v16 offset:26624
 s_waitcnt lgkmcnt(0)
 s_barrier
 ds_write_b128 v3, a[80:83] offset:16384
 ds_write_b128 v3, a[84:87] offset:17408
 ds_write_b128 v3, a[64:67] offset:18432
 ds_write_b128 v3, a[68:71] offset:19456
 ds_write_b128 v3, a[40:43] offset:20480
 ds_write_b128 v3, a[44:47] offset:21504
 ds_write_b128 v3, a[24:27] offset:22528
 ds_write_b128 v3, a[28:31] offset:23552
 s_waitcnt lgkmcnt(0)
 v_accvgpr_write_b32 a80, v32
 v_accvgpr_write_b32 a81, v33
 v_accvgpr_write_b32 a82, v34
 v_accvgpr_write_b32 a83, v35
 v_accvgpr_write_b32 a84, v36
 v_accvgpr_write_b32 a85, v37
 v_accvgpr_write_b32 a86, v38
 v_accvgpr_write_b32 a87, v39
 v_accvgpr_write_b32 a64, v40
 v_accvgpr_write_b32 a65, v41
 v_accvgpr_write_b32 a66, v42
 v_accvgpr_write_b32 a67, v43
 v_accvgpr_write_b32 a68, v44
 v_accvgpr_write_b32 a69, v45
 v_accvgpr_write_b32 a70, v46
 v_accvgpr_write_b32 a71, v47
 v_accvgpr_write_b32 a40, v48
 v_accvgpr_write_b32 a41, v49
 v_accvgpr_write_b32 a42, v50
 v_accvgpr_write_b32 a43, v51
 v_accvgpr_write_b32 a44, v52
 v_accvgpr_write_b32 a45, v53
 v_accvgpr_write_b32 a46, v54
 v_accvgpr_write_b32 a47, v55
 v_accvgpr_write_b32 a24, v56
 v_accvgpr_write_b32 a25, v57
 v_accvgpr_write_b32 a26, v58
 v_accvgpr_write_b32 a27, v59
 v_accvgpr_write_b32 a28, v60
 v_accvgpr_write_b32 a29, v61
 v_accvgpr_write_b32 a30, v62
 v_accvgpr_write_b32 a31, v63
 v_lshlrev_b32 v5, 3, v0
 v_and_b32 v6, 0x1e0, v5
 v_and_b32 v7, 1, v0
 v_lshl_add_u32 v6, v7, 4, v6
 v_and_b32 v7, 2, v0
 v_lshl_add_u32 v6, v7, 2, v6
 v_bfe_u32 v4, v0, 2, 2
 v_lshrrev_b32 v7, 4, v0
 v_cmp_eq_u32 vcc, v4, v7
 v_and_b32 v7, 16, v1
 v_mov_b32 v5, 0x3f80
 v_lshlrev_b32 v7, v7, v5
 v_cndmask_b32 v4, 0, v7, vcc
 v_mov_b32 v5, 0
 s_lshl_b32 s59, s53, 16
 s_add_u32 s59, s59, 983040
 s_mul_i32 s15, s53, 327680
 s_add_u32 s15, s15, 225280
 s_lshl_b32 s3, s52, 8
 s_add_u32 s15, s15, s3
 s_add_u32 s64, s15, 0
 s_add_u32 s65, s15, 81920
 s_add_u32 s66, s15, 163840
 s_add_u32 s67, s15, 245760
 s_lshr_b32 s14, s52, 2
 s_and_b32 s15, s52, 3
 s_mov_b32 s16, 0
 s_mov_b32 s84, 0x00ff00ff
 s_mov_b32 s85, 0
 s_lshl_b32 s57, s14, 10
 s_lshl_b32 s3, s15, 6
 s_add_u32 s57, s57, s3
 s_lshl_b32 s3, s16, 8
 s_add_u32 s57, s57, s3
 s_add_u32 s57, s57, s59
 s_add_u32 s59, s59, 0
 s_lshl_b32 s14, s14, 7
 s_mul_i32 s15, s15, 2560
 s_add_u32 s14, s14, s15
 s_lshl_b32 s3, s16, 3
 s_add_u32 s14, s14, s3
 s_mov_b32 s8, s18
 s_and_b32 s9, s19, 0xffff
 s_mov_b32 s10, 10240
 s_mov_b32 s11, 0x00020000
 v_bfe_u32 v40, v0, 4, 1
 v_mul_u32_u24 v40, 1280, v40
 v_and_b32 v41, 7, v0
 v_lshl_add_u32 v40, v41, 1, v40
 buffer_load_ushort v44, v40, s[8:11], s14 offen offset:0
 buffer_load_ushort v45, v40, s[8:11], s14 offen offset:32
 buffer_load_ushort v46, v40, s[8:11], s14 offen offset:64
 buffer_load_ushort v47, v40, s[8:11], s14 offen offset:96
 v_lshrrev_b32 v42, 7, v1
 v_mul_u32_u24 v42, 10240, v42
 v_and_b32 v7, 112, v1
 v_add_u32 v42, v42, v7
 v_and_b32 v43, 32, v1
 v_and_b32 v7, 64, v1
 v_lshl_add_u32 v43, v7, 2, v43
 v_bfe_u32 v7, v1, 8, 1
 v_lshl_add_u32 v43, v7, 4, v43
 v_bfe_u32 v7, v1, 4, 1
 v_lshl_add_u32 v43, v7, 3, v43
 s_waitcnt vmcnt(2)
 v_lshl_or_b32 v44, v45, 16, v44
 s_waitcnt vmcnt(0)
 v_lshl_or_b32 v45, v47, 16, v46
 s_add_u32 s16, s60, 8192
 s_waitcnt vmcnt(0) lgkmcnt(0)
 s_mov_b32 s96, s44
 s_and_b32 s97, s45, 0xffff
 s_mov_b32 s98, 256
 s_mov_b32 s99, 0x00020000
 v_mov_b32 v8, 132
 s_mov_b32 s51, 0
 s_mov_b64 exec, 1
L_wb_159:
 buffer_load_dword v9, v8, s[96:99], 0 offen sc1
 s_waitcnt vmcnt(0)
 v_cmp_eq_u32 vcc, 0, v9
 s_cbranch_vccz L_wbd_160
 s_sleep 2
 s_add_u32 s51, s51, 1
 s_cmp_lt_u32 s51, 131072
 s_cbranch_scc1 L_wb_159
 s_branch L_bail
L_wbd_160:
 s_mov_b64 exec, -1
 s_mov_b32 s96, s44
 s_and_b32 s97, s45, 0xffff
 s_mov_b32 s98, 256
 s_mov_b32 s99, 0x00020000
 v_mov_b32 v8, 212
 s_mov_b32 s51, 0
 s_mov_b64 exec, 1
L_wb_161:
 buffer_load_dword v9, v8, s[96:99], 0 offen sc1
 s_waitcnt vmcnt(0)
 v_cmp_eq_u32 vcc, 0, v9
 s_cbranch_vccz L_wbd_162
 s_sleep 2
 s_add_u32 s51, s51, 1
 s_cmp_lt_u32 s51, 131072
 s_cbranch_scc1 L_wb_161
 s_branch L_bail
L_wbd_162:
 s_mov_b64 exec, -1
 s_mov_b32 s96, s44
 s_and_b32 s97, s45, 0xffff
 s_mov_b32 s98, 256
 s_mov_b32 s99, 0x00020000
 v_lshlrev_b32 v8, 5, v0
 s_mov_b32 s51, 0
L_gl_163:
 buffer_load_dword v9, v8, s[96:99], 0 offen sc1
 s_waitcnt vmcnt(0)
 v_readlane_b32 s3, v9, s48
 s_mov_b32 s80, 0
 s_nop 2
 s_cmp_ge_u32 s3, 32
 s_cbranch_scc1 L_gld_164
 s_mov_b32 s80, 0
 v_readlane_b32 s3, v9, 0
 s_nop 3
 s_add_u32 s80, s80, s3
 v_readlane_b32 s3, v9, 1
 s_nop 3
 s_add_u32 s80, s80, s3
 v_readlane_b32 s3, v9, 2
 s_nop 3
 s_add_u32 s80, s80, s3
 v_readlane_b32 s3, v9, 3
 s_nop 3
 s_add_u32 s80, s80, s3
 v_readlane_b32 s3, v9, 4
 s_nop 3
 s_add_u32 s80, s80, s3
 v_readlane_b32 s3, v9, 5
 s_nop 3
 s_add_u32 s80, s80, s3
 v_readlane_b32 s3, v9, 6
 s_nop 3
 s_add_u32 s80, s80, s3
 v_readlane_b32 s3, v9, 7
 s_nop 3
 s_add_u32 s80, s80, s3
 s_cmp_ge_u32 s80, 256
 s_cbranch_scc1 L_gld_164
 s_sleep 4
 s_add_u32 s51, s51, 1
 s_cmp_lt_u32 s51, 131072
 s_cbranch_scc1 L_gl_163
 s_branch L_bail
L_gld_164:
 s_mov_b64 exec, s[84:85]
 buffer_store_dwordx2 v[44:45], v43, s[4:7], s57 offen sc1
 s_mov_b64 exec, -1
 v_and_b32 v7, 2, v0
 v_mul_u32_u24 v7, 0x5555, v7
 v_add_u32 v0, 0x4444, v7
 s_mov_b32 m0, 2048
 s_waitcnt vmcnt(0) lgkmcnt(0)
 s_barrier
 buffer_load_dwordx4 v[32:35], v1, s[4:7], s63 offen offset:0
 buffer_load_dwordx4 v[36:39], v1, s[4:7], s63 offen offset:1024
 buffer_load_dwordx4 v[40:43], v1, s[4:7], s63 offen offset:2048
 buffer_load_dwordx4 v[44:47], v1, s[4:7], s63 offen offset:3072
 buffer_load_dwordx4 v[48:51], v1, s[4:7], s81 offen offset:0
 buffer_load_dwordx4 v[52:55], v1, s[4:7], s81 offen offset:1024
 buffer_load_dwordx4 v[56:59], v1, s[4:7], s81 offen offset:2048
 buffer_load_dwordx4 v[60:63], v1, s[4:7], s81 offen offset:3072
 ds_read_b128 v[8:11], v3 offset:49152
 ds_read_b128 v[12:15], v3 offset:49152
 ds_read_b128 v[16:19], v3 offset:49152
 ds_read_b128 v[20:23], v3 offset:49152
 s_waitcnt vmcnt(0) lgkmcnt(0)
 s_cmp_lg_u32 s80, 0
 s_cbranch_scc1 L_ch0_s
.p2align 6
L_ch0_f:
 s_mov_b32 s51, 0
L_pm_165:
 buffer_load_dwordx4 v[24:27], v1, s[4:7], s59 offen offset:0 sc1
 buffer_load_dwordx4 v[28:31], v1, s[4:7], s59 offen offset:1024 sc1
 s_waitcnt vmcnt(1)
 ds_write_b128 v1, v[24:27] offset:0
 v_max_u32 v7, v24, v26
 s_waitcnt vmcnt(0)
 ds_write_b128 v1, v[28:31] offset:1024
 v_max3_u32 v7, v7, v28, v30
 v_cmp_eq_u32 vcc, -1, v7
 s_cbranch_vccnz L_rt_166
 v_smfmac_f32_16x16x64_bf16 v[16:19], v[24:27], v[32:39], v0
 ds_read_b128 v[32:35], v2 offset:6144
 ds_read_b128 v[36:39], v2 offset:7168
 v_smfmac_f32_16x16x64_bf16 v[20:23], v[24:27], v[40:47], v0
 ds_read_b128 v[40:43], v2 offset:4096
 ds_read_b128 v[44:47], v2 offset:5120
 v_smfmac_f32_16x16x64_bf16 v[16:19], v[28:31], v[48:55], v0
 v_smfmac_f32_16x16x64_bf16 v[20:23], v[28:31], v[56:63], v0
 s_waitcnt lgkmcnt(4)
 s_barrier
 buffer_load_dwordx4 v[56:59], v1, s[4:7], s101 offen offset:0
 v_smfmac_f32_16x16x64_bf16 v[8:11], v[24:27], v[240:247], v0
 v_smfmac_f32_16x16x64_bf16 v[12:15], v[24:27], v[248:255], v0
 ds_read_b128 v[24:27], v1 offset:2048
 buffer_load_dwordx4 v[60:63], v1, s[4:7], s101 offen offset:1024
 v_smfmac_f32_16x16x64_bf16 v[8:11], v[28:31], v[224:231], v0
 v_smfmac_f32_16x16x64_bf16 v[12:15], v[28:31], v[216:223], v0
 ds_read_b128 v[28:31], v1 offset:3072
 buffer_load_dwordx4 v[48:51], v1, s[4:7], s101 offen offset:2048
 s_waitcnt lgkmcnt(1)
 v_smfmac_f32_16x16x64_bf16 v[16:19], v[24:27], v[32:39], v0
 ds_read_b128 v[32:35], v2 offset:2048
 ds_read_b128 v[36:39], v2 offset:3072
 v_smfmac_f32_16x16x64_bf16 v[8:11], v[24:27], v[200:207], v0
 buffer_load_dwordx4 v[52:55], v1, s[4:7], s101 offen offset:3072
 v_smfmac_f32_16x16x64_bf16 v[12:15], v[24:27], v[192:199], v0
 v_smfmac_f32_16x16x64_bf16 v[20:23], v[24:27], v[40:47], v0
 ds_read_b128 v[40:43], v2 offset:0
 ds_read_b128 v[44:47], v2 offset:1024
 ds_read_b128 v[24:27], v1 offset:4096
 s_waitcnt lgkmcnt(5)
 v_smfmac_f32_16x16x64_bf16 v[8:11], v[28:31], v[184:191], v0
 v_smfmac_f32_16x16x64_bf16 v[12:15], v[28:31], v[176:183], v0
 s_waitcnt lgkmcnt(3)
 v_smfmac_f32_16x16x64_bf16 v[16:19], v[28:31], v[32:39], v0
 ds_read_b128 v[32:35], v1 offset:38912
 ds_read_b128 v[36:39], v1 offset:39936
 v_smfmac_f32_16x16x64_bf16 v[20:23], v[28:31], v[152:159], v0
 ds_read_b128 v[28:31], v1 offset:5120
 s_waitcnt lgkmcnt(3)
 v_smfmac_f32_16x16x64_bf16 v[8:11], v[24:27], v[160:167], v0
 v_smfmac_f32_16x16x64_bf16 v[16:19], v[24:27], v[40:47], v0
 ds_read_b128 v[40:43], v1 offset:36864
 ds_read_b128 v[44:47], v1 offset:37888
 v_smfmac_f32_16x16x64_bf16 v[12:15], v[24:27], v[144:151], v0
 v_smfmac_f32_16x16x64_bf16 v[20:23], v[24:27], v[168:175], v0
 ds_read_b128 v[24:27], v1 offset:6144
 s_waitcnt lgkmcnt(3)
 v_smfmac_f32_16x16x64_bf16 v[16:19], v[28:31], v[32:39], v0
 ds_read_b128 v[32:35], v1 offset:34816
 ds_read_b128 v[36:39], v1 offset:35840
 v_smfmac_f32_16x16x64_bf16 v[8:11], v[28:31], v[136:143], v0
 v_smfmac_f32_16x16x64_bf16 v[12:15], v[28:31], v[128:135], v0
 s_waitcnt lgkmcnt(3)
 v_smfmac_f32_16x16x64_bf16 v[20:23], v[28:31], v[40:47], v0
 ds_read_b128 v[40:43], v1 offset:32768
 ds_read_b128 v[44:47], v1 offset:33792
 ds_read_b128 v[28:31], v1 offset:7168
 s_waitcnt lgkmcnt(5)
 v_smfmac_f32_16x16x64_bf16 v[8:11], v[24:27], a[144:151], v0
 v_smfmac_f32_16x16x64_bf16 v[12:15], v[24:27], a[136:143], v0
 s_waitcnt lgkmcnt(3)
 v_smfmac_f32_16x16x64_bf16 v[16:19], v[24:27], v[32:39], v0
 ds_read_b128 v[32:35], v1 offset:18432
 ds_read_b128 v[36:39], v1 offset:19456
 s_waitcnt vmcnt(2)
 v_smfmac_f32_16x16x64_bf16 v[20:23], v[24:27], v[56:63], v0
 ds_read_b128 v[24:27], v1 offset:8192
 buffer_load_dwordx4 v[56:59], v1, s[4:7], s61 offen offset:0 sc1 nt
 s_waitcnt lgkmcnt(3)
 v_smfmac_f32_16x16x64_bf16 v[8:11], v[28:31], a[96:103], v0
 v_smfmac_f32_16x16x64_bf16 v[16:19], v[28:31], v[40:47], v0
 ds_read_b128 v[40:43], v1 offset:16384
 ds_read_b128 v[44:47], v1 offset:17408
 s_add_u32 s3, s61, 4096
 buffer_load_dwordx4 v[60:63], v1, s[4:7], s3 offen offset:0 sc1 nt
 v_smfmac_f32_16x16x64_bf16 v[12:15], v[28:31], a[88:95], v0
 v_smfmac_f32_16x16x64_bf16 v[20:23], v[28:31], v[208:215], v0
 ds_read_b128 v[28:31], v1 offset:9216
 s_waitcnt lgkmcnt(3)
 v_smfmac_f32_16x16x64_bf16 v[16:19], v[24:27], v[32:39], v0
 v_smfmac_f32_16x16x64_bf16 v[8:11], v[24:27], a[80:87], v0
 s_add_u32 s3, s61, 67108864
 buffer_load_dwordx4 v[32:35], v1, s[4:7], s3 offen offset:0 sc1 nt
 v_smfmac_f32_16x16x64_bf16 v[12:15], v[24:27], a[64:71], v0
 s_waitcnt lgkmcnt(1)
 v_smfmac_f32_16x16x64_bf16 v[20:23], v[24:27], v[40:47], v0
 ds_read_b128 v[40:43], v3 offset:49152
 ds_read_b128 v[44:47], v3 offset:49152
 buffer_load_dwordx4 v[36:39], v1, s[4:7], s3 offen offset:1024 sc1 nt
 s_waitcnt lgkmcnt(2)
 v_smfmac_f32_16x16x64_bf16 v[8:11], v[28:31], a[40:47], v0
 v_smfmac_f32_16x16x64_bf16 v[12:15], v[28:31], a[24:31], v0
 v_smfmac_f32_16x16x64_bf16 v[16:19], v[28:31], v[232:239], v0
 s_waitcnt vmcnt(4)
 v_smfmac_f32_16x16x64_bf16 v[20:23], v[28:31], v[48:55], v0
 ds_read_b128 v[52:55], v1 offset:0
 v_add_f32 v8, v8, v10
 v_add_f32 v11, v9, v11
 v_cvt_pk_bf16_f32 v9, v8, v11
 v_cvt_pk_bf16_f32 v8, v8, v11
 v_add_f32 v12, v12, v14
 v_add_f32 v15, v13, v15
 v_cvt_pk_bf16_f32 v13, v12, v15
 v_cvt_pk_bf16_f32 v12, v12, v15
 v_mfma_f32_16x16x16_bf16 v[8:11], v[8:9], v[4:5], 0
 v_mfma_f32_16x16x16_bf16 v[12:15], v[12:13], v[4:5], 0
 v_add_f32 v16, v16, v18
 v_add_f32 v19, v17, v19
 v_cvt_pk_bf16_f32 v17, v16, v19
 v_cvt_pk_bf16_f32 v16, v16, v19
 v_add_f32 v20, v20, v22
 v_add_f32 v23, v21, v23
 v_cvt_pk_bf16_f32 v21, v20, v23
 v_cvt_pk_bf16_f32 v20, v20, v23
 v_mfma_f32_16x16x16_bf16 v[16:19], v[16:17], v[4:5], 0
 v_mfma_f32_16x16x16_bf16 v[20:23], v[20:21], v[4:5], 0
 s_waitcnt lgkmcnt(2)
 v_smfmac_f32_16x16x64_bf16 v[40:43], v[24:27], v[96:103], v0
 s_waitcnt lgkmcnt(1)
 v_smfmac_f32_16x16x64_bf16 v[44:47], v[24:27], v[104:111], v0
 ds_read_b128 v[24:27], v1 offset:1024
 v_cvt_pk_bf16_f32 v15, v14, v15
 v_cvt_pk_bf16_f32 v14, v12, v13
 v_cvt_pk_bf16_f32 v13, v10, v11
 v_cvt_pk_bf16_f32 v12, v8, v9
 s_waitcnt vmcnt(3)
 s_nop 0
 v_mfma_f32_16x16x32_bf16 v[8:11], v[56:59], v[12:15], 0
 v_cvt_pk_bf16_f32 v23, v22, v23
 v_cvt_pk_bf16_f32 v22, v20, v21
 v_cvt_pk_bf16_f32 v21, v18, v19
 v_cvt_pk_bf16_f32 v20, v16, v17
 s_waitcnt vmcnt(2)
 v_mfma_f32_16x16x32_bf16 v[16:19], v[60:63], v[12:15], 0
 v_mfma_f32_16x16x32_bf16 v[48:51], v[20:23], v[12:15], 0
 v_smfmac_f32_16x16x64_bf16 v[40:43], v[28:31], v[112:119], v0
 v_smfmac_f32_16x16x64_bf16 v[44:47], v[28:31], v[120:127], v0
 ds_read_b128 v[28:31], v1 offset:2048
 s_waitcnt lgkmcnt(2)
 v_smfmac_f32_16x16x64_bf16 v[40:43], v[52:55], a[160:167], v0
 v_cndmask_b32 v8, v8, v16, s[70:71]
 v_cndmask_b32 v9, v9, v17, s[70:71]
 v_cndmask_b32 v10, v10, v18, s[70:71]
 v_cndmask_b32 v11, v11, v19, s[70:71]
 ds_write_b128 v1, v[8:11] offset:10240
 ds_write_b64 v1, v[48:49] offset:14336
 v_smfmac_f32_16x16x64_bf16 v[44:47], v[52:55], a[168:175], v0
 ds_read_b128 v[52:55], v1 offset:3072
 s_waitcnt lgkmcnt(4)
 v_smfmac_f32_16x16x64_bf16 v[40:43], v[24:27], a[176:183], v0
 v_smfmac_f32_16x16x64_bf16 v[44:47], v[24:27], a[184:191], v0
 ds_read_b128 v[24:27], v1 offset:4096
 s_waitcnt lgkmcnt(4)
 v_smfmac_f32_16x16x64_bf16 v[40:43], v[28:31], a[192:199], v0
 v_smfmac_f32_16x16x64_bf16 v[44:47], v[28:31], a[200:207], v0
 ds_read_b128 v[28:31], v1 offset:5120
 s_waitcnt lgkmcnt(2)
 v_smfmac_f32_16x16x64_bf16 v[40:43], v[52:55], a[208:215], v0
 v_smfmac_f32_16x16x64_bf16 v[44:47], v[52:55], a[216:223], v0
 ds_read_b128 v[52:55], v1 offset:6144
 s_barrier
 ds_read_b128 v[56:59], v1 offset:11264
 ds_read_b128 v[60:63], v1 offset:12288
 ds_read_b128 v[16:19], v1 offset:13312
 ds_read_b128 v[12:15], v1 offset:14336
 ds_read_b128 v[48:51], v1 offset:15360
 s_waitcnt lgkmcnt(7)
 v_smfmac_f32_16x16x64_bf16 v[40:43], v[24:27], a[224:231], v0
 s_mov_b64 exec, s[68:69]
 buffer_store_dwordx4 v[20:23], v6, s[4:7], s62 offen offset:0 sc1
 s_mov_b64 exec, -1
 v_smfmac_f32_16x16x64_bf16 v[44:47], v[24:27], a[232:239], v0
 ds_read_b128 v[24:27], v1 offset:7168
 s_waitcnt lgkmcnt(7)
 v_smfmac_f32_16x16x64_bf16 v[40:43], v[28:31], a[240:247], v0
 v_smfmac_f32_16x16x64_bf16 v[44:47], v[28:31], a[248:255], v0
 s_waitcnt lgkmcnt(6)
 v_smfmac_f32_16x16x64_bf16 v[40:43], v[52:55], v[64:71], v0
 v_smfmac_f32_16x16x64_bf16 v[44:47], v[52:55], v[72:79], v0
 s_waitcnt lgkmcnt(0)
 v_smfmac_f32_16x16x64_bf16 v[40:43], v[24:27], v[80:87], v0
 v_smfmac_f32_16x16x64_bf16 v[44:47], v[24:27], v[88:95], v0
 v_pk_add_f32 v[8:9], v[8:9], v[56:57]
 v_pk_add_f32 v[10:11], v[10:11], v[58:59]
 v_pk_add_f32 v[60:61], v[60:61], v[16:17]
 v_pk_add_f32 v[62:63], v[62:63], v[18:19]
 v_pk_add_f32 v[12:13], v[12:13], v[14:15]
 v_pk_add_f32 v[48:49], v[48:49], v[50:51]
 v_pk_add_f32 v[8:9], v[8:9], v[60:61]
 v_pk_add_f32 v[10:11], v[10:11], v[62:63]
 v_pk_add_f32 v[48:49], v[12:13], v[48:49]
 v_max3_f32 v50, v8, v9, v10
 v_max3_f32 v50, v50, v11, v48
 v_max_f32 v50, v50, v49
 v_add_f32 v40, v40, v42
 v_add_f32 v41, v41, v43
 v_max_f32_dpp v50, v50, v50 quad_perm:[2,3,0,1] row_mask:0xf bank_mask:0xf
 v_mov_b32 v51, v50
 v_add_f32 v44, v44, v46
 v_add_f32 v45, v45, v47
 v_permlane16_swap_b32 v50, v51
 v_max_f32 v50, v50, v51
 v_mov_b32 v51, v50
 v_cvt_pk_bf16_f32 v40, v40, v41
 v_cvt_pk_bf16_f32 v41, v44, v45
 v_permlane32_swap_b32 v50, v51
 v_max_f32 v50, v50, v51
 v_mul_f32 v50, s56, v50
 v_fma_f32 v48, v48, s56, -v50
 v_fma_f32 v49, v49, s56, -v50
 v_fma_f32 v8, v8, s56, -v50
 v_fma_f32 v9, v9, s56, -v50
 v_fma_f32 v10, v10, s56, -v50
 v_fma_f32 v11, v11, s56, -v50
 v_exp_f32 v48, v48
 v_lshrrev_b32 v51, 1, v1
 v_exp_f32 v49, v49
 ds_read_b128 v[56:59], v3 offset:18432
 ds_read_b128 v[60:63], v3 offset:19456
 v_exp_f32 v8, v8
 v_exp_f32 v9, v9
 ds_read_b128 v[24:27], v2 offset:36864
 ds_read_b128 v[28:31], v2 offset:37888
 v_exp_f32 v10, v10
 buffer_store_dwordx2 v[40:41], v51, s[4:7], s62 offen offset:2048 sc1
 v_exp_f32 v11, v11
 v_cvt_pk_bf16_f32 v14, v48, v49
 v_cvt_pk_bf16_f32 v12, v8, v9
 v_cvt_pk_bf16_f32 v13, v10, v11
 v_cndmask_b32 v52, 0, v14, s[68:69]
 v_cndmask_b32 v53, 0, v14, s[70:71]
 v_cndmask_b32 v22, 0, v12, s[70:71]
 v_cndmask_b32 v23, 0, v13, s[70:71]
 v_mfma_f32_16x16x16_bf16 v[44:47], v[40:41], v[52:53], 0
 v_cndmask_b32 v16, 0, v12, s[68:69]
 v_cndmask_b32 v17, 0, v13, s[68:69]
 v_mov_b32_dpp v18, v22 quad_perm:[2,3,0,1] row_mask:0xf bank_mask:0xf
 v_mov_b32_dpp v19, v23 quad_perm:[2,3,0,1] row_mask:0xf bank_mask:0xf
 v_mov_b32_dpp v20, v16 quad_perm:[2,3,0,1] row_mask:0xf bank_mask:0xf
 v_mov_b32_dpp v21, v17 quad_perm:[2,3,0,1] row_mask:0xf bank_mask:0xf
 s_waitcnt vmcnt(3)
 v_mfma_f32_16x16x32_bf16 v[44:47], v[32:35], v[16:19], v[44:47]
 v_add_f32 v54, v8, v9
 v_add_f32 v55, v48, v49
 s_waitcnt vmcnt(2)
 v_mfma_f32_16x16x32_bf16 v[44:47], v[36:39], v[20:23], v[44:47]
 v_add_f32 v54, v54, v10
 v_fma_f32 v55, v55, 0.5, v11
 v_add_f32 v54, v54, v55
 ds_read_b128 v[16:19], v3 offset:49152
 ds_read_b128 v[20:23], v3 offset:49152
 v_add_f32_dpp v54, v54, v54 quad_perm:[2,3,0,1] row_mask:0xf bank_mask:0xf
 v_mov_b32 v55, v54
 ds_read_b128 v[32:35], v3 offset:49152
 ds_read_b128 v[36:39], v3 offset:49152
 v_permlane16_swap_b32 v54, v55
 v_add_f32 v54, v54, v55
 v_mov_b32 v55, v54
 ds_read_b128 v[8:11], v3 offset:49152
 s_cmp_eq_u32 s54, 63
 v_permlane32_swap_b32 v54, v55
 v_add_f32 v54, v54, v55
 v_rcp_f32 v54, v54
 s_cbranch_scc1 L_ch0_end
 v_mul_f32 v44, v44, v54
 v_mul_f32 v45, v45, v54
 v_cvt_pk_bf16_f32 v42, v44, v45
 v_mul_f32 v46, v46, v54
 v_mul_f32 v47, v47, v54
 v_cvt_pk_bf16_f32 v43, v46, v47
 ds_write_b64 v6, v[42:43] offset:0
 v_and_b32 v40, -9, v6
 v_mov_b32_dpp v12, v42 quad_perm:[0,1,0,1] row_mask:0xf bank_mask:0xf
 v_mov_b32_dpp v14, v42 quad_perm:[2,3,2,3] row_mask:0xf bank_mask:0xf
 v_mov_b32_dpp v13, v43 quad_perm:[0,1,0,1] row_mask:0xf bank_mask:0xf
 v_mov_b32_dpp v15, v43 quad_perm:[2,3,2,3] row_mask:0xf bank_mask:0xf
 s_waitcnt lgkmcnt(5)
 s_nop 0
 v_smfmac_f32_16x16x64_bf16 v[16:19], v[12:15], a[0:7], v0
 s_waitcnt lgkmcnt(4)
 v_smfmac_f32_16x16x64_bf16 v[20:23], v[12:15], a[32:39], v0
 s_waitcnt lgkmcnt(0)
 s_barrier
 ds_read_b128 v[48:51], v40 offset:512
 ds_read_b128 v[52:55], v40 offset:1024
 ds_read_b128 v[44:47], v40 offset:1536
 v_smfmac_f32_16x16x64_bf16 v[32:35], v[12:15], v[56:63], v0
 ds_read_b128 v[56:59], v3 offset:22528
 ds_read_b128 v[60:63], v3 offset:23552
 s_mov_b32 m0, 8192
 v_smfmac_f32_16x16x64_bf16 v[36:39], v[12:15], v[24:31], v0
 ds_read_b128 v[24:27], v3 offset:20480
 ds_read_b128 v[28:31], v3 offset:21504
 buffer_load_dwordx4 v1, s[4:7], s63 offen offset:2048 lds
 v_smfmac_f32_16x16x64_bf16 v[8:11], v[12:15], a[128:135], v0
 s_mov_b32 m0, 8192
 s_waitcnt lgkmcnt(6)
 v_smfmac_f32_16x16x64_bf16 v[16:19], v[48:51], a[8:15], v0
 buffer_load_dwordx4 v1, s[4:7], s63 offen offset:3072 lds
 s_waitcnt lgkmcnt(5)
 v_smfmac_f32_16x16x64_bf16 v[16:19], v[52:55], a[16:23], v0
 s_mov_b32 m0, 14336
 s_waitcnt lgkmcnt(2)
 v_smfmac_f32_16x16x64_bf16 v[16:19], v[44:47], v[56:63], v0
 ds_read_b128 v[56:59], v3 offset:16384
 ds_read_b128 v[60:63], v3 offset:17408
 buffer_load_dwordx4 v1, s[4:7], s81 offen offset:0 lds
 s_waitcnt lgkmcnt(2)
 v_smfmac_f32_16x16x64_bf16 v[20:23], v[48:51], v[24:31], v0
 ds_read_b128 v[24:27], v2 offset:38912
 ds_read_b128 v[28:31], v2 offset:39936
 s_mov_b32 m0, 14336
 v_smfmac_f32_16x16x64_bf16 v[20:23], v[52:55], a[48:55], v0
 buffer_load_dwordx4 v1, s[4:7], s81 offen offset:1024 lds
 v_smfmac_f32_16x16x64_bf16 v[20:23], v[44:47], a[56:63], v0
 v_cvt_pk_bf16_f32 v16, v16, v17
 v_smfmac_f32_16x16x64_bf16 v[32:35], v[48:51], a[72:79], v0
 v_cvt_pk_bf16_f32 v17, v18, v19
 s_waitcnt lgkmcnt(2)
 v_smfmac_f32_16x16x64_bf16 v[32:35], v[52:55], v[56:63], v0
 ds_read_b128 v[56:59], v2 offset:34816
 ds_read_b128 v[60:63], v2 offset:35840
 v_and_or_b32 v16, v16, -2, s55
 s_waitcnt lgkmcnt(2)
 v_smfmac_f32_16x16x64_bf16 v[32:35], v[44:47], v[24:31], v0
 ds_read_b128 v[24:27], v2 offset:32768
 ds_read_b128 v[28:31], v2 offset:33792
 v_cvt_pk_bf16_f32 v18, v20, v21
 v_smfmac_f32_16x16x64_bf16 v[36:39], v[48:51], a[104:111], v0
 v_cvt_pk_bf16_f32 v19, v22, v23
 v_smfmac_f32_16x16x64_bf16 v[36:39], v[52:55], a[112:119], v0
 v_and_or_b32 v18, v18, -2, s55
 buffer_store_dwordx4 v[16:19], v1, s[4:7], s60 offen offset:0
 v_smfmac_f32_16x16x64_bf16 v[36:39], v[44:47], a[120:127], v0
 v_cvt_pk_bf16_f32 v32, v32, v33
 s_waitcnt lgkmcnt(2)
 v_smfmac_f32_16x16x64_bf16 v[8:11], v[48:51], v[56:63], v0
 v_cvt_pk_bf16_f32 v33, v34, v35
 s_waitcnt lgkmcnt(0)
 v_smfmac_f32_16x16x64_bf16 v[8:11], v[52:55], v[24:31], v0
 v_and_or_b32 v32, v32, -2, s55
 v_smfmac_f32_16x16x64_bf16 v[8:11], v[44:47], a[152:159], v0
 v_cvt_pk_bf16_f32 v34, v36, v37
 v_cvt_pk_bf16_f32 v35, v38, v39
 v_and_or_b32 v34, v34, -2, s55
 buffer_store_dwordx4 v[32:35], v1, s[4:7], s60 offen offset:1024
 s_nop 3
 v_cvt_pk_bf16_f32 v8, v8, v9
 v_cvt_pk_bf16_f32 v9, v10, v11
 v_and_or_b32 v8, v8, -2, s55
 buffer_store_dwordx2 v[8:9], v1, s[4:7], s16 offen offset:0
 buffer_load_dwordx4 v[32:35], v1, s[4:7], s63 offen offset:0
 buffer_load_dwordx4 v[36:39], v1, s[4:7], s63 offen offset:1024
 s_add_u32 s54, s54, 1
 s_add_u32 s61, s61, 524288
 s_and_b32 s3, s54, 3
 s_cselect_b32 s3, 1, -3
 s_lshl_b32 s3, s3, 17
 s_add_u32 s62, s62, s3
 s_and_b32 s3, s54, 3
 s_cselect_b32 s3, 1, -3
 s_lshl_b32 s3, s3, 14
 s_add_u32 s57, s57, s3
 s_add_u32 s59, s59, s3
 s_xor_b32 s58, s57, 32768
 v_lshrrev_b32 v56, 7, v1
 v_mul_u32_u24 v56, 10240, v56
 v_and_b32 v60, 112, v1
 v_add_u32 v56, v56, v60
 v_and_b32 v57, 32, v1
 v_and_b32 v60, 64, v1
 v_lshl_add_u32 v57, v60, 2, v57
 v_bfe_u32 v60, v1, 8, 1
 v_lshl_add_u32 v57, v60, 4, v57
 v_bfe_u32 v60, v1, 4, 1
 v_lshl_add_u32 v57, v60, 3, v57
 v_mov_b32 v60, 0x3f80
 v_mov_b32 v28, 0x3f800000
 v_cndmask_b32 v60, v60, v28, s[82:83]
 v_cndmask_b32 v28, 0, v60, s[72:73]
 v_cndmask_b32 v29, 0, v60, s[74:75]
 v_cndmask_b32 v30, 0, v60, s[76:77]
 v_cndmask_b32 v31, 0, v60, s[78:79]
 v_mov_b64 v[58:59], -1
 s_mov_b64 exec, s[84:85]
 buffer_store_dwordx2 v[58:59], v57, s[4:7], s58 offen
 s_mov_b64 exec, -1
 s_nop 15
 s_nop 15
 s_nop 15
 s_nop 15
 s_nop 15
 s_mov_b32 s51, 0
 buffer_load_dwordx4 v[8:11], v56, s[4:7], s64 offen sc1
 buffer_load_dwordx4 v[12:15], v56, s[4:7], s65 offen sc1
 buffer_load_dwordx4 v[16:19], v56, s[4:7], s66 offen sc1
 buffer_load_dwordx4 v[20:23], v56, s[4:7], s67 offen sc1
L_pp_167:
 s_waitcnt vmcnt(3)
 v_mfma_f32_16x16x32_bf16 v[24:27], v[28:31], v[8:11], 0
 v_bitop3_b32 v60, v8, v10, s55 bitop3:0x7e
 s_waitcnt vmcnt(2)
 v_mfma_f32_16x16x32_bf16 v[24:27], v[28:31], v[12:15], v[24:27]
 v_bitop3_b32 v61, v12, v14, s55 bitop3:0x7e
 s_waitcnt vmcnt(1)
 v_mfma_f32_16x16x32_bf16 v[24:27], v[28:31], v[16:19], v[24:27]
 v_bitop3_b32 v62, v16, v18, s55 bitop3:0x7e
 s_waitcnt vmcnt(0)
 v_mfma_f32_16x16x32_bf16 v[24:27], v[28:31], v[20:23], v[24:27]
 v_bitop3_b32 v63, v20, v22, s55 bitop3:0x7e
 v_or3_b32 v7, v60, v61, v62
 v_bitop3_b32 v7, v7, v63, 1 bitop3:0xa8
 v_cmp_ne_u32 vcc, 0, v7
 s_cbranch_vccnz L_rt_168
 s_nop 2
 v_add_f32_dpp v24, v24, v24 row_ror:8 row_mask:0xf bank_mask:0xf
 v_add_f32_dpp v25, v25, v25 row_ror:8 row_mask:0xf bank_mask:0xf
 v_add_f32_dpp v26, v26, v26 row_ror:8 row_mask:0xf bank_mask:0xf
 v_add_f32_dpp v27, v27, v27 row_ror:8 row_mask:0xf bank_mask:0xf
 s_mov_b64 exec, s[84:85]
 v_cvt_pk_bf16_f32 v24, v24, v25
 v_cvt_pk_bf16_f32 v25, v26, v27
 buffer_store_dwordx2 v[24:25], v57, s[4:7], s57 offen
 s_mov_b64 exec, -1
 s_xor_b32 s55, s55, 1
 ds_read_b128 v[40:43], v1 offset:10240
 ds_read_b128 v[44:47], v1 offset:11264
 ds_read_b128 v[48:51], v1 offset:14336
 ds_read_b128 v[52:55], v1 offset:15360
 buffer_load_dwordx4 v[56:59], v1, s[4:7], s81 offen offset:2048
 buffer_load_dwordx4 v[60:63], v1, s[4:7], s81 offen offset:3072
 ds_read_b128 v[8:11], v3 offset:49152
 ds_read_b128 v[12:15], v3 offset:49152
 ds_read_b128 v[16:19], v3 offset:49152
 ds_read_b128 v[20:23], v3 offset:49152
 s_waitcnt lgkmcnt(0)
 s_nop 15
 s_nop 15
 s_nop 7
 s_branch L_ch0_f
L_rt_166:
 s_add_u32 s51, s51, 1
 s_cmp_lt_u32 s51, 131072
 s_cbranch_scc1 L_pm_165
 s_branch L_bail
L_rt_168:
 buffer_load_dwordx4 v[8:11], v56, s[4:7], s64 offen sc1
 buffer_load_dwordx4 v[12:15], v56, s[4:7], s65 offen sc1
 buffer_load_dwordx4 v[16:19], v56, s[4:7], s66 offen sc1
 buffer_load_dwordx4 v[20:23], v56, s[4:7], s67 offen sc1
 s_add_u32 s51, s51, 1
 s_cmp_lt_u32 s51, 131072
 s_cbranch_scc1 L_pp_167
 s_branch L_bail
.p2align 6
L_ch0_s:
 s_mov_b32 s51, 0
L_pm_169:
 buffer_load_dwordx4 v[24:27], v1, s[4:7], s59 offen offset:0 sc1
 buffer_load_dwordx4 v[28:31], v1, s[4:7], s59 offen offset:1024 sc1
 s_waitcnt vmcnt(1)
 ds_write_b128 v1, v[24:27] offset:0
 v_max_u32 v7, v24, v26
 s_waitcnt vmcnt(0)
 ds_write_b128 v1, v[28:31] offset:1024
 v_max3_u32 v7, v7, v28, v30
 v_cmp_eq_u32 vcc, -1, v7
 s_cbranch_vccnz L_rt_170
 v_smfmac_f32_16x16x64_bf16 v[16:19], v[24:27], v[32:39], v0
 ds_read_b128 v[32:35], v2 offset:6144
 ds_read_b128 v[36:39], v2 offset:7168
 v_smfmac_f32_16x16x64_bf16 v[20:23], v[24:27], v[40:47], v0
 ds_read_b128 v[40:43], v2 offset:4096
 ds_read_b128 v[44:47], v2 offset:5120
 v_smfmac_f32_16x16x64_bf16 v[16:19], v[28:31], v[48:55], v0
 v_smfmac_f32_16x16x64_bf16 v[20:23], v[28:31], v[56:63], v0
 s_waitcnt lgkmcnt(4)
 s_barrier
 buffer_load_dwordx4 v[56:59], v1, s[4:7], s101 offen offset:0
 v_smfmac_f32_16x16x64_bf16 v[8:11], v[24:27], v[240:247], v0
 v_smfmac_f32_16x16x64_bf16 v[12:15], v[24:27], v[248:255], v0
 ds_read_b128 v[24:27], v1 offset:2048
 buffer_load_dwordx4 v[60:63], v1, s[4:7], s101 offen offset:1024
 v_smfmac_f32_16x16x64_bf16 v[8:11], v[28:31], v[224:231], v0
 v_smfmac_f32_16x16x64_bf16 v[12:15], v[28:31], v[216:223], v0
 ds_read_b128 v[28:31], v1 offset:3072
 buffer_load_dwordx4 v[48:51], v1, s[4:7], s101 offen offset:2048
 s_waitcnt lgkmcnt(1)
 v_smfmac_f32_16x16x64_bf16 v[16:19], v[24:27], v[32:39], v0
 ds_read_b128 v[32:35], v2 offset:2048
 ds_read_b128 v[36:39], v2 offset:3072
 v_smfmac_f32_16x16x64_bf16 v[8:11], v[24:27], v[200:207], v0
 buffer_load_dwordx4 v[52:55], v1, s[4:7], s101 offen offset:3072
 v_smfmac_f32_16x16x64_bf16 v[12:15], v[24:27], v[192:199], v0
 v_smfmac_f32_16x16x64_bf16 v[20:23], v[24:27], v[40:47], v0
 ds_read_b128 v[40:43], v2 offset:0
 ds_read_b128 v[44:47], v2 offset:1024
 ds_read_b128 v[24:27], v1 offset:4096
 s_waitcnt lgkmcnt(5)
 v_smfmac_f32_16x16x64_bf16 v[8:11], v[28:31], v[184:191], v0
 v_smfmac_f32_16x16x64_bf16 v[12:15], v[28:31], v[176:183], v0
 s_waitcnt lgkmcnt(3)
 v_smfmac_f32_16x16x64_bf16 v[16:19], v[28:31], v[32:39], v0
 ds_read_b128 v[32:35], v1 offset:38912
 ds_read_b128 v[36:39], v1 offset:39936
 v_smfmac_f32_16x16x64_bf16 v[20:23], v[28:31], v[152:159], v0
 ds_read_b128 v[28:31], v1 offset:5120
 s_waitcnt lgkmcnt(3)
 v_smfmac_f32_16x16x64_bf16 v[8:11], v[24:27], v[160:167], v0
 v_smfmac_f32_16x16x64_bf16 v[16:19], v[24:27], v[40:47], v0
 ds_read_b128 v[40:43], v1 offset:36864
 ds_read_b128 v[44:47], v1 offset:37888
 v_smfmac_f32_16x16x64_bf16 v[12:15], v[24:27], v[144:151], v0
 v_smfmac_f32_16x16x64_bf16 v[20:23], v[24:27], v[168:175], v0
 ds_read_b128 v[24:27], v1 offset:6144
 s_waitcnt lgkmcnt(3)
 v_smfmac_f32_16x16x64_bf16 v[16:19], v[28:31], v[32:39], v0
 ds_read_b128 v[32:35], v1 offset:34816
 ds_read_b128 v[36:39], v1 offset:35840
 v_smfmac_f32_16x16x64_bf16 v[8:11], v[28:31], v[136:143], v0
 v_smfmac_f32_16x16x64_bf16 v[12:15], v[28:31], v[128:135], v0
 s_waitcnt lgkmcnt(3)
 v_smfmac_f32_16x16x64_bf16 v[20:23], v[28:31], v[40:47], v0
 ds_read_b128 v[40:43], v1 offset:32768
 ds_read_b128 v[44:47], v1 offset:33792
 ds_read_b128 v[28:31], v1 offset:7168
 s_waitcnt lgkmcnt(5)
 v_smfmac_f32_16x16x64_bf16 v[8:11], v[24:27], a[144:151], v0
 v_smfmac_f32_16x16x64_bf16 v[12:15], v[24:27], a[136:143], v0
 s_waitcnt lgkmcnt(3)
 v_smfmac_f32_16x16x64_bf16 v[16:19], v[24:27], v[32:39], v0
 ds_read_b128 v[32:35], v1 offset:18432
 ds_read_b128 v[36:39], v1 offset:19456
 s_waitcnt vmcnt(2)
 v_smfmac_f32_16x16x64_bf16 v[20:23], v[24:27], v[56:63], v0
 ds_read_b128 v[24:27], v1 offset:8192
 buffer_load_dwordx4 v[56:59], v1, s[4:7], s61 offen offset:0 sc1 nt
 s_waitcnt lgkmcnt(3)
 v_smfmac_f32_16x16x64_bf16 v[8:11], v[28:31], a[96:103], v0
 v_smfmac_f32_16x16x64_bf16 v[16:19], v[28:31], v[40:47], v0
 ds_read_b128 v[40:43], v1 offset:16384
 ds_read_b128 v[44:47], v1 offset:17408
 s_add_u32 s3, s61, 4096
 buffer_load_dwordx4 v[60:63], v1, s[4:7], s3 offen offset:0 sc1 nt
 v_smfmac_f32_16x16x64_bf16 v[12:15], v[28:31], a[88:95], v0
 v_smfmac_f32_16x16x64_bf16 v[20:23], v[28:31], v[208:215], v0
 ds_read_b128 v[28:31], v1 offset:9216
 s_waitcnt lgkmcnt(3)
 v_smfmac_f32_16x16x64_bf16 v[16:19], v[24:27], v[32:39], v0
 v_smfmac_f32_16x16x64_bf16 v[8:11], v[24:27], a[80:87], v0
 s_add_u32 s3, s61, 67108864
 buffer_load_dwordx4 v[32:35], v1, s[4:7], s3 offen offset:0 sc1 nt
 v_smfmac_f32_16x16x64_bf16 v[12:15], v[24:27], a[64:71], v0
 s_waitcnt lgkmcnt(1)
 v_smfmac_f32_16x16x64_bf16 v[20:23], v[24:27], v[40:47], v0
 ds_read_b128 v[40:43], v3 offset:49152
 ds_read_b128 v[44:47], v3 offset:49152
 buffer_load_dwordx4 v[36:39], v1, s[4:7], s3 offen offset:1024 sc1 nt
 s_waitcnt lgkmcnt(2)
 v_smfmac_f32_16x16x64_bf16 v[8:11], v[28:31], a[40:47], v0
 v_smfmac_f32_16x16x64_bf16 v[12:15], v[28:31], a[24:31], v0
 v_smfmac_f32_16x16x64_bf16 v[16:19], v[28:31], v[232:239], v0
 s_waitcnt vmcnt(4)
 v_smfmac_f32_16x16x64_bf16 v[20:23], v[28:31], v[48:55], v0
 ds_read_b128 v[52:55], v1 offset:0
 v_add_f32 v8, v8, v10
 v_add_f32 v11, v9, v11
 v_cvt_pk_bf16_f32 v9, v8, v11
 v_cvt_pk_bf16_f32 v8, v8, v11
 v_add_f32 v12, v12, v14
 v_add_f32 v15, v13, v15
 v_cvt_pk_bf16_f32 v13, v12, v15
 v_cvt_pk_bf16_f32 v12, v12, v15
 v_mfma_f32_16x16x16_bf16 v[8:11], v[8:9], v[4:5], 0
 v_mfma_f32_16x16x16_bf16 v[12:15], v[12:13], v[4:5], 0
 v_add_f32 v16, v16, v18
 v_add_f32 v19, v17, v19
 v_cvt_pk_bf16_f32 v17, v16, v19
 v_cvt_pk_bf16_f32 v16, v16, v19
 v_add_f32 v20, v20, v22
 v_add_f32 v23, v21, v23
 v_cvt_pk_bf16_f32 v21, v20, v23
 v_cvt_pk_bf16_f32 v20, v20, v23
 v_mfma_f32_16x16x16_bf16 v[16:19], v[16:17], v[4:5], 0
 v_mfma_f32_16x16x16_bf16 v[20:23], v[20:21], v[4:5], 0
 s_waitcnt lgkmcnt(2)
 v_smfmac_f32_16x16x64_bf16 v[40:43], v[24:27], v[96:103], v0
 s_waitcnt lgkmcnt(1)
 v_smfmac_f32_16x16x64_bf16 v[44:47], v[24:27], v[104:111], v0
 ds_read_b128 v[24:27], v1 offset:1024
 v_cvt_pk_bf16_f32 v15, v14, v15
 v_cvt_pk_bf16_f32 v14, v12, v13
 v_cvt_pk_bf16_f32 v13, v10, v11
 v_cvt_pk_bf16_f32 v12, v8, v9
 s_waitcnt vmcnt(3)
 s_nop 0
 v_mfma_f32_16x16x32_bf16 v[8:11], v[56:59], v[12:15], 0
 v_cvt_pk_bf16_f32 v23, v22, v23
 v_cvt_pk_bf16_f32 v22, v20, v21
 v_cvt_pk_bf16_f32 v21, v18, v19
 v_cvt_pk_bf16_f32 v20, v16, v17
 s_waitcnt vmcnt(2)
 v_mfma_f32_16x16x32_bf16 v[16:19], v[60:63], v[12:15], 0
 v_mfma_f32_16x16x32_bf16 v[48:51], v[20:23], v[12:15], 0
 v_smfmac_f32_16x16x64_bf16 v[40:43], v[28:31], v[112:119], v0
 v_smfmac_f32_16x16x64_bf16 v[44:47], v[28:31], v[120:127], v0
 ds_read_b128 v[28:31], v1 offset:2048
 s_waitcnt lgkmcnt(2)
 v_smfmac_f32_16x16x64_bf16 v[40:43], v[52:55], a[160:167], v0
 v_cndmask_b32 v8, v8, v16, s[70:71]
 v_cndmask_b32 v9, v9, v17, s[70:71]
 v_cndmask_b32 v10, v10, v18, s[70:71]
 v_cndmask_b32 v11, v11, v19, s[70:71]
 ds_write_b128 v1, v[8:11] offset:10240
 ds_write_b64 v1, v[48:49] offset:14336
 v_smfmac_f32_16x16x64_bf16 v[44:47], v[52:55], a[168:175], v0
 ds_read_b128 v[52:55], v1 offset:3072
 s_waitcnt lgkmcnt(4)
 v_smfmac_f32_16x16x64_bf16 v[40:43], v[24:27], a[176:183], v0
 v_smfmac_f32_16x16x64_bf16 v[44:47], v[24:27], a[184:191], v0
 ds_read_b128 v[24:27], v1 offset:4096
 s_waitcnt lgkmcnt(4)
 v_smfmac_f32_16x16x64_bf16 v[40:43], v[28:31], a[192:199], v0
 v_smfmac_f32_16x16x64_bf16 v[44:47], v[28:31], a[200:207], v0
 ds_read_b128 v[28:31], v1 offset:5120
 s_waitcnt lgkmcnt(2)
 v_smfmac_f32_16x16x64_bf16 v[40:43], v[52:55], a[208:215], v0
 v_smfmac_f32_16x16x64_bf16 v[44:47], v[52:55], a[216:223], v0
 ds_read_b128 v[52:55], v1 offset:6144
 s_barrier
 ds_read_b128 v[56:59], v1 offset:11264
 ds_read_b128 v[60:63], v1 offset:12288
 ds_read_b128 v[16:19], v1 offset:13312
 ds_read_b128 v[12:15], v1 offset:14336
 ds_read_b128 v[48:51], v1 offset:15360
 s_waitcnt lgkmcnt(7)
 v_smfmac_f32_16x16x64_bf16 v[40:43], v[24:27], a[224:231], v0
 s_mov_b64 exec, s[68:69]
 buffer_store_dwordx4 v[20:23], v6, s[4:7], s62 offen offset:0 sc1
 s_mov_b64 exec, -1
 v_smfmac_f32_16x16x64_bf16 v[44:47], v[24:27], a[232:239], v0
 ds_read_b128 v[24:27], v1 offset:7168
 s_waitcnt lgkmcnt(7)
 v_smfmac_f32_16x16x64_bf16 v[40:43], v[28:31], a[240:247], v0
 v_smfmac_f32_16x16x64_bf16 v[44:47], v[28:31], a[248:255], v0
 s_waitcnt lgkmcnt(6)
 v_smfmac_f32_16x16x64_bf16 v[40:43], v[52:55], v[64:71], v0
 v_smfmac_f32_16x16x64_bf16 v[44:47], v[52:55], v[72:79], v0
 s_waitcnt lgkmcnt(0)
 v_smfmac_f32_16x16x64_bf16 v[40:43], v[24:27], v[80:87], v0
 v_smfmac_f32_16x16x64_bf16 v[44:47], v[24:27], v[88:95], v0
 v_pk_add_f32 v[8:9], v[8:9], v[56:57]
 v_pk_add_f32 v[10:11], v[10:11], v[58:59]
 v_pk_add_f32 v[60:61], v[60:61], v[16:17]
 v_pk_add_f32 v[62:63], v[62:63], v[18:19]
 v_pk_add_f32 v[12:13], v[12:13], v[14:15]
 v_pk_add_f32 v[48:49], v[48:49], v[50:51]
 v_pk_add_f32 v[8:9], v[8:9], v[60:61]
 v_pk_add_f32 v[10:11], v[10:11], v[62:63]
 v_pk_add_f32 v[48:49], v[12:13], v[48:49]
 v_max3_f32 v50, v8, v9, v10
 v_max3_f32 v50, v50, v11, v48
 v_max_f32 v50, v50, v49
 v_add_f32 v40, v40, v42
 v_add_f32 v41, v41, v43
 v_max_f32_dpp v50, v50, v50 quad_perm:[2,3,0,1] row_mask:0xf bank_mask:0xf
 v_mov_b32 v51, v50
 v_add_f32 v44, v44, v46
 v_add_f32 v45, v45, v47
 v_permlane16_swap_b32 v50, v51
 v_max_f32 v50, v50, v51
 v_mov_b32 v51, v50
 v_cvt_pk_bf16_f32 v40, v40, v41
 v_cvt_pk_bf16_f32 v41, v44, v45
 v_permlane32_swap_b32 v50, v51
 v_max_f32 v50, v50, v51
 v_mul_f32 v50, s56, v50
 v_fma_f32 v48, v48, s56, -v50
 v_fma_f32 v49, v49, s56, -v50
 v_fma_f32 v8, v8, s56, -v50
 v_fma_f32 v9, v9, s56, -v50
 v_fma_f32 v10, v10, s56, -v50
 v_fma_f32 v11, v11, s56, -v50
 v_exp_f32 v48, v48
 v_lshrrev_b32 v51, 1, v1
 v_exp_f32 v49, v49
 ds_read_b128 v[56:59], v3 offset:18432
 ds_read_b128 v[60:63], v3 offset:19456
 v_exp_f32 v8, v8
 v_exp_f32 v9, v9
 ds_read_b128 v[24:27], v2 offset:36864
 ds_read_b128 v[28:31], v2 offset:37888
 v_exp_f32 v10, v10
 buffer_store_dwordx2 v[40:41], v51, s[4:7], s62 offen offset:2048 sc1
 v_exp_f32 v11, v11
 v_cvt_pk_bf16_f32 v14, v48, v49
 v_cvt_pk_bf16_f32 v12, v8, v9
 v_cvt_pk_bf16_f32 v13, v10, v11
 v_cndmask_b32 v52, 0, v14, s[68:69]
 v_cndmask_b32 v53, 0, v14, s[70:71]
 v_cndmask_b32 v22, 0, v12, s[70:71]
 v_cndmask_b32 v23, 0, v13, s[70:71]
 v_mfma_f32_16x16x16_bf16 v[44:47], v[40:41], v[52:53], 0
 v_cndmask_b32 v16, 0, v12, s[68:69]
 v_cndmask_b32 v17, 0, v13, s[68:69]
 v_mov_b32_dpp v18, v22 quad_perm:[2,3,0,1] row_mask:0xf bank_mask:0xf
 v_mov_b32_dpp v19, v23 quad_perm:[2,3,0,1] row_mask:0xf bank_mask:0xf
 v_mov_b32_dpp v20, v16 quad_perm:[2,3,0,1] row_mask:0xf bank_mask:0xf
 v_mov_b32_dpp v21, v17 quad_perm:[2,3,0,1] row_mask:0xf bank_mask:0xf
 s_waitcnt vmcnt(3)
 v_mfma_f32_16x16x32_bf16 v[44:47], v[32:35], v[16:19], v[44:47]
 v_add_f32 v54, v8, v9
 v_add_f32 v55, v48, v49
 s_waitcnt vmcnt(2)
 v_mfma_f32_16x16x32_bf16 v[44:47], v[36:39], v[20:23], v[44:47]
 v_add_f32 v54, v54, v10
 v_fma_f32 v55, v55, 0.5, v11
 v_add_f32 v54, v54, v55
 ds_read_b128 v[16:19], v3 offset:49152
 ds_read_b128 v[20:23], v3 offset:49152
 v_add_f32_dpp v54, v54, v54 quad_perm:[2,3,0,1] row_mask:0xf bank_mask:0xf
 v_mov_b32 v55, v54
 ds_read_b128 v[32:35], v3 offset:49152
 ds_read_b128 v[36:39], v3 offset:49152
 v_permlane16_swap_b32 v54, v55
 v_add_f32 v54, v54, v55
 v_mov_b32 v55, v54
 ds_read_b128 v[8:11], v3 offset:49152
 s_cmp_eq_u32 s54, 63
 v_permlane32_swap_b32 v54, v55
 v_add_f32 v54, v54, v55
 v_rcp_f32 v54, v54
 s_cbranch_scc1 L_ch0_end
 v_mul_f32 v44, v44, v54
 v_mul_f32 v45, v45, v54
 v_cvt_pk_bf16_f32 v42, v44, v45
 v_mul_f32 v46, v46, v54
 v_mul_f32 v47, v47, v54
 v_cvt_pk_bf16_f32 v43, v46, v47
 ds_write_b64 v6, v[42:43] offset:0
 v_and_b32 v40, -9, v6
 v_mov_b32_dpp v12, v42 quad_perm:[0,1,0,1] row_mask:0xf bank_mask:0xf
 v_mov_b32_dpp v14, v42 quad_perm:[2,3,2,3] row_mask:0xf bank_mask:0xf
 v_mov_b32_dpp v13, v43 quad_perm:[0,1,0,1] row_mask:0xf bank_mask:0xf
 v_mov_b32_dpp v15, v43 quad_perm:[2,3,2,3] row_mask:0xf bank_mask:0xf
 s_waitcnt lgkmcnt(5)
 s_nop 0
 v_smfmac_f32_16x16x64_bf16 v[16:19], v[12:15], a[0:7], v0
 s_waitcnt lgkmcnt(4)
 v_smfmac_f32_16x16x64_bf16 v[20:23], v[12:15], a[32:39], v0
 s_waitcnt lgkmcnt(0)
 s_barrier
 ds_read_b128 v[48:51], v40 offset:512
 ds_read_b128 v[52:55], v40 offset:1024
 ds_read_b128 v[44:47], v40 offset:1536
 v_smfmac_f32_16x16x64_bf16 v[32:35], v[12:15], v[56:63], v0
 ds_read_b128 v[56:59], v3 offset:22528
 ds_read_b128 v[60:63], v3 offset:23552
 s_mov_b32 m0, 8192
 v_smfmac_f32_16x16x64_bf16 v[36:39], v[12:15], v[24:31], v0
 ds_read_b128 v[24:27], v3 offset:20480
 ds_read_b128 v[28:31], v3 offset:21504
 buffer_load_dwordx4 v1, s[4:7], s63 offen offset:2048 lds
 v_smfmac_f32_16x16x64_bf16 v[8:11], v[12:15], a[128:135], v0
 s_mov_b32 m0, 8192
 s_waitcnt lgkmcnt(6)
 v_smfmac_f32_16x16x64_bf16 v[16:19], v[48:51], a[8:15], v0
 buffer_load_dwordx4 v1, s[4:7], s63 offen offset:3072 lds
 s_waitcnt lgkmcnt(5)
 v_smfmac_f32_16x16x64_bf16 v[16:19], v[52:55], a[16:23], v0
 s_mov_b32 m0, 14336
 s_waitcnt lgkmcnt(2)
 v_smfmac_f32_16x16x64_bf16 v[16:19], v[44:47], v[56:63], v0
 ds_read_b128 v[56:59], v3 offset:16384
 ds_read_b128 v[60:63], v3 offset:17408
 buffer_load_dwordx4 v1, s[4:7], s81 offen offset:0 lds
 s_waitcnt lgkmcnt(2)
 v_smfmac_f32_16x16x64_bf16 v[20:23], v[48:51], v[24:31], v0
 ds_read_b128 v[24:27], v2 offset:38912
 ds_read_b128 v[28:31], v2 offset:39936
 s_mov_b32 m0, 14336
 v_smfmac_f32_16x16x64_bf16 v[20:23], v[52:55], a[48:55], v0
 buffer_load_dwordx4 v1, s[4:7], s81 offen offset:1024 lds
 v_smfmac_f32_16x16x64_bf16 v[20:23], v[44:47], a[56:63], v0
 v_cvt_pk_bf16_f32 v16, v16, v17
 v_smfmac_f32_16x16x64_bf16 v[32:35], v[48:51], a[72:79], v0
 v_cvt_pk_bf16_f32 v17, v18, v19
 s_waitcnt lgkmcnt(2)
 v_smfmac_f32_16x16x64_bf16 v[32:35], v[52:55], v[56:63], v0
 ds_read_b128 v[56:59], v2 offset:34816
 ds_read_b128 v[60:63], v2 offset:35840
 v_and_or_b32 v16, v16, -2, s55
 s_waitcnt lgkmcnt(2)
 v_smfmac_f32_16x16x64_bf16 v[32:35], v[44:47], v[24:31], v0
 ds_read_b128 v[24:27], v2 offset:32768
 ds_read_b128 v[28:31], v2 offset:33792
 v_cvt_pk_bf16_f32 v18, v20, v21
 v_smfmac_f32_16x16x64_bf16 v[36:39], v[48:51], a[104:111], v0
 v_cvt_pk_bf16_f32 v19, v22, v23
 v_smfmac_f32_16x16x64_bf16 v[36:39], v[52:55], a[112:119], v0
 v_and_or_b32 v18, v18, -2, s55
 buffer_store_dwordx4 v[16:19], v1, s[4:7], s60 offen offset:0 sc1
 v_smfmac_f32_16x16x64_bf16 v[36:39], v[44:47], a[120:127], v0
 v_cvt_pk_bf16_f32 v32, v32, v33
 s_waitcnt lgkmcnt(2)
 v_smfmac_f32_16x16x64_bf16 v[8:11], v[48:51], v[56:63], v0
 v_cvt_pk_bf16_f32 v33, v34, v35
 s_waitcnt lgkmcnt(0)
 v_smfmac_f32_16x16x64_bf16 v[8:11], v[52:55], v[24:31], v0
 v_and_or_b32 v32, v32, -2, s55
 v_smfmac_f32_16x16x64_bf16 v[8:11], v[44:47], a[152:159], v0
 v_cvt_pk_bf16_f32 v34, v36, v37
 v_cvt_pk_bf16_f32 v35, v38, v39
 v_and_or_b32 v34, v34, -2, s55
 buffer_store_dwordx4 v[32:35], v1, s[4:7], s60 offen offset:1024 sc1
 s_nop 3
 v_cvt_pk_bf16_f32 v8, v8, v9
 v_cvt_pk_bf16_f32 v9, v10, v11
 v_and_or_b32 v8, v8, -2, s55
 buffer_store_dwordx2 v[8:9], v1, s[4:7], s16 offen offset:0 sc1
 buffer_load_dwordx4 v[32:35], v1, s[4:7], s63 offen offset:0
 buffer_load_dwordx4 v[36:39], v1, s[4:7], s63 offen offset:1024
 s_add_u32 s54, s54, 1
 s_add_u32 s61, s61, 524288
 s_and_b32 s3, s54, 3
 s_cselect_b32 s3, 1, -3
 s_lshl_b32 s3, s3, 17
 s_add_u32 s62, s62, s3
 s_and_b32 s3, s54, 3
 s_cselect_b32 s3, 1, -3
 s_lshl_b32 s3, s3, 14
 s_add_u32 s57, s57, s3
 s_add_u32 s59, s59, s3
 s_xor_b32 s58, s57, 32768
 v_lshrrev_b32 v56, 7, v1
 v_mul_u32_u24 v56, 10240, v56
 v_and_b32 v60, 112, v1
 v_add_u32 v56, v56, v60
 v_and_b32 v57, 32, v1
 v_and_b32 v60, 64, v1
 v_lshl_add_u32 v57, v60, 2, v57
 v_bfe_u32 v60, v1, 8, 1
 v_lshl_add_u32 v57, v60, 4, v57
 v_bfe_u32 v60, v1, 4, 1
 v_lshl_add_u32 v57, v60, 3, v57
 v_mov_b32 v60, 0x3f80
 v_mov_b32 v28, 0x3f800000
 v_cndmask_b32 v60, v60, v28, s[82:83]
 v_cndmask_b32 v28, 0, v60, s[72:73]
 v_cndmask_b32 v29, 0, v60, s[74:75]
 v_cndmask_b32 v30, 0, v60, s[76:77]
 v_cndmask_b32 v31, 0, v60, s[78:79]
 v_mov_b64 v[58:59], -1
 s_mov_b64 exec, s[84:85]
 buffer_store_dwordx2 v[58:59], v57, s[4:7], s58 offen sc1
 s_mov_b64 exec, -1
 s_nop 15
 s_nop 15
 s_nop 15
 s_nop 15
 s_nop 15
 s_mov_b32 s51, 0
 buffer_load_dwordx4 v[8:11], v56, s[4:7], s64 offen sc1
 buffer_load_dwordx4 v[12:15], v56, s[4:7], s65 offen sc1
 buffer_load_dwordx4 v[16:19], v56, s[4:7], s66 offen sc1
 buffer_load_dwordx4 v[20:23], v56, s[4:7], s67 offen sc1
L_pp_171:
 s_waitcnt vmcnt(3)
 v_mfma_f32_16x16x32_bf16 v[24:27], v[28:31], v[8:11], 0
 v_bitop3_b32 v60, v8, v10, s55 bitop3:0x7e
 s_waitcnt vmcnt(2)
 v_mfma_f32_16x16x32_bf16 v[24:27], v[28:31], v[12:15], v[24:27]
 v_bitop3_b32 v61, v12, v14, s55 bitop3:0x7e
 s_waitcnt vmcnt(1)
 v_mfma_f32_16x16x32_bf16 v[24:27], v[28:31], v[16:19], v[24:27]
 v_bitop3_b32 v62, v16, v18, s55 bitop3:0x7e
 s_waitcnt vmcnt(0)
 v_mfma_f32_16x16x32_bf16 v[24:27], v[28:31], v[20:23], v[24:27]
 v_bitop3_b32 v63, v20, v22, s55 bitop3:0x7e
 v_or3_b32 v7, v60, v61, v62
 v_bitop3_b32 v7, v7, v63, 1 bitop3:0xa8
 v_cmp_ne_u32 vcc, 0, v7
 s_cbranch_vccnz L_rt_172
 s_nop 2
 v_add_f32_dpp v24, v24, v24 row_ror:8 row_mask:0xf bank_mask:0xf
 v_add_f32_dpp v25, v25, v25 row_ror:8 row_mask:0xf bank_mask:0xf
 v_add_f32_dpp v26, v26, v26 row_ror:8 row_mask:0xf bank_mask:0xf
 v_add_f32_dpp v27, v27, v27 row_ror:8 row_mask:0xf bank_mask:0xf
 s_mov_b64 exec, s[84:85]
 v_cvt_pk_bf16_f32 v24, v24, v25
 v_cvt_pk_bf16_f32 v25, v26, v27
 buffer_store_dwordx2 v[24:25], v57, s[4:7], s57 offen sc1
 s_mov_b64 exec, -1
 s_xor_b32 s55, s55, 1
 ds_read_b128 v[40:43], v1 offset:10240
 ds_read_b128 v[44:47], v1 offset:11264
 ds_read_b128 v[48:51], v1 offset:14336
 ds_read_b128 v[52:55], v1 offset:15360
 buffer_load_dwordx4 v[56:59], v1, s[4:7], s81 offen offset:2048
 buffer_load_dwordx4 v[60:63], v1, s[4:7], s81 offen offset:3072
 ds_read_b128 v[8:11], v3 offset:49152
 ds_read_b128 v[12:15], v3 offset:49152
 ds_read_b128 v[16:19], v3 offset:49152
 ds_read_b128 v[20:23], v3 offset:49152
 s_waitcnt lgkmcnt(0)
 s_nop 15
 s_nop 15
 s_nop 7
 s_branch L_ch0_s
L_rt_170:
 s_add_u32 s51, s51, 1
 s_cmp_lt_u32 s51, 131072
 s_cbranch_scc1 L_pm_169
 s_branch L_bail
L_rt_172:
 buffer_load_dwordx4 v[8:11], v56, s[4:7], s64 offen sc1
 buffer_load_dwordx4 v[12:15], v56, s[4:7], s65 offen sc1
 buffer_load_dwordx4 v[16:19], v56, s[4:7], s66 offen sc1
 buffer_load_dwordx4 v[20:23], v56, s[4:7], s67 offen sc1
 s_add_u32 s51, s51, 1
 s_cmp_lt_u32 s51, 131072
 s_cbranch_scc1 L_pp_171
 s_branch L_bail
L_ch0_end:
 s_waitcnt vmcnt(0)
 s_endpgm
L_ch1:
 v_lshrrev_b32 v8, 4, v0
 s_mov_b32 s3, 1280
 v_mul_lo_u32 v8, v8, s3
 v_lshrrev_b32 v7, 3, v0
 v_and_b32 v7, 6, v7
 v_xor_b32 v7, v7, v0
 v_and_b32 v7, 15, v7
 v_lshl_add_u32 v8, v7, 4, v8
 v_xor_b32 v9, 128, v8
 v_lshrrev_b32 v10, 4, v0
 s_mov_b32 s3, 8192
 v_mul_lo_u32 v10, v10, s3
 v_lshrrev_b32 v7, 3, v0
 v_and_b32 v7, 6, v7
 v_xor_b32 v7, v7, v0
 v_and_b32 v7, 15, v7
 v_lshl_add_u32 v10, v7, 4, v10
 v_xor_b32 v11, 128, v10
 s_mov_b32 s8, s26
 s_and_b32 s9, s27, 0xffff
 s_mov_b32 s10, 5242880
 s_mul_i32 s14, s52, 163840
 s_add_u32 s14, s14, 40960
 s_mov_b32 m0, 8192
 s_nop 0
 buffer_load_dwordx4 v8, s[8:11], s14 offen lds
 s_add_u32 s14, s14, 5120
 s_mov_b32 m0, 9216
 s_nop 0
 buffer_load_dwordx4 v8, s[8:11], s14 offen lds
 s_add_u32 s14, s14, 5120
 s_mov_b32 m0, 10240
 s_nop 0
 buffer_load_dwordx4 v8, s[8:11], s14 offen lds
 s_add_u32 s14, s14, 5120
 s_mov_b32 m0, 11264
 s_nop 0
 buffer_load_dwordx4 v8, s[8:11], s14 offen lds
 s_add_u32 s14, s14, 5120
 s_mov_b32 m0, 12288
 s_nop 0
 buffer_load_dwordx4 v9, s[8:11], s14 offen lds
 s_add_u32 s14, s14, 5120
 s_mov_b32 m0, 13312
 s_nop 0
 buffer_load_dwordx4 v9, s[8:11], s14 offen lds
 s_add_u32 s14, s14, 5120
 s_mov_b32 m0, 14336
 s_nop 0
 buffer_load_dwordx4 v9, s[8:11], s14 offen lds
 s_add_u32 s14, s14, 5120
 s_mov_b32 m0, 15360
 s_nop 0
 buffer_load_dwordx4 v9, s[8:11], s14 offen lds
 s_mul_i32 s14, s52, 163840
 s_add_u32 s14, s14, 41216
 s_mov_b32 m0, 40960
 s_nop 0
 buffer_load_dwordx4 v8, s[8:11], s14 offen lds
 s_add_u32 s14, s14, 5120
 s_mov_b32 m0, 41984
 s_nop 0
 buffer_load_dwordx4 v8, s[8:11], s14 offen lds
 s_add_u32 s14, s14, 5120
 s_mov_b32 m0, 43008
 s_nop 0
 buffer_load_dwordx4 v8, s[8:11], s14 offen lds
 s_add_u32 s14, s14, 5120
 s_mov_b32 m0, 44032
 s_nop 0
 buffer_load_dwordx4 v8, s[8:11], s14 offen lds
 s_add_u32 s14, s14, 5120
 s_mov_b32 m0, 45056
 s_nop 0
 buffer_load_dwordx4 v9, s[8:11], s14 offen lds
 s_add_u32 s14, s14, 5120
 s_mov_b32 m0, 46080
 s_nop 0
 buffer_load_dwordx4 v9, s[8:11], s14 offen lds
 s_add_u32 s14, s14, 5120
 s_mov_b32 m0, 47104
 s_nop 0
 buffer_load_dwordx4 v9, s[8:11], s14 offen lds
 s_add_u32 s14, s14, 5120
 s_mov_b32 m0, 48128
 s_nop 0
 buffer_load_dwordx4 v9, s[8:11], s14 offen lds
 s_mul_i32 s14, s52, 163840
 s_add_u32 s14, s14, 41472
 s_mov_b32 m0, 73728
 s_nop 0
 buffer_load_dwordx4 v8, s[8:11], s14 offen lds
 s_add_u32 s14, s14, 5120
 s_mov_b32 m0, 74752
 s_nop 0
 buffer_load_dwordx4 v8, s[8:11], s14 offen lds
 s_add_u32 s14, s14, 5120
 s_mov_b32 m0, 75776
 s_nop 0
 buffer_load_dwordx4 v8, s[8:11], s14 offen lds
 s_add_u32 s14, s14, 5120
 s_mov_b32 m0, 76800
 s_nop 0
 buffer_load_dwordx4 v8, s[8:11], s14 offen lds
 s_add_u32 s14, s14, 5120
 s_mov_b32 m0, 77824
 s_nop 0
 buffer_load_dwordx4 v9, s[8:11], s14 offen lds
 s_add_u32 s14, s14, 5120
 s_mov_b32 m0, 78848
 s_nop 0
 buffer_load_dwordx4 v9, s[8:11], s14 offen lds
 s_add_u32 s14, s14, 5120
 s_mov_b32 m0, 79872
 s_nop 0
 buffer_load_dwordx4 v9, s[8:11], s14 offen lds
 s_add_u32 s14, s14, 5120
 s_mov_b32 m0, 80896
 s_nop 0
 buffer_load_dwordx4 v9, s[8:11], s14 offen lds
 s_mul_i32 s14, s52, 163840
 s_add_u32 s14, s14, 41728
 s_mov_b32 m0, 106496
 s_nop 0
 buffer_load_dwordx4 v8, s[8:11], s14 offen lds
 s_add_u32 s14, s14, 5120
 s_mov_b32 m0, 107520
 s_nop 0
 buffer_load_dwordx4 v8, s[8:11], s14 offen lds
 s_add_u32 s14, s14, 5120
 s_mov_b32 m0, 108544
 s_nop 0
 buffer_load_dwordx4 v8, s[8:11], s14 offen lds
 s_add_u32 s14, s14, 5120
 s_mov_b32 m0, 109568
 s_nop 0
 buffer_load_dwordx4 v8, s[8:11], s14 offen lds
 s_add_u32 s14, s14, 5120
 s_mov_b32 m0, 110592
 s_nop 0
 buffer_load_dwordx4 v9, s[8:11], s14 offen lds
 s_add_u32 s14, s14, 5120
 s_mov_b32 m0, 111616
 s_nop 0
 buffer_load_dwordx4 v9, s[8:11], s14 offen lds
 s_add_u32 s14, s14, 5120
 s_mov_b32 m0, 112640
 s_nop 0
 buffer_load_dwordx4 v9, s[8:11], s14 offen lds
 s_add_u32 s14, s14, 5120
 s_mov_b32 m0, 113664
 s_nop 0
 buffer_load_dwordx4 v9, s[8:11], s14 offen lds
 s_mul_i32 s14, s52, 163840
 s_add_u32 s14, s14, 41984
 s_mov_b32 m0, 139264
 s_nop 0
 buffer_load_dwordx4 v8, s[8:11], s14 offen lds
 s_add_u32 s14, s14, 5120
 s_mov_b32 m0, 140288
 s_nop 0
 buffer_load_dwordx4 v8, s[8:11], s14 offen lds
 s_add_u32 s14, s14, 5120
 s_mov_b32 m0, 141312
 s_nop 0
 buffer_load_dwordx4 v8, s[8:11], s14 offen lds
 s_add_u32 s14, s14, 5120
 s_mov_b32 m0, 142336
 s_nop 0
 buffer_load_dwordx4 v8, s[8:11], s14 offen lds
 s_add_u32 s14, s14, 5120
 s_mov_b32 m0, 143360
 s_nop 0
 buffer_load_dwordx4 v9, s[8:11], s14 offen lds
 s_add_u32 s14, s14, 5120
 s_mov_b32 m0, 144384
 s_nop 0
 buffer_load_dwordx4 v9, s[8:11], s14 offen lds
 s_add_u32 s14, s14, 5120
 s_mov_b32 m0, 145408
 s_nop 0
 buffer_load_dwordx4 v9, s[8:11], s14 offen lds
 s_add_u32 s14, s14, 5120
 s_mov_b32 m0, 146432
 s_nop 0
 buffer_load_dwordx4 v9, s[8:11], s14 offen lds
 v_lshrrev_b32 v20, 4, v0
 v_bfe_u32 v21, v0, 2, 1
 v_bfe_u32 v22, v0, 3, 1
 v_and_b32 v23, 1, v20
 v_lshrrev_b32 v24, 1, v20
 v_and_b32 v25, 3, v0
 v_lshlrev_b32 v25, 3, v25
 v_lshl_add_u32 v26, v22, 1, v23
 v_lshl_add_u32 v27, v21, 2, v26
 v_lshl_add_u32 v26, v24, 2, v26
 v_lshl_add_u32 v26, v21, 4, v26
 v_xor_b32 v27, 2, v27
 v_lshl_add_u32 v27, v27, 5, v25
 v_lshl_add_u32 v12, v26, 8, v27
 v_lshl_add_u32 v26, v24, 2, v21
 v_lshl_add_u32 v26, v23, 4, v26
 v_lshl_add_u32 v27, v23, 2, v21
 v_lshl_add_u32 v27, v22, 1, v27
 v_lshl_add_u32 v27, v27, 5, v25
 v_lshl_add_u32 v14, v26, 8, v27
 v_lshlrev_b32 v1, 4, v0
 v_add_u32 v2, 65536, v1
 v_add_u32 v3, 114688, v1
 s_waitcnt vmcnt(32)
 s_barrier
 s_waitcnt lgkmcnt(0)
 s_barrier
 s_mov_b32 s8, s24
 s_and_b32 s9, s25, 0xffff
 s_mov_b32 s10, 5242880
 s_lshl_b32 s14, s52, 8
 s_add_u32 s14, s14, 262144
 s_mov_b32 m0, 8192
 s_nop 0
 buffer_load_dwordx4 v10, s[8:11], s14 offen lds
 s_add_u32 s14, s14, 32768
 s_mov_b32 m0, 9216
 s_nop 0
 buffer_load_dwordx4 v10, s[8:11], s14 offen lds
 s_add_u32 s14, s14, 32768
 s_mov_b32 m0, 10240
 s_nop 0
 buffer_load_dwordx4 v10, s[8:11], s14 offen lds
 s_add_u32 s14, s14, 32768
 s_mov_b32 m0, 11264
 s_nop 0
 buffer_load_dwordx4 v10, s[8:11], s14 offen lds
 s_add_u32 s14, s14, 32768
 s_mov_b32 m0, 12288
 s_nop 0
 buffer_load_dwordx4 v11, s[8:11], s14 offen lds
 s_add_u32 s14, s14, 32768
 s_mov_b32 m0, 13312
 s_nop 0
 buffer_load_dwordx4 v11, s[8:11], s14 offen lds
 s_add_u32 s14, s14, 32768
 s_mov_b32 m0, 14336
 s_nop 0
 buffer_load_dwordx4 v11, s[8:11], s14 offen lds
 s_add_u32 s14, s14, 32768
 s_mov_b32 m0, 15360
 s_nop 0
 buffer_load_dwordx4 v11, s[8:11], s14 offen lds
 s_waitcnt vmcnt(32)
 s_barrier
 v_xor_b32 v16, 0, v14
 v_add_u32 v16, 32768, v16
 v_xor_b32 v17, 64, v16
 ds_read_b64_tr_b16 a[0:1], v16 offset:0
 ds_read_b64_tr_b16 a[2:3], v17 offset:512
 ds_read_b64_tr_b16 a[4:5], v16 offset:2048
 ds_read_b64_tr_b16 a[6:7], v17 offset:2560
 v_xor_b32 v16, 0, v14
 v_add_u32 v16, 32768, v16
 v_xor_b32 v17, 64, v16
 ds_read_b64_tr_b16 a[8:9], v16 offset:8192
 ds_read_b64_tr_b16 a[10:11], v17 offset:8704
 ds_read_b64_tr_b16 a[12:13], v16 offset:10240
 ds_read_b64_tr_b16 a[14:15], v17 offset:10752
 v_xor_b32 v16, 0, v14
 v_add_u32 v16, 32768, v16
 v_xor_b32 v17, 64, v16
 ds_read_b64_tr_b16 a[16:17], v16 offset:16384
 ds_read_b64_tr_b16 a[18:19], v17 offset:16896
 ds_read_b64_tr_b16 a[20:21], v16 offset:18432
 ds_read_b64_tr_b16 a[22:23], v17 offset:18944
 v_xor_b32 v16, 0, v14
 v_add_u32 v16, 32768, v16
 v_xor_b32 v17, 64, v16
 ds_read_b64_tr_b16 a[24:25], v16 offset:24576
 ds_read_b64_tr_b16 a[26:27], v17 offset:25088
 ds_read_b64_tr_b16 a[28:29], v16 offset:26624
 ds_read_b64_tr_b16 a[30:31], v17 offset:27136
 v_xor_b32 v16, 32, v14
 v_add_u32 v16, 32768, v16
 v_xor_b32 v17, 64, v16
 ds_read_b64_tr_b16 a[32:33], v16 offset:0
 ds_read_b64_tr_b16 a[34:35], v17 offset:512
 ds_read_b64_tr_b16 a[36:37], v16 offset:2048
 ds_read_b64_tr_b16 a[38:39], v17 offset:2560
 v_xor_b32 v16, 32, v14
 v_add_u32 v16, 32768, v16
 v_xor_b32 v17, 64, v16
 ds_read_b64_tr_b16 a[40:41], v16 offset:8192
 ds_read_b64_tr_b16 a[42:43], v17 offset:8704
 ds_read_b64_tr_b16 a[44:45], v16 offset:10240
 ds_read_b64_tr_b16 a[46:47], v17 offset:10752
 v_xor_b32 v16, 32, v14
 v_add_u32 v16, 32768, v16
 v_xor_b32 v17, 64, v16
 ds_read_b64_tr_b16 a[48:49], v16 offset:16384
 ds_read_b64_tr_b16 a[50:51], v17 offset:16896
 ds_read_b64_tr_b16 a[52:53], v16 offset:18432
 ds_read_b64_tr_b16 a[54:55], v17 offset:18944
 v_xor_b32 v16, 32, v14
 v_add_u32 v16, 32768, v16
 v_xor_b32 v17, 64, v16
 ds_read_b64_tr_b16 a[56:57], v16 offset:24576
 ds_read_b64_tr_b16 a[58:59], v17 offset:25088
 ds_read_b64_tr_b16 a[60:61], v16 offset:26624
 ds_read_b64_tr_b16 a[62:63], v17 offset:27136
 v_xor_b32 v16, 128, v14
 v_add_u32 v16, 32768, v16
 v_xor_b32 v17, 64, v16
 ds_read_b64_tr_b16 a[64:65], v16 offset:0
 ds_read_b64_tr_b16 a[66:67], v17 offset:512
 ds_read_b64_tr_b16 a[68:69], v16 offset:2048
 ds_read_b64_tr_b16 a[70:71], v17 offset:2560
 v_xor_b32 v16, 128, v14
 v_add_u32 v16, 32768, v16
 v_xor_b32 v17, 64, v16
 ds_read_b64_tr_b16 a[72:73], v16 offset:8192
 ds_read_b64_tr_b16 a[74:75], v17 offset:8704
 ds_read_b64_tr_b16 a[76:77], v16 offset:10240
 ds_read_b64_tr_b16 a[78:79], v17 offset:10752
 v_xor_b32 v16, 128, v14
 v_add_u32 v16, 32768, v16
 v_xor_b32 v17, 64, v16
 ds_read_b64_tr_b16 a[80:81], v16 offset:16384
 ds_read_b64_tr_b16 a[82:83], v17 offset:16896
 ds_read_b64_tr_b16 a[84:85], v16 offset:18432
 ds_read_b64_tr_b16 a[86:87], v17 offset:18944
 v_xor_b32 v16, 128, v14
 v_add_u32 v16, 32768, v16
 v_xor_b32 v17, 64, v16
 ds_read_b64_tr_b16 a[88:89], v16 offset:24576
 ds_read_b64_tr_b16 a[90:91], v17 offset:25088
 ds_read_b64_tr_b16 a[92:93], v16 offset:26624
 ds_read_b64_tr_b16 a[94:95], v17 offset:27136
 v_xor_b32 v16, 160, v14
 v_add_u32 v16, 32768, v16
 v_xor_b32 v17, 64, v16
 ds_read_b64_tr_b16 a[96:97], v16 offset:0
 ds_read_b64_tr_b16 a[98:99], v17 offset:512
 ds_read_b64_tr_b16 a[100:101], v16 offset:2048
 ds_read_b64_tr_b16 a[102:103], v17 offset:2560
 v_xor_b32 v16, 160, v14
 v_add_u32 v16, 32768, v16
 v_xor_b32 v17, 64, v16
 ds_read_b64_tr_b16 a[104:105], v16 offset:8192
 ds_read_b64_tr_b16 a[106:107], v17 offset:8704
 ds_read_b64_tr_b16 a[108:109], v16 offset:10240
 ds_read_b64_tr_b16 a[110:111], v17 offset:10752
 v_xor_b32 v16, 160, v14
 v_add_u32 v16, 32768, v16
 v_xor_b32 v17, 64, v16
 ds_read_b64_tr_b16 a[112:113], v16 offset:16384
 ds_read_b64_tr_b16 a[114:115], v17 offset:16896
 ds_read_b64_tr_b16 a[116:117], v16 offset:18432
 ds_read_b64_tr_b16 a[118:119], v17 offset:18944
 v_xor_b32 v16, 160, v14
 v_add_u32 v16, 32768, v16
 v_xor_b32 v17, 64, v16
 ds_read_b64_tr_b16 a[120:121], v16 offset:24576
 ds_read_b64_tr_b16 a[122:123], v17 offset:25088
 ds_read_b64_tr_b16 a[124:125], v16 offset:26624
 ds_read_b64_tr_b16 a[126:127], v17 offset:27136
 s_waitcnt lgkmcnt(0)
 s_barrier
 s_lshl_b32 s14, s52, 8
 s_add_u32 s14, s14, 1310720
 s_mov_b32 m0, 40960
 s_nop 0
 buffer_load_dwordx4 v10, s[8:11], s14 offen lds
 s_add_u32 s14, s14, 32768
 s_mov_b32 m0, 41984
 s_nop 0
 buffer_load_dwordx4 v10, s[8:11], s14 offen lds
 s_add_u32 s14, s14, 32768
 s_mov_b32 m0, 43008
 s_nop 0
 buffer_load_dwordx4 v10, s[8:11], s14 offen lds
 s_add_u32 s14, s14, 32768
 s_mov_b32 m0, 44032
 s_nop 0
 buffer_load_dwordx4 v10, s[8:11], s14 offen lds
 s_add_u32 s14, s14, 32768
 s_mov_b32 m0, 45056
 s_nop 0
 buffer_load_dwordx4 v11, s[8:11], s14 offen lds
 s_add_u32 s14, s14, 32768
 s_mov_b32 m0, 46080
 s_nop 0
 buffer_load_dwordx4 v11, s[8:11], s14 offen lds
 s_add_u32 s14, s14, 32768
 s_mov_b32 m0, 47104
 s_nop 0
 buffer_load_dwordx4 v11, s[8:11], s14 offen lds
 s_add_u32 s14, s14, 32768
 s_mov_b32 m0, 48128
 s_nop 0
 buffer_load_dwordx4 v11, s[8:11], s14 offen lds
 s_waitcnt vmcnt(32)
 s_barrier
 s_waitcnt lgkmcnt(0)
 s_barrier
 s_lshl_b32 s14, s52, 8
 s_add_u32 s14, s14, 2359296
 s_mov_b32 m0, 73728
 s_nop 0
 buffer_load_dwordx4 v10, s[8:11], s14 offen lds
 s_add_u32 s14, s14, 32768
 s_mov_b32 m0, 74752
 s_nop 0
 buffer_load_dwordx4 v10, s[8:11], s14 offen lds
 s_add_u32 s14, s14, 32768
 s_mov_b32 m0, 75776
 s_nop 0
 buffer_load_dwordx4 v10, s[8:11], s14 offen lds
 s_add_u32 s14, s14, 32768
 s_mov_b32 m0, 76800
 s_nop 0
 buffer_load_dwordx4 v10, s[8:11], s14 offen lds
 s_add_u32 s14, s14, 32768
 s_mov_b32 m0, 77824
 s_nop 0
 buffer_load_dwordx4 v11, s[8:11], s14 offen lds
 s_add_u32 s14, s14, 32768
 s_mov_b32 m0, 78848
 s_nop 0
 buffer_load_dwordx4 v11, s[8:11], s14 offen lds
 s_add_u32 s14, s14, 32768
 s_mov_b32 m0, 79872
 s_nop 0
 buffer_load_dwordx4 v11, s[8:11], s14 offen lds
 s_add_u32 s14, s14, 32768
 s_mov_b32 m0, 80896
 s_nop 0
 buffer_load_dwordx4 v11, s[8:11], s14 offen lds
 s_waitcnt vmcnt(32)
 s_barrier
 s_waitcnt lgkmcnt(0)
 s_barrier
 s_lshl_b32 s14, s52, 8
 s_add_u32 s14, s14, 3407872
 s_mov_b32 m0, 106496
 s_nop 0
 buffer_load_dwordx4 v10, s[8:11], s14 offen lds
 s_add_u32 s14, s14, 32768
 s_mov_b32 m0, 107520
 s_nop 0
 buffer_load_dwordx4 v10, s[8:11], s14 offen lds
 s_add_u32 s14, s14, 32768
 s_mov_b32 m0, 108544
 s_nop 0
 buffer_load_dwordx4 v10, s[8:11], s14 offen lds
 s_add_u32 s14, s14, 32768
 s_mov_b32 m0, 109568
 s_nop 0
 buffer_load_dwordx4 v10, s[8:11], s14 offen lds
 s_add_u32 s14, s14, 32768
 s_mov_b32 m0, 110592
 s_nop 0
 buffer_load_dwordx4 v11, s[8:11], s14 offen lds
 s_add_u32 s14, s14, 32768
 s_mov_b32 m0, 111616
 s_nop 0
 buffer_load_dwordx4 v11, s[8:11], s14 offen lds
 s_add_u32 s14, s14, 32768
 s_mov_b32 m0, 112640
 s_nop 0
 buffer_load_dwordx4 v11, s[8:11], s14 offen lds
 s_add_u32 s14, s14, 32768
 s_mov_b32 m0, 113664
 s_nop 0
 buffer_load_dwordx4 v11, s[8:11], s14 offen lds
 s_waitcnt vmcnt(32)
 s_barrier
 v_xor_b32 v16, 32, v14
 v_add_u32 v16, 131072, v16
 v_xor_b32 v17, 64, v16
 ds_read_b64_tr_b16 a[128:129], v16 offset:0
 ds_read_b64_tr_b16 a[130:131], v17 offset:512
 ds_read_b64_tr_b16 a[132:133], v16 offset:2048
 ds_read_b64_tr_b16 a[134:135], v17 offset:2560
 v_xor_b32 v16, 32, v14
 v_add_u32 v16, 131072, v16
 v_xor_b32 v17, 64, v16
 ds_read_b64_tr_b16 a[136:137], v16 offset:8192
 ds_read_b64_tr_b16 a[138:139], v17 offset:8704
 ds_read_b64_tr_b16 a[140:141], v16 offset:10240
 ds_read_b64_tr_b16 a[142:143], v17 offset:10752
 v_xor_b32 v16, 32, v14
 v_add_u32 v16, 131072, v16
 v_xor_b32 v17, 64, v16
 ds_read_b64_tr_b16 a[144:145], v16 offset:16384
 ds_read_b64_tr_b16 a[146:147], v17 offset:16896
 ds_read_b64_tr_b16 a[148:149], v16 offset:18432
 ds_read_b64_tr_b16 a[150:151], v17 offset:18944
 v_xor_b32 v16, 32, v14
 v_add_u32 v16, 131072, v16
 v_xor_b32 v17, 64, v16
 ds_read_b64_tr_b16 a[152:153], v16 offset:24576
 ds_read_b64_tr_b16 a[154:155], v17 offset:25088
 ds_read_b64_tr_b16 a[156:157], v16 offset:26624
 ds_read_b64_tr_b16 a[158:159], v17 offset:27136
 s_waitcnt lgkmcnt(0)
 s_barrier
 s_lshl_b32 s14, s52, 8
 s_add_u32 s14, s14, 4456448
 s_mov_b32 m0, 139264
 s_nop 0
 buffer_load_dwordx4 v10, s[8:11], s14 offen lds
 s_add_u32 s14, s14, 32768
 s_mov_b32 m0, 140288
 s_nop 0
 buffer_load_dwordx4 v10, s[8:11], s14 offen lds
 s_add_u32 s14, s14, 32768
 s_mov_b32 m0, 141312
 s_nop 0
 buffer_load_dwordx4 v10, s[8:11], s14 offen lds
 s_add_u32 s14, s14, 32768
 s_mov_b32 m0, 142336
 s_nop 0
 buffer_load_dwordx4 v10, s[8:11], s14 offen lds
 s_add_u32 s14, s14, 32768
 s_mov_b32 m0, 143360
 s_nop 0
 buffer_load_dwordx4 v11, s[8:11], s14 offen lds
 s_add_u32 s14, s14, 32768
 s_mov_b32 m0, 144384
 s_nop 0
 buffer_load_dwordx4 v11, s[8:11], s14 offen lds
 s_add_u32 s14, s14, 32768
 s_mov_b32 m0, 145408
 s_nop 0
 buffer_load_dwordx4 v11, s[8:11], s14 offen lds
 s_add_u32 s14, s14, 32768
 s_mov_b32 m0, 146432
 s_nop 0
 buffer_load_dwordx4 v11, s[8:11], s14 offen lds
 s_waitcnt vmcnt(32)
 s_barrier
 v_xor_b32 v16, 0, v12
 v_add_u32 v16, 0, v16
 ds_read_b64_tr_b16 a[160:161], v16 offset:0
 ds_read_b64_tr_b16 a[162:163], v16 offset:8192
 ds_read_b64_tr_b16 a[164:165], v16 offset:2048
 ds_read_b64_tr_b16 a[166:167], v16 offset:10240
 v_xor_b32 v16, 32, v12
 v_add_u32 v16, 0, v16
 ds_read_b64_tr_b16 a[168:169], v16 offset:0
 ds_read_b64_tr_b16 a[170:171], v16 offset:8192
 ds_read_b64_tr_b16 a[172:173], v16 offset:2048
 ds_read_b64_tr_b16 a[174:175], v16 offset:10240
 v_xor_b32 v16, 0, v12
 v_add_u32 v16, 0, v16
 ds_read_b64_tr_b16 a[176:177], v16 offset:16384
 ds_read_b64_tr_b16 a[178:179], v16 offset:24576
 ds_read_b64_tr_b16 a[180:181], v16 offset:18432
 ds_read_b64_tr_b16 a[182:183], v16 offset:26624
 v_xor_b32 v16, 32, v12
 v_add_u32 v16, 0, v16
 ds_read_b64_tr_b16 a[184:185], v16 offset:16384
 ds_read_b64_tr_b16 a[186:187], v16 offset:24576
 ds_read_b64_tr_b16 a[188:189], v16 offset:18432
 ds_read_b64_tr_b16 a[190:191], v16 offset:26624
 s_waitcnt lgkmcnt(0)
 s_barrier
 s_mov_b32 s8, s22
 s_and_b32 s9, s23, 0xffff
 s_mov_b32 s10, 5242880
 s_lshl_b32 s14, s52, 8
 s_add_u32 s14, s14, 262144
 s_mov_b32 m0, 8192
 s_nop 0
 buffer_load_dwordx4 v10, s[8:11], s14 offen lds
 s_add_u32 s14, s14, 32768
 s_mov_b32 m0, 9216
 s_nop 0
 buffer_load_dwordx4 v10, s[8:11], s14 offen lds
 s_add_u32 s14, s14, 32768
 s_mov_b32 m0, 10240
 s_nop 0
 buffer_load_dwordx4 v10, s[8:11], s14 offen lds
 s_add_u32 s14, s14, 32768
 s_mov_b32 m0, 11264
 s_nop 0
 buffer_load_dwordx4 v10, s[8:11], s14 offen lds
 s_add_u32 s14, s14, 32768
 s_mov_b32 m0, 12288
 s_nop 0
 buffer_load_dwordx4 v11, s[8:11], s14 offen lds
 s_add_u32 s14, s14, 32768
 s_mov_b32 m0, 13312
 s_nop 0
 buffer_load_dwordx4 v11, s[8:11], s14 offen lds
 s_add_u32 s14, s14, 32768
 s_mov_b32 m0, 14336
 s_nop 0
 buffer_load_dwordx4 v11, s[8:11], s14 offen lds
 s_add_u32 s14, s14, 32768
 s_mov_b32 m0, 15360
 s_nop 0
 buffer_load_dwordx4 v11, s[8:11], s14 offen lds
 s_waitcnt vmcnt(32)
 s_barrier
 v_xor_b32 v16, 0, v12
 v_add_u32 v16, 32768, v16
 ds_read_b64_tr_b16 a[192:193], v16 offset:0
 ds_read_b64_tr_b16 a[194:195], v16 offset:8192
 ds_read_b64_tr_b16 a[196:197], v16 offset:2048
 ds_read_b64_tr_b16 a[198:199], v16 offset:10240
 v_xor_b32 v16, 32, v12
 v_add_u32 v16, 32768, v16
 ds_read_b64_tr_b16 a[200:201], v16 offset:0
 ds_read_b64_tr_b16 a[202:203], v16 offset:8192
 ds_read_b64_tr_b16 a[204:205], v16 offset:2048
 ds_read_b64_tr_b16 a[206:207], v16 offset:10240
 v_xor_b32 v16, 0, v12
 v_add_u32 v16, 32768, v16
 ds_read_b64_tr_b16 a[208:209], v16 offset:16384
 ds_read_b64_tr_b16 a[210:211], v16 offset:24576
 ds_read_b64_tr_b16 a[212:213], v16 offset:18432
 ds_read_b64_tr_b16 a[214:215], v16 offset:26624
 v_xor_b32 v16, 32, v12
 v_add_u32 v16, 32768, v16
 ds_read_b64_tr_b16 a[216:217], v16 offset:16384
 ds_read_b64_tr_b16 a[218:219], v16 offset:24576
 ds_read_b64_tr_b16 a[220:221], v16 offset:18432
 ds_read_b64_tr_b16 a[222:223], v16 offset:26624
 s_waitcnt lgkmcnt(0)
 s_barrier
 s_lshl_b32 s14, s52, 8
 s_add_u32 s14, s14, 1310720
 s_mov_b32 m0, 40960
 s_nop 0
 buffer_load_dwordx4 v10, s[8:11], s14 offen lds
 s_add_u32 s14, s14, 32768
 s_mov_b32 m0, 41984
 s_nop 0
 buffer_load_dwordx4 v10, s[8:11], s14 offen lds
 s_add_u32 s14, s14, 32768
 s_mov_b32 m0, 43008
 s_nop 0
 buffer_load_dwordx4 v10, s[8:11], s14 offen lds
 s_add_u32 s14, s14, 32768
 s_mov_b32 m0, 44032
 s_nop 0
 buffer_load_dwordx4 v10, s[8:11], s14 offen lds
 s_add_u32 s14, s14, 32768
 s_mov_b32 m0, 45056
 s_nop 0
 buffer_load_dwordx4 v11, s[8:11], s14 offen lds
 s_add_u32 s14, s14, 32768
 s_mov_b32 m0, 46080
 s_nop 0
 buffer_load_dwordx4 v11, s[8:11], s14 offen lds
 s_add_u32 s14, s14, 32768
 s_mov_b32 m0, 47104
 s_nop 0
 buffer_load_dwordx4 v11, s[8:11], s14 offen lds
 s_add_u32 s14, s14, 32768
 s_mov_b32 m0, 48128
 s_nop 0
 buffer_load_dwordx4 v11, s[8:11], s14 offen lds
 s_waitcnt vmcnt(32)
 s_barrier
 v_xor_b32 v16, 0, v12
 v_add_u32 v16, 65536, v16
 ds_read_b64_tr_b16 a[224:225], v16 offset:0
 ds_read_b64_tr_b16 a[226:227], v16 offset:8192
 ds_read_b64_tr_b16 a[228:229], v16 offset:2048
 ds_read_b64_tr_b16 a[230:231], v16 offset:10240
 v_xor_b32 v16, 32, v12
 v_add_u32 v16, 65536, v16
 ds_read_b64_tr_b16 a[232:233], v16 offset:0
 ds_read_b64_tr_b16 a[234:235], v16 offset:8192
 ds_read_b64_tr_b16 a[236:237], v16 offset:2048
 ds_read_b64_tr_b16 a[238:239], v16 offset:10240
 v_xor_b32 v16, 0, v12
 v_add_u32 v16, 65536, v16
 ds_read_b64_tr_b16 a[240:241], v16 offset:16384
 ds_read_b64_tr_b16 a[242:243], v16 offset:24576
 ds_read_b64_tr_b16 a[244:245], v16 offset:18432
 ds_read_b64_tr_b16 a[246:247], v16 offset:26624
 v_xor_b32 v16, 32, v12
 v_add_u32 v16, 65536, v16
 ds_read_b64_tr_b16 a[248:249], v16 offset:16384
 ds_read_b64_tr_b16 a[250:251], v16 offset:24576
 ds_read_b64_tr_b16 a[252:253], v16 offset:18432
 ds_read_b64_tr_b16 a[254:255], v16 offset:26624
 s_waitcnt lgkmcnt(0)
 s_barrier
 s_lshl_b32 s14, s52, 8
 s_add_u32 s14, s14, 2359296
 s_mov_b32 m0, 73728
 s_nop 0
 buffer_load_dwordx4 v10, s[8:11], s14 offen lds
 s_add_u32 s14, s14, 32768
 s_mov_b32 m0, 74752
 s_nop 0
 buffer_load_dwordx4 v10, s[8:11], s14 offen lds
 s_add_u32 s14, s14, 32768
 s_mov_b32 m0, 75776
 s_nop 0
 buffer_load_dwordx4 v10, s[8:11], s14 offen lds
 s_add_u32 s14, s14, 32768
 s_mov_b32 m0, 76800
 s_nop 0
 buffer_load_dwordx4 v10, s[8:11], s14 offen lds
 s_add_u32 s14, s14, 32768
 s_mov_b32 m0, 77824
 s_nop 0
 buffer_load_dwordx4 v11, s[8:11], s14 offen lds
 s_add_u32 s14, s14, 32768
 s_mov_b32 m0, 78848
 s_nop 0
 buffer_load_dwordx4 v11, s[8:11], s14 offen lds
 s_add_u32 s14, s14, 32768
 s_mov_b32 m0, 79872
 s_nop 0
 buffer_load_dwordx4 v11, s[8:11], s14 offen lds
 s_add_u32 s14, s14, 32768
 s_mov_b32 m0, 80896
 s_nop 0
 buffer_load_dwordx4 v11, s[8:11], s14 offen lds
 s_waitcnt vmcnt(32)
 s_barrier
 v_xor_b32 v16, 0, v12
 v_add_u32 v16, 98304, v16
 ds_read_b64_tr_b16 v[64:65], v16 offset:0
 ds_read_b64_tr_b16 v[66:67], v16 offset:8192
 ds_read_b64_tr_b16 v[68:69], v16 offset:2048
 ds_read_b64_tr_b16 v[70:71], v16 offset:10240
 v_xor_b32 v16, 32, v12
 v_add_u32 v16, 98304, v16
 ds_read_b64_tr_b16 v[72:73], v16 offset:0
 ds_read_b64_tr_b16 v[74:75], v16 offset:8192
 ds_read_b64_tr_b16 v[76:77], v16 offset:2048
 ds_read_b64_tr_b16 v[78:79], v16 offset:10240
 v_xor_b32 v16, 0, v12
 v_add_u32 v16, 98304, v16
 ds_read_b64_tr_b16 v[80:81], v16 offset:16384
 ds_read_b64_tr_b16 v[82:83], v16 offset:24576
 ds_read_b64_tr_b16 v[84:85], v16 offset:18432
 ds_read_b64_tr_b16 v[86:87], v16 offset:26624
 v_xor_b32 v16, 32, v12
 v_add_u32 v16, 98304, v16
 ds_read_b64_tr_b16 v[88:89], v16 offset:16384
 ds_read_b64_tr_b16 v[90:91], v16 offset:24576
 ds_read_b64_tr_b16 v[92:93], v16 offset:18432
 ds_read_b64_tr_b16 v[94:95], v16 offset:26624
 s_waitcnt lgkmcnt(0)
 s_barrier
 s_lshl_b32 s14, s52, 8
 s_add_u32 s14, s14, 3407872
 s_mov_b32 m0, 106496
 s_nop 0
 buffer_load_dwordx4 v10, s[8:11], s14 offen lds
 s_add_u32 s14, s14, 32768
 s_mov_b32 m0, 107520
 s_nop 0
 buffer_load_dwordx4 v10, s[8:11], s14 offen lds
 s_add_u32 s14, s14, 32768
 s_mov_b32 m0, 108544
 s_nop 0
 buffer_load_dwordx4 v10, s[8:11], s14 offen lds
 s_add_u32 s14, s14, 32768
 s_mov_b32 m0, 109568
 s_nop 0
 buffer_load_dwordx4 v10, s[8:11], s14 offen lds
 s_add_u32 s14, s14, 32768
 s_mov_b32 m0, 110592
 s_nop 0
 buffer_load_dwordx4 v11, s[8:11], s14 offen lds
 s_add_u32 s14, s14, 32768
 s_mov_b32 m0, 111616
 s_nop 0
 buffer_load_dwordx4 v11, s[8:11], s14 offen lds
 s_add_u32 s14, s14, 32768
 s_mov_b32 m0, 112640
 s_nop 0
 buffer_load_dwordx4 v11, s[8:11], s14 offen lds
 s_add_u32 s14, s14, 32768
 s_mov_b32 m0, 113664
 s_nop 0
 buffer_load_dwordx4 v11, s[8:11], s14 offen lds
 s_waitcnt vmcnt(32)
 s_barrier
 v_xor_b32 v16, 0, v12
 v_add_u32 v16, 131072, v16
 ds_read_b64_tr_b16 v[96:97], v16 offset:0
 ds_read_b64_tr_b16 v[98:99], v16 offset:8192
 ds_read_b64_tr_b16 v[100:101], v16 offset:2048
 ds_read_b64_tr_b16 v[102:103], v16 offset:10240
 v_xor_b32 v16, 32, v12
 v_add_u32 v16, 131072, v16
 ds_read_b64_tr_b16 v[104:105], v16 offset:0
 ds_read_b64_tr_b16 v[106:107], v16 offset:8192
 ds_read_b64_tr_b16 v[108:109], v16 offset:2048
 ds_read_b64_tr_b16 v[110:111], v16 offset:10240
 v_xor_b32 v16, 0, v12
 v_add_u32 v16, 131072, v16
 ds_read_b64_tr_b16 v[112:113], v16 offset:16384
 ds_read_b64_tr_b16 v[114:115], v16 offset:24576
 ds_read_b64_tr_b16 v[116:117], v16 offset:18432
 ds_read_b64_tr_b16 v[118:119], v16 offset:26624
 v_xor_b32 v16, 32, v12
 v_add_u32 v16, 131072, v16
 ds_read_b64_tr_b16 v[120:121], v16 offset:16384
 ds_read_b64_tr_b16 v[122:123], v16 offset:24576
 ds_read_b64_tr_b16 v[124:125], v16 offset:18432
 ds_read_b64_tr_b16 v[126:127], v16 offset:26624
 s_waitcnt lgkmcnt(0)
 s_barrier
 s_lshl_b32 s14, s52, 8
 s_add_u32 s14, s14, 4456448
 s_mov_b32 m0, 139264
 s_nop 0
 buffer_load_dwordx4 v10, s[8:11], s14 offen lds
 s_add_u32 s14, s14, 32768
 s_mov_b32 m0, 140288
 s_nop 0
 buffer_load_dwordx4 v10, s[8:11], s14 offen lds
 s_add_u32 s14, s14, 32768
 s_mov_b32 m0, 141312
 s_nop 0
 buffer_load_dwordx4 v10, s[8:11], s14 offen lds
 s_add_u32 s14, s14, 32768
 s_mov_b32 m0, 142336
 s_nop 0
 buffer_load_dwordx4 v10, s[8:11], s14 offen lds
 s_add_u32 s14, s14, 32768
 s_mov_b32 m0, 143360
 s_nop 0
 buffer_load_dwordx4 v11, s[8:11], s14 offen lds
 s_add_u32 s14, s14, 32768
 s_mov_b32 m0, 144384
 s_nop 0
 buffer_load_dwordx4 v11, s[8:11], s14 offen lds
 s_add_u32 s14, s14, 32768
 s_mov_b32 m0, 145408
 s_nop 0
 buffer_load_dwordx4 v11, s[8:11], s14 offen lds
 s_add_u32 s14, s14, 32768
 s_mov_b32 m0, 146432
 s_nop 0
 buffer_load_dwordx4 v11, s[8:11], s14 offen lds
 s_waitcnt vmcnt(32)
 s_barrier
 v_xor_b32 v16, 0, v12
 v_add_u32 v16, 0, v16
 ds_read_b64_tr_b16 v[128:129], v16 offset:0
 ds_read_b64_tr_b16 v[130:131], v16 offset:8192
 ds_read_b64_tr_b16 v[132:133], v16 offset:2048
 ds_read_b64_tr_b16 v[134:135], v16 offset:10240
 v_xor_b32 v16, 32, v12
 v_add_u32 v16, 0, v16
 ds_read_b64_tr_b16 v[136:137], v16 offset:0
 ds_read_b64_tr_b16 v[138:139], v16 offset:8192
 ds_read_b64_tr_b16 v[140:141], v16 offset:2048
 ds_read_b64_tr_b16 v[142:143], v16 offset:10240
 v_xor_b32 v16, 0, v12
 v_add_u32 v16, 0, v16
 ds_read_b64_tr_b16 v[144:145], v16 offset:16384
 ds_read_b64_tr_b16 v[146:147], v16 offset:24576
 ds_read_b64_tr_b16 v[148:149], v16 offset:18432
 ds_read_b64_tr_b16 v[150:151], v16 offset:26624
 v_xor_b32 v16, 32, v12
 v_add_u32 v16, 0, v16
 ds_read_b64_tr_b16 v[152:153], v16 offset:16384
 ds_read_b64_tr_b16 v[154:155], v16 offset:24576
 ds_read_b64_tr_b16 v[156:157], v16 offset:18432
 ds_read_b64_tr_b16 v[158:159], v16 offset:26624
 s_waitcnt lgkmcnt(0)
 s_barrier
 s_mov_b32 s8, s20
 s_and_b32 s9, s21, 0xffff
 s_mov_b32 s10, 5242880
 s_lshl_b32 s14, s52, 8
 s_add_u32 s14, s14, 262144
 s_mov_b32 m0, 8192
 s_nop 0
 buffer_load_dwordx4 v10, s[8:11], s14 offen lds
 s_add_u32 s14, s14, 32768
 s_mov_b32 m0, 9216
 s_nop 0
 buffer_load_dwordx4 v10, s[8:11], s14 offen lds
 s_add_u32 s14, s14, 32768
 s_mov_b32 m0, 10240
 s_nop 0
 buffer_load_dwordx4 v10, s[8:11], s14 offen lds
 s_add_u32 s14, s14, 32768
 s_mov_b32 m0, 11264
 s_nop 0
 buffer_load_dwordx4 v10, s[8:11], s14 offen lds
 s_add_u32 s14, s14, 32768
 s_mov_b32 m0, 12288
 s_nop 0
 buffer_load_dwordx4 v11, s[8:11], s14 offen lds
 s_add_u32 s14, s14, 32768
 s_mov_b32 m0, 13312
 s_nop 0
 buffer_load_dwordx4 v11, s[8:11], s14 offen lds
 s_add_u32 s14, s14, 32768
 s_mov_b32 m0, 14336
 s_nop 0
 buffer_load_dwordx4 v11, s[8:11], s14 offen lds
 s_add_u32 s14, s14, 32768
 s_mov_b32 m0, 15360
 s_nop 0
 buffer_load_dwordx4 v11, s[8:11], s14 offen lds
 s_waitcnt vmcnt(32)
 s_barrier
 v_xor_b32 v16, 0, v12
 v_add_u32 v16, 32768, v16
 ds_read_b64_tr_b16 v[32:33], v16 offset:0
 ds_read_b64_tr_b16 v[34:35], v16 offset:8192
 ds_read_b64_tr_b16 v[36:37], v16 offset:2048
 ds_read_b64_tr_b16 v[38:39], v16 offset:10240
 s_add_u32 s3, s63, 0
 s_waitcnt lgkmcnt(2)
 buffer_store_dwordx4 v[32:35], v1, s[4:7], s3 offen offset:0
 s_waitcnt lgkmcnt(0)
 buffer_store_dwordx4 v[36:39], v1, s[4:7], s3 offen offset:1024
 v_xor_b32 v16, 32, v12
 v_add_u32 v16, 32768, v16
 ds_read_b64_tr_b16 v[40:41], v16 offset:0
 ds_read_b64_tr_b16 v[42:43], v16 offset:8192
 ds_read_b64_tr_b16 v[44:45], v16 offset:2048
 ds_read_b64_tr_b16 v[46:47], v16 offset:10240
 s_add_u32 s3, s63, 2048
 s_waitcnt lgkmcnt(2)
 buffer_store_dwordx4 v[40:43], v1, s[4:7], s3 offen offset:0
 s_waitcnt lgkmcnt(0)
 buffer_store_dwordx4 v[44:47], v1, s[4:7], s3 offen offset:1024
 v_xor_b32 v16, 0, v12
 v_add_u32 v16, 32768, v16
 ds_read_b64_tr_b16 v[48:49], v16 offset:16384
 ds_read_b64_tr_b16 v[50:51], v16 offset:24576
 ds_read_b64_tr_b16 v[52:53], v16 offset:18432
 ds_read_b64_tr_b16 v[54:55], v16 offset:26624
 s_add_u32 s3, s63, 4096
 s_waitcnt lgkmcnt(2)
 buffer_store_dwordx4 v[48:51], v1, s[4:7], s3 offen offset:0
 s_waitcnt lgkmcnt(0)
 buffer_store_dwordx4 v[52:55], v1, s[4:7], s3 offen offset:1024
 v_xor_b32 v16, 32, v12
 v_add_u32 v16, 32768, v16
 ds_read_b64_tr_b16 v[56:57], v16 offset:16384
 ds_read_b64_tr_b16 v[58:59], v16 offset:24576
 ds_read_b64_tr_b16 v[60:61], v16 offset:18432
 ds_read_b64_tr_b16 v[62:63], v16 offset:26624
 s_add_u32 s3, s63, 6144
 s_waitcnt lgkmcnt(2)
 buffer_store_dwordx4 v[56:59], v1, s[4:7], s3 offen offset:0
 s_waitcnt lgkmcnt(0)
 buffer_store_dwordx4 v[60:63], v1, s[4:7], s3 offen offset:1024
 s_waitcnt lgkmcnt(0)
 s_barrier
 s_lshl_b32 s14, s52, 8
 s_add_u32 s14, s14, 1310720
 s_mov_b32 m0, 40960
 s_nop 0
 buffer_load_dwordx4 v10, s[8:11], s14 offen lds
 s_add_u32 s14, s14, 32768
 s_mov_b32 m0, 41984
 s_nop 0
 buffer_load_dwordx4 v10, s[8:11], s14 offen lds
 s_add_u32 s14, s14, 32768
 s_mov_b32 m0, 43008
 s_nop 0
 buffer_load_dwordx4 v10, s[8:11], s14 offen lds
 s_add_u32 s14, s14, 32768
 s_mov_b32 m0, 44032
 s_nop 0
 buffer_load_dwordx4 v10, s[8:11], s14 offen lds
 s_add_u32 s14, s14, 32768
 s_mov_b32 m0, 45056
 s_nop 0
 buffer_load_dwordx4 v11, s[8:11], s14 offen lds
 s_add_u32 s14, s14, 32768
 s_mov_b32 m0, 46080
 s_nop 0
 buffer_load_dwordx4 v11, s[8:11], s14 offen lds
 s_add_u32 s14, s14, 32768
 s_mov_b32 m0, 47104
 s_nop 0
 buffer_load_dwordx4 v11, s[8:11], s14 offen lds
 s_add_u32 s14, s14, 32768
 s_mov_b32 m0, 48128
 s_nop 0
 buffer_load_dwordx4 v11, s[8:11], s14 offen lds
 s_waitcnt vmcnt(40)
 s_barrier
 v_xor_b32 v16, 0, v12
 v_add_u32 v16, 65536, v16
 ds_read_b64_tr_b16 v[160:161], v16 offset:0
 ds_read_b64_tr_b16 v[162:163], v16 offset:8192
 ds_read_b64_tr_b16 v[164:165], v16 offset:2048
 ds_read_b64_tr_b16 v[166:167], v16 offset:10240
 v_xor_b32 v16, 32, v12
 v_add_u32 v16, 65536, v16
 ds_read_b64_tr_b16 v[168:169], v16 offset:0
 ds_read_b64_tr_b16 v[170:171], v16 offset:8192
 ds_read_b64_tr_b16 v[172:173], v16 offset:2048
 ds_read_b64_tr_b16 v[174:175], v16 offset:10240
 v_xor_b32 v16, 0, v12
 v_add_u32 v16, 65536, v16
 ds_read_b64_tr_b16 v[176:177], v16 offset:16384
 ds_read_b64_tr_b16 v[178:179], v16 offset:24576
 ds_read_b64_tr_b16 v[180:181], v16 offset:18432
 ds_read_b64_tr_b16 v[182:183], v16 offset:26624
 v_xor_b32 v16, 32, v12
 v_add_u32 v16, 65536, v16
 ds_read_b64_tr_b16 v[184:185], v16 offset:16384
 ds_read_b64_tr_b16 v[186:187], v16 offset:24576
 ds_read_b64_tr_b16 v[188:189], v16 offset:18432
 ds_read_b64_tr_b16 v[190:191], v16 offset:26624
 s_waitcnt lgkmcnt(0)
 s_barrier
 s_lshl_b32 s14, s52, 8
 s_add_u32 s14, s14, 2359296
 s_mov_b32 m0, 73728
 s_nop 0
 buffer_load_dwordx4 v10, s[8:11], s14 offen lds
 s_add_u32 s14, s14, 32768
 s_mov_b32 m0, 74752
 s_nop 0
 buffer_load_dwordx4 v10, s[8:11], s14 offen lds
 s_add_u32 s14, s14, 32768
 s_mov_b32 m0, 75776
 s_nop 0
 buffer_load_dwordx4 v10, s[8:11], s14 offen lds
 s_add_u32 s14, s14, 32768
 s_mov_b32 m0, 76800
 s_nop 0
 buffer_load_dwordx4 v10, s[8:11], s14 offen lds
 s_add_u32 s14, s14, 32768
 s_mov_b32 m0, 77824
 s_nop 0
 buffer_load_dwordx4 v11, s[8:11], s14 offen lds
 s_add_u32 s14, s14, 32768
 s_mov_b32 m0, 78848
 s_nop 0
 buffer_load_dwordx4 v11, s[8:11], s14 offen lds
 s_add_u32 s14, s14, 32768
 s_mov_b32 m0, 79872
 s_nop 0
 buffer_load_dwordx4 v11, s[8:11], s14 offen lds
 s_add_u32 s14, s14, 32768
 s_mov_b32 m0, 80896
 s_nop 0
 buffer_load_dwordx4 v11, s[8:11], s14 offen lds
 s_waitcnt vmcnt(40)
 s_barrier
 v_xor_b32 v16, 0, v12
 v_add_u32 v16, 98304, v16
 ds_read_b64_tr_b16 v[192:193], v16 offset:0
 ds_read_b64_tr_b16 v[194:195], v16 offset:8192
 ds_read_b64_tr_b16 v[196:197], v16 offset:2048
 ds_read_b64_tr_b16 v[198:199], v16 offset:10240
 v_xor_b32 v16, 32, v12
 v_add_u32 v16, 98304, v16
 ds_read_b64_tr_b16 v[32:33], v16 offset:0
 ds_read_b64_tr_b16 v[34:35], v16 offset:8192
 ds_read_b64_tr_b16 v[36:37], v16 offset:2048
 ds_read_b64_tr_b16 v[38:39], v16 offset:10240
 s_add_u32 s3, s63, 8192
 s_waitcnt lgkmcnt(2)
 buffer_store_dwordx4 v[32:35], v1, s[4:7], s3 offen offset:0
 s_waitcnt lgkmcnt(0)
 buffer_store_dwordx4 v[36:39], v1, s[4:7], s3 offen offset:1024
 v_xor_b32 v16, 0, v12
 v_add_u32 v16, 98304, v16
 ds_read_b64_tr_b16 v[200:201], v16 offset:16384
 ds_read_b64_tr_b16 v[202:203], v16 offset:24576
 ds_read_b64_tr_b16 v[204:205], v16 offset:18432
 ds_read_b64_tr_b16 v[206:207], v16 offset:26624
 v_xor_b32 v16, 32, v12
 v_add_u32 v16, 98304, v16
 ds_read_b64_tr_b16 v[208:209], v16 offset:16384
 ds_read_b64_tr_b16 v[210:211], v16 offset:24576
 ds_read_b64_tr_b16 v[212:213], v16 offset:18432
 ds_read_b64_tr_b16 v[214:215], v16 offset:26624
 s_waitcnt lgkmcnt(0)
 s_barrier
 s_lshl_b32 s14, s52, 8
 s_add_u32 s14, s14, 3407872
 s_mov_b32 m0, 106496
 s_nop 0
 buffer_load_dwordx4 v10, s[8:11], s14 offen lds
 s_add_u32 s14, s14, 32768
 s_mov_b32 m0, 107520
 s_nop 0
 buffer_load_dwordx4 v10, s[8:11], s14 offen lds
 s_add_u32 s14, s14, 32768
 s_mov_b32 m0, 108544
 s_nop 0
 buffer_load_dwordx4 v10, s[8:11], s14 offen lds
 s_add_u32 s14, s14, 32768
 s_mov_b32 m0, 109568
 s_nop 0
 buffer_load_dwordx4 v10, s[8:11], s14 offen lds
 s_add_u32 s14, s14, 32768
 s_mov_b32 m0, 110592
 s_nop 0
 buffer_load_dwordx4 v11, s[8:11], s14 offen lds
 s_add_u32 s14, s14, 32768
 s_mov_b32 m0, 111616
 s_nop 0
 buffer_load_dwordx4 v11, s[8:11], s14 offen lds
 s_add_u32 s14, s14, 32768
 s_mov_b32 m0, 112640
 s_nop 0
 buffer_load_dwordx4 v11, s[8:11], s14 offen lds
 s_add_u32 s14, s14, 32768
 s_mov_b32 m0, 113664
 s_nop 0
 buffer_load_dwordx4 v11, s[8:11], s14 offen lds
 s_waitcnt vmcnt(42)
 s_barrier
 v_xor_b32 v16, 0, v12
 v_add_u32 v16, 131072, v16
 ds_read_b64_tr_b16 v[216:217], v16 offset:0
 ds_read_b64_tr_b16 v[218:219], v16 offset:8192
 ds_read_b64_tr_b16 v[220:221], v16 offset:2048
 ds_read_b64_tr_b16 v[222:223], v16 offset:10240
 v_xor_b32 v16, 32, v12
 v_add_u32 v16, 131072, v16
 ds_read_b64_tr_b16 v[224:225], v16 offset:0
 ds_read_b64_tr_b16 v[226:227], v16 offset:8192
 ds_read_b64_tr_b16 v[228:229], v16 offset:2048
 ds_read_b64_tr_b16 v[230:231], v16 offset:10240
 v_xor_b32 v16, 0, v12
 v_add_u32 v16, 131072, v16
 ds_read_b64_tr_b16 v[232:233], v16 offset:16384
 ds_read_b64_tr_b16 v[234:235], v16 offset:24576
 ds_read_b64_tr_b16 v[236:237], v16 offset:18432
 ds_read_b64_tr_b16 v[238:239], v16 offset:26624
 v_xor_b32 v16, 32, v12
 v_add_u32 v16, 131072, v16
 ds_read_b64_tr_b16 v[40:41], v16 offset:16384
 ds_read_b64_tr_b16 v[42:43], v16 offset:24576
 ds_read_b64_tr_b16 v[44:45], v16 offset:18432
 ds_read_b64_tr_b16 v[46:47], v16 offset:26624
 s_add_u32 s3, s63, 10240
 s_waitcnt lgkmcnt(2)
 buffer_store_dwordx4 v[40:43], v1, s[4:7], s3 offen offset:0
 s_waitcnt lgkmcnt(0)
 buffer_store_dwordx4 v[44:47], v1, s[4:7], s3 offen offset:1024
 s_waitcnt lgkmcnt(0)
 s_barrier
 s_lshl_b32 s14, s52, 8
 s_add_u32 s14, s14, 4456448
 s_mov_b32 m0, 139264
 s_nop 0
 buffer_load_dwordx4 v10, s[8:11], s14 offen lds
 s_add_u32 s14, s14, 32768
 s_mov_b32 m0, 140288
 s_nop 0
 buffer_load_dwordx4 v10, s[8:11], s14 offen lds
 s_add_u32 s14, s14, 32768
 s_mov_b32 m0, 141312
 s_nop 0
 buffer_load_dwordx4 v10, s[8:11], s14 offen lds
 s_add_u32 s14, s14, 32768
 s_mov_b32 m0, 142336
 s_nop 0
 buffer_load_dwordx4 v10, s[8:11], s14 offen lds
 s_add_u32 s14, s14, 32768
 s_mov_b32 m0, 143360
 s_nop 0
 buffer_load_dwordx4 v11, s[8:11], s14 offen lds
 s_add_u32 s14, s14, 32768
 s_mov_b32 m0, 144384
 s_nop 0
 buffer_load_dwordx4 v11, s[8:11], s14 offen lds
 s_add_u32 s14, s14, 32768
 s_mov_b32 m0, 145408
 s_nop 0
 buffer_load_dwordx4 v11, s[8:11], s14 offen lds
 s_add_u32 s14, s14, 32768
 s_mov_b32 m0, 146432
 s_nop 0
 buffer_load_dwordx4 v11, s[8:11], s14 offen lds
 s_waitcnt vmcnt(44)
 s_barrier
 v_xor_b32 v16, 0, v12
 v_add_u32 v16, 0, v16
 ds_read_b64_tr_b16 v[240:241], v16 offset:0
 ds_read_b64_tr_b16 v[242:243], v16 offset:8192
 ds_read_b64_tr_b16 v[244:245], v16 offset:2048
 ds_read_b64_tr_b16 v[246:247], v16 offset:10240
 v_xor_b32 v16, 32, v12
 v_add_u32 v16, 0, v16
 ds_read_b64_tr_b16 v[248:249], v16 offset:0
 ds_read_b64_tr_b16 v[250:251], v16 offset:8192
 ds_read_b64_tr_b16 v[252:253], v16 offset:2048
 ds_read_b64_tr_b16 v[254:255], v16 offset:10240
 v_xor_b32 v16, 0, v12
 v_add_u32 v16, 0, v16
 ds_read_b64_tr_b16 v[32:33], v16 offset:16384
 ds_read_b64_tr_b16 v[34:35], v16 offset:24576
 ds_read_b64_tr_b16 v[36:37], v16 offset:18432
 ds_read_b64_tr_b16 v[38:39], v16 offset:26624
 v_xor_b32 v16, 32, v12
 v_add_u32 v16, 0, v16
 ds_read_b64_tr_b16 v[40:41], v16 offset:16384
 ds_read_b64_tr_b16 v[42:43], v16 offset:24576
 ds_read_b64_tr_b16 v[44:45], v16 offset:18432
 ds_read_b64_tr_b16 v[46:47], v16 offset:26624
 s_waitcnt lgkmcnt(0)
 s_barrier
 ds_write_b128 v1, v[224:227] offset:20480
 ds_write_b128 v1, v[228:231] offset:21504
 ds_write_b128 v1, v[216:219] offset:22528
 ds_write_b128 v1, v[220:223] offset:23552
 s_waitcnt lgkmcnt(0)
 v_mov_b32 v224, v32
 v_mov_b32 v225, v33
 v_mov_b32 v226, v34
 v_mov_b32 v227, v35
 v_mov_b32 v228, v36
 v_mov_b32 v229, v37
 v_mov_b32 v230, v38
 v_mov_b32 v231, v39
 v_mov_b32 v216, v40
 v_mov_b32 v217, v41
 v_mov_b32 v218, v42
 v_mov_b32 v219, v43
 v_mov_b32 v220, v44
 v_mov_b32 v221, v45
 v_mov_b32 v222, v46
 v_mov_b32 v223, v47
 s_waitcnt vmcnt(28)
 s_barrier
 v_xor_b32 v16, 0, v12
 v_add_u32 v16, 32768, v16
 ds_read_b64_tr_b16 v[32:33], v16 offset:0
 ds_read_b64_tr_b16 v[34:35], v16 offset:8192
 ds_read_b64_tr_b16 v[36:37], v16 offset:2048
 ds_read_b64_tr_b16 v[38:39], v16 offset:10240
 v_xor_b32 v16, 32, v12
 v_add_u32 v16, 32768, v16
 ds_read_b64_tr_b16 v[40:41], v16 offset:0
 ds_read_b64_tr_b16 v[42:43], v16 offset:8192
 ds_read_b64_tr_b16 v[44:45], v16 offset:2048
 ds_read_b64_tr_b16 v[46:47], v16 offset:10240
 v_xor_b32 v16, 0, v12
 v_add_u32 v16, 32768, v16
 ds_read_b64_tr_b16 v[48:49], v16 offset:16384
 ds_read_b64_tr_b16 v[50:51], v16 offset:24576
 ds_read_b64_tr_b16 v[52:53], v16 offset:18432
 ds_read_b64_tr_b16 v[54:55], v16 offset:26624
 v_xor_b32 v16, 32, v12
 v_add_u32 v16, 32768, v16
 ds_read_b64_tr_b16 v[56:57], v16 offset:16384
 ds_read_b64_tr_b16 v[58:59], v16 offset:24576
 ds_read_b64_tr_b16 v[60:61], v16 offset:18432
 ds_read_b64_tr_b16 v[62:63], v16 offset:26624
 s_waitcnt lgkmcnt(0)
 s_barrier
 ds_write_b128 v1, v[200:203] offset:40960
 ds_write_b128 v1, v[204:207] offset:41984
 ds_write_b128 v1, v[192:195] offset:43008
 ds_write_b128 v1, v[196:199] offset:44032
 ds_write_b128 v1, v[184:187] offset:45056
 ds_write_b128 v1, v[188:191] offset:46080
 ds_write_b128 v1, v[176:179] offset:47104
 ds_write_b128 v1, v[180:183] offset:48128
 s_waitcnt lgkmcnt(0)
 v_mov_b32 v200, v32
 v_mov_b32 v201, v33
 v_mov_b32 v202, v34
 v_mov_b32 v203, v35
 v_mov_b32 v204, v36
 v_mov_b32 v205, v37
 v_mov_b32 v206, v38
 v_mov_b32 v207, v39
 v_mov_b32 v192, v40
 v_mov_b32 v193, v41
 v_mov_b32 v194, v42
 v_mov_b32 v195, v43
 v_mov_b32 v196, v44
 v_mov_b32 v197, v45
 v_mov_b32 v198, v46
 v_mov_b32 v199, v47
 v_mov_b32 v184, v48
 v_mov_b32 v185, v49
 v_mov_b32 v186, v50
 v_mov_b32 v187, v51
 v_mov_b32 v188, v52
 v_mov_b32 v189, v53
 v_mov_b32 v190, v54
 v_mov_b32 v191, v55
 v_mov_b32 v176, v56
 v_mov_b32 v177, v57
 v_mov_b32 v178, v58
 v_mov_b32 v179, v59
 v_mov_b32 v180, v60
 v_mov_b32 v181, v61
 v_mov_b32 v182, v62
 v_mov_b32 v183, v63
 s_waitcnt vmcnt(20)
 s_barrier
 v_xor_b32 v16, 0, v12
 v_add_u32 v16, 65536, v16
 ds_read_b64_tr_b16 v[32:33], v16 offset:0
 ds_read_b64_tr_b16 v[34:35], v16 offset:8192
 ds_read_b64_tr_b16 v[36:37], v16 offset:2048
 ds_read_b64_tr_b16 v[38:39], v16 offset:10240
 v_xor_b32 v16, 32, v12
 v_add_u32 v16, 65536, v16
 ds_read_b64_tr_b16 v[40:41], v16 offset:0
 ds_read_b64_tr_b16 v[42:43], v16 offset:8192
 ds_read_b64_tr_b16 v[44:45], v16 offset:2048
 ds_read_b64_tr_b16 v[46:47], v16 offset:10240
 v_xor_b32 v16, 0, v12
 v_add_u32 v16, 65536, v16
 ds_read_b64_tr_b16 v[48:49], v16 offset:16384
 ds_read_b64_tr_b16 v[50:51], v16 offset:24576
 ds_read_b64_tr_b16 v[52:53], v16 offset:18432
 ds_read_b64_tr_b16 v[54:55], v16 offset:26624
 v_xor_b32 v16, 32, v12
 v_add_u32 v16, 65536, v16
 ds_read_b64_tr_b16 v[56:57], v16 offset:16384
 ds_read_b64_tr_b16 v[58:59], v16 offset:24576
 ds_read_b64_tr_b16 v[60:61], v16 offset:18432
 ds_read_b64_tr_b16 v[62:63], v16 offset:26624
 s_waitcnt lgkmcnt(0)
 s_barrier
 ds_write_b128 v2, v[160:163] offset:8192
 ds_write_b128 v2, v[164:167] offset:9216
 ds_write_b128 v2, v[144:147] offset:10240
 ds_write_b128 v2, v[148:151] offset:11264
 ds_write_b128 v2, v[136:139] offset:12288
 ds_write_b128 v2, v[140:143] offset:13312
 ds_write_b128 v2, v[128:131] offset:14336
 ds_write_b128 v2, v[132:135] offset:15360
 s_waitcnt lgkmcnt(0)
 v_mov_b32 v160, v32
 v_mov_b32 v161, v33
 v_mov_b32 v162, v34
 v_mov_b32 v163, v35
 v_mov_b32 v164, v36
 v_mov_b32 v165, v37
 v_mov_b32 v166, v38
 v_mov_b32 v167, v39
 v_mov_b32 v144, v40
 v_mov_b32 v145, v41
 v_mov_b32 v146, v42
 v_mov_b32 v147, v43
 v_mov_b32 v148, v44
 v_mov_b32 v149, v45
 v_mov_b32 v150, v46
 v_mov_b32 v151, v47
 v_mov_b32 v136, v48
 v_mov_b32 v137, v49
 v_mov_b32 v138, v50
 v_mov_b32 v139, v51
 v_mov_b32 v140, v52
 v_mov_b32 v141, v53
 v_mov_b32 v142, v54
 v_mov_b32 v143, v55
 v_mov_b32 v128, v56
 v_mov_b32 v129, v57
 v_mov_b32 v130, v58
 v_mov_b32 v131, v59
 v_mov_b32 v132, v60
 v_mov_b32 v133, v61
 v_mov_b32 v134, v62
 v_mov_b32 v135, v63
 s_waitcnt vmcnt(10)
 s_barrier
 v_xor_b32 v16, 0, v12
 v_add_u32 v16, 98304, v16
 ds_read_b64_tr_b16 v[32:33], v16 offset:0
 ds_read_b64_tr_b16 v[34:35], v16 offset:8192
 ds_read_b64_tr_b16 v[36:37], v16 offset:2048
 ds_read_b64_tr_b16 v[38:39], v16 offset:10240
 v_xor_b32 v16, 32, v12
 v_add_u32 v16, 98304, v16
 ds_read_b64_tr_b16 v[40:41], v16 offset:0
 ds_read_b64_tr_b16 v[42:43], v16 offset:8192
 ds_read_b64_tr_b16 v[44:45], v16 offset:2048
 ds_read_b64_tr_b16 v[46:47], v16 offset:10240
 v_xor_b32 v16, 0, v12
 v_add_u32 v16, 98304, v16
 ds_read_b64_tr_b16 v[48:49], v16 offset:16384
 ds_read_b64_tr_b16 v[50:51], v16 offset:24576
 ds_read_b64_tr_b16 v[52:53], v16 offset:18432
 ds_read_b64_tr_b16 v[54:55], v16 offset:26624
 v_xor_b32 v16, 32, v12
 v_add_u32 v16, 98304, v16
 ds_read_b64_tr_b16 v[56:57], v16 offset:16384
 ds_read_b64_tr_b16 v[58:59], v16 offset:24576
 ds_read_b64_tr_b16 v[60:61], v16 offset:18432
 ds_read_b64_tr_b16 v[62:63], v16 offset:26624
 s_waitcnt lgkmcnt(0)
 s_barrier
 ds_write_b128 v2, a[144:147] offset:40960
 ds_write_b128 v2, a[148:151] offset:41984
 ds_write_b128 v2, a[128:131] offset:43008
 ds_write_b128 v2, a[132:135] offset:44032
 ds_write_b128 v2, a[104:107] offset:45056
 ds_write_b128 v2, a[108:111] offset:46080
 ds_write_b128 v2, a[88:91] offset:47104
 ds_write_b128 v2, a[92:95] offset:48128
 s_waitcnt lgkmcnt(0)
 v_accvgpr_write_b32 a144, v32
 v_accvgpr_write_b32 a145, v33
 v_accvgpr_write_b32 a146, v34
 v_accvgpr_write_b32 a147, v35
 v_accvgpr_write_b32 a148, v36
 v_accvgpr_write_b32 a149, v37
 v_accvgpr_write_b32 a150, v38
 v_accvgpr_write_b32 a151, v39
 v_accvgpr_write_b32 a128, v40
 v_accvgpr_write_b32 a129, v41
 v_accvgpr_write_b32 a130, v42
 v_accvgpr_write_b32 a131, v43
 v_accvgpr_write_b32 a132, v44
 v_accvgpr_write_b32 a133, v45
 v_accvgpr_write_b32 a134, v46
 v_accvgpr_write_b32 a135, v47
 v_accvgpr_write_b32 a104, v48
 v_accvgpr_write_b32 a105, v49
 v_accvgpr_write_b32 a106, v50
 v_accvgpr_write_b32 a107, v51
 v_accvgpr_write_b32 a108, v52
 v_accvgpr_write_b32 a109, v53
 v_accvgpr_write_b32 a110, v54
 v_accvgpr_write_b32 a111, v55
 v_accvgpr_write_b32 a88, v56
 v_accvgpr_write_b32 a89, v57
 v_accvgpr_write_b32 a90, v58
 v_accvgpr_write_b32 a91, v59
 v_accvgpr_write_b32 a92, v60
 v_accvgpr_write_b32 a93, v61
 v_accvgpr_write_b32 a94, v62
 v_accvgpr_write_b32 a95, v63
 s_waitcnt vmcnt(0)
 s_barrier
 v_xor_b32 v16, 0, v12
 v_add_u32 v16, 131072, v16
 ds_read_b64_tr_b16 v[32:33], v16 offset:0
 ds_read_b64_tr_b16 v[34:35], v16 offset:8192
 ds_read_b64_tr_b16 v[36:37], v16 offset:2048
 ds_read_b64_tr_b16 v[38:39], v16 offset:10240
 v_xor_b32 v16, 32, v12
 v_add_u32 v16, 131072, v16
 ds_read_b64_tr_b16 v[40:41], v16 offset:0
 ds_read_b64_tr_b16 v[42:43], v16 offset:8192
 ds_read_b64_tr_b16 v[44:45], v16 offset:2048
 ds_read_b64_tr_b16 v[46:47], v16 offset:10240
 v_xor_b32 v16, 0, v12
 v_add_u32 v16, 131072, v16
 ds_read_b64_tr_b16 v[48:49], v16 offset:16384
 ds_read_b64_tr_b16 v[50:51], v16 offset:24576
 ds_read_b64_tr_b16 v[52:53], v16 offset:18432
 ds_read_b64_tr_b16 v[54:55], v16 offset:26624
 v_xor_b32 v16, 32, v12
 v_add_u32 v16, 131072, v16
 ds_read_b64_tr_b16 v[56:57], v16 offset:16384
 ds_read_b64_tr_b16 v[58:59], v16 offset:24576
 ds_read_b64_tr_b16 v[60:61], v16 offset:18432
 ds_read_b64_tr_b16 v[62:63], v16 offset:26624
 s_waitcnt lgkmcnt(0)
 s_barrier
 ds_write_b128 v3, a[80:83] offset:24576
 ds_write_b128 v3, a[84:87] offset:25600
 ds_write_b128 v3, a[72:75] offset:26624
 ds_write_b128 v3, a[76:79] offset:27648
 ds_write_b128 v3, a[32:35] offset:28672
 ds_write_b128 v3, a[36:39] offset:29696
 ds_write_b128 v3, a[24:27] offset:30720
 ds_write_b128 v3, a[28:31] offset:31744
 s_waitcnt lgkmcnt(0)
 v_accvgpr_write_b32 a80, v32
 v_accvgpr_write_b32 a81, v33
 v_accvgpr_write_b32 a82, v34
 v_accvgpr_write_b32 a83, v35
 v_accvgpr_write_b32 a84, v36
 v_accvgpr_write_b32 a85, v37
 v_accvgpr_write_b32 a86, v38
 v_accvgpr_write_b32 a87, v39
 v_accvgpr_write_b32 a72, v40
 v_accvgpr_write_b32 a73, v41
 v_accvgpr_write_b32 a74, v42
 v_accvgpr_write_b32 a75, v43
 v_accvgpr_write_b32 a76, v44
 v_accvgpr_write_b32 a77, v45
 v_accvgpr_write_b32 a78, v46
 v_accvgpr_write_b32 a79, v47
 v_accvgpr_write_b32 a32, v48
 v_accvgpr_write_b32 a33, v49
 v_accvgpr_write_b32 a34, v50
 v_accvgpr_write_b32 a35, v51
 v_accvgpr_write_b32 a36, v52
 v_accvgpr_write_b32 a37, v53
 v_accvgpr_write_b32 a38, v54
 v_accvgpr_write_b32 a39, v55
 v_accvgpr_write_b32 a24, v56
 v_accvgpr_write_b32 a25, v57
 v_accvgpr_write_b32 a26, v58
 v_accvgpr_write_b32 a27, v59
 v_accvgpr_write_b32 a28, v60
 v_accvgpr_write_b32 a29, v61
 v_accvgpr_write_b32 a30, v62
 v_accvgpr_write_b32 a31, v63
 v_lshlrev_b32 v5, 3, v0
 v_and_b32 v6, 0x1e0, v5
 v_and_b32 v7, 1, v0
 v_lshl_add_u32 v6, v7, 4, v6
 v_and_b32 v7, 2, v0
 v_lshl_add_u32 v6, v7, 2, v6
 v_bfe_u32 v4, v0, 2, 2
 v_lshrrev_b32 v7, 4, v0
 v_cmp_eq_u32 vcc, v4, v7
 v_and_b32 v7, 16, v1
 v_mov_b32 v5, 0x3f80
 v_lshlrev_b32 v7, v7, v5
 v_cndmask_b32 v4, 0, v7, vcc
 v_mov_b32 v5, 0
 s_lshl_b32 s59, s53, 16
 s_add_u32 s59, s59, 983040
 s_mul_i32 s15, s53, 327680
 s_add_u32 s15, s15, 225280
 s_lshl_b32 s3, s52, 8
 s_add_u32 s15, s15, s3
 s_add_u32 s64, s15, 128
 s_add_u32 s65, s15, 82048
 s_add_u32 s66, s15, 163968
 s_add_u32 s67, s15, 245888
 s_lshr_b32 s14, s52, 2
 s_and_b32 s15, s52, 3
 s_mov_b32 s16, 2
 s_mov_b32 s84, 0x00ff00ff
 s_mov_b32 s85, 0
 s_lshl_b32 s57, s14, 10
 s_lshl_b32 s3, s15, 6
 s_add_u32 s57, s57, s3
 s_lshl_b32 s3, s16, 8
 s_add_u32 s57, s57, s3
 s_add_u32 s57, s57, s59
 s_add_u32 s59, s59, 2048
 s_lshl_b32 s14, s14, 7
 s_mul_i32 s15, s15, 2560
 s_add_u32 s14, s14, s15
 s_lshl_b32 s3, s16, 3
 s_add_u32 s14, s14, s3
 s_mov_b32 s8, s18
 s_and_b32 s9, s19, 0xffff
 s_mov_b32 s10, 10240
 s_mov_b32 s11, 0x00020000
 v_bfe_u32 v40, v0, 4, 1
 v_mul_u32_u24 v40, 1280, v40
 v_and_b32 v41, 7, v0
 v_lshl_add_u32 v40, v41, 1, v40
 buffer_load_ushort v44, v40, s[8:11], s14 offen offset:0
 buffer_load_ushort v45, v40, s[8:11], s14 offen offset:32
 buffer_load_ushort v46, v40, s[8:11], s14 offen offset:64
 buffer_load_ushort v47, v40, s[8:11], s14 offen offset:96
 v_lshrrev_b32 v42, 7, v1
 v_mul_u32_u24 v42, 10240, v42
 v_and_b32 v7, 112, v1
 v_add_u32 v42, v42, v7
 v_and_b32 v43, 32, v1
 v_and_b32 v7, 64, v1
 v_lshl_add_u32 v43, v7, 2, v43
 v_bfe_u32 v7, v1, 8, 1
 v_lshl_add_u32 v43, v7, 4, v43
 v_bfe_u32 v7, v1, 4, 1
 v_lshl_add_u32 v43, v7, 3, v43
 s_waitcnt vmcnt(2)
 v_lshl_or_b32 v44, v45, 16, v44
 s_waitcnt vmcnt(0)
 v_lshl_or_b32 v45, v47, 16, v46
 s_add_u32 s16, s60, 6144
 s_waitcnt vmcnt(0) lgkmcnt(0)
 s_mov_b32 s96, s44
 s_and_b32 s97, s45, 0xffff
 s_mov_b32 s98, 256
 s_mov_b32 s99, 0x00020000
 v_mov_b32 v8, 132
 s_mov_b32 s51, 0
 s_mov_b64 exec, 1
L_wb_173:
 buffer_load_dword v9, v8, s[96:99], 0 offen sc1
 s_waitcnt vmcnt(0)
 v_cmp_eq_u32 vcc, 0, v9
 s_cbranch_vccz L_wbd_174
 s_sleep 2
 s_add_u32 s51, s51, 1
 s_cmp_lt_u32 s51, 131072
 s_cbranch_scc1 L_wb_173
 s_branch L_bail
L_wbd_174:
 s_mov_b64 exec, -1
 s_mov_b32 s96, s44
 s_and_b32 s97, s45, 0xffff
 s_mov_b32 s98, 256
 s_mov_b32 s99, 0x00020000
 v_mov_b32 v8, 212
 s_mov_b32 s51, 0
 s_mov_b64 exec, 1
L_wb_175:
 buffer_load_dword v9, v8, s[96:99], 0 offen sc1
 s_waitcnt vmcnt(0)
 v_cmp_eq_u32 vcc, 0, v9
 s_cbranch_vccz L_wbd_176
 s_sleep 2
 s_add_u32 s51, s51, 1
 s_cmp_lt_u32 s51, 131072
 s_cbranch_scc1 L_wb_175
 s_branch L_bail
L_wbd_176:
 s_mov_b64 exec, -1
 s_mov_b32 s96, s44
 s_and_b32 s97, s45, 0xffff
 s_mov_b32 s98, 256
 s_mov_b32 s99, 0x00020000
 v_lshlrev_b32 v8, 5, v0
 s_mov_b32 s51, 0
L_gl_177:
 buffer_load_dword v9, v8, s[96:99], 0 offen sc1
 s_waitcnt vmcnt(0)
 v_readlane_b32 s3, v9, s48
 s_mov_b32 s80, 0
 s_nop 2
 s_cmp_ge_u32 s3, 32
 s_cbranch_scc1 L_gld_178
 s_mov_b32 s80, 0
 v_readlane_b32 s3, v9, 0
 s_nop 3
 s_add_u32 s80, s80, s3
 v_readlane_b32 s3, v9, 1
 s_nop 3
 s_add_u32 s80, s80, s3
 v_readlane_b32 s3, v9, 2
 s_nop 3
 s_add_u32 s80, s80, s3
 v_readlane_b32 s3, v9, 3
 s_nop 3
 s_add_u32 s80, s80, s3
 v_readlane_b32 s3, v9, 4
 s_nop 3
 s_add_u32 s80, s80, s3
 v_readlane_b32 s3, v9, 5
 s_nop 3
 s_add_u32 s80, s80, s3
 v_readlane_b32 s3, v9, 6
 s_nop 3
 s_add_u32 s80, s80, s3
 v_readlane_b32 s3, v9, 7
 s_nop 3
 s_add_u32 s80, s80, s3
 s_cmp_ge_u32 s80, 256
 s_cbranch_scc1 L_gld_178
 s_sleep 4
 s_add_u32 s51, s51, 1
 s_cmp_lt_u32 s51, 131072
 s_cbranch_scc1 L_gl_177
 s_branch L_bail
L_gld_178:
 s_mov_b64 exec, s[84:85]
 buffer_store_dwordx2 v[44:45], v43, s[4:7], s57 offen sc1
 s_mov_b64 exec, -1
 v_and_b32 v7, 2, v0
 v_mul_u32_u24 v7, 0x5555, v7
 v_add_u32 v0, 0x4444, v7
 s_mov_b32 m0, 2048
 s_waitcnt vmcnt(0) lgkmcnt(0)
 s_barrier
 buffer_load_dwordx4 v[32:35], v1, s[4:7], s63 offen offset:0
 buffer_load_dwordx4 v[36:39], v1, s[4:7], s63 offen offset:1024
 buffer_load_dwordx4 v[40:43], v1, s[4:7], s63 offen offset:2048
 buffer_load_dwordx4 v[44:47], v1, s[4:7], s63 offen offset:3072
 buffer_load_dwordx4 v[48:51], v1, s[4:7], s81 offen offset:0
 buffer_load_dwordx4 v[52:55], v1, s[4:7], s81 offen offset:1024
 buffer_load_dwordx4 v[56:59], v1, s[4:7], s81 offen offset:2048
 buffer_load_dwordx4 v[60:63], v1, s[4:7], s81 offen offset:3072
 ds_read_b128 v[8:11], v3 offset:49152
 ds_read_b128 v[12:15], v3 offset:49152
 ds_read_b128 v[16:19], v3 offset:49152
 ds_read_b128 v[20:23], v3 offset:49152
 s_waitcnt vmcnt(0) lgkmcnt(0)
 s_cmp_lg_u32 s80, 0
 s_cbranch_scc1 L_ch1_s
.p2align 6
L_ch1_f:
 s_mov_b32 s51, 0
L_pm_179:
 buffer_load_dwordx4 v[24:27], v1, s[4:7], s59 offen offset:0 sc1
 buffer_load_dwordx4 v[28:31], v1, s[4:7], s59 offen offset:1024 sc1
 s_waitcnt vmcnt(1)
 ds_write_b128 v1, v[24:27] offset:2048
 v_max_u32 v7, v24, v26
 s_waitcnt vmcnt(0)
 ds_write_b128 v1, v[28:31] offset:3072
 v_max3_u32 v7, v7, v28, v30
 v_cmp_eq_u32 vcc, -1, v7
 s_cbranch_vccnz L_rt_180
 v_smfmac_f32_16x16x64_bf16 v[16:19], v[24:27], v[32:39], v0
 ds_read_b128 v[32:35], v2 offset:14336
 ds_read_b128 v[36:39], v2 offset:15360
 v_smfmac_f32_16x16x64_bf16 v[20:23], v[24:27], v[40:47], v0
 ds_read_b128 v[40:43], v2 offset:12288
 ds_read_b128 v[44:47], v2 offset:13312
 v_smfmac_f32_16x16x64_bf16 v[16:19], v[28:31], v[48:55], v0
 v_smfmac_f32_16x16x64_bf16 v[20:23], v[28:31], v[56:63], v0
 s_waitcnt lgkmcnt(4)
 s_barrier
 buffer_load_dwordx4 v[56:59], v1, s[4:7], s101 offen offset:0
 v_smfmac_f32_16x16x64_bf16 v[8:11], v[24:27], v[200:207], v0
 v_smfmac_f32_16x16x64_bf16 v[12:15], v[24:27], v[192:199], v0
 ds_read_b128 v[24:27], v1 offset:0
 buffer_load_dwordx4 v[60:63], v1, s[4:7], s101 offen offset:1024
 v_smfmac_f32_16x16x64_bf16 v[8:11], v[28:31], v[184:191], v0
 v_smfmac_f32_16x16x64_bf16 v[12:15], v[28:31], v[176:183], v0
 ds_read_b128 v[28:31], v1 offset:1024
 buffer_load_dwordx4 v[48:51], v1, s[4:7], s101 offen offset:2048
 s_waitcnt lgkmcnt(1)
 v_smfmac_f32_16x16x64_bf16 v[16:19], v[24:27], v[32:39], v0
 ds_read_b128 v[32:35], v2 offset:10240
 ds_read_b128 v[36:39], v2 offset:11264
 v_smfmac_f32_16x16x64_bf16 v[8:11], v[24:27], v[240:247], v0
 buffer_load_dwordx4 v[52:55], v1, s[4:7], s101 offen offset:3072
 v_smfmac_f32_16x16x64_bf16 v[12:15], v[24:27], v[248:255], v0
 v_smfmac_f32_16x16x64_bf16 v[20:23], v[24:27], v[40:47], v0
 ds_read_b128 v[40:43], v2 offset:8192
 ds_read_b128 v[44:47], v2 offset:9216
 ds_read_b128 v[24:27], v1 offset:4096
 s_waitcnt lgkmcnt(5)
 v_smfmac_f32_16x16x64_bf16 v[8:11], v[28:31], v[224:231], v0
 v_smfmac_f32_16x16x64_bf16 v[12:15], v[28:31], v[216:223], v0
 s_waitcnt lgkmcnt(3)
 v_smfmac_f32_16x16x64_bf16 v[16:19], v[28:31], v[32:39], v0
 ds_read_b128 v[32:35], v1 offset:47104
 ds_read_b128 v[36:39], v1 offset:48128
 v_smfmac_f32_16x16x64_bf16 v[20:23], v[28:31], v[152:159], v0
 ds_read_b128 v[28:31], v1 offset:5120
 s_waitcnt lgkmcnt(3)
 v_smfmac_f32_16x16x64_bf16 v[8:11], v[24:27], v[160:167], v0
 v_smfmac_f32_16x16x64_bf16 v[16:19], v[24:27], v[40:47], v0
 ds_read_b128 v[40:43], v1 offset:45056
 ds_read_b128 v[44:47], v1 offset:46080
 v_smfmac_f32_16x16x64_bf16 v[12:15], v[24:27], v[144:151], v0
 v_smfmac_f32_16x16x64_bf16 v[20:23], v[24:27], v[168:175], v0
 ds_read_b128 v[24:27], v1 offset:6144
 s_waitcnt lgkmcnt(3)
 v_smfmac_f32_16x16x64_bf16 v[16:19], v[28:31], v[32:39], v0
 ds_read_b128 v[32:35], v1 offset:43008
 ds_read_b128 v[36:39], v1 offset:44032
 v_smfmac_f32_16x16x64_bf16 v[8:11], v[28:31], v[136:143], v0
 v_smfmac_f32_16x16x64_bf16 v[12:15], v[28:31], v[128:135], v0
 s_waitcnt lgkmcnt(3)
 v_smfmac_f32_16x16x64_bf16 v[20:23], v[28:31], v[40:47], v0
 ds_read_b128 v[40:43], v1 offset:40960
 ds_read_b128 v[44:47], v1 offset:41984
 ds_read_b128 v[28:31], v1 offset:7168
 s_waitcnt lgkmcnt(5)
 v_smfmac_f32_16x16x64_bf16 v[8:11], v[24:27], a[144:151], v0
 v_smfmac_f32_16x16x64_bf16 v[12:15], v[24:27], a[128:135], v0
 s_waitcnt lgkmcnt(3)
 v_smfmac_f32_16x16x64_bf16 v[16:19], v[24:27], v[32:39], v0
 ds_read_b128 v[32:35], v1 offset:22528
 ds_read_b128 v[36:39], v1 offset:23552
 s_waitcnt vmcnt(2)
 v_smfmac_f32_16x16x64_bf16 v[20:23], v[24:27], v[56:63], v0
 ds_read_b128 v[24:27], v1 offset:8192
 buffer_load_dwordx4 v[56:59], v1, s[4:7], s61 offen offset:1024 sc1 nt
 s_waitcnt lgkmcnt(3)
 v_smfmac_f32_16x16x64_bf16 v[8:11], v[28:31], a[104:111], v0
 v_smfmac_f32_16x16x64_bf16 v[16:19], v[28:31], v[40:47], v0
 ds_read_b128 v[40:43], v1 offset:20480
 ds_read_b128 v[44:47], v1 offset:21504
 s_add_u32 s3, s61, 4096
 buffer_load_dwordx4 v[60:63], v1, s[4:7], s3 offen offset:1024 sc1 nt
 v_smfmac_f32_16x16x64_bf16 v[12:15], v[28:31], a[88:95], v0
 v_smfmac_f32_16x16x64_bf16 v[20:23], v[28:31], v[208:215], v0
 ds_read_b128 v[28:31], v1 offset:9216
 s_waitcnt lgkmcnt(3)
 v_smfmac_f32_16x16x64_bf16 v[16:19], v[24:27], v[32:39], v0
 v_smfmac_f32_16x16x64_bf16 v[8:11], v[24:27], a[80:87], v0
 s_add_u32 s3, s61, 67110912
 buffer_load_dwordx4 v[32:35], v1, s[4:7], s3 offen offset:0 sc1 nt
 v_smfmac_f32_16x16x64_bf16 v[12:15], v[24:27], a[72:79], v0
 s_waitcnt lgkmcnt(1)
 v_smfmac_f32_16x16x64_bf16 v[20:23], v[24:27], v[40:47], v0
 ds_read_b128 v[40:43], v3 offset:49152
 ds_read_b128 v[44:47], v3 offset:49152
 buffer_load_dwordx4 v[36:39], v1, s[4:7], s3 offen offset:1024 sc1 nt
 s_waitcnt lgkmcnt(2)
 v_smfmac_f32_16x16x64_bf16 v[8:11], v[28:31], a[32:39], v0
 v_smfmac_f32_16x16x64_bf16 v[12:15], v[28:31], a[24:31], v0
 v_lshlrev_b32 v7, 3, v1
 v_smfmac_f32_16x16x64_bf16 v[16:19], v[28:31], v[232:239], v0
 s_waitcnt vmcnt(4)
 v_smfmac_f32_16x16x64_bf16 v[20:23], v[28:31], v[48:55], v0
 s_add_u32 s3, s61, 524288
 buffer_load_dword v7, v7, s[4:7], s3 offen sc1
 ds_read_b128 v[52:55], v1 offset:0
 v_add_f32 v8, v8, v10
 v_add_f32 v11, v9, v11
 v_cvt_pk_bf16_f32 v9, v8, v11
 v_cvt_pk_bf16_f32 v8, v8, v11
 v_add_f32 v12, v12, v14
 v_add_f32 v15, v13, v15
 v_cvt_pk_bf16_f32 v13, v12, v15
 v_cvt_pk_bf16_f32 v12, v12, v15
 v_mfma_f32_16x16x16_bf16 v[8:11], v[8:9], v[4:5], 0
 v_mfma_f32_16x16x16_bf16 v[12:15], v[12:13], v[4:5], 0
 v_add_f32 v16, v16, v18
 v_add_f32 v19, v17, v19
 v_cvt_pk_bf16_f32 v17, v16, v19
 v_cvt_pk_bf16_f32 v16, v16, v19
 v_add_f32 v20, v20, v22
 v_add_f32 v23, v21, v23
 v_cvt_pk_bf16_f32 v21, v20, v23
 v_cvt_pk_bf16_f32 v20, v20, v23
 v_mfma_f32_16x16x16_bf16 v[16:19], v[16:17], v[4:5], 0
 v_mfma_f32_16x16x16_bf16 v[20:23], v[20:21], v[4:5], 0
 s_waitcnt lgkmcnt(2)
 v_smfmac_f32_16x16x64_bf16 v[40:43], v[24:27], v[96:103], v0
 s_waitcnt lgkmcnt(1)
 v_smfmac_f32_16x16x64_bf16 v[44:47], v[24:27], v[104:111], v0
 ds_read_b128 v[24:27], v1 offset:1024
 v_cvt_pk_bf16_f32 v15, v14, v15
 v_cvt_pk_bf16_f32 v14, v12, v13
 v_cvt_pk_bf16_f32 v13, v10, v11
 v_cvt_pk_bf16_f32 v12, v8, v9
 s_waitcnt vmcnt(4)
 s_nop 0
 v_mfma_f32_16x16x32_bf16 v[8:11], v[56:59], v[12:15], 0
 v_cvt_pk_bf16_f32 v23, v22, v23
 v_cvt_pk_bf16_f32 v22, v20, v21
 v_cvt_pk_bf16_f32 v21, v18, v19
 v_cvt_pk_bf16_f32 v20, v16, v17
 s_waitcnt vmcnt(3)
 v_mfma_f32_16x16x32_bf16 v[16:19], v[60:63], v[12:15], 0
 v_mfma_f32_16x16x32_bf16 v[48:51], v[20:23], v[12:15], 0
 v_smfmac_f32_16x16x64_bf16 v[40:43], v[28:31], v[112:119], v0
 v_smfmac_f32_16x16x64_bf16 v[44:47], v[28:31], v[120:127], v0
 ds_read_b128 v[28:31], v1 offset:2048
 s_waitcnt lgkmcnt(2)
 v_smfmac_f32_16x16x64_bf16 v[40:43], v[52:55], a[160:167], v0
 v_cndmask_b32 v8, v8, v16, s[70:71]
 v_cndmask_b32 v9, v9, v17, s[70:71]
 v_cndmask_b32 v10, v10, v18, s[70:71]
 v_cndmask_b32 v11, v11, v19, s[70:71]
 ds_write_b128 v1, v[8:11] offset:11264
 ds_write_b64 v1, v[48:49] offset:14344
 v_smfmac_f32_16x16x64_bf16 v[44:47], v[52:55], a[168:175], v0
 ds_read_b128 v[52:55], v1 offset:3072
 s_waitcnt lgkmcnt(4)
 v_smfmac_f32_16x16x64_bf16 v[40:43], v[24:27], a[176:183], v0
 v_smfmac_f32_16x16x64_bf16 v[44:47], v[24:27], a[184:191], v0
 ds_read_b128 v[24:27], v1 offset:4096
 s_waitcnt lgkmcnt(4)
 v_smfmac_f32_16x16x64_bf16 v[40:43], v[28:31], a[192:199], v0
 v_smfmac_f32_16x16x64_bf16 v[44:47], v[28:31], a[200:207], v0
 ds_read_b128 v[28:31], v1 offset:5120
 s_waitcnt lgkmcnt(2)
 v_smfmac_f32_16x16x64_bf16 v[40:43], v[52:55], a[208:215], v0
 v_smfmac_f32_16x16x64_bf16 v[44:47], v[52:55], a[216:223], v0
 ds_read_b128 v[52:55], v1 offset:6144
 s_barrier
 ds_read_b128 v[56:59], v1 offset:10240
 ds_read_b128 v[60:63], v1 offset:12288
 ds_read_b128 v[16:19], v1 offset:13312
 ds_read_b128 v[12:15], v1 offset:14336
 ds_read_b128 v[48:51], v1 offset:15360
 s_waitcnt lgkmcnt(7)
 v_smfmac_f32_16x16x64_bf16 v[40:43], v[24:27], a[224:231], v0
 s_mov_b64 exec, s[68:69]
 buffer_store_dwordx4 v[20:23], v6, s[4:7], s62 offen offset:512 sc1
 s_mov_b64 exec, -1
 v_smfmac_f32_16x16x64_bf16 v[44:47], v[24:27], a[232:239], v0
 ds_read_b128 v[24:27], v1 offset:7168
 s_waitcnt lgkmcnt(7)
 v_smfmac_f32_16x16x64_bf16 v[40:43], v[28:31], a[240:247], v0
 v_smfmac_f32_16x16x64_bf16 v[44:47], v[28:31], a[248:255], v0
 s_waitcnt lgkmcnt(6)
 v_smfmac_f32_16x16x64_bf16 v[40:43], v[52:55], v[64:71], v0
 v_smfmac_f32_16x16x64_bf16 v[44:47], v[52:55], v[72:79], v0
 s_waitcnt lgkmcnt(0)
 v_smfmac_f32_16x16x64_bf16 v[40:43], v[24:27], v[80:87], v0
 v_smfmac_f32_16x16x64_bf16 v[44:47], v[24:27], v[88:95], v0
 v_pk_add_f32 v[8:9], v[8:9], v[56:57]
 v_pk_add_f32 v[10:11], v[10:11], v[58:59]
 v_pk_add_f32 v[60:61], v[60:61], v[16:17]
 v_pk_add_f32 v[62:63], v[62:63], v[18:19]
 v_pk_add_f32 v[12:13], v[12:13], v[14:15]
 v_pk_add_f32 v[48:49], v[48:49], v[50:51]
 v_pk_add_f32 v[8:9], v[8:9], v[60:61]
 v_pk_add_f32 v[10:11], v[10:11], v[62:63]
 v_pk_add_f32 v[48:49], v[12:13], v[48:49]
 v_max3_f32 v50, v8, v9, v10
 v_max3_f32 v50, v50, v11, v48
 v_max_f32 v50, v50, v49
 v_add_f32 v40, v40, v42
 v_add_f32 v41, v41, v43
 v_max_f32_dpp v50, v50, v50 quad_perm:[2,3,0,1] row_mask:0xf bank_mask:0xf
 v_mov_b32 v51, v50
 v_add_f32 v44, v44, v46
 v_add_f32 v45, v45, v47
 v_permlane16_swap_b32 v50, v51
 v_max_f32 v50, v50, v51
 v_mov_b32 v51, v50
 v_cvt_pk_bf16_f32 v40, v40, v41
 v_cvt_pk_bf16_f32 v41, v44, v45
 v_permlane32_swap_b32 v50, v51
 v_max_f32 v50, v50, v51
 v_mul_f32 v50, s56, v50
 v_fma_f32 v48, v48, s56, -v50
 v_fma_f32 v49, v49, s56, -v50
 v_fma_f32 v8, v8, s56, -v50
 v_fma_f32 v9, v9, s56, -v50
 v_fma_f32 v10, v10, s56, -v50
 v_fma_f32 v11, v11, s56, -v50
 v_exp_f32 v48, v48
 v_lshrrev_b32 v51, 1, v1
 v_exp_f32 v49, v49
 ds_read_b128 v[56:59], v3 offset:26624
 ds_read_b128 v[60:63], v3 offset:27648
 v_exp_f32 v8, v8
 v_exp_f32 v9, v9
 ds_read_b128 v[24:27], v2 offset:45056
 ds_read_b128 v[28:31], v2 offset:46080
 v_exp_f32 v10, v10
 buffer_store_dwordx2 v[40:41], v51, s[4:7], s62 offen offset:2560 sc1
 v_exp_f32 v11, v11
 v_cvt_pk_bf16_f32 v14, v48, v49
 v_cvt_pk_bf16_f32 v12, v8, v9
 v_cvt_pk_bf16_f32 v13, v10, v11
 v_cndmask_b32 v52, 0, v14, s[68:69]
 v_cndmask_b32 v53, 0, v14, s[70:71]
 v_cndmask_b32 v22, 0, v12, s[70:71]
 v_cndmask_b32 v23, 0, v13, s[70:71]
 v_mfma_f32_16x16x16_bf16 v[44:47], v[40:41], v[52:53], 0
 v_cndmask_b32 v16, 0, v12, s[68:69]
 v_cndmask_b32 v17, 0, v13, s[68:69]
 v_mov_b32_dpp v18, v22 quad_perm:[2,3,0,1] row_mask:0xf bank_mask:0xf
 v_mov_b32_dpp v19, v23 quad_perm:[2,3,0,1] row_mask:0xf bank_mask:0xf
 v_mov_b32_dpp v20, v16 quad_perm:[2,3,0,1] row_mask:0xf bank_mask:0xf
 v_mov_b32_dpp v21, v17 quad_perm:[2,3,0,1] row_mask:0xf bank_mask:0xf
 s_waitcnt vmcnt(4)
 v_mfma_f32_16x16x32_bf16 v[44:47], v[32:35], v[16:19], v[44:47]
 v_add_f32 v54, v8, v9
 v_add_f32 v55, v48, v49
 s_waitcnt vmcnt(3)
 v_mfma_f32_16x16x32_bf16 v[44:47], v[36:39], v[20:23], v[44:47]
 v_add_f32 v54, v54, v10
 v_fma_f32 v55, v55, 0.5, v11
 v_add_f32 v54, v54, v55
 ds_read_b128 v[16:19], v3 offset:49152
 ds_read_b128 v[20:23], v3 offset:49152
 v_add_f32_dpp v54, v54, v54 quad_perm:[2,3,0,1] row_mask:0xf bank_mask:0xf
 v_mov_b32 v55, v54
 ds_read_b128 v[32:35], v3 offset:49152
 ds_read_b128 v[36:39], v3 offset:49152
 v_permlane16_swap_b32 v54, v55
 v_add_f32 v54, v54, v55
 v_mov_b32 v55, v54
 ds_read_b128 v[8:11], v3 offset:49152
 s_cmp_eq_u32 s54, 63
 v_permlane32_swap_b32 v54, v55
 v_add_f32 v54, v54, v55
 v_rcp_f32 v54, v54
 s_cbranch_scc1 L_ch1_end
 v_mul_f32 v44, v44, v54
 v_mul_f32 v45, v45, v54
 v_cvt_pk_bf16_f32 v42, v44, v45
 v_mul_f32 v46, v46, v54
 v_mul_f32 v47, v47, v54
 v_cvt_pk_bf16_f32 v43, v46, v47
 ds_write_b64 v6, v[42:43] offset:512
 v_and_b32 v40, -9, v6
 v_mov_b32_dpp v12, v42 quad_perm:[0,1,0,1] row_mask:0xf bank_mask:0xf
 v_mov_b32_dpp v14, v42 quad_perm:[2,3,2,3] row_mask:0xf bank_mask:0xf
 v_mov_b32_dpp v13, v43 quad_perm:[0,1,0,1] row_mask:0xf bank_mask:0xf
 v_mov_b32_dpp v15, v43 quad_perm:[2,3,2,3] row_mask:0xf bank_mask:0xf
 s_waitcnt lgkmcnt(5)
 s_nop 0
 v_smfmac_f32_16x16x64_bf16 v[16:19], v[12:15], a[8:15], v0
 s_waitcnt lgkmcnt(4)
 v_smfmac_f32_16x16x64_bf16 v[20:23], v[12:15], a[40:47], v0
 s_waitcnt lgkmcnt(0)
 s_barrier
 ds_read_b128 v[48:51], v40 offset:0
 ds_read_b128 v[52:55], v40 offset:1024
 ds_read_b128 v[44:47], v40 offset:1536
 v_smfmac_f32_16x16x64_bf16 v[32:35], v[12:15], v[56:63], v0
 ds_read_b128 v[56:59], v3 offset:30720
 ds_read_b128 v[60:63], v3 offset:31744
 s_mov_b32 m0, 10240
 v_smfmac_f32_16x16x64_bf16 v[36:39], v[12:15], v[24:31], v0
 ds_read_b128 v[24:27], v3 offset:28672
 ds_read_b128 v[28:31], v3 offset:29696
 buffer_load_dwordx4 v1, s[4:7], s63 offen offset:2048 lds
 v_smfmac_f32_16x16x64_bf16 v[8:11], v[12:15], a[136:143], v0
 s_mov_b32 m0, 10240
 s_waitcnt lgkmcnt(6)
 v_smfmac_f32_16x16x64_bf16 v[16:19], v[48:51], a[0:7], v0
 buffer_load_dwordx4 v1, s[4:7], s63 offen offset:3072 lds
 s_waitcnt lgkmcnt(5)
 v_smfmac_f32_16x16x64_bf16 v[16:19], v[52:55], a[16:23], v0
 s_mov_b32 m0, 2048
 s_waitcnt lgkmcnt(2)
 v_smfmac_f32_16x16x64_bf16 v[16:19], v[44:47], v[56:63], v0
 ds_read_b128 v[56:59], v3 offset:24576
 ds_read_b128 v[60:63], v3 offset:25600
 buffer_load_dwordx4 v1, s[4:7], s81 offen offset:0 lds
 s_waitcnt lgkmcnt(2)
 v_smfmac_f32_16x16x64_bf16 v[20:23], v[48:51], v[24:31], v0
 ds_read_b128 v[24:27], v2 offset:47104
 ds_read_b128 v[28:31], v2 offset:48128
 s_mov_b32 m0, 2048
 v_smfmac_f32_16x16x64_bf16 v[20:23], v[52:55], a[48:55], v0
 buffer_load_dwordx4 v1, s[4:7], s81 offen offset:1024 lds
 v_smfmac_f32_16x16x64_bf16 v[20:23], v[44:47], a[56:63], v0
 v_cvt_pk_bf16_f32 v16, v16, v17
 v_smfmac_f32_16x16x64_bf16 v[32:35], v[48:51], a[64:71], v0
 v_cvt_pk_bf16_f32 v17, v18, v19
 s_waitcnt lgkmcnt(2)
 v_smfmac_f32_16x16x64_bf16 v[32:35], v[52:55], v[56:63], v0
 ds_read_b128 v[56:59], v2 offset:43008
 ds_read_b128 v[60:63], v2 offset:44032
 v_and_or_b32 v16, v16, -2, s55
 s_waitcnt lgkmcnt(2)
 v_smfmac_f32_16x16x64_bf16 v[32:35], v[44:47], v[24:31], v0
 ds_read_b128 v[24:27], v2 offset:40960
 ds_read_b128 v[28:31], v2 offset:41984
 v_cvt_pk_bf16_f32 v18, v20, v21
 v_smfmac_f32_16x16x64_bf16 v[36:39], v[48:51], a[96:103], v0
 v_cvt_pk_bf16_f32 v19, v22, v23
 v_smfmac_f32_16x16x64_bf16 v[36:39], v[52:55], a[112:119], v0
 v_and_or_b32 v18, v18, -2, s55
 buffer_store_dwordx4 v[16:19], v1, s[4:7], s60 offen offset:0
 v_smfmac_f32_16x16x64_bf16 v[36:39], v[44:47], a[120:127], v0
 v_cvt_pk_bf16_f32 v32, v32, v33
 s_waitcnt lgkmcnt(2)
 v_smfmac_f32_16x16x64_bf16 v[8:11], v[48:51], v[56:63], v0
 v_cvt_pk_bf16_f32 v33, v34, v35
 s_waitcnt lgkmcnt(0)
 v_smfmac_f32_16x16x64_bf16 v[8:11], v[52:55], v[24:31], v0
 v_and_or_b32 v32, v32, -2, s55
 v_smfmac_f32_16x16x64_bf16 v[8:11], v[44:47], a[152:159], v0
 v_cvt_pk_bf16_f32 v34, v36, v37
 v_cvt_pk_bf16_f32 v35, v38, v39
 v_and_or_b32 v34, v34, -2, s55
 buffer_store_dwordx4 v[32:35], v1, s[4:7], s60 offen offset:1024
 s_nop 3
 v_cvt_pk_bf16_f32 v8, v8, v9
 v_cvt_pk_bf16_f32 v9, v10, v11
 v_and_or_b32 v8, v8, -2, s55
 buffer_store_dwordx2 v[8:9], v1, s[4:7], s16 offen offset:8
 buffer_load_dwordx4 v[32:35], v1, s[4:7], s63 offen offset:0
 buffer_load_dwordx4 v[36:39], v1, s[4:7], s63 offen offset:1024
 s_add_u32 s54, s54, 1
 s_add_u32 s61, s61, 524288
 s_and_b32 s3, s54, 3
 s_cselect_b32 s3, 1, -3
 s_lshl_b32 s3, s3, 17
 s_add_u32 s62, s62, s3
 s_and_b32 s3, s54, 3
 s_cselect_b32 s3, 1, -3
 s_lshl_b32 s3, s3, 14
 s_add_u32 s57, s57, s3
 s_add_u32 s59, s59, s3
 s_xor_b32 s58, s57, 32768
 v_lshrrev_b32 v56, 7, v1
 v_mul_u32_u24 v56, 10240, v56
 v_and_b32 v60, 112, v1
 v_add_u32 v56, v56, v60
 v_and_b32 v57, 32, v1
 v_and_b32 v60, 64, v1
 v_lshl_add_u32 v57, v60, 2, v57
 v_bfe_u32 v60, v1, 8, 1
 v_lshl_add_u32 v57, v60, 4, v57
 v_bfe_u32 v60, v1, 4, 1
 v_lshl_add_u32 v57, v60, 3, v57
 v_mov_b32 v60, 0x3f80
 v_mov_b32 v28, 0x3f800000
 v_cndmask_b32 v60, v60, v28, s[82:83]
 v_cndmask_b32 v28, 0, v60, s[72:73]
 v_cndmask_b32 v29, 0, v60, s[74:75]
 v_cndmask_b32 v30, 0, v60, s[76:77]
 v_cndmask_b32 v31, 0, v60, s[78:79]
 v_mov_b64 v[58:59], -1
 s_mov_b64 exec, s[84:85]
 buffer_store_dwordx2 v[58:59], v57, s[4:7], s58 offen
 s_mov_b64 exec, -1
 s_nop 15
 s_nop 15
 s_nop 15
 s_nop 15
 s_nop 15
 s_mov_b32 s51, 0
 buffer_load_dwordx4 v[8:11], v56, s[4:7], s64 offen sc1
 buffer_load_dwordx4 v[12:15], v56, s[4:7], s65 offen sc1
 buffer_load_dwordx4 v[16:19], v56, s[4:7], s66 offen sc1
 buffer_load_dwordx4 v[20:23], v56, s[4:7], s67 offen sc1
L_pp_181:
 s_waitcnt vmcnt(3)
 v_mfma_f32_16x16x32_bf16 v[24:27], v[28:31], v[8:11], 0
 v_bitop3_b32 v60, v8, v10, s55 bitop3:0x7e
 s_waitcnt vmcnt(2)
 v_mfma_f32_16x16x32_bf16 v[24:27], v[28:31], v[12:15], v[24:27]
 v_bitop3_b32 v61, v12, v14, s55 bitop3:0x7e
 s_waitcnt vmcnt(1)
 v_mfma_f32_16x16x32_bf16 v[24:27], v[28:31], v[16:19], v[24:27]
 v_bitop3_b32 v62, v16, v18, s55 bitop3:0x7e
 s_waitcnt vmcnt(0)
 v_mfma_f32_16x16x32_bf16 v[24:27], v[28:31], v[20:23], v[24:27]
 v_bitop3_b32 v63, v20, v22, s55 bitop3:0x7e
 v_or3_b32 v7, v60, v61, v62
 v_bitop3_b32 v7, v7, v63, 1 bitop3:0xa8
 v_cmp_ne_u32 vcc, 0, v7
 s_cbranch_vccnz L_rt_182
 s_nop 2
 v_add_f32_dpp v24, v24, v24 row_ror:8 row_mask:0xf bank_mask:0xf
 v_add_f32_dpp v25, v25, v25 row_ror:8 row_mask:0xf bank_mask:0xf
 v_add_f32_dpp v26, v26, v26 row_ror:8 row_mask:0xf bank_mask:0xf
 v_add_f32_dpp v27, v27, v27 row_ror:8 row_mask:0xf bank_mask:0xf
 s_mov_b64 exec, s[84:85]
 v_cvt_pk_bf16_f32 v24, v24, v25
 v_cvt_pk_bf16_f32 v25, v26, v27
 buffer_store_dwordx2 v[24:25], v57, s[4:7], s57 offen
 s_mov_b64 exec, -1
 s_xor_b32 s55, s55, 1
 ds_read_b128 v[40:43], v1 offset:12288
 ds_read_b128 v[44:47], v1 offset:13312
 ds_read_b128 v[48:51], v1 offset:2048
 ds_read_b128 v[52:55], v1 offset:3072
 buffer_load_dwordx4 v[56:59], v1, s[4:7], s81 offen offset:2048
 buffer_load_dwordx4 v[60:63], v1, s[4:7], s81 offen offset:3072
 ds_read_b128 v[8:11], v3 offset:49152
 ds_read_b128 v[12:15], v3 offset:49152
 ds_read_b128 v[16:19], v3 offset:49152
 ds_read_b128 v[20:23], v3 offset:49152
 s_waitcnt lgkmcnt(0)
 s_nop 15
 s_nop 15
 s_nop 7
 s_branch L_ch1_f
L_rt_180:
 s_add_u32 s51, s51, 1
 s_cmp_lt_u32 s51, 131072
 s_cbranch_scc1 L_pm_179
 s_branch L_bail
L_rt_182:
 buffer_load_dwordx4 v[8:11], v56, s[4:7], s64 offen sc1
 buffer_load_dwordx4 v[12:15], v56, s[4:7], s65 offen sc1
 buffer_load_dwordx4 v[16:19], v56, s[4:7], s66 offen sc1
 buffer_load_dwordx4 v[20:23], v56, s[4:7], s67 offen sc1
 s_add_u32 s51, s51, 1
 s_cmp_lt_u32 s51, 131072
 s_cbranch_scc1 L_pp_181
 s_branch L_bail
.p2align 6
L_ch1_s:
 s_mov_b32 s51, 0
L_pm_183:
 buffer_load_dwordx4 v[24:27], v1, s[4:7], s59 offen offset:0 sc1
 buffer_load_dwordx4 v[28:31], v1, s[4:7], s59 offen offset:1024 sc1
 s_waitcnt vmcnt(1)
 ds_write_b128 v1, v[24:27] offset:2048
 v_max_u32 v7, v24, v26
 s_waitcnt vmcnt(0)
 ds_write_b128 v1, v[28:31] offset:3072
 v_max3_u32 v7, v7, v28, v30
 v_cmp_eq_u32 vcc, -1, v7
 s_cbranch_vccnz L_rt_184
 v_smfmac_f32_16x16x64_bf16 v[16:19], v[24:27], v[32:39], v0
 ds_read_b128 v[32:35], v2 offset:14336
 ds_read_b128 v[36:39], v2 offset:15360
 v_smfmac_f32_16x16x64_bf16 v[20:23], v[24:27], v[40:47], v0
 ds_read_b128 v[40:43], v2 offset:12288
 ds_read_b128 v[44:47], v2 offset:13312
 v_smfmac_f32_16x16x64_bf16 v[16:19], v[28:31], v[48:55], v0
 v_smfmac_f32_16x16x64_bf16 v[20:23], v[28:31], v[56:63], v0
 s_waitcnt lgkmcnt(4)
 s_barrier
 buffer_load_dwordx4 v[56:59], v1, s[4:7], s101 offen offset:0
 v_smfmac_f32_16x16x64_bf16 v[8:11], v[24:27], v[200:207], v0
 v_smfmac_f32_16x16x64_bf16 v[12:15], v[24:27], v[192:199], v0
 ds_read_b128 v[24:27], v1 offset:0
 buffer_load_dwordx4 v[60:63], v1, s[4:7], s101 offen offset:1024
 v_smfmac_f32_16x16x64_bf16 v[8:11], v[28:31], v[184:191], v0
 v_smfmac_f32_16x16x64_bf16 v[12:15], v[28:31], v[176:183], v0
 ds_read_b128 v[28:31], v1 offset:1024
 buffer_load_dwordx4 v[48:51], v1, s[4:7], s101 offen offset:2048
 s_waitcnt lgkmcnt(1)
 v_smfmac_f32_16x16x64_bf16 v[16:19], v[24:27], v[32:39], v0
 ds_read_b128 v[32:35], v2 offset:10240
 ds_read_b128 v[36:39], v2 offset:11264
 v_smfmac_f32_16x16x64_bf16 v[8:11], v[24:27], v[240:247], v0
 buffer_load_dwordx4 v[52:55], v1, s[4:7], s101 offen offset:3072
 v_smfmac_f32_16x16x64_bf16 v[12:15], v[24:27], v[248:255], v0
 v_smfmac_f32_16x16x64_bf16 v[20:23], v[24:27], v[40:47], v0
 ds_read_b128 v[40:43], v2 offset:8192
 ds_read_b128 v[44:47], v2 offset:9216
 ds_read_b128 v[24:27], v1 offset:4096
 s_waitcnt lgkmcnt(5)
 v_smfmac_f32_16x16x64_bf16 v[8:11], v[28:31], v[224:231], v0
 v_smfmac_f32_16x16x64_bf16 v[12:15], v[28:31], v[216:223], v0
 s_waitcnt lgkmcnt(3)
 v_smfmac_f32_16x16x64_bf16 v[16:19], v[28:31], v[32:39], v0
 ds_read_b128 v[32:35], v1 offset:47104
 ds_read_b128 v[36:39], v1 offset:48128
 v_smfmac_f32_16x16x64_bf16 v[20:23], v[28:31], v[152:159], v0
 ds_read_b128 v[28:31], v1 offset:5120
 s_waitcnt lgkmcnt(3)
 v_smfmac_f32_16x16x64_bf16 v[8:11], v[24:27], v[160:167], v0
 v_smfmac_f32_16x16x64_bf16 v[16:19], v[24:27], v[40:47], v0
 ds_read_b128 v[40:43], v1 offset:45056
 ds_read_b128 v[44:47], v1 offset:46080
 v_smfmac_f32_16x16x64_bf16 v[12:15], v[24:27], v[144:151], v0
 v_smfmac_f32_16x16x64_bf16 v[20:23], v[24:27], v[168:175], v0
 ds_read_b128 v[24:27], v1 offset:6144
 s_waitcnt lgkmcnt(3)
 v_smfmac_f32_16x16x64_bf16 v[16:19], v[28:31], v[32:39], v0
 ds_read_b128 v[32:35], v1 offset:43008
 ds_read_b128 v[36:39], v1 offset:44032
 v_smfmac_f32_16x16x64_bf16 v[8:11], v[28:31], v[136:143], v0
 v_smfmac_f32_16x16x64_bf16 v[12:15], v[28:31], v[128:135], v0
 s_waitcnt lgkmcnt(3)
 v_smfmac_f32_16x16x64_bf16 v[20:23], v[28:31], v[40:47], v0
 ds_read_b128 v[40:43], v1 offset:40960
 ds_read_b128 v[44:47], v1 offset:41984
 ds_read_b128 v[28:31], v1 offset:7168
 s_waitcnt lgkmcnt(5)
 v_smfmac_f32_16x16x64_bf16 v[8:11], v[24:27], a[144:151], v0
 v_smfmac_f32_16x16x64_bf16 v[12:15], v[24:27], a[128:135], v0
 s_waitcnt lgkmcnt(3)
 v_smfmac_f32_16x16x64_bf16 v[16:19], v[24:27], v[32:39], v0
 ds_read_b128 v[32:35], v1 offset:22528
 ds_read_b128 v[36:39], v1 offset:23552
 s_waitcnt vmcnt(2)
 v_smfmac_f32_16x16x64_bf16 v[20:23], v[24:27], v[56:63], v0
 ds_read_b128 v[24:27], v1 offset:8192
 buffer_load_dwordx4 v[56:59], v1, s[4:7], s61 offen offset:1024 sc1 nt
 s_waitcnt lgkmcnt(3)
 v_smfmac_f32_16x16x64_bf16 v[8:11], v[28:31], a[104:111], v0
 v_smfmac_f32_16x16x64_bf16 v[16:19], v[28:31], v[40:47], v0
 ds_read_b128 v[40:43], v1 offset:20480
 ds_read_b128 v[44:47], v1 offset:21504
 s_add_u32 s3, s61, 4096
 buffer_load_dwordx4 v[60:63], v1, s[4:7], s3 offen offset:1024 sc1 nt
 v_smfmac_f32_16x16x64_bf16 v[12:15], v[28:31], a[88:95], v0
 v_smfmac_f32_16x16x64_bf16 v[20:23], v[28:31], v[208:215], v0
 ds_read_b128 v[28:31], v1 offset:9216
 s_waitcnt lgkmcnt(3)
 v_smfmac_f32_16x16x64_bf16 v[16:19], v[24:27], v[32:39], v0
 v_smfmac_f32_16x16x64_bf16 v[8:11], v[24:27], a[80:87], v0
 s_add_u32 s3, s61, 67110912
 buffer_load_dwordx4 v[32:35], v1, s[4:7], s3 offen offset:0 sc1 nt
 v_smfmac_f32_16x16x64_bf16 v[12:15], v[24:27], a[72:79], v0
 s_waitcnt lgkmcnt(1)
 v_smfmac_f32_16x16x64_bf16 v[20:23], v[24:27], v[40:47], v0
 ds_read_b128 v[40:43], v3 offset:49152
 ds_read_b128 v[44:47], v3 offset:49152
 buffer_load_dwordx4 v[36:39], v1, s[4:7], s3 offen offset:1024 sc1 nt
 s_waitcnt lgkmcnt(2)
 v_smfmac_f32_16x16x64_bf16 v[8:11], v[28:31], a[32:39], v0
 v_smfmac_f32_16x16x64_bf16 v[12:15], v[28:31], a[24:31], v0
 v_lshlrev_b32 v7, 3, v1
 v_smfmac_f32_16x16x64_bf16 v[16:19], v[28:31], v[232:239], v0
 s_waitcnt vmcnt(4)
 v_smfmac_f32_16x16x64_bf16 v[20:23], v[28:31], v[48:55], v0
 s_add_u32 s3, s61, 524288
 buffer_load_dword v7, v7, s[4:7], s3 offen sc1
 ds_read_b128 v[52:55], v1 offset:0
 v_add_f32 v8, v8, v10
 v_add_f32 v11, v9, v11
 v_cvt_pk_bf16_f32 v9, v8, v11
 v_cvt_pk_bf16_f32 v8, v8, v11
 v_add_f32 v12, v12, v14
 v_add_f32 v15, v13, v15
 v_cvt_pk_bf16_f32 v13, v12, v15
 v_cvt_pk_bf16_f32 v12, v12, v15
 v_mfma_f32_16x16x16_bf16 v[8:11], v[8:9], v[4:5], 0
 v_mfma_f32_16x16x16_bf16 v[12:15], v[12:13], v[4:5], 0
 v_add_f32 v16, v16, v18
 v_add_f32 v19, v17, v19
 v_cvt_pk_bf16_f32 v17, v16, v19
 v_cvt_pk_bf16_f32 v16, v16, v19
 v_add_f32 v20, v20, v22
 v_add_f32 v23, v21, v23
 v_cvt_pk_bf16_f32 v21, v20, v23
 v_cvt_pk_bf16_f32 v20, v20, v23
 v_mfma_f32_16x16x16_bf16 v[16:19], v[16:17], v[4:5], 0
 v_mfma_f32_16x16x16_bf16 v[20:23], v[20:21], v[4:5], 0
 s_waitcnt lgkmcnt(2)
 v_smfmac_f32_16x16x64_bf16 v[40:43], v[24:27], v[96:103], v0
 s_waitcnt lgkmcnt(1)
 v_smfmac_f32_16x16x64_bf16 v[44:47], v[24:27], v[104:111], v0
 ds_read_b128 v[24:27], v1 offset:1024
 v_cvt_pk_bf16_f32 v15, v14, v15
 v_cvt_pk_bf16_f32 v14, v12, v13
 v_cvt_pk_bf16_f32 v13, v10, v11
 v_cvt_pk_bf16_f32 v12, v8, v9
 s_waitcnt vmcnt(4)
 s_nop 0
 v_mfma_f32_16x16x32_bf16 v[8:11], v[56:59], v[12:15], 0
 v_cvt_pk_bf16_f32 v23, v22, v23
 v_cvt_pk_bf16_f32 v22, v20, v21
 v_cvt_pk_bf16_f32 v21, v18, v19
 v_cvt_pk_bf16_f32 v20, v16, v17
 s_waitcnt vmcnt(3)
 v_mfma_f32_16x16x32_bf16 v[16:19], v[60:63], v[12:15], 0
 v_mfma_f32_16x16x32_bf16 v[48:51], v[20:23], v[12:15], 0
 v_smfmac_f32_16x16x64_bf16 v[40:43], v[28:31], v[112:119], v0
 v_smfmac_f32_16x16x64_bf16 v[44:47], v[28:31], v[120:127], v0
 ds_read_b128 v[28:31], v1 offset:2048
 s_waitcnt lgkmcnt(2)
 v_smfmac_f32_16x16x64_bf16 v[40:43], v[52:55], a[160:167], v0
 v_cndmask_b32 v8, v8, v16, s[70:71]
 v_cndmask_b32 v9, v9, v17, s[70:71]
 v_cndmask_b32 v10, v10, v18, s[70:71]
 v_cndmask_b32 v11, v11, v19, s[70:71]
 ds_write_b128 v1, v[8:11] offset:11264
 ds_write_b64 v1, v[48:49] offset:14344
 v_smfmac_f32_16x16x64_bf16 v[44:47], v[52:55], a[168:175], v0
 ds_read_b128 v[52:55], v1 offset:3072
 s_waitcnt lgkmcnt(4)
 v_smfmac_f32_16x16x64_bf16 v[40:43], v[24:27], a[176:183], v0
 v_smfmac_f32_16x16x64_bf16 v[44:47], v[24:27], a[184:191], v0
 ds_read_b128 v[24:27], v1 offset:4096
 s_waitcnt lgkmcnt(4)
 v_smfmac_f32_16x16x64_bf16 v[40:43], v[28:31], a[192:199], v0
 v_smfmac_f32_16x16x64_bf16 v[44:47], v[28:31], a[200:207], v0
 ds_read_b128 v[28:31], v1 offset:5120
 s_waitcnt lgkmcnt(2)
 v_smfmac_f32_16x16x64_bf16 v[40:43], v[52:55], a[208:215], v0
 v_smfmac_f32_16x16x64_bf16 v[44:47], v[52:55], a[216:223], v0
 ds_read_b128 v[52:55], v1 offset:6144
 s_barrier
 ds_read_b128 v[56:59], v1 offset:10240
 ds_read_b128 v[60:63], v1 offset:12288
 ds_read_b128 v[16:19], v1 offset:13312
 ds_read_b128 v[12:15], v1 offset:14336
 ds_read_b128 v[48:51], v1 offset:15360
 s_waitcnt lgkmcnt(7)
 v_smfmac_f32_16x16x64_bf16 v[40:43], v[24:27], a[224:231], v0
 s_mov_b64 exec, s[68:69]
 buffer_store_dwordx4 v[20:23], v6, s[4:7], s62 offen offset:512 sc1
 s_mov_b64 exec, -1
 v_smfmac_f32_16x16x64_bf16 v[44:47], v[24:27], a[232:239], v0
 ds_read_b128 v[24:27], v1 offset:7168
 s_waitcnt lgkmcnt(7)
 v_smfmac_f32_16x16x64_bf16 v[40:43], v[28:31], a[240:247], v0
 v_smfmac_f32_16x16x64_bf16 v[44:47], v[28:31], a[248:255], v0
 s_waitcnt lgkmcnt(6)
 v_smfmac_f32_16x16x64_bf16 v[40:43], v[52:55], v[64:71], v0
 v_smfmac_f32_16x16x64_bf16 v[44:47], v[52:55], v[72:79], v0
 s_waitcnt lgkmcnt(0)
 v_smfmac_f32_16x16x64_bf16 v[40:43], v[24:27], v[80:87], v0
 v_smfmac_f32_16x16x64_bf16 v[44:47], v[24:27], v[88:95], v0
 v_pk_add_f32 v[8:9], v[8:9], v[56:57]
 v_pk_add_f32 v[10:11], v[10:11], v[58:59]
 v_pk_add_f32 v[60:61], v[60:61], v[16:17]
 v_pk_add_f32 v[62:63], v[62:63], v[18:19]
 v_pk_add_f32 v[12:13], v[12:13], v[14:15]
 v_pk_add_f32 v[48:49], v[48:49], v[50:51]
 v_pk_add_f32 v[8:9], v[8:9], v[60:61]
 v_pk_add_f32 v[10:11], v[10:11], v[62:63]
 v_pk_add_f32 v[48:49], v[12:13], v[48:49]
 v_max3_f32 v50, v8, v9, v10
 v_max3_f32 v50, v50, v11, v48
 v_max_f32 v50, v50, v49
 v_add_f32 v40, v40, v42
 v_add_f32 v41, v41, v43
 v_max_f32_dpp v50, v50, v50 quad_perm:[2,3,0,1] row_mask:0xf bank_mask:0xf
 v_mov_b32 v51, v50
 v_add_f32 v44, v44, v46
 v_add_f32 v45, v45, v47
 v_permlane16_swap_b32 v50, v51
 v_max_f32 v50, v50, v51
 v_mov_b32 v51, v50
 v_cvt_pk_bf16_f32 v40, v40, v41
 v_cvt_pk_bf16_f32 v41, v44, v45
 v_permlane32_swap_b32 v50, v51
 v_max_f32 v50, v50, v51
 v_mul_f32 v50, s56, v50
 v_fma_f32 v48, v48, s56, -v50
 v_fma_f32 v49, v49, s56, -v50
 v_fma_f32 v8, v8, s56, -v50
 v_fma_f32 v9, v9, s56, -v50
 v_fma_f32 v10, v10, s56, -v50
 v_fma_f32 v11, v11, s56, -v50
 v_exp_f32 v48, v48
 v_lshrrev_b32 v51, 1, v1
 v_exp_f32 v49, v49
 ds_read_b128 v[56:59], v3 offset:26624
 ds_read_b128 v[60:63], v3 offset:27648
 v_exp_f32 v8, v8
 v_exp_f32 v9, v9
 ds_read_b128 v[24:27], v2 offset:45056
 ds_read_b128 v[28:31], v2 offset:46080
 v_exp_f32 v10, v10
 buffer_store_dwordx2 v[40:41], v51, s[4:7], s62 offen offset:2560 sc1
 v_exp_f32 v11, v11
 v_cvt_pk_bf16_f32 v14, v48, v49
 v_cvt_pk_bf16_f32 v12, v8, v9
 v_cvt_pk_bf16_f32 v13, v10, v11
 v_cndmask_b32 v52, 0, v14, s[68:69]
 v_cndmask_b32 v53, 0, v14, s[70:71]
 v_cndmask_b32 v22, 0, v12, s[70:71]
 v_cndmask_b32 v23, 0, v13, s[70:71]
 v_mfma_f32_16x16x16_bf16 v[44:47], v[40:41], v[52:53], 0
 v_cndmask_b32 v16, 0, v12, s[68:69]
 v_cndmask_b32 v17, 0, v13, s[68:69]
 v_mov_b32_dpp v18, v22 quad_perm:[2,3,0,1] row_mask:0xf bank_mask:0xf
 v_mov_b32_dpp v19, v23 quad_perm:[2,3,0,1] row_mask:0xf bank_mask:0xf
 v_mov_b32_dpp v20, v16 quad_perm:[2,3,0,1] row_mask:0xf bank_mask:0xf
 v_mov_b32_dpp v21, v17 quad_perm:[2,3,0,1] row_mask:0xf bank_mask:0xf
 s_waitcnt vmcnt(4)
 v_mfma_f32_16x16x32_bf16 v[44:47], v[32:35], v[16:19], v[44:47]
 v_add_f32 v54, v8, v9
 v_add_f32 v55, v48, v49
 s_waitcnt vmcnt(3)
 v_mfma_f32_16x16x32_bf16 v[44:47], v[36:39], v[20:23], v[44:47]
 v_add_f32 v54, v54, v10
 v_fma_f32 v55, v55, 0.5, v11
 v_add_f32 v54, v54, v55
 ds_read_b128 v[16:19], v3 offset:49152
 ds_read_b128 v[20:23], v3 offset:49152
 v_add_f32_dpp v54, v54, v54 quad_perm:[2,3,0,1] row_mask:0xf bank_mask:0xf
 v_mov_b32 v55, v54
 ds_read_b128 v[32:35], v3 offset:49152
 ds_read_b128 v[36:39], v3 offset:49152
 v_permlane16_swap_b32 v54, v55
 v_add_f32 v54, v54, v55
 v_mov_b32 v55, v54
 ds_read_b128 v[8:11], v3 offset:49152
 s_cmp_eq_u32 s54, 63
 v_permlane32_swap_b32 v54, v55
 v_add_f32 v54, v54, v55
 v_rcp_f32 v54, v54
 s_cbranch_scc1 L_ch1_end
 v_mul_f32 v44, v44, v54
 v_mul_f32 v45, v45, v54
 v_cvt_pk_bf16_f32 v42, v44, v45
 v_mul_f32 v46, v46, v54
 v_mul_f32 v47, v47, v54
 v_cvt_pk_bf16_f32 v43, v46, v47
 ds_write_b64 v6, v[42:43] offset:512
 v_and_b32 v40, -9, v6
 v_mov_b32_dpp v12, v42 quad_perm:[0,1,0,1] row_mask:0xf bank_mask:0xf
 v_mov_b32_dpp v14, v42 quad_perm:[2,3,2,3] row_mask:0xf bank_mask:0xf
 v_mov_b32_dpp v13, v43 quad_perm:[0,1,0,1] row_mask:0xf bank_mask:0xf
 v_mov_b32_dpp v15, v43 quad_perm:[2,3,2,3] row_mask:0xf bank_mask:0xf
 s_waitcnt lgkmcnt(5)
 s_nop 0
 v_smfmac_f32_16x16x64_bf16 v[16:19], v[12:15], a[8:15], v0
 s_waitcnt lgkmcnt(4)
 v_smfmac_f32_16x16x64_bf16 v[20:23], v[12:15], a[40:47], v0
 s_waitcnt lgkmcnt(0)
 s_barrier
 ds_read_b128 v[48:51], v40 offset:0
 ds_read_b128 v[52:55], v40 offset:1024
 ds_read_b128 v[44:47], v40 offset:1536
 v_smfmac_f32_16x16x64_bf16 v[32:35], v[12:15], v[56:63], v0
 ds_read_b128 v[56:59], v3 offset:30720
 ds_read_b128 v[60:63], v3 offset:31744
 s_mov_b32 m0, 10240
 v_smfmac_f32_16x16x64_bf16 v[36:39], v[12:15], v[24:31], v0
 ds_read_b128 v[24:27], v3 offset:28672
 ds_read_b128 v[28:31], v3 offset:29696
 buffer_load_dwordx4 v1, s[4:7], s63 offen offset:2048 lds
 v_smfmac_f32_16x16x64_bf16 v[8:11], v[12:15], a[136:143], v0
 s_mov_b32 m0, 10240
 s_waitcnt lgkmcnt(6)
 v_smfmac_f32_16x16x64_bf16 v[16:19], v[48:51], a[0:7], v0
 buffer_load_dwordx4 v1, s[4:7], s63 offen offset:3072 lds
 s_waitcnt lgkmcnt(5)
 v_smfmac_f32_16x16x64_bf16 v[16:19], v[52:55], a[16:23], v0
 s_mov_b32 m0, 2048
 s_waitcnt lgkmcnt(2)
 v_smfmac_f32_16x16x64_bf16 v[16:19], v[44:47], v[56:63], v0
 ds_read_b128 v[56:59], v3 offset:24576
 ds_read_b128 v[60:63], v3 offset:25600
 buffer_load_dwordx4 v1, s[4:7], s81 offen offset:0 lds
 s_waitcnt lgkmcnt(2)
 v_smfmac_f32_16x16x64_bf16 v[20:23], v[48:51], v[24:31], v0
 ds_read_b128 v[24:27], v2 offset:47104
 ds_read_b128 v[28:31], v2 offset:48128
 s_mov_b32 m0, 2048
 v_smfmac_f32_16x16x64_bf16 v[20:23], v[52:55], a[48:55], v0
 buffer_load_dwordx4 v1, s[4:7], s81 offen offset:1024 lds
 v_smfmac_f32_16x16x64_bf16 v[20:23], v[44:47], a[56:63], v0
 v_cvt_pk_bf16_f32 v16, v16, v17
 v_smfmac_f32_16x16x64_bf16 v[32:35], v[48:51], a[64:71], v0
 v_cvt_pk_bf16_f32 v17, v18, v19
 s_waitcnt lgkmcnt(2)
 v_smfmac_f32_16x16x64_bf16 v[32:35], v[52:55], v[56:63], v0
 ds_read_b128 v[56:59], v2 offset:43008
 ds_read_b128 v[60:63], v2 offset:44032
 v_and_or_b32 v16, v16, -2, s55
 s_waitcnt lgkmcnt(2)
 v_smfmac_f32_16x16x64_bf16 v[32:35], v[44:47], v[24:31], v0
 ds_read_b128 v[24:27], v2 offset:40960
 ds_read_b128 v[28:31], v2 offset:41984
 v_cvt_pk_bf16_f32 v18, v20, v21
 v_smfmac_f32_16x16x64_bf16 v[36:39], v[48:51], a[96:103], v0
 v_cvt_pk_bf16_f32 v19, v22, v23
 v_smfmac_f32_16x16x64_bf16 v[36:39], v[52:55], a[112:119], v0
 v_and_or_b32 v18, v18, -2, s55
 buffer_store_dwordx4 v[16:19], v1, s[4:7], s60 offen offset:0 sc1
 v_smfmac_f32_16x16x64_bf16 v[36:39], v[44:47], a[120:127], v0
 v_cvt_pk_bf16_f32 v32, v32, v33
 s_waitcnt lgkmcnt(2)
 v_smfmac_f32_16x16x64_bf16 v[8:11], v[48:51], v[56:63], v0
 v_cvt_pk_bf16_f32 v33, v34, v35
 s_waitcnt lgkmcnt(0)
 v_smfmac_f32_16x16x64_bf16 v[8:11], v[52:55], v[24:31], v0
 v_and_or_b32 v32, v32, -2, s55
 v_smfmac_f32_16x16x64_bf16 v[8:11], v[44:47], a[152:159], v0
 v_cvt_pk_bf16_f32 v34, v36, v37
 v_cvt_pk_bf16_f32 v35, v38, v39
 v_and_or_b32 v34, v34, -2, s55
 buffer_store_dwordx4 v[32:35], v1, s[4:7], s60 offen offset:1024 sc1
 s_nop 3
 v_cvt_pk_bf16_f32 v8, v8, v9
 v_cvt_pk_bf16_f32 v9, v10, v11
 v_and_or_b32 v8, v8, -2, s55
 buffer_store_dwordx2 v[8:9], v1, s[4:7], s16 offen offset:8 sc1
 buffer_load_dwordx4 v[32:35], v1, s[4:7], s63 offen offset:0
 buffer_load_dwordx4 v[36:39], v1, s[4:7], s63 offen offset:1024
 s_add_u32 s54, s54, 1
 s_add_u32 s61, s61, 524288
 s_and_b32 s3, s54, 3
 s_cselect_b32 s3, 1, -3
 s_lshl_b32 s3, s3, 17
 s_add_u32 s62, s62, s3
 s_and_b32 s3, s54, 3
 s_cselect_b32 s3, 1, -3
 s_lshl_b32 s3, s3, 14
 s_add_u32 s57, s57, s3
 s_add_u32 s59, s59, s3
 s_xor_b32 s58, s57, 32768
 v_lshrrev_b32 v56, 7, v1
 v_mul_u32_u24 v56, 10240, v56
 v_and_b32 v60, 112, v1
 v_add_u32 v56, v56, v60
 v_and_b32 v57, 32, v1
 v_and_b32 v60, 64, v1
 v_lshl_add_u32 v57, v60, 2, v57
 v_bfe_u32 v60, v1, 8, 1
 v_lshl_add_u32 v57, v60, 4, v57
 v_bfe_u32 v60, v1, 4, 1
 v_lshl_add_u32 v57, v60, 3, v57
 v_mov_b32 v60, 0x3f80
 v_mov_b32 v28, 0x3f800000
 v_cndmask_b32 v60, v60, v28, s[82:83]
 v_cndmask_b32 v28, 0, v60, s[72:73]
 v_cndmask_b32 v29, 0, v60, s[74:75]
 v_cndmask_b32 v30, 0, v60, s[76:77]
 v_cndmask_b32 v31, 0, v60, s[78:79]
 v_mov_b64 v[58:59], -1
 s_mov_b64 exec, s[84:85]
 buffer_store_dwordx2 v[58:59], v57, s[4:7], s58 offen sc1
 s_mov_b64 exec, -1
 s_nop 15
 s_nop 15
 s_nop 15
 s_nop 15
 s_nop 15
 s_mov_b32 s51, 0
 buffer_load_dwordx4 v[8:11], v56, s[4:7], s64 offen sc1
 buffer_load_dwordx4 v[12:15], v56, s[4:7], s65 offen sc1
 buffer_load_dwordx4 v[16:19], v56, s[4:7], s66 offen sc1
 buffer_load_dwordx4 v[20:23], v56, s[4:7], s67 offen sc1
L_pp_185:
 s_waitcnt vmcnt(3)
 v_mfma_f32_16x16x32_bf16 v[24:27], v[28:31], v[8:11], 0
 v_bitop3_b32 v60, v8, v10, s55 bitop3:0x7e
 s_waitcnt vmcnt(2)
 v_mfma_f32_16x16x32_bf16 v[24:27], v[28:31], v[12:15], v[24:27]
 v_bitop3_b32 v61, v12, v14, s55 bitop3:0x7e
 s_waitcnt vmcnt(1)
 v_mfma_f32_16x16x32_bf16 v[24:27], v[28:31], v[16:19], v[24:27]
 v_bitop3_b32 v62, v16, v18, s55 bitop3:0x7e
 s_waitcnt vmcnt(0)
 v_mfma_f32_16x16x32_bf16 v[24:27], v[28:31], v[20:23], v[24:27]
 v_bitop3_b32 v63, v20, v22, s55 bitop3:0x7e
 v_or3_b32 v7, v60, v61, v62
 v_bitop3_b32 v7, v7, v63, 1 bitop3:0xa8
 v_cmp_ne_u32 vcc, 0, v7
 s_cbranch_vccnz L_rt_186
 s_nop 2
 v_add_f32_dpp v24, v24, v24 row_ror:8 row_mask:0xf bank_mask:0xf
 v_add_f32_dpp v25, v25, v25 row_ror:8 row_mask:0xf bank_mask:0xf
 v_add_f32_dpp v26, v26, v26 row_ror:8 row_mask:0xf bank_mask:0xf
 v_add_f32_dpp v27, v27, v27 row_ror:8 row_mask:0xf bank_mask:0xf
 s_mov_b64 exec, s[84:85]
 v_cvt_pk_bf16_f32 v24, v24, v25
 v_cvt_pk_bf16_f32 v25, v26, v27
 buffer_store_dwordx2 v[24:25], v57, s[4:7], s57 offen sc1
 s_mov_b64 exec, -1
 s_xor_b32 s55, s55, 1
 ds_read_b128 v[40:43], v1 offset:12288
 ds_read_b128 v[44:47], v1 offset:13312
 ds_read_b128 v[48:51], v1 offset:2048
 ds_read_b128 v[52:55], v1 offset:3072
 buffer_load_dwordx4 v[56:59], v1, s[4:7], s81 offen offset:2048
 buffer_load_dwordx4 v[60:63], v1, s[4:7], s81 offen offset:3072
 ds_read_b128 v[8:11], v3 offset:49152
 ds_read_b128 v[12:15], v3 offset:49152
 ds_read_b128 v[16:19], v3 offset:49152
 ds_read_b128 v[20:23], v3 offset:49152
 s_waitcnt lgkmcnt(0)
 s_nop 15
 s_nop 15
 s_nop 7
 s_branch L_ch1_s
L_rt_184:
 s_add_u32 s51, s51, 1
 s_cmp_lt_u32 s51, 131072
 s_cbranch_scc1 L_pm_183
 s_branch L_bail
L_rt_186:
 buffer_load_dwordx4 v[8:11], v56, s[4:7], s64 offen sc1
 buffer_load_dwordx4 v[12:15], v56, s[4:7], s65 offen sc1
 buffer_load_dwordx4 v[16:19], v56, s[4:7], s66 offen sc1
 buffer_load_dwordx4 v[20:23], v56, s[4:7], s67 offen sc1
 s_add_u32 s51, s51, 1
 s_cmp_lt_u32 s51, 131072
 s_cbranch_scc1 L_pp_185
 s_branch L_bail
L_ch1_end:
 s_waitcnt vmcnt(0)
 s_endpgm
L_ch2:
 v_lshrrev_b32 v8, 4, v0
 s_mov_b32 s3, 1280
 v_mul_lo_u32 v8, v8, s3
 v_lshrrev_b32 v7, 3, v0
 v_and_b32 v7, 6, v7
 v_xor_b32 v7, v7, v0
 v_and_b32 v7, 15, v7
 v_lshl_add_u32 v8, v7, 4, v8
 v_xor_b32 v9, 128, v8
 v_lshrrev_b32 v10, 4, v0
 s_mov_b32 s3, 8192
 v_mul_lo_u32 v10, v10, s3
 v_lshrrev_b32 v7, 3, v0
 v_and_b32 v7, 6, v7
 v_xor_b32 v7, v7, v0
 v_and_b32 v7, 15, v7
 v_lshl_add_u32 v10, v7, 4, v10
 v_xor_b32 v11, 128, v10
 s_mov_b32 s8, s26
 s_and_b32 s9, s27, 0xffff
 s_mov_b32 s10, 5242880
 s_mul_i32 s14, s52, 163840
 s_add_u32 s14, s14, 81920
 s_mov_b32 m0, 16384
 s_nop 0
 buffer_load_dwordx4 v8, s[8:11], s14 offen lds
 s_add_u32 s14, s14, 5120
 s_mov_b32 m0, 17408
 s_nop 0
 buffer_load_dwordx4 v8, s[8:11], s14 offen lds
 s_add_u32 s14, s14, 5120
 s_mov_b32 m0, 18432
 s_nop 0
 buffer_load_dwordx4 v8, s[8:11], s14 offen lds
 s_add_u32 s14, s14, 5120
 s_mov_b32 m0, 19456
 s_nop 0
 buffer_load_dwordx4 v8, s[8:11], s14 offen lds
 s_add_u32 s14, s14, 5120
 s_mov_b32 m0, 20480
 s_nop 0
 buffer_load_dwordx4 v9, s[8:11], s14 offen lds
 s_add_u32 s14, s14, 5120
 s_mov_b32 m0, 21504
 s_nop 0
 buffer_load_dwordx4 v9, s[8:11], s14 offen lds
 s_add_u32 s14, s14, 5120
 s_mov_b32 m0, 22528
 s_nop 0
 buffer_load_dwordx4 v9, s[8:11], s14 offen lds
 s_add_u32 s14, s14, 5120
 s_mov_b32 m0, 23552
 s_nop 0
 buffer_load_dwordx4 v9, s[8:11], s14 offen lds
 s_mul_i32 s14, s52, 163840
 s_add_u32 s14, s14, 82176
 s_mov_b32 m0, 49152
 s_nop 0
 buffer_load_dwordx4 v8, s[8:11], s14 offen lds
 s_add_u32 s14, s14, 5120
 s_mov_b32 m0, 50176
 s_nop 0
 buffer_load_dwordx4 v8, s[8:11], s14 offen lds
 s_add_u32 s14, s14, 5120
 s_mov_b32 m0, 51200
 s_nop 0
 buffer_load_dwordx4 v8, s[8:11], s14 offen lds
 s_add_u32 s14, s14, 5120
 s_mov_b32 m0, 52224
 s_nop 0
 buffer_load_dwordx4 v8, s[8:11], s14 offen lds
 s_add_u32 s14, s14, 5120
 s_mov_b32 m0, 53248
 s_nop 0
 buffer_load_dwordx4 v9, s[8:11], s14 offen lds
 s_add_u32 s14, s14, 5120
 s_mov_b32 m0, 54272
 s_nop 0
 buffer_load_dwordx4 v9, s[8:11], s14 offen lds
 s_add_u32 s14, s14, 5120
 s_mov_b32 m0, 55296
 s_nop 0
 buffer_load_dwordx4 v9, s[8:11], s14 offen lds
 s_add_u32 s14, s14, 5120
 s_mov_b32 m0, 56320
 s_nop 0
 buffer_load_dwordx4 v9, s[8:11], s14 offen lds
 s_mul_i32 s14, s52, 163840
 s_add_u32 s14, s14, 82432
 s_mov_b32 m0, 81920
 s_nop 0
 buffer_load_dwordx4 v8, s[8:11], s14 offen lds
 s_add_u32 s14, s14, 5120
 s_mov_b32 m0, 82944
 s_nop 0
 buffer_load_dwordx4 v8, s[8:11], s14 offen lds
 s_add_u32 s14, s14, 5120
 s_mov_b32 m0, 83968
 s_nop 0
 buffer_load_dwordx4 v8, s[8:11], s14 offen lds
 s_add_u32 s14, s14, 5120
 s_mov_b32 m0, 84992
 s_nop 0
 buffer_load_dwordx4 v8, s[8:11], s14 offen lds
 s_add_u32 s14, s14, 5120
 s_mov_b32 m0, 86016
 s_nop 0
 buffer_load_dwordx4 v9, s[8:11], s14 offen lds
 s_add_u32 s14, s14, 5120
 s_mov_b32 m0, 87040
 s_nop 0
 buffer_load_dwordx4 v9, s[8:11], s14 offen lds
 s_add_u32 s14, s14, 5120
 s_mov_b32 m0, 88064
 s_nop 0
 buffer_load_dwordx4 v9, s[8:11], s14 offen lds
 s_add_u32 s14, s14, 5120
 s_mov_b32 m0, 89088
 s_nop 0
 buffer_load_dwordx4 v9, s[8:11], s14 offen lds
 s_mul_i32 s14, s52, 163840
 s_add_u32 s14, s14, 82688
 s_mov_b32 m0, 114688
 s_nop 0
 buffer_load_dwordx4 v8, s[8:11], s14 offen lds
 s_add_u32 s14, s14, 5120
 s_mov_b32 m0, 115712
 s_nop 0
 buffer_load_dwordx4 v8, s[8:11], s14 offen lds
 s_add_u32 s14, s14, 5120
 s_mov_b32 m0, 116736
 s_nop 0
 buffer_load_dwordx4 v8, s[8:11], s14 offen lds
 s_add_u32 s14, s14, 5120
 s_mov_b32 m0, 117760
 s_nop 0
 buffer_load_dwordx4 v8, s[8:11], s14 offen lds
 s_add_u32 s14, s14, 5120
 s_mov_b32 m0, 118784
 s_nop 0
 buffer_load_dwordx4 v9, s[8:11], s14 offen lds
 s_add_u32 s14, s14, 5120
 s_mov_b32 m0, 119808
 s_nop 0
 buffer_load_dwordx4 v9, s[8:11], s14 offen lds
 s_add_u32 s14, s14, 5120
 s_mov_b32 m0, 120832
 s_nop 0
 buffer_load_dwordx4 v9, s[8:11], s14 offen lds
 s_add_u32 s14, s14, 5120
 s_mov_b32 m0, 121856
 s_nop 0
 buffer_load_dwordx4 v9, s[8:11], s14 offen lds
 s_mul_i32 s14, s52, 163840
 s_add_u32 s14, s14, 82944
 s_mov_b32 m0, 147456
 s_nop 0
 buffer_load_dwordx4 v8, s[8:11], s14 offen lds
 s_add_u32 s14, s14, 5120
 s_mov_b32 m0, 148480
 s_nop 0
 buffer_load_dwordx4 v8, s[8:11], s14 offen lds
 s_add_u32 s14, s14, 5120
 s_mov_b32 m0, 149504
 s_nop 0
 buffer_load_dwordx4 v8, s[8:11], s14 offen lds
 s_add_u32 s14, s14, 5120
 s_mov_b32 m0, 150528
 s_nop 0
 buffer_load_dwordx4 v8, s[8:11], s14 offen lds
 s_add_u32 s14, s14, 5120
 s_mov_b32 m0, 151552
 s_nop 0
 buffer_load_dwordx4 v9, s[8:11], s14 offen lds
 s_add_u32 s14, s14, 5120
 s_mov_b32 m0, 152576
 s_nop 0
 buffer_load_dwordx4 v9, s[8:11], s14 offen lds
 s_add_u32 s14, s14, 5120
 s_mov_b32 m0, 153600
 s_nop 0
 buffer_load_dwordx4 v9, s[8:11], s14 offen lds
 s_add_u32 s14, s14, 5120
 s_mov_b32 m0, 154624
 s_nop 0
 buffer_load_dwordx4 v9, s[8:11], s14 offen lds
 v_lshrrev_b32 v20, 4, v0
 v_bfe_u32 v21, v0, 2, 1
 v_bfe_u32 v22, v0, 3, 1
 v_and_b32 v23, 1, v20
 v_lshrrev_b32 v24, 1, v20
 v_and_b32 v25, 3, v0
 v_lshlrev_b32 v25, 3, v25
 v_lshl_add_u32 v26, v22, 1, v23
 v_lshl_add_u32 v27, v21, 2, v26
 v_lshl_add_u32 v26, v24, 2, v26
 v_lshl_add_u32 v26, v21, 4, v26
 v_xor_b32 v27, 4, v27
 v_lshl_add_u32 v27, v27, 5, v25
 v_lshl_add_u32 v12, v26, 8, v27
 v_lshl_add_u32 v26, v24, 2, v21
 v_lshl_add_u32 v26, v23, 4, v26
 v_lshl_add_u32 v27, v23, 2, v21
 v_lshl_add_u32 v27, v22, 1, v27
 v_lshl_add_u32 v27, v27, 5, v25
 v_lshl_add_u32 v14, v26, 8, v27
 v_lshlrev_b32 v1, 4, v0
 v_add_u32 v2, 65536, v1
 v_add_u32 v3, 114688, v1
 s_waitcnt vmcnt(32)
 s_barrier
 s_waitcnt lgkmcnt(0)
 s_barrier
 s_mov_b32 s8, s24
 s_and_b32 s9, s25, 0xffff
 s_mov_b32 s10, 5242880
 s_lshl_b32 s14, s52, 8
 s_add_u32 s14, s14, 524288
 s_mov_b32 m0, 16384
 s_nop 0
 buffer_load_dwordx4 v10, s[8:11], s14 offen lds
 s_add_u32 s14, s14, 32768
 s_mov_b32 m0, 17408
 s_nop 0
 buffer_load_dwordx4 v10, s[8:11], s14 offen lds
 s_add_u32 s14, s14, 32768
 s_mov_b32 m0, 18432
 s_nop 0
 buffer_load_dwordx4 v10, s[8:11], s14 offen lds
 s_add_u32 s14, s14, 32768
 s_mov_b32 m0, 19456
 s_nop 0
 buffer_load_dwordx4 v10, s[8:11], s14 offen lds
 s_add_u32 s14, s14, 32768
 s_mov_b32 m0, 20480
 s_nop 0
 buffer_load_dwordx4 v11, s[8:11], s14 offen lds
 s_add_u32 s14, s14, 32768
 s_mov_b32 m0, 21504
 s_nop 0
 buffer_load_dwordx4 v11, s[8:11], s14 offen lds
 s_add_u32 s14, s14, 32768
 s_mov_b32 m0, 22528
 s_nop 0
 buffer_load_dwordx4 v11, s[8:11], s14 offen lds
 s_add_u32 s14, s14, 32768
 s_mov_b32 m0, 23552
 s_nop 0
 buffer_load_dwordx4 v11, s[8:11], s14 offen lds
 s_waitcnt vmcnt(32)
 s_barrier
 s_waitcnt lgkmcnt(0)
 s_barrier
 s_lshl_b32 s14, s52, 8
 s_add_u32 s14, s14, 1572864
 s_mov_b32 m0, 49152
 s_nop 0
 buffer_load_dwordx4 v10, s[8:11], s14 offen lds
 s_add_u32 s14, s14, 32768
 s_mov_b32 m0, 50176
 s_nop 0
 buffer_load_dwordx4 v10, s[8:11], s14 offen lds
 s_add_u32 s14, s14, 32768
 s_mov_b32 m0, 51200
 s_nop 0
 buffer_load_dwordx4 v10, s[8:11], s14 offen lds
 s_add_u32 s14, s14, 32768
 s_mov_b32 m0, 52224
 s_nop 0
 buffer_load_dwordx4 v10, s[8:11], s14 offen lds
 s_add_u32 s14, s14, 32768
 s_mov_b32 m0, 53248
 s_nop 0
 buffer_load_dwordx4 v11, s[8:11], s14 offen lds
 s_add_u32 s14, s14, 32768
 s_mov_b32 m0, 54272
 s_nop 0
 buffer_load_dwordx4 v11, s[8:11], s14 offen lds
 s_add_u32 s14, s14, 32768
 s_mov_b32 m0, 55296
 s_nop 0
 buffer_load_dwordx4 v11, s[8:11], s14 offen lds
 s_add_u32 s14, s14, 32768
 s_mov_b32 m0, 56320
 s_nop 0
 buffer_load_dwordx4 v11, s[8:11], s14 offen lds
 s_waitcnt vmcnt(32)
 s_barrier
 v_xor_b32 v16, 0, v14
 v_add_u32 v16, 65536, v16
 v_xor_b32 v17, 64, v16
 ds_read_b64_tr_b16 a[0:1], v16 offset:0
 ds_read_b64_tr_b16 a[2:3], v17 offset:512
 ds_read_b64_tr_b16 a[4:5], v16 offset:2048
 ds_read_b64_tr_b16 a[6:7], v17 offset:2560
 v_xor_b32 v16, 0, v14
 v_add_u32 v16, 65536, v16
 v_xor_b32 v17, 64, v16
 ds_read_b64_tr_b16 a[8:9], v16 offset:8192
 ds_read_b64_tr_b16 a[10:11], v17 offset:8704
 ds_read_b64_tr_b16 a[12:13], v16 offset:10240
 ds_read_b64_tr_b16 a[14:15], v17 offset:10752
 v_xor_b32 v16, 0, v14
 v_add_u32 v16, 65536, v16
 v_xor_b32 v17, 64, v16
 ds_read_b64_tr_b16 a[16:17], v16 offset:16384
 ds_read_b64_tr_b16 a[18:19], v17 offset:16896
 ds_read_b64_tr_b16 a[20:21], v16 offset:18432
 ds_read_b64_tr_b16 a[22:23], v17 offset:18944
 v_xor_b32 v16, 0, v14
 v_add_u32 v16, 65536, v16
 v_xor_b32 v17, 64, v16
 ds_read_b64_tr_b16 a[24:25], v16 offset:24576
 ds_read_b64_tr_b16 a[26:27], v17 offset:25088
 ds_read_b64_tr_b16 a[28:29], v16 offset:26624
 ds_read_b64_tr_b16 a[30:31], v17 offset:27136
 v_xor_b32 v16, 32, v14
 v_add_u32 v16, 65536, v16
 v_xor_b32 v17, 64, v16
 ds_read_b64_tr_b16 a[32:33], v16 offset:0
 ds_read_b64_tr_b16 a[34:35], v17 offset:512
 ds_read_b64_tr_b16 a[36:37], v16 offset:2048
 ds_read_b64_tr_b16 a[38:39], v17 offset:2560
 v_xor_b32 v16, 32, v14
 v_add_u32 v16, 65536, v16
 v_xor_b32 v17, 64, v16
 ds_read_b64_tr_b16 a[40:41], v16 offset:8192
 ds_read_b64_tr_b16 a[42:43], v17 offset:8704
 ds_read_b64_tr_b16 a[44:45], v16 offset:10240
 ds_read_b64_tr_b16 a[46:47], v17 offset:10752
 v_xor_b32 v16, 32, v14
 v_add_u32 v16, 65536, v16
 v_xor_b32 v17, 64, v16
 ds_read_b64_tr_b16 a[48:49], v16 offset:16384
 ds_read_b64_tr_b16 a[50:51], v17 offset:16896
 ds_read_b64_tr_b16 a[52:53], v16 offset:18432
 ds_read_b64_tr_b16 a[54:55], v17 offset:18944
 v_xor_b32 v16, 32, v14
 v_add_u32 v16, 65536, v16
 v_xor_b32 v17, 64, v16
 ds_read_b64_tr_b16 a[56:57], v16 offset:24576
 ds_read_b64_tr_b16 a[58:59], v17 offset:25088
 ds_read_b64_tr_b16 a[60:61], v16 offset:26624
 ds_read_b64_tr_b16 a[62:63], v17 offset:27136
 v_xor_b32 v16, 128, v14
 v_add_u32 v16, 65536, v16
 v_xor_b32 v17, 64, v16
 ds_read_b64_tr_b16 a[64:65], v16 offset:0
 ds_read_b64_tr_b16 a[66:67], v17 offset:512
 ds_read_b64_tr_b16 a[68:69], v16 offset:2048
 ds_read_b64_tr_b16 a[70:71], v17 offset:2560
 v_xor_b32 v16, 128, v14
 v_add_u32 v16, 65536, v16
 v_xor_b32 v17, 64, v16
 ds_read_b64_tr_b16 a[72:73], v16 offset:8192
 ds_read_b64_tr_b16 a[74:75], v17 offset:8704
 ds_read_b64_tr_b16 a[76:77], v16 offset:10240
 ds_read_b64_tr_b16 a[78:79], v17 offset:10752
 v_xor_b32 v16, 128, v14
 v_add_u32 v16, 65536, v16
 v_xor_b32 v17, 64, v16
 ds_read_b64_tr_b16 a[80:81], v16 offset:16384
 ds_read_b64_tr_b16 a[82:83], v17 offset:16896
 ds_read_b64_tr_b16 a[84:85], v16 offset:18432
 ds_read_b64_tr_b16 a[86:87], v17 offset:18944
 v_xor_b32 v16, 128, v14
 v_add_u32 v16, 65536, v16
 v_xor_b32 v17, 64, v16
 ds_read_b64_tr_b16 a[88:89], v16 offset:24576
 ds_read_b64_tr_b16 a[90:91], v17 offset:25088
 ds_read_b64_tr_b16 a[92:93], v16 offset:26624
 ds_read_b64_tr_b16 a[94:95], v17 offset:27136
 v_xor_b32 v16, 160, v14
 v_add_u32 v16, 65536, v16
 v_xor_b32 v17, 64, v16
 ds_read_b64_tr_b16 a[96:97], v16 offset:0
 ds_read_b64_tr_b16 a[98:99], v17 offset:512
 ds_read_b64_tr_b16 a[100:101], v16 offset:2048
 ds_read_b64_tr_b16 a[102:103], v17 offset:2560
 v_xor_b32 v16, 160, v14
 v_add_u32 v16, 65536, v16
 v_xor_b32 v17, 64, v16
 ds_read_b64_tr_b16 a[104:105], v16 offset:8192
 ds_read_b64_tr_b16 a[106:107], v17 offset:8704
 ds_read_b64_tr_b16 a[108:109], v16 offset:10240
 ds_read_b64_tr_b16 a[110:111], v17 offset:10752
 v_xor_b32 v16, 160, v14
 v_add_u32 v16, 65536, v16
 v_xor_b32 v17, 64, v16
 ds_read_b64_tr_b16 a[112:113], v16 offset:16384
 ds_read_b64_tr_b16 a[114:115], v17 offset:16896
 ds_read_b64_tr_b16 a[116:117], v16 offset:18432
 ds_read_b64_tr_b16 a[118:119], v17 offset:18944
 v_xor_b32 v16, 160, v14
 v_add_u32 v16, 65536, v16
 v_xor_b32 v17, 64, v16
 ds_read_b64_tr_b16 a[120:121], v16 offset:24576
 ds_read_b64_tr_b16 a[122:123], v17 offset:25088
 ds_read_b64_tr_b16 a[124:125], v16 offset:26624
 ds_read_b64_tr_b16 a[126:127], v17 offset:27136
 s_waitcnt lgkmcnt(0)
 s_barrier
 s_lshl_b32 s14, s52, 8
 s_add_u32 s14, s14, 2621440
 s_mov_b32 m0, 81920
 s_nop 0
 buffer_load_dwordx4 v10, s[8:11], s14 offen lds
 s_add_u32 s14, s14, 32768
 s_mov_b32 m0, 82944
 s_nop 0
 buffer_load_dwordx4 v10, s[8:11], s14 offen lds
 s_add_u32 s14, s14, 32768
 s_mov_b32 m0, 83968
 s_nop 0
 buffer_load_dwordx4 v10, s[8:11], s14 offen lds
 s_add_u32 s14, s14, 32768
 s_mov_b32 m0, 84992
 s_nop 0
 buffer_load_dwordx4 v10, s[8:11], s14 offen lds
 s_add_u32 s14, s14, 32768
 s_mov_b32 m0, 86016
 s_nop 0
 buffer_load_dwordx4 v11, s[8:11], s14 offen lds
 s_add_u32 s14, s14, 32768
 s_mov_b32 m0, 87040
 s_nop 0
 buffer_load_dwordx4 v11, s[8:11], s14 offen lds
 s_add_u32 s14, s14, 32768
 s_mov_b32 m0, 88064
 s_nop 0
 buffer_load_dwordx4 v11, s[8:11], s14 offen lds
 s_add_u32 s14, s14, 32768
 s_mov_b32 m0, 89088
 s_nop 0
 buffer_load_dwordx4 v11, s[8:11], s14 offen lds
 s_waitcnt vmcnt(32)
 s_barrier
 s_waitcnt lgkmcnt(0)
 s_barrier
 s_lshl_b32 s14, s52, 8
 s_add_u32 s14, s14, 3670016
 s_mov_b32 m0, 114688
 s_nop 0
 buffer_load_dwordx4 v10, s[8:11], s14 offen lds
 s_add_u32 s14, s14, 32768
 s_mov_b32 m0, 115712
 s_nop 0
 buffer_load_dwordx4 v10, s[8:11], s14 offen lds
 s_add_u32 s14, s14, 32768
 s_mov_b32 m0, 116736
 s_nop 0
 buffer_load_dwordx4 v10, s[8:11], s14 offen lds
 s_add_u32 s14, s14, 32768
 s_mov_b32 m0, 117760
 s_nop 0
 buffer_load_dwordx4 v10, s[8:11], s14 offen lds
 s_add_u32 s14, s14, 32768
 s_mov_b32 m0, 118784
 s_nop 0
 buffer_load_dwordx4 v11, s[8:11], s14 offen lds
 s_add_u32 s14, s14, 32768
 s_mov_b32 m0, 119808
 s_nop 0
 buffer_load_dwordx4 v11, s[8:11], s14 offen lds
 s_add_u32 s14, s14, 32768
 s_mov_b32 m0, 120832
 s_nop 0
 buffer_load_dwordx4 v11, s[8:11], s14 offen lds
 s_add_u32 s14, s14, 32768
 s_mov_b32 m0, 121856
 s_nop 0
 buffer_load_dwordx4 v11, s[8:11], s14 offen lds
 s_waitcnt vmcnt(32)
 s_barrier
 v_xor_b32 v16, 128, v14
 v_add_u32 v16, 131072, v16
 v_xor_b32 v17, 64, v16
 ds_read_b64_tr_b16 a[128:129], v16 offset:0
 ds_read_b64_tr_b16 a[130:131], v17 offset:512
 ds_read_b64_tr_b16 a[132:133], v16 offset:2048
 ds_read_b64_tr_b16 a[134:135], v17 offset:2560
 v_xor_b32 v16, 128, v14
 v_add_u32 v16, 131072, v16
 v_xor_b32 v17, 64, v16
 ds_read_b64_tr_b16 a[136:137], v16 offset:8192
 ds_read_b64_tr_b16 a[138:139], v17 offset:8704
 ds_read_b64_tr_b16 a[140:141], v16 offset:10240
 ds_read_b64_tr_b16 a[142:143], v17 offset:10752
 v_xor_b32 v16, 128, v14
 v_add_u32 v16, 131072, v16
 v_xor_b32 v17, 64, v16
 ds_read_b64_tr_b16 a[144:145], v16 offset:16384
 ds_read_b64_tr_b16 a[146:147], v17 offset:16896
 ds_read_b64_tr_b16 a[148:149], v16 offset:18432
 ds_read_b64_tr_b16 a[150:151], v17 offset:18944
 v_xor_b32 v16, 128, v14
 v_add_u32 v16, 131072, v16
 v_xor_b32 v17, 64, v16
 ds_read_b64_tr_b16 a[152:153], v16 offset:24576
 ds_read_b64_tr_b16 a[154:155], v17 offset:25088
 ds_read_b64_tr_b16 a[156:157], v16 offset:26624
 ds_read_b64_tr_b16 a[158:159], v17 offset:27136
 s_waitcnt lgkmcnt(0)
 s_barrier
 s_lshl_b32 s14, s52, 8
 s_add_u32 s14, s14, 4718592
 s_mov_b32 m0, 147456
 s_nop 0
 buffer_load_dwordx4 v10, s[8:11], s14 offen lds
 s_add_u32 s14, s14, 32768
 s_mov_b32 m0, 148480
 s_nop 0
 buffer_load_dwordx4 v10, s[8:11], s14 offen lds
 s_add_u32 s14, s14, 32768
 s_mov_b32 m0, 149504
 s_nop 0
 buffer_load_dwordx4 v10, s[8:11], s14 offen lds
 s_add_u32 s14, s14, 32768
 s_mov_b32 m0, 150528
 s_nop 0
 buffer_load_dwordx4 v10, s[8:11], s14 offen lds
 s_add_u32 s14, s14, 32768
 s_mov_b32 m0, 151552
 s_nop 0
 buffer_load_dwordx4 v11, s[8:11], s14 offen lds
 s_add_u32 s14, s14, 32768
 s_mov_b32 m0, 152576
 s_nop 0
 buffer_load_dwordx4 v11, s[8:11], s14 offen lds
 s_add_u32 s14, s14, 32768
 s_mov_b32 m0, 153600
 s_nop 0
 buffer_load_dwordx4 v11, s[8:11], s14 offen lds
 s_add_u32 s14, s14, 32768
 s_mov_b32 m0, 154624
 s_nop 0
 buffer_load_dwordx4 v11, s[8:11], s14 offen lds
 s_waitcnt vmcnt(32)
 s_barrier
 v_xor_b32 v16, 0, v12
 v_add_u32 v16, 0, v16
 ds_read_b64_tr_b16 a[160:161], v16 offset:0
 ds_read_b64_tr_b16 a[162:163], v16 offset:8192
 ds_read_b64_tr_b16 a[164:165], v16 offset:2048
 ds_read_b64_tr_b16 a[166:167], v16 offset:10240
 v_xor_b32 v16, 32, v12
 v_add_u32 v16, 0, v16
 ds_read_b64_tr_b16 a[168:169], v16 offset:0
 ds_read_b64_tr_b16 a[170:171], v16 offset:8192
 ds_read_b64_tr_b16 a[172:173], v16 offset:2048
 ds_read_b64_tr_b16 a[174:175], v16 offset:10240
 v_xor_b32 v16, 0, v12
 v_add_u32 v16, 0, v16
 ds_read_b64_tr_b16 a[176:177], v16 offset:16384
 ds_read_b64_tr_b16 a[178:179], v16 offset:24576
 ds_read_b64_tr_b16 a[180:181], v16 offset:18432
 ds_read_b64_tr_b16 a[182:183], v16 offset:26624
 v_xor_b32 v16, 32, v12
 v_add_u32 v16, 0, v16
 ds_read_b64_tr_b16 a[184:185], v16 offset:16384
 ds_read_b64_tr_b16 a[186:187], v16 offset:24576
 ds_read_b64_tr_b16 a[188:189], v16 offset:18432
 ds_read_b64_tr_b16 a[190:191], v16 offset:26624
 s_waitcnt lgkmcnt(0)
 s_barrier
 s_mov_b32 s8, s22
 s_and_b32 s9, s23, 0xffff
 s_mov_b32 s10, 5242880
 s_lshl_b32 s14, s52, 8
 s_add_u32 s14, s14, 524288
 s_mov_b32 m0, 16384
 s_nop 0
 buffer_load_dwordx4 v10, s[8:11], s14 offen lds
 s_add_u32 s14, s14, 32768
 s_mov_b32 m0, 17408
 s_nop 0
 buffer_load_dwordx4 v10, s[8:11], s14 offen lds
 s_add_u32 s14, s14, 32768
 s_mov_b32 m0, 18432
 s_nop 0
 buffer_load_dwordx4 v10, s[8:11], s14 offen lds
 s_add_u32 s14, s14, 32768
 s_mov_b32 m0, 19456
 s_nop 0
 buffer_load_dwordx4 v10, s[8:11], s14 offen lds
 s_add_u32 s14, s14, 32768
 s_mov_b32 m0, 20480
 s_nop 0
 buffer_load_dwordx4 v11, s[8:11], s14 offen lds
 s_add_u32 s14, s14, 32768
 s_mov_b32 m0, 21504
 s_nop 0
 buffer_load_dwordx4 v11, s[8:11], s14 offen lds
 s_add_u32 s14, s14, 32768
 s_mov_b32 m0, 22528
 s_nop 0
 buffer_load_dwordx4 v11, s[8:11], s14 offen lds
 s_add_u32 s14, s14, 32768
 s_mov_b32 m0, 23552
 s_nop 0
 buffer_load_dwordx4 v11, s[8:11], s14 offen lds
 s_waitcnt vmcnt(32)
 s_barrier
 v_xor_b32 v16, 0, v12
 v_add_u32 v16, 32768, v16
 ds_read_b64_tr_b16 a[192:193], v16 offset:0
 ds_read_b64_tr_b16 a[194:195], v16 offset:8192
 ds_read_b64_tr_b16 a[196:197], v16 offset:2048
 ds_read_b64_tr_b16 a[198:199], v16 offset:10240
 v_xor_b32 v16, 32, v12
 v_add_u32 v16, 32768, v16
 ds_read_b64_tr_b16 a[200:201], v16 offset:0
 ds_read_b64_tr_b16 a[202:203], v16 offset:8192
 ds_read_b64_tr_b16 a[204:205], v16 offset:2048
 ds_read_b64_tr_b16 a[206:207], v16 offset:10240
 v_xor_b32 v16, 0, v12
 v_add_u32 v16, 32768, v16
 ds_read_b64_tr_b16 a[208:209], v16 offset:16384
 ds_read_b64_tr_b16 a[210:211], v16 offset:24576
 ds_read_b64_tr_b16 a[212:213], v16 offset:18432
 ds_read_b64_tr_b16 a[214:215], v16 offset:26624
 v_xor_b32 v16, 32, v12
 v_add_u32 v16, 32768, v16
 ds_read_b64_tr_b16 a[216:217], v16 offset:16384
 ds_read_b64_tr_b16 a[218:219], v16 offset:24576
 ds_read_b64_tr_b16 a[220:221], v16 offset:18432
 ds_read_b64_tr_b16 a[222:223], v16 offset:26624
 s_waitcnt lgkmcnt(0)
 s_barrier
 s_lshl_b32 s14, s52, 8
 s_add_u32 s14, s14, 1572864
 s_mov_b32 m0, 49152
 s_nop 0
 buffer_load_dwordx4 v10, s[8:11], s14 offen lds
 s_add_u32 s14, s14, 32768
 s_mov_b32 m0, 50176
 s_nop 0
 buffer_load_dwordx4 v10, s[8:11], s14 offen lds
 s_add_u32 s14, s14, 32768
 s_mov_b32 m0, 51200
 s_nop 0
 buffer_load_dwordx4 v10, s[8:11], s14 offen lds
 s_add_u32 s14, s14, 32768
 s_mov_b32 m0, 52224
 s_nop 0
 buffer_load_dwordx4 v10, s[8:11], s14 offen lds
 s_add_u32 s14, s14, 32768
 s_mov_b32 m0, 53248
 s_nop 0
 buffer_load_dwordx4 v11, s[8:11], s14 offen lds
 s_add_u32 s14, s14, 32768
 s_mov_b32 m0, 54272
 s_nop 0
 buffer_load_dwordx4 v11, s[8:11], s14 offen lds
 s_add_u32 s14, s14, 32768
 s_mov_b32 m0, 55296
 s_nop 0
 buffer_load_dwordx4 v11, s[8:11], s14 offen lds
 s_add_u32 s14, s14, 32768
 s_mov_b32 m0, 56320
 s_nop 0
 buffer_load_dwordx4 v11, s[8:11], s14 offen lds
 s_waitcnt vmcnt(32)
 s_barrier
 v_xor_b32 v16, 0, v12
 v_add_u32 v16, 65536, v16
 ds_read_b64_tr_b16 a[224:225], v16 offset:0
 ds_read_b64_tr_b16 a[226:227], v16 offset:8192
 ds_read_b64_tr_b16 a[228:229], v16 offset:2048
 ds_read_b64_tr_b16 a[230:231], v16 offset:10240
 v_xor_b32 v16, 32, v12
 v_add_u32 v16, 65536, v16
 ds_read_b64_tr_b16 a[232:233], v16 offset:0
 ds_read_b64_tr_b16 a[234:235], v16 offset:8192
 ds_read_b64_tr_b16 a[236:237], v16 offset:2048
 ds_read_b64_tr_b16 a[238:239], v16 offset:10240
 v_xor_b32 v16, 0, v12
 v_add_u32 v16, 65536, v16
 ds_read_b64_tr_b16 a[240:241], v16 offset:16384
 ds_read_b64_tr_b16 a[242:243], v16 offset:24576
 ds_read_b64_tr_b16 a[244:245], v16 offset:18432
 ds_read_b64_tr_b16 a[246:247], v16 offset:26624
 v_xor_b32 v16, 32, v12
 v_add_u32 v16, 65536, v16
 ds_read_b64_tr_b16 a[248:249], v16 offset:16384
 ds_read_b64_tr_b16 a[250:251], v16 offset:24576
 ds_read_b64_tr_b16 a[252:253], v16 offset:18432
 ds_read_b64_tr_b16 a[254:255], v16 offset:26624
 s_waitcnt lgkmcnt(0)
 s_barrier
 s_lshl_b32 s14, s52, 8
 s_add_u32 s14, s14, 2621440
 s_mov_b32 m0, 81920
 s_nop 0
 buffer_load_dwordx4 v10, s[8:11], s14 offen lds
 s_add_u32 s14, s14, 32768
 s_mov_b32 m0, 82944
 s_nop 0
 buffer_load_dwordx4 v10, s[8:11], s14 offen lds
 s_add_u32 s14, s14, 32768
 s_mov_b32 m0, 83968
 s_nop 0
 buffer_load_dwordx4 v10, s[8:11], s14 offen lds
 s_add_u32 s14, s14, 32768
 s_mov_b32 m0, 84992
 s_nop 0
 buffer_load_dwordx4 v10, s[8:11], s14 offen lds
 s_add_u32 s14, s14, 32768
 s_mov_b32 m0, 86016
 s_nop 0
 buffer_load_dwordx4 v11, s[8:11], s14 offen lds
 s_add_u32 s14, s14, 32768
 s_mov_b32 m0, 87040
 s_nop 0
 buffer_load_dwordx4 v11, s[8:11], s14 offen lds
 s_add_u32 s14, s14, 32768
 s_mov_b32 m0, 88064
 s_nop 0
 buffer_load_dwordx4 v11, s[8:11], s14 offen lds
 s_add_u32 s14, s14, 32768
 s_mov_b32 m0, 89088
 s_nop 0
 buffer_load_dwordx4 v11, s[8:11], s14 offen lds
 s_waitcnt vmcnt(32)
 s_barrier
 v_xor_b32 v16, 0, v12
 v_add_u32 v16, 98304, v16
 ds_read_b64_tr_b16 v[64:65], v16 offset:0
 ds_read_b64_tr_b16 v[66:67], v16 offset:8192
 ds_read_b64_tr_b16 v[68:69], v16 offset:2048
 ds_read_b64_tr_b16 v[70:71], v16 offset:10240
 v_xor_b32 v16, 32, v12
 v_add_u32 v16, 98304, v16
 ds_read_b64_tr_b16 v[72:73], v16 offset:0
 ds_read_b64_tr_b16 v[74:75], v16 offset:8192
 ds_read_b64_tr_b16 v[76:77], v16 offset:2048
 ds_read_b64_tr_b16 v[78:79], v16 offset:10240
 v_xor_b32 v16, 0, v12
 v_add_u32 v16, 98304, v16
 ds_read_b64_tr_b16 v[80:81], v16 offset:16384
 ds_read_b64_tr_b16 v[82:83], v16 offset:24576
 ds_read_b64_tr_b16 v[84:85], v16 offset:18432
 ds_read_b64_tr_b16 v[86:87], v16 offset:26624
 v_xor_b32 v16, 32, v12
 v_add_u32 v16, 98304, v16
 ds_read_b64_tr_b16 v[88:89], v16 offset:16384
 ds_read_b64_tr_b16 v[90:91], v16 offset:24576
 ds_read_b64_tr_b16 v[92:93], v16 offset:18432
 ds_read_b64_tr_b16 v[94:95], v16 offset:26624
 s_waitcnt lgkmcnt(0)
 s_barrier
 s_lshl_b32 s14, s52, 8
 s_add_u32 s14, s14, 3670016
 s_mov_b32 m0, 114688
 s_nop 0
 buffer_load_dwordx4 v10, s[8:11], s14 offen lds
 s_add_u32 s14, s14, 32768
 s_mov_b32 m0, 115712
 s_nop 0
 buffer_load_dwordx4 v10, s[8:11], s14 offen lds
 s_add_u32 s14, s14, 32768
 s_mov_b32 m0, 116736
 s_nop 0
 buffer_load_dwordx4 v10, s[8:11], s14 offen lds
 s_add_u32 s14, s14, 32768
 s_mov_b32 m0, 117760
 s_nop 0
 buffer_load_dwordx4 v10, s[8:11], s14 offen lds
 s_add_u32 s14, s14, 32768
 s_mov_b32 m0, 118784
 s_nop 0
 buffer_load_dwordx4 v11, s[8:11], s14 offen lds
 s_add_u32 s14, s14, 32768
 s_mov_b32 m0, 119808
 s_nop 0
 buffer_load_dwordx4 v11, s[8:11], s14 offen lds
 s_add_u32 s14, s14, 32768
 s_mov_b32 m0, 120832
 s_nop 0
 buffer_load_dwordx4 v11, s[8:11], s14 offen lds
 s_add_u32 s14, s14, 32768
 s_mov_b32 m0, 121856
 s_nop 0
 buffer_load_dwordx4 v11, s[8:11], s14 offen lds
 s_waitcnt vmcnt(32)
 s_barrier
 v_xor_b32 v16, 0, v12
 v_add_u32 v16, 131072, v16
 ds_read_b64_tr_b16 v[96:97], v16 offset:0
 ds_read_b64_tr_b16 v[98:99], v16 offset:8192
 ds_read_b64_tr_b16 v[100:101], v16 offset:2048
 ds_read_b64_tr_b16 v[102:103], v16 offset:10240
 v_xor_b32 v16, 32, v12
 v_add_u32 v16, 131072, v16
 ds_read_b64_tr_b16 v[104:105], v16 offset:0
 ds_read_b64_tr_b16 v[106:107], v16 offset:8192
 ds_read_b64_tr_b16 v[108:109], v16 offset:2048
 ds_read_b64_tr_b16 v[110:111], v16 offset:10240
 v_xor_b32 v16, 0, v12
 v_add_u32 v16, 131072, v16
 ds_read_b64_tr_b16 v[112:113], v16 offset:16384
 ds_read_b64_tr_b16 v[114:115], v16 offset:24576
 ds_read_b64_tr_b16 v[116:117], v16 offset:18432
 ds_read_b64_tr_b16 v[118:119], v16 offset:26624
 v_xor_b32 v16, 32, v12
 v_add_u32 v16, 131072, v16
 ds_read_b64_tr_b16 v[120:121], v16 offset:16384
 ds_read_b64_tr_b16 v[122:123], v16 offset:24576
 ds_read_b64_tr_b16 v[124:125], v16 offset:18432
 ds_read_b64_tr_b16 v[126:127], v16 offset:26624
 s_waitcnt lgkmcnt(0)
 s_barrier
 s_lshl_b32 s14, s52, 8
 s_add_u32 s14, s14, 4718592
 s_mov_b32 m0, 147456
 s_nop 0
 buffer_load_dwordx4 v10, s[8:11], s14 offen lds
 s_add_u32 s14, s14, 32768
 s_mov_b32 m0, 148480
 s_nop 0
 buffer_load_dwordx4 v10, s[8:11], s14 offen lds
 s_add_u32 s14, s14, 32768
 s_mov_b32 m0, 149504
 s_nop 0
 buffer_load_dwordx4 v10, s[8:11], s14 offen lds
 s_add_u32 s14, s14, 32768
 s_mov_b32 m0, 150528
 s_nop 0
 buffer_load_dwordx4 v10, s[8:11], s14 offen lds
 s_add_u32 s14, s14, 32768
 s_mov_b32 m0, 151552
 s_nop 0
 buffer_load_dwordx4 v11, s[8:11], s14 offen lds
 s_add_u32 s14, s14, 32768
 s_mov_b32 m0, 152576
 s_nop 0
 buffer_load_dwordx4 v11, s[8:11], s14 offen lds
 s_add_u32 s14, s14, 32768
 s_mov_b32 m0, 153600
 s_nop 0
 buffer_load_dwordx4 v11, s[8:11], s14 offen lds
 s_add_u32 s14, s14, 32768
 s_mov_b32 m0, 154624
 s_nop 0
 buffer_load_dwordx4 v11, s[8:11], s14 offen lds
 s_waitcnt vmcnt(32)
 s_barrier
 v_xor_b32 v16, 0, v12
 v_add_u32 v16, 0, v16
 ds_read_b64_tr_b16 v[128:129], v16 offset:0
 ds_read_b64_tr_b16 v[130:131], v16 offset:8192
 ds_read_b64_tr_b16 v[132:133], v16 offset:2048
 ds_read_b64_tr_b16 v[134:135], v16 offset:10240
 v_xor_b32 v16, 32, v12
 v_add_u32 v16, 0, v16
 ds_read_b64_tr_b16 v[136:137], v16 offset:0
 ds_read_b64_tr_b16 v[138:139], v16 offset:8192
 ds_read_b64_tr_b16 v[140:141], v16 offset:2048
 ds_read_b64_tr_b16 v[142:143], v16 offset:10240
 v_xor_b32 v16, 0, v12
 v_add_u32 v16, 0, v16
 ds_read_b64_tr_b16 v[144:145], v16 offset:16384
 ds_read_b64_tr_b16 v[146:147], v16 offset:24576
 ds_read_b64_tr_b16 v[148:149], v16 offset:18432
 ds_read_b64_tr_b16 v[150:151], v16 offset:26624
 v_xor_b32 v16, 32, v12
 v_add_u32 v16, 0, v16
 ds_read_b64_tr_b16 v[152:153], v16 offset:16384
 ds_read_b64_tr_b16 v[154:155], v16 offset:24576
 ds_read_b64_tr_b16 v[156:157], v16 offset:18432
 ds_read_b64_tr_b16 v[158:159], v16 offset:26624
 s_waitcnt lgkmcnt(0)
 s_barrier
 s_mov_b32 s8, s20
 s_and_b32 s9, s21, 0xffff
 s_mov_b32 s10, 5242880
 s_lshl_b32 s14, s52, 8
 s_add_u32 s14, s14, 524288
 s_mov_b32 m0, 16384
 s_nop 0
 buffer_load_dwordx4 v10, s[8:11], s14 offen lds
 s_add_u32 s14, s14, 32768
 s_mov_b32 m0, 17408
 s_nop 0
 buffer_load_dwordx4 v10, s[8:11], s14 offen lds
 s_add_u32 s14, s14, 32768
 s_mov_b32 m0, 18432
 s_nop 0
 buffer_load_dwordx4 v10, s[8:11], s14 offen lds
 s_add_u32 s14, s14, 32768
 s_mov_b32 m0, 19456
 s_nop 0
 buffer_load_dwordx4 v10, s[8:11], s14 offen lds
 s_add_u32 s14, s14, 32768
 s_mov_b32 m0, 20480
 s_nop 0
 buffer_load_dwordx4 v11, s[8:11], s14 offen lds
 s_add_u32 s14, s14, 32768
 s_mov_b32 m0, 21504
 s_nop 0
 buffer_load_dwordx4 v11, s[8:11], s14 offen lds
 s_add_u32 s14, s14, 32768
 s_mov_b32 m0, 22528
 s_nop 0
 buffer_load_dwordx4 v11, s[8:11], s14 offen lds
 s_add_u32 s14, s14, 32768
 s_mov_b32 m0, 23552
 s_nop 0
 buffer_load_dwordx4 v11, s[8:11], s14 offen lds
 s_waitcnt vmcnt(32)
 s_barrier
 v_xor_b32 v16, 0, v12
 v_add_u32 v16, 32768, v16
 ds_read_b64_tr_b16 v[160:161], v16 offset:0
 ds_read_b64_tr_b16 v[162:163], v16 offset:8192
 ds_read_b64_tr_b16 v[164:165], v16 offset:2048
 ds_read_b64_tr_b16 v[166:167], v16 offset:10240
 v_xor_b32 v16, 32, v12
 v_add_u32 v16, 32768, v16
 ds_read_b64_tr_b16 v[168:169], v16 offset:0
 ds_read_b64_tr_b16 v[170:171], v16 offset:8192
 ds_read_b64_tr_b16 v[172:173], v16 offset:2048
 ds_read_b64_tr_b16 v[174:175], v16 offset:10240
 v_xor_b32 v16, 0, v12
 v_add_u32 v16, 32768, v16
 ds_read_b64_tr_b16 v[176:177], v16 offset:16384
 ds_read_b64_tr_b16 v[178:179], v16 offset:24576
 ds_read_b64_tr_b16 v[180:181], v16 offset:18432
 ds_read_b64_tr_b16 v[182:183], v16 offset:26624
 v_xor_b32 v16, 32, v12
 v_add_u32 v16, 32768, v16
 ds_read_b64_tr_b16 v[32:33], v16 offset:16384
 ds_read_b64_tr_b16 v[34:35], v16 offset:24576
 ds_read_b64_tr_b16 v[36:37], v16 offset:18432
 ds_read_b64_tr_b16 v[38:39], v16 offset:26624
 s_add_u32 s3, s63, 0
 s_waitcnt lgkmcnt(2)
 buffer_store_dwordx4 v[32:35], v1, s[4:7], s3 offen offset:0
 s_waitcnt lgkmcnt(0)
 buffer_store_dwordx4 v[36:39], v1, s[4:7], s3 offen offset:1024
 s_waitcnt lgkmcnt(0)
 s_barrier
 s_lshl_b32 s14, s52, 8
 s_add_u32 s14, s14, 1572864
 s_mov_b32 m0, 49152
 s_nop 0
 buffer_load_dwordx4 v10, s[8:11], s14 offen lds
 s_add_u32 s14, s14, 32768
 s_mov_b32 m0, 50176
 s_nop 0
 buffer_load_dwordx4 v10, s[8:11], s14 offen lds
 s_add_u32 s14, s14, 32768
 s_mov_b32 m0, 51200
 s_nop 0
 buffer_load_dwordx4 v10, s[8:11], s14 offen lds
 s_add_u32 s14, s14, 32768
 s_mov_b32 m0, 52224
 s_nop 0
 buffer_load_dwordx4 v10, s[8:11], s14 offen lds
 s_add_u32 s14, s14, 32768
 s_mov_b32 m0, 53248
 s_nop 0
 buffer_load_dwordx4 v11, s[8:11], s14 offen lds
 s_add_u32 s14, s14, 32768
 s_mov_b32 m0, 54272
 s_nop 0
 buffer_load_dwordx4 v11, s[8:11], s14 offen lds
 s_add_u32 s14, s14, 32768
 s_mov_b32 m0, 55296
 s_nop 0
 buffer_load_dwordx4 v11, s[8:11], s14 offen lds
 s_add_u32 s14, s14, 32768
 s_mov_b32 m0, 56320
 s_nop 0
 buffer_load_dwordx4 v11, s[8:11], s14 offen lds
 s_waitcnt vmcnt(34)
 s_barrier
 v_xor_b32 v16, 0, v12
 v_add_u32 v16, 65536, v16
 ds_read_b64_tr_b16 v[40:41], v16 offset:0
 ds_read_b64_tr_b16 v[42:43], v16 offset:8192
 ds_read_b64_tr_b16 v[44:45], v16 offset:2048
 ds_read_b64_tr_b16 v[46:47], v16 offset:10240
 s_add_u32 s3, s63, 2048
 s_waitcnt lgkmcnt(2)
 buffer_store_dwordx4 v[40:43], v1, s[4:7], s3 offen offset:0
 s_waitcnt lgkmcnt(0)
 buffer_store_dwordx4 v[44:47], v1, s[4:7], s3 offen offset:1024
 v_xor_b32 v16, 32, v12
 v_add_u32 v16, 65536, v16
 ds_read_b64_tr_b16 v[48:49], v16 offset:0
 ds_read_b64_tr_b16 v[50:51], v16 offset:8192
 ds_read_b64_tr_b16 v[52:53], v16 offset:2048
 ds_read_b64_tr_b16 v[54:55], v16 offset:10240
 s_add_u32 s3, s63, 4096
 s_waitcnt lgkmcnt(2)
 buffer_store_dwordx4 v[48:51], v1, s[4:7], s3 offen offset:0
 s_waitcnt lgkmcnt(0)
 buffer_store_dwordx4 v[52:55], v1, s[4:7], s3 offen offset:1024
 v_xor_b32 v16, 0, v12
 v_add_u32 v16, 65536, v16
 ds_read_b64_tr_b16 v[56:57], v16 offset:16384
 ds_read_b64_tr_b16 v[58:59], v16 offset:24576
 ds_read_b64_tr_b16 v[60:61], v16 offset:18432
 ds_read_b64_tr_b16 v[62:63], v16 offset:26624
 s_add_u32 s3, s63, 6144
 s_waitcnt lgkmcnt(2)
 buffer_store_dwordx4 v[56:59], v1, s[4:7], s3 offen offset:0
 s_waitcnt lgkmcnt(0)
 buffer_store_dwordx4 v[60:63], v1, s[4:7], s3 offen offset:1024
 v_xor_b32 v16, 32, v12
 v_add_u32 v16, 65536, v16
 ds_read_b64_tr_b16 v[32:33], v16 offset:16384
 ds_read_b64_tr_b16 v[34:35], v16 offset:24576
 ds_read_b64_tr_b16 v[36:37], v16 offset:18432
 ds_read_b64_tr_b16 v[38:39], v16 offset:26624
 s_add_u32 s3, s63, 8192
 s_waitcnt lgkmcnt(2)
 buffer_store_dwordx4 v[32:35], v1, s[4:7], s3 offen offset:0
 s_waitcnt lgkmcnt(0)
 buffer_store_dwordx4 v[36:39], v1, s[4:7], s3 offen offset:1024
 s_waitcnt lgkmcnt(0)
 s_barrier
 s_lshl_b32 s14, s52, 8
 s_add_u32 s14, s14, 2621440
 s_mov_b32 m0, 81920
 s_nop 0
 buffer_load_dwordx4 v10, s[8:11], s14 offen lds
 s_add_u32 s14, s14, 32768
 s_mov_b32 m0, 82944
 s_nop 0
 buffer_load_dwordx4 v10, s[8:11], s14 offen lds
 s_add_u32 s14, s14, 32768
 s_mov_b32 m0, 83968
 s_nop 0
 buffer_load_dwordx4 v10, s[8:11], s14 offen lds
 s_add_u32 s14, s14, 32768
 s_mov_b32 m0, 84992
 s_nop 0
 buffer_load_dwordx4 v10, s[8:11], s14 offen lds
 s_add_u32 s14, s14, 32768
 s_mov_b32 m0, 86016
 s_nop 0
 buffer_load_dwordx4 v11, s[8:11], s14 offen lds
 s_add_u32 s14, s14, 32768
 s_mov_b32 m0, 87040
 s_nop 0
 buffer_load_dwordx4 v11, s[8:11], s14 offen lds
 s_add_u32 s14, s14, 32768
 s_mov_b32 m0, 88064
 s_nop 0
 buffer_load_dwordx4 v11, s[8:11], s14 offen lds
 s_add_u32 s14, s14, 32768
 s_mov_b32 m0, 89088
 s_nop 0
 buffer_load_dwordx4 v11, s[8:11], s14 offen lds
 s_waitcnt vmcnt(42)
 s_barrier
 v_xor_b32 v16, 0, v12
 v_add_u32 v16, 98304, v16
 ds_read_b64_tr_b16 v[184:185], v16 offset:0
 ds_read_b64_tr_b16 v[186:187], v16 offset:8192
 ds_read_b64_tr_b16 v[188:189], v16 offset:2048
 ds_read_b64_tr_b16 v[190:191], v16 offset:10240
 v_xor_b32 v16, 32, v12
 v_add_u32 v16, 98304, v16
 ds_read_b64_tr_b16 v[192:193], v16 offset:0
 ds_read_b64_tr_b16 v[194:195], v16 offset:8192
 ds_read_b64_tr_b16 v[196:197], v16 offset:2048
 ds_read_b64_tr_b16 v[198:199], v16 offset:10240
 v_xor_b32 v16, 0, v12
 v_add_u32 v16, 98304, v16
 ds_read_b64_tr_b16 v[200:201], v16 offset:16384
 ds_read_b64_tr_b16 v[202:203], v16 offset:24576
 ds_read_b64_tr_b16 v[204:205], v16 offset:18432
 ds_read_b64_tr_b16 v[206:207], v16 offset:26624
 v_xor_b32 v16, 32, v12
 v_add_u32 v16, 98304, v16
 ds_read_b64_tr_b16 v[208:209], v16 offset:16384
 ds_read_b64_tr_b16 v[210:211], v16 offset:24576
 ds_read_b64_tr_b16 v[212:213], v16 offset:18432
 ds_read_b64_tr_b16 v[214:215], v16 offset:26624
 s_waitcnt lgkmcnt(0)
 s_barrier
 s_lshl_b32 s14, s52, 8
 s_add_u32 s14, s14, 3670016
 s_mov_b32 m0, 114688
 s_nop 0
 buffer_load_dwordx4 v10, s[8:11], s14 offen lds
 s_add_u32 s14, s14, 32768
 s_mov_b32 m0, 115712
 s_nop 0
 buffer_load_dwordx4 v10, s[8:11], s14 offen lds
 s_add_u32 s14, s14, 32768
 s_mov_b32 m0, 116736
 s_nop 0
 buffer_load_dwordx4 v10, s[8:11], s14 offen lds
 s_add_u32 s14, s14, 32768
 s_mov_b32 m0, 117760
 s_nop 0
 buffer_load_dwordx4 v10, s[8:11], s14 offen lds
 s_add_u32 s14, s14, 32768
 s_mov_b32 m0, 118784
 s_nop 0
 buffer_load_dwordx4 v11, s[8:11], s14 offen lds
 s_add_u32 s14, s14, 32768
 s_mov_b32 m0, 119808
 s_nop 0
 buffer_load_dwordx4 v11, s[8:11], s14 offen lds
 s_add_u32 s14, s14, 32768
 s_mov_b32 m0, 120832
 s_nop 0
 buffer_load_dwordx4 v11, s[8:11], s14 offen lds
 s_add_u32 s14, s14, 32768
 s_mov_b32 m0, 121856
 s_nop 0
 buffer_load_dwordx4 v11, s[8:11], s14 offen lds
 s_waitcnt vmcnt(42)
 s_barrier
 v_xor_b32 v16, 0, v12
 v_add_u32 v16, 131072, v16
 ds_read_b64_tr_b16 v[216:217], v16 offset:0
 ds_read_b64_tr_b16 v[218:219], v16 offset:8192
 ds_read_b64_tr_b16 v[220:221], v16 offset:2048
 ds_read_b64_tr_b16 v[222:223], v16 offset:10240
 v_xor_b32 v16, 32, v12
 v_add_u32 v16, 131072, v16
 ds_read_b64_tr_b16 v[224:225], v16 offset:0
 ds_read_b64_tr_b16 v[226:227], v16 offset:8192
 ds_read_b64_tr_b16 v[228:229], v16 offset:2048
 ds_read_b64_tr_b16 v[230:231], v16 offset:10240
 v_xor_b32 v16, 0, v12
 v_add_u32 v16, 131072, v16
 ds_read_b64_tr_b16 v[232:233], v16 offset:16384
 ds_read_b64_tr_b16 v[234:235], v16 offset:24576
 ds_read_b64_tr_b16 v[236:237], v16 offset:18432
 ds_read_b64_tr_b16 v[238:239], v16 offset:26624
 v_xor_b32 v16, 32, v12
 v_add_u32 v16, 131072, v16
 ds_read_b64_tr_b16 v[40:41], v16 offset:16384
 ds_read_b64_tr_b16 v[42:43], v16 offset:24576
 ds_read_b64_tr_b16 v[44:45], v16 offset:18432
 ds_read_b64_tr_b16 v[46:47], v16 offset:26624
 s_add_u32 s3, s63, 10240
 s_waitcnt lgkmcnt(2)
 buffer_store_dwordx4 v[40:43], v1, s[4:7], s3 offen offset:0
 s_waitcnt lgkmcnt(0)
 buffer_store_dwordx4 v[44:47], v1, s[4:7], s3 offen offset:1024
 s_waitcnt lgkmcnt(0)
 s_barrier
 s_lshl_b32 s14, s52, 8
 s_add_u32 s14, s14, 4718592
 s_mov_b32 m0, 147456
 s_nop 0
 buffer_load_dwordx4 v10, s[8:11], s14 offen lds
 s_add_u32 s14, s14, 32768
 s_mov_b32 m0, 148480
 s_nop 0
 buffer_load_dwordx4 v10, s[8:11], s14 offen lds
 s_add_u32 s14, s14, 32768
 s_mov_b32 m0, 149504
 s_nop 0
 buffer_load_dwordx4 v10, s[8:11], s14 offen lds
 s_add_u32 s14, s14, 32768
 s_mov_b32 m0, 150528
 s_nop 0
 buffer_load_dwordx4 v10, s[8:11], s14 offen lds
 s_add_u32 s14, s14, 32768
 s_mov_b32 m0, 151552
 s_nop 0
 buffer_load_dwordx4 v11, s[8:11], s14 offen lds
 s_add_u32 s14, s14, 32768
 s_mov_b32 m0, 152576
 s_nop 0
 buffer_load_dwordx4 v11, s[8:11], s14 offen lds
 s_add_u32 s14, s14, 32768
 s_mov_b32 m0, 153600
 s_nop 0
 buffer_load_dwordx4 v11, s[8:11], s14 offen lds
 s_add_u32 s14, s14, 32768
 s_mov_b32 m0, 154624
 s_nop 0
 buffer_load_dwordx4 v11, s[8:11], s14 offen lds
 s_waitcnt vmcnt(44)
 s_barrier
 v_xor_b32 v16, 0, v12
 v_add_u32 v16, 0, v16
 ds_read_b64_tr_b16 v[240:241], v16 offset:0
 ds_read_b64_tr_b16 v[242:243], v16 offset:8192
 ds_read_b64_tr_b16 v[244:245], v16 offset:2048
 ds_read_b64_tr_b16 v[246:247], v16 offset:10240
 v_xor_b32 v16, 32, v12
 v_add_u32 v16, 0, v16
 ds_read_b64_tr_b16 v[248:249], v16 offset:0
 ds_read_b64_tr_b16 v[250:251], v16 offset:8192
 ds_read_b64_tr_b16 v[252:253], v16 offset:2048
 ds_read_b64_tr_b16 v[254:255], v16 offset:10240
 v_xor_b32 v16, 0, v12
 v_add_u32 v16, 0, v16
 ds_read_b64_tr_b16 v[32:33], v16 offset:16384
 ds_read_b64_tr_b16 v[34:35], v16 offset:24576
 ds_read_b64_tr_b16 v[36:37], v16 offset:18432
 ds_read_b64_tr_b16 v[38:39], v16 offset:26624
 v_xor_b32 v16, 32, v12
 v_add_u32 v16, 0, v16
 ds_read_b64_tr_b16 v[40:41], v16 offset:16384
 ds_read_b64_tr_b16 v[42:43], v16 offset:24576
 ds_read_b64_tr_b16 v[44:45], v16 offset:18432
 ds_read_b64_tr_b16 v[46:47], v16 offset:26624
 s_waitcnt lgkmcnt(0)
 s_barrier
 ds_write_b128 v1, v[224:227] offset:24576
 ds_write_b128 v1, v[228:231] offset:25600
 ds_write_b128 v1, v[216:219] offset:26624
 ds_write_b128 v1, v[220:223] offset:27648
 s_waitcnt lgkmcnt(0)
 v_mov_b32 v224, v32
 v_mov_b32 v225, v33
 v_mov_b32 v226, v34
 v_mov_b32 v227, v35
 v_mov_b32 v228, v36
 v_mov_b32 v229, v37
 v_mov_b32 v230, v38
 v_mov_b32 v231, v39
 v_mov_b32 v216, v40
 v_mov_b32 v217, v41
 v_mov_b32 v218, v42
 v_mov_b32 v219, v43
 v_mov_b32 v220, v44
 v_mov_b32 v221, v45
 v_mov_b32 v222, v46
 v_mov_b32 v223, v47
 s_waitcnt vmcnt(34)
 s_barrier
 v_xor_b32 v16, 0, v12
 v_add_u32 v16, 32768, v16
 ds_read_b64_tr_b16 v[32:33], v16 offset:0
 ds_read_b64_tr_b16 v[34:35], v16 offset:8192
 ds_read_b64_tr_b16 v[36:37], v16 offset:2048
 ds_read_b64_tr_b16 v[38:39], v16 offset:10240
 v_xor_b32 v16, 32, v12
 v_add_u32 v16, 32768, v16
 ds_read_b64_tr_b16 v[40:41], v16 offset:0
 ds_read_b64_tr_b16 v[42:43], v16 offset:8192
 ds_read_b64_tr_b16 v[44:45], v16 offset:2048
 ds_read_b64_tr_b16 v[46:47], v16 offset:10240
 v_xor_b32 v16, 0, v12
 v_add_u32 v16, 32768, v16
 ds_read_b64_tr_b16 v[48:49], v16 offset:16384
 ds_read_b64_tr_b16 v[50:51], v16 offset:24576
 ds_read_b64_tr_b16 v[52:53], v16 offset:18432
 ds_read_b64_tr_b16 v[54:55], v16 offset:26624
 v_xor_b32 v16, 32, v12
 v_add_u32 v16, 32768, v16
 ds_read_b64_tr_b16 v[56:57], v16 offset:16384
 ds_read_b64_tr_b16 v[58:59], v16 offset:24576
 ds_read_b64_tr_b16 v[60:61], v16 offset:18432
 ds_read_b64_tr_b16 v[62:63], v16 offset:26624
 s_waitcnt lgkmcnt(0)
 s_barrier
 ds_write_b128 v1, v[208:211] offset:49152
 ds_write_b128 v1, v[212:215] offset:50176
 ds_write_b128 v1, v[200:203] offset:51200
 ds_write_b128 v1, v[204:207] offset:52224
 ds_write_b128 v1, v[184:187] offset:53248
 ds_write_b128 v1, v[188:191] offset:54272
 ds_write_b128 v1, v[176:179] offset:55296
 ds_write_b128 v1, v[180:183] offset:56320
 s_waitcnt lgkmcnt(0)
 v_mov_b32 v208, v32
 v_mov_b32 v209, v33
 v_mov_b32 v210, v34
 v_mov_b32 v211, v35
 v_mov_b32 v212, v36
 v_mov_b32 v213, v37
 v_mov_b32 v214, v38
 v_mov_b32 v215, v39
 v_mov_b32 v200, v40
 v_mov_b32 v201, v41
 v_mov_b32 v202, v42
 v_mov_b32 v203, v43
 v_mov_b32 v204, v44
 v_mov_b32 v205, v45
 v_mov_b32 v206, v46
 v_mov_b32 v207, v47
 v_mov_b32 v184, v48
 v_mov_b32 v185, v49
 v_mov_b32 v186, v50
 v_mov_b32 v187, v51
 v_mov_b32 v188, v52
 v_mov_b32 v189, v53
 v_mov_b32 v190, v54
 v_mov_b32 v191, v55
 v_mov_b32 v176, v56
 v_mov_b32 v177, v57
 v_mov_b32 v178, v58
 v_mov_b32 v179, v59
 v_mov_b32 v180, v60
 v_mov_b32 v181, v61
 v_mov_b32 v182, v62
 v_mov_b32 v183, v63
 s_waitcnt vmcnt(18)
 s_barrier
 v_xor_b32 v16, 0, v12
 v_add_u32 v16, 65536, v16
 ds_read_b64_tr_b16 v[32:33], v16 offset:0
 ds_read_b64_tr_b16 v[34:35], v16 offset:8192
 ds_read_b64_tr_b16 v[36:37], v16 offset:2048
 ds_read_b64_tr_b16 v[38:39], v16 offset:10240
 v_xor_b32 v16, 32, v12
 v_add_u32 v16, 65536, v16
 ds_read_b64_tr_b16 v[40:41], v16 offset:0
 ds_read_b64_tr_b16 v[42:43], v16 offset:8192
 ds_read_b64_tr_b16 v[44:45], v16 offset:2048
 ds_read_b64_tr_b16 v[46:47], v16 offset:10240
 v_xor_b32 v16, 0, v12
 v_add_u32 v16, 65536, v16
 ds_read_b64_tr_b16 v[48:49], v16 offset:16384
 ds_read_b64_tr_b16 v[50:51], v16 offset:24576
 ds_read_b64_tr_b16 v[52:53], v16 offset:18432
 ds_read_b64_tr_b16 v[54:55], v16 offset:26624
 v_xor_b32 v16, 32, v12
 v_add_u32 v16, 65536, v16
 ds_read_b64_tr_b16 v[56:57], v16 offset:16384
 ds_read_b64_tr_b16 v[58:59], v16 offset:24576
 ds_read_b64_tr_b16 v[60:61], v16 offset:18432
 ds_read_b64_tr_b16 v[62:63], v16 offset:26624
 s_waitcnt lgkmcnt(0)
 s_barrier
 ds_write_b128 v2, v[168:171] offset:16384
 ds_write_b128 v2, v[172:175] offset:17408
 ds_write_b128 v2, v[160:163] offset:18432
 ds_write_b128 v2, v[164:167] offset:19456
 ds_write_b128 v2, v[144:147] offset:20480
 ds_write_b128 v2, v[148:151] offset:21504
 ds_write_b128 v2, v[128:131] offset:22528
 ds_write_b128 v2, v[132:135] offset:23552
 s_waitcnt lgkmcnt(0)
 v_mov_b32 v168, v32
 v_mov_b32 v169, v33
 v_mov_b32 v170, v34
 v_mov_b32 v171, v35
 v_mov_b32 v172, v36
 v_mov_b32 v173, v37
 v_mov_b32 v174, v38
 v_mov_b32 v175, v39
 v_mov_b32 v160, v40
 v_mov_b32 v161, v41
 v_mov_b32 v162, v42
 v_mov_b32 v163, v43
 v_mov_b32 v164, v44
 v_mov_b32 v165, v45
 v_mov_b32 v166, v46
 v_mov_b32 v167, v47
 v_mov_b32 v144, v48
 v_mov_b32 v145, v49
 v_mov_b32 v146, v50
 v_mov_b32 v147, v51
 v_mov_b32 v148, v52
 v_mov_b32 v149, v53
 v_mov_b32 v150, v54
 v_mov_b32 v151, v55
 v_mov_b32 v128, v56
 v_mov_b32 v129, v57
 v_mov_b32 v130, v58
 v_mov_b32 v131, v59
 v_mov_b32 v132, v60
 v_mov_b32 v133, v61
 v_mov_b32 v134, v62
 v_mov_b32 v135, v63
 s_waitcnt vmcnt(10)
 s_barrier
 v_xor_b32 v16, 0, v12
 v_add_u32 v16, 98304, v16
 ds_read_b64_tr_b16 v[32:33], v16 offset:0
 ds_read_b64_tr_b16 v[34:35], v16 offset:8192
 ds_read_b64_tr_b16 v[36:37], v16 offset:2048
 ds_read_b64_tr_b16 v[38:39], v16 offset:10240
 v_xor_b32 v16, 32, v12
 v_add_u32 v16, 98304, v16
 ds_read_b64_tr_b16 v[40:41], v16 offset:0
 ds_read_b64_tr_b16 v[42:43], v16 offset:8192
 ds_read_b64_tr_b16 v[44:45], v16 offset:2048
 ds_read_b64_tr_b16 v[46:47], v16 offset:10240
 v_xor_b32 v16, 0, v12
 v_add_u32 v16, 98304, v16
 ds_read_b64_tr_b16 v[48:49], v16 offset:16384
 ds_read_b64_tr_b16 v[50:51], v16 offset:24576
 ds_read_b64_tr_b16 v[52:53], v16 offset:18432
 ds_read_b64_tr_b16 v[54:55], v16 offset:26624
 v_xor_b32 v16, 32, v12
 v_add_u32 v16, 98304, v16
 ds_read_b64_tr_b16 v[56:57], v16 offset:16384
 ds_read_b64_tr_b16 v[58:59], v16 offset:24576
 ds_read_b64_tr_b16 v[60:61], v16 offset:18432
 ds_read_b64_tr_b16 v[62:63], v16 offset:26624
 s_waitcnt lgkmcnt(0)
 s_barrier
 ds_write_b128 v3, a[136:139] offset:0
 ds_write_b128 v3, a[140:143] offset:1024
 ds_write_b128 v3, a[128:131] offset:2048
 ds_write_b128 v3, a[132:135] offset:3072
 ds_write_b128 v3, a[112:115] offset:4096
 ds_write_b128 v3, a[116:119] offset:5120
 ds_write_b128 v3, a[88:91] offset:6144
 ds_write_b128 v3, a[92:95] offset:7168
 s_waitcnt lgkmcnt(0)
 v_accvgpr_write_b32 a136, v32
 v_accvgpr_write_b32 a137, v33
 v_accvgpr_write_b32 a138, v34
 v_accvgpr_write_b32 a139, v35
 v_accvgpr_write_b32 a140, v36
 v_accvgpr_write_b32 a141, v37
 v_accvgpr_write_b32 a142, v38
 v_accvgpr_write_b32 a143, v39
 v_accvgpr_write_b32 a128, v40
 v_accvgpr_write_b32 a129, v41
 v_accvgpr_write_b32 a130, v42
 v_accvgpr_write_b32 a131, v43
 v_accvgpr_write_b32 a132, v44
 v_accvgpr_write_b32 a133, v45
 v_accvgpr_write_b32 a134, v46
 v_accvgpr_write_b32 a135, v47
 v_accvgpr_write_b32 a112, v48
 v_accvgpr_write_b32 a113, v49
 v_accvgpr_write_b32 a114, v50
 v_accvgpr_write_b32 a115, v51
 v_accvgpr_write_b32 a116, v52
 v_accvgpr_write_b32 a117, v53
 v_accvgpr_write_b32 a118, v54
 v_accvgpr_write_b32 a119, v55
 v_accvgpr_write_b32 a88, v56
 v_accvgpr_write_b32 a89, v57
 v_accvgpr_write_b32 a90, v58
 v_accvgpr_write_b32 a91, v59
 v_accvgpr_write_b32 a92, v60
 v_accvgpr_write_b32 a93, v61
 v_accvgpr_write_b32 a94, v62
 v_accvgpr_write_b32 a95, v63
 s_waitcnt vmcnt(0)
 s_barrier
 v_xor_b32 v16, 0, v12
 v_add_u32 v16, 131072, v16
 ds_read_b64_tr_b16 v[32:33], v16 offset:0
 ds_read_b64_tr_b16 v[34:35], v16 offset:8192
 ds_read_b64_tr_b16 v[36:37], v16 offset:2048
 ds_read_b64_tr_b16 v[38:39], v16 offset:10240
 v_xor_b32 v16, 32, v12
 v_add_u32 v16, 131072, v16
 ds_read_b64_tr_b16 v[40:41], v16 offset:0
 ds_read_b64_tr_b16 v[42:43], v16 offset:8192
 ds_read_b64_tr_b16 v[44:45], v16 offset:2048
 ds_read_b64_tr_b16 v[46:47], v16 offset:10240
 v_xor_b32 v16, 0, v12
 v_add_u32 v16, 131072, v16
 ds_read_b64_tr_b16 v[48:49], v16 offset:16384
 ds_read_b64_tr_b16 v[50:51], v16 offset:24576
 ds_read_b64_tr_b16 v[52:53], v16 offset:18432
 ds_read_b64_tr_b16 v[54:55], v16 offset:26624
 v_xor_b32 v16, 32, v12
 v_add_u32 v16, 131072, v16
 ds_read_b64_tr_b16 v[56:57], v16 offset:16384
 ds_read_b64_tr_b16 v[58:59], v16 offset:24576
 ds_read_b64_tr_b16 v[60:61], v16 offset:18432
 ds_read_b64_tr_b16 v[62:63], v16 offset:26624
 s_waitcnt lgkmcnt(0)
 s_barrier
 ds_write_b128 v3, a[80:83] offset:32768
 ds_write_b128 v3, a[84:87] offset:33792
 ds_write_b128 v3, a[72:75] offset:34816
 ds_write_b128 v3, a[76:79] offset:35840
 ds_write_b128 v3, a[32:35] offset:36864
 ds_write_b128 v3, a[36:39] offset:37888
 ds_write_b128 v3, a[24:27] offset:38912
 ds_write_b128 v3, a[28:31] offset:39936
 s_waitcnt lgkmcnt(0)
 v_accvgpr_write_b32 a80, v32
 v_accvgpr_write_b32 a81, v33
 v_accvgpr_write_b32 a82, v34
 v_accvgpr_write_b32 a83, v35
 v_accvgpr_write_b32 a84, v36
 v_accvgpr_write_b32 a85, v37
 v_accvgpr_write_b32 a86, v38
 v_accvgpr_write_b32 a87, v39
 v_accvgpr_write_b32 a72, v40
 v_accvgpr_write_b32 a73, v41
 v_accvgpr_write_b32 a74, v42
 v_accvgpr_write_b32 a75, v43
 v_accvgpr_write_b32 a76, v44
 v_accvgpr_write_b32 a77, v45
 v_accvgpr_write_b32 a78, v46
 v_accvgpr_write_b32 a79, v47
 v_accvgpr_write_b32 a32, v48
 v_accvgpr_write_b32 a33, v49
 v_accvgpr_write_b32 a34, v50
 v_accvgpr_write_b32 a35, v51
 v_accvgpr_write_b32 a36, v52
 v_accvgpr_write_b32 a37, v53
 v_accvgpr_write_b32 a38, v54
 v_accvgpr_write_b32 a39, v55
 v_accvgpr_write_b32 a24, v56
 v_accvgpr_write_b32 a25, v57
 v_accvgpr_write_b32 a26, v58
 v_accvgpr_write_b32 a27, v59
 v_accvgpr_write_b32 a28, v60
 v_accvgpr_write_b32 a29, v61
 v_accvgpr_write_b32 a30, v62
 v_accvgpr_write_b32 a31, v63
 v_lshlrev_b32 v5, 3, v0
 v_and_b32 v6, 0x1e0, v5
 v_and_b32 v7, 1, v0
 v_lshl_add_u32 v6, v7, 4, v6
 v_and_b32 v7, 2, v0
 v_lshl_add_u32 v6, v7, 2, v6
 v_bfe_u32 v4, v0, 2, 2
 v_lshrrev_b32 v7, 4, v0
 v_cmp_eq_u32 vcc, v4, v7
 v_and_b32 v7, 16, v1
 v_mov_b32 v5, 0x3f80
 v_lshlrev_b32 v7, v7, v5
 v_cndmask_b32 v4, 0, v7, vcc
 v_mov_b32 v5, 0
 s_lshl_b32 s59, s53, 16
 s_add_u32 s59, s59, 983040
 s_mul_i32 s15, s53, 327680
 s_add_u32 s15, s15, 225280
 s_lshl_b32 s3, s52, 6
 s_add_u32 s15, s15, s3
 s_add_u32 s64, s15, 8192
 s_add_u32 s65, s15, 172032
 s_lshr_b32 s14, s52, 4
 s_add_u32 s14, s14, 8
 s_bfe_u32 s15, s52, 0x20002
 s_and_b32 s16, s52, 3
 s_mov_b32 s84, 0x000f000f
 s_mov_b32 s85, 0
 s_lshl_b32 s57, s14, 10
 s_lshl_b32 s3, s15, 6
 s_add_u32 s57, s57, s3
 s_lshl_b32 s3, s16, 8
 s_add_u32 s57, s57, s3
 s_add_u32 s57, s57, s59
 s_add_u32 s59, s59, 4096
 s_lshl_b32 s14, s14, 7
 s_mul_i32 s15, s15, 2560
 s_add_u32 s14, s14, s15
 s_lshl_b32 s3, s16, 3
 s_add_u32 s14, s14, s3
 s_mov_b32 s8, s18
 s_and_b32 s9, s19, 0xffff
 s_mov_b32 s10, 10240
 s_mov_b32 s11, 0x00020000
 v_bfe_u32 v40, v0, 4, 1
 v_mul_u32_u24 v40, 1280, v40
 v_and_b32 v41, 7, v0
 v_lshl_add_u32 v40, v41, 1, v40
 buffer_load_ushort v44, v40, s[8:11], s14 offen offset:0
 buffer_load_ushort v45, v40, s[8:11], s14 offen offset:32
 buffer_load_ushort v46, v40, s[8:11], s14 offen offset:64
 buffer_load_ushort v47, v40, s[8:11], s14 offen offset:96
 v_lshrrev_b32 v42, 6, v1
 v_mul_u32_u24 v42, 10240, v42
 v_and_b32 v7, 48, v1
 v_add_u32 v42, v42, v7
 v_and_b32 v43, 32, v1
 v_and_b32 v7, 64, v1
 v_lshl_add_u32 v43, v7, 2, v43
 v_bfe_u32 v7, v1, 8, 1
 v_lshl_add_u32 v43, v7, 4, v43
 v_bfe_u32 v7, v1, 4, 1
 v_lshl_add_u32 v43, v7, 3, v43
 s_waitcnt vmcnt(2)
 v_lshl_or_b32 v44, v45, 16, v44
 s_waitcnt vmcnt(0)
 v_lshl_or_b32 v45, v47, 16, v46
 s_add_u32 s16, s60, 5120
 s_waitcnt vmcnt(0) lgkmcnt(0)
 s_mov_b32 s96, s44
 s_and_b32 s97, s45, 0xffff
 s_mov_b32 s98, 256
 s_mov_b32 s99, 0x00020000
 v_mov_b32 v8, 132
 s_mov_b32 s51, 0
 s_mov_b64 exec, 1
L_wb_187:
 buffer_load_dword v9, v8, s[96:99], 0 offen sc1
 s_waitcnt vmcnt(0)
 v_cmp_eq_u32 vcc, 0, v9
 s_cbranch_vccz L_wbd_188
 s_sleep 2
 s_add_u32 s51, s51, 1
 s_cmp_lt_u32 s51, 131072
 s_cbranch_scc1 L_wb_187
 s_branch L_bail
L_wbd_188:
 s_mov_b64 exec, -1
 s_mov_b32 s96, s44
 s_and_b32 s97, s45, 0xffff
 s_mov_b32 s98, 256
 s_mov_b32 s99, 0x00020000
 v_mov_b32 v8, 212
 s_mov_b32 s51, 0
 s_mov_b64 exec, 1
L_wb_189:
 buffer_load_dword v9, v8, s[96:99], 0 offen sc1
 s_waitcnt vmcnt(0)
 v_cmp_eq_u32 vcc, 0, v9
 s_cbranch_vccz L_wbd_190
 s_sleep 2
 s_add_u32 s51, s51, 1
 s_cmp_lt_u32 s51, 131072
 s_cbranch_scc1 L_wb_189
 s_branch L_bail
L_wbd_190:
 s_mov_b64 exec, -1
 s_mov_b32 s96, s44
 s_and_b32 s97, s45, 0xffff
 s_mov_b32 s98, 256
 s_mov_b32 s99, 0x00020000
 v_lshlrev_b32 v8, 5, v0
 s_mov_b32 s51, 0
L_gl_191:
 buffer_load_dword v9, v8, s[96:99], 0 offen sc1
 s_waitcnt vmcnt(0)
 v_readlane_b32 s3, v9, s48
 s_mov_b32 s80, 0
 s_nop 2
 s_cmp_ge_u32 s3, 32
 s_cbranch_scc1 L_gld_192
 s_mov_b32 s80, 0
 v_readlane_b32 s3, v9, 0
 s_nop 3
 s_add_u32 s80, s80, s3
 v_readlane_b32 s3, v9, 1
 s_nop 3
 s_add_u32 s80, s80, s3
 v_readlane_b32 s3, v9, 2
 s_nop 3
 s_add_u32 s80, s80, s3
 v_readlane_b32 s3, v9, 3
 s_nop 3
 s_add_u32 s80, s80, s3
 v_readlane_b32 s3, v9, 4
 s_nop 3
 s_add_u32 s80, s80, s3
 v_readlane_b32 s3, v9, 5
 s_nop 3
 s_add_u32 s80, s80, s3
 v_readlane_b32 s3, v9, 6
 s_nop 3
 s_add_u32 s80, s80, s3
 v_readlane_b32 s3, v9, 7
 s_nop 3
 s_add_u32 s80, s80, s3
 s_cmp_ge_u32 s80, 256
 s_cbranch_scc1 L_gld_192
 s_sleep 4
 s_add_u32 s51, s51, 1
 s_cmp_lt_u32 s51, 131072
 s_cbranch_scc1 L_gl_191
 s_branch L_bail
L_gld_192:
 s_mov_b64 exec, s[84:85]
 buffer_store_dwordx2 v[44:45], v43, s[4:7], s57 offen sc1
 s_mov_b64 exec, -1
 v_and_b32 v7, 2, v0
 v_mul_u32_u24 v7, 0x5555, v7
 v_add_u32 v0, 0x4444, v7
 s_mov_b32 m0, 2048
 s_waitcnt vmcnt(0) lgkmcnt(0)
 s_barrier
 buffer_load_dwordx4 v[32:35], v1, s[4:7], s63 offen offset:2048
 buffer_load_dwordx4 v[36:39], v1, s[4:7], s63 offen offset:3072
 buffer_load_dwordx4 v[40:43], v1, s[4:7], s81 offen offset:0
 buffer_load_dwordx4 v[44:47], v1, s[4:7], s81 offen offset:1024
 buffer_load_dwordx4 v[48:51], v1, s[4:7], s81 offen offset:2048
 buffer_load_dwordx4 v[52:55], v1, s[4:7], s81 offen offset:3072
 buffer_load_dwordx4 v[56:59], v1, s[4:7], s101 offen offset:0
 buffer_load_dwordx4 v[60:63], v1, s[4:7], s101 offen offset:1024
 ds_read_b128 v[8:11], v3 offset:49152
 ds_read_b128 v[12:15], v3 offset:49152
 ds_read_b128 v[16:19], v3 offset:49152
 ds_read_b128 v[20:23], v3 offset:49152
 s_waitcnt vmcnt(0) lgkmcnt(0)
 s_cmp_lg_u32 s80, 0
 s_cbranch_scc1 L_ch2_s
.p2align 6
L_ch2_f:
 s_mov_b32 s51, 0
L_pm_193:
 buffer_load_dwordx4 v[24:27], v1, s[4:7], s59 offen offset:0 sc1
 buffer_load_dwordx4 v[28:31], v1, s[4:7], s59 offen offset:1024 sc1
 s_add_u32 s3, s59, 4096
 buffer_load_dwordx4 v[12:15], v1, s[4:7], s3 offen offset:0 sc1
 s_waitcnt vmcnt(2)
 ds_write_b128 v1, v[24:27] offset:4096
 v_max_u32 v7, v24, v26
 s_waitcnt vmcnt(1)
 ds_write_b128 v1, v[28:31] offset:5120
 v_max3_u32 v7, v7, v28, v30
 s_waitcnt vmcnt(0)
 ds_write_b128 v1, v[12:15] offset:8192
 v_max3_u32 v7, v7, v12, v14
 v_cmp_eq_u32 vcc, -1, v7
 s_cbranch_vccnz L_rt_194
 ds_read_b128 v[12:15], v3 offset:49152
 v_smfmac_f32_16x16x64_bf16 v[16:19], v[24:27], v[32:39], v0
 ds_read_b128 v[32:35], v1 offset:26624
 ds_read_b128 v[36:39], v1 offset:27648
 v_smfmac_f32_16x16x64_bf16 v[20:23], v[24:27], v[40:47], v0
 ds_read_b128 v[40:43], v1 offset:24576
 ds_read_b128 v[44:47], v1 offset:25600
 v_smfmac_f32_16x16x64_bf16 v[16:19], v[28:31], v[48:55], v0
 v_smfmac_f32_16x16x64_bf16 v[20:23], v[28:31], v[56:63], v0
 s_waitcnt lgkmcnt(5)
 s_barrier
 buffer_load_dwordx4 v[56:59], v1, s[4:7], s63 offen offset:0
 v_smfmac_f32_16x16x64_bf16 v[8:11], v[24:27], v[168:175], v0
 s_waitcnt lgkmcnt(4)
 v_smfmac_f32_16x16x64_bf16 v[12:15], v[24:27], v[160:167], v0
 ds_read_b128 v[24:27], v1 offset:8192
 buffer_load_dwordx4 v[60:63], v1, s[4:7], s63 offen offset:1024
 v_smfmac_f32_16x16x64_bf16 v[8:11], v[28:31], v[144:151], v0
 v_smfmac_f32_16x16x64_bf16 v[12:15], v[28:31], v[128:135], v0
 ds_read_b128 v[28:31], v1 offset:0
 buffer_load_dwordx4 v[48:51], v1, s[4:7], s101 offen offset:2048
 s_waitcnt lgkmcnt(1)
 v_smfmac_f32_16x16x64_bf16 v[16:19], v[24:27], v[32:39], v0
 ds_read_b128 v[32:35], v2 offset:22528
 ds_read_b128 v[36:39], v2 offset:23552
 v_smfmac_f32_16x16x64_bf16 v[8:11], v[24:27], a[80:87], v0
 buffer_load_dwordx4 v[52:55], v1, s[4:7], s101 offen offset:3072
 v_smfmac_f32_16x16x64_bf16 v[12:15], v[24:27], a[72:79], v0
 v_smfmac_f32_16x16x64_bf16 v[20:23], v[24:27], v[40:47], v0
 ds_read_b128 v[40:43], v2 offset:20480
 ds_read_b128 v[44:47], v2 offset:21504
 ds_read_b128 v[24:27], v1 offset:1024
 s_waitcnt lgkmcnt(5)
 v_smfmac_f32_16x16x64_bf16 v[8:11], v[28:31], v[240:247], v0
 v_smfmac_f32_16x16x64_bf16 v[12:15], v[28:31], v[248:255], v0
 s_waitcnt lgkmcnt(3)
 v_smfmac_f32_16x16x64_bf16 v[16:19], v[28:31], v[32:39], v0
 ds_read_b128 v[32:35], v2 offset:18432
 ds_read_b128 v[36:39], v2 offset:19456
 v_smfmac_f32_16x16x64_bf16 v[20:23], v[28:31], v[136:143], v0
 ds_read_b128 v[28:31], v1 offset:2048
 s_waitcnt lgkmcnt(3)
 v_smfmac_f32_16x16x64_bf16 v[8:11], v[24:27], v[224:231], v0
 v_smfmac_f32_16x16x64_bf16 v[16:19], v[24:27], v[40:47], v0
 ds_read_b128 v[40:43], v2 offset:16384
 ds_read_b128 v[44:47], v2 offset:17408
 v_smfmac_f32_16x16x64_bf16 v[12:15], v[24:27], v[216:223], v0
 v_smfmac_f32_16x16x64_bf16 v[20:23], v[24:27], v[152:159], v0
 ds_read_b128 v[24:27], v1 offset:3072
 s_waitcnt lgkmcnt(3)
 v_smfmac_f32_16x16x64_bf16 v[16:19], v[28:31], v[32:39], v0
 ds_read_b128 v[32:35], v1 offset:55296
 ds_read_b128 v[36:39], v1 offset:56320
 v_smfmac_f32_16x16x64_bf16 v[8:11], v[28:31], v[208:215], v0
 v_smfmac_f32_16x16x64_bf16 v[12:15], v[28:31], v[200:207], v0
 s_waitcnt lgkmcnt(3)
 v_smfmac_f32_16x16x64_bf16 v[20:23], v[28:31], v[40:47], v0
 ds_read_b128 v[40:43], v1 offset:53248
 ds_read_b128 v[44:47], v1 offset:54272
 ds_read_b128 v[28:31], v1 offset:6144
 s_waitcnt lgkmcnt(5)
 v_smfmac_f32_16x16x64_bf16 v[8:11], v[24:27], v[184:191], v0
 v_smfmac_f32_16x16x64_bf16 v[12:15], v[24:27], v[176:183], v0
 s_waitcnt lgkmcnt(3)
 v_smfmac_f32_16x16x64_bf16 v[16:19], v[24:27], v[32:39], v0
 ds_read_b128 v[32:35], v1 offset:51200
 ds_read_b128 v[36:39], v1 offset:52224
 s_waitcnt vmcnt(2)
 v_smfmac_f32_16x16x64_bf16 v[20:23], v[24:27], v[56:63], v0
 ds_read_b128 v[24:27], v1 offset:7168
 buffer_load_dwordx4 v[56:59], v1, s[4:7], s61 offen offset:2048 sc1 nt
 s_waitcnt lgkmcnt(3)
 v_smfmac_f32_16x16x64_bf16 v[8:11], v[28:31], a[136:143], v0
 v_smfmac_f32_16x16x64_bf16 v[16:19], v[28:31], v[40:47], v0
 ds_read_b128 v[40:43], v1 offset:49152
 ds_read_b128 v[44:47], v1 offset:50176
 s_add_u32 s3, s61, 4096
 buffer_load_dwordx4 v[60:63], v1, s[4:7], s3 offen offset:2048 sc1 nt
 v_smfmac_f32_16x16x64_bf16 v[12:15], v[28:31], a[128:135], v0
 v_smfmac_f32_16x16x64_bf16 v[20:23], v[28:31], v[192:199], v0
 ds_read_b128 v[28:31], v1 offset:9216
 s_waitcnt lgkmcnt(3)
 v_smfmac_f32_16x16x64_bf16 v[16:19], v[24:27], v[32:39], v0
 v_smfmac_f32_16x16x64_bf16 v[8:11], v[24:27], a[112:119], v0
 s_add_u32 s3, s61, 67112960
 buffer_load_dwordx4 v[32:35], v1, s[4:7], s3 offen offset:0 sc1 nt
 v_smfmac_f32_16x16x64_bf16 v[12:15], v[24:27], a[88:95], v0
 s_waitcnt lgkmcnt(1)
 v_smfmac_f32_16x16x64_bf16 v[20:23], v[24:27], v[40:47], v0
 ds_read_b128 v[40:43], v3 offset:49152
 ds_read_b128 v[44:47], v3 offset:49152
 buffer_load_dwordx4 v[36:39], v1, s[4:7], s3 offen offset:1024 sc1 nt
 s_waitcnt lgkmcnt(2)
 v_smfmac_f32_16x16x64_bf16 v[8:11], v[28:31], a[32:39], v0
 v_smfmac_f32_16x16x64_bf16 v[12:15], v[28:31], a[24:31], v0
 v_lshlrev_b32 v7, 3, v1
 v_smfmac_f32_16x16x64_bf16 v[16:19], v[28:31], v[232:239], v0
 s_waitcnt vmcnt(4)
 v_smfmac_f32_16x16x64_bf16 v[20:23], v[28:31], v[48:55], v0
 s_add_u32 s3, s61, 67633152
 buffer_load_dword v7, v7, s[4:7], s3 offen sc1
 ds_read_b128 v[52:55], v1 offset:0
 v_add_f32 v8, v8, v10
 v_add_f32 v11, v9, v11
 v_cvt_pk_bf16_f32 v9, v8, v11
 v_cvt_pk_bf16_f32 v8, v8, v11
 v_add_f32 v12, v12, v14
 v_add_f32 v15, v13, v15
 v_cvt_pk_bf16_f32 v13, v12, v15
 v_cvt_pk_bf16_f32 v12, v12, v15
 v_mfma_f32_16x16x16_bf16 v[8:11], v[8:9], v[4:5], 0
 v_mfma_f32_16x16x16_bf16 v[12:15], v[12:13], v[4:5], 0
 v_add_f32 v16, v16, v18
 v_add_f32 v19, v17, v19
 v_cvt_pk_bf16_f32 v17, v16, v19
 v_cvt_pk_bf16_f32 v16, v16, v19
 v_add_f32 v20, v20, v22
 v_add_f32 v23, v21, v23
 v_cvt_pk_bf16_f32 v21, v20, v23
 v_cvt_pk_bf16_f32 v20, v20, v23
 v_mfma_f32_16x16x16_bf16 v[16:19], v[16:17], v[4:5], 0
 v_mfma_f32_16x16x16_bf16 v[20:23], v[20:21], v[4:5], 0
 s_waitcnt lgkmcnt(2)
 v_smfmac_f32_16x16x64_bf16 v[40:43], v[24:27], v[80:87], v0
 s_waitcnt lgkmcnt(1)
 v_smfmac_f32_16x16x64_bf16 v[44:47], v[24:27], v[88:95], v0
 ds_read_b128 v[24:27], v1 offset:1024
 v_cvt_pk_bf16_f32 v15, v14, v15
 v_cvt_pk_bf16_f32 v14, v12, v13
 v_cvt_pk_bf16_f32 v13, v10, v11
 v_cvt_pk_bf16_f32 v12, v8, v9
 s_waitcnt vmcnt(4)
 s_nop 0
 v_mfma_f32_16x16x32_bf16 v[8:11], v[56:59], v[12:15], 0
 v_cvt_pk_bf16_f32 v23, v22, v23
 v_cvt_pk_bf16_f32 v22, v20, v21
 v_cvt_pk_bf16_f32 v21, v18, v19
 v_cvt_pk_bf16_f32 v20, v16, v17
 s_waitcnt vmcnt(3)
 v_mfma_f32_16x16x32_bf16 v[16:19], v[60:63], v[12:15], 0
 v_mfma_f32_16x16x32_bf16 v[48:51], v[20:23], v[12:15], 0
 v_smfmac_f32_16x16x64_bf16 v[40:43], v[28:31], v[112:119], v0
 v_smfmac_f32_16x16x64_bf16 v[44:47], v[28:31], v[120:127], v0
 ds_read_b128 v[28:31], v1 offset:2048
 s_waitcnt lgkmcnt(2)
 v_smfmac_f32_16x16x64_bf16 v[40:43], v[52:55], a[160:167], v0
 v_cndmask_b32 v8, v8, v16, s[70:71]
 v_cndmask_b32 v9, v9, v17, s[70:71]
 v_cndmask_b32 v10, v10, v18, s[70:71]
 v_cndmask_b32 v11, v11, v19, s[70:71]
 ds_write_b128 v1, v[8:11] offset:12288
 ds_write_b64 v1, v[48:49] offset:15360
 v_smfmac_f32_16x16x64_bf16 v[44:47], v[52:55], a[168:175], v0
 ds_read_b128 v[52:55], v1 offset:3072
 s_waitcnt lgkmcnt(4)
 v_smfmac_f32_16x16x64_bf16 v[40:43], v[24:27], a[176:183], v0
 v_smfmac_f32_16x16x64_bf16 v[44:47], v[24:27], a[184:191], v0
 ds_read_b128 v[24:27], v1 offset:4096
 s_waitcnt lgkmcnt(4)
 v_smfmac_f32_16x16x64_bf16 v[40:43], v[28:31], a[192:199], v0
 v_smfmac_f32_16x16x64_bf16 v[44:47], v[28:31], a[200:207], v0
 ds_read_b128 v[28:31], v1 offset:5120
 s_waitcnt lgkmcnt(2)
 v_smfmac_f32_16x16x64_bf16 v[40:43], v[52:55], a[208:215], v0
 v_smfmac_f32_16x16x64_bf16 v[44:47], v[52:55], a[216:223], v0
 ds_read_b128 v[52:55], v1 offset:6144
 s_barrier
 ds_read_b128 v[56:59], v1 offset:10240
 ds_read_b128 v[60:63], v1 offset:11264
 ds_read_b128 v[16:19], v1 offset:13312
 ds_read_b128 v[12:15], v1 offset:14336
 ds_read_b128 v[48:51], v1 offset:15360
 s_waitcnt lgkmcnt(7)
 v_smfmac_f32_16x16x64_bf16 v[40:43], v[24:27], a[224:231], v0
 s_mov_b64 exec, s[68:69]
 buffer_store_dwordx4 v[20:23], v6, s[4:7], s62 offen offset:1024 sc1
 s_mov_b64 exec, -1
 v_smfmac_f32_16x16x64_bf16 v[44:47], v[24:27], a[232:239], v0
 ds_read_b128 v[24:27], v1 offset:8192
 s_waitcnt lgkmcnt(7)
 v_smfmac_f32_16x16x64_bf16 v[40:43], v[28:31], a[240:247], v0
 v_smfmac_f32_16x16x64_bf16 v[44:47], v[28:31], a[248:255], v0
 s_waitcnt lgkmcnt(6)
 v_smfmac_f32_16x16x64_bf16 v[40:43], v[52:55], v[64:71], v0
 v_smfmac_f32_16x16x64_bf16 v[44:47], v[52:55], v[72:79], v0
 s_waitcnt lgkmcnt(0)
 v_smfmac_f32_16x16x64_bf16 v[40:43], v[24:27], v[96:103], v0
 v_smfmac_f32_16x16x64_bf16 v[44:47], v[24:27], v[104:111], v0
 v_pk_add_f32 v[8:9], v[8:9], v[56:57]
 v_pk_add_f32 v[10:11], v[10:11], v[58:59]
 v_pk_add_f32 v[60:61], v[60:61], v[16:17]
 v_pk_add_f32 v[62:63], v[62:63], v[18:19]
 v_pk_add_f32 v[12:13], v[12:13], v[14:15]
 v_pk_add_f32 v[48:49], v[48:49], v[50:51]
 v_pk_add_f32 v[8:9], v[8:9], v[60:61]
 v_pk_add_f32 v[10:11], v[10:11], v[62:63]
 v_pk_add_f32 v[48:49], v[12:13], v[48:49]
 v_max3_f32 v50, v8, v9, v10
 v_max3_f32 v50, v50, v11, v48
 v_max_f32 v50, v50, v49
 v_add_f32 v40, v40, v42
 v_add_f32 v41, v41, v43
 v_max_f32_dpp v50, v50, v50 quad_perm:[2,3,0,1] row_mask:0xf bank_mask:0xf
 v_mov_b32 v51, v50
 v_add_f32 v44, v44, v46
 v_add_f32 v45, v45, v47
 v_permlane16_swap_b32 v50, v51
 v_max_f32 v50, v50, v51
 v_mov_b32 v51, v50
 v_cvt_pk_bf16_f32 v40, v40, v41
 v_cvt_pk_bf16_f32 v41, v44, v45
 v_permlane32_swap_b32 v50, v51
 v_max_f32 v50, v50, v51
 v_mul_f32 v50, s56, v50
 v_fma_f32 v48, v48, s56, -v50
 v_fma_f32 v49, v49, s56, -v50
 v_fma_f32 v8, v8, s56, -v50
 v_fma_f32 v9, v9, s56, -v50
 v_fma_f32 v10, v10, s56, -v50
 v_fma_f32 v11, v11, s56, -v50
 v_exp_f32 v48, v48
 v_lshrrev_b32 v51, 1, v1
 v_exp_f32 v49, v49
 ds_read_b128 v[56:59], v3 offset:32768
 ds_read_b128 v[60:63], v3 offset:33792
 v_exp_f32 v8, v8
 v_exp_f32 v9, v9
 ds_read_b128 v[24:27], v3 offset:4096
 ds_read_b128 v[28:31], v3 offset:5120
 v_exp_f32 v10, v10
 buffer_store_dwordx2 v[40:41], v51, s[4:7], s62 offen offset:3072 sc1
 v_exp_f32 v11, v11
 v_cvt_pk_bf16_f32 v14, v48, v49
 v_cvt_pk_bf16_f32 v12, v8, v9
 v_cvt_pk_bf16_f32 v13, v10, v11
 v_cndmask_b32 v52, 0, v14, s[68:69]
 v_cndmask_b32 v53, 0, v14, s[70:71]
 v_cndmask_b32 v22, 0, v12, s[70:71]
 v_cndmask_b32 v23, 0, v13, s[70:71]
 v_mfma_f32_16x16x16_bf16 v[44:47], v[40:41], v[52:53], 0
 v_cndmask_b32 v16, 0, v12, s[68:69]
 v_cndmask_b32 v17, 0, v13, s[68:69]
 v_mov_b32_dpp v18, v22 quad_perm:[2,3,0,1] row_mask:0xf bank_mask:0xf
 v_mov_b32_dpp v19, v23 quad_perm:[2,3,0,1] row_mask:0xf bank_mask:0xf
 v_mov_b32_dpp v20, v16 quad_perm:[2,3,0,1] row_mask:0xf bank_mask:0xf
 v_mov_b32_dpp v21, v17 quad_perm:[2,3,0,1] row_mask:0xf bank_mask:0xf
 s_waitcnt vmcnt(4)
 v_mfma_f32_16x16x32_bf16 v[44:47], v[32:35], v[16:19], v[44:47]
 v_add_f32 v54, v8, v9
 v_add_f32 v55, v48, v49
 s_waitcnt vmcnt(3)
 v_mfma_f32_16x16x32_bf16 v[44:47], v[36:39], v[20:23], v[44:47]
 v_add_f32 v54, v54, v10
 v_fma_f32 v55, v55, 0.5, v11
 v_add_f32 v54, v54, v55
 ds_read_b128 v[16:19], v3 offset:49152
 ds_read_b128 v[20:23], v3 offset:49152
 v_add_f32_dpp v54, v54, v54 quad_perm:[2,3,0,1] row_mask:0xf bank_mask:0xf
 v_mov_b32 v55, v54
 ds_read_b128 v[32:35], v3 offset:49152
 ds_read_b128 v[36:39], v3 offset:49152
 v_permlane16_swap_b32 v54, v55
 v_add_f32 v54, v54, v55
 v_mov_b32 v55, v54
 ds_read_b128 v[8:11], v3 offset:49152
 s_cmp_eq_u32 s54, 63
 v_permlane32_swap_b32 v54, v55
 v_add_f32 v54, v54, v55
 v_rcp_f32 v54, v54
 s_cbranch_scc1 L_ch2_end
 v_mul_f32 v44, v44, v54
 v_mul_f32 v45, v45, v54
 v_cvt_pk_bf16_f32 v42, v44, v45
 v_mul_f32 v46, v46, v54
 v_mul_f32 v47, v47, v54
 v_cvt_pk_bf16_f32 v43, v46, v47
 ds_write_b64 v6, v[42:43] offset:1024
 v_and_b32 v40, -9, v6
 v_mov_b32_dpp v12, v42 quad_perm:[0,1,0,1] row_mask:0xf bank_mask:0xf
 v_mov_b32_dpp v14, v42 quad_perm:[2,3,2,3] row_mask:0xf bank_mask:0xf
 v_mov_b32_dpp v13, v43 quad_perm:[0,1,0,1] row_mask:0xf bank_mask:0xf
 v_mov_b32_dpp v15, v43 quad_perm:[2,3,2,3] row_mask:0xf bank_mask:0xf
 s_waitcnt lgkmcnt(5)
 s_nop 0
 v_smfmac_f32_16x16x64_bf16 v[16:19], v[12:15], a[16:23], v0
 s_waitcnt lgkmcnt(4)
 v_smfmac_f32_16x16x64_bf16 v[20:23], v[12:15], a[48:55], v0
 s_waitcnt lgkmcnt(0)
 s_barrier
 ds_read_b128 v[48:51], v40 offset:0
 ds_read_b128 v[52:55], v40 offset:512
 ds_read_b128 v[44:47], v40 offset:1536
 v_smfmac_f32_16x16x64_bf16 v[32:35], v[12:15], v[56:63], v0
 ds_read_b128 v[56:59], v3 offset:38912
 ds_read_b128 v[60:63], v3 offset:39936
 s_mov_b32 m0, 4096
 v_smfmac_f32_16x16x64_bf16 v[36:39], v[12:15], v[24:31], v0
 ds_read_b128 v[24:27], v3 offset:36864
 ds_read_b128 v[28:31], v3 offset:37888
 buffer_load_dwordx4 v1, s[4:7], s81 offen offset:0 lds
 v_smfmac_f32_16x16x64_bf16 v[8:11], v[12:15], a[144:151], v0
 s_mov_b32 m0, 4096
 s_waitcnt lgkmcnt(6)
 v_smfmac_f32_16x16x64_bf16 v[16:19], v[48:51], a[0:7], v0
 buffer_load_dwordx4 v1, s[4:7], s81 offen offset:1024 lds
 s_waitcnt lgkmcnt(5)
 v_smfmac_f32_16x16x64_bf16 v[16:19], v[52:55], a[8:15], v0
 s_mov_b32 m0, 6144
 s_waitcnt lgkmcnt(2)
 v_smfmac_f32_16x16x64_bf16 v[16:19], v[44:47], v[56:63], v0
 ds_read_b128 v[56:59], v3 offset:34816
 ds_read_b128 v[60:63], v3 offset:35840
 buffer_load_dwordx4 v1, s[4:7], s81 offen offset:2048 lds
 s_waitcnt lgkmcnt(2)
 v_smfmac_f32_16x16x64_bf16 v[20:23], v[48:51], v[24:31], v0
 ds_read_b128 v[24:27], v3 offset:6144
 ds_read_b128 v[28:31], v3 offset:7168
 v_smfmac_f32_16x16x64_bf16 v[20:23], v[52:55], a[40:47], v0
 v_smfmac_f32_16x16x64_bf16 v[20:23], v[44:47], a[56:63], v0
 v_cvt_pk_bf16_f32 v16, v16, v17
 v_smfmac_f32_16x16x64_bf16 v[32:35], v[48:51], a[64:71], v0
 v_cvt_pk_bf16_f32 v17, v18, v19
 s_waitcnt lgkmcnt(2)
 v_smfmac_f32_16x16x64_bf16 v[32:35], v[52:55], v[56:63], v0
 ds_read_b128 v[56:59], v3 offset:2048
 ds_read_b128 v[60:63], v3 offset:3072
 v_and_or_b32 v16, v16, -2, s55
 s_waitcnt lgkmcnt(2)
 v_smfmac_f32_16x16x64_bf16 v[32:35], v[44:47], v[24:31], v0
 ds_read_b128 v[24:27], v3 offset:0
 ds_read_b128 v[28:31], v3 offset:1024
 v_cvt_pk_bf16_f32 v18, v20, v21
 v_smfmac_f32_16x16x64_bf16 v[36:39], v[48:51], a[96:103], v0
 v_cvt_pk_bf16_f32 v19, v22, v23
 v_smfmac_f32_16x16x64_bf16 v[36:39], v[52:55], a[104:111], v0
 v_and_or_b32 v18, v18, -2, s55
 buffer_store_dwordx4 v[16:19], v1, s[4:7], s60 offen offset:0
 v_smfmac_f32_16x16x64_bf16 v[36:39], v[44:47], a[120:127], v0
 v_cvt_pk_bf16_f32 v32, v32, v33
 s_waitcnt lgkmcnt(2)
 v_smfmac_f32_16x16x64_bf16 v[8:11], v[48:51], v[56:63], v0
 v_cvt_pk_bf16_f32 v33, v34, v35
 s_waitcnt lgkmcnt(0)
 v_smfmac_f32_16x16x64_bf16 v[8:11], v[52:55], v[24:31], v0
 v_and_or_b32 v32, v32, -2, s55
 v_smfmac_f32_16x16x64_bf16 v[8:11], v[44:47], a[152:159], v0
 v_cvt_pk_bf16_f32 v34, v36, v37
 v_cvt_pk_bf16_f32 v35, v38, v39
 v_and_or_b32 v34, v34, -2, s55
 buffer_store_dwordx4 v[32:35], v1, s[4:7], s60 offen offset:1024
 s_nop 3
 v_cvt_pk_bf16_f32 v8, v8, v9
 v_cvt_pk_bf16_f32 v9, v10, v11
 v_and_or_b32 v8, v8, -2, s55
 buffer_store_dwordx2 v[8:9], v1, s[4:7], s16 offen offset:0
 buffer_load_dwordx4 v[32:35], v1, s[4:7], s63 offen offset:2048
 buffer_load_dwordx4 v[36:39], v1, s[4:7], s63 offen offset:3072
 s_add_u32 s54, s54, 1
 s_add_u32 s61, s61, 524288
 s_and_b32 s3, s54, 3
 s_cselect_b32 s3, 1, -3
 s_lshl_b32 s3, s3, 17
 s_add_u32 s62, s62, s3
 s_and_b32 s3, s54, 3
 s_cselect_b32 s3, 1, -3
 s_lshl_b32 s3, s3, 14
 s_add_u32 s57, s57, s3
 s_add_u32 s59, s59, s3
 s_xor_b32 s58, s57, 32768
 v_lshrrev_b32 v56, 6, v1
 v_mul_u32_u24 v56, 10240, v56
 v_and_b32 v60, 48, v1
 v_add_u32 v56, v56, v60
 v_and_b32 v57, 32, v1
 v_and_b32 v60, 64, v1
 v_lshl_add_u32 v57, v60, 2, v57
 v_bfe_u32 v60, v1, 8, 1
 v_lshl_add_u32 v57, v60, 4, v57
 v_bfe_u32 v60, v1, 4, 1
 v_lshl_add_u32 v57, v60, 3, v57
 v_mov_b32 v60, 0x3f80
 v_mov_b32 v28, 0x3f800000
 v_cndmask_b32 v60, v60, v28, s[82:83]
 v_cndmask_b32 v28, 0, v60, s[72:73]
 v_cndmask_b32 v29, 0, v60, s[74:75]
 v_cndmask_b32 v30, 0, v60, s[76:77]
 v_cndmask_b32 v31, 0, v60, s[78:79]
 v_mov_b64 v[58:59], -1
 s_mov_b64 exec, s[84:85]
 buffer_store_dwordx2 v[58:59], v57, s[4:7], s58 offen
 s_mov_b64 exec, -1
 s_nop 15
 s_nop 15
 s_nop 15
 s_nop 15
 s_nop 15
 s_mov_b32 s51, 0
 buffer_load_dwordx4 v[8:11], v56, s[4:7], s64 offen sc1
 buffer_load_dwordx4 v[12:15], v56, s[4:7], s65 offen sc1
L_pp_195:
 s_waitcnt vmcnt(1)
 v_mfma_f32_16x16x32_bf16 v[24:27], v[28:31], v[8:11], 0
 v_bitop3_b32 v60, v8, v10, s55 bitop3:0x7e
 s_waitcnt vmcnt(0)
 v_mfma_f32_16x16x32_bf16 v[24:27], v[28:31], v[12:15], v[24:27]
 v_bitop3_b32 v61, v12, v14, s55 bitop3:0x7e
 v_bitop3_b32 v7, v60, v61, 1 bitop3:0xa8
 v_cmp_ne_u32 vcc, 0, v7
 s_cbranch_vccnz L_rt_196
 s_nop 3
 v_add_f32_dpp v24, v24, v24 row_ror:8 row_mask:0xf bank_mask:0xf
 v_add_f32_dpp v25, v25, v25 row_ror:8 row_mask:0xf bank_mask:0xf
 v_add_f32_dpp v26, v26, v26 row_ror:8 row_mask:0xf bank_mask:0xf
 v_add_f32_dpp v27, v27, v27 row_ror:8 row_mask:0xf bank_mask:0xf
 v_add_f32_dpp v24, v24, v24 row_ror:4 row_mask:0xf bank_mask:0xf
 v_add_f32_dpp v25, v25, v25 row_ror:4 row_mask:0xf bank_mask:0xf
 v_add_f32_dpp v26, v26, v26 row_ror:4 row_mask:0xf bank_mask:0xf
 v_add_f32_dpp v27, v27, v27 row_ror:4 row_mask:0xf bank_mask:0xf
 s_mov_b64 exec, s[84:85]
 v_cvt_pk_bf16_f32 v24, v24, v25
 v_cvt_pk_bf16_f32 v25, v26, v27
 buffer_store_dwordx2 v[24:25], v57, s[4:7], s57 offen
 s_mov_b64 exec, -1
 s_xor_b32 s55, s55, 1
 ds_read_b128 v[40:43], v1 offset:4096
 ds_read_b128 v[44:47], v1 offset:5120
 ds_read_b128 v[48:51], v1 offset:8192
 buffer_load_dwordx4 v[52:55], v1, s[4:7], s81 offen offset:3072
 buffer_load_dwordx4 v[56:59], v1, s[4:7], s101 offen offset:0
 buffer_load_dwordx4 v[60:63], v1, s[4:7], s101 offen offset:1024
 ds_read_b128 v[8:11], v3 offset:49152
 ds_read_b128 v[16:19], v3 offset:49152
 ds_read_b128 v[20:23], v3 offset:49152
 s_waitcnt lgkmcnt(0)
 s_nop 15
 s_nop 15
 s_nop 7
 s_branch L_ch2_f
L_rt_194:
 s_add_u32 s51, s51, 1
 s_cmp_lt_u32 s51, 131072
 s_cbranch_scc1 L_pm_193
 s_branch L_bail
L_rt_196:
 buffer_load_dwordx4 v[8:11], v56, s[4:7], s64 offen sc1
 buffer_load_dwordx4 v[12:15], v56, s[4:7], s65 offen sc1
 s_add_u32 s51, s51, 1
 s_cmp_lt_u32 s51, 131072
 s_cbranch_scc1 L_pp_195
 s_branch L_bail
.p2align 6
L_ch2_s:
 s_mov_b32 s51, 0
L_pm_197:
 buffer_load_dwordx4 v[24:27], v1, s[4:7], s59 offen offset:0 sc1
 buffer_load_dwordx4 v[28:31], v1, s[4:7], s59 offen offset:1024 sc1
 s_add_u32 s3, s59, 4096
 buffer_load_dwordx4 v[12:15], v1, s[4:7], s3 offen offset:0 sc1
 s_waitcnt vmcnt(2)
 ds_write_b128 v1, v[24:27] offset:4096
 v_max_u32 v7, v24, v26
 s_waitcnt vmcnt(1)
 ds_write_b128 v1, v[28:31] offset:5120
 v_max3_u32 v7, v7, v28, v30
 s_waitcnt vmcnt(0)
 ds_write_b128 v1, v[12:15] offset:8192
 v_max3_u32 v7, v7, v12, v14
 v_cmp_eq_u32 vcc, -1, v7
 s_cbranch_vccnz L_rt_198
 ds_read_b128 v[12:15], v3 offset:49152
 v_smfmac_f32_16x16x64_bf16 v[16:19], v[24:27], v[32:39], v0
 ds_read_b128 v[32:35], v1 offset:26624
 ds_read_b128 v[36:39], v1 offset:27648
 v_smfmac_f32_16x16x64_bf16 v[20:23], v[24:27], v[40:47], v0
 ds_read_b128 v[40:43], v1 offset:24576
 ds_read_b128 v[44:47], v1 offset:25600
 v_smfmac_f32_16x16x64_bf16 v[16:19], v[28:31], v[48:55], v0
 v_smfmac_f32_16x16x64_bf16 v[20:23], v[28:31], v[56:63], v0
 s_waitcnt lgkmcnt(5)
 s_barrier
 buffer_load_dwordx4 v[56:59], v1, s[4:7], s63 offen offset:0
 v_smfmac_f32_16x16x64_bf16 v[8:11], v[24:27], v[168:175], v0
 s_waitcnt lgkmcnt(4)
 v_smfmac_f32_16x16x64_bf16 v[12:15], v[24:27], v[160:167], v0
 ds_read_b128 v[24:27], v1 offset:8192
 buffer_load_dwordx4 v[60:63], v1, s[4:7], s63 offen offset:1024
 v_smfmac_f32_16x16x64_bf16 v[8:11], v[28:31], v[144:151], v0
 v_smfmac_f32_16x16x64_bf16 v[12:15], v[28:31], v[128:135], v0
 ds_read_b128 v[28:31], v1 offset:0
 buffer_load_dwordx4 v[48:51], v1, s[4:7], s101 offen offset:2048
 s_waitcnt lgkmcnt(1)
 v_smfmac_f32_16x16x64_bf16 v[16:19], v[24:27], v[32:39], v0
 ds_read_b128 v[32:35], v2 offset:22528
 ds_read_b128 v[36:39], v2 offset:23552
 v_smfmac_f32_16x16x64_bf16 v[8:11], v[24:27], a[80:87], v0
 buffer_load_dwordx4 v[52:55], v1, s[4:7], s101 offen offset:3072
 v_smfmac_f32_16x16x64_bf16 v[12:15], v[24:27], a[72:79], v0
 v_smfmac_f32_16x16x64_bf16 v[20:23], v[24:27], v[40:47], v0
 ds_read_b128 v[40:43], v2 offset:20480
 ds_read_b128 v[44:47], v2 offset:21504
 ds_read_b128 v[24:27], v1 offset:1024
 s_waitcnt lgkmcnt(5)
 v_smfmac_f32_16x16x64_bf16 v[8:11], v[28:31], v[240:247], v0
 v_smfmac_f32_16x16x64_bf16 v[12:15], v[28:31], v[248:255], v0
 s_waitcnt lgkmcnt(3)
 v_smfmac_f32_16x16x64_bf16 v[16:19], v[28:31], v[32:39], v0
 ds_read_b128 v[32:35], v2 offset:18432
 ds_read_b128 v[36:39], v2 offset:19456
 v_smfmac_f32_16x16x64_bf16 v[20:23], v[28:31], v[136:143], v0
 ds_read_b128 v[28:31], v1 offset:2048
 s_waitcnt lgkmcnt(3)
 v_smfmac_f32_16x16x64_bf16 v[8:11], v[24:27], v[224:231], v0
 v_smfmac_f32_16x16x64_bf16 v[16:19], v[24:27], v[40:47], v0
 ds_read_b128 v[40:43], v2 offset:16384
 ds_read_b128 v[44:47], v2 offset:17408
 v_smfmac_f32_16x16x64_bf16 v[12:15], v[24:27], v[216:223], v0
 v_smfmac_f32_16x16x64_bf16 v[20:23], v[24:27], v[152:159], v0
 ds_read_b128 v[24:27], v1 offset:3072
 s_waitcnt lgkmcnt(3)
 v_smfmac_f32_16x16x64_bf16 v[16:19], v[28:31], v[32:39], v0
 ds_read_b128 v[32:35], v1 offset:55296
 ds_read_b128 v[36:39], v1 offset:56320
 v_smfmac_f32_16x16x64_bf16 v[8:11], v[28:31], v[208:215], v0
 v_smfmac_f32_16x16x64_bf16 v[12:15], v[28:31], v[200:207], v0
 s_waitcnt lgkmcnt(3)
 v_smfmac_f32_16x16x64_bf16 v[20:23], v[28:31], v[40:47], v0
 ds_read_b128 v[40:43], v1 offset:53248
 ds_read_b128 v[44:47], v1 offset:54272
 ds_read_b128 v[28:31], v1 offset:6144
 s_waitcnt lgkmcnt(5)
 v_smfmac_f32_16x16x64_bf16 v[8:11], v[24:27], v[184:191], v0
 v_smfmac_f32_16x16x64_bf16 v[12:15], v[24:27], v[176:183], v0
 s_waitcnt lgkmcnt(3)
 v_smfmac_f32_16x16x64_bf16 v[16:19], v[24:27], v[32:39], v0
 ds_read_b128 v[32:35], v1 offset:51200
 ds_read_b128 v[36:39], v1 offset:52224
 s_waitcnt vmcnt(2)
 v_smfmac_f32_16x16x64_bf16 v[20:23], v[24:27], v[56:63], v0
 ds_read_b128 v[24:27], v1 offset:7168
 buffer_load_dwordx4 v[56:59], v1, s[4:7], s61 offen offset:2048 sc1 nt
 s_waitcnt lgkmcnt(3)
 v_smfmac_f32_16x16x64_bf16 v[8:11], v[28:31], a[136:143], v0
 v_smfmac_f32_16x16x64_bf16 v[16:19], v[28:31], v[40:47], v0
 ds_read_b128 v[40:43], v1 offset:49152
 ds_read_b128 v[44:47], v1 offset:50176
 s_add_u32 s3, s61, 4096
 buffer_load_dwordx4 v[60:63], v1, s[4:7], s3 offen offset:2048 sc1 nt
 v_smfmac_f32_16x16x64_bf16 v[12:15], v[28:31], a[128:135], v0
 v_smfmac_f32_16x16x64_bf16 v[20:23], v[28:31], v[192:199], v0
 ds_read_b128 v[28:31], v1 offset:9216
 s_waitcnt lgkmcnt(3)
 v_smfmac_f32_16x16x64_bf16 v[16:19], v[24:27], v[32:39], v0
 v_smfmac_f32_16x16x64_bf16 v[8:11], v[24:27], a[112:119], v0
 s_add_u32 s3, s61, 67112960
 buffer_load_dwordx4 v[32:35], v1, s[4:7], s3 offen offset:0 sc1 nt
 v_smfmac_f32_16x16x64_bf16 v[12:15], v[24:27], a[88:95], v0
 s_waitcnt lgkmcnt(1)
 v_smfmac_f32_16x16x64_bf16 v[20:23], v[24:27], v[40:47], v0
 ds_read_b128 v[40:43], v3 offset:49152
 ds_read_b128 v[44:47], v3 offset:49152
 buffer_load_dwordx4 v[36:39], v1, s[4:7], s3 offen offset:1024 sc1 nt
 s_waitcnt lgkmcnt(2)
 v_smfmac_f32_16x16x64_bf16 v[8:11], v[28:31], a[32:39], v0
 v_smfmac_f32_16x16x64_bf16 v[12:15], v[28:31], a[24:31], v0
 v_lshlrev_b32 v7, 3, v1
 v_smfmac_f32_16x16x64_bf16 v[16:19], v[28:31], v[232:239], v0
 s_waitcnt vmcnt(4)
 v_smfmac_f32_16x16x64_bf16 v[20:23], v[28:31], v[48:55], v0
 s_add_u32 s3, s61, 67633152
 buffer_load_dword v7, v7, s[4:7], s3 offen sc1
 ds_read_b128 v[52:55], v1 offset:0
 v_add_f32 v8, v8, v10
 v_add_f32 v11, v9, v11
 v_cvt_pk_bf16_f32 v9, v8, v11
 v_cvt_pk_bf16_f32 v8, v8, v11
 v_add_f32 v12, v12, v14
 v_add_f32 v15, v13, v15
 v_cvt_pk_bf16_f32 v13, v12, v15
 v_cvt_pk_bf16_f32 v12, v12, v15
 v_mfma_f32_16x16x16_bf16 v[8:11], v[8:9], v[4:5], 0
 v_mfma_f32_16x16x16_bf16 v[12:15], v[12:13], v[4:5], 0
 v_add_f32 v16, v16, v18
 v_add_f32 v19, v17, v19
 v_cvt_pk_bf16_f32 v17, v16, v19
 v_cvt_pk_bf16_f32 v16, v16, v19
 v_add_f32 v20, v20, v22
 v_add_f32 v23, v21, v23
 v_cvt_pk_bf16_f32 v21, v20, v23
 v_cvt_pk_bf16_f32 v20, v20, v23
 v_mfma_f32_16x16x16_bf16 v[16:19], v[16:17], v[4:5], 0
 v_mfma_f32_16x16x16_bf16 v[20:23], v[20:21], v[4:5], 0
 s_waitcnt lgkmcnt(2)
 v_smfmac_f32_16x16x64_bf16 v[40:43], v[24:27], v[80:87], v0
 s_waitcnt lgkmcnt(1)
 v_smfmac_f32_16x16x64_bf16 v[44:47], v[24:27], v[88:95], v0
 ds_read_b128 v[24:27], v1 offset:1024
 v_cvt_pk_bf16_f32 v15, v14, v15
 v_cvt_pk_bf16_f32 v14, v12, v13
 v_cvt_pk_bf16_f32 v13, v10, v11
 v_cvt_pk_bf16_f32 v12, v8, v9
 s_waitcnt vmcnt(4)
 s_nop 0
 v_mfma_f32_16x16x32_bf16 v[8:11], v[56:59], v[12:15], 0
 v_cvt_pk_bf16_f32 v23, v22, v23
 v_cvt_pk_bf16_f32 v22, v20, v21
 v_cvt_pk_bf16_f32 v21, v18, v19
 v_cvt_pk_bf16_f32 v20, v16, v17
 s_waitcnt vmcnt(3)
 v_mfma_f32_16x16x32_bf16 v[16:19], v[60:63], v[12:15], 0
 v_mfma_f32_16x16x32_bf16 v[48:51], v[20:23], v[12:15], 0
 v_smfmac_f32_16x16x64_bf16 v[40:43], v[28:31], v[112:119], v0
 v_smfmac_f32_16x16x64_bf16 v[44:47], v[28:31], v[120:127], v0
 ds_read_b128 v[28:31], v1 offset:2048
 s_waitcnt lgkmcnt(2)
 v_smfmac_f32_16x16x64_bf16 v[40:43], v[52:55], a[160:167], v0
 v_cndmask_b32 v8, v8, v16, s[70:71]
 v_cndmask_b32 v9, v9, v17, s[70:71]
 v_cndmask_b32 v10, v10, v18, s[70:71]
 v_cndmask_b32 v11, v11, v19, s[70:71]
 ds_write_b128 v1, v[8:11] offset:12288
 ds_write_b64 v1, v[48:49] offset:15360
 v_smfmac_f32_16x16x64_bf16 v[44:47], v[52:55], a[168:175], v0
 ds_read_b128 v[52:55], v1 offset:3072
 s_waitcnt lgkmcnt(4)
 v_smfmac_f32_16x16x64_bf16 v[40:43], v[24:27], a[176:183], v0
 v_smfmac_f32_16x16x64_bf16 v[44:47], v[24:27], a[184:191], v0
 ds_read_b128 v[24:27], v1 offset:4096
 s_waitcnt lgkmcnt(4)
 v_smfmac_f32_16x16x64_bf16 v[40:43], v[28:31], a[192:199], v0
 v_smfmac_f32_16x16x64_bf16 v[44:47], v[28:31], a[200:207], v0
 ds_read_b128 v[28:31], v1 offset:5120
 s_waitcnt lgkmcnt(2)
 v_smfmac_f32_16x16x64_bf16 v[40:43], v[52:55], a[208:215], v0
 v_smfmac_f32_16x16x64_bf16 v[44:47], v[52:55], a[216:223], v0
 ds_read_b128 v[52:55], v1 offset:6144
 s_barrier
 ds_read_b128 v[56:59], v1 offset:10240
 ds_read_b128 v[60:63], v1 offset:11264
 ds_read_b128 v[16:19], v1 offset:13312
 ds_read_b128 v[12:15], v1 offset:14336
 ds_read_b128 v[48:51], v1 offset:15360
 s_waitcnt lgkmcnt(7)
 v_smfmac_f32_16x16x64_bf16 v[40:43], v[24:27], a[224:231], v0
 s_mov_b64 exec, s[68:69]
 buffer_store_dwordx4 v[20:23], v6, s[4:7], s62 offen offset:1024 sc1
 s_mov_b64 exec, -1
 v_smfmac_f32_16x16x64_bf16 v[44:47], v[24:27], a[232:239], v0
 ds_read_b128 v[24:27], v1 offset:8192
 s_waitcnt lgkmcnt(7)
 v_smfmac_f32_16x16x64_bf16 v[40:43], v[28:31], a[240:247], v0
 v_smfmac_f32_16x16x64_bf16 v[44:47], v[28:31], a[248:255], v0
 s_waitcnt lgkmcnt(6)
 v_smfmac_f32_16x16x64_bf16 v[40:43], v[52:55], v[64:71], v0
 v_smfmac_f32_16x16x64_bf16 v[44:47], v[52:55], v[72:79], v0
 s_waitcnt lgkmcnt(0)
 v_smfmac_f32_16x16x64_bf16 v[40:43], v[24:27], v[96:103], v0
 v_smfmac_f32_16x16x64_bf16 v[44:47], v[24:27], v[104:111], v0
 v_pk_add_f32 v[8:9], v[8:9], v[56:57]
 v_pk_add_f32 v[10:11], v[10:11], v[58:59]
 v_pk_add_f32 v[60:61], v[60:61], v[16:17]
 v_pk_add_f32 v[62:63], v[62:63], v[18:19]
 v_pk_add_f32 v[12:13], v[12:13], v[14:15]
 v_pk_add_f32 v[48:49], v[48:49], v[50:51]
 v_pk_add_f32 v[8:9], v[8:9], v[60:61]
 v_pk_add_f32 v[10:11], v[10:11], v[62:63]
 v_pk_add_f32 v[48:49], v[12:13], v[48:49]
 v_max3_f32 v50, v8, v9, v10
 v_max3_f32 v50, v50, v11, v48
 v_max_f32 v50, v50, v49
 v_add_f32 v40, v40, v42
 v_add_f32 v41, v41, v43
 v_max_f32_dpp v50, v50, v50 quad_perm:[2,3,0,1] row_mask:0xf bank_mask:0xf
 v_mov_b32 v51, v50
 v_add_f32 v44, v44, v46
 v_add_f32 v45, v45, v47
 v_permlane16_swap_b32 v50, v51
 v_max_f32 v50, v50, v51
 v_mov_b32 v51, v50
 v_cvt_pk_bf16_f32 v40, v40, v41
 v_cvt_pk_bf16_f32 v41, v44, v45
 v_permlane32_swap_b32 v50, v51
 v_max_f32 v50, v50, v51
 v_mul_f32 v50, s56, v50
 v_fma_f32 v48, v48, s56, -v50
 v_fma_f32 v49, v49, s56, -v50
 v_fma_f32 v8, v8, s56, -v50
 v_fma_f32 v9, v9, s56, -v50
 v_fma_f32 v10, v10, s56, -v50
 v_fma_f32 v11, v11, s56, -v50
 v_exp_f32 v48, v48
 v_lshrrev_b32 v51, 1, v1
 v_exp_f32 v49, v49
 ds_read_b128 v[56:59], v3 offset:32768
 ds_read_b128 v[60:63], v3 offset:33792
 v_exp_f32 v8, v8
 v_exp_f32 v9, v9
 ds_read_b128 v[24:27], v3 offset:4096
 ds_read_b128 v[28:31], v3 offset:5120
 v_exp_f32 v10, v10
 buffer_store_dwordx2 v[40:41], v51, s[4:7], s62 offen offset:3072 sc1
 v_exp_f32 v11, v11
 v_cvt_pk_bf16_f32 v14, v48, v49
 v_cvt_pk_bf16_f32 v12, v8, v9
 v_cvt_pk_bf16_f32 v13, v10, v11
 v_cndmask_b32 v52, 0, v14, s[68:69]
 v_cndmask_b32 v53, 0, v14, s[70:71]
 v_cndmask_b32 v22, 0, v12, s[70:71]
 v_cndmask_b32 v23, 0, v13, s[70:71]
 v_mfma_f32_16x16x16_bf16 v[44:47], v[40:41], v[52:53], 0
 v_cndmask_b32 v16, 0, v12, s[68:69]
 v_cndmask_b32 v17, 0, v13, s[68:69]
 v_mov_b32_dpp v18, v22 quad_perm:[2,3,0,1] row_mask:0xf bank_mask:0xf
 v_mov_b32_dpp v19, v23 quad_perm:[2,3,0,1] row_mask:0xf bank_mask:0xf
 v_mov_b32_dpp v20, v16 quad_perm:[2,3,0,1] row_mask:0xf bank_mask:0xf
 v_mov_b32_dpp v21, v17 quad_perm:[2,3,0,1] row_mask:0xf bank_mask:0xf
 s_waitcnt vmcnt(4)
 v_mfma_f32_16x16x32_bf16 v[44:47], v[32:35], v[16:19], v[44:47]
 v_add_f32 v54, v8, v9
 v_add_f32 v55, v48, v49
 s_waitcnt vmcnt(3)
 v_mfma_f32_16x16x32_bf16 v[44:47], v[36:39], v[20:23], v[44:47]
 v_add_f32 v54, v54, v10
 v_fma_f32 v55, v55, 0.5, v11
 v_add_f32 v54, v54, v55
 ds_read_b128 v[16:19], v3 offset:49152
 ds_read_b128 v[20:23], v3 offset:49152
 v_add_f32_dpp v54, v54, v54 quad_perm:[2,3,0,1] row_mask:0xf bank_mask:0xf
 v_mov_b32 v55, v54
 ds_read_b128 v[32:35], v3 offset:49152
 ds_read_b128 v[36:39], v3 offset:49152
 v_permlane16_swap_b32 v54, v55
 v_add_f32 v54, v54, v55
 v_mov_b32 v55, v54
 ds_read_b128 v[8:11], v3 offset:49152
 s_cmp_eq_u32 s54, 63
 v_permlane32_swap_b32 v54, v55
 v_add_f32 v54, v54, v55
 v_rcp_f32 v54, v54
 s_cbranch_scc1 L_ch2_end
 v_mul_f32 v44, v44, v54
 v_mul_f32 v45, v45, v54
 v_cvt_pk_bf16_f32 v42, v44, v45
 v_mul_f32 v46, v46, v54
 v_mul_f32 v47, v47, v54
 v_cvt_pk_bf16_f32 v43, v46, v47
 ds_write_b64 v6, v[42:43] offset:1024
 v_and_b32 v40, -9, v6
 v_mov_b32_dpp v12, v42 quad_perm:[0,1,0,1] row_mask:0xf bank_mask:0xf
 v_mov_b32_dpp v14, v42 quad_perm:[2,3,2,3] row_mask:0xf bank_mask:0xf
 v_mov_b32_dpp v13, v43 quad_perm:[0,1,0,1] row_mask:0xf bank_mask:0xf
 v_mov_b32_dpp v15, v43 quad_perm:[2,3,2,3] row_mask:0xf bank_mask:0xf
 s_waitcnt lgkmcnt(5)
 s_nop 0
 v_smfmac_f32_16x16x64_bf16 v[16:19], v[12:15], a[16:23], v0
 s_waitcnt lgkmcnt(4)
 v_smfmac_f32_16x16x64_bf16 v[20:23], v[12:15], a[48:55], v0
 s_waitcnt lgkmcnt(0)
 s_barrier
 ds_read_b128 v[48:51], v40 offset:0
 ds_read_b128 v[52:55], v40 offset:512
 ds_read_b128 v[44:47], v40 offset:1536
 v_smfmac_f32_16x16x64_bf16 v[32:35], v[12:15], v[56:63], v0
 ds_read_b128 v[56:59], v3 offset:38912
 ds_read_b128 v[60:63], v3 offset:39936
 s_mov_b32 m0, 4096
 v_smfmac_f32_16x16x64_bf16 v[36:39], v[12:15], v[24:31], v0
 ds_read_b128 v[24:27], v3 offset:36864
 ds_read_b128 v[28:31], v3 offset:37888
 buffer_load_dwordx4 v1, s[4:7], s81 offen offset:0 lds
 v_smfmac_f32_16x16x64_bf16 v[8:11], v[12:15], a[144:151], v0
 s_mov_b32 m0, 4096
 s_waitcnt lgkmcnt(6)
 v_smfmac_f32_16x16x64_bf16 v[16:19], v[48:51], a[0:7], v0
 buffer_load_dwordx4 v1, s[4:7], s81 offen offset:1024 lds
 s_waitcnt lgkmcnt(5)
 v_smfmac_f32_16x16x64_bf16 v[16:19], v[52:55], a[8:15], v0
 s_mov_b32 m0, 6144
 s_waitcnt lgkmcnt(2)
 v_smfmac_f32_16x16x64_bf16 v[16:19], v[44:47], v[56:63], v0
 ds_read_b128 v[56:59], v3 offset:34816
 ds_read_b128 v[60:63], v3 offset:35840
 buffer_load_dwordx4 v1, s[4:7], s81 offen offset:2048 lds
 s_waitcnt lgkmcnt(2)
 v_smfmac_f32_16x16x64_bf16 v[20:23], v[48:51], v[24:31], v0
 ds_read_b128 v[24:27], v3 offset:6144
 ds_read_b128 v[28:31], v3 offset:7168
 v_smfmac_f32_16x16x64_bf16 v[20:23], v[52:55], a[40:47], v0
 v_smfmac_f32_16x16x64_bf16 v[20:23], v[44:47], a[56:63], v0
 v_cvt_pk_bf16_f32 v16, v16, v17
 v_smfmac_f32_16x16x64_bf16 v[32:35], v[48:51], a[64:71], v0
 v_cvt_pk_bf16_f32 v17, v18, v19
 s_waitcnt lgkmcnt(2)
 v_smfmac_f32_16x16x64_bf16 v[32:35], v[52:55], v[56:63], v0
 ds_read_b128 v[56:59], v3 offset:2048
 ds_read_b128 v[60:63], v3 offset:3072
 v_and_or_b32 v16, v16, -2, s55
 s_waitcnt lgkmcnt(2)
 v_smfmac_f32_16x16x64_bf16 v[32:35], v[44:47], v[24:31], v0
 ds_read_b128 v[24:27], v3 offset:0
 ds_read_b128 v[28:31], v3 offset:1024
 v_cvt_pk_bf16_f32 v18, v20, v21
 v_smfmac_f32_16x16x64_bf16 v[36:39], v[48:51], a[96:103], v0
 v_cvt_pk_bf16_f32 v19, v22, v23
 v_smfmac_f32_16x16x64_bf16 v[36:39], v[52:55], a[104:111], v0
 v_and_or_b32 v18, v18, -2, s55
 buffer_store_dwordx4 v[16:19], v1, s[4:7], s60 offen offset:0 sc1
 v_smfmac_f32_16x16x64_bf16 v[36:39], v[44:47], a[120:127], v0
 v_cvt_pk_bf16_f32 v32, v32, v33
 s_waitcnt lgkmcnt(2)
 v_smfmac_f32_16x16x64_bf16 v[8:11], v[48:51], v[56:63], v0
 v_cvt_pk_bf16_f32 v33, v34, v35
 s_waitcnt lgkmcnt(0)
 v_smfmac_f32_16x16x64_bf16 v[8:11], v[52:55], v[24:31], v0
 v_and_or_b32 v32, v32, -2, s55
 v_smfmac_f32_16x16x64_bf16 v[8:11], v[44:47], a[152:159], v0
 v_cvt_pk_bf16_f32 v34, v36, v37
 v_cvt_pk_bf16_f32 v35, v38, v39
 v_and_or_b32 v34, v34, -2, s55
 buffer_store_dwordx4 v[32:35], v1, s[4:7], s60 offen offset:1024 sc1
 s_nop 3
 v_cvt_pk_bf16_f32 v8, v8, v9
 v_cvt_pk_bf16_f32 v9, v10, v11
 v_and_or_b32 v8, v8, -2, s55
 buffer_store_dwordx2 v[8:9], v1, s[4:7], s16 offen offset:0 sc1
 buffer_load_dwordx4 v[32:35], v1, s[4:7], s63 offen offset:2048
 buffer_load_dwordx4 v[36:39], v1, s[4:7], s63 offen offset:3072
 s_add_u32 s54, s54, 1
 s_add_u32 s61, s61, 524288
 s_and_b32 s3, s54, 3
 s_cselect_b32 s3, 1, -3
 s_lshl_b32 s3, s3, 17
 s_add_u32 s62, s62, s3
 s_and_b32 s3, s54, 3
 s_cselect_b32 s3, 1, -3
 s_lshl_b32 s3, s3, 14
 s_add_u32 s57, s57, s3
 s_add_u32 s59, s59, s3
 s_xor_b32 s58, s57, 32768
 v_lshrrev_b32 v56, 6, v1
 v_mul_u32_u24 v56, 10240, v56
 v_and_b32 v60, 48, v1
 v_add_u32 v56, v56, v60
 v_and_b32 v57, 32, v1
 v_and_b32 v60, 64, v1
 v_lshl_add_u32 v57, v60, 2, v57
 v_bfe_u32 v60, v1, 8, 1
 v_lshl_add_u32 v57, v60, 4, v57
 v_bfe_u32 v60, v1, 4, 1
 v_lshl_add_u32 v57, v60, 3, v57
 v_mov_b32 v60, 0x3f80
 v_mov_b32 v28, 0x3f800000
 v_cndmask_b32 v60, v60, v28, s[82:83]
 v_cndmask_b32 v28, 0, v60, s[72:73]
 v_cndmask_b32 v29, 0, v60, s[74:75]
 v_cndmask_b32 v30, 0, v60, s[76:77]
 v_cndmask_b32 v31, 0, v60, s[78:79]
 v_mov_b64 v[58:59], -1
 s_mov_b64 exec, s[84:85]
 buffer_store_dwordx2 v[58:59], v57, s[4:7], s58 offen sc1
 s_mov_b64 exec, -1
 s_nop 15
 s_nop 15
 s_nop 15
 s_nop 15
 s_nop 15
 s_mov_b32 s51, 0
 buffer_load_dwordx4 v[8:11], v56, s[4:7], s64 offen sc1
 buffer_load_dwordx4 v[12:15], v56, s[4:7], s65 offen sc1
L_pp_199:
 s_waitcnt vmcnt(1)
 v_mfma_f32_16x16x32_bf16 v[24:27], v[28:31], v[8:11], 0
 v_bitop3_b32 v60, v8, v10, s55 bitop3:0x7e
 s_waitcnt vmcnt(0)
 v_mfma_f32_16x16x32_bf16 v[24:27], v[28:31], v[12:15], v[24:27]
 v_bitop3_b32 v61, v12, v14, s55 bitop3:0x7e
 v_bitop3_b32 v7, v60, v61, 1 bitop3:0xa8
 v_cmp_ne_u32 vcc, 0, v7
 s_cbranch_vccnz L_rt_200
 s_nop 3
 v_add_f32_dpp v24, v24, v24 row_ror:8 row_mask:0xf bank_mask:0xf
 v_add_f32_dpp v25, v25, v25 row_ror:8 row_mask:0xf bank_mask:0xf
 v_add_f32_dpp v26, v26, v26 row_ror:8 row_mask:0xf bank_mask:0xf
 v_add_f32_dpp v27, v27, v27 row_ror:8 row_mask:0xf bank_mask:0xf
 v_add_f32_dpp v24, v24, v24 row_ror:4 row_mask:0xf bank_mask:0xf
 v_add_f32_dpp v25, v25, v25 row_ror:4 row_mask:0xf bank_mask:0xf
 v_add_f32_dpp v26, v26, v26 row_ror:4 row_mask:0xf bank_mask:0xf
 v_add_f32_dpp v27, v27, v27 row_ror:4 row_mask:0xf bank_mask:0xf
 s_mov_b64 exec, s[84:85]
 v_cvt_pk_bf16_f32 v24, v24, v25
 v_cvt_pk_bf16_f32 v25, v26, v27
 buffer_store_dwordx2 v[24:25], v57, s[4:7], s57 offen sc1
 s_mov_b64 exec, -1
 s_xor_b32 s55, s55, 1
 ds_read_b128 v[40:43], v1 offset:4096
 ds_read_b128 v[44:47], v1 offset:5120
 ds_read_b128 v[48:51], v1 offset:8192
 buffer_load_dwordx4 v[52:55], v1, s[4:7], s81 offen offset:3072
 buffer_load_dwordx4 v[56:59], v1, s[4:7], s101 offen offset:0
 buffer_load_dwordx4 v[60:63], v1, s[4:7], s101 offen offset:1024
 ds_read_b128 v[8:11], v3 offset:49152
 ds_read_b128 v[16:19], v3 offset:49152
 ds_read_b128 v[20:23], v3 offset:49152
 s_waitcnt lgkmcnt(0)
 s_nop 15
 s_nop 15
 s_nop 7
 s_branch L_ch2_s
L_rt_198:
 s_add_u32 s51, s51, 1
 s_cmp_lt_u32 s51, 131072
 s_cbranch_scc1 L_pm_197
 s_branch L_bail
L_rt_200:
 buffer_load_dwordx4 v[8:11], v56, s[4:7], s64 offen sc1
 buffer_load_dwordx4 v[12:15], v56, s[4:7], s65 offen sc1
 s_add_u32 s51, s51, 1
 s_cmp_lt_u32 s51, 131072
 s_cbranch_scc1 L_pp_199
 s_branch L_bail
L_ch2_end:
 s_waitcnt vmcnt(0)
 s_endpgm
L_ch3:
 v_lshrrev_b32 v8, 4, v0
 s_mov_b32 s3, 1280
 v_mul_lo_u32 v8, v8, s3
 v_lshrrev_b32 v7, 3, v0
 v_and_b32 v7, 6, v7
 v_xor_b32 v7, v7, v0
 v_and_b32 v7, 15, v7
 v_lshl_add_u32 v8, v7, 4, v8
 v_xor_b32 v9, 128, v8
 v_lshrrev_b32 v10, 4, v0
 s_mov_b32 s3, 8192
 v_mul_lo_u32 v10, v10, s3
 v_lshrrev_b32 v7, 3, v0
 v_and_b32 v7, 6, v7
 v_xor_b32 v7, v7, v0
 v_and_b32 v7, 15, v7
 v_lshl_add_u32 v10, v7, 4, v10
 v_xor_b32 v11, 128, v10
 s_mov_b32 s8, s26
 s_and_b32 s9, s27, 0xffff
 s_mov_b32 s10, 5242880
 s_mul_i32 s14, s52, 163840
 s_add_u32 s14, s14, 122880
 s_mov_b32 m0, 24576
 s_nop 0
 buffer_load_dwordx4 v8, s[8:11], s14 offen lds
 s_add_u32 s14, s14, 5120
 s_mov_b32 m0, 25600
 s_nop 0
 buffer_load_dwordx4 v8, s[8:11], s14 offen lds
 s_add_u32 s14, s14, 5120
 s_mov_b32 m0, 26624
 s_nop 0
 buffer_load_dwordx4 v8, s[8:11], s14 offen lds
 s_add_u32 s14, s14, 5120
 s_mov_b32 m0, 27648
 s_nop 0
 buffer_load_dwordx4 v8, s[8:11], s14 offen lds
 s_add_u32 s14, s14, 5120
 s_mov_b32 m0, 28672
 s_nop 0
 buffer_load_dwordx4 v9, s[8:11], s14 offen lds
 s_add_u32 s14, s14, 5120
 s_mov_b32 m0, 29696
 s_nop 0
 buffer_load_dwordx4 v9, s[8:11], s14 offen lds
 s_add_u32 s14, s14, 5120
 s_mov_b32 m0, 30720
 s_nop 0
 buffer_load_dwordx4 v9, s[8:11], s14 offen lds
 s_add_u32 s14, s14, 5120
 s_mov_b32 m0, 31744
 s_nop 0
 buffer_load_dwordx4 v9, s[8:11], s14 offen lds
 s_mul_i32 s14, s52, 163840
 s_add_u32 s14, s14, 123136
 s_mov_b32 m0, 57344
 s_nop 0
 buffer_load_dwordx4 v8, s[8:11], s14 offen lds
 s_add_u32 s14, s14, 5120
 s_mov_b32 m0, 58368
 s_nop 0
 buffer_load_dwordx4 v8, s[8:11], s14 offen lds
 s_add_u32 s14, s14, 5120
 s_mov_b32 m0, 59392
 s_nop 0
 buffer_load_dwordx4 v8, s[8:11], s14 offen lds
 s_add_u32 s14, s14, 5120
 s_mov_b32 m0, 60416
 s_nop 0
 buffer_load_dwordx4 v8, s[8:11], s14 offen lds
 s_add_u32 s14, s14, 5120
 s_mov_b32 m0, 61440
 s_nop 0
 buffer_load_dwordx4 v9, s[8:11], s14 offen lds
 s_add_u32 s14, s14, 5120
 s_mov_b32 m0, 62464
 s_nop 0
 buffer_load_dwordx4 v9, s[8:11], s14 offen lds
 s_add_u32 s14, s14, 5120
 s_mov_b32 m0, 63488
 s_nop 0
 buffer_load_dwordx4 v9, s[8:11], s14 offen lds
 s_add_u32 s14, s14, 5120
 s_mov_b32 m0, 64512
 s_nop 0
 buffer_load_dwordx4 v9, s[8:11], s14 offen lds
 s_mul_i32 s14, s52, 163840
 s_add_u32 s14, s14, 123392
 s_mov_b32 m0, 90112
 s_nop 0
 buffer_load_dwordx4 v8, s[8:11], s14 offen lds
 s_add_u32 s14, s14, 5120
 s_mov_b32 m0, 91136
 s_nop 0
 buffer_load_dwordx4 v8, s[8:11], s14 offen lds
 s_add_u32 s14, s14, 5120
 s_mov_b32 m0, 92160
 s_nop 0
 buffer_load_dwordx4 v8, s[8:11], s14 offen lds
 s_add_u32 s14, s14, 5120
 s_mov_b32 m0, 93184
 s_nop 0
 buffer_load_dwordx4 v8, s[8:11], s14 offen lds
 s_add_u32 s14, s14, 5120
 s_mov_b32 m0, 94208
 s_nop 0
 buffer_load_dwordx4 v9, s[8:11], s14 offen lds
 s_add_u32 s14, s14, 5120
 s_mov_b32 m0, 95232
 s_nop 0
 buffer_load_dwordx4 v9, s[8:11], s14 offen lds
 s_add_u32 s14, s14, 5120
 s_mov_b32 m0, 96256
 s_nop 0
 buffer_load_dwordx4 v9, s[8:11], s14 offen lds
 s_add_u32 s14, s14, 5120
 s_mov_b32 m0, 97280
 s_nop 0
 buffer_load_dwordx4 v9, s[8:11], s14 offen lds
 s_mul_i32 s14, s52, 163840
 s_add_u32 s14, s14, 123648
 s_mov_b32 m0, 122880
 s_nop 0
 buffer_load_dwordx4 v8, s[8:11], s14 offen lds
 s_add_u32 s14, s14, 5120
 s_mov_b32 m0, 123904
 s_nop 0
 buffer_load_dwordx4 v8, s[8:11], s14 offen lds
 s_add_u32 s14, s14, 5120
 s_mov_b32 m0, 124928
 s_nop 0
 buffer_load_dwordx4 v8, s[8:11], s14 offen lds
 s_add_u32 s14, s14, 5120
 s_mov_b32 m0, 125952
 s_nop 0
 buffer_load_dwordx4 v8, s[8:11], s14 offen lds
 s_add_u32 s14, s14, 5120
 s_mov_b32 m0, 126976
 s_nop 0
 buffer_load_dwordx4 v9, s[8:11], s14 offen lds
 s_add_u32 s14, s14, 5120
 s_mov_b32 m0, 128000
 s_nop 0
 buffer_load_dwordx4 v9, s[8:11], s14 offen lds
 s_add_u32 s14, s14, 5120
 s_mov_b32 m0, 129024
 s_nop 0
 buffer_load_dwordx4 v9, s[8:11], s14 offen lds
 s_add_u32 s14, s14, 5120
 s_mov_b32 m0, 130048
 s_nop 0
 buffer_load_dwordx4 v9, s[8:11], s14 offen lds
 s_mul_i32 s14, s52, 163840
 s_add_u32 s14, s14, 123904
 s_mov_b32 m0, 155648
 s_nop 0
 buffer_load_dwordx4 v8, s[8:11], s14 offen lds
 s_add_u32 s14, s14, 5120
 s_mov_b32 m0, 156672
 s_nop 0
 buffer_load_dwordx4 v8, s[8:11], s14 offen lds
 s_add_u32 s14, s14, 5120
 s_mov_b32 m0, 157696
 s_nop 0
 buffer_load_dwordx4 v8, s[8:11], s14 offen lds
 s_add_u32 s14, s14, 5120
 s_mov_b32 m0, 158720
 s_nop 0
 buffer_load_dwordx4 v8, s[8:11], s14 offen lds
 s_add_u32 s14, s14, 5120
 s_mov_b32 m0, 159744
 s_nop 0
 buffer_load_dwordx4 v9, s[8:11], s14 offen lds
 s_add_u32 s14, s14, 5120
 s_mov_b32 m0, 160768
 s_nop 0
 buffer_load_dwordx4 v9, s[8:11], s14 offen lds
 s_add_u32 s14, s14, 5120
 s_mov_b32 m0, 161792
 s_nop 0
 buffer_load_dwordx4 v9, s[8:11], s14 offen lds
 s_add_u32 s14, s14, 5120
 s_mov_b32 m0, 162816
 s_nop 0
 buffer_load_dwordx4 v9, s[8:11], s14 offen lds
 v_lshrrev_b32 v20, 4, v0
 v_bfe_u32 v21, v0, 2, 1
 v_bfe_u32 v22, v0, 3, 1
 v_and_b32 v23, 1, v20
 v_lshrrev_b32 v24, 1, v20
 v_and_b32 v25, 3, v0
 v_lshlrev_b32 v25, 3, v25
 v_lshl_add_u32 v26, v22, 1, v23
 v_lshl_add_u32 v27, v21, 2, v26
 v_lshl_add_u32 v26, v24, 2, v26
 v_lshl_add_u32 v26, v21, 4, v26
 v_xor_b32 v27, 6, v27
 v_lshl_add_u32 v27, v27, 5, v25
 v_lshl_add_u32 v12, v26, 8, v27
 v_lshl_add_u32 v26, v24, 2, v21
 v_lshl_add_u32 v26, v23, 4, v26
 v_lshl_add_u32 v27, v23, 2, v21
 v_lshl_add_u32 v27, v22, 1, v27
 v_lshl_add_u32 v27, v27, 5, v25
 v_lshl_add_u32 v14, v26, 8, v27
 v_lshlrev_b32 v1, 4, v0
 v_add_u32 v2, 65536, v1
 v_add_u32 v3, 114688, v1
 s_waitcnt vmcnt(32)
 s_barrier
 s_waitcnt lgkmcnt(0)
 s_barrier
 s_mov_b32 s8, s24
 s_and_b32 s9, s25, 0xffff
 s_mov_b32 s10, 5242880
 s_lshl_b32 s14, s52, 8
 s_add_u32 s14, s14, 786432
 s_mov_b32 m0, 24576
 s_nop 0
 buffer_load_dwordx4 v10, s[8:11], s14 offen lds
 s_add_u32 s14, s14, 32768
 s_mov_b32 m0, 25600
 s_nop 0
 buffer_load_dwordx4 v10, s[8:11], s14 offen lds
 s_add_u32 s14, s14, 32768
 s_mov_b32 m0, 26624
 s_nop 0
 buffer_load_dwordx4 v10, s[8:11], s14 offen lds
 s_add_u32 s14, s14, 32768
 s_mov_b32 m0, 27648
 s_nop 0
 buffer_load_dwordx4 v10, s[8:11], s14 offen lds
 s_add_u32 s14, s14, 32768
 s_mov_b32 m0, 28672
 s_nop 0
 buffer_load_dwordx4 v11, s[8:11], s14 offen lds
 s_add_u32 s14, s14, 32768
 s_mov_b32 m0, 29696
 s_nop 0
 buffer_load_dwordx4 v11, s[8:11], s14 offen lds
 s_add_u32 s14, s14, 32768
 s_mov_b32 m0, 30720
 s_nop 0
 buffer_load_dwordx4 v11, s[8:11], s14 offen lds
 s_add_u32 s14, s14, 32768
 s_mov_b32 m0, 31744
 s_nop 0
 buffer_load_dwordx4 v11, s[8:11], s14 offen lds
 s_waitcnt vmcnt(32)
 s_barrier
 s_waitcnt lgkmcnt(0)
 s_barrier
 s_lshl_b32 s14, s52, 8
 s_add_u32 s14, s14, 1835008
 s_mov_b32 m0, 57344
 s_nop 0
 buffer_load_dwordx4 v10, s[8:11], s14 offen lds
 s_add_u32 s14, s14, 32768
 s_mov_b32 m0, 58368
 s_nop 0
 buffer_load_dwordx4 v10, s[8:11], s14 offen lds
 s_add_u32 s14, s14, 32768
 s_mov_b32 m0, 59392
 s_nop 0
 buffer_load_dwordx4 v10, s[8:11], s14 offen lds
 s_add_u32 s14, s14, 32768
 s_mov_b32 m0, 60416
 s_nop 0
 buffer_load_dwordx4 v10, s[8:11], s14 offen lds
 s_add_u32 s14, s14, 32768
 s_mov_b32 m0, 61440
 s_nop 0
 buffer_load_dwordx4 v11, s[8:11], s14 offen lds
 s_add_u32 s14, s14, 32768
 s_mov_b32 m0, 62464
 s_nop 0
 buffer_load_dwordx4 v11, s[8:11], s14 offen lds
 s_add_u32 s14, s14, 32768
 s_mov_b32 m0, 63488
 s_nop 0
 buffer_load_dwordx4 v11, s[8:11], s14 offen lds
 s_add_u32 s14, s14, 32768
 s_mov_b32 m0, 64512
 s_nop 0
 buffer_load_dwordx4 v11, s[8:11], s14 offen lds
 s_waitcnt vmcnt(32)
 s_barrier
 s_waitcnt lgkmcnt(0)
 s_barrier
 s_lshl_b32 s14, s52, 8
 s_add_u32 s14, s14, 2883584
 s_mov_b32 m0, 90112
 s_nop 0
 buffer_load_dwordx4 v10, s[8:11], s14 offen lds
 s_add_u32 s14, s14, 32768
 s_mov_b32 m0, 91136
 s_nop 0
 buffer_load_dwordx4 v10, s[8:11], s14 offen lds
 s_add_u32 s14, s14, 32768
 s_mov_b32 m0, 92160
 s_nop 0
 buffer_load_dwordx4 v10, s[8:11], s14 offen lds
 s_add_u32 s14, s14, 32768
 s_mov_b32 m0, 93184
 s_nop 0
 buffer_load_dwordx4 v10, s[8:11], s14 offen lds
 s_add_u32 s14, s14, 32768
 s_mov_b32 m0, 94208
 s_nop 0
 buffer_load_dwordx4 v11, s[8:11], s14 offen lds
 s_add_u32 s14, s14, 32768
 s_mov_b32 m0, 95232
 s_nop 0
 buffer_load_dwordx4 v11, s[8:11], s14 offen lds
 s_add_u32 s14, s14, 32768
 s_mov_b32 m0, 96256
 s_nop 0
 buffer_load_dwordx4 v11, s[8:11], s14 offen lds
 s_add_u32 s14, s14, 32768
 s_mov_b32 m0, 97280
 s_nop 0
 buffer_load_dwordx4 v11, s[8:11], s14 offen lds
 s_waitcnt vmcnt(32)
 s_barrier
 v_xor_b32 v16, 0, v14
 v_add_u32 v16, 98304, v16
 v_xor_b32 v17, 64, v16
 ds_read_b64_tr_b16 a[0:1], v16 offset:0
 ds_read_b64_tr_b16 a[2:3], v17 offset:512
 ds_read_b64_tr_b16 a[4:5], v16 offset:2048
 ds_read_b64_tr_b16 a[6:7], v17 offset:2560
 v_xor_b32 v16, 0, v14
 v_add_u32 v16, 98304, v16
 v_xor_b32 v17, 64, v16
 ds_read_b64_tr_b16 a[8:9], v16 offset:8192
 ds_read_b64_tr_b16 a[10:11], v17 offset:8704
 ds_read_b64_tr_b16 a[12:13], v16 offset:10240
 ds_read_b64_tr_b16 a[14:15], v17 offset:10752
 v_xor_b32 v16, 0, v14
 v_add_u32 v16, 98304, v16
 v_xor_b32 v17, 64, v16
 ds_read_b64_tr_b16 a[16:17], v16 offset:16384
 ds_read_b64_tr_b16 a[18:19], v17 offset:16896
 ds_read_b64_tr_b16 a[20:21], v16 offset:18432
 ds_read_b64_tr_b16 a[22:23], v17 offset:18944
 v_xor_b32 v16, 0, v14
 v_add_u32 v16, 98304, v16
 v_xor_b32 v17, 64, v16
 ds_read_b64_tr_b16 a[24:25], v16 offset:24576
 ds_read_b64_tr_b16 a[26:27], v17 offset:25088
 ds_read_b64_tr_b16 a[28:29], v16 offset:26624
 ds_read_b64_tr_b16 a[30:31], v17 offset:27136
 v_xor_b32 v16, 32, v14
 v_add_u32 v16, 98304, v16
 v_xor_b32 v17, 64, v16
 ds_read_b64_tr_b16 a[32:33], v16 offset:0
 ds_read_b64_tr_b16 a[34:35], v17 offset:512
 ds_read_b64_tr_b16 a[36:37], v16 offset:2048
 ds_read_b64_tr_b16 a[38:39], v17 offset:2560
 v_xor_b32 v16, 32, v14
 v_add_u32 v16, 98304, v16
 v_xor_b32 v17, 64, v16
 ds_read_b64_tr_b16 a[40:41], v16 offset:8192
 ds_read_b64_tr_b16 a[42:43], v17 offset:8704
 ds_read_b64_tr_b16 a[44:45], v16 offset:10240
 ds_read_b64_tr_b16 a[46:47], v17 offset:10752
 v_xor_b32 v16, 32, v14
 v_add_u32 v16, 98304, v16
 v_xor_b32 v17, 64, v16
 ds_read_b64_tr_b16 a[48:49], v16 offset:16384
 ds_read_b64_tr_b16 a[50:51], v17 offset:16896
 ds_read_b64_tr_b16 a[52:53], v16 offset:18432
 ds_read_b64_tr_b16 a[54:55], v17 offset:18944
 v_xor_b32 v16, 32, v14
 v_add_u32 v16, 98304, v16
 v_xor_b32 v17, 64, v16
 ds_read_b64_tr_b16 a[56:57], v16 offset:24576
 ds_read_b64_tr_b16 a[58:59], v17 offset:25088
 ds_read_b64_tr_b16 a[60:61], v16 offset:26624
 ds_read_b64_tr_b16 a[62:63], v17 offset:27136
 v_xor_b32 v16, 128, v14
 v_add_u32 v16, 98304, v16
 v_xor_b32 v17, 64, v16
 ds_read_b64_tr_b16 a[64:65], v16 offset:0
 ds_read_b64_tr_b16 a[66:67], v17 offset:512
 ds_read_b64_tr_b16 a[68:69], v16 offset:2048
 ds_read_b64_tr_b16 a[70:71], v17 offset:2560
 v_xor_b32 v16, 128, v14
 v_add_u32 v16, 98304, v16
 v_xor_b32 v17, 64, v16
 ds_read_b64_tr_b16 a[72:73], v16 offset:8192
 ds_read_b64_tr_b16 a[74:75], v17 offset:8704
 ds_read_b64_tr_b16 a[76:77], v16 offset:10240
 ds_read_b64_tr_b16 a[78:79], v17 offset:10752
 v_xor_b32 v16, 128, v14
 v_add_u32 v16, 98304, v16
 v_xor_b32 v17, 64, v16
 ds_read_b64_tr_b16 a[80:81], v16 offset:16384
 ds_read_b64_tr_b16 a[82:83], v17 offset:16896
 ds_read_b64_tr_b16 a[84:85], v16 offset:18432
 ds_read_b64_tr_b16 a[86:87], v17 offset:18944
 v_xor_b32 v16, 128, v14
 v_add_u32 v16, 98304, v16
 v_xor_b32 v17, 64, v16
 ds_read_b64_tr_b16 a[88:89], v16 offset:24576
 ds_read_b64_tr_b16 a[90:91], v17 offset:25088
 ds_read_b64_tr_b16 a[92:93], v16 offset:26624
 ds_read_b64_tr_b16 a[94:95], v17 offset:27136
 v_xor_b32 v16, 160, v14
 v_add_u32 v16, 98304, v16
 v_xor_b32 v17, 64, v16
 ds_read_b64_tr_b16 a[96:97], v16 offset:0
 ds_read_b64_tr_b16 a[98:99], v17 offset:512
 ds_read_b64_tr_b16 a[100:101], v16 offset:2048
 ds_read_b64_tr_b16 a[102:103], v17 offset:2560
 v_xor_b32 v16, 160, v14
 v_add_u32 v16, 98304, v16
 v_xor_b32 v17, 64, v16
 ds_read_b64_tr_b16 a[104:105], v16 offset:8192
 ds_read_b64_tr_b16 a[106:107], v17 offset:8704
 ds_read_b64_tr_b16 a[108:109], v16 offset:10240
 ds_read_b64_tr_b16 a[110:111], v17 offset:10752
 v_xor_b32 v16, 160, v14
 v_add_u32 v16, 98304, v16
 v_xor_b32 v17, 64, v16
 ds_read_b64_tr_b16 a[112:113], v16 offset:16384
 ds_read_b64_tr_b16 a[114:115], v17 offset:16896
 ds_read_b64_tr_b16 a[116:117], v16 offset:18432
 ds_read_b64_tr_b16 a[118:119], v17 offset:18944
 v_xor_b32 v16, 160, v14
 v_add_u32 v16, 98304, v16
 v_xor_b32 v17, 64, v16
 ds_read_b64_tr_b16 a[120:121], v16 offset:24576
 ds_read_b64_tr_b16 a[122:123], v17 offset:25088
 ds_read_b64_tr_b16 a[124:125], v16 offset:26624
 ds_read_b64_tr_b16 a[126:127], v17 offset:27136
 s_waitcnt lgkmcnt(0)
 s_barrier
 s_lshl_b32 s14, s52, 8
 s_add_u32 s14, s14, 3932160
 s_mov_b32 m0, 122880
 s_nop 0
 buffer_load_dwordx4 v10, s[8:11], s14 offen lds
 s_add_u32 s14, s14, 32768
 s_mov_b32 m0, 123904
 s_nop 0
 buffer_load_dwordx4 v10, s[8:11], s14 offen lds
 s_add_u32 s14, s14, 32768
 s_mov_b32 m0, 124928
 s_nop 0
 buffer_load_dwordx4 v10, s[8:11], s14 offen lds
 s_add_u32 s14, s14, 32768
 s_mov_b32 m0, 125952
 s_nop 0
 buffer_load_dwordx4 v10, s[8:11], s14 offen lds
 s_add_u32 s14, s14, 32768
 s_mov_b32 m0, 126976
 s_nop 0
 buffer_load_dwordx4 v11, s[8:11], s14 offen lds
 s_add_u32 s14, s14, 32768
 s_mov_b32 m0, 128000
 s_nop 0
 buffer_load_dwordx4 v11, s[8:11], s14 offen lds
 s_add_u32 s14, s14, 32768
 s_mov_b32 m0, 129024
 s_nop 0
 buffer_load_dwordx4 v11, s[8:11], s14 offen lds
 s_add_u32 s14, s14, 32768
 s_mov_b32 m0, 130048
 s_nop 0
 buffer_load_dwordx4 v11, s[8:11], s14 offen lds
 s_waitcnt vmcnt(32)
 s_barrier
 v_xor_b32 v16, 160, v14
 v_add_u32 v16, 131072, v16
 v_xor_b32 v17, 64, v16
 ds_read_b64_tr_b16 a[128:129], v16 offset:0
 ds_read_b64_tr_b16 a[130:131], v17 offset:512
 ds_read_b64_tr_b16 a[132:133], v16 offset:2048
 ds_read_b64_tr_b16 a[134:135], v17 offset:2560
 v_xor_b32 v16, 160, v14
 v_add_u32 v16, 131072, v16
 v_xor_b32 v17, 64, v16
 ds_read_b64_tr_b16 a[136:137], v16 offset:8192
 ds_read_b64_tr_b16 a[138:139], v17 offset:8704
 ds_read_b64_tr_b16 a[140:141], v16 offset:10240
 ds_read_b64_tr_b16 a[142:143], v17 offset:10752
 v_xor_b32 v16, 160, v14
 v_add_u32 v16, 131072, v16
 v_xor_b32 v17, 64, v16
 ds_read_b64_tr_b16 a[144:145], v16 offset:16384
 ds_read_b64_tr_b16 a[146:147], v17 offset:16896
 ds_read_b64_tr_b16 a[148:149], v16 offset:18432
 ds_read_b64_tr_b16 a[150:151], v17 offset:18944
 v_xor_b32 v16, 160, v14
 v_add_u32 v16, 131072, v16
 v_xor_b32 v17, 64, v16
 ds_read_b64_tr_b16 a[152:153], v16 offset:24576
 ds_read_b64_tr_b16 a[154:155], v17 offset:25088
 ds_read_b64_tr_b16 a[156:157], v16 offset:26624
 ds_read_b64_tr_b16 a[158:159], v17 offset:27136
 s_waitcnt lgkmcnt(0)
 s_barrier
 s_lshl_b32 s14, s52, 8
 s_add_u32 s14, s14, 4980736
 s_mov_b32 m0, 155648
 s_nop 0
 buffer_load_dwordx4 v10, s[8:11], s14 offen lds
 s_add_u32 s14, s14, 32768
 s_mov_b32 m0, 156672
 s_nop 0
 buffer_load_dwordx4 v10, s[8:11], s14 offen lds
 s_add_u32 s14, s14, 32768
 s_mov_b32 m0, 157696
 s_nop 0
 buffer_load_dwordx4 v10, s[8:11], s14 offen lds
 s_add_u32 s14, s14, 32768
 s_mov_b32 m0, 158720
 s_nop 0
 buffer_load_dwordx4 v10, s[8:11], s14 offen lds
 s_add_u32 s14, s14, 32768
 s_mov_b32 m0, 159744
 s_nop 0
 buffer_load_dwordx4 v11, s[8:11], s14 offen lds
 s_add_u32 s14, s14, 32768
 s_mov_b32 m0, 160768
 s_nop 0
 buffer_load_dwordx4 v11, s[8:11], s14 offen lds
 s_add_u32 s14, s14, 32768
 s_mov_b32 m0, 161792
 s_nop 0
 buffer_load_dwordx4 v11, s[8:11], s14 offen lds
 s_add_u32 s14, s14, 32768
 s_mov_b32 m0, 162816
 s_nop 0
 buffer_load_dwordx4 v11, s[8:11], s14 offen lds
 s_waitcnt vmcnt(32)
 s_barrier
 v_xor_b32 v16, 0, v12
 v_add_u32 v16, 0, v16
 ds_read_b64_tr_b16 a[160:161], v16 offset:0
 ds_read_b64_tr_b16 a[162:163], v16 offset:8192
 ds_read_b64_tr_b16 a[164:165], v16 offset:2048
 ds_read_b64_tr_b16 a[166:167], v16 offset:10240
 v_xor_b32 v16, 32, v12
 v_add_u32 v16, 0, v16
 ds_read_b64_tr_b16 a[168:169], v16 offset:0
 ds_read_b64_tr_b16 a[170:171], v16 offset:8192
 ds_read_b64_tr_b16 a[172:173], v16 offset:2048
 ds_read_b64_tr_b16 a[174:175], v16 offset:10240
 v_xor_b32 v16, 0, v12
 v_add_u32 v16, 0, v16
 ds_read_b64_tr_b16 a[176:177], v16 offset:16384
 ds_read_b64_tr_b16 a[178:179], v16 offset:24576
 ds_read_b64_tr_b16 a[180:181], v16 offset:18432
 ds_read_b64_tr_b16 a[182:183], v16 offset:26624
 v_xor_b32 v16, 32, v12
 v_add_u32 v16, 0, v16
 ds_read_b64_tr_b16 a[184:185], v16 offset:16384
 ds_read_b64_tr_b16 a[186:187], v16 offset:24576
 ds_read_b64_tr_b16 a[188:189], v16 offset:18432
 ds_read_b64_tr_b16 a[190:191], v16 offset:26624
 s_waitcnt lgkmcnt(0)
 s_barrier
 s_mov_b32 s8, s22
 s_and_b32 s9, s23, 0xffff
 s_mov_b32 s10, 5242880
 s_lshl_b32 s14, s52, 8
 s_add_u32 s14, s14, 786432
 s_mov_b32 m0, 24576
 s_nop 0
 buffer_load_dwordx4 v10, s[8:11], s14 offen lds
 s_add_u32 s14, s14, 32768
 s_mov_b32 m0, 25600
 s_nop 0
 buffer_load_dwordx4 v10, s[8:11], s14 offen lds
 s_add_u32 s14, s14, 32768
 s_mov_b32 m0, 26624
 s_nop 0
 buffer_load_dwordx4 v10, s[8:11], s14 offen lds
 s_add_u32 s14, s14, 32768
 s_mov_b32 m0, 27648
 s_nop 0
 buffer_load_dwordx4 v10, s[8:11], s14 offen lds
 s_add_u32 s14, s14, 32768
 s_mov_b32 m0, 28672
 s_nop 0
 buffer_load_dwordx4 v11, s[8:11], s14 offen lds
 s_add_u32 s14, s14, 32768
 s_mov_b32 m0, 29696
 s_nop 0
 buffer_load_dwordx4 v11, s[8:11], s14 offen lds
 s_add_u32 s14, s14, 32768
 s_mov_b32 m0, 30720
 s_nop 0
 buffer_load_dwordx4 v11, s[8:11], s14 offen lds
 s_add_u32 s14, s14, 32768
 s_mov_b32 m0, 31744
 s_nop 0
 buffer_load_dwordx4 v11, s[8:11], s14 offen lds
 s_waitcnt vmcnt(32)
 s_barrier
 v_xor_b32 v16, 0, v12
 v_add_u32 v16, 32768, v16
 ds_read_b64_tr_b16 a[192:193], v16 offset:0
 ds_read_b64_tr_b16 a[194:195], v16 offset:8192
 ds_read_b64_tr_b16 a[196:197], v16 offset:2048
 ds_read_b64_tr_b16 a[198:199], v16 offset:10240
 v_xor_b32 v16, 32, v12
 v_add_u32 v16, 32768, v16
 ds_read_b64_tr_b16 a[200:201], v16 offset:0
 ds_read_b64_tr_b16 a[202:203], v16 offset:8192
 ds_read_b64_tr_b16 a[204:205], v16 offset:2048
 ds_read_b64_tr_b16 a[206:207], v16 offset:10240
 v_xor_b32 v16, 0, v12
 v_add_u32 v16, 32768, v16
 ds_read_b64_tr_b16 a[208:209], v16 offset:16384
 ds_read_b64_tr_b16 a[210:211], v16 offset:24576
 ds_read_b64_tr_b16 a[212:213], v16 offset:18432
 ds_read_b64_tr_b16 a[214:215], v16 offset:26624
 v_xor_b32 v16, 32, v12
 v_add_u32 v16, 32768, v16
 ds_read_b64_tr_b16 a[216:217], v16 offset:16384
 ds_read_b64_tr_b16 a[218:219], v16 offset:24576
 ds_read_b64_tr_b16 a[220:221], v16 offset:18432
 ds_read_b64_tr_b16 a[222:223], v16 offset:26624
 s_waitcnt lgkmcnt(0)
 s_barrier
 s_lshl_b32 s14, s52, 8
 s_add_u32 s14, s14, 1835008
 s_mov_b32 m0, 57344
 s_nop 0
 buffer_load_dwordx4 v10, s[8:11], s14 offen lds
 s_add_u32 s14, s14, 32768
 s_mov_b32 m0, 58368
 s_nop 0
 buffer_load_dwordx4 v10, s[8:11], s14 offen lds
 s_add_u32 s14, s14, 32768
 s_mov_b32 m0, 59392
 s_nop 0
 buffer_load_dwordx4 v10, s[8:11], s14 offen lds
 s_add_u32 s14, s14, 32768
 s_mov_b32 m0, 60416
 s_nop 0
 buffer_load_dwordx4 v10, s[8:11], s14 offen lds
 s_add_u32 s14, s14, 32768
 s_mov_b32 m0, 61440
 s_nop 0
 buffer_load_dwordx4 v11, s[8:11], s14 offen lds
 s_add_u32 s14, s14, 32768
 s_mov_b32 m0, 62464
 s_nop 0
 buffer_load_dwordx4 v11, s[8:11], s14 offen lds
 s_add_u32 s14, s14, 32768
 s_mov_b32 m0, 63488
 s_nop 0
 buffer_load_dwordx4 v11, s[8:11], s14 offen lds
 s_add_u32 s14, s14, 32768
 s_mov_b32 m0, 64512
 s_nop 0
 buffer_load_dwordx4 v11, s[8:11], s14 offen lds
 s_waitcnt vmcnt(32)
 s_barrier
 v_xor_b32 v16, 0, v12
 v_add_u32 v16, 65536, v16
 ds_read_b64_tr_b16 a[224:225], v16 offset:0
 ds_read_b64_tr_b16 a[226:227], v16 offset:8192
 ds_read_b64_tr_b16 a[228:229], v16 offset:2048
 ds_read_b64_tr_b16 a[230:231], v16 offset:10240
 v_xor_b32 v16, 32, v12
 v_add_u32 v16, 65536, v16
 ds_read_b64_tr_b16 a[232:233], v16 offset:0
 ds_read_b64_tr_b16 a[234:235], v16 offset:8192
 ds_read_b64_tr_b16 a[236:237], v16 offset:2048
 ds_read_b64_tr_b16 a[238:239], v16 offset:10240
 v_xor_b32 v16, 0, v12
 v_add_u32 v16, 65536, v16
 ds_read_b64_tr_b16 a[240:241], v16 offset:16384
 ds_read_b64_tr_b16 a[242:243], v16 offset:24576
 ds_read_b64_tr_b16 a[244:245], v16 offset:18432
 ds_read_b64_tr_b16 a[246:247], v16 offset:26624
 v_xor_b32 v16, 32, v12
 v_add_u32 v16, 65536, v16
 ds_read_b64_tr_b16 a[248:249], v16 offset:16384
 ds_read_b64_tr_b16 a[250:251], v16 offset:24576
 ds_read_b64_tr_b16 a[252:253], v16 offset:18432
 ds_read_b64_tr_b16 a[254:255], v16 offset:26624
 s_waitcnt lgkmcnt(0)
 s_barrier
 s_lshl_b32 s14, s52, 8
 s_add_u32 s14, s14, 2883584
 s_mov_b32 m0, 90112
 s_nop 0
 buffer_load_dwordx4 v10, s[8:11], s14 offen lds
 s_add_u32 s14, s14, 32768
 s_mov_b32 m0, 91136
 s_nop 0
 buffer_load_dwordx4 v10, s[8:11], s14 offen lds
 s_add_u32 s14, s14, 32768
 s_mov_b32 m0, 92160
 s_nop 0
 buffer_load_dwordx4 v10, s[8:11], s14 offen lds
 s_add_u32 s14, s14, 32768
 s_mov_b32 m0, 93184
 s_nop 0
 buffer_load_dwordx4 v10, s[8:11], s14 offen lds
 s_add_u32 s14, s14, 32768
 s_mov_b32 m0, 94208
 s_nop 0
 buffer_load_dwordx4 v11, s[8:11], s14 offen lds
 s_add_u32 s14, s14, 32768
 s_mov_b32 m0, 95232
 s_nop 0
 buffer_load_dwordx4 v11, s[8:11], s14 offen lds
 s_add_u32 s14, s14, 32768
 s_mov_b32 m0, 96256
 s_nop 0
 buffer_load_dwordx4 v11, s[8:11], s14 offen lds
 s_add_u32 s14, s14, 32768
 s_mov_b32 m0, 97280
 s_nop 0
 buffer_load_dwordx4 v11, s[8:11], s14 offen lds
 s_waitcnt vmcnt(32)
 s_barrier
 v_xor_b32 v16, 0, v12
 v_add_u32 v16, 98304, v16
 ds_read_b64_tr_b16 v[64:65], v16 offset:0
 ds_read_b64_tr_b16 v[66:67], v16 offset:8192
 ds_read_b64_tr_b16 v[68:69], v16 offset:2048
 ds_read_b64_tr_b16 v[70:71], v16 offset:10240
 v_xor_b32 v16, 32, v12
 v_add_u32 v16, 98304, v16
 ds_read_b64_tr_b16 v[72:73], v16 offset:0
 ds_read_b64_tr_b16 v[74:75], v16 offset:8192
 ds_read_b64_tr_b16 v[76:77], v16 offset:2048
 ds_read_b64_tr_b16 v[78:79], v16 offset:10240
 v_xor_b32 v16, 0, v12
 v_add_u32 v16, 98304, v16
 ds_read_b64_tr_b16 v[80:81], v16 offset:16384
 ds_read_b64_tr_b16 v[82:83], v16 offset:24576
 ds_read_b64_tr_b16 v[84:85], v16 offset:18432
 ds_read_b64_tr_b16 v[86:87], v16 offset:26624
 v_xor_b32 v16, 32, v12
 v_add_u32 v16, 98304, v16
 ds_read_b64_tr_b16 v[88:89], v16 offset:16384
 ds_read_b64_tr_b16 v[90:91], v16 offset:24576
 ds_read_b64_tr_b16 v[92:93], v16 offset:18432
 ds_read_b64_tr_b16 v[94:95], v16 offset:26624
 s_waitcnt lgkmcnt(0)
 s_barrier
 s_lshl_b32 s14, s52, 8
 s_add_u32 s14, s14, 3932160
 s_mov_b32 m0, 122880
 s_nop 0
 buffer_load_dwordx4 v10, s[8:11], s14 offen lds
 s_add_u32 s14, s14, 32768
 s_mov_b32 m0, 123904
 s_nop 0
 buffer_load_dwordx4 v10, s[8:11], s14 offen lds
 s_add_u32 s14, s14, 32768
 s_mov_b32 m0, 124928
 s_nop 0
 buffer_load_dwordx4 v10, s[8:11], s14 offen lds
 s_add_u32 s14, s14, 32768
 s_mov_b32 m0, 125952
 s_nop 0
 buffer_load_dwordx4 v10, s[8:11], s14 offen lds
 s_add_u32 s14, s14, 32768
 s_mov_b32 m0, 126976
 s_nop 0
 buffer_load_dwordx4 v11, s[8:11], s14 offen lds
 s_add_u32 s14, s14, 32768
 s_mov_b32 m0, 128000
 s_nop 0
 buffer_load_dwordx4 v11, s[8:11], s14 offen lds
 s_add_u32 s14, s14, 32768
 s_mov_b32 m0, 129024
 s_nop 0
 buffer_load_dwordx4 v11, s[8:11], s14 offen lds
 s_add_u32 s14, s14, 32768
 s_mov_b32 m0, 130048
 s_nop 0
 buffer_load_dwordx4 v11, s[8:11], s14 offen lds
 s_waitcnt vmcnt(32)
 s_barrier
 v_xor_b32 v16, 0, v12
 v_add_u32 v16, 131072, v16
 ds_read_b64_tr_b16 v[96:97], v16 offset:0
 ds_read_b64_tr_b16 v[98:99], v16 offset:8192
 ds_read_b64_tr_b16 v[100:101], v16 offset:2048
 ds_read_b64_tr_b16 v[102:103], v16 offset:10240
 v_xor_b32 v16, 32, v12
 v_add_u32 v16, 131072, v16
 ds_read_b64_tr_b16 v[104:105], v16 offset:0
 ds_read_b64_tr_b16 v[106:107], v16 offset:8192
 ds_read_b64_tr_b16 v[108:109], v16 offset:2048
 ds_read_b64_tr_b16 v[110:111], v16 offset:10240
 v_xor_b32 v16, 0, v12
 v_add_u32 v16, 131072, v16
 ds_read_b64_tr_b16 v[112:113], v16 offset:16384
 ds_read_b64_tr_b16 v[114:115], v16 offset:24576
 ds_read_b64_tr_b16 v[116:117], v16 offset:18432
 ds_read_b64_tr_b16 v[118:119], v16 offset:26624
 v_xor_b32 v16, 32, v12
 v_add_u32 v16, 131072, v16
 ds_read_b64_tr_b16 v[120:121], v16 offset:16384
 ds_read_b64_tr_b16 v[122:123], v16 offset:24576
 ds_read_b64_tr_b16 v[124:125], v16 offset:18432
 ds_read_b64_tr_b16 v[126:127], v16 offset:26624
 s_waitcnt lgkmcnt(0)
 s_barrier
 s_lshl_b32 s14, s52, 8
 s_add_u32 s14, s14, 4980736
 s_mov_b32 m0, 155648
 s_nop 0
 buffer_load_dwordx4 v10, s[8:11], s14 offen lds
 s_add_u32 s14, s14, 32768
 s_mov_b32 m0, 156672
 s_nop 0
 buffer_load_dwordx4 v10, s[8:11], s14 offen lds
 s_add_u32 s14, s14, 32768
 s_mov_b32 m0, 157696
 s_nop 0
 buffer_load_dwordx4 v10, s[8:11], s14 offen lds
 s_add_u32 s14, s14, 32768
 s_mov_b32 m0, 158720
 s_nop 0
 buffer_load_dwordx4 v10, s[8:11], s14 offen lds
 s_add_u32 s14, s14, 32768
 s_mov_b32 m0, 159744
 s_nop 0
 buffer_load_dwordx4 v11, s[8:11], s14 offen lds
 s_add_u32 s14, s14, 32768
 s_mov_b32 m0, 160768
 s_nop 0
 buffer_load_dwordx4 v11, s[8:11], s14 offen lds
 s_add_u32 s14, s14, 32768
 s_mov_b32 m0, 161792
 s_nop 0
 buffer_load_dwordx4 v11, s[8:11], s14 offen lds
 s_add_u32 s14, s14, 32768
 s_mov_b32 m0, 162816
 s_nop 0
 buffer_load_dwordx4 v11, s[8:11], s14 offen lds
 s_waitcnt vmcnt(32)
 s_barrier
 v_xor_b32 v16, 0, v12
 v_add_u32 v16, 0, v16
 ds_read_b64_tr_b16 v[128:129], v16 offset:0
 ds_read_b64_tr_b16 v[130:131], v16 offset:8192
 ds_read_b64_tr_b16 v[132:133], v16 offset:2048
 ds_read_b64_tr_b16 v[134:135], v16 offset:10240
 v_xor_b32 v16, 32, v12
 v_add_u32 v16, 0, v16
 ds_read_b64_tr_b16 v[136:137], v16 offset:0
 ds_read_b64_tr_b16 v[138:139], v16 offset:8192
 ds_read_b64_tr_b16 v[140:141], v16 offset:2048
 ds_read_b64_tr_b16 v[142:143], v16 offset:10240
 v_xor_b32 v16, 0, v12
 v_add_u32 v16, 0, v16
 ds_read_b64_tr_b16 v[144:145], v16 offset:16384
 ds_read_b64_tr_b16 v[146:147], v16 offset:24576
 ds_read_b64_tr_b16 v[148:149], v16 offset:18432
 ds_read_b64_tr_b16 v[150:151], v16 offset:26624
 v_xor_b32 v16, 32, v12
 v_add_u32 v16, 0, v16
 ds_read_b64_tr_b16 v[152:153], v16 offset:16384
 ds_read_b64_tr_b16 v[154:155], v16 offset:24576
 ds_read_b64_tr_b16 v[156:157], v16 offset:18432
 ds_read_b64_tr_b16 v[158:159], v16 offset:26624
 s_waitcnt lgkmcnt(0)
 s_barrier
 s_mov_b32 s8, s20
 s_and_b32 s9, s21, 0xffff
 s_mov_b32 s10, 5242880
 s_lshl_b32 s14, s52, 8
 s_add_u32 s14, s14, 786432
 s_mov_b32 m0, 24576
 s_nop 0
 buffer_load_dwordx4 v10, s[8:11], s14 offen lds
 s_add_u32 s14, s14, 32768
 s_mov_b32 m0, 25600
 s_nop 0
 buffer_load_dwordx4 v10, s[8:11], s14 offen lds
 s_add_u32 s14, s14, 32768
 s_mov_b32 m0, 26624
 s_nop 0
 buffer_load_dwordx4 v10, s[8:11], s14 offen lds
 s_add_u32 s14, s14, 32768
 s_mov_b32 m0, 27648
 s_nop 0
 buffer_load_dwordx4 v10, s[8:11], s14 offen lds
 s_add_u32 s14, s14, 32768
 s_mov_b32 m0, 28672
 s_nop 0
 buffer_load_dwordx4 v11, s[8:11], s14 offen lds
 s_add_u32 s14, s14, 32768
 s_mov_b32 m0, 29696
 s_nop 0
 buffer_load_dwordx4 v11, s[8:11], s14 offen lds
 s_add_u32 s14, s14, 32768
 s_mov_b32 m0, 30720
 s_nop 0
 buffer_load_dwordx4 v11, s[8:11], s14 offen lds
 s_add_u32 s14, s14, 32768
 s_mov_b32 m0, 31744
 s_nop 0
 buffer_load_dwordx4 v11, s[8:11], s14 offen lds
 s_waitcnt vmcnt(32)
 s_barrier
 v_xor_b32 v16, 0, v12
 v_add_u32 v16, 32768, v16
 ds_read_b64_tr_b16 v[160:161], v16 offset:0
 ds_read_b64_tr_b16 v[162:163], v16 offset:8192
 ds_read_b64_tr_b16 v[164:165], v16 offset:2048
 ds_read_b64_tr_b16 v[166:167], v16 offset:10240
 v_xor_b32 v16, 32, v12
 v_add_u32 v16, 32768, v16
 ds_read_b64_tr_b16 v[168:169], v16 offset:0
 ds_read_b64_tr_b16 v[170:171], v16 offset:8192
 ds_read_b64_tr_b16 v[172:173], v16 offset:2048
 ds_read_b64_tr_b16 v[174:175], v16 offset:10240
 v_xor_b32 v16, 0, v12
 v_add_u32 v16, 32768, v16
 ds_read_b64_tr_b16 v[176:177], v16 offset:16384
 ds_read_b64_tr_b16 v[178:179], v16 offset:24576
 ds_read_b64_tr_b16 v[180:181], v16 offset:18432
 ds_read_b64_tr_b16 v[182:183], v16 offset:26624
 v_xor_b32 v16, 32, v12
 v_add_u32 v16, 32768, v16
 ds_read_b64_tr_b16 v[32:33], v16 offset:16384
 ds_read_b64_tr_b16 v[34:35], v16 offset:24576
 ds_read_b64_tr_b16 v[36:37], v16 offset:18432
 ds_read_b64_tr_b16 v[38:39], v16 offset:26624
 s_add_u32 s3, s63, 0
 s_waitcnt lgkmcnt(2)
 buffer_store_dwordx4 v[32:35], v1, s[4:7], s3 offen offset:0
 s_waitcnt lgkmcnt(0)
 buffer_store_dwordx4 v[36:39], v1, s[4:7], s3 offen offset:1024
 s_waitcnt lgkmcnt(0)
 s_barrier
 s_lshl_b32 s14, s52, 8
 s_add_u32 s14, s14, 1835008
 s_mov_b32 m0, 57344
 s_nop 0
 buffer_load_dwordx4 v10, s[8:11], s14 offen lds
 s_add_u32 s14, s14, 32768
 s_mov_b32 m0, 58368
 s_nop 0
 buffer_load_dwordx4 v10, s[8:11], s14 offen lds
 s_add_u32 s14, s14, 32768
 s_mov_b32 m0, 59392
 s_nop 0
 buffer_load_dwordx4 v10, s[8:11], s14 offen lds
 s_add_u32 s14, s14, 32768
 s_mov_b32 m0, 60416
 s_nop 0
 buffer_load_dwordx4 v10, s[8:11], s14 offen lds
 s_add_u32 s14, s14, 32768
 s_mov_b32 m0, 61440
 s_nop 0
 buffer_load_dwordx4 v11, s[8:11], s14 offen lds
 s_add_u32 s14, s14, 32768
 s_mov_b32 m0, 62464
 s_nop 0
 buffer_load_dwordx4 v11, s[8:11], s14 offen lds
 s_add_u32 s14, s14, 32768
 s_mov_b32 m0, 63488
 s_nop 0
 buffer_load_dwordx4 v11, s[8:11], s14 offen lds
 s_add_u32 s14, s14, 32768
 s_mov_b32 m0, 64512
 s_nop 0
 buffer_load_dwordx4 v11, s[8:11], s14 offen lds
 s_waitcnt vmcnt(34)
 s_barrier
 v_xor_b32 v16, 0, v12
 v_add_u32 v16, 65536, v16
 ds_read_b64_tr_b16 v[184:185], v16 offset:0
 ds_read_b64_tr_b16 v[186:187], v16 offset:8192
 ds_read_b64_tr_b16 v[188:189], v16 offset:2048
 ds_read_b64_tr_b16 v[190:191], v16 offset:10240
 v_xor_b32 v16, 32, v12
 v_add_u32 v16, 65536, v16
 ds_read_b64_tr_b16 v[192:193], v16 offset:0
 ds_read_b64_tr_b16 v[194:195], v16 offset:8192
 ds_read_b64_tr_b16 v[196:197], v16 offset:2048
 ds_read_b64_tr_b16 v[198:199], v16 offset:10240
 v_xor_b32 v16, 0, v12
 v_add_u32 v16, 65536, v16
 ds_read_b64_tr_b16 v[200:201], v16 offset:16384
 ds_read_b64_tr_b16 v[202:203], v16 offset:24576
 ds_read_b64_tr_b16 v[204:205], v16 offset:18432
 ds_read_b64_tr_b16 v[206:207], v16 offset:26624
 v_xor_b32 v16, 32, v12
 v_add_u32 v16, 65536, v16
 ds_read_b64_tr_b16 v[208:209], v16 offset:16384
 ds_read_b64_tr_b16 v[210:211], v16 offset:24576
 ds_read_b64_tr_b16 v[212:213], v16 offset:18432
 ds_read_b64_tr_b16 v[214:215], v16 offset:26624
 s_waitcnt lgkmcnt(0)
 s_barrier
 s_lshl_b32 s14, s52, 8
 s_add_u32 s14, s14, 2883584
 s_mov_b32 m0, 90112
 s_nop 0
 buffer_load_dwordx4 v10, s[8:11], s14 offen lds
 s_add_u32 s14, s14, 32768
 s_mov_b32 m0, 91136
 s_nop 0
 buffer_load_dwordx4 v10, s[8:11], s14 offen lds
 s_add_u32 s14, s14, 32768
 s_mov_b32 m0, 92160
 s_nop 0
 buffer_load_dwordx4 v10, s[8:11], s14 offen lds
 s_add_u32 s14, s14, 32768
 s_mov_b32 m0, 93184
 s_nop 0
 buffer_load_dwordx4 v10, s[8:11], s14 offen lds
 s_add_u32 s14, s14, 32768
 s_mov_b32 m0, 94208
 s_nop 0
 buffer_load_dwordx4 v11, s[8:11], s14 offen lds
 s_add_u32 s14, s14, 32768
 s_mov_b32 m0, 95232
 s_nop 0
 buffer_load_dwordx4 v11, s[8:11], s14 offen lds
 s_add_u32 s14, s14, 32768
 s_mov_b32 m0, 96256
 s_nop 0
 buffer_load_dwordx4 v11, s[8:11], s14 offen lds
 s_add_u32 s14, s14, 32768
 s_mov_b32 m0, 97280
 s_nop 0
 buffer_load_dwordx4 v11, s[8:11], s14 offen lds
 s_waitcnt vmcnt(34)
 s_barrier
 v_xor_b32 v16, 0, v12
 v_add_u32 v16, 98304, v16
 ds_read_b64_tr_b16 v[40:41], v16 offset:0
 ds_read_b64_tr_b16 v[42:43], v16 offset:8192
 ds_read_b64_tr_b16 v[44:45], v16 offset:2048
 ds_read_b64_tr_b16 v[46:47], v16 offset:10240
 s_add_u32 s3, s63, 2048
 s_waitcnt lgkmcnt(2)
 buffer_store_dwordx4 v[40:43], v1, s[4:7], s3 offen offset:0
 s_waitcnt lgkmcnt(0)
 buffer_store_dwordx4 v[44:47], v1, s[4:7], s3 offen offset:1024
 v_xor_b32 v16, 32, v12
 v_add_u32 v16, 98304, v16
 ds_read_b64_tr_b16 v[48:49], v16 offset:0
 ds_read_b64_tr_b16 v[50:51], v16 offset:8192
 ds_read_b64_tr_b16 v[52:53], v16 offset:2048
 ds_read_b64_tr_b16 v[54:55], v16 offset:10240
 s_add_u32 s3, s63, 4096
 s_waitcnt lgkmcnt(2)
 buffer_store_dwordx4 v[48:51], v1, s[4:7], s3 offen offset:0
 s_waitcnt lgkmcnt(0)
 buffer_store_dwordx4 v[52:55], v1, s[4:7], s3 offen offset:1024
 v_xor_b32 v16, 0, v12
 v_add_u32 v16, 98304, v16
 ds_read_b64_tr_b16 v[56:57], v16 offset:16384
 ds_read_b64_tr_b16 v[58:59], v16 offset:24576
 ds_read_b64_tr_b16 v[60:61], v16 offset:18432
 ds_read_b64_tr_b16 v[62:63], v16 offset:26624
 s_add_u32 s3, s63, 6144
 s_waitcnt lgkmcnt(2)
 buffer_store_dwordx4 v[56:59], v1, s[4:7], s3 offen offset:0
 s_waitcnt lgkmcnt(0)
 buffer_store_dwordx4 v[60:63], v1, s[4:7], s3 offen offset:1024
 v_xor_b32 v16, 32, v12
 v_add_u32 v16, 98304, v16
 ds_read_b64_tr_b16 v[32:33], v16 offset:16384
 ds_read_b64_tr_b16 v[34:35], v16 offset:24576
 ds_read_b64_tr_b16 v[36:37], v16 offset:18432
 ds_read_b64_tr_b16 v[38:39], v16 offset:26624
 s_add_u32 s3, s63, 8192
 s_waitcnt lgkmcnt(2)
 buffer_store_dwordx4 v[32:35], v1, s[4:7], s3 offen offset:0
 s_waitcnt lgkmcnt(0)
 buffer_store_dwordx4 v[36:39], v1, s[4:7], s3 offen offset:1024
 s_waitcnt lgkmcnt(0)
 s_barrier
 s_lshl_b32 s14, s52, 8
 s_add_u32 s14, s14, 3932160
 s_mov_b32 m0, 122880
 s_nop 0
 buffer_load_dwordx4 v10, s[8:11], s14 offen lds
 s_add_u32 s14, s14, 32768
 s_mov_b32 m0, 123904
 s_nop 0
 buffer_load_dwordx4 v10, s[8:11], s14 offen lds
 s_add_u32 s14, s14, 32768
 s_mov_b32 m0, 124928
 s_nop 0
 buffer_load_dwordx4 v10, s[8:11], s14 offen lds
 s_add_u32 s14, s14, 32768
 s_mov_b32 m0, 125952
 s_nop 0
 buffer_load_dwordx4 v10, s[8:11], s14 offen lds
 s_add_u32 s14, s14, 32768
 s_mov_b32 m0, 126976
 s_nop 0
 buffer_load_dwordx4 v11, s[8:11], s14 offen lds
 s_add_u32 s14, s14, 32768
 s_mov_b32 m0, 128000
 s_nop 0
 buffer_load_dwordx4 v11, s[8:11], s14 offen lds
 s_add_u32 s14, s14, 32768
 s_mov_b32 m0, 129024
 s_nop 0
 buffer_load_dwordx4 v11, s[8:11], s14 offen lds
 s_add_u32 s14, s14, 32768
 s_mov_b32 m0, 130048
 s_nop 0
 buffer_load_dwordx4 v11, s[8:11], s14 offen lds
 s_waitcnt vmcnt(42)
 s_barrier
 v_xor_b32 v16, 0, v12
 v_add_u32 v16, 131072, v16
 ds_read_b64_tr_b16 v[216:217], v16 offset:0
 ds_read_b64_tr_b16 v[218:219], v16 offset:8192
 ds_read_b64_tr_b16 v[220:221], v16 offset:2048
 ds_read_b64_tr_b16 v[222:223], v16 offset:10240
 v_xor_b32 v16, 32, v12
 v_add_u32 v16, 131072, v16
 ds_read_b64_tr_b16 v[40:41], v16 offset:0
 ds_read_b64_tr_b16 v[42:43], v16 offset:8192
 ds_read_b64_tr_b16 v[44:45], v16 offset:2048
 ds_read_b64_tr_b16 v[46:47], v16 offset:10240
 s_add_u32 s3, s63, 10240
 s_waitcnt lgkmcnt(2)
 buffer_store_dwordx4 v[40:43], v1, s[4:7], s3 offen offset:0
 s_waitcnt lgkmcnt(0)
 buffer_store_dwordx4 v[44:47], v1, s[4:7], s3 offen offset:1024
 v_xor_b32 v16, 0, v12
 v_add_u32 v16, 131072, v16
 ds_read_b64_tr_b16 v[224:225], v16 offset:16384
 ds_read_b64_tr_b16 v[226:227], v16 offset:24576
 ds_read_b64_tr_b16 v[228:229], v16 offset:18432
 ds_read_b64_tr_b16 v[230:231], v16 offset:26624
 v_xor_b32 v16, 32, v12
 v_add_u32 v16, 131072, v16
 ds_read_b64_tr_b16 v[232:233], v16 offset:16384
 ds_read_b64_tr_b16 v[234:235], v16 offset:24576
 ds_read_b64_tr_b16 v[236:237], v16 offset:18432
 ds_read_b64_tr_b16 v[238:239], v16 offset:26624
 s_waitcnt lgkmcnt(0)
 s_barrier
 s_lshl_b32 s14, s52, 8
 s_add_u32 s14, s14, 4980736
 s_mov_b32 m0, 155648
 s_nop 0
 buffer_load_dwordx4 v10, s[8:11], s14 offen lds
 s_add_u32 s14, s14, 32768
 s_mov_b32 m0, 156672
 s_nop 0
 buffer_load_dwordx4 v10, s[8:11], s14 offen lds
 s_add_u32 s14, s14, 32768
 s_mov_b32 m0, 157696
 s_nop 0
 buffer_load_dwordx4 v10, s[8:11], s14 offen lds
 s_add_u32 s14, s14, 32768
 s_mov_b32 m0, 158720
 s_nop 0
 buffer_load_dwordx4 v10, s[8:11], s14 offen lds
 s_add_u32 s14, s14, 32768
 s_mov_b32 m0, 159744
 s_nop 0
 buffer_load_dwordx4 v11, s[8:11], s14 offen lds
 s_add_u32 s14, s14, 32768
 s_mov_b32 m0, 160768
 s_nop 0
 buffer_load_dwordx4 v11, s[8:11], s14 offen lds
 s_add_u32 s14, s14, 32768
 s_mov_b32 m0, 161792
 s_nop 0
 buffer_load_dwordx4 v11, s[8:11], s14 offen lds
 s_add_u32 s14, s14, 32768
 s_mov_b32 m0, 162816
 s_nop 0
 buffer_load_dwordx4 v11, s[8:11], s14 offen lds
 s_waitcnt vmcnt(44)
 s_barrier
 v_xor_b32 v16, 0, v12
 v_add_u32 v16, 0, v16
 ds_read_b64_tr_b16 v[240:241], v16 offset:0
 ds_read_b64_tr_b16 v[242:243], v16 offset:8192
 ds_read_b64_tr_b16 v[244:245], v16 offset:2048
 ds_read_b64_tr_b16 v[246:247], v16 offset:10240
 v_xor_b32 v16, 32, v12
 v_add_u32 v16, 0, v16
 ds_read_b64_tr_b16 v[248:249], v16 offset:0
 ds_read_b64_tr_b16 v[250:251], v16 offset:8192
 ds_read_b64_tr_b16 v[252:253], v16 offset:2048
 ds_read_b64_tr_b16 v[254:255], v16 offset:10240
 v_xor_b32 v16, 0, v12
 v_add_u32 v16, 0, v16
 ds_read_b64_tr_b16 v[32:33], v16 offset:16384
 ds_read_b64_tr_b16 v[34:35], v16 offset:24576
 ds_read_b64_tr_b16 v[36:37], v16 offset:18432
 ds_read_b64_tr_b16 v[38:39], v16 offset:26624
 v_xor_b32 v16, 32, v12
 v_add_u32 v16, 0, v16
 ds_read_b64_tr_b16 v[40:41], v16 offset:16384
 ds_read_b64_tr_b16 v[42:43], v16 offset:24576
 ds_read_b64_tr_b16 v[44:45], v16 offset:18432
 ds_read_b64_tr_b16 v[46:47], v16 offset:26624
 s_waitcnt lgkmcnt(0)
 s_barrier
 ds_write_b128 v1, v[232:235] offset:28672
 ds_write_b128 v1, v[236:239] offset:29696
 ds_write_b128 v1, v[224:227] offset:30720
 ds_write_b128 v1, v[228:231] offset:31744
 s_waitcnt lgkmcnt(0)
 v_mov_b32 v232, v32
 v_mov_b32 v233, v33
 v_mov_b32 v234, v34
 v_mov_b32 v235, v35
 v_mov_b32 v236, v36
 v_mov_b32 v237, v37
 v_mov_b32 v238, v38
 v_mov_b32 v239, v39
 v_mov_b32 v224, v40
 v_mov_b32 v225, v41
 v_mov_b32 v226, v42
 v_mov_b32 v227, v43
 v_mov_b32 v228, v44
 v_mov_b32 v229, v45
 v_mov_b32 v230, v46
 v_mov_b32 v231, v47
 s_waitcnt vmcnt(34)
 s_barrier
 v_xor_b32 v16, 0, v12
 v_add_u32 v16, 32768, v16
 ds_read_b64_tr_b16 v[32:33], v16 offset:0
 ds_read_b64_tr_b16 v[34:35], v16 offset:8192
 ds_read_b64_tr_b16 v[36:37], v16 offset:2048
 ds_read_b64_tr_b16 v[38:39], v16 offset:10240
 v_xor_b32 v16, 32, v12
 v_add_u32 v16, 32768, v16
 ds_read_b64_tr_b16 v[40:41], v16 offset:0
 ds_read_b64_tr_b16 v[42:43], v16 offset:8192
 ds_read_b64_tr_b16 v[44:45], v16 offset:2048
 ds_read_b64_tr_b16 v[46:47], v16 offset:10240
 v_xor_b32 v16, 0, v12
 v_add_u32 v16, 32768, v16
 ds_read_b64_tr_b16 v[48:49], v16 offset:16384
 ds_read_b64_tr_b16 v[50:51], v16 offset:24576
 ds_read_b64_tr_b16 v[52:53], v16 offset:18432
 ds_read_b64_tr_b16 v[54:55], v16 offset:26624
 v_xor_b32 v16, 32, v12
 v_add_u32 v16, 32768, v16
 ds_read_b64_tr_b16 v[56:57], v16 offset:16384
 ds_read_b64_tr_b16 v[58:59], v16 offset:24576
 ds_read_b64_tr_b16 v[60:61], v16 offset:18432
 ds_read_b64_tr_b16 v[62:63], v16 offset:26624
 s_waitcnt lgkmcnt(0)
 s_barrier
 ds_write_b128 v1, v[208:211] offset:57344
 ds_write_b128 v1, v[212:215] offset:58368
 ds_write_b128 v1, v[200:203] offset:59392
 ds_write_b128 v1, v[204:207] offset:60416
 ds_write_b128 v1, v[184:187] offset:61440
 ds_write_b128 v1, v[188:191] offset:62464
 ds_write_b128 v1, v[176:179] offset:63488
 ds_write_b128 v1, v[180:183] offset:64512
 s_waitcnt lgkmcnt(0)
 v_mov_b32 v208, v32
 v_mov_b32 v209, v33
 v_mov_b32 v210, v34
 v_mov_b32 v211, v35
 v_mov_b32 v212, v36
 v_mov_b32 v213, v37
 v_mov_b32 v214, v38
 v_mov_b32 v215, v39
 v_mov_b32 v200, v40
 v_mov_b32 v201, v41
 v_mov_b32 v202, v42
 v_mov_b32 v203, v43
 v_mov_b32 v204, v44
 v_mov_b32 v205, v45
 v_mov_b32 v206, v46
 v_mov_b32 v207, v47
 v_mov_b32 v184, v48
 v_mov_b32 v185, v49
 v_mov_b32 v186, v50
 v_mov_b32 v187, v51
 v_mov_b32 v188, v52
 v_mov_b32 v189, v53
 v_mov_b32 v190, v54
 v_mov_b32 v191, v55
 v_mov_b32 v176, v56
 v_mov_b32 v177, v57
 v_mov_b32 v178, v58
 v_mov_b32 v179, v59
 v_mov_b32 v180, v60
 v_mov_b32 v181, v61
 v_mov_b32 v182, v62
 v_mov_b32 v183, v63
 s_waitcnt vmcnt(26)
 s_barrier
 v_xor_b32 v16, 0, v12
 v_add_u32 v16, 65536, v16
 ds_read_b64_tr_b16 v[32:33], v16 offset:0
 ds_read_b64_tr_b16 v[34:35], v16 offset:8192
 ds_read_b64_tr_b16 v[36:37], v16 offset:2048
 ds_read_b64_tr_b16 v[38:39], v16 offset:10240
 v_xor_b32 v16, 32, v12
 v_add_u32 v16, 65536, v16
 ds_read_b64_tr_b16 v[40:41], v16 offset:0
 ds_read_b64_tr_b16 v[42:43], v16 offset:8192
 ds_read_b64_tr_b16 v[44:45], v16 offset:2048
 ds_read_b64_tr_b16 v[46:47], v16 offset:10240
 v_xor_b32 v16, 0, v12
 v_add_u32 v16, 65536, v16
 ds_read_b64_tr_b16 v[48:49], v16 offset:16384
 ds_read_b64_tr_b16 v[50:51], v16 offset:24576
 ds_read_b64_tr_b16 v[52:53], v16 offset:18432
 ds_read_b64_tr_b16 v[54:55], v16 offset:26624
 v_xor_b32 v16, 32, v12
 v_add_u32 v16, 65536, v16
 ds_read_b64_tr_b16 v[56:57], v16 offset:16384
 ds_read_b64_tr_b16 v[58:59], v16 offset:24576
 ds_read_b64_tr_b16 v[60:61], v16 offset:18432
 ds_read_b64_tr_b16 v[62:63], v16 offset:26624
 s_waitcnt lgkmcnt(0)
 s_barrier
 ds_write_b128 v2, v[168:171] offset:24576
 ds_write_b128 v2, v[172:175] offset:25600
 ds_write_b128 v2, v[160:163] offset:26624
 ds_write_b128 v2, v[164:167] offset:27648
 ds_write_b128 v2, v[144:147] offset:28672
 ds_write_b128 v2, v[148:151] offset:29696
 ds_write_b128 v2, v[128:131] offset:30720
 ds_write_b128 v2, v[132:135] offset:31744
 s_waitcnt lgkmcnt(0)
 v_mov_b32 v168, v32
 v_mov_b32 v169, v33
 v_mov_b32 v170, v34
 v_mov_b32 v171, v35
 v_mov_b32 v172, v36
 v_mov_b32 v173, v37
 v_mov_b32 v174, v38
 v_mov_b32 v175, v39
 v_mov_b32 v160, v40
 v_mov_b32 v161, v41
 v_mov_b32 v162, v42
 v_mov_b32 v163, v43
 v_mov_b32 v164, v44
 v_mov_b32 v165, v45
 v_mov_b32 v166, v46
 v_mov_b32 v167, v47
 v_mov_b32 v144, v48
 v_mov_b32 v145, v49
 v_mov_b32 v146, v50
 v_mov_b32 v147, v51
 v_mov_b32 v148, v52
 v_mov_b32 v149, v53
 v_mov_b32 v150, v54
 v_mov_b32 v151, v55
 v_mov_b32 v128, v56
 v_mov_b32 v129, v57
 v_mov_b32 v130, v58
 v_mov_b32 v131, v59
 v_mov_b32 v132, v60
 v_mov_b32 v133, v61
 v_mov_b32 v134, v62
 v_mov_b32 v135, v63
 s_waitcnt vmcnt(10)
 s_barrier
 v_xor_b32 v16, 0, v12
 v_add_u32 v16, 98304, v16
 ds_read_b64_tr_b16 v[32:33], v16 offset:0
 ds_read_b64_tr_b16 v[34:35], v16 offset:8192
 ds_read_b64_tr_b16 v[36:37], v16 offset:2048
 ds_read_b64_tr_b16 v[38:39], v16 offset:10240
 v_xor_b32 v16, 32, v12
 v_add_u32 v16, 98304, v16
 ds_read_b64_tr_b16 v[40:41], v16 offset:0
 ds_read_b64_tr_b16 v[42:43], v16 offset:8192
 ds_read_b64_tr_b16 v[44:45], v16 offset:2048
 ds_read_b64_tr_b16 v[46:47], v16 offset:10240
 v_xor_b32 v16, 0, v12
 v_add_u32 v16, 98304, v16
 ds_read_b64_tr_b16 v[48:49], v16 offset:16384
 ds_read_b64_tr_b16 v[50:51], v16 offset:24576
 ds_read_b64_tr_b16 v[52:53], v16 offset:18432
 ds_read_b64_tr_b16 v[54:55], v16 offset:26624
 v_xor_b32 v16, 32, v12
 v_add_u32 v16, 98304, v16
 ds_read_b64_tr_b16 v[56:57], v16 offset:16384
 ds_read_b64_tr_b16 v[58:59], v16 offset:24576
 ds_read_b64_tr_b16 v[60:61], v16 offset:18432
 ds_read_b64_tr_b16 v[62:63], v16 offset:26624
 s_waitcnt lgkmcnt(0)
 s_barrier
 ds_write_b128 v3, a[136:139] offset:8192
 ds_write_b128 v3, a[140:143] offset:9216
 ds_write_b128 v3, a[128:131] offset:10240
 ds_write_b128 v3, a[132:135] offset:11264
 ds_write_b128 v3, a[120:123] offset:12288
 ds_write_b128 v3, a[124:127] offset:13312
 ds_write_b128 v3, a[88:91] offset:14336
 ds_write_b128 v3, a[92:95] offset:15360
 s_waitcnt lgkmcnt(0)
 v_accvgpr_write_b32 a136, v32
 v_accvgpr_write_b32 a137, v33
 v_accvgpr_write_b32 a138, v34
 v_accvgpr_write_b32 a139, v35
 v_accvgpr_write_b32 a140, v36
 v_accvgpr_write_b32 a141, v37
 v_accvgpr_write_b32 a142, v38
 v_accvgpr_write_b32 a143, v39
 v_accvgpr_write_b32 a128, v40
 v_accvgpr_write_b32 a129, v41
 v_accvgpr_write_b32 a130, v42
 v_accvgpr_write_b32 a131, v43
 v_accvgpr_write_b32 a132, v44
 v_accvgpr_write_b32 a133, v45
 v_accvgpr_write_b32 a134, v46
 v_accvgpr_write_b32 a135, v47
 v_accvgpr_write_b32 a120, v48
 v_accvgpr_write_b32 a121, v49
 v_accvgpr_write_b32 a122, v50
 v_accvgpr_write_b32 a123, v51
 v_accvgpr_write_b32 a124, v52
 v_accvgpr_write_b32 a125, v53
 v_accvgpr_write_b32 a126, v54
 v_accvgpr_write_b32 a127, v55
 v_accvgpr_write_b32 a88, v56
 v_accvgpr_write_b32 a89, v57
 v_accvgpr_write_b32 a90, v58
 v_accvgpr_write_b32 a91, v59
 v_accvgpr_write_b32 a92, v60
 v_accvgpr_write_b32 a93, v61
 v_accvgpr_write_b32 a94, v62
 v_accvgpr_write_b32 a95, v63
 s_waitcnt vmcnt(0)
 s_barrier
 v_xor_b32 v16, 0, v12
 v_add_u32 v16, 131072, v16
 ds_read_b64_tr_b16 v[32:33], v16 offset:0
 ds_read_b64_tr_b16 v[34:35], v16 offset:8192
 ds_read_b64_tr_b16 v[36:37], v16 offset:2048
 ds_read_b64_tr_b16 v[38:39], v16 offset:10240
 v_xor_b32 v16, 32, v12
 v_add_u32 v16, 131072, v16
 ds_read_b64_tr_b16 v[40:41], v16 offset:0
 ds_read_b64_tr_b16 v[42:43], v16 offset:8192
 ds_read_b64_tr_b16 v[44:45], v16 offset:2048
 ds_read_b64_tr_b16 v[46:47], v16 offset:10240
 v_xor_b32 v16, 0, v12
 v_add_u32 v16, 131072, v16
 ds_read_b64_tr_b16 v[48:49], v16 offset:16384
 ds_read_b64_tr_b16 v[50:51], v16 offset:24576
 ds_read_b64_tr_b16 v[52:53], v16 offset:18432
 ds_read_b64_tr_b16 v[54:55], v16 offset:26624
 v_xor_b32 v16, 32, v12
 v_add_u32 v16, 131072, v16
 ds_read_b64_tr_b16 v[56:57], v16 offset:16384
 ds_read_b64_tr_b16 v[58:59], v16 offset:24576
 ds_read_b64_tr_b16 v[60:61], v16 offset:18432
 ds_read_b64_tr_b16 v[62:63], v16 offset:26624
 s_waitcnt lgkmcnt(0)
 s_barrier
 ds_write_b128 v3, a[80:83] offset:40960
 ds_write_b128 v3, a[84:87] offset:41984
 ds_write_b128 v3, a[72:75] offset:43008
 ds_write_b128 v3, a[76:79] offset:44032
 ds_write_b128 v3, a[32:35] offset:45056
 ds_write_b128 v3, a[36:39] offset:46080
 ds_write_b128 v3, a[16:19] offset:47104
 ds_write_b128 v3, a[20:23] offset:48128
 s_waitcnt lgkmcnt(0)
 v_accvgpr_write_b32 a80, v32
 v_accvgpr_write_b32 a81, v33
 v_accvgpr_write_b32 a82, v34
 v_accvgpr_write_b32 a83, v35
 v_accvgpr_write_b32 a84, v36
 v_accvgpr_write_b32 a85, v37
 v_accvgpr_write_b32 a86, v38
 v_accvgpr_write_b32 a87, v39
 v_accvgpr_write_b32 a72, v40
 v_accvgpr_write_b32 a73, v41
 v_accvgpr_write_b32 a74, v42
 v_accvgpr_write_b32 a75, v43
 v_accvgpr_write_b32 a76, v44
 v_accvgpr_write_b32 a77, v45
 v_accvgpr_write_b32 a78, v46
 v_accvgpr_write_b32 a79, v47
 v_accvgpr_write_b32 a32, v48
 v_accvgpr_write_b32 a33, v49
 v_accvgpr_write_b32 a34, v50
 v_accvgpr_write_b32 a35, v51
 v_accvgpr_write_b32 a36, v52
 v_accvgpr_write_b32 a37, v53
 v_accvgpr_write_b32 a38, v54
 v_accvgpr_write_b32 a39, v55
 v_accvgpr_write_b32 a16, v56
 v_accvgpr_write_b32 a17, v57
 v_accvgpr_write_b32 a18, v58
 v_accvgpr_write_b32 a19, v59
 v_accvgpr_write_b32 a20, v60
 v_accvgpr_write_b32 a21, v61
 v_accvgpr_write_b32 a22, v62
 v_accvgpr_write_b32 a23, v63
 v_lshlrev_b32 v5, 3, v0
 v_and_b32 v6, 0x1e0, v5
 v_and_b32 v7, 1, v0
 v_lshl_add_u32 v6, v7, 4, v6
 v_and_b32 v7, 2, v0
 v_lshl_add_u32 v6, v7, 2, v6
 v_bfe_u32 v4, v0, 2, 2
 v_lshrrev_b32 v7, 4, v0
 v_cmp_eq_u32 vcc, v4, v7
 v_and_b32 v7, 16, v1
 v_mov_b32 v5, 0x3f80
 v_lshlrev_b32 v7, v7, v5
 v_cndmask_b32 v4, 0, v7, vcc
 v_mov_b32 v5, 0
 s_lshl_b32 s59, s53, 16
 s_add_u32 s59, s59, 983040
 s_mul_i32 s15, s53, 327680
 s_add_u32 s15, s15, 225280
 s_lshl_b32 s3, s52, 6
 s_add_u32 s15, s15, s3
 s_add_u32 s64, s15, 8192
 s_add_u32 s65, s15, 172032
 s_lshr_b32 s14, s52, 4
 s_add_u32 s14, s14, 8
 s_bfe_u32 s15, s52, 0x20002
 s_and_b32 s16, s52, 3
 s_mov_b32 s84, 0x000f000f
 s_mov_b32 s85, 0
 s_lshl_b32 s57, s14, 10
 s_lshl_b32 s3, s15, 6
 s_add_u32 s57, s57, s3
 s_lshl_b32 s3, s16, 8
 s_add_u32 s57, s57, s3
 s_add_u32 s57, s57, s59
 s_add_u32 s59, s59, 6144
 s_add_u32 s16, s60, 3072
 s_waitcnt vmcnt(0) lgkmcnt(0)
 s_mov_b32 s96, s44
 s_and_b32 s97, s45, 0xffff
 s_mov_b32 s98, 256
 s_mov_b32 s99, 0x00020000
 v_mov_b32 v8, 132
 s_mov_b32 s51, 0
 s_mov_b64 exec, 1
L_wb_201:
 buffer_load_dword v9, v8, s[96:99], 0 offen sc1
 s_waitcnt vmcnt(0)
 v_cmp_eq_u32 vcc, 0, v9
 s_cbranch_vccz L_wbd_202
 s_sleep 2
 s_add_u32 s51, s51, 1
 s_cmp_lt_u32 s51, 131072
 s_cbranch_scc1 L_wb_201
 s_branch L_bail
L_wbd_202:
 s_mov_b64 exec, -1
 s_mov_b32 s96, s44
 s_and_b32 s97, s45, 0xffff
 s_mov_b32 s98, 256
 s_mov_b32 s99, 0x00020000
 v_mov_b32 v8, 212
 s_mov_b32 s51, 0
 s_mov_b64 exec, 1
L_wb_203:
 buffer_load_dword v9, v8, s[96:99], 0 offen sc1
 s_waitcnt vmcnt(0)
 v_cmp_eq_u32 vcc, 0, v9
 s_cbranch_vccz L_wbd_204
 s_sleep 2
 s_add_u32 s51, s51, 1
 s_cmp_lt_u32 s51, 131072
 s_cbranch_scc1 L_wb_203
 s_branch L_bail
L_wbd_204:
 s_mov_b64 exec, -1
 s_mov_b32 s96, s44
 s_and_b32 s97, s45, 0xffff
 s_mov_b32 s98, 256
 s_mov_b32 s99, 0x00020000
 v_lshlrev_b32 v8, 5, v0
 s_mov_b32 s51, 0
L_gl_205:
 buffer_load_dword v9, v8, s[96:99], 0 offen sc1
 s_waitcnt vmcnt(0)
 v_readlane_b32 s3, v9, s48
 s_mov_b32 s80, 0
 s_nop 2
 s_cmp_ge_u32 s3, 32
 s_cbranch_scc1 L_gld_206
 s_mov_b32 s80, 0
 v_readlane_b32 s3, v9, 0
 s_nop 3
 s_add_u32 s80, s80, s3
 v_readlane_b32 s3, v9, 1
 s_nop 3
 s_add_u32 s80, s80, s3
 v_readlane_b32 s3, v9, 2
 s_nop 3
 s_add_u32 s80, s80, s3
 v_readlane_b32 s3, v9, 3
 s_nop 3
 s_add_u32 s80, s80, s3
 v_readlane_b32 s3, v9, 4
 s_nop 3
 s_add_u32 s80, s80, s3
 v_readlane_b32 s3, v9, 5
 s_nop 3
 s_add_u32 s80, s80, s3
 v_readlane_b32 s3, v9, 6
 s_nop 3
 s_add_u32 s80, s80, s3
 v_readlane_b32 s3, v9, 7
 s_nop 3
 s_add_u32 s80, s80, s3
 s_cmp_ge_u32 s80, 256
 s_cbranch_scc1 L_gld_206
 s_sleep 4
 s_add_u32 s51, s51, 1
 s_cmp_lt_u32 s51, 131072
 s_cbranch_scc1 L_gl_205
 s_branch L_bail
L_gld_206:
 s_mov_b32 s51, 0
L_f0_207:
 v_mov_b32 v7, 0
 s_mov_b64 exec, 1
 buffer_atomic_add v7, off, s[4:7], s12 sc0
 s_mov_b64 exec, -1
 s_waitcnt vmcnt(0)
 v_readfirstlane_b32 s3, v7
 s_nop 3
 s_cmp_ge_u32 s3, 8
 s_cbranch_scc1 L_f0d_208
 s_sleep 8
 s_add_u32 s51, s51, 1
 s_cmp_lt_u32 s51, 131072
 s_cbranch_scc1 L_f0_207
 s_branch L_bail
L_f0d_208:
 s_add_u32 s12, s12, 4
 v_and_b32 v7, 2, v0
 v_mul_u32_u24 v7, 0x5555, v7
 v_add_u32 v0, 0x4444, v7
 s_mov_b32 m0, 2048
 s_waitcnt vmcnt(0) lgkmcnt(0)
 s_barrier
 buffer_load_dwordx4 v[32:35], v1, s[4:7], s63 offen offset:2048
 buffer_load_dwordx4 v[36:39], v1, s[4:7], s63 offen offset:3072
 buffer_load_dwordx4 v[40:43], v1, s[4:7], s81 offen offset:0
 buffer_load_dwordx4 v[44:47], v1, s[4:7], s81 offen offset:1024
 buffer_load_dwordx4 v[48:51], v1, s[4:7], s81 offen offset:2048
 buffer_load_dwordx4 v[52:55], v1, s[4:7], s81 offen offset:3072
 buffer_load_dwordx4 v[56:59], v1, s[4:7], s101 offen offset:0
 buffer_load_dwordx4 v[60:63], v1, s[4:7], s101 offen offset:1024
 ds_read_b128 v[8:11], v3 offset:49152
 ds_read_b128 v[12:15], v3 offset:49152
 ds_read_b128 v[16:19], v3 offset:49152
 ds_read_b128 v[20:23], v3 offset:49152
 s_waitcnt vmcnt(0) lgkmcnt(0)
 s_cmp_lg_u32 s80, 0
 s_cbranch_scc1 L_ch3_s
.p2align 6
L_ch3_f:
 s_mov_b32 s51, 0
L_pm_209:
 buffer_load_dwordx4 v[24:27], v1, s[4:7], s59 offen offset:0 sc1
 buffer_load_dwordx4 v[28:31], v1, s[4:7], s59 offen offset:1024 sc1
 s_add_u32 s3, s59, 3072
 buffer_load_dwordx4 v[12:15], v1, s[4:7], s3 offen offset:0 sc1
 s_waitcnt vmcnt(2)
 ds_write_b128 v1, v[24:27] offset:6144
 v_max_u32 v7, v24, v26
 s_waitcnt vmcnt(1)
 ds_write_b128 v1, v[28:31] offset:7168
 v_max3_u32 v7, v7, v28, v30
 s_waitcnt vmcnt(0)
 ds_write_b128 v1, v[12:15] offset:9216
 v_max3_u32 v7, v7, v12, v14
 v_cmp_eq_u32 vcc, -1, v7
 s_cbranch_vccnz L_rt_210
 ds_read_b128 v[12:15], v3 offset:49152
 v_smfmac_f32_16x16x64_bf16 v[16:19], v[24:27], v[32:39], v0
 ds_read_b128 v[32:35], v1 offset:30720
 ds_read_b128 v[36:39], v1 offset:31744
 v_smfmac_f32_16x16x64_bf16 v[20:23], v[24:27], v[40:47], v0
 ds_read_b128 v[40:43], v1 offset:28672
 ds_read_b128 v[44:47], v1 offset:29696
 v_smfmac_f32_16x16x64_bf16 v[16:19], v[28:31], v[48:55], v0
 v_smfmac_f32_16x16x64_bf16 v[20:23], v[28:31], v[56:63], v0
 s_waitcnt lgkmcnt(5)
 s_barrier
 buffer_load_dwordx4 v[56:59], v1, s[4:7], s63 offen offset:0
 v_smfmac_f32_16x16x64_bf16 v[8:11], v[24:27], a[136:143], v0
 s_waitcnt lgkmcnt(4)
 v_smfmac_f32_16x16x64_bf16 v[12:15], v[24:27], a[128:135], v0
 ds_read_b128 v[24:27], v1 offset:9216
 buffer_load_dwordx4 v[60:63], v1, s[4:7], s63 offen offset:1024
 v_smfmac_f32_16x16x64_bf16 v[8:11], v[28:31], a[120:127], v0
 v_smfmac_f32_16x16x64_bf16 v[12:15], v[28:31], a[88:95], v0
 ds_read_b128 v[28:31], v1 offset:0
 buffer_load_dwordx4 v[48:51], v1, s[4:7], s101 offen offset:2048
 s_waitcnt lgkmcnt(1)
 v_smfmac_f32_16x16x64_bf16 v[16:19], v[24:27], v[32:39], v0
 ds_read_b128 v[32:35], v2 offset:30720
 ds_read_b128 v[36:39], v2 offset:31744
 v_smfmac_f32_16x16x64_bf16 v[8:11], v[24:27], a[32:39], v0
 buffer_load_dwordx4 v[52:55], v1, s[4:7], s101 offen offset:3072
 v_smfmac_f32_16x16x64_bf16 v[12:15], v[24:27], a[16:23], v0
 v_smfmac_f32_16x16x64_bf16 v[20:23], v[24:27], v[40:47], v0
 ds_read_b128 v[40:43], v2 offset:28672
 ds_read_b128 v[44:47], v2 offset:29696
 ds_read_b128 v[24:27], v1 offset:1024
 s_waitcnt lgkmcnt(5)
 v_smfmac_f32_16x16x64_bf16 v[8:11], v[28:31], v[240:247], v0
 v_smfmac_f32_16x16x64_bf16 v[12:15], v[28:31], v[248:255], v0
 s_waitcnt lgkmcnt(3)
 v_smfmac_f32_16x16x64_bf16 v[16:19], v[28:31], v[32:39], v0
 ds_read_b128 v[32:35], v2 offset:26624
 ds_read_b128 v[36:39], v2 offset:27648
 v_smfmac_f32_16x16x64_bf16 v[20:23], v[28:31], v[136:143], v0
 ds_read_b128 v[28:31], v1 offset:2048
 s_waitcnt lgkmcnt(3)
 v_smfmac_f32_16x16x64_bf16 v[8:11], v[24:27], v[232:239], v0
 v_smfmac_f32_16x16x64_bf16 v[16:19], v[24:27], v[40:47], v0
 ds_read_b128 v[40:43], v2 offset:24576
 ds_read_b128 v[44:47], v2 offset:25600
 v_smfmac_f32_16x16x64_bf16 v[12:15], v[24:27], v[224:231], v0
 v_smfmac_f32_16x16x64_bf16 v[20:23], v[24:27], v[152:159], v0
 ds_read_b128 v[24:27], v1 offset:3072
 s_waitcnt lgkmcnt(3)
 v_smfmac_f32_16x16x64_bf16 v[16:19], v[28:31], v[32:39], v0
 ds_read_b128 v[32:35], v1 offset:63488
 ds_read_b128 v[36:39], v1 offset:64512
 v_smfmac_f32_16x16x64_bf16 v[8:11], v[28:31], v[208:215], v0
 v_smfmac_f32_16x16x64_bf16 v[12:15], v[28:31], v[200:207], v0
 s_waitcnt lgkmcnt(3)
 v_smfmac_f32_16x16x64_bf16 v[20:23], v[28:31], v[40:47], v0
 ds_read_b128 v[40:43], v1 offset:61440
 ds_read_b128 v[44:47], v1 offset:62464
 ds_read_b128 v[28:31], v1 offset:4096
 s_waitcnt lgkmcnt(5)
 v_smfmac_f32_16x16x64_bf16 v[8:11], v[24:27], v[184:191], v0
 v_smfmac_f32_16x16x64_bf16 v[12:15], v[24:27], v[176:183], v0
 s_waitcnt lgkmcnt(3)
 v_smfmac_f32_16x16x64_bf16 v[16:19], v[24:27], v[32:39], v0
 ds_read_b128 v[32:35], v1 offset:59392
 ds_read_b128 v[36:39], v1 offset:60416
 s_waitcnt vmcnt(2)
 v_smfmac_f32_16x16x64_bf16 v[20:23], v[24:27], v[56:63], v0
 ds_read_b128 v[24:27], v1 offset:5120
 buffer_load_dwordx4 v[56:59], v1, s[4:7], s61 offen offset:3072 sc1 nt
 s_waitcnt lgkmcnt(3)
 v_smfmac_f32_16x16x64_bf16 v[8:11], v[28:31], v[168:175], v0
 v_smfmac_f32_16x16x64_bf16 v[16:19], v[28:31], v[40:47], v0
 ds_read_b128 v[40:43], v1 offset:57344
 ds_read_b128 v[44:47], v1 offset:58368
 s_add_u32 s3, s61, 4096
 buffer_load_dwordx4 v[60:63], v1, s[4:7], s3 offen offset:3072 sc1 nt
 v_smfmac_f32_16x16x64_bf16 v[12:15], v[28:31], v[160:167], v0
 v_smfmac_f32_16x16x64_bf16 v[20:23], v[28:31], v[192:199], v0
 ds_read_b128 v[28:31], v1 offset:8192
 s_waitcnt lgkmcnt(3)
 v_smfmac_f32_16x16x64_bf16 v[16:19], v[24:27], v[32:39], v0
 v_smfmac_f32_16x16x64_bf16 v[8:11], v[24:27], v[144:151], v0
 s_add_u32 s3, s61, 67115008
 buffer_load_dwordx4 v[32:35], v1, s[4:7], s3 offen offset:0 sc1 nt
 v_smfmac_f32_16x16x64_bf16 v[12:15], v[24:27], v[128:135], v0
 s_waitcnt lgkmcnt(1)
 v_smfmac_f32_16x16x64_bf16 v[20:23], v[24:27], v[40:47], v0
 ds_read_b128 v[40:43], v3 offset:49152
 ds_read_b128 v[44:47], v3 offset:49152
 buffer_load_dwordx4 v[36:39], v1, s[4:7], s3 offen offset:1024 sc1 nt
 s_waitcnt lgkmcnt(2)
 v_smfmac_f32_16x16x64_bf16 v[8:11], v[28:31], a[80:87], v0
 v_smfmac_f32_16x16x64_bf16 v[12:15], v[28:31], a[72:79], v0
 v_smfmac_f32_16x16x64_bf16 v[16:19], v[28:31], v[216:223], v0
 s_waitcnt vmcnt(4)
 v_smfmac_f32_16x16x64_bf16 v[20:23], v[28:31], v[48:55], v0
 ds_read_b128 v[52:55], v1 offset:0
 v_add_f32 v8, v8, v10
 v_add_f32 v11, v9, v11
 v_cvt_pk_bf16_f32 v9, v8, v11
 v_cvt_pk_bf16_f32 v8, v8, v11
 v_add_f32 v12, v12, v14
 v_add_f32 v15, v13, v15
 v_cvt_pk_bf16_f32 v13, v12, v15
 v_cvt_pk_bf16_f32 v12, v12, v15
 v_mfma_f32_16x16x16_bf16 v[8:11], v[8:9], v[4:5], 0
 v_mfma_f32_16x16x16_bf16 v[12:15], v[12:13], v[4:5], 0
 v_add_f32 v16, v16, v18
 v_add_f32 v19, v17, v19
 v_cvt_pk_bf16_f32 v17, v16, v19
 v_cvt_pk_bf16_f32 v16, v16, v19
 v_add_f32 v20, v20, v22
 v_add_f32 v23, v21, v23
 v_cvt_pk_bf16_f32 v21, v20, v23
 v_cvt_pk_bf16_f32 v20, v20, v23
 v_mfma_f32_16x16x16_bf16 v[16:19], v[16:17], v[4:5], 0
 v_mfma_f32_16x16x16_bf16 v[20:23], v[20:21], v[4:5], 0
 s_waitcnt lgkmcnt(2)
 v_smfmac_f32_16x16x64_bf16 v[40:43], v[24:27], a[240:247], v0
 s_waitcnt lgkmcnt(1)
 v_smfmac_f32_16x16x64_bf16 v[44:47], v[24:27], a[248:255], v0
 ds_read_b128 v[24:27], v1 offset:1024
 v_cvt_pk_bf16_f32 v15, v14, v15
 v_cvt_pk_bf16_f32 v14, v12, v13
 v_cvt_pk_bf16_f32 v13, v10, v11
 v_cvt_pk_bf16_f32 v12, v8, v9
 s_waitcnt vmcnt(3)
 s_nop 0
 v_mfma_f32_16x16x32_bf16 v[8:11], v[56:59], v[12:15], 0
 v_cvt_pk_bf16_f32 v23, v22, v23
 v_cvt_pk_bf16_f32 v22, v20, v21
 v_cvt_pk_bf16_f32 v21, v18, v19
 v_cvt_pk_bf16_f32 v20, v16, v17
 s_waitcnt vmcnt(2)
 v_mfma_f32_16x16x32_bf16 v[16:19], v[60:63], v[12:15], 0
 v_mfma_f32_16x16x32_bf16 v[48:51], v[20:23], v[12:15], 0
 v_smfmac_f32_16x16x64_bf16 v[40:43], v[28:31], v[96:103], v0
 v_smfmac_f32_16x16x64_bf16 v[44:47], v[28:31], v[104:111], v0
 ds_read_b128 v[28:31], v1 offset:2048
 s_waitcnt lgkmcnt(2)
 v_smfmac_f32_16x16x64_bf16 v[40:43], v[52:55], a[160:167], v0
 v_cndmask_b32 v8, v8, v16, s[70:71]
 v_cndmask_b32 v9, v9, v17, s[70:71]
 v_cndmask_b32 v10, v10, v18, s[70:71]
 v_cndmask_b32 v11, v11, v19, s[70:71]
 ds_write_b128 v1, v[8:11] offset:13312
 ds_write_b64 v1, v[48:49] offset:15368
 v_smfmac_f32_16x16x64_bf16 v[44:47], v[52:55], a[168:175], v0
 ds_read_b128 v[52:55], v1 offset:3072
 s_waitcnt lgkmcnt(4)
 v_smfmac_f32_16x16x64_bf16 v[40:43], v[24:27], a[176:183], v0
 v_smfmac_f32_16x16x64_bf16 v[44:47], v[24:27], a[184:191], v0
 ds_read_b128 v[24:27], v1 offset:4096
 s_waitcnt lgkmcnt(4)
 v_smfmac_f32_16x16x64_bf16 v[40:43], v[28:31], a[192:199], v0
 v_smfmac_f32_16x16x64_bf16 v[44:47], v[28:31], a[200:207], v0
 ds_read_b128 v[28:31], v1 offset:6144
 s_waitcnt lgkmcnt(2)
 v_smfmac_f32_16x16x64_bf16 v[40:43], v[52:55], a[208:215], v0
 v_smfmac_f32_16x16x64_bf16 v[44:47], v[52:55], a[216:223], v0
 ds_read_b128 v[52:55], v1 offset:7168
 s_barrier
 ds_read_b128 v[56:59], v1 offset:10240
 ds_read_b128 v[60:63], v1 offset:11264
 ds_read_b128 v[16:19], v1 offset:12288
 ds_read_b128 v[12:15], v1 offset:14336
 ds_read_b128 v[48:51], v1 offset:15360
 s_waitcnt lgkmcnt(7)
 v_smfmac_f32_16x16x64_bf16 v[40:43], v[24:27], a[224:231], v0
 s_mov_b64 exec, s[68:69]
 buffer_store_dwordx4 v[20:23], v6, s[4:7], s62 offen offset:1536 sc1
 s_mov_b64 exec, -1
 v_smfmac_f32_16x16x64_bf16 v[44:47], v[24:27], a[232:239], v0
 ds_read_b128 v[24:27], v1 offset:9216
 v_mov_b32 v7, 0
 s_waitcnt lgkmcnt(7)
 v_smfmac_f32_16x16x64_bf16 v[40:43], v[28:31], v[64:71], v0
 s_mov_b64 exec, 1
 buffer_atomic_add v7, off, s[4:7], s12 sc0
 s_mov_b64 exec, 2
 buffer_atomic_add v7, off, s[4:7], s13 sc0
 s_mov_b64 exec, -1
 v_smfmac_f32_16x16x64_bf16 v[44:47], v[28:31], v[72:79], v0
 s_waitcnt lgkmcnt(6)
 v_smfmac_f32_16x16x64_bf16 v[40:43], v[52:55], v[80:87], v0
 v_smfmac_f32_16x16x64_bf16 v[44:47], v[52:55], v[88:95], v0
 s_waitcnt lgkmcnt(0)
 v_smfmac_f32_16x16x64_bf16 v[40:43], v[24:27], v[112:119], v0
 v_smfmac_f32_16x16x64_bf16 v[44:47], v[24:27], v[120:127], v0
 v_pk_add_f32 v[8:9], v[8:9], v[56:57]
 v_pk_add_f32 v[10:11], v[10:11], v[58:59]
 v_pk_add_f32 v[60:61], v[60:61], v[16:17]
 v_pk_add_f32 v[62:63], v[62:63], v[18:19]
 v_pk_add_f32 v[12:13], v[12:13], v[14:15]
 v_pk_add_f32 v[48:49], v[48:49], v[50:51]
 v_pk_add_f32 v[8:9], v[8:9], v[60:61]
 v_pk_add_f32 v[10:11], v[10:11], v[62:63]
 v_pk_add_f32 v[48:49], v[12:13], v[48:49]
 v_max3_f32 v50, v8, v9, v10
 v_max3_f32 v50, v50, v11, v48
 v_max_f32 v50, v50, v49
 v_add_f32 v40, v40, v42
 v_add_f32 v41, v41, v43
 v_max_f32_dpp v50, v50, v50 quad_perm:[2,3,0,1] row_mask:0xf bank_mask:0xf
 v_mov_b32 v51, v50
 v_add_f32 v44, v44, v46
 v_add_f32 v45, v45, v47
 v_permlane16_swap_b32 v50, v51
 v_max_f32 v50, v50, v51
 v_mov_b32 v51, v50
 v_cvt_pk_bf16_f32 v40, v40, v41
 v_cvt_pk_bf16_f32 v41, v44, v45
 v_permlane32_swap_b32 v50, v51
 v_max_f32 v50, v50, v51
 v_mul_f32 v50, s56, v50
 v_fma_f32 v48, v48, s56, -v50
 v_fma_f32 v49, v49, s56, -v50
 v_fma_f32 v8, v8, s56, -v50
 v_fma_f32 v9, v9, s56, -v50
 v_fma_f32 v10, v10, s56, -v50
 v_fma_f32 v11, v11, s56, -v50
 v_exp_f32 v48, v48
 v_lshrrev_b32 v51, 1, v1
 v_exp_f32 v49, v49
 ds_read_b128 v[56:59], v3 offset:14336
 ds_read_b128 v[60:63], v3 offset:15360
 v_exp_f32 v8, v8
 v_exp_f32 v9, v9
 ds_read_b128 v[24:27], v3 offset:12288
 ds_read_b128 v[28:31], v3 offset:13312
 v_exp_f32 v10, v10
 buffer_store_dwordx2 v[40:41], v51, s[4:7], s62 offen offset:3584 sc1
 v_exp_f32 v11, v11
 v_cvt_pk_bf16_f32 v14, v48, v49
 v_cvt_pk_bf16_f32 v12, v8, v9
 v_cvt_pk_bf16_f32 v13, v10, v11
 v_cndmask_b32 v52, 0, v14, s[68:69]
 v_cndmask_b32 v53, 0, v14, s[70:71]
 v_cndmask_b32 v22, 0, v12, s[70:71]
 v_cndmask_b32 v23, 0, v13, s[70:71]
 v_mfma_f32_16x16x16_bf16 v[44:47], v[40:41], v[52:53], 0
 v_cndmask_b32 v16, 0, v12, s[68:69]
 v_cndmask_b32 v17, 0, v13, s[68:69]
 v_mov_b32_dpp v18, v22 quad_perm:[2,3,0,1] row_mask:0xf bank_mask:0xf
 v_mov_b32_dpp v19, v23 quad_perm:[2,3,0,1] row_mask:0xf bank_mask:0xf
 v_mov_b32_dpp v20, v16 quad_perm:[2,3,0,1] row_mask:0xf bank_mask:0xf
 v_mov_b32_dpp v21, v17 quad_perm:[2,3,0,1] row_mask:0xf bank_mask:0xf
 s_waitcnt vmcnt(5)
 v_mfma_f32_16x16x32_bf16 v[44:47], v[32:35], v[16:19], v[44:47]
 v_add_f32 v54, v8, v9
 v_add_f32 v55, v48, v49
 s_waitcnt vmcnt(4)
 v_mfma_f32_16x16x32_bf16 v[44:47], v[36:39], v[20:23], v[44:47]
 v_add_f32 v54, v54, v10
 v_fma_f32 v55, v55, 0.5, v11
 v_add_f32 v54, v54, v55
 ds_read_b128 v[16:19], v3 offset:49152
 ds_read_b128 v[20:23], v3 offset:49152
 v_add_f32_dpp v54, v54, v54 quad_perm:[2,3,0,1] row_mask:0xf bank_mask:0xf
 v_mov_b32 v55, v54
 ds_read_b128 v[32:35], v3 offset:49152
 ds_read_b128 v[36:39], v3 offset:49152
 v_permlane16_swap_b32 v54, v55
 v_add_f32 v54, v54, v55
 v_mov_b32 v55, v54
 ds_read_b128 v[8:11], v3 offset:49152
 s_cmp_eq_u32 s54, 63
 v_permlane32_swap_b32 v54, v55
 v_add_f32 v54, v54, v55
 v_rcp_f32 v54, v54
 s_cbranch_scc1 L_ch3_end
 v_mul_f32 v44, v44, v54
 v_mul_f32 v45, v45, v54
 v_cvt_pk_bf16_f32 v42, v44, v45
 v_mul_f32 v46, v46, v54
 v_mul_f32 v47, v47, v54
 v_cvt_pk_bf16_f32 v43, v46, v47
 ds_write_b64 v6, v[42:43] offset:1536
 v_and_b32 v40, -9, v6
 v_mov_b32_dpp v12, v42 quad_perm:[0,1,0,1] row_mask:0xf bank_mask:0xf
 v_mov_b32_dpp v14, v42 quad_perm:[2,3,2,3] row_mask:0xf bank_mask:0xf
 v_mov_b32_dpp v13, v43 quad_perm:[0,1,0,1] row_mask:0xf bank_mask:0xf
 v_mov_b32_dpp v15, v43 quad_perm:[2,3,2,3] row_mask:0xf bank_mask:0xf
 s_waitcnt lgkmcnt(5)
 s_nop 0
 v_smfmac_f32_16x16x64_bf16 v[16:19], v[12:15], a[24:31], v0
 s_waitcnt lgkmcnt(4)
 v_smfmac_f32_16x16x64_bf16 v[20:23], v[12:15], a[56:63], v0
 s_waitcnt lgkmcnt(0)
 s_barrier
 ds_read_b128 v[48:51], v40 offset:0
 ds_read_b128 v[52:55], v40 offset:512
 ds_read_b128 v[44:47], v40 offset:1024
 v_smfmac_f32_16x16x64_bf16 v[32:35], v[12:15], v[56:63], v0
 ds_read_b128 v[56:59], v3 offset:47104
 ds_read_b128 v[60:63], v3 offset:48128
 s_mov_b32 m0, 6144
 v_smfmac_f32_16x16x64_bf16 v[36:39], v[12:15], v[24:31], v0
 ds_read_b128 v[24:27], v3 offset:45056
 ds_read_b128 v[28:31], v3 offset:46080
 buffer_load_dwordx4 v1, s[4:7], s81 offen offset:0 lds
 v_smfmac_f32_16x16x64_bf16 v[8:11], v[12:15], a[152:159], v0
 s_mov_b32 m0, 6144
 s_waitcnt lgkmcnt(6)
 v_smfmac_f32_16x16x64_bf16 v[16:19], v[48:51], a[0:7], v0
 buffer_load_dwordx4 v1, s[4:7], s81 offen offset:1024 lds
 s_waitcnt lgkmcnt(5)
 v_smfmac_f32_16x16x64_bf16 v[16:19], v[52:55], a[8:15], v0
 s_mov_b32 m0, 7168
 s_waitcnt lgkmcnt(2)
 v_smfmac_f32_16x16x64_bf16 v[16:19], v[44:47], v[56:63], v0
 ds_read_b128 v[56:59], v3 offset:43008
 ds_read_b128 v[60:63], v3 offset:44032
 buffer_load_dwordx4 v1, s[4:7], s81 offen offset:2048 lds
 s_waitcnt lgkmcnt(2)
 v_smfmac_f32_16x16x64_bf16 v[20:23], v[48:51], v[24:31], v0
 ds_read_b128 v[24:27], v3 offset:40960
 ds_read_b128 v[28:31], v3 offset:41984
 v_smfmac_f32_16x16x64_bf16 v[20:23], v[52:55], a[40:47], v0
 v_smfmac_f32_16x16x64_bf16 v[20:23], v[44:47], a[48:55], v0
 v_cvt_pk_bf16_f32 v16, v16, v17
 v_smfmac_f32_16x16x64_bf16 v[32:35], v[48:51], a[64:71], v0
 v_cvt_pk_bf16_f32 v17, v18, v19
 s_waitcnt lgkmcnt(2)
 v_smfmac_f32_16x16x64_bf16 v[32:35], v[52:55], v[56:63], v0
 ds_read_b128 v[56:59], v3 offset:10240
 ds_read_b128 v[60:63], v3 offset:11264
 v_and_or_b32 v16, v16, -2, s55
 s_waitcnt lgkmcnt(2)
 v_smfmac_f32_16x16x64_bf16 v[32:35], v[44:47], v[24:31], v0
 ds_read_b128 v[24:27], v3 offset:8192
 ds_read_b128 v[28:31], v3 offset:9216
 v_cvt_pk_bf16_f32 v18, v20, v21
 v_smfmac_f32_16x16x64_bf16 v[36:39], v[48:51], a[96:103], v0
 v_cvt_pk_bf16_f32 v19, v22, v23
 v_smfmac_f32_16x16x64_bf16 v[36:39], v[52:55], a[104:111], v0
 v_and_or_b32 v18, v18, -2, s55
 buffer_store_dwordx4 v[16:19], v1, s[4:7], s60 offen offset:0
 v_smfmac_f32_16x16x64_bf16 v[36:39], v[44:47], a[112:119], v0
 v_cvt_pk_bf16_f32 v32, v32, v33
 s_waitcnt lgkmcnt(2)
 v_smfmac_f32_16x16x64_bf16 v[8:11], v[48:51], v[56:63], v0
 v_cvt_pk_bf16_f32 v33, v34, v35
 s_waitcnt lgkmcnt(0)
 v_smfmac_f32_16x16x64_bf16 v[8:11], v[52:55], v[24:31], v0
 v_and_or_b32 v32, v32, -2, s55
 v_smfmac_f32_16x16x64_bf16 v[8:11], v[44:47], a[144:151], v0
 v_cvt_pk_bf16_f32 v34, v36, v37
 v_cvt_pk_bf16_f32 v35, v38, v39
 v_and_or_b32 v34, v34, -2, s55
 buffer_store_dwordx4 v[32:35], v1, s[4:7], s60 offen offset:1024
 s_nop 3
 v_cvt_pk_bf16_f32 v8, v8, v9
 v_cvt_pk_bf16_f32 v9, v10, v11
 v_and_or_b32 v8, v8, -2, s55
 buffer_store_dwordx2 v[8:9], v1, s[4:7], s16 offen offset:8
 buffer_load_dwordx4 v[32:35], v1, s[4:7], s63 offen offset:2048
 buffer_load_dwordx4 v[36:39], v1, s[4:7], s63 offen offset:3072
 s_add_u32 s54, s54, 1
 s_add_u32 s61, s61, 524288
 s_and_b32 s3, s54, 3
 s_cselect_b32 s3, 1, -3
 s_lshl_b32 s3, s3, 17
 s_add_u32 s62, s62, s3
 s_and_b32 s3, s54, 3
 s_cselect_b32 s3, 1, -3
 s_lshl_b32 s3, s3, 14
 s_add_u32 s57, s57, s3
 s_add_u32 s59, s59, s3
 s_xor_b32 s58, s57, 32768
 s_mov_b32 s51, 0
L_fl_211:
 s_waitcnt vmcnt(9)
 v_readlane_b32 s14, v7, 0
 v_readlane_b32 s15, v7, 1
 s_nop 3
 s_cmp_lt_u32 s14, 8
 s_cbranch_scc1 L_fr_212
 s_add_u32 s15, s15, 4
 s_cmp_le_u32 s15, s54
 s_cbranch_scc1 L_fr_212
 s_add_u32 s12, s12, 4
 s_nop 15
 s_nop 15
 s_nop 15
 s_nop 15
 s_nop 15
 s_nop 15
 s_nop 15
 s_nop 15
 s_nop 15
 s_nop 15
 s_nop 15
 s_nop 15
 s_nop 15
 s_nop 11
 s_xor_b32 s55, s55, 1
 s_waitcnt vmcnt(5)
 ds_read_b128 v[40:43], v1 offset:6144
 ds_read_b128 v[44:47], v1 offset:7168
 ds_read_b128 v[48:51], v1 offset:9216
 buffer_load_dwordx4 v[52:55], v1, s[4:7], s81 offen offset:3072
 buffer_load_dwordx4 v[56:59], v1, s[4:7], s101 offen offset:0
 buffer_load_dwordx4 v[60:63], v1, s[4:7], s101 offen offset:1024
 ds_read_b128 v[8:11], v3 offset:49152
 ds_read_b128 v[16:19], v3 offset:49152
 ds_read_b128 v[20:23], v3 offset:49152
 s_waitcnt lgkmcnt(0)
 s_nop 15
 s_nop 15
 s_nop 7
 s_branch L_ch3_f
L_rt_210:
 s_add_u32 s51, s51, 1
 s_cmp_lt_u32 s51, 131072
 s_cbranch_scc1 L_pm_209
 s_branch L_bail
L_fr_212:
 s_sleep 4
 v_mov_b32 v7, 0
 s_mov_b64 exec, 1
 buffer_atomic_add v7, off, s[4:7], s12 sc0
 s_mov_b64 exec, 2
 buffer_atomic_add v7, off, s[4:7], s13 sc0
 s_mov_b64 exec, -1
 s_waitcnt vmcnt(0)
 s_add_u32 s51, s51, 1
 s_cmp_lt_u32 s51, 131072
 s_cbranch_scc1 L_fl_211
 s_branch L_bail
.p2align 6
L_ch3_s:
 s_mov_b32 s51, 0
L_pm_213:
 buffer_load_dwordx4 v[24:27], v1, s[4:7], s59 offen offset:0 sc1
 buffer_load_dwordx4 v[28:31], v1, s[4:7], s59 offen offset:1024 sc1
 s_add_u32 s3, s59, 3072
 buffer_load_dwordx4 v[12:15], v1, s[4:7], s3 offen offset:0 sc1
 s_waitcnt vmcnt(2)
 ds_write_b128 v1, v[24:27] offset:6144
 v_max_u32 v7, v24, v26
 s_waitcnt vmcnt(1)
 ds_write_b128 v1, v[28:31] offset:7168
 v_max3_u32 v7, v7, v28, v30
 s_waitcnt vmcnt(0)
 ds_write_b128 v1, v[12:15] offset:9216
 v_max3_u32 v7, v7, v12, v14
 v_cmp_eq_u32 vcc, -1, v7
 s_cbranch_vccnz L_rt_214
 ds_read_b128 v[12:15], v3 offset:49152
 v_smfmac_f32_16x16x64_bf16 v[16:19], v[24:27], v[32:39], v0
 ds_read_b128 v[32:35], v1 offset:30720
 ds_read_b128 v[36:39], v1 offset:31744
 v_smfmac_f32_16x16x64_bf16 v[20:23], v[24:27], v[40:47], v0
 ds_read_b128 v[40:43], v1 offset:28672
 ds_read_b128 v[44:47], v1 offset:29696
 v_smfmac_f32_16x16x64_bf16 v[16:19], v[28:31], v[48:55], v0
 v_smfmac_f32_16x16x64_bf16 v[20:23], v[28:31], v[56:63], v0
 s_waitcnt lgkmcnt(5)
 s_barrier
 buffer_load_dwordx4 v[56:59], v1, s[4:7], s63 offen offset:0
 v_smfmac_f32_16x16x64_bf16 v[8:11], v[24:27], a[136:143], v0
 s_waitcnt lgkmcnt(4)
 v_smfmac_f32_16x16x64_bf16 v[12:15], v[24:27], a[128:135], v0
 ds_read_b128 v[24:27], v1 offset:9216
 buffer_load_dwordx4 v[60:63], v1, s[4:7], s63 offen offset:1024
 v_smfmac_f32_16x16x64_bf16 v[8:11], v[28:31], a[120:127], v0
 v_smfmac_f32_16x16x64_bf16 v[12:15], v[28:31], a[88:95], v0
 ds_read_b128 v[28:31], v1 offset:0
 buffer_load_dwordx4 v[48:51], v1, s[4:7], s101 offen offset:2048
 s_waitcnt lgkmcnt(1)
 v_smfmac_f32_16x16x64_bf16 v[16:19], v[24:27], v[32:39], v0
 ds_read_b128 v[32:35], v2 offset:30720
 ds_read_b128 v[36:39], v2 offset:31744
 v_smfmac_f32_16x16x64_bf16 v[8:11], v[24:27], a[32:39], v0
 buffer_load_dwordx4 v[52:55], v1, s[4:7], s101 offen offset:3072
 v_smfmac_f32_16x16x64_bf16 v[12:15], v[24:27], a[16:23], v0
 v_smfmac_f32_16x16x64_bf16 v[20:23], v[24:27], v[40:47], v0
 ds_read_b128 v[40:43], v2 offset:28672
 ds_read_b128 v[44:47], v2 offset:29696
 ds_read_b128 v[24:27], v1 offset:1024
 s_waitcnt lgkmcnt(5)
 v_smfmac_f32_16x16x64_bf16 v[8:11], v[28:31], v[240:247], v0
 v_smfmac_f32_16x16x64_bf16 v[12:15], v[28:31], v[248:255], v0
 s_waitcnt lgkmcnt(3)
 v_smfmac_f32_16x16x64_bf16 v[16:19], v[28:31], v[32:39], v0
 ds_read_b128 v[32:35], v2 offset:26624
 ds_read_b128 v[36:39], v2 offset:27648
 v_smfmac_f32_16x16x64_bf16 v[20:23], v[28:31], v[136:143], v0
 ds_read_b128 v[28:31], v1 offset:2048
 s_waitcnt lgkmcnt(3)
 v_smfmac_f32_16x16x64_bf16 v[8:11], v[24:27], v[232:239], v0
 v_smfmac_f32_16x16x64_bf16 v[16:19], v[24:27], v[40:47], v0
 ds_read_b128 v[40:43], v2 offset:24576
 ds_read_b128 v[44:47], v2 offset:25600
 v_smfmac_f32_16x16x64_bf16 v[12:15], v[24:27], v[224:231], v0
 v_smfmac_f32_16x16x64_bf16 v[20:23], v[24:27], v[152:159], v0
 ds_read_b128 v[24:27], v1 offset:3072
 s_waitcnt lgkmcnt(3)
 v_smfmac_f32_16x16x64_bf16 v[16:19], v[28:31], v[32:39], v0
 ds_read_b128 v[32:35], v1 offset:63488
 ds_read_b128 v[36:39], v1 offset:64512
 v_smfmac_f32_16x16x64_bf16 v[8:11], v[28:31], v[208:215], v0
 v_smfmac_f32_16x16x64_bf16 v[12:15], v[28:31], v[200:207], v0
 s_waitcnt lgkmcnt(3)
 v_smfmac_f32_16x16x64_bf16 v[20:23], v[28:31], v[40:47], v0
 ds_read_b128 v[40:43], v1 offset:61440
 ds_read_b128 v[44:47], v1 offset:62464
 ds_read_b128 v[28:31], v1 offset:4096
 s_waitcnt lgkmcnt(5)
 v_smfmac_f32_16x16x64_bf16 v[8:11], v[24:27], v[184:191], v0
 v_smfmac_f32_16x16x64_bf16 v[12:15], v[24:27], v[176:183], v0
 s_waitcnt lgkmcnt(3)
 v_smfmac_f32_16x16x64_bf16 v[16:19], v[24:27], v[32:39], v0
 ds_read_b128 v[32:35], v1 offset:59392
 ds_read_b128 v[36:39], v1 offset:60416
 s_waitcnt vmcnt(2)
 v_smfmac_f32_16x16x64_bf16 v[20:23], v[24:27], v[56:63], v0
 ds_read_b128 v[24:27], v1 offset:5120
 buffer_load_dwordx4 v[56:59], v1, s[4:7], s61 offen offset:3072 sc1 nt
 s_waitcnt lgkmcnt(3)
 v_smfmac_f32_16x16x64_bf16 v[8:11], v[28:31], v[168:175], v0
 v_smfmac_f32_16x16x64_bf16 v[16:19], v[28:31], v[40:47], v0
 ds_read_b128 v[40:43], v1 offset:57344
 ds_read_b128 v[44:47], v1 offset:58368
 s_add_u32 s3, s61, 4096
 buffer_load_dwordx4 v[60:63], v1, s[4:7], s3 offen offset:3072 sc1 nt
 v_smfmac_f32_16x16x64_bf16 v[12:15], v[28:31], v[160:167], v0
 v_smfmac_f32_16x16x64_bf16 v[20:23], v[28:31], v[192:199], v0
 ds_read_b128 v[28:31], v1 offset:8192
 s_waitcnt lgkmcnt(3)
 v_smfmac_f32_16x16x64_bf16 v[16:19], v[24:27], v[32:39], v0
 v_smfmac_f32_16x16x64_bf16 v[8:11], v[24:27], v[144:151], v0
 s_add_u32 s3, s61, 67115008
 buffer_load_dwordx4 v[32:35], v1, s[4:7], s3 offen offset:0 sc1 nt
 v_smfmac_f32_16x16x64_bf16 v[12:15], v[24:27], v[128:135], v0
 s_waitcnt lgkmcnt(1)
 v_smfmac_f32_16x16x64_bf16 v[20:23], v[24:27], v[40:47], v0
 ds_read_b128 v[40:43], v3 offset:49152
 ds_read_b128 v[44:47], v3 offset:49152
 buffer_load_dwordx4 v[36:39], v1, s[4:7], s3 offen offset:1024 sc1 nt
 s_waitcnt lgkmcnt(2)
 v_smfmac_f32_16x16x64_bf16 v[8:11], v[28:31], a[80:87], v0
 v_smfmac_f32_16x16x64_bf16 v[12:15], v[28:31], a[72:79], v0
 v_smfmac_f32_16x16x64_bf16 v[16:19], v[28:31], v[216:223], v0
 s_waitcnt vmcnt(4)
 v_smfmac_f32_16x16x64_bf16 v[20:23], v[28:31], v[48:55], v0
 ds_read_b128 v[52:55], v1 offset:0
 v_add_f32 v8, v8, v10
 v_add_f32 v11, v9, v11
 v_cvt_pk_bf16_f32 v9, v8, v11
 v_cvt_pk_bf16_f32 v8, v8, v11
 v_add_f32 v12, v12, v14
 v_add_f32 v15, v13, v15
 v_cvt_pk_bf16_f32 v13, v12, v15
 v_cvt_pk_bf16_f32 v12, v12, v15
 v_mfma_f32_16x16x16_bf16 v[8:11], v[8:9], v[4:5], 0
 v_mfma_f32_16x16x16_bf16 v[12:15], v[12:13], v[4:5], 0
 v_add_f32 v16, v16, v18
 v_add_f32 v19, v17, v19
 v_cvt_pk_bf16_f32 v17, v16, v19
 v_cvt_pk_bf16_f32 v16, v16, v19
 v_add_f32 v20, v20, v22
 v_add_f32 v23, v21, v23
 v_cvt_pk_bf16_f32 v21, v20, v23
 v_cvt_pk_bf16_f32 v20, v20, v23
 v_mfma_f32_16x16x16_bf16 v[16:19], v[16:17], v[4:5], 0
 v_mfma_f32_16x16x16_bf16 v[20:23], v[20:21], v[4:5], 0
 s_waitcnt lgkmcnt(2)
 v_smfmac_f32_16x16x64_bf16 v[40:43], v[24:27], a[240:247], v0
 s_waitcnt lgkmcnt(1)
 v_smfmac_f32_16x16x64_bf16 v[44:47], v[24:27], a[248:255], v0
 ds_read_b128 v[24:27], v1 offset:1024
 v_cvt_pk_bf16_f32 v15, v14, v15
 v_cvt_pk_bf16_f32 v14, v12, v13
 v_cvt_pk_bf16_f32 v13, v10, v11
 v_cvt_pk_bf16_f32 v12, v8, v9
 s_waitcnt vmcnt(3)
 s_nop 0
 v_mfma_f32_16x16x32_bf16 v[8:11], v[56:59], v[12:15], 0
 v_cvt_pk_bf16_f32 v23, v22, v23
 v_cvt_pk_bf16_f32 v22, v20, v21
 v_cvt_pk_bf16_f32 v21, v18, v19
 v_cvt_pk_bf16_f32 v20, v16, v17
 s_waitcnt vmcnt(2)
 v_mfma_f32_16x16x32_bf16 v[16:19], v[60:63], v[12:15], 0
 v_mfma_f32_16x16x32_bf16 v[48:51], v[20:23], v[12:15], 0
 v_smfmac_f32_16x16x64_bf16 v[40:43], v[28:31], v[96:103], v0
 v_smfmac_f32_16x16x64_bf16 v[44:47], v[28:31], v[104:111], v0
 ds_read_b128 v[28:31], v1 offset:2048
 s_waitcnt lgkmcnt(2)
 v_smfmac_f32_16x16x64_bf16 v[40:43], v[52:55], a[160:167], v0
 v_cndmask_b32 v8, v8, v16, s[70:71]
 v_cndmask_b32 v9, v9, v17, s[70:71]
 v_cndmask_b32 v10, v10, v18, s[70:71]
 v_cndmask_b32 v11, v11, v19, s[70:71]
 ds_write_b128 v1, v[8:11] offset:13312
 ds_write_b64 v1, v[48:49] offset:15368
 v_smfmac_f32_16x16x64_bf16 v[44:47], v[52:55], a[168:175], v0
 ds_read_b128 v[52:55], v1 offset:3072
 s_waitcnt lgkmcnt(4)
 v_smfmac_f32_16x16x64_bf16 v[40:43], v[24:27], a[176:183], v0
 v_smfmac_f32_16x16x64_bf16 v[44:47], v[24:27], a[184:191], v0
 ds_read_b128 v[24:27], v1 offset:4096
 s_waitcnt lgkmcnt(4)
 v_smfmac_f32_16x16x64_bf16 v[40:43], v[28:31], a[192:199], v0
 v_smfmac_f32_16x16x64_bf16 v[44:47], v[28:31], a[200:207], v0
 ds_read_b128 v[28:31], v1 offset:6144
 s_waitcnt lgkmcnt(2)
 v_smfmac_f32_16x16x64_bf16 v[40:43], v[52:55], a[208:215], v0
 v_smfmac_f32_16x16x64_bf16 v[44:47], v[52:55], a[216:223], v0
 ds_read_b128 v[52:55], v1 offset:7168
 s_barrier
 ds_read_b128 v[56:59], v1 offset:10240
 ds_read_b128 v[60:63], v1 offset:11264
 ds_read_b128 v[16:19], v1 offset:12288
 ds_read_b128 v[12:15], v1 offset:14336
 ds_read_b128 v[48:51], v1 offset:15360
 s_waitcnt lgkmcnt(7)
 v_smfmac_f32_16x16x64_bf16 v[40:43], v[24:27], a[224:231], v0
 s_mov_b64 exec, s[68:69]
 buffer_store_dwordx4 v[20:23], v6, s[4:7], s62 offen offset:1536 sc1
 s_mov_b64 exec, -1
 v_smfmac_f32_16x16x64_bf16 v[44:47], v[24:27], a[232:239], v0
 ds_read_b128 v[24:27], v1 offset:9216
 v_mov_b32 v7, 0
 s_waitcnt lgkmcnt(7)
 v_smfmac_f32_16x16x64_bf16 v[40:43], v[28:31], v[64:71], v0
 s_mov_b64 exec, 1
 buffer_atomic_add v7, off, s[4:7], s12 sc0
 s_mov_b64 exec, 2
 buffer_atomic_add v7, off, s[4:7], s13 sc0
 s_mov_b64 exec, -1
 v_smfmac_f32_16x16x64_bf16 v[44:47], v[28:31], v[72:79], v0
 s_waitcnt lgkmcnt(6)
 v_smfmac_f32_16x16x64_bf16 v[40:43], v[52:55], v[80:87], v0
 v_smfmac_f32_16x16x64_bf16 v[44:47], v[52:55], v[88:95], v0
 s_waitcnt lgkmcnt(0)
 v_smfmac_f32_16x16x64_bf16 v[40:43], v[24:27], v[112:119], v0
 v_smfmac_f32_16x16x64_bf16 v[44:47], v[24:27], v[120:127], v0
 v_pk_add_f32 v[8:9], v[8:9], v[56:57]
 v_pk_add_f32 v[10:11], v[10:11], v[58:59]
 v_pk_add_f32 v[60:61], v[60:61], v[16:17]
 v_pk_add_f32 v[62:63], v[62:63], v[18:19]
 v_pk_add_f32 v[12:13], v[12:13], v[14:15]
 v_pk_add_f32 v[48:49], v[48:49], v[50:51]
 v_pk_add_f32 v[8:9], v[8:9], v[60:61]
 v_pk_add_f32 v[10:11], v[10:11], v[62:63]
 v_pk_add_f32 v[48:49], v[12:13], v[48:49]
 v_max3_f32 v50, v8, v9, v10
 v_max3_f32 v50, v50, v11, v48
 v_max_f32 v50, v50, v49
 v_add_f32 v40, v40, v42
 v_add_f32 v41, v41, v43
 v_max_f32_dpp v50, v50, v50 quad_perm:[2,3,0,1] row_mask:0xf bank_mask:0xf
 v_mov_b32 v51, v50
 v_add_f32 v44, v44, v46
 v_add_f32 v45, v45, v47
 v_permlane16_swap_b32 v50, v51
 v_max_f32 v50, v50, v51
 v_mov_b32 v51, v50
 v_cvt_pk_bf16_f32 v40, v40, v41
 v_cvt_pk_bf16_f32 v41, v44, v45
 v_permlane32_swap_b32 v50, v51
 v_max_f32 v50, v50, v51
 v_mul_f32 v50, s56, v50
 v_fma_f32 v48, v48, s56, -v50
 v_fma_f32 v49, v49, s56, -v50
 v_fma_f32 v8, v8, s56, -v50
 v_fma_f32 v9, v9, s56, -v50
 v_fma_f32 v10, v10, s56, -v50
 v_fma_f32 v11, v11, s56, -v50
 v_exp_f32 v48, v48
 v_lshrrev_b32 v51, 1, v1
 v_exp_f32 v49, v49
 ds_read_b128 v[56:59], v3 offset:14336
 ds_read_b128 v[60:63], v3 offset:15360
 v_exp_f32 v8, v8
 v_exp_f32 v9, v9
 ds_read_b128 v[24:27], v3 offset:12288
 ds_read_b128 v[28:31], v3 offset:13312
 v_exp_f32 v10, v10
 buffer_store_dwordx2 v[40:41], v51, s[4:7], s62 offen offset:3584 sc1
 v_exp_f32 v11, v11
 v_cvt_pk_bf16_f32 v14, v48, v49
 v_cvt_pk_bf16_f32 v12, v8, v9
 v_cvt_pk_bf16_f32 v13, v10, v11
 v_cndmask_b32 v52, 0, v14, s[68:69]
 v_cndmask_b32 v53, 0, v14, s[70:71]
 v_cndmask_b32 v22, 0, v12, s[70:71]
 v_cndmask_b32 v23, 0, v13, s[70:71]
 v_mfma_f32_16x16x16_bf16 v[44:47], v[40:41], v[52:53], 0
 v_cndmask_b32 v16, 0, v12, s[68:69]
 v_cndmask_b32 v17, 0, v13, s[68:69]
 v_mov_b32_dpp v18, v22 quad_perm:[2,3,0,1] row_mask:0xf bank_mask:0xf
 v_mov_b32_dpp v19, v23 quad_perm:[2,3,0,1] row_mask:0xf bank_mask:0xf
 v_mov_b32_dpp v20, v16 quad_perm:[2,3,0,1] row_mask:0xf bank_mask:0xf
 v_mov_b32_dpp v21, v17 quad_perm:[2,3,0,1] row_mask:0xf bank_mask:0xf
 s_waitcnt vmcnt(5)
 v_mfma_f32_16x16x32_bf16 v[44:47], v[32:35], v[16:19], v[44:47]
 v_add_f32 v54, v8, v9
 v_add_f32 v55, v48, v49
 s_waitcnt vmcnt(4)
 v_mfma_f32_16x16x32_bf16 v[44:47], v[36:39], v[20:23], v[44:47]
 v_add_f32 v54, v54, v10
 v_fma_f32 v55, v55, 0.5, v11
 v_add_f32 v54, v54, v55
 ds_read_b128 v[16:19], v3 offset:49152
 ds_read_b128 v[20:23], v3 offset:49152
 v_add_f32_dpp v54, v54, v54 quad_perm:[2,3,0,1] row_mask:0xf bank_mask:0xf
 v_mov_b32 v55, v54
 ds_read_b128 v[32:35], v3 offset:49152
 ds_read_b128 v[36:39], v3 offset:49152
 v_permlane16_swap_b32 v54, v55
 v_add_f32 v54, v54, v55
 v_mov_b32 v55, v54
 ds_read_b128 v[8:11], v3 offset:49152
 s_cmp_eq_u32 s54, 63
 v_permlane32_swap_b32 v54, v55
 v_add_f32 v54, v54, v55
 v_rcp_f32 v54, v54
 s_cbranch_scc1 L_ch3_end
 v_mul_f32 v44, v44, v54
 v_mul_f32 v45, v45, v54
 v_cvt_pk_bf16_f32 v42, v44, v45
 v_mul_f32 v46, v46, v54
 v_mul_f32 v47, v47, v54
 v_cvt_pk_bf16_f32 v43, v46, v47
 ds_write_b64 v6, v[42:43] offset:1536
 v_and_b32 v40, -9, v6
 v_mov_b32_dpp v12, v42 quad_perm:[0,1,0,1] row_mask:0xf bank_mask:0xf
 v_mov_b32_dpp v14, v42 quad_perm:[2,3,2,3] row_mask:0xf bank_mask:0xf
 v_mov_b32_dpp v13, v43 quad_perm:[0,1,0,1] row_mask:0xf bank_mask:0xf
 v_mov_b32_dpp v15, v43 quad_perm:[2,3,2,3] row_mask:0xf bank_mask:0xf
 s_waitcnt lgkmcnt(5)
 s_nop 0
 v_smfmac_f32_16x16x64_bf16 v[16:19], v[12:15], a[24:31], v0
 s_waitcnt lgkmcnt(4)
 v_smfmac_f32_16x16x64_bf16 v[20:23], v[12:15], a[56:63], v0
 s_waitcnt lgkmcnt(0)
 s_barrier
 ds_read_b128 v[48:51], v40 offset:0
 ds_read_b128 v[52:55], v40 offset:512
 ds_read_b128 v[44:47], v40 offset:1024
 v_smfmac_f32_16x16x64_bf16 v[32:35], v[12:15], v[56:63], v0
 ds_read_b128 v[56:59], v3 offset:47104
 ds_read_b128 v[60:63], v3 offset:48128
 s_mov_b32 m0, 6144
 v_smfmac_f32_16x16x64_bf16 v[36:39], v[12:15], v[24:31], v0
 ds_read_b128 v[24:27], v3 offset:45056
 ds_read_b128 v[28:31], v3 offset:46080
 buffer_load_dwordx4 v1, s[4:7], s81 offen offset:0 lds
 v_smfmac_f32_16x16x64_bf16 v[8:11], v[12:15], a[152:159], v0
 s_mov_b32 m0, 6144
 s_waitcnt lgkmcnt(6)
 v_smfmac_f32_16x16x64_bf16 v[16:19], v[48:51], a[0:7], v0
 buffer_load_dwordx4 v1, s[4:7], s81 offen offset:1024 lds
 s_waitcnt lgkmcnt(5)
 v_smfmac_f32_16x16x64_bf16 v[16:19], v[52:55], a[8:15], v0
 s_mov_b32 m0, 7168
 s_waitcnt lgkmcnt(2)
 v_smfmac_f32_16x16x64_bf16 v[16:19], v[44:47], v[56:63], v0
 ds_read_b128 v[56:59], v3 offset:43008
 ds_read_b128 v[60:63], v3 offset:44032
 buffer_load_dwordx4 v1, s[4:7], s81 offen offset:2048 lds
 s_waitcnt lgkmcnt(2)
 v_smfmac_f32_16x16x64_bf16 v[20:23], v[48:51], v[24:31], v0
 ds_read_b128 v[24:27], v3 offset:40960
 ds_read_b128 v[28:31], v3 offset:41984
 v_smfmac_f32_16x16x64_bf16 v[20:23], v[52:55], a[40:47], v0
 v_smfmac_f32_16x16x64_bf16 v[20:23], v[44:47], a[48:55], v0
 v_cvt_pk_bf16_f32 v16, v16, v17
 v_smfmac_f32_16x16x64_bf16 v[32:35], v[48:51], a[64:71], v0
 v_cvt_pk_bf16_f32 v17, v18, v19
 s_waitcnt lgkmcnt(2)
 v_smfmac_f32_16x16x64_bf16 v[32:35], v[52:55], v[56:63], v0
 ds_read_b128 v[56:59], v3 offset:10240
 ds_read_b128 v[60:63], v3 offset:11264
 v_and_or_b32 v16, v16, -2, s55
 s_waitcnt lgkmcnt(2)
 v_smfmac_f32_16x16x64_bf16 v[32:35], v[44:47], v[24:31], v0
 ds_read_b128 v[24:27], v3 offset:8192
 ds_read_b128 v[28:31], v3 offset:9216
 v_cvt_pk_bf16_f32 v18, v20, v21
 v_smfmac_f32_16x16x64_bf16 v[36:39], v[48:51], a[96:103], v0
 v_cvt_pk_bf16_f32 v19, v22, v23
 v_smfmac_f32_16x16x64_bf16 v[36:39], v[52:55], a[104:111], v0
 v_and_or_b32 v18, v18, -2, s55
 buffer_store_dwordx4 v[16:19], v1, s[4:7], s60 offen offset:0 sc1
 v_smfmac_f32_16x16x64_bf16 v[36:39], v[44:47], a[112:119], v0
 v_cvt_pk_bf16_f32 v32, v32, v33
 s_waitcnt lgkmcnt(2)
 v_smfmac_f32_16x16x64_bf16 v[8:11], v[48:51], v[56:63], v0
 v_cvt_pk_bf16_f32 v33, v34, v35
 s_waitcnt lgkmcnt(0)
 v_smfmac_f32_16x16x64_bf16 v[8:11], v[52:55], v[24:31], v0
 v_and_or_b32 v32, v32, -2, s55
 v_smfmac_f32_16x16x64_bf16 v[8:11], v[44:47], a[144:151], v0
 v_cvt_pk_bf16_f32 v34, v36, v37
 v_cvt_pk_bf16_f32 v35, v38, v39
 v_and_or_b32 v34, v34, -2, s55
 buffer_store_dwordx4 v[32:35], v1, s[4:7], s60 offen offset:1024 sc1
 s_nop 3
 v_cvt_pk_bf16_f32 v8, v8, v9
 v_cvt_pk_bf16_f32 v9, v10, v11
 v_and_or_b32 v8, v8, -2, s55
 buffer_store_dwordx2 v[8:9], v1, s[4:7], s16 offen offset:8 sc1
 buffer_load_dwordx4 v[32:35], v1, s[4:7], s63 offen offset:2048
 buffer_load_dwordx4 v[36:39], v1, s[4:7], s63 offen offset:3072
 s_add_u32 s54, s54, 1
 s_add_u32 s61, s61, 524288
 s_and_b32 s3, s54, 3
 s_cselect_b32 s3, 1, -3
 s_lshl_b32 s3, s3, 17
 s_add_u32 s62, s62, s3
 s_and_b32 s3, s54, 3
 s_cselect_b32 s3, 1, -3
 s_lshl_b32 s3, s3, 14
 s_add_u32 s57, s57, s3
 s_add_u32 s59, s59, s3
 s_xor_b32 s58, s57, 32768
 s_mov_b32 s51, 0
L_fl_215:
 s_waitcnt vmcnt(9)
 v_readlane_b32 s14, v7, 0
 v_readlane_b32 s15, v7, 1
 s_nop 3
 s_cmp_lt_u32 s14, 8
 s_cbranch_scc1 L_fr_216
 s_add_u32 s15, s15, 4
 s_cmp_le_u32 s15, s54
 s_cbranch_scc1 L_fr_216
 s_add_u32 s12, s12, 4
 s_nop 15
 s_nop 15
 s_nop 15
 s_nop 15
 s_nop 15
 s_nop 15
 s_nop 15
 s_nop 15
 s_nop 15
 s_nop 15
 s_nop 15
 s_nop 15
 s_nop 15
 s_nop 11
 s_xor_b32 s55, s55, 1
 s_waitcnt vmcnt(5)
 ds_read_b128 v[40:43], v1 offset:6144
 ds_read_b128 v[44:47], v1 offset:7168
 ds_read_b128 v[48:51], v1 offset:9216
 buffer_load_dwordx4 v[52:55], v1, s[4:7], s81 offen offset:3072
 buffer_load_dwordx4 v[56:59], v1, s[4:7], s101 offen offset:0
 buffer_load_dwordx4 v[60:63], v1, s[4:7], s101 offen offset:1024
 ds_read_b128 v[8:11], v3 offset:49152
 ds_read_b128 v[16:19], v3 offset:49152
 ds_read_b128 v[20:23], v3 offset:49152
 s_waitcnt lgkmcnt(0)
 s_nop 15
 s_nop 15
 s_nop 7
 s_branch L_ch3_s
L_rt_214:
 s_add_u32 s51, s51, 1
 s_cmp_lt_u32 s51, 131072
 s_cbranch_scc1 L_pm_213
 s_branch L_bail
L_fr_216:
 s_sleep 4
 v_mov_b32 v7, 0
 s_mov_b64 exec, 1
 buffer_atomic_add v7, off, s[4:7], s12 sc0
 s_mov_b64 exec, 2
 buffer_atomic_add v7, off, s[4:7], s13 sc0
 s_mov_b64 exec, -1
 s_waitcnt vmcnt(0)
 s_add_u32 s51, s51, 1
 s_cmp_lt_u32 s51, 131072
 s_cbranch_scc1 L_fl_215
 s_branch L_bail
L_ch3_end:
 s_waitcnt vmcnt(0)
 s_endpgm
L_code_end:
 s_endpgm
.section .rodata,"a"
.p2align 6
.amdhsa_kernel interleave_layers__memory_aug_recurrent_mem_tr__ssm_conv_h3__prompt_kernel
  .amdhsa_next_free_vgpr 512
  .amdhsa_next_free_sgpr 102
  .amdhsa_accum_offset 256
  .amdhsa_group_segment_fixed_size 0
  .amdhsa_kernarg_size 128
  .amdhsa_user_sgpr_count 2
  .amdhsa_user_sgpr_kernarg_segment_ptr 1
  .amdhsa_system_sgpr_workgroup_id_x 1
  .amdhsa_float_denorm_mode_32 3
.end_amdhsa_kernel
.text
```

```asm
; @launch grid=(256,1,1) block=(256,1,1) lds=163840
.amdgcn_target "amdgcn-amd-amdhsa--gfx950"
.text
.globl interleave_layers__memory_aug_recurrent_mem_tr__ssm_conv_h3__prompt_kernel
.p2align 8
.type interleave_layers__memory_aug_recurrent_mem_tr__ssm_conv_h3__prompt_kernel,@function
interleave_layers__memory_aug_recurrent_mem_tr__ssm_conv_h3__prompt_kernel:
 s_cmp_ge_u32 s2, 256
 s_cbranch_scc1 L_bail
 s_load_dwordx16 s[16:31], s[0:1], 0
 s_load_dwordx16 s[32:47], s[0:1], 64
 s_getreg_b32 s48, hwreg(HW_REG_XCC_ID, 0, 3)
 v_lshrrev_b32 v1, 6, v0
 v_and_b32 v0, 63, v0
 s_nop 0
 v_readfirstlane_b32 s50, v1
 s_waitcnt lgkmcnt(0)
 s_mov_b32 s4, s46
 s_and_b32 s5, s47, 0xffff
 s_mov_b32 s6, 268435456
 s_mov_b32 s7, 0x00020000
 s_mov_b32 s8, s46
 s_and_b32 s9, s47, 0xffff
 s_mov_b32 s10, 268435456
 s_mov_b32 s11, 0x00020000
 s_mov_b32 s12, s46
 s_and_b32 s13, s47, 0xffff
 s_mov_b32 s14, 268435456
 s_mov_b32 s15, 0x00020000
 s_mov_b32 s96, s44
 s_and_b32 s97, s45, 0xffff
 s_mov_b32 s98, 256
 s_mov_b32 s99, 0x00020000
 s_cmp_lg_u32 s50, 0
 s_cbranch_scc1 L_tk_wait
 s_mov_b32 s96, s44
 s_and_b32 s97, s45, 0xffff
 s_mov_b32 s98, 256
 s_mov_b32 s99, 0x00020000
 s_lshl_b32 s3, s48, 5
 v_mov_b32 v1, 1
 v_mov_b32 v2, 0
 s_mov_b64 exec, 1
 buffer_atomic_add v1, off, s[96:99], s3 sc0
 s_waitcnt vmcnt(0)
 s_mov_b64 exec, -1
 v_readfirstlane_b32 s60, v1
 s_nop 3
 s_cmp_lt_u32 s60, 32
 s_cbranch_scc1 L_tk_ok
 v_lshlrev_b32 v3, 5, v0
 s_mov_b32 s51, 0
L_tk_lp:
 buffer_load_dword v4, v3, s[96:99], 0 offen sc1
 s_waitcnt vmcnt(0)
 s_mov_b32 s61, 0
 v_readlane_b32 s64, v4, 0
 s_nop 3
 s_add_u32 s61, s61, s64
 v_readlane_b32 s65, v4, 1
 s_nop 3
 s_add_u32 s61, s61, s65
 v_readlane_b32 s66, v4, 2
 s_nop 3
 s_add_u32 s61, s61, s66
 v_readlane_b32 s67, v4, 3
 s_nop 3
 s_add_u32 s61, s61, s67
 v_readlane_b32 s68, v4, 4
 s_nop 3
 s_add_u32 s61, s61, s68
 v_readlane_b32 s69, v4, 5
 s_nop 3
 s_add_u32 s61, s61, s69
 v_readlane_b32 s70, v4, 6
 s_nop 3
 s_add_u32 s61, s61, s70
 v_readlane_b32 s71, v4, 7
 s_nop 3
 s_add_u32 s61, s61, s71
 s_cmp_ge_u32 s61, 256
 s_cbranch_scc1 L_tk_all
 s_sleep 4
 s_add_u32 s51, s51, 1
 s_cmp_lt_u32 s51, 131072
 s_cbranch_scc1 L_tk_lp
 s_branch L_bail
L_tk_all:
 v_mov_b32 v1, 1
 s_mov_b64 exec, 1
 buffer_atomic_add v1, off, s[96:99], 0 offset:20 sc0
 s_waitcnt vmcnt(0)
 s_mov_b64 exec, -1
 v_readfirstlane_b32 s61, v1
 s_nop 3
 s_min_u32 s62, s64, 32
 s_add_u32 s60, s62, s61
 s_mov_b32 s48, 0
 s_cmp_lt_u32 s60, 32
 s_cbranch_scc1 L_tk_ok
 s_sub_u32 s61, s60, 32
 s_min_u32 s62, s65, 32
 s_add_u32 s60, s62, s61
 s_mov_b32 s48, 1
 s_cmp_lt_u32 s60, 32
 s_cbranch_scc1 L_tk_ok
 s_sub_u32 s61, s60, 32
 s_min_u32 s62, s66, 32
 s_add_u32 s60, s62, s61
 s_mov_b32 s48, 2
 s_cmp_lt_u32 s60, 32
 s_cbranch_scc1 L_tk_ok
 s_sub_u32 s61, s60, 32
 s_min_u32 s62, s67, 32
 s_add_u32 s60, s62, s61
 s_mov_b32 s48, 3
 s_cmp_lt_u32 s60, 32
 s_cbranch_scc1 L_tk_ok
 s_sub_u32 s61, s60, 32
 s_min_u32 s62, s68, 32
 s_add_u32 s60, s62, s61
 s_mov_b32 s48, 4
 s_cmp_lt_u32 s60, 32
 s_cbranch_scc1 L_tk_ok
 s_sub_u32 s61, s60, 32
 s_min_u32 s62, s69, 32
 s_add_u32 s60, s62, s61
 s_mov_b32 s48, 5
 s_cmp_lt_u32 s60, 32
 s_cbranch_scc1 L_tk_ok
 s_sub_u32 s61, s60, 32
 s_min_u32 s62, s70, 32
 s_add_u32 s60, s62, s61
 s_mov_b32 s48, 6
 s_cmp_lt_u32 s60, 32
 s_cbranch_scc1 L_tk_ok
 s_sub_u32 s61, s60, 32
 s_min_u32 s62, s71, 32
 s_add_u32 s60, s62, s61
 s_mov_b32 s48, 7
 s_cmp_lt_u32 s60, 32
 s_cbranch_scc1 L_tk_ok
 s_sub_u32 s61, s60, 32
 s_mov_b32 s48, 8
 s_mov_b32 s60, 0
L_tk_ok:
 s_lshl_b32 s3, s48, 5
 s_add_u32 s3, s3, s60
 v_mov_b32 v1, s3
 ds_write_b32 v2, v1
 s_waitcnt lgkmcnt(0)
L_tk_wait:
 s_barrier
 v_mov_b32 v2, 0
 ds_read_b32 v1, v2
 s_waitcnt lgkmcnt(0)
 v_readfirstlane_b32 s101, v1
 s_barrier
 s_mov_b32 s51, 0
 s_cmp_ge_u32 s101, 256
 s_cbranch_scc1 L_bail
 s_lshr_b32 s48, s101, 5
 s_and_b32 s48, s48, 7
 s_and_b32 s49, s101, 31
 s_mov_b32 s53, 0
 s_cmp_eq_u32 s48, 0
 s_cbranch_scc1 L_ch
 s_mov_b32 s53, 1
 s_cmp_eq_u32 s48, 4
 s_cbranch_scc1 L_ch
 s_cmp_gt_u32 s48, 4
 s_cselect_b32 s60, 2, 1
 s_sub_u32 s60, s48, s60
 s_lshl_b32 s3, s60, 4
 s_add_u32 s3, s3, s49
 s_cmp_lt_u32 s49, 16
 s_cbranch_scc1 L_qkv_idx
 s_lshl_b32 s82, s60, 2
 s_add_u32 s82, s82, s49
 s_add_u32 s82, s82, 56
 s_mov_b32 s83, 2
 s_cmp_lt_u32 s49, 20
 s_cbranch_scc1 L_helper
 s_min_u32 s61, s60, 2
 s_add_u32 s62, s61, s60
 s_mul_i32 s62, s62, 5
 s_mul_i32 s63, s60, 12
 s_sub_u32 s63, s63, s62
 s_cmp_lt_u32 s60, 2
 s_cselect_b32 s61, 30, 25
 s_sub_u32 s52, s49, s61
 s_add_u32 s52, s52, s63
 s_mov_b32 s82, s52
 s_mov_b32 s83, 0
 s_cmp_ge_u32 s49, s61
 s_cbranch_scc1 L_helper
 s_add_u32 s3, s62, s49
 s_sub_u32 s3, s3, 20
 s_mul_i32 s52, s3, 13108
 s_lshr_b32 s52, s52, 16
 s_mul_i32 s53, s52, 5
 s_sub_u32 s53, s3, s53
 s_add_u32 s82, s3, 32
 s_mov_b32 s83, 1
 s_branch L_helper
L_qkv_idx:
 s_mul_i32 s52, s3, 21846
 s_lshr_b32 s52, s52, 16
 s_mul_i32 s53, s52, 3
 s_sub_u32 s53, s3, s53
 s_mov_b32 s8, s24
 s_and_b32 s9, s25, 0xffff
 s_mov_b32 s10, 5242880
 s_mov_b32 s11, 0x00020000
 s_cmp_eq_u32 s53, 2
 s_cbranch_scc1 L_qkvv
 s_cmp_eq_u32 s53, 0
 s_cselect_b32 s8, s20, s22
 s_cselect_b32 s9, s21, s23
 s_and_b32 s9, s9, 0xffff
 s_branch L_qkvq
L_conv0:
 s_mov_b32 s8, s38
 s_and_b32 s9, s39, 0xffff
 s_mov_b32 s10, 2621440
 s_mov_b32 s11, 0x00020000
 s_mov_b32 s12, s40
 s_and_b32 s13, s41, 0xffff
 s_mov_b32 s14, 1280
 s_mov_b32 s15, 0x00020000
 v_lshlrev_b32 v130, 4, v0
 v_add_u32 v7, s71, v130
 v_mov_b32 v8, 0
 v_mov_b32 v9, 0
 v_mov_b32 v10, 0
 v_mov_b32 v11, 0
 s_mov_b32 exec_hi, 0
 ds_write_b128 v7, v[8:11] offset:0
 s_mov_b32 exec_lo, 3
 ds_write_b128 v7, v[8:11] offset:4608
 ds_write_b128 v7, v[8:11] offset:8768
 s_mov_b64 exec, -1
 v_and_b32 v8, 15, v0
 v_lshrrev_b32 v9, 5, v0
 v_sub_u32 v10, v8, v9
 v_lshlrev_b32 v10, 5, v10
 v_and_b32 v11, 16, v0
 v_add_u32 v10, v10, v11
 s_add_u32 s3, s71, 64
 v_add_u32 v14, s3, v10
 v_lshlrev_b32 v10, 5, v9
 v_lshl_add_u32 v10, v8, 1, v10
 v_sub_u32 v10, v10, v11
 v_and_b32 v11, 1, v0
 v_cmp_eq_u32 vcc, 1, v11
 v_mov_b32 v12, 8784
 v_mov_b32 v11, 4626
 s_nop 0
 v_cndmask_b32 v11, v12, v11, vcc
 v_add3_u32 v16, v10, v11, s71
 v_add_u32 v17, 512, v16
 v_add_u32 v18, 1024, v16
 v_add_u32 v19, 1536, v16
 v_lshlrev_b32 v10, 5, v8
 v_lshl_add_u32 v10, v9, 4, v10
 v_and_b32 v11, 16, v0
 v_lshrrev_b32 v11, 1, v11
 v_xor_b32 v11, 8, v11
 s_add_u32 s3, s71, 512
 v_add3_u32 v15, v10, v11, s3
 v_and_b32 v10, 1, v0
 v_lshlrev_b32 v10, 4, v10
 v_lshrrev_b32 v11, 4, v0
 v_lshl_add_u32 v10, v11, 2, v10
 s_mov_b32 s3, 40960
 v_mul_lo_u32 v13, v10, s3
 v_lshrrev_b32 v11, 1, v8
 v_lshl_add_u32 v13, v11, 3, v13
 s_cmp_lg_u32 s50, 0
 s_cbranch_scc1 L_ww_1
 s_mov_b32 s96, s44
 s_and_b32 s97, s45, 0xffff
 s_mov_b32 s98, 256
 s_mov_b32 s99, 0x00020000
 v_mov_b32 v24, 196
 s_mov_b32 s51, 0
 s_mov_b64 exec, 1
L_wb_2:
 buffer_load_dword v25, v24, s[96:99], 0 offen sc1
 s_waitcnt vmcnt(0)
 v_cmp_eq_u32 vcc, 0, v25
 s_cbranch_vccz L_wbd_3
 s_sleep 2
 s_add_u32 s51, s51, 1
 s_cmp_lt_u32 s51, 131072
 s_cbranch_scc1 L_wb_2
 s_branch L_bail
L_wbd_3:
 s_mov_b64 exec, -1
L_ww_1:
 s_barrier
 s_lshl_b32 s3, s70, 12
 s_add_u32 s3, s3, 231735296
 buffer_load_dwordx4 v[104:107], v130, s[4:7], s3 offen offset:0 sc1
 buffer_load_dwordx4 v[108:111], v130, s[4:7], s3 offen offset:1024 sc1
 s_waitcnt vmcnt(0)
L_cv_4:
 s_waitcnt vmcnt(4)
 ds_write_b128 v7, v[104:107] offset:512
 ds_write_b128 v7, v[96:99] offset:4640
 ds_write_b128 v7, v[112:115] offset:8800
 ds_write_b128 v7, v[108:111] offset:1536
 ds_write_b128 v7, v[100:103] offset:5664
 ds_write_b128 v7, v[116:119] offset:9824
 v_lshlrev_b32 v8, 16, v96
 v_lshlrev_b32 v12, 16, v128
 s_mov_b64 exec, 1
 ds_write_b32 v7, v8 offset:8796
 s_mov_b64 exec, -1
 s_lshl_b32 s72, s70, 6
 s_add_u32 s72, s72, 234356736
 s_add_u32 s70, s70, s69
 s_waitcnt lgkmcnt(0)
 s_lshl_b32 s73, s70, 12
 s_add_u32 s74, s73, 2
 buffer_load_dwordx4 v[96:99], v130, s[8:11], s73 offen offset:0
 buffer_load_dwordx4 v[100:103], v130, s[8:11], s73 offen offset:1024
 buffer_load_dwordx4 v[112:115], v130, s[8:11], s74 offen offset:0
 buffer_load_dwordx4 v[116:119], v130, s[8:11], s74 offen offset:1024
 s_lshl_b32 s3, s70, 1
 buffer_load_ushort v128, off, s[12:15], s3
 s_lshl_b32 s3, s70, 12
 s_add_u32 s3, s3, 231735296
 buffer_load_dwordx4 v[104:107], v130, s[4:7], s3 offen offset:0 sc1
 buffer_load_dwordx4 v[108:111], v130, s[4:7], s3 offen offset:1024 sc1
 ds_read_b128 v[32:35], v14 offset:448
 ds_read2_b32 v[64:65], v16 offset0:0 offset1:1
 ds_read2_b32 v[66:67], v16 offset0:2 offset1:3
 ds_read_b128 v[36:39], v14 offset:960
 ds_read2_b32 v[68:69], v17 offset0:0 offset1:1
 ds_read2_b32 v[70:71], v17 offset0:2 offset1:3
 ds_read_b128 v[40:43], v14 offset:1472
 ds_read2_b32 v[72:73], v18 offset0:0 offset1:1
 ds_read2_b32 v[74:75], v18 offset0:2 offset1:3
 ds_read_b128 v[44:47], v14 offset:1984
 ds_read2_b32 v[76:77], v19 offset0:0 offset1:1
 ds_read2_b32 v[78:79], v19 offset0:2 offset1:3
 s_waitcnt lgkmcnt(0)
 v_mfma_f32_16x16x32_bf16 v[144:147], v[64:67], v[32:35], 0
 ds_read_b128 v[176:179], v14 offset:384
 ds_read2_b32 v[208:209], v16 offset0:16 offset1:17
 v_mfma_f32_16x16x32_bf16 v[148:151], v[64:67], v[36:39], 0
 ds_read2_b32 v[210:211], v16 offset0:18 offset1:19
 ds_read_b128 v[180:183], v14 offset:896
 v_mfma_f32_16x16x32_bf16 v[152:155], v[64:67], v[40:43], 0
 ds_read2_b32 v[212:213], v17 offset0:16 offset1:17
 ds_read2_b32 v[214:215], v17 offset0:18 offset1:19
 v_mfma_f32_16x16x32_bf16 v[156:159], v[64:67], v[44:47], 0
 ds_read_b128 v[184:187], v14 offset:1408
 ds_read2_b32 v[216:217], v18 offset0:16 offset1:17
 v_mfma_f32_16x16x32_bf16 v[148:151], v[68:71], v[32:35], v[148:151]
 ds_read2_b32 v[218:219], v18 offset0:18 offset1:19
 ds_read_b128 v[188:191], v14 offset:1920
 v_mfma_f32_16x16x32_bf16 v[152:155], v[68:71], v[36:39], v[152:155]
 ds_read2_b32 v[220:221], v19 offset0:16 offset1:17
 ds_read2_b32 v[222:223], v19 offset0:18 offset1:19
 v_mfma_f32_16x16x32_bf16 v[156:159], v[68:71], v[40:43], v[156:159]
 v_mfma_f32_16x16x32_bf16 v[152:155], v[72:75], v[32:35], v[152:155]
 v_mfma_f32_16x16x32_bf16 v[156:159], v[72:75], v[36:39], v[156:159]
 v_mfma_f32_16x16x32_bf16 v[156:159], v[76:79], v[32:35], v[156:159]
 s_waitcnt lgkmcnt(0)
 v_mfma_f32_16x16x32_bf16 v[144:147], v[208:211], v[176:179], v[144:147]
 ds_read_b128 v[32:35], v14 offset:320
 ds_read2_b32 v[64:65], v16 offset0:32 offset1:33
 v_mfma_f32_16x16x32_bf16 v[148:151], v[208:211], v[180:183], v[148:151]
 ds_read2_b32 v[66:67], v16 offset0:34 offset1:35
 ds_read_b128 v[36:39], v14 offset:832
 v_mfma_f32_16x16x32_bf16 v[152:155], v[208:211], v[184:187], v[152:155]
 ds_read2_b32 v[68:69], v17 offset0:32 offset1:33
 ds_read2_b32 v[70:71], v17 offset0:34 offset1:35
 v_mfma_f32_16x16x32_bf16 v[156:159], v[208:211], v[188:191], v[156:159]
 ds_read_b128 v[40:43], v14 offset:1344
 ds_read2_b32 v[72:73], v18 offset0:32 offset1:33
 v_mfma_f32_16x16x32_bf16 v[148:151], v[212:215], v[176:179], v[148:151]
 ds_read2_b32 v[74:75], v18 offset0:34 offset1:35
 ds_read_b128 v[44:47], v14 offset:1856
 v_mfma_f32_16x16x32_bf16 v[152:155], v[212:215], v[180:183], v[152:155]
 ds_read2_b32 v[76:77], v19 offset0:32 offset1:33
 ds_read2_b32 v[78:79], v19 offset0:34 offset1:35
 v_mfma_f32_16x16x32_bf16 v[156:159], v[212:215], v[184:187], v[156:159]
 v_mfma_f32_16x16x32_bf16 v[152:155], v[216:219], v[176:179], v[152:155]
 v_mfma_f32_16x16x32_bf16 v[156:159], v[216:219], v[180:183], v[156:159]
 v_mfma_f32_16x16x32_bf16 v[156:159], v[220:223], v[176:179], v[156:159]
 s_waitcnt lgkmcnt(0)
 v_mfma_f32_16x16x32_bf16 v[144:147], v[64:67], v[32:35], v[144:147]
 ds_read_b128 v[176:179], v14 offset:256
 ds_read2_b32 v[208:209], v16 offset0:48 offset1:49
 v_mfma_f32_16x16x32_bf16 v[148:151], v[64:67], v[36:39], v[148:151]
 ds_read2_b32 v[210:211], v16 offset0:50 offset1:51
 ds_read_b128 v[180:183], v14 offset:768
 v_mfma_f32_16x16x32_bf16 v[152:155], v[64:67], v[40:43], v[152:155]
 ds_read2_b32 v[212:213], v17 offset0:48 offset1:49
 ds_read2_b32 v[214:215], v17 offset0:50 offset1:51
 v_mfma_f32_16x16x32_bf16 v[156:159], v[64:67], v[44:47], v[156:159]
 ds_read_b128 v[184:187], v14 offset:1280
 ds_read2_b32 v[216:217], v18 offset0:48 offset1:49
 v_mfma_f32_16x16x32_bf16 v[148:151], v[68:71], v[32:35], v[148:151]
 ds_read2_b32 v[218:219], v18 offset0:50 offset1:51
 ds_read_b128 v[188:191], v14 offset:1792
 v_mfma_f32_16x16x32_bf16 v[152:155], v[68:71], v[36:39], v[152:155]
 ds_read2_b32 v[220:221], v19 offset0:48 offset1:49
 ds_read2_b32 v[222:223], v19 offset0:50 offset1:51
 v_mfma_f32_16x16x32_bf16 v[156:159], v[68:71], v[40:43], v[156:159]
 v_mfma_f32_16x16x32_bf16 v[152:155], v[72:75], v[32:35], v[152:155]
 v_mfma_f32_16x16x32_bf16 v[156:159], v[72:75], v[36:39], v[156:159]
 v_mfma_f32_16x16x32_bf16 v[156:159], v[76:79], v[32:35], v[156:159]
 s_waitcnt lgkmcnt(0)
 v_mfma_f32_16x16x32_bf16 v[144:147], v[208:211], v[176:179], v[144:147]
 ds_read_b128 v[32:35], v14 offset:192
 ds_read2_b32 v[64:65], v16 offset0:64 offset1:65
 v_mfma_f32_16x16x32_bf16 v[148:151], v[208:211], v[180:183], v[148:151]
 ds_read2_b32 v[66:67], v16 offset0:66 offset1:67
 ds_read_b128 v[36:39], v14 offset:704
 v_mfma_f32_16x16x32_bf16 v[152:155], v[208:211], v[184:187], v[152:155]
 ds_read2_b32 v[68:69], v17 offset0:64 offset1:65
 ds_read2_b32 v[70:71], v17 offset0:66 offset1:67
 v_mfma_f32_16x16x32_bf16 v[156:159], v[208:211], v[188:191], v[156:159]
 ds_read_b128 v[40:43], v14 offset:1216
 ds_read2_b32 v[72:73], v18 offset0:64 offset1:65
 v_mfma_f32_16x16x32_bf16 v[148:151], v[212:215], v[176:179], v[148:151]
 ds_read2_b32 v[74:75], v18 offset0:66 offset1:67
 ds_read_b128 v[44:47], v14 offset:1728
 v_mfma_f32_16x16x32_bf16 v[152:155], v[212:215], v[180:183], v[152:155]
 ds_read2_b32 v[76:77], v19 offset0:64 offset1:65
 ds_read2_b32 v[78:79], v19 offset0:66 offset1:67
 v_mfma_f32_16x16x32_bf16 v[156:159], v[212:215], v[184:187], v[156:159]
 v_mfma_f32_16x16x32_bf16 v[152:155], v[216:219], v[176:179], v[152:155]
 v_mfma_f32_16x16x32_bf16 v[156:159], v[216:219], v[180:183], v[156:159]
 v_mfma_f32_16x16x32_bf16 v[156:159], v[220:223], v[176:179], v[156:159]
 s_waitcnt lgkmcnt(0)
 v_mfma_f32_16x16x32_bf16 v[144:147], v[64:67], v[32:35], v[144:147]
 ds_read_b128 v[176:179], v14 offset:128
 ds_read2_b32 v[208:209], v16 offset0:80 offset1:81
 v_mfma_f32_16x16x32_bf16 v[148:151], v[64:67], v[36:39], v[148:151]
 ds_read2_b32 v[210:211], v16 offset0:82 offset1:83
 ds_read_b128 v[180:183], v14 offset:640
 v_mfma_f32_16x16x32_bf16 v[152:155], v[64:67], v[40:43], v[152:155]
 ds_read2_b32 v[212:213], v17 offset0:80 offset1:81
 ds_read2_b32 v[214:215], v17 offset0:82 offset1:83
 v_mfma_f32_16x16x32_bf16 v[156:159], v[64:67], v[44:47], v[156:159]
 ds_read_b128 v[184:187], v14 offset:1152
 ds_read2_b32 v[216:217], v18 offset0:80 offset1:81
 v_mfma_f32_16x16x32_bf16 v[148:151], v[68:71], v[32:35], v[148:151]
 ds_read2_b32 v[218:219], v18 offset0:82 offset1:83
 ds_read_b128 v[188:191], v14 offset:1664
 v_mfma_f32_16x16x32_bf16 v[152:155], v[68:71], v[36:39], v[152:155]
 ds_read2_b32 v[220:221], v19 offset0:80 offset1:81
 ds_read2_b32 v[222:223], v19 offset0:82 offset1:83
 v_mfma_f32_16x16x32_bf16 v[156:159], v[68:71], v[40:43], v[156:159]
 v_mfma_f32_16x16x32_bf16 v[152:155], v[72:75], v[32:35], v[152:155]
 v_mfma_f32_16x16x32_bf16 v[156:159], v[72:75], v[36:39], v[156:159]
 v_mfma_f32_16x16x32_bf16 v[156:159], v[76:79], v[32:35], v[156:159]
 s_waitcnt lgkmcnt(0)
 v_mfma_f32_16x16x32_bf16 v[144:147], v[208:211], v[176:179], v[144:147]
 ds_read_b128 v[32:35], v14 offset:64
 ds_read2_b32 v[64:65], v16 offset0:96 offset1:97
 v_mfma_f32_16x16x32_bf16 v[148:151], v[208:211], v[180:183], v[148:151]
 ds_read2_b32 v[66:67], v16 offset0:98 offset1:99
 ds_read_b128 v[36:39], v14 offset:576
 v_mfma_f32_16x16x32_bf16 v[152:155], v[208:211], v[184:187], v[152:155]
 ds_read2_b32 v[68:69], v17 offset0:96 offset1:97
 ds_read2_b32 v[70:71], v17 offset0:98 offset1:99
 v_mfma_f32_16x16x32_bf16 v[156:159], v[208:211], v[188:191], v[156:159]
 ds_read_b128 v[40:43], v14 offset:1088
 ds_read2_b32 v[72:73], v18 offset0:96 offset1:97
 v_mfma_f32_16x16x32_bf16 v[148:151], v[212:215], v[176:179], v[148:151]
 ds_read2_b32 v[74:75], v18 offset0:98 offset1:99
 ds_read_b128 v[44:47], v14 offset:1600
 v_mfma_f32_16x16x32_bf16 v[152:155], v[212:215], v[180:183], v[152:155]
 ds_read2_b32 v[76:77], v19 offset0:96 offset1:97
 ds_read2_b32 v[78:79], v19 offset0:98 offset1:99
 v_mfma_f32_16x16x32_bf16 v[156:159], v[212:215], v[184:187], v[156:159]
 v_mfma_f32_16x16x32_bf16 v[152:155], v[216:219], v[176:179], v[152:155]
 v_mfma_f32_16x16x32_bf16 v[156:159], v[216:219], v[180:183], v[156:159]
 v_mfma_f32_16x16x32_bf16 v[156:159], v[220:223], v[176:179], v[156:159]
 s_waitcnt lgkmcnt(0)
 v_mfma_f32_16x16x32_bf16 v[144:147], v[64:67], v[32:35], v[144:147]
 ds_read_b128 v[176:179], v14 offset:0
 ds_read2_b32 v[208:209], v16 offset0:112 offset1:113
 v_mfma_f32_16x16x32_bf16 v[148:151], v[64:67], v[36:39], v[148:151]
 ds_read2_b32 v[210:211], v16 offset0:114 offset1:115
 ds_read_b128 v[180:183], v14 offset:512
 v_mfma_f32_16x16x32_bf16 v[152:155], v[64:67], v[40:43], v[152:155]
 ds_read2_b32 v[212:213], v17 offset0:112 offset1:113
 ds_read2_b32 v[214:215], v17 offset0:114 offset1:115
 v_mfma_f32_16x16x32_bf16 v[156:159], v[64:67], v[44:47], v[156:159]
 ds_read_b128 v[184:187], v14 offset:1024
 ds_read2_b32 v[216:217], v18 offset0:112 offset1:113
 v_mfma_f32_16x16x32_bf16 v[148:151], v[68:71], v[32:35], v[148:151]
 ds_read2_b32 v[218:219], v18 offset0:114 offset1:115
 ds_read_b128 v[188:191], v14 offset:1536
 v_mfma_f32_16x16x32_bf16 v[152:155], v[68:71], v[36:39], v[152:155]
 ds_read2_b32 v[220:221], v19 offset0:112 offset1:113
 ds_read2_b32 v[222:223], v19 offset0:114 offset1:115
 v_mfma_f32_16x16x32_bf16 v[156:159], v[68:71], v[40:43], v[156:159]
 v_mfma_f32_16x16x32_bf16 v[152:155], v[72:75], v[32:35], v[152:155]
 v_mfma_f32_16x16x32_bf16 v[156:159], v[72:75], v[36:39], v[156:159]
 v_mfma_f32_16x16x32_bf16 v[156:159], v[76:79], v[32:35], v[156:159]
 s_waitcnt lgkmcnt(0)
 v_mfma_f32_16x16x32_bf16 v[144:147], v[208:211], v[176:179], v[144:147]
 ds_read_b64 v[32:33], v15 offset:0
 ds_read_b64 v[34:35], v15 offset:512
 v_mfma_f32_16x16x32_bf16 v[148:151], v[208:211], v[180:183], v[148:151]
 ds_read_b64 v[36:37], v15 offset:1024
 ds_read_b64 v[38:39], v15 offset:1536
 v_mfma_f32_16x16x32_bf16 v[152:155], v[208:211], v[184:187], v[152:155]
 v_mfma_f32_16x16x32_bf16 v[156:159], v[208:211], v[188:191], v[156:159]
 v_mfma_f32_16x16x32_bf16 v[148:151], v[212:215], v[176:179], v[148:151]
 v_mfma_f32_16x16x32_bf16 v[152:155], v[212:215], v[180:183], v[152:155]
 v_mfma_f32_16x16x32_bf16 v[156:159], v[212:215], v[184:187], v[156:159]
 v_mfma_f32_16x16x32_bf16 v[152:155], v[216:219], v[176:179], v[152:155]
 v_mfma_f32_16x16x32_bf16 v[156:159], v[216:219], v[180:183], v[156:159]
 v_mfma_f32_16x16x32_bf16 v[156:159], v[220:223], v[176:179], v[156:159]
 s_waitcnt lgkmcnt(0)
 v_and_b32 v64, 0xffff0000, v33
 v_lshlrev_b32 v65, 16, v33
 v_and_b32 v66, 0xffff0000, v32
 v_lshlrev_b32 v67, 16, v32
 v_mul_f32 v64, v64, v12
 v_mul_f32 v65, v65, v12
 v_mul_f32 v66, v66, v12
 v_mul_f32 v67, v67, v12
 v_and_b32 v68, 0xffff0000, v35
 v_lshlrev_b32 v69, 16, v35
 v_and_b32 v70, 0xffff0000, v34
 v_lshlrev_b32 v71, 16, v34
 v_mul_f32 v68, v68, v12
 v_mul_f32 v69, v69, v12
 v_mul_f32 v70, v70, v12
 v_mul_f32 v71, v71, v12
 v_and_b32 v72, 0xffff0000, v37
 v_lshlrev_b32 v73, 16, v37
 v_and_b32 v74, 0xffff0000, v36
 v_lshlrev_b32 v75, 16, v36
 v_mul_f32 v72, v72, v12
 v_mul_f32 v73, v73, v12
 v_mul_f32 v74, v74, v12
 v_mul_f32 v75, v75, v12
 v_and_b32 v76, 0xffff0000, v39
 v_lshlrev_b32 v77, 16, v39
 v_and_b32 v78, 0xffff0000, v38
 v_lshlrev_b32 v79, 16, v38
 v_mul_f32 v76, v76, v12
 v_mul_f32 v77, v77, v12
 v_mul_f32 v78, v78, v12
 v_mul_f32 v79, v79, v12
 v_cvt_pk_bf16_f32 v8, v64, v65
 v_lshlrev_b32 v64, 16, v8
 v_and_b32 v65, 0xffff0000, v8
 v_cvt_pk_bf16_f32 v8, v66, v67
 v_lshlrev_b32 v66, 16, v8
 v_and_b32 v67, 0xffff0000, v8
 v_cvt_pk_bf16_f32 v8, v68, v69
 v_lshlrev_b32 v68, 16, v8
 v_and_b32 v69, 0xffff0000, v8
 v_cvt_pk_bf16_f32 v8, v70, v71
 v_lshlrev_b32 v70, 16, v8
 v_and_b32 v71, 0xffff0000, v8
 v_cvt_pk_bf16_f32 v8, v72, v73
 v_lshlrev_b32 v72, 16, v8
 v_and_b32 v73, 0xffff0000, v8
 v_cvt_pk_bf16_f32 v8, v74, v75
 v_lshlrev_b32 v74, 16, v8
 v_and_b32 v75, 0xffff0000, v8
 v_cvt_pk_bf16_f32 v8, v76, v77
 v_lshlrev_b32 v76, 16, v8
 v_and_b32 v77, 0xffff0000, v8
 v_cvt_pk_bf16_f32 v8, v78, v79
 v_lshlrev_b32 v78, 16, v8
 v_and_b32 v79, 0xffff0000, v8
 v_cvt_pk_bf16_f32 v8, v144, v145
 v_lshlrev_b32 v144, 16, v8
 v_and_b32 v145, 0xffff0000, v8
 v_cvt_pk_bf16_f32 v8, v146, v147
 v_lshlrev_b32 v146, 16, v8
 v_and_b32 v147, 0xffff0000, v8
 v_cvt_pk_bf16_f32 v8, v148, v149
 v_lshlrev_b32 v148, 16, v8
 v_and_b32 v149, 0xffff0000, v8
 v_cvt_pk_bf16_f32 v8, v150, v151
 v_lshlrev_b32 v150, 16, v8
 v_and_b32 v151, 0xffff0000, v8
 v_cvt_pk_bf16_f32 v8, v152, v153
 v_lshlrev_b32 v152, 16, v8
 v_and_b32 v153, 0xffff0000, v8
 v_cvt_pk_bf16_f32 v8, v154, v155
 v_lshlrev_b32 v154, 16, v8
 v_and_b32 v155, 0xffff0000, v8
 v_cvt_pk_bf16_f32 v8, v156, v157
 v_lshlrev_b32 v156, 16, v8
 v_and_b32 v157, 0xffff0000, v8
 v_cvt_pk_bf16_f32 v8, v158, v159
 v_lshlrev_b32 v158, 16, v8
 v_and_b32 v159, 0xffff0000, v8
 v_pk_add_f32 v[144:145], v[144:145], v[64:65]
 v_pk_add_f32 v[146:147], v[146:147], v[66:67]
 v_pk_add_f32 v[148:149], v[148:149], v[68:69]
 v_pk_add_f32 v[150:151], v[150:151], v[70:71]
 v_pk_add_f32 v[152:153], v[152:153], v[72:73]
 v_pk_add_f32 v[154:155], v[154:155], v[74:75]
 v_pk_add_f32 v[156:157], v[156:157], v[76:77]
 v_pk_add_f32 v[158:159], v[158:159], v[78:79]
 v_cvt_pk_bf16_f32 v160, v144, v148
 v_cvt_pk_bf16_f32 v161, v152, v156
 buffer_store_dwordx2 v[160:161], v13, s[4:7], s72 offen sc1
 s_add_u32 s72, s72, 40960
 v_cvt_pk_bf16_f32 v162, v145, v149
 v_cvt_pk_bf16_f32 v163, v153, v157
 buffer_store_dwordx2 v[162:163], v13, s[4:7], s72 offen sc1
 s_add_u32 s72, s72, 40960
 v_cvt_pk_bf16_f32 v164, v146, v150
 v_cvt_pk_bf16_f32 v165, v154, v158
 buffer_store_dwordx2 v[164:165], v13, s[4:7], s72 offen sc1
 s_add_u32 s72, s72, 40960
 v_cvt_pk_bf16_f32 v166, v147, v151
 v_cvt_pk_bf16_f32 v167, v155, v159
 buffer_store_dwordx2 v[166:167], v13, s[4:7], s72 offen sc1
 s_add_u32 s72, s72, 40960
 s_cmp_lt_u32 s70, 640
 s_cbranch_scc1 L_cv_4
 s_setpc_b64 s[76:77]
L_conv1:
 s_mov_b32 s8, s38
 s_and_b32 s9, s39, 0xffff
 s_mov_b32 s10, 2621440
 s_mov_b32 s11, 0x00020000
 s_mov_b32 s12, s40
 s_and_b32 s13, s41, 0xffff
 s_mov_b32 s14, 1280
 s_mov_b32 s15, 0x00020000
 v_lshlrev_b32 v130, 4, v0
 v_add_u32 v7, s71, v130
 v_mov_b32 v8, 0
 v_mov_b32 v9, 0
 v_mov_b32 v10, 0
 v_mov_b32 v11, 0
 s_mov_b32 exec_hi, 0
 ds_write_b128 v7, v[8:11] offset:0
 s_mov_b32 exec_lo, 3
 ds_write_b128 v7, v[8:11] offset:4608
 ds_write_b128 v7, v[8:11] offset:8768
 s_mov_b64 exec, -1
 v_and_b32 v8, 15, v0
 v_lshrrev_b32 v9, 5, v0
 v_sub_u32 v10, v8, v9
 v_lshlrev_b32 v10, 5, v10
 v_and_b32 v11, 16, v0
 v_add_u32 v10, v10, v11
 s_add_u32 s3, s71, 64
 v_add_u32 v14, s3, v10
 v_lshlrev_b32 v10, 5, v9
 v_lshl_add_u32 v10, v8, 1, v10
 v_sub_u32 v10, v10, v11
 v_and_b32 v11, 1, v0
 v_cmp_eq_u32 vcc, 1, v11
 v_mov_b32 v12, 8784
 v_mov_b32 v11, 4626
 s_nop 0
 v_cndmask_b32 v11, v12, v11, vcc
 v_add3_u32 v16, v10, v11, s71
 v_add_u32 v17, 512, v16
 v_add_u32 v18, 1024, v16
 v_add_u32 v19, 1536, v16
 v_add_u32 v20, 2048, v16
 v_add_u32 v21, 2560, v16
 v_add_u32 v22, 3072, v16
 v_add_u32 v23, 3584, v16
 v_lshlrev_b32 v10, 5, v8
 v_lshl_add_u32 v10, v9, 4, v10
 v_and_b32 v11, 16, v0
 v_lshrrev_b32 v11, 1, v11
 v_xor_b32 v11, 8, v11
 s_add_u32 s3, s71, 512
 v_add3_u32 v15, v10, v11, s3
 v_and_b32 v10, 1, v0
 v_lshlrev_b32 v10, 4, v10
 v_lshrrev_b32 v11, 4, v0
 v_lshl_add_u32 v10, v11, 2, v10
 s_mov_b32 s3, 40960
 v_mul_lo_u32 v13, v10, s3
 v_lshrrev_b32 v11, 1, v8
 v_lshl_add_u32 v13, v11, 3, v13
 s_waitcnt vmcnt(0)
L_cv_5:
 s_waitcnt vmcnt(4)
 ds_write_b128 v7, v[240:243] offset:512
 ds_write_b128 v7, v[96:99] offset:4640
 ds_write_b128 v7, v[112:115] offset:8800
 ds_write_b128 v7, v[244:247] offset:1536
 ds_write_b128 v7, v[100:103] offset:5664
 ds_write_b128 v7, v[116:119] offset:9824
 ds_write_b128 v7, v[248:251] offset:2560
 ds_write_b128 v7, v[104:107] offset:6688
 ds_write_b128 v7, v[120:123] offset:10848
 ds_write_b128 v7, v[252:255] offset:3584
 ds_write_b128 v7, v[108:111] offset:7712
 ds_write_b128 v7, v[124:127] offset:11872
 v_lshlrev_b32 v8, 16, v96
 v_lshlrev_b32 v12, 16, v128
 s_mov_b64 exec, 1
 ds_write_b32 v7, v8 offset:8796
 s_mov_b64 exec, -1
 s_lshl_b32 s72, s70, 6
 s_add_u32 s72, s72, 235667456
 s_add_u32 s70, s70, s69
 s_waitcnt lgkmcnt(0)
 s_lshl_b32 s73, s70, 12
 s_add_u32 s74, s73, 2
 buffer_load_dwordx4 v[96:99], v130, s[8:11], s73 offen offset:0
 buffer_load_dwordx4 v[100:103], v130, s[8:11], s73 offen offset:1024
 buffer_load_dwordx4 v[104:107], v130, s[8:11], s73 offen offset:2048
 buffer_load_dwordx4 v[108:111], v130, s[8:11], s73 offen offset:3072
 buffer_load_dwordx4 v[112:115], v130, s[8:11], s74 offen offset:0
 buffer_load_dwordx4 v[116:119], v130, s[8:11], s74 offen offset:1024
 buffer_load_dwordx4 v[120:123], v130, s[8:11], s74 offen offset:2048
 buffer_load_dwordx4 v[124:127], v130, s[8:11], s74 offen offset:3072
 s_lshl_b32 s3, s70, 1
 buffer_load_ushort v128, off, s[12:15], s3
 s_lshl_b32 s3, s70, 12
 s_add_u32 s3, s3, 231735296
 buffer_load_dwordx4 v[240:243], v130, s[4:7], s3 offen offset:0 sc1
 buffer_load_dwordx4 v[244:247], v130, s[4:7], s3 offen offset:1024 sc1
 buffer_load_dwordx4 v[248:251], v130, s[4:7], s3 offen offset:2048 sc1
 buffer_load_dwordx4 v[252:255], v130, s[4:7], s3 offen offset:3072 sc1
 ds_read_b128 v[32:35], v14 offset:448
 ds_read2_b32 v[64:65], v16 offset0:0 offset1:1
 ds_read2_b32 v[66:67], v16 offset0:2 offset1:3
 ds_read_b128 v[36:39], v14 offset:960
 ds_read2_b32 v[68:69], v17 offset0:0 offset1:1
 ds_read2_b32 v[70:71], v17 offset0:2 offset1:3
 ds_read_b128 v[40:43], v14 offset:1472
 ds_read2_b32 v[72:73], v18 offset0:0 offset1:1
 ds_read2_b32 v[74:75], v18 offset0:2 offset1:3
 ds_read_b128 v[44:47], v14 offset:1984
 ds_read2_b32 v[76:77], v19 offset0:0 offset1:1
 ds_read2_b32 v[78:79], v19 offset0:2 offset1:3
 ds_read_b128 v[48:51], v14 offset:2496
 ds_read2_b32 v[80:81], v20 offset0:0 offset1:1
 ds_read2_b32 v[82:83], v20 offset0:2 offset1:3
 ds_read_b128 v[52:55], v14 offset:3008
 ds_read2_b32 v[84:85], v21 offset0:0 offset1:1
 ds_read2_b32 v[86:87], v21 offset0:2 offset1:3
 ds_read_b128 v[56:59], v14 offset:3520
 ds_read2_b32 v[88:89], v22 offset0:0 offset1:1
 ds_read2_b32 v[90:91], v22 offset0:2 offset1:3
 ds_read_b128 v[60:63], v14 offset:4032
 ds_read2_b32 v[92:93], v23 offset0:0 offset1:1
 ds_read2_b32 v[94:95], v23 offset0:2 offset1:3
 s_waitcnt lgkmcnt(0)
 v_mfma_f32_16x16x32_bf16 v[144:147], v[64:67], v[48:51], 0
 ds_read_b128 v[176:179], v14 offset:384
 v_mfma_f32_16x16x32_bf16 v[148:151], v[64:67], v[52:55], 0
 ds_read2_b32 v[208:209], v16 offset0:16 offset1:17
 v_mfma_f32_16x16x32_bf16 v[152:155], v[64:67], v[56:59], 0
 ds_read2_b32 v[210:211], v16 offset0:18 offset1:19
 v_mfma_f32_16x16x32_bf16 v[156:159], v[64:67], v[60:63], 0
 ds_read_b128 v[180:183], v14 offset:896
 v_mfma_f32_16x16x32_bf16 v[144:147], v[68:71], v[44:47], v[144:147]
 ds_read2_b32 v[212:213], v17 offset0:16 offset1:17
 v_mfma_f32_16x16x32_bf16 v[148:151], v[68:71], v[48:51], v[148:151]
 ds_read2_b32 v[214:215], v17 offset0:18 offset1:19
 v_mfma_f32_16x16x32_bf16 v[152:155], v[68:71], v[52:55], v[152:155]
 ds_read_b128 v[184:187], v14 offset:1408
 v_mfma_f32_16x16x32_bf16 v[156:159], v[68:71], v[56:59], v[156:159]
 ds_read2_b32 v[216:217], v18 offset0:16 offset1:17
 v_mfma_f32_16x16x32_bf16 v[144:147], v[72:75], v[40:43], v[144:147]
 ds_read2_b32 v[218:219], v18 offset0:18 offset1:19
 v_mfma_f32_16x16x32_bf16 v[148:151], v[72:75], v[44:47], v[148:151]
 ds_read_b128 v[188:191], v14 offset:1920
 v_mfma_f32_16x16x32_bf16 v[152:155], v[72:75], v[48:51], v[152:155]
 ds_read2_b32 v[220:221], v19 offset0:16 offset1:17
 v_mfma_f32_16x16x32_bf16 v[156:159], v[72:75], v[52:55], v[156:159]
 ds_read2_b32 v[222:223], v19 offset0:18 offset1:19
 v_mfma_f32_16x16x32_bf16 v[144:147], v[76:79], v[36:39], v[144:147]
 ds_read_b128 v[192:195], v14 offset:2432
 v_mfma_f32_16x16x32_bf16 v[148:151], v[76:79], v[40:43], v[148:151]
 ds_read2_b32 v[224:225], v20 offset0:16 offset1:17
 v_mfma_f32_16x16x32_bf16 v[152:155], v[76:79], v[44:47], v[152:155]
 ds_read2_b32 v[226:227], v20 offset0:18 offset1:19
 v_mfma_f32_16x16x32_bf16 v[156:159], v[76:79], v[48:51], v[156:159]
 ds_read_b128 v[196:199], v14 offset:2944
 v_mfma_f32_16x16x32_bf16 v[144:147], v[80:83], v[32:35], v[144:147]
 ds_read2_b32 v[228:229], v21 offset0:16 offset1:17
 v_mfma_f32_16x16x32_bf16 v[148:151], v[80:83], v[36:39], v[148:151]
 ds_read2_b32 v[230:231], v21 offset0:18 offset1:19
 v_mfma_f32_16x16x32_bf16 v[152:155], v[80:83], v[40:43], v[152:155]
 ds_read_b128 v[200:203], v14 offset:3456
 v_mfma_f32_16x16x32_bf16 v[156:159], v[80:83], v[44:47], v[156:159]
 ds_read2_b32 v[232:233], v22 offset0:16 offset1:17
 v_mfma_f32_16x16x32_bf16 v[148:151], v[84:87], v[32:35], v[148:151]
 ds_read2_b32 v[234:235], v22 offset0:18 offset1:19
 v_mfma_f32_16x16x32_bf16 v[152:155], v[84:87], v[36:39], v[152:155]
 ds_read_b128 v[204:207], v14 offset:3968
 v_mfma_f32_16x16x32_bf16 v[156:159], v[84:87], v[40:43], v[156:159]
 ds_read2_b32 v[236:237], v23 offset0:16 offset1:17
 v_mfma_f32_16x16x32_bf16 v[152:155], v[88:91], v[32:35], v[152:155]
 ds_read2_b32 v[238:239], v23 offset0:18 offset1:19
 v_mfma_f32_16x16x32_bf16 v[156:159], v[88:91], v[36:39], v[156:159]
 v_mfma_f32_16x16x32_bf16 v[156:159], v[92:95], v[32:35], v[156:159]
 s_waitcnt lgkmcnt(0)
 v_mfma_f32_16x16x32_bf16 v[144:147], v[208:211], v[192:195], v[144:147]
 ds_read_b128 v[32:35], v14 offset:320
 v_mfma_f32_16x16x32_bf16 v[148:151], v[208:211], v[196:199], v[148:151]
 ds_read2_b32 v[64:65], v16 offset0:32 offset1:33
 v_mfma_f32_16x16x32_bf16 v[152:155], v[208:211], v[200:203], v[152:155]
 ds_read2_b32 v[66:67], v16 offset0:34 offset1:35
 v_mfma_f32_16x16x32_bf16 v[156:159], v[208:211], v[204:207], v[156:159]
 ds_read_b128 v[36:39], v14 offset:832
 v_mfma_f32_16x16x32_bf16 v[144:147], v[212:215], v[188:191], v[144:147]
 ds_read2_b32 v[68:69], v17 offset0:32 offset1:33
 v_mfma_f32_16x16x32_bf16 v[148:151], v[212:215], v[192:195], v[148:151]
 ds_read2_b32 v[70:71], v17 offset0:34 offset1:35
 v_mfma_f32_16x16x32_bf16 v[152:155], v[212:215], v[196:199], v[152:155]
 ds_read_b128 v[40:43], v14 offset:1344
 v_mfma_f32_16x16x32_bf16 v[156:159], v[212:215], v[200:203], v[156:159]
 ds_read2_b32 v[72:73], v18 offset0:32 offset1:33
 v_mfma_f32_16x16x32_bf16 v[144:147], v[216:219], v[184:187], v[144:147]
 ds_read2_b32 v[74:75], v18 offset0:34 offset1:35
 v_mfma_f32_16x16x32_bf16 v[148:151], v[216:219], v[188:191], v[148:151]
 ds_read_b128 v[44:47], v14 offset:1856
 v_mfma_f32_16x16x32_bf16 v[152:155], v[216:219], v[192:195], v[152:155]
 ds_read2_b32 v[76:77], v19 offset0:32 offset1:33
 v_mfma_f32_16x16x32_bf16 v[156:159], v[216:219], v[196:199], v[156:159]
 ds_read2_b32 v[78:79], v19 offset0:34 offset1:35
 v_mfma_f32_16x16x32_bf16 v[144:147], v[220:223], v[180:183], v[144:147]
 ds_read_b128 v[48:51], v14 offset:2368
 v_mfma_f32_16x16x32_bf16 v[148:151], v[220:223], v[184:187], v[148:151]
 ds_read2_b32 v[80:81], v20 offset0:32 offset1:33
 v_mfma_f32_16x16x32_bf16 v[152:155], v[220:223], v[188:191], v[152:155]
 ds_read2_b32 v[82:83], v20 offset0:34 offset1:35
 v_mfma_f32_16x16x32_bf16 v[156:159], v[220:223], v[192:195], v[156:159]
 ds_read_b128 v[52:55], v14 offset:2880
 v_mfma_f32_16x16x32_bf16 v[144:147], v[224:227], v[176:179], v[144:147]
 ds_read2_b32 v[84:85], v21 offset0:32 offset1:33
 v_mfma_f32_16x16x32_bf16 v[148:151], v[224:227], v[180:183], v[148:151]
 ds_read2_b32 v[86:87], v21 offset0:34 offset1:35
 v_mfma_f32_16x16x32_bf16 v[152:155], v[224:227], v[184:187], v[152:155]
 ds_read_b128 v[56:59], v14 offset:3392
 v_mfma_f32_16x16x32_bf16 v[156:159], v[224:227], v[188:191], v[156:159]
 ds_read2_b32 v[88:89], v22 offset0:32 offset1:33
 v_mfma_f32_16x16x32_bf16 v[148:151], v[228:231], v[176:179], v[148:151]
 ds_read2_b32 v[90:91], v22 offset0:34 offset1:35
 v_mfma_f32_16x16x32_bf16 v[152:155], v[228:231], v[180:183], v[152:155]
 ds_read_b128 v[60:63], v14 offset:3904
 v_mfma_f32_16x16x32_bf16 v[156:159], v[228:231], v[184:187], v[156:159]
 ds_read2_b32 v[92:93], v23 offset0:32 offset1:33
 v_mfma_f32_16x16x32_bf16 v[152:155], v[232:235], v[176:179], v[152:155]
 ds_read2_b32 v[94:95], v23 offset0:34 offset1:35
 v_mfma_f32_16x16x32_bf16 v[156:159], v[232:235], v[180:183], v[156:159]
 v_mfma_f32_16x16x32_bf16 v[156:159], v[236:239], v[176:179], v[156:159]
 s_waitcnt lgkmcnt(0)
 v_mfma_f32_16x16x32_bf16 v[144:147], v[64:67], v[48:51], v[144:147]
 ds_read_b128 v[176:179], v14 offset:256
 v_mfma_f32_16x16x32_bf16 v[148:151], v[64:67], v[52:55], v[148:151]
 ds_read2_b32 v[208:209], v16 offset0:48 offset1:49
 v_mfma_f32_16x16x32_bf16 v[152:155], v[64:67], v[56:59], v[152:155]
 ds_read2_b32 v[210:211], v16 offset0:50 offset1:51
 v_mfma_f32_16x16x32_bf16 v[156:159], v[64:67], v[60:63], v[156:159]
 ds_read_b128 v[180:183], v14 offset:768
 v_mfma_f32_16x16x32_bf16 v[144:147], v[68:71], v[44:47], v[144:147]
 ds_read2_b32 v[212:213], v17 offset0:48 offset1:49
 v_mfma_f32_16x16x32_bf16 v[148:151], v[68:71], v[48:51], v[148:151]
 ds_read2_b32 v[214:215], v17 offset0:50 offset1:51
 v_mfma_f32_16x16x32_bf16 v[152:155], v[68:71], v[52:55], v[152:155]
 ds_read_b128 v[184:187], v14 offset:1280
 v_mfma_f32_16x16x32_bf16 v[156:159], v[68:71], v[56:59], v[156:159]
 ds_read2_b32 v[216:217], v18 offset0:48 offset1:49
 v_mfma_f32_16x16x32_bf16 v[144:147], v[72:75], v[40:43], v[144:147]
 ds_read2_b32 v[218:219], v18 offset0:50 offset1:51
 v_mfma_f32_16x16x32_bf16 v[148:151], v[72:75], v[44:47], v[148:151]
 ds_read_b128 v[188:191], v14 offset:1792
 v_mfma_f32_16x16x32_bf16 v[152:155], v[72:75], v[48:51], v[152:155]
 ds_read2_b32 v[220:221], v19 offset0:48 offset1:49
 v_mfma_f32_16x16x32_bf16 v[156:159], v[72:75], v[52:55], v[156:159]
 ds_read2_b32 v[222:223], v19 offset0:50 offset1:51
 v_mfma_f32_16x16x32_bf16 v[144:147], v[76:79], v[36:39], v[144:147]
 ds_read_b128 v[192:195], v14 offset:2304
 v_mfma_f32_16x16x32_bf16 v[148:151], v[76:79], v[40:43], v[148:151]
 ds_read2_b32 v[224:225], v20 offset0:48 offset1:49
 v_mfma_f32_16x16x32_bf16 v[152:155], v[76:79], v[44:47], v[152:155]
 ds_read2_b32 v[226:227], v20 offset0:50 offset1:51
 v_mfma_f32_16x16x32_bf16 v[156:159], v[76:79], v[48:51], v[156:159]
 ds_read_b128 v[196:199], v14 offset:2816
 v_mfma_f32_16x16x32_bf16 v[144:147], v[80:83], v[32:35], v[144:147]
 ds_read2_b32 v[228:229], v21 offset0:48 offset1:49
 v_mfma_f32_16x16x32_bf16 v[148:151], v[80:83], v[36:39], v[148:151]
 ds_read2_b32 v[230:231], v21 offset0:50 offset1:51
 v_mfma_f32_16x16x32_bf16 v[152:155], v[80:83], v[40:43], v[152:155]
 ds_read_b128 v[200:203], v14 offset:3328
 v_mfma_f32_16x16x32_bf16 v[156:159], v[80:83], v[44:47], v[156:159]
 ds_read2_b32 v[232:233], v22 offset0:48 offset1:49
 v_mfma_f32_16x16x32_bf16 v[148:151], v[84:87], v[32:35], v[148:151]
 ds_read2_b32 v[234:235], v22 offset0:50 offset1:51
 v_mfma_f32_16x16x32_bf16 v[152:155], v[84:87], v[36:39], v[152:155]
 ds_read_b128 v[204:207], v14 offset:3840
 v_mfma_f32_16x16x32_bf16 v[156:159], v[84:87], v[40:43], v[156:159]
 ds_read2_b32 v[236:237], v23 offset0:48 offset1:49
 v_mfma_f32_16x16x32_bf16 v[152:155], v[88:91], v[32:35], v[152:155]
 ds_read2_b32 v[238:239], v23 offset0:50 offset1:51
 v_mfma_f32_16x16x32_bf16 v[156:159], v[88:91], v[36:39], v[156:159]
 v_mfma_f32_16x16x32_bf16 v[156:159], v[92:95], v[32:35], v[156:159]
 s_waitcnt lgkmcnt(0)
 v_mfma_f32_16x16x32_bf16 v[144:147], v[208:211], v[192:195], v[144:147]
 ds_read_b128 v[32:35], v14 offset:192
 v_mfma_f32_16x16x32_bf16 v[148:151], v[208:211], v[196:199], v[148:151]
 ds_read2_b32 v[64:65], v16 offset0:64 offset1:65
 v_mfma_f32_16x16x32_bf16 v[152:155], v[208:211], v[200:203], v[152:155]
 ds_read2_b32 v[66:67], v16 offset0:66 offset1:67
 v_mfma_f32_16x16x32_bf16 v[156:159], v[208:211], v[204:207], v[156:159]
 ds_read_b128 v[36:39], v14 offset:704
 v_mfma_f32_16x16x32_bf16 v[144:147], v[212:215], v[188:191], v[144:147]
 ds_read2_b32 v[68:69], v17 offset0:64 offset1:65
 v_mfma_f32_16x16x32_bf16 v[148:151], v[212:215], v[192:195], v[148:151]
 ds_read2_b32 v[70:71], v17 offset0:66 offset1:67
 v_mfma_f32_16x16x32_bf16 v[152:155], v[212:215], v[196:199], v[152:155]
 ds_read_b128 v[40:43], v14 offset:1216
 v_mfma_f32_16x16x32_bf16 v[156:159], v[212:215], v[200:203], v[156:159]
 ds_read2_b32 v[72:73], v18 offset0:64 offset1:65
 v_mfma_f32_16x16x32_bf16 v[144:147], v[216:219], v[184:187], v[144:147]
 ds_read2_b32 v[74:75], v18 offset0:66 offset1:67
 v_mfma_f32_16x16x32_bf16 v[148:151], v[216:219], v[188:191], v[148:151]
 ds_read_b128 v[44:47], v14 offset:1728
 v_mfma_f32_16x16x32_bf16 v[152:155], v[216:219], v[192:195], v[152:155]
 ds_read2_b32 v[76:77], v19 offset0:64 offset1:65
 v_mfma_f32_16x16x32_bf16 v[156:159], v[216:219], v[196:199], v[156:159]
 ds_read2_b32 v[78:79], v19 offset0:66 offset1:67
 v_mfma_f32_16x16x32_bf16 v[144:147], v[220:223], v[180:183], v[144:147]
 ds_read_b128 v[48:51], v14 offset:2240
 v_mfma_f32_16x16x32_bf16 v[148:151], v[220:223], v[184:187], v[148:151]
 ds_read2_b32 v[80:81], v20 offset0:64 offset1:65
 v_mfma_f32_16x16x32_bf16 v[152:155], v[220:223], v[188:191], v[152:155]
 ds_read2_b32 v[82:83], v20 offset0:66 offset1:67
 v_mfma_f32_16x16x32_bf16 v[156:159], v[220:223], v[192:195], v[156:159]
 ds_read_b128 v[52:55], v14 offset:2752
 v_mfma_f32_16x16x32_bf16 v[144:147], v[224:227], v[176:179], v[144:147]
 ds_read2_b32 v[84:85], v21 offset0:64 offset1:65
 v_mfma_f32_16x16x32_bf16 v[148:151], v[224:227], v[180:183], v[148:151]
 ds_read2_b32 v[86:87], v21 offset0:66 offset1:67
 v_mfma_f32_16x16x32_bf16 v[152:155], v[224:227], v[184:187], v[152:155]
 ds_read_b128 v[56:59], v14 offset:3264
 v_mfma_f32_16x16x32_bf16 v[156:159], v[224:227], v[188:191], v[156:159]
 ds_read2_b32 v[88:89], v22 offset0:64 offset1:65
 v_mfma_f32_16x16x32_bf16 v[148:151], v[228:231], v[176:179], v[148:151]
 ds_read2_b32 v[90:91], v22 offset0:66 offset1:67
 v_mfma_f32_16x16x32_bf16 v[152:155], v[228:231], v[180:183], v[152:155]
 ds_read_b128 v[60:63], v14 offset:3776
 v_mfma_f32_16x16x32_bf16 v[156:159], v[228:231], v[184:187], v[156:159]
 ds_read2_b32 v[92:93], v23 offset0:64 offset1:65
 v_mfma_f32_16x16x32_bf16 v[152:155], v[232:235], v[176:179], v[152:155]
 ds_read2_b32 v[94:95], v23 offset0:66 offset1:67
 v_mfma_f32_16x16x32_bf16 v[156:159], v[232:235], v[180:183], v[156:159]
 v_mfma_f32_16x16x32_bf16 v[156:159], v[236:239], v[176:179], v[156:159]
 s_waitcnt lgkmcnt(0)
 v_mfma_f32_16x16x32_bf16 v[144:147], v[64:67], v[48:51], v[144:147]
 ds_read_b128 v[176:179], v14 offset:128
 v_mfma_f32_16x16x32_bf16 v[148:151], v[64:67], v[52:55], v[148:151]
 ds_read2_b32 v[208:209], v16 offset0:80 offset1:81
 v_mfma_f32_16x16x32_bf16 v[152:155], v[64:67], v[56:59], v[152:155]
 ds_read2_b32 v[210:211], v16 offset0:82 offset1:83
 v_mfma_f32_16x16x32_bf16 v[156:159], v[64:67], v[60:63], v[156:159]
 ds_read_b128 v[180:183], v14 offset:640
 v_mfma_f32_16x16x32_bf16 v[144:147], v[68:71], v[44:47], v[144:147]
 ds_read2_b32 v[212:213], v17 offset0:80 offset1:81
 v_mfma_f32_16x16x32_bf16 v[148:151], v[68:71], v[48:51], v[148:151]
 ds_read2_b32 v[214:215], v17 offset0:82 offset1:83
 v_mfma_f32_16x16x32_bf16 v[152:155], v[68:71], v[52:55], v[152:155]
 ds_read_b128 v[184:187], v14 offset:1152
 v_mfma_f32_16x16x32_bf16 v[156:159], v[68:71], v[56:59], v[156:159]
 ds_read2_b32 v[216:217], v18 offset0:80 offset1:81
 v_mfma_f32_16x16x32_bf16 v[144:147], v[72:75], v[40:43], v[144:147]
 ds_read2_b32 v[218:219], v18 offset0:82 offset1:83
 v_mfma_f32_16x16x32_bf16 v[148:151], v[72:75], v[44:47], v[148:151]
 ds_read_b128 v[188:191], v14 offset:1664
 v_mfma_f32_16x16x32_bf16 v[152:155], v[72:75], v[48:51], v[152:155]
 ds_read2_b32 v[220:221], v19 offset0:80 offset1:81
 v_mfma_f32_16x16x32_bf16 v[156:159], v[72:75], v[52:55], v[156:159]
 ds_read2_b32 v[222:223], v19 offset0:82 offset1:83
 v_mfma_f32_16x16x32_bf16 v[144:147], v[76:79], v[36:39], v[144:147]
 ds_read_b128 v[192:195], v14 offset:2176
 v_mfma_f32_16x16x32_bf16 v[148:151], v[76:79], v[40:43], v[148:151]
 ds_read2_b32 v[224:225], v20 offset0:80 offset1:81
 v_mfma_f32_16x16x32_bf16 v[152:155], v[76:79], v[44:47], v[152:155]
 ds_read2_b32 v[226:227], v20 offset0:82 offset1:83
 v_mfma_f32_16x16x32_bf16 v[156:159], v[76:79], v[48:51], v[156:159]
 ds_read_b128 v[196:199], v14 offset:2688
 v_mfma_f32_16x16x32_bf16 v[144:147], v[80:83], v[32:35], v[144:147]
 ds_read2_b32 v[228:229], v21 offset0:80 offset1:81
 v_mfma_f32_16x16x32_bf16 v[148:151], v[80:83], v[36:39], v[148:151]
 ds_read2_b32 v[230:231], v21 offset0:82 offset1:83
 v_mfma_f32_16x16x32_bf16 v[152:155], v[80:83], v[40:43], v[152:155]
 ds_read_b128 v[200:203], v14 offset:3200
 v_mfma_f32_16x16x32_bf16 v[156:159], v[80:83], v[44:47], v[156:159]
 ds_read2_b32 v[232:233], v22 offset0:80 offset1:81
 v_mfma_f32_16x16x32_bf16 v[148:151], v[84:87], v[32:35], v[148:151]
 ds_read2_b32 v[234:235], v22 offset0:82 offset1:83
 v_mfma_f32_16x16x32_bf16 v[152:155], v[84:87], v[36:39], v[152:155]
 ds_read_b128 v[204:207], v14 offset:3712
 v_mfma_f32_16x16x32_bf16 v[156:159], v[84:87], v[40:43], v[156:159]
 ds_read2_b32 v[236:237], v23 offset0:80 offset1:81
 v_mfma_f32_16x16x32_bf16 v[152:155], v[88:91], v[32:35], v[152:155]
 ds_read2_b32 v[238:239], v23 offset0:82 offset1:83
 v_mfma_f32_16x16x32_bf16 v[156:159], v[88:91], v[36:39], v[156:159]
 v_mfma_f32_16x16x32_bf16 v[156:159], v[92:95], v[32:35], v[156:159]
 s_waitcnt lgkmcnt(0)
 v_mfma_f32_16x16x32_bf16 v[144:147], v[208:211], v[192:195], v[144:147]
 ds_read_b128 v[32:35], v14 offset:64
 v_mfma_f32_16x16x32_bf16 v[148:151], v[208:211], v[196:199], v[148:151]
 ds_read2_b32 v[64:65], v16 offset0:96 offset1:97
 v_mfma_f32_16x16x32_bf16 v[152:155], v[208:211], v[200:203], v[152:155]
 ds_read2_b32 v[66:67], v16 offset0:98 offset1:99
 v_mfma_f32_16x16x32_bf16 v[156:159], v[208:211], v[204:207], v[156:159]
 ds_read_b128 v[36:39], v14 offset:576
 v_mfma_f32_16x16x32_bf16 v[144:147], v[212:215], v[188:191], v[144:147]
 ds_read2_b32 v[68:69], v17 offset0:96 offset1:97
 v_mfma_f32_16x16x32_bf16 v[148:151], v[212:215], v[192:195], v[148:151]
 ds_read2_b32 v[70:71], v17 offset0:98 offset1:99
 v_mfma_f32_16x16x32_bf16 v[152:155], v[212:215], v[196:199], v[152:155]
 ds_read_b128 v[40:43], v14 offset:1088
 v_mfma_f32_16x16x32_bf16 v[156:159], v[212:215], v[200:203], v[156:159]
 ds_read2_b32 v[72:73], v18 offset0:96 offset1:97
 v_mfma_f32_16x16x32_bf16 v[144:147], v[216:219], v[184:187], v[144:147]
 ds_read2_b32 v[74:75], v18 offset0:98 offset1:99
 v_mfma_f32_16x16x32_bf16 v[148:151], v[216:219], v[188:191], v[148:151]
 ds_read_b128 v[44:47], v14 offset:1600
 v_mfma_f32_16x16x32_bf16 v[152:155], v[216:219], v[192:195], v[152:155]
 ds_read2_b32 v[76:77], v19 offset0:96 offset1:97
 v_mfma_f32_16x16x32_bf16 v[156:159], v[216:219], v[196:199], v[156:159]
 ds_read2_b32 v[78:79], v19 offset0:98 offset1:99
 v_mfma_f32_16x16x32_bf16 v[144:147], v[220:223], v[180:183], v[144:147]
 ds_read_b128 v[48:51], v14 offset:2112
 v_mfma_f32_16x16x32_bf16 v[148:151], v[220:223], v[184:187], v[148:151]
 ds_read2_b32 v[80:81], v20 offset0:96 offset1:97
 v_mfma_f32_16x16x32_bf16 v[152:155], v[220:223], v[188:191], v[152:155]
 ds_read2_b32 v[82:83], v20 offset0:98 offset1:99
 v_mfma_f32_16x16x32_bf16 v[156:159], v[220:223], v[192:195], v[156:159]
 ds_read_b128 v[52:55], v14 offset:2624
 v_mfma_f32_16x16x32_bf16 v[144:147], v[224:227], v[176:179], v[144:147]
 ds_read2_b32 v[84:85], v21 offset0:96 offset1:97
 v_mfma_f32_16x16x32_bf16 v[148:151], v[224:227], v[180:183], v[148:151]
 ds_read2_b32 v[86:87], v21 offset0:98 offset1:99
 v_mfma_f32_16x16x32_bf16 v[152:155], v[224:227], v[184:187], v[152:155]
 ds_read_b128 v[56:59], v14 offset:3136
 v_mfma_f32_16x16x32_bf16 v[156:159], v[224:227], v[188:191], v[156:159]
 ds_read2_b32 v[88:89], v22 offset0:96 offset1:97
 v_mfma_f32_16x16x32_bf16 v[148:151], v[228:231], v[176:179], v[148:151]
 ds_read2_b32 v[90:91], v22 offset0:98 offset1:99
 v_mfma_f32_16x16x32_bf16 v[152:155], v[228:231], v[180:183], v[152:155]
 ds_read_b128 v[60:63], v14 offset:3648
 v_mfma_f32_16x16x32_bf16 v[156:159], v[228:231], v[184:187], v[156:159]
 ds_read2_b32 v[92:93], v23 offset0:96 offset1:97
 v_mfma_f32_16x16x32_bf16 v[152:155], v[232:235], v[176:179], v[152:155]
 ds_read2_b32 v[94:95], v23 offset0:98 offset1:99
 v_mfma_f32_16x16x32_bf16 v[156:159], v[232:235], v[180:183], v[156:159]
 v_mfma_f32_16x16x32_bf16 v[156:159], v[236:239], v[176:179], v[156:159]
 s_waitcnt lgkmcnt(0)
 v_mfma_f32_16x16x32_bf16 v[144:147], v[64:67], v[48:51], v[144:147]
 ds_read_b128 v[176:179], v14 offset:0
 v_mfma_f32_16x16x32_bf16 v[148:151], v[64:67], v[52:55], v[148:151]
 ds_read2_b32 v[208:209], v16 offset0:112 offset1:113
 v_mfma_f32_16x16x32_bf16 v[152:155], v[64:67], v[56:59], v[152:155]
 ds_read2_b32 v[210:211], v16 offset0:114 offset1:115
 v_mfma_f32_16x16x32_bf16 v[156:159], v[64:67], v[60:63], v[156:159]
 ds_read_b128 v[180:183], v14 offset:512
 v_mfma_f32_16x16x32_bf16 v[144:147], v[68:71], v[44:47], v[144:147]
 ds_read2_b32 v[212:213], v17 offset0:112 offset1:113
 v_mfma_f32_16x16x32_bf16 v[148:151], v[68:71], v[48:51], v[148:151]
 ds_read2_b32 v[214:215], v17 offset0:114 offset1:115
 v_mfma_f32_16x16x32_bf16 v[152:155], v[68:71], v[52:55], v[152:155]
 ds_read_b128 v[184:187], v14 offset:1024
 v_mfma_f32_16x16x32_bf16 v[156:159], v[68:71], v[56:59], v[156:159]
 ds_read2_b32 v[216:217], v18 offset0:112 offset1:113
 v_mfma_f32_16x16x32_bf16 v[144:147], v[72:75], v[40:43], v[144:147]
 ds_read2_b32 v[218:219], v18 offset0:114 offset1:115
 v_mfma_f32_16x16x32_bf16 v[148:151], v[72:75], v[44:47], v[148:151]
 ds_read_b128 v[188:191], v14 offset:1536
 v_mfma_f32_16x16x32_bf16 v[152:155], v[72:75], v[48:51], v[152:155]
 ds_read2_b32 v[220:221], v19 offset0:112 offset1:113
 v_mfma_f32_16x16x32_bf16 v[156:159], v[72:75], v[52:55], v[156:159]
 ds_read2_b32 v[222:223], v19 offset0:114 offset1:115
 v_mfma_f32_16x16x32_bf16 v[144:147], v[76:79], v[36:39], v[144:147]
 ds_read_b128 v[192:195], v14 offset:2048
 v_mfma_f32_16x16x32_bf16 v[148:151], v[76:79], v[40:43], v[148:151]
 ds_read2_b32 v[224:225], v20 offset0:112 offset1:113
 v_mfma_f32_16x16x32_bf16 v[152:155], v[76:79], v[44:47], v[152:155]
 ds_read2_b32 v[226:227], v20 offset0:114 offset1:115
 v_mfma_f32_16x16x32_bf16 v[156:159], v[76:79], v[48:51], v[156:159]
 ds_read_b128 v[196:199], v14 offset:2560
 v_mfma_f32_16x16x32_bf16 v[144:147], v[80:83], v[32:35], v[144:147]
 ds_read2_b32 v[228:229], v21 offset0:112 offset1:113
 v_mfma_f32_16x16x32_bf16 v[148:151], v[80:83], v[36:39], v[148:151]
 ds_read2_b32 v[230:231], v21 offset0:114 offset1:115
 v_mfma_f32_16x16x32_bf16 v[152:155], v[80:83], v[40:43], v[152:155]
 ds_read_b128 v[200:203], v14 offset:3072
 v_mfma_f32_16x16x32_bf16 v[156:159], v[80:83], v[44:47], v[156:159]
 ds_read2_b32 v[232:233], v22 offset0:112 offset1:113
 v_mfma_f32_16x16x32_bf16 v[148:151], v[84:87], v[32:35], v[148:151]
 ds_read2_b32 v[234:235], v22 offset0:114 offset1:115
 v_mfma_f32_16x16x32_bf16 v[152:155], v[84:87], v[36:39], v[152:155]
 ds_read_b128 v[204:207], v14 offset:3584
 v_mfma_f32_16x16x32_bf16 v[156:159], v[84:87], v[40:43], v[156:159]
 ds_read2_b32 v[236:237], v23 offset0:112 offset1:113
 v_mfma_f32_16x16x32_bf16 v[152:155], v[88:91], v[32:35], v[152:155]
 ds_read2_b32 v[238:239], v23 offset0:114 offset1:115
 v_mfma_f32_16x16x32_bf16 v[156:159], v[88:91], v[36:39], v[156:159]
 v_mfma_f32_16x16x32_bf16 v[156:159], v[92:95], v[32:35], v[156:159]
 s_waitcnt lgkmcnt(0)
 v_mfma_f32_16x16x32_bf16 v[144:147], v[208:211], v[192:195], v[144:147]
 ds_read_b64 v[32:33], v15 offset:2048
 v_mfma_f32_16x16x32_bf16 v[148:151], v[208:211], v[196:199], v[148:151]
 ds_read_b64 v[34:35], v15 offset:2560
 v_mfma_f32_16x16x32_bf16 v[152:155], v[208:211], v[200:203], v[152:155]
 ds_read_b64 v[36:37], v15 offset:3072
 v_mfma_f32_16x16x32_bf16 v[156:159], v[208:211], v[204:207], v[156:159]
 ds_read_b64 v[38:39], v15 offset:3584
 v_mfma_f32_16x16x32_bf16 v[144:147], v[212:215], v[188:191], v[144:147]
 v_mfma_f32_16x16x32_bf16 v[148:151], v[212:215], v[192:195], v[148:151]
 v_mfma_f32_16x16x32_bf16 v[152:155], v[212:215], v[196:199], v[152:155]
 v_mfma_f32_16x16x32_bf16 v[156:159], v[212:215], v[200:203], v[156:159]
 v_mfma_f32_16x16x32_bf16 v[144:147], v[216:219], v[184:187], v[144:147]
 v_mfma_f32_16x16x32_bf16 v[148:151], v[216:219], v[188:191], v[148:151]
 v_mfma_f32_16x16x32_bf16 v[152:155], v[216:219], v[192:195], v[152:155]
 v_mfma_f32_16x16x32_bf16 v[156:159], v[216:219], v[196:199], v[156:159]
 v_mfma_f32_16x16x32_bf16 v[144:147], v[220:223], v[180:183], v[144:147]
 v_mfma_f32_16x16x32_bf16 v[148:151], v[220:223], v[184:187], v[148:151]
 v_mfma_f32_16x16x32_bf16 v[152:155], v[220:223], v[188:191], v[152:155]
 v_mfma_f32_16x16x32_bf16 v[156:159], v[220:223], v[192:195], v[156:159]
 v_mfma_f32_16x16x32_bf16 v[144:147], v[224:227], v[176:179], v[144:147]
 v_mfma_f32_16x16x32_bf16 v[148:151], v[224:227], v[180:183], v[148:151]
 v_mfma_f32_16x16x32_bf16 v[152:155], v[224:227], v[184:187], v[152:155]
 v_mfma_f32_16x16x32_bf16 v[156:159], v[224:227], v[188:191], v[156:159]
 v_mfma_f32_16x16x32_bf16 v[148:151], v[228:231], v[176:179], v[148:151]
 v_mfma_f32_16x16x32_bf16 v[152:155], v[228:231], v[180:183], v[152:155]
 v_mfma_f32_16x16x32_bf16 v[156:159], v[228:231], v[184:187], v[156:159]
 v_mfma_f32_16x16x32_bf16 v[152:155], v[232:235], v[176:179], v[152:155]
 v_mfma_f32_16x16x32_bf16 v[156:159], v[232:235], v[180:183], v[156:159]
 v_mfma_f32_16x16x32_bf16 v[156:159], v[236:239], v[176:179], v[156:159]
 s_waitcnt lgkmcnt(0)
 v_and_b32 v64, 0xffff0000, v33
 v_lshlrev_b32 v65, 16, v33
 v_and_b32 v66, 0xffff0000, v32
 v_lshlrev_b32 v67, 16, v32
 v_mul_f32 v64, v64, v12
 v_mul_f32 v65, v65, v12
 v_mul_f32 v66, v66, v12
 v_mul_f32 v67, v67, v12
 v_and_b32 v68, 0xffff0000, v35
 v_lshlrev_b32 v69, 16, v35
 v_and_b32 v70, 0xffff0000, v34
 v_lshlrev_b32 v71, 16, v34
 v_mul_f32 v68, v68, v12
 v_mul_f32 v69, v69, v12
 v_mul_f32 v70, v70, v12
 v_mul_f32 v71, v71, v12
 v_and_b32 v72, 0xffff0000, v37
 v_lshlrev_b32 v73, 16, v37
 v_and_b32 v74, 0xffff0000, v36
 v_lshlrev_b32 v75, 16, v36
 v_mul_f32 v72, v72, v12
 v_mul_f32 v73, v73, v12
 v_mul_f32 v74, v74, v12
 v_mul_f32 v75, v75, v12
 v_and_b32 v76, 0xffff0000, v39
 v_lshlrev_b32 v77, 16, v39
 v_and_b32 v78, 0xffff0000, v38
 v_lshlrev_b32 v79, 16, v38
 v_mul_f32 v76, v76, v12
 v_mul_f32 v77, v77, v12
 v_mul_f32 v78, v78, v12
 v_mul_f32 v79, v79, v12
 v_cvt_pk_bf16_f32 v8, v64, v65
 v_lshlrev_b32 v64, 16, v8
 v_and_b32 v65, 0xffff0000, v8
 v_cvt_pk_bf16_f32 v8, v66, v67
 v_lshlrev_b32 v66, 16, v8
 v_and_b32 v67, 0xffff0000, v8
 v_cvt_pk_bf16_f32 v8, v68, v69
 v_lshlrev_b32 v68, 16, v8
 v_and_b32 v69, 0xffff0000, v8
 v_cvt_pk_bf16_f32 v8, v70, v71
 v_lshlrev_b32 v70, 16, v8
 v_and_b32 v71, 0xffff0000, v8
 v_cvt_pk_bf16_f32 v8, v72, v73
 v_lshlrev_b32 v72, 16, v8
 v_and_b32 v73, 0xffff0000, v8
 v_cvt_pk_bf16_f32 v8, v74, v75
 v_lshlrev_b32 v74, 16, v8
 v_and_b32 v75, 0xffff0000, v8
 v_cvt_pk_bf16_f32 v8, v76, v77
 v_lshlrev_b32 v76, 16, v8
 v_and_b32 v77, 0xffff0000, v8
 v_cvt_pk_bf16_f32 v8, v78, v79
 v_lshlrev_b32 v78, 16, v8
 v_and_b32 v79, 0xffff0000, v8
 v_cvt_pk_bf16_f32 v8, v144, v145
 v_lshlrev_b32 v144, 16, v8
 v_and_b32 v145, 0xffff0000, v8
 v_cvt_pk_bf16_f32 v8, v146, v147
 v_lshlrev_b32 v146, 16, v8
 v_and_b32 v147, 0xffff0000, v8
 v_cvt_pk_bf16_f32 v8, v148, v149
 v_lshlrev_b32 v148, 16, v8
 v_and_b32 v149, 0xffff0000, v8
 v_cvt_pk_bf16_f32 v8, v150, v151
 v_lshlrev_b32 v150, 16, v8
 v_and_b32 v151, 0xffff0000, v8
 v_cvt_pk_bf16_f32 v8, v152, v153
 v_lshlrev_b32 v152, 16, v8
 v_and_b32 v153, 0xffff0000, v8
 v_cvt_pk_bf16_f32 v8, v154, v155
 v_lshlrev_b32 v154, 16, v8
 v_and_b32 v155, 0xffff0000, v8
 v_cvt_pk_bf16_f32 v8, v156, v157
 v_lshlrev_b32 v156, 16, v8
 v_and_b32 v157, 0xffff0000, v8
 v_cvt_pk_bf16_f32 v8, v158, v159
 v_lshlrev_b32 v158, 16, v8
 v_and_b32 v159, 0xffff0000, v8
 v_pk_add_f32 v[144:145], v[144:145], v[64:65]
 v_pk_add_f32 v[146:147], v[146:147], v[66:67]
 v_pk_add_f32 v[148:149], v[148:149], v[68:69]
 v_pk_add_f32 v[150:151], v[150:151], v[70:71]
 v_pk_add_f32 v[152:153], v[152:153], v[72:73]
 v_pk_add_f32 v[154:155], v[154:155], v[74:75]
 v_pk_add_f32 v[156:157], v[156:157], v[76:77]
 v_pk_add_f32 v[158:159], v[158:159], v[78:79]
 v_cvt_pk_bf16_f32 v160, v144, v148
 v_cvt_pk_bf16_f32 v161, v152, v156
 buffer_store_dwordx2 v[160:161], v13, s[4:7], s72 offen sc1
 s_add_u32 s72, s72, 40960
 v_cvt_pk_bf16_f32 v162, v145, v149
 v_cvt_pk_bf16_f32 v163, v153, v157
 buffer_store_dwordx2 v[162:163], v13, s[4:7], s72 offen sc1
 s_add_u32 s72, s72, 40960
 v_cvt_pk_bf16_f32 v164, v146, v150
 v_cvt_pk_bf16_f32 v165, v154, v158
 buffer_store_dwordx2 v[164:165], v13, s[4:7], s72 offen sc1
 s_add_u32 s72, s72, 40960
 v_cvt_pk_bf16_f32 v166, v147, v151
 v_cvt_pk_bf16_f32 v167, v155, v159
 buffer_store_dwordx2 v[166:167], v13, s[4:7], s72 offen sc1
 s_add_u32 s72, s72, 40960
 s_cmp_lt_u32 s70, 640
 s_cbranch_scc1 L_cv_5
 s_setpc_b64 s[76:77]
L_helper:
 s_lshl_b32 s60, s82, 2
 s_add_u32 s60, s60, s50
 s_mov_b32 s72, s60
 s_mov_b32 s8, s16
 s_and_b32 s9, s17, 0xffff
 s_mov_b32 s10, 2621440
 s_mov_b32 s11, 0x00020000
 v_lshlrev_b32 v1, 4, v0
 v_lshlrev_b32 v2, 3, v0
 v_cmp_lt_u32 vcc, 31, v0
 v_mov_b32 v3, 268435456
 s_nop 1
 v_cndmask_b32 v7, v2, v3, vcc
 s_mov_b32 s63, 0x3acccccd
 s_mov_b32 s68, 0x3727c5ac
 s_add_u32 s3, s72, 0
 s_mul_i32 s3, s3, 1280
 buffer_load_dwordx2 v[48:49], v2, s[8:11], s3 offen offset:0
 buffer_load_dwordx2 v[50:51], v2, s[8:11], s3 offen offset:512
 buffer_load_dwordx2 v[52:53], v7, s[8:11], s3 offen offset:1024
 v_mov_b32 v12, 0
 v_mov_b32 v13, 0
 v_mov_b32 v14, 0
 v_mov_b32 v15, 0
 s_lshl_b32 s73, s60, 10
 s_add_u32 s73, s73, 0
L_cl_6:
 s_cmp_ge_u32 s73, 225280
 s_cbranch_scc1 L_cle_7
 buffer_store_dwordx4 v[12:15], v1, s[4:7], s73 offen sc1
 s_add_u32 s73, s73, 393216
 s_branch L_cl_6
L_cle_7:
 s_nop 1
 s_waitcnt vmcnt(0)
L_ln_8:
 v_lshlrev_b32 v12, 16, v48
 v_and_b32 v13, 0xffff0000, v48
 v_lshlrev_b32 v14, 16, v49
 v_and_b32 v15, 0xffff0000, v49
 v_lshlrev_b32 v16, 16, v50
 v_and_b32 v17, 0xffff0000, v50
 v_lshlrev_b32 v18, 16, v51
 v_and_b32 v19, 0xffff0000, v51
 v_lshlrev_b32 v20, 16, v52
 v_and_b32 v21, 0xffff0000, v52
 v_lshlrev_b32 v22, 16, v53
 v_and_b32 v23, 0xffff0000, v53
 s_and_b32 s3, s72, 15
 v_lshrrev_b32 v4, 3, v0
 v_lshlrev_b32 v4, 2, v4
 v_and_b32 v9, 3, v0
 v_add_u32 v4, v4, v9
 v_xor_b32 v4, s3, v4
 v_lshlrev_b32 v4, 4, v4
 v_and_b32 v9, 4, v0
 v_lshl_add_u32 v4, v9, 1, v4
 v_cndmask_b32 v8, v4, v3, vcc
 v_readfirstlane_b32 s3, v12
 s_nop 1
 v_subrev_f32 v36, s3, v12
 v_subrev_f32 v37, s3, v13
 v_subrev_f32 v38, s3, v14
 v_subrev_f32 v39, s3, v15
 v_subrev_f32 v40, s3, v16
 v_subrev_f32 v41, s3, v17
 v_subrev_f32 v42, s3, v18
 v_subrev_f32 v43, s3, v19
 v_mov_b32 v44, 0
 v_mov_b32 v45, 0
 v_mov_b32 v46, 0
 v_mov_b32 v47, 0
 s_mov_b32 exec_hi, 0
 v_subrev_f32 v44, s3, v20
 v_subrev_f32 v45, s3, v21
 v_subrev_f32 v46, s3, v22
 v_subrev_f32 v47, s3, v23
 s_mov_b32 exec_hi, -1
 v_pk_mul_f32 v[10:11], v[36:37], v[36:37]
 v_pk_fma_f32 v[10:11], v[38:39], v[38:39], v[10:11]
 v_pk_fma_f32 v[10:11], v[40:41], v[40:41], v[10:11]
 v_pk_fma_f32 v[10:11], v[42:43], v[42:43], v[10:11]
 v_pk_fma_f32 v[10:11], v[44:45], v[44:45], v[10:11]
 v_pk_fma_f32 v[10:11], v[46:47], v[46:47], v[10:11]
 v_pk_add_f32 v[36:37], v[36:37], v[38:39]
 v_pk_add_f32 v[36:37], v[36:37], v[40:41]
 v_pk_add_f32 v[36:37], v[36:37], v[42:43]
 v_pk_add_f32 v[36:37], v[36:37], v[44:45]
 v_pk_add_f32 v[36:37], v[36:37], v[46:47]
 v_add_f32 v11, v10, v11
 v_add_f32 v10, v36, v37
 s_nop 0
 v_add_f32_dpp v11, v11, v11 quad_perm:[1,0,3,2] row_mask:0xf bank_mask:0xf
 v_add_f32_dpp v10, v10, v10 quad_perm:[1,0,3,2] row_mask:0xf bank_mask:0xf
 s_nop 0
 v_add_f32_dpp v11, v11, v11 quad_perm:[2,3,0,1] row_mask:0xf bank_mask:0xf
 v_add_f32_dpp v10, v10, v10 quad_perm:[2,3,0,1] row_mask:0xf bank_mask:0xf
 s_nop 0
 v_add_f32_dpp v11, v11, v11 row_half_mirror row_mask:0xf bank_mask:0xf
 v_add_f32_dpp v10, v10, v10 row_half_mirror row_mask:0xf bank_mask:0xf
 s_nop 0
 v_add_f32_dpp v11, v11, v11 row_mirror row_mask:0xf bank_mask:0xf
 v_add_f32_dpp v10, v10, v10 row_mirror row_mask:0xf bank_mask:0xf
 v_mov_b32 v37, v11
 v_mov_b32 v36, v10
 s_nop 0
 v_permlane16_swap_b32 v11, v37
 v_permlane16_swap_b32 v10, v36
 v_pk_add_f32 v[10:11], v[10:11], v[36:37]
 v_mov_b32 v37, v11
 v_mov_b32 v36, v10
 s_nop 0
 v_permlane32_swap_b32 v11, v37
 v_permlane32_swap_b32 v10, v36
 v_pk_add_f32 v[10:11], v[10:11], v[36:37]
 v_mul_f32 v10, s63, v10
 v_mul_f32 v11, s63, v11
 v_fma_f32 v11, -v10, v10, v11
 v_max_f32 v11, 0, v11
 v_add_f32 v10, s3, v10
 v_cvt_pk_bf16_f32 v9, v10, v11
 v_lshlrev_b32 v10, 16, v9
 v_and_b32 v11, 0xffff0000, v9
 v_add_f32 v11, s68, v11
 v_cvt_pk_bf16_f32 v11, v11, v11
 v_and_b32 v11, 0xffff0000, v11
 v_sqrt_f32 v11, v11
 s_nop 0
 v_pk_add_f32 v[36:37], v[12:13], v[10:11] op_sel_hi:[1,0] neg_lo:[0,1] neg_hi:[0,1]
 v_pk_add_f32 v[38:39], v[14:15], v[10:11] op_sel_hi:[1,0] neg_lo:[0,1] neg_hi:[0,1]
 v_pk_add_f32 v[40:41], v[16:17], v[10:11] op_sel_hi:[1,0] neg_lo:[0,1] neg_hi:[0,1]
 v_pk_add_f32 v[42:43], v[18:19], v[10:11] op_sel_hi:[1,0] neg_lo:[0,1] neg_hi:[0,1]
 v_pk_add_f32 v[44:45], v[20:21], v[10:11] op_sel_hi:[1,0] neg_lo:[0,1] neg_hi:[0,1]
 v_pk_add_f32 v[46:47], v[22:23], v[10:11] op_sel_hi:[1,0] neg_lo:[0,1] neg_hi:[0,1]
 v_cvt_pk_bf16_f32 v11, v11, v11
 v_and_b32 v11, 0xffff0000, v11
 v_rcp_f32 v11, v11
 v_cvt_pk_bf16_f32 v9, v36, v37
 v_lshlrev_b32 v36, 16, v9
 v_and_b32 v37, 0xffff0000, v9
 v_cvt_pk_bf16_f32 v9, v38, v39
 v_lshlrev_b32 v38, 16, v9
 v_and_b32 v39, 0xffff0000, v9
 v_cvt_pk_bf16_f32 v9, v40, v41
 v_lshlrev_b32 v40, 16, v9
 v_and_b32 v41, 0xffff0000, v9
 v_cvt_pk_bf16_f32 v9, v42, v43
 v_lshlrev_b32 v42, 16, v9
 v_and_b32 v43, 0xffff0000, v9
 v_cvt_pk_bf16_f32 v9, v44, v45
 v_lshlrev_b32 v44, 16, v9
 v_and_b32 v45, 0xffff0000, v9
 v_cvt_pk_bf16_f32 v9, v46, v47
 v_lshlrev_b32 v46, 16, v9
 v_and_b32 v47, 0xffff0000, v9
 v_pk_mul_f32 v[36:37], v[36:37], v[10:11] op_sel:[0,1] op_sel_hi:[1,1]
 v_pk_mul_f32 v[38:39], v[38:39], v[10:11] op_sel:[0,1] op_sel_hi:[1,1]
 v_pk_mul_f32 v[40:41], v[40:41], v[10:11] op_sel:[0,1] op_sel_hi:[1,1]
 v_pk_mul_f32 v[42:43], v[42:43], v[10:11] op_sel:[0,1] op_sel_hi:[1,1]
 v_pk_mul_f32 v[44:45], v[44:45], v[10:11] op_sel:[0,1] op_sel_hi:[1,1]
 v_pk_mul_f32 v[46:47], v[46:47], v[10:11] op_sel:[0,1] op_sel_hi:[1,1]
 v_cvt_pk_bf16_f32 v24, v36, v37
 v_cvt_pk_bf16_f32 v25, v38, v39
 v_cvt_pk_bf16_f32 v26, v40, v41
 v_cvt_pk_bf16_f32 v27, v42, v43
 v_cvt_pk_bf16_f32 v28, v44, v45
 v_cvt_pk_bf16_f32 v29, v46, v47
 s_mul_i32 s3, s72, 1280
 s_add_u32 s3, s3, 226492416
 buffer_store_dwordx2 v[24:25], v4, s[4:7], s3 offen offset:0 sc1
 buffer_store_dwordx2 v[26:27], v4, s[4:7], s3 offen offset:512 sc1
 buffer_store_dwordx2 v[28:29], v8, s[4:7], s3 offen offset:1024 sc1
 s_waitcnt vmcnt(0)
 s_barrier
 s_cmp_lg_u32 s50, 3
 s_cbranch_scc1 L_ar_9
 s_mov_b32 s96, s44
 s_and_b32 s97, s45, 0xffff
 s_mov_b32 s98, 256
 s_mov_b32 s99, 0x00020000
 v_mov_b32 v1, 1
 s_mov_b64 exec, 1
 buffer_atomic_add v1, off, s[96:99], 0 offset:4 sc0
 s_waitcnt vmcnt(0)
 v_cmp_eq_u32 vcc, 95, v1
 s_cbranch_vccz L_aw_10
 buffer_store_dword v1, off, s[96:99], 0 offset:132 sc1
L_aw_10:
 s_mov_b64 exec, -1
L_ar_9:
 s_cmp_lt_u32 s82, 72
 s_cbranch_scc1 L_np_11
 s_sub_u32 s60, s60, 288
 v_lshlrev_b32 v1, 4, v0
 v_mov_b32 v12, 0
 v_mov_b32 v13, 0
 v_mov_b32 v14, 0
 v_mov_b32 v15, 0
 s_lshl_b32 s73, s60, 10
 s_add_u32 s73, s73, 225280
L_cl_12:
 s_cmp_ge_u32 s73, 946176
 s_cbranch_scc1 L_cle_13
 buffer_store_dwordx4 v[12:15], v1, s[4:7], s73 offen sc1
 s_add_u32 s73, s73, 98304
 s_branch L_cl_12
L_cle_13:
 s_nop 1
 v_mov_b32 v12, -1
 v_mov_b32 v13, -1
 v_mov_b32 v14, -1
 v_mov_b32 v15, -1
 s_lshl_b32 s73, s60, 10
 s_add_u32 s73, s73, 983040
L_cl_14:
 s_cmp_ge_u32 s73, 2162688
 s_cbranch_scc1 L_cle_15
 buffer_store_dwordx4 v[12:15], v1, s[4:7], s73 offen sc1
 s_add_u32 s73, s73, 98304
 s_branch L_cl_14
L_cle_15:
 s_nop 1
 s_waitcnt vmcnt(19)
 s_waitcnt vmcnt(0)
 s_barrier
 s_cmp_lg_u32 s50, 3
 s_cbranch_scc1 L_ar_16
 s_mov_b32 s96, s44
 s_and_b32 s97, s45, 0xffff
 s_mov_b32 s98, 256
 s_mov_b32 s99, 0x00020000
 v_mov_b32 v1, 1
 s_mov_b64 exec, 1
 buffer_atomic_add v1, off, s[96:99], 0 offset:84 sc0
 s_waitcnt vmcnt(0)
 v_cmp_eq_u32 vcc, 23, v1
 s_cbranch_vccz L_aw_17
 buffer_store_dword v1, off, s[96:99], 0 offset:212 sc1
L_aw_17:
 s_mov_b64 exec, -1
L_ar_16:
 s_add_u32 s60, s60, 288
 s_cmp_lt_u32 s82, 80
 s_cbranch_scc1 L_np_11
 s_add_u32 s72, s60, 64
 s_mov_b32 s8, s16
 s_and_b32 s9, s17, 0xffff
 s_mov_b32 s10, 2621440
 s_mov_b32 s11, 0x00020000
 v_lshlrev_b32 v1, 4, v0
 v_lshlrev_b32 v2, 3, v0
 v_cmp_lt_u32 vcc, 31, v0
 v_mov_b32 v3, 268435456
 s_nop 1
 v_cndmask_b32 v7, v2, v3, vcc
 s_mov_b32 s63, 0x3acccccd
 s_mov_b32 s68, 0x3727c5ac
 s_add_u32 s3, s72, 0
 s_mul_i32 s3, s3, 1280
 buffer_load_dwordx2 v[48:49], v2, s[8:11], s3 offen offset:0
 buffer_load_dwordx2 v[50:51], v2, s[8:11], s3 offen offset:512
 buffer_load_dwordx2 v[52:53], v7, s[8:11], s3 offen offset:1024
 s_waitcnt vmcnt(0)
L_ln_18:
 v_lshlrev_b32 v12, 16, v48
 v_and_b32 v13, 0xffff0000, v48
 v_lshlrev_b32 v14, 16, v49
 v_and_b32 v15, 0xffff0000, v49
 v_lshlrev_b32 v16, 16, v50
 v_and_b32 v17, 0xffff0000, v50
 v_lshlrev_b32 v18, 16, v51
 v_and_b32 v19, 0xffff0000, v51
 v_lshlrev_b32 v20, 16, v52
 v_and_b32 v21, 0xffff0000, v52
 v_lshlrev_b32 v22, 16, v53
 v_and_b32 v23, 0xffff0000, v53
 s_add_u32 s3, s72, 64
 s_mul_i32 s3, s3, 1280
 buffer_load_dwordx2 v[48:49], v2, s[8:11], s3 offen offset:0
 buffer_load_dwordx2 v[50:51], v2, s[8:11], s3 offen offset:512
 buffer_load_dwordx2 v[52:53], v7, s[8:11], s3 offen offset:1024
 s_and_b32 s3, s72, 15
 v_lshrrev_b32 v4, 3, v0
 v_lshlrev_b32 v4, 2, v4
 v_and_b32 v9, 3, v0
 v_add_u32 v4, v4, v9
 v_xor_b32 v4, s3, v4
 v_lshlrev_b32 v4, 4, v4
 v_and_b32 v9, 4, v0
 v_lshl_add_u32 v4, v9, 1, v4
 v_cndmask_b32 v8, v4, v3, vcc
 v_readfirstlane_b32 s3, v12
 s_nop 1
 v_subrev_f32 v36, s3, v12
 v_subrev_f32 v37, s3, v13
 v_subrev_f32 v38, s3, v14
 v_subrev_f32 v39, s3, v15
 v_subrev_f32 v40, s3, v16
 v_subrev_f32 v41, s3, v17
 v_subrev_f32 v42, s3, v18
 v_subrev_f32 v43, s3, v19
 v_mov_b32 v44, 0
 v_mov_b32 v45, 0
 v_mov_b32 v46, 0
 v_mov_b32 v47, 0
 s_mov_b32 exec_hi, 0
 v_subrev_f32 v44, s3, v20
 v_subrev_f32 v45, s3, v21
 v_subrev_f32 v46, s3, v22
 v_subrev_f32 v47, s3, v23
 s_mov_b32 exec_hi, -1
 v_pk_mul_f32 v[10:11], v[36:37], v[36:37]
 v_pk_fma_f32 v[10:11], v[38:39], v[38:39], v[10:11]
 v_pk_fma_f32 v[10:11], v[40:41], v[40:41], v[10:11]
 v_pk_fma_f32 v[10:11], v[42:43], v[42:43], v[10:11]
 v_pk_fma_f32 v[10:11], v[44:45], v[44:45], v[10:11]
 v_pk_fma_f32 v[10:11], v[46:47], v[46:47], v[10:11]
 v_pk_add_f32 v[36:37], v[36:37], v[38:39]
 v_pk_add_f32 v[36:37], v[36:37], v[40:41]
 v_pk_add_f32 v[36:37], v[36:37], v[42:43]
 v_pk_add_f32 v[36:37], v[36:37], v[44:45]
 v_pk_add_f32 v[36:37], v[36:37], v[46:47]
 v_add_f32 v11, v10, v11
 v_add_f32 v10, v36, v37
 s_nop 0
 v_add_f32_dpp v11, v11, v11 quad_perm:[1,0,3,2] row_mask:0xf bank_mask:0xf
 v_add_f32_dpp v10, v10, v10 quad_perm:[1,0,3,2] row_mask:0xf bank_mask:0xf
 s_nop 0
 v_add_f32_dpp v11, v11, v11 quad_perm:[2,3,0,1] row_mask:0xf bank_mask:0xf
 v_add_f32_dpp v10, v10, v10 quad_perm:[2,3,0,1] row_mask:0xf bank_mask:0xf
 s_nop 0
 v_add_f32_dpp v11, v11, v11 row_half_mirror row_mask:0xf bank_mask:0xf
 v_add_f32_dpp v10, v10, v10 row_half_mirror row_mask:0xf bank_mask:0xf
 s_nop 0
 v_add_f32_dpp v11, v11, v11 row_mirror row_mask:0xf bank_mask:0xf
 v_add_f32_dpp v10, v10, v10 row_mirror row_mask:0xf bank_mask:0xf
 v_mov_b32 v37, v11
 v_mov_b32 v36, v10
 s_nop 0
 v_permlane16_swap_b32 v11, v37
 v_permlane16_swap_b32 v10, v36
 v_pk_add_f32 v[10:11], v[10:11], v[36:37]
 v_mov_b32 v37, v11
 v_mov_b32 v36, v10
 s_nop 0
 v_permlane32_swap_b32 v11, v37
 v_permlane32_swap_b32 v10, v36
 v_pk_add_f32 v[10:11], v[10:11], v[36:37]
 v_mul_f32 v10, s63, v10
 v_mul_f32 v11, s63, v11
 v_fma_f32 v11, -v10, v10, v11
 v_max_f32 v11, 0, v11
 v_add_f32 v10, s3, v10
 v_cvt_pk_bf16_f32 v9, v10, v11
 v_lshlrev_b32 v10, 16, v9
 v_and_b32 v11, 0xffff0000, v9
 v_add_f32 v11, s68, v11
 v_cvt_pk_bf16_f32 v11, v11, v11
 v_and_b32 v11, 0xffff0000, v11
 v_sqrt_f32 v11, v11
 s_nop 0
 v_pk_add_f32 v[36:37], v[12:13], v[10:11] op_sel_hi:[1,0] neg_lo:[0,1] neg_hi:[0,1]
 v_pk_add_f32 v[38:39], v[14:15], v[10:11] op_sel_hi:[1,0] neg_lo:[0,1] neg_hi:[0,1]
 v_pk_add_f32 v[40:41], v[16:17], v[10:11] op_sel_hi:[1,0] neg_lo:[0,1] neg_hi:[0,1]
 v_pk_add_f32 v[42:43], v[18:19], v[10:11] op_sel_hi:[1,0] neg_lo:[0,1] neg_hi:[0,1]
 v_pk_add_f32 v[44:45], v[20:21], v[10:11] op_sel_hi:[1,0] neg_lo:[0,1] neg_hi:[0,1]
 v_pk_add_f32 v[46:47], v[22:23], v[10:11] op_sel_hi:[1,0] neg_lo:[0,1] neg_hi:[0,1]
 v_cvt_pk_bf16_f32 v11, v11, v11
 v_and_b32 v11, 0xffff0000, v11
 v_rcp_f32 v11, v11
 v_cvt_pk_bf16_f32 v9, v36, v37
 v_lshlrev_b32 v36, 16, v9
 v_and_b32 v37, 0xffff0000, v9
 v_cvt_pk_bf16_f32 v9, v38, v39
 v_lshlrev_b32 v38, 16, v9
 v_and_b32 v39, 0xffff0000, v9
 v_cvt_pk_bf16_f32 v9, v40, v41
 v_lshlrev_b32 v40, 16, v9
 v_and_b32 v41, 0xffff0000, v9
 v_cvt_pk_bf16_f32 v9, v42, v43
 v_lshlrev_b32 v42, 16, v9
 v_and_b32 v43, 0xffff0000, v9
 v_cvt_pk_bf16_f32 v9, v44, v45
 v_lshlrev_b32 v44, 16, v9
 v_and_b32 v45, 0xffff0000, v9
 v_cvt_pk_bf16_f32 v9, v46, v47
 v_lshlrev_b32 v46, 16, v9
 v_and_b32 v47, 0xffff0000, v9
 v_pk_mul_f32 v[36:37], v[36:37], v[10:11] op_sel:[0,1] op_sel_hi:[1,1]
 v_pk_mul_f32 v[38:39], v[38:39], v[10:11] op_sel:[0,1] op_sel_hi:[1,1]
 v_pk_mul_f32 v[40:41], v[40:41], v[10:11] op_sel:[0,1] op_sel_hi:[1,1]
 v_pk_mul_f32 v[42:43], v[42:43], v[10:11] op_sel:[0,1] op_sel_hi:[1,1]
 v_pk_mul_f32 v[44:45], v[44:45], v[10:11] op_sel:[0,1] op_sel_hi:[1,1]
 v_pk_mul_f32 v[46:47], v[46:47], v[10:11] op_sel:[0,1] op_sel_hi:[1,1]
 v_cvt_pk_bf16_f32 v24, v36, v37
 v_cvt_pk_bf16_f32 v25, v38, v39
 v_cvt_pk_bf16_f32 v26, v40, v41
 v_cvt_pk_bf16_f32 v27, v42, v43
 v_cvt_pk_bf16_f32 v28, v44, v45
 v_cvt_pk_bf16_f32 v29, v46, v47
 s_mul_i32 s3, s72, 1280
 s_add_u32 s3, s3, 226492416
 buffer_store_dwordx2 v[24:25], v4, s[4:7], s3 offen offset:0 sc1
 buffer_store_dwordx2 v[26:27], v4, s[4:7], s3 offen offset:512 sc1
 buffer_store_dwordx2 v[28:29], v8, s[4:7], s3 offen offset:1024 sc1
 s_add_u32 s72, s72, 64
 s_waitcnt vmcnt(3)
 s_cmp_lt_u32 s72, 1024
 s_cbranch_scc1 L_ln_18
 s_waitcnt vmcnt(0)
 s_barrier
 s_cmp_lg_u32 s50, 3
 s_cbranch_scc1 L_ar_19
 s_mov_b32 s96, s44
 s_and_b32 s97, s45, 0xffff
 s_mov_b32 s98, 256
 s_mov_b32 s99, 0x00020000
 v_mov_b32 v1, 1
 s_mov_b64 exec, 1
 buffer_atomic_add v1, off, s[96:99], 0 offset:72 sc0
 s_waitcnt vmcnt(0)
 v_cmp_eq_u32 vcc, 15, v1
 s_cbranch_vccz L_aw_20
 buffer_store_dword v1, off, s[96:99], 0 offset:200 sc1
L_aw_20:
 s_mov_b64 exec, -1
L_ar_19:
L_help_ln2:
 s_cmp_lg_u32 s50, 0
 s_cbranch_scc1 L_ww_21
 s_mov_b32 s96, s44
 s_and_b32 s97, s45, 0xffff
 s_mov_b32 s98, 256
 s_mov_b32 s99, 0x00020000
 v_mov_b32 v1, 212
 s_mov_b32 s51, 0
 s_mov_b64 exec, 1
L_wb_22:
 buffer_load_dword v2, v1, s[96:99], 0 offen sc1
 s_waitcnt vmcnt(0)
 v_cmp_eq_u32 vcc, 0, v2
 s_cbranch_vccz L_wbd_23
 s_sleep 2
 s_add_u32 s51, s51, 1
 s_cmp_lt_u32 s51, 131072
 s_cbranch_scc1 L_wb_22
 s_branch L_bail
L_wbd_23:
 s_mov_b64 exec, -1
L_ww_21:
 s_barrier
 s_branch L_help_done
L_np_11:
 s_sub_u32 s60, s60, 128
 s_cmp_eq_u32 s83, 1
 s_cbranch_scc1 L_k2_24
 s_add_u32 s3, s60, 288
 s_add_u32 s60, s60, 128
 s_cmp_eq_u32 s83, 0
 s_cselect_b32 s60, s3, s60
L_k2_24:
 s_mov_b32 s8, s32
 s_and_b32 s9, s33, 0xffff
 s_mov_b32 s10, 2621440
 s_mov_b32 s11, 0x00020000
 s_mov_b32 s12, s34
 s_and_b32 s13, s35, 0xffff
 s_mov_b32 s14, 2621440
 s_mov_b32 s15, 0x00020000
 s_mul_i32 s73, s60, 6554
 s_lshr_b32 s73, s73, 16
 s_mul_i32 s3, s73, 10
 s_sub_u32 s74, s60, s3
 s_mul_i32 s69, s73, 81920
 s_lshl_b32 s3, s74, 7
 s_add_u32 s69, s69, s3
 v_lshrrev_b32 v90, 3, v0
 s_mov_b32 s3, 10240
 v_mul_lo_u32 v91, v90, s3
 v_and_b32 v92, 7, v0
 v_lshl_add_u32 v91, v92, 4, v91
 v_add_u32 v91, s69, v91
 v_subrev_u32 v93, 3840, v91
 v_cmp_gt_i32 vcc, 0, v93
 s_nop 1
 v_cndmask_b32 v93, v93, v3, vcc
 buffer_load_dwordx4 v[100:103], v93, s[8:11], 0 offen offset:0
 buffer_load_dwordx4 v[104:107], v93, s[8:11], 0 offen offset:1280
 buffer_load_dwordx4 v[108:111], v93, s[8:11], 0 offen offset:2560
 s_mov_b32 s3, 0
 buffer_load_dwordx4 v[112:115], v91, s[8:11], s3 offen
 buffer_load_dwordx4 v[144:147], v91, s[12:15], s3 offen
 s_mov_b32 s3, 1280
 buffer_load_dwordx4 v[116:119], v91, s[8:11], s3 offen
 buffer_load_dwordx4 v[148:151], v91, s[12:15], s3 offen
 s_mov_b32 s3, 2560
 buffer_load_dwordx4 v[120:123], v91, s[8:11], s3 offen
 buffer_load_dwordx4 v[152:155], v91, s[12:15], s3 offen
 s_mov_b32 s3, 3840
 buffer_load_dwordx4 v[124:127], v91, s[8:11], s3 offen
 buffer_load_dwordx4 v[156:159], v91, s[12:15], s3 offen
 s_mov_b32 s3, 5120
 buffer_load_dwordx4 v[128:131], v91, s[8:11], s3 offen
 buffer_load_dwordx4 v[160:163], v91, s[12:15], s3 offen
 s_mov_b32 s3, 6400
 buffer_load_dwordx4 v[132:135], v91, s[8:11], s3 offen
 buffer_load_dwordx4 v[164:167], v91, s[12:15], s3 offen
 s_mov_b32 s3, 7680
 buffer_load_dwordx4 v[136:139], v91, s[8:11], s3 offen
 buffer_load_dwordx4 v[168:171], v91, s[12:15], s3 offen
 s_mov_b32 s3, 8960
 buffer_load_dwordx4 v[140:143], v91, s[8:11], s3 offen
 buffer_load_dwordx4 v[172:175], v91, s[12:15], s3 offen
 s_mov_b32 s8, s36
 s_and_b32 s9, s37, 0xffff
 s_mov_b32 s10, 5120
 s_mov_b32 s11, 0x00020000
 v_lshlrev_b32 v93, 6, v92
 s_lshl_b32 s3, s74, 9
 buffer_load_dwordx4 v[176:179], v93, s[8:11], s3 offen offset:0
 buffer_load_dwordx4 v[180:183], v93, s[8:11], s3 offen offset:16
 buffer_load_dwordx4 v[184:187], v93, s[8:11], s3 offen offset:32
 buffer_load_dwordx4 v[188:191], v93, s[8:11], s3 offen offset:48
 v_lshlrev_b32 v94, 15, v92
 v_lshl_add_u32 v94, v90, 4, v94
 s_lshl_b32 s70, s74, 18
 s_lshl_b32 s3, s73, 7
 s_add_u32 s70, s70, s3
 s_add_u32 s70, s70, 231735296
 s_waitcnt vmcnt(0)
 v_lshlrev_b32 v12, 16, v100
 v_and_b32 v13, 0xffff0000, v100
 v_lshlrev_b32 v14, 16, v104
 v_and_b32 v15, 0xffff0000, v104
 v_lshlrev_b32 v16, 16, v108
 v_and_b32 v17, 0xffff0000, v108
 v_lshlrev_b32 v18, 16, v112
 v_and_b32 v19, 0xffff0000, v112
 v_lshlrev_b32 v20, 16, v116
 v_and_b32 v21, 0xffff0000, v116
 v_lshlrev_b32 v22, 16, v120
 v_and_b32 v23, 0xffff0000, v120
 v_lshlrev_b32 v24, 16, v124
 v_and_b32 v25, 0xffff0000, v124
 v_lshlrev_b32 v26, 16, v128
 v_and_b32 v27, 0xffff0000, v128
 v_lshlrev_b32 v28, 16, v132
 v_and_b32 v29, 0xffff0000, v132
 v_lshlrev_b32 v30, 16, v136
 v_and_b32 v31, 0xffff0000, v136
 v_lshlrev_b32 v32, 16, v140
 v_and_b32 v33, 0xffff0000, v140
 v_lshlrev_b32 v68, 16, v176
 v_lshlrev_b32 v69, 16, v178
 v_and_b32 v70, 0xffff0000, v176
 v_and_b32 v71, 0xffff0000, v178
 v_lshlrev_b32 v72, 16, v177
 v_lshlrev_b32 v73, 16, v179
 v_and_b32 v74, 0xffff0000, v177
 v_and_b32 v75, 0xffff0000, v179
 v_pk_mul_f32 v[36:37], v[12:13], v[74:75]
 v_pk_mul_f32 v[38:39], v[14:15], v[74:75]
 v_pk_mul_f32 v[40:41], v[16:17], v[74:75]
 v_pk_mul_f32 v[42:43], v[18:19], v[74:75]
 v_pk_mul_f32 v[44:45], v[20:21], v[74:75]
 v_pk_mul_f32 v[46:47], v[22:23], v[74:75]
 v_pk_mul_f32 v[48:49], v[24:25], v[74:75]
 v_pk_mul_f32 v[50:51], v[26:27], v[74:75]
 v_cvt_pk_bf16_f32 v84, v36, v37
 v_lshlrev_b32 v36, 16, v84
 v_and_b32 v37, 0xffff0000, v84
 v_cvt_pk_bf16_f32 v84, v38, v39
 v_lshlrev_b32 v38, 16, v84
 v_and_b32 v39, 0xffff0000, v84
 v_cvt_pk_bf16_f32 v84, v40, v41
 v_lshlrev_b32 v40, 16, v84
 v_and_b32 v41, 0xffff0000, v84
 v_cvt_pk_bf16_f32 v84, v42, v43
 v_lshlrev_b32 v42, 16, v84
 v_and_b32 v43, 0xffff0000, v84
 v_cvt_pk_bf16_f32 v84, v44, v45
 v_lshlrev_b32 v44, 16, v84
 v_and_b32 v45, 0xffff0000, v84
 v_cvt_pk_bf16_f32 v84, v46, v47
 v_lshlrev_b32 v46, 16, v84
 v_and_b32 v47, 0xffff0000, v84
 v_cvt_pk_bf16_f32 v84, v48, v49
 v_lshlrev_b32 v48, 16, v84
 v_and_b32 v49, 0xffff0000, v84
 v_cvt_pk_bf16_f32 v84, v50, v51
 v_lshlrev_b32 v50, 16, v84
 v_and_b32 v51, 0xffff0000, v84
 v_pk_mul_f32 v[52:53], v[14:15], v[72:73]
 v_pk_mul_f32 v[54:55], v[16:17], v[72:73]
 v_pk_mul_f32 v[56:57], v[18:19], v[72:73]
 v_pk_mul_f32 v[58:59], v[20:21], v[72:73]
 v_pk_mul_f32 v[60:61], v[22:23], v[72:73]
 v_pk_mul_f32 v[62:63], v[24:25], v[72:73]
 v_pk_mul_f32 v[64:65], v[26:27], v[72:73]
 v_pk_mul_f32 v[66:67], v[28:29], v[72:73]
 v_cvt_pk_bf16_f32 v84, v52, v53
 v_lshlrev_b32 v52, 16, v84
 v_and_b32 v53, 0xffff0000, v84
 v_cvt_pk_bf16_f32 v84, v54, v55
 v_lshlrev_b32 v54, 16, v84
 v_and_b32 v55, 0xffff0000, v84
 v_cvt_pk_bf16_f32 v84, v56, v57
 v_lshlrev_b32 v56, 16, v84
 v_and_b32 v57, 0xffff0000, v84
 v_cvt_pk_bf16_f32 v84, v58, v59
 v_lshlrev_b32 v58, 16, v84
 v_and_b32 v59, 0xffff0000, v84
 v_cvt_pk_bf16_f32 v84, v60, v61
 v_lshlrev_b32 v60, 16, v84
 v_and_b32 v61, 0xffff0000, v84
 v_cvt_pk_bf16_f32 v84, v62, v63
 v_lshlrev_b32 v62, 16, v84
 v_and_b32 v63, 0xffff0000, v84
 v_cvt_pk_bf16_f32 v84, v64, v65
 v_lshlrev_b32 v64, 16, v84
 v_and_b32 v65, 0xffff0000, v84
 v_cvt_pk_bf16_f32 v84, v66, v67
 v_lshlrev_b32 v66, 16, v84
 v_and_b32 v67, 0xffff0000, v84
 v_pk_add_f32 v[36:37], v[36:37], v[52:53]
 v_pk_add_f32 v[38:39], v[38:39], v[54:55]
 v_pk_add_f32 v[40:41], v[40:41], v[56:57]
 v_pk_add_f32 v[42:43], v[42:43], v[58:59]
 v_pk_add_f32 v[44:45], v[44:45], v[60:61]
 v_pk_add_f32 v[46:47], v[46:47], v[62:63]
 v_pk_add_f32 v[48:49], v[48:49], v[64:65]
 v_pk_add_f32 v[50:51], v[50:51], v[66:67]
 v_cvt_pk_bf16_f32 v84, v36, v37
 v_lshlrev_b32 v36, 16, v84
 v_and_b32 v37, 0xffff0000, v84
 v_cvt_pk_bf16_f32 v84, v38, v39
 v_lshlrev_b32 v38, 16, v84
 v_and_b32 v39, 0xffff0000, v84
 v_cvt_pk_bf16_f32 v84, v40, v41
 v_lshlrev_b32 v40, 16, v84
 v_and_b32 v41, 0xffff0000, v84
 v_cvt_pk_bf16_f32 v84, v42, v43
 v_lshlrev_b32 v42, 16, v84
 v_and_b32 v43, 0xffff0000, v84
 v_cvt_pk_bf16_f32 v84, v44, v45
 v_lshlrev_b32 v44, 16, v84
 v_and_b32 v45, 0xffff0000, v84
 v_cvt_pk_bf16_f32 v84, v46, v47
 v_lshlrev_b32 v46, 16, v84
 v_and_b32 v47, 0xffff0000, v84
 v_cvt_pk_bf16_f32 v84, v48, v49
 v_lshlrev_b32 v48, 16, v84
 v_and_b32 v49, 0xffff0000, v84
 v_cvt_pk_bf16_f32 v84, v50, v51
 v_lshlrev_b32 v50, 16, v84
 v_and_b32 v51, 0xffff0000, v84
 v_pk_mul_f32 v[52:53], v[16:17], v[70:71]
 v_pk_mul_f32 v[54:55], v[18:19], v[70:71]
 v_pk_mul_f32 v[56:57], v[20:21], v[70:71]
 v_pk_mul_f32 v[58:59], v[22:23], v[70:71]
 v_pk_mul_f32 v[60:61], v[24:25], v[70:71]
 v_pk_mul_f32 v[62:63], v[26:27], v[70:71]
 v_pk_mul_f32 v[64:65], v[28:29], v[70:71]
 v_pk_mul_f32 v[66:67], v[30:31], v[70:71]
 v_cvt_pk_bf16_f32 v84, v52, v53
 v_lshlrev_b32 v52, 16, v84
 v_and_b32 v53, 0xffff0000, v84
 v_cvt_pk_bf16_f32 v84, v54, v55
 v_lshlrev_b32 v54, 16, v84
 v_and_b32 v55, 0xffff0000, v84
 v_cvt_pk_bf16_f32 v84, v56, v57
 v_lshlrev_b32 v56, 16, v84
 v_and_b32 v57, 0xffff0000, v84
 v_cvt_pk_bf16_f32 v84, v58, v59
 v_lshlrev_b32 v58, 16, v84
 v_and_b32 v59, 0xffff0000, v84
 v_cvt_pk_bf16_f32 v84, v60, v61
 v_lshlrev_b32 v60, 16, v84
 v_and_b32 v61, 0xffff0000, v84
 v_cvt_pk_bf16_f32 v84, v62, v63
 v_lshlrev_b32 v62, 16, v84
 v_and_b32 v63, 0xffff0000, v84
 v_cvt_pk_bf16_f32 v84, v64, v65
 v_lshlrev_b32 v64, 16, v84
 v_and_b32 v65, 0xffff0000, v84
 v_cvt_pk_bf16_f32 v84, v66, v67
 v_lshlrev_b32 v66, 16, v84
 v_and_b32 v67, 0xffff0000, v84
 v_pk_add_f32 v[36:37], v[36:37], v[52:53]
 v_pk_add_f32 v[38:39], v[38:39], v[54:55]
 v_pk_add_f32 v[40:41], v[40:41], v[56:57]
 v_pk_add_f32 v[42:43], v[42:43], v[58:59]
 v_pk_add_f32 v[44:45], v[44:45], v[60:61]
 v_pk_add_f32 v[46:47], v[46:47], v[62:63]
 v_pk_add_f32 v[48:49], v[48:49], v[64:65]
 v_pk_add_f32 v[50:51], v[50:51], v[66:67]
 v_cvt_pk_bf16_f32 v84, v36, v37
 v_lshlrev_b32 v36, 16, v84
 v_and_b32 v37, 0xffff0000, v84
 v_cvt_pk_bf16_f32 v84, v38, v39
 v_lshlrev_b32 v38, 16, v84
 v_and_b32 v39, 0xffff0000, v84
 v_cvt_pk_bf16_f32 v84, v40, v41
 v_lshlrev_b32 v40, 16, v84
 v_and_b32 v41, 0xffff0000, v84
 v_cvt_pk_bf16_f32 v84, v42, v43
 v_lshlrev_b32 v42, 16, v84
 v_and_b32 v43, 0xffff0000, v84
 v_cvt_pk_bf16_f32 v84, v44, v45
 v_lshlrev_b32 v44, 16, v84
 v_and_b32 v45, 0xffff0000, v84
 v_cvt_pk_bf16_f32 v84, v46, v47
 v_lshlrev_b32 v46, 16, v84
 v_and_b32 v47, 0xffff0000, v84
 v_cvt_pk_bf16_f32 v84, v48, v49
 v_lshlrev_b32 v48, 16, v84
 v_and_b32 v49, 0xffff0000, v84
 v_cvt_pk_bf16_f32 v84, v50, v51
 v_lshlrev_b32 v50, 16, v84
 v_and_b32 v51, 0xffff0000, v84
 v_pk_mul_f32 v[52:53], v[18:19], v[68:69]
 v_pk_mul_f32 v[54:55], v[20:21], v[68:69]
 v_pk_mul_f32 v[56:57], v[22:23], v[68:69]
 v_pk_mul_f32 v[58:59], v[24:25], v[68:69]
 v_pk_mul_f32 v[60:61], v[26:27], v[68:69]
 v_pk_mul_f32 v[62:63], v[28:29], v[68:69]
 v_pk_mul_f32 v[64:65], v[30:31], v[68:69]
 v_pk_mul_f32 v[66:67], v[32:33], v[68:69]
 v_cvt_pk_bf16_f32 v84, v52, v53
 v_lshlrev_b32 v52, 16, v84
 v_and_b32 v53, 0xffff0000, v84
 v_cvt_pk_bf16_f32 v84, v54, v55
 v_lshlrev_b32 v54, 16, v84
 v_and_b32 v55, 0xffff0000, v84
 v_cvt_pk_bf16_f32 v84, v56, v57
 v_lshlrev_b32 v56, 16, v84
 v_and_b32 v57, 0xffff0000, v84
 v_cvt_pk_bf16_f32 v84, v58, v59
 v_lshlrev_b32 v58, 16, v84
 v_and_b32 v59, 0xffff0000, v84
 v_cvt_pk_bf16_f32 v84, v60, v61
 v_lshlrev_b32 v60, 16, v84
 v_and_b32 v61, 0xffff0000, v84
 v_cvt_pk_bf16_f32 v84, v62, v63
 v_lshlrev_b32 v62, 16, v84
 v_and_b32 v63, 0xffff0000, v84
 v_cvt_pk_bf16_f32 v84, v64, v65
 v_lshlrev_b32 v64, 16, v84
 v_and_b32 v65, 0xffff0000, v84
 v_cvt_pk_bf16_f32 v84, v66, v67
 v_lshlrev_b32 v66, 16, v84
 v_and_b32 v67, 0xffff0000, v84
 v_pk_add_f32 v[36:37], v[36:37], v[52:53]
 v_pk_add_f32 v[38:39], v[38:39], v[54:55]
 v_pk_add_f32 v[40:41], v[40:41], v[56:57]
 v_pk_add_f32 v[42:43], v[42:43], v[58:59]
 v_pk_add_f32 v[44:45], v[44:45], v[60:61]
 v_pk_add_f32 v[46:47], v[46:47], v[62:63]
 v_pk_add_f32 v[48:49], v[48:49], v[64:65]
 v_pk_add_f32 v[50:51], v[50:51], v[66:67]
 v_cvt_pk_bf16_f32 v84, v36, v37
 v_lshlrev_b32 v36, 16, v84
 v_and_b32 v37, 0xffff0000, v84
 v_cvt_pk_bf16_f32 v84, v38, v39
 v_lshlrev_b32 v38, 16, v84
 v_and_b32 v39, 0xffff0000, v84
 v_cvt_pk_bf16_f32 v84, v40, v41
 v_lshlrev_b32 v40, 16, v84
 v_and_b32 v41, 0xffff0000, v84
 v_cvt_pk_bf16_f32 v84, v42, v43
 v_lshlrev_b32 v42, 16, v84
 v_and_b32 v43, 0xffff0000, v84
 v_cvt_pk_bf16_f32 v84, v44, v45
 v_lshlrev_b32 v44, 16, v84
 v_and_b32 v45, 0xffff0000, v84
 v_cvt_pk_bf16_f32 v84, v46, v47
 v_lshlrev_b32 v46, 16, v84
 v_and_b32 v47, 0xffff0000, v84
 v_cvt_pk_bf16_f32 v84, v48, v49
 v_lshlrev_b32 v48, 16, v84
 v_and_b32 v49, 0xffff0000, v84
 v_cvt_pk_bf16_f32 v84, v50, v51
 v_lshlrev_b32 v50, 16, v84
 v_and_b32 v51, 0xffff0000, v84
 v_lshlrev_b32 v12, 16, v144
 v_and_b32 v13, 0xffff0000, v144
 v_lshlrev_b32 v14, 16, v148
 v_and_b32 v15, 0xffff0000, v148
 v_lshlrev_b32 v16, 16, v152
 v_and_b32 v17, 0xffff0000, v152
 v_lshlrev_b32 v18, 16, v156
 v_and_b32 v19, 0xffff0000, v156
 v_lshlrev_b32 v20, 16, v160
 v_and_b32 v21, 0xffff0000, v160
 v_lshlrev_b32 v22, 16, v164
 v_and_b32 v23, 0xffff0000, v164
 v_lshlrev_b32 v24, 16, v168
 v_and_b32 v25, 0xffff0000, v168
 v_lshlrev_b32 v26, 16, v172
 v_and_b32 v27, 0xffff0000, v172
 v_pk_mul_f32 v[36:37], v[36:37], v[12:13]
 v_pk_mul_f32 v[38:39], v[38:39], v[14:15]
 v_pk_mul_f32 v[40:41], v[40:41], v[16:17]
 v_pk_mul_f32 v[42:43], v[42:43], v[18:19]
 v_pk_mul_f32 v[44:45], v[44:45], v[20:21]
 v_pk_mul_f32 v[46:47], v[46:47], v[22:23]
 v_pk_mul_f32 v[48:49], v[48:49], v[24:25]
 v_pk_mul_f32 v[50:51], v[50:51], v[26:27]
 v_cvt_pk_bf16_f32 v76, v50, v48
 v_cvt_pk_bf16_f32 v77, v46, v44
 v_cvt_pk_bf16_f32 v78, v42, v40
 v_cvt_pk_bf16_f32 v79, v38, v36
 s_add_u32 s3, s70, 0
 buffer_store_dwordx4 v[76:79], v94, s[4:7], s3 offen sc1
 v_cvt_pk_bf16_f32 v80, v51, v49
 v_cvt_pk_bf16_f32 v81, v47, v45
 v_cvt_pk_bf16_f32 v82, v43, v41
 v_cvt_pk_bf16_f32 v83, v39, v37
 s_add_u32 s3, s70, 4096
 buffer_store_dwordx4 v[80:83], v94, s[4:7], s3 offen sc1
 v_lshlrev_b32 v12, 16, v101
 v_and_b32 v13, 0xffff0000, v101
 v_lshlrev_b32 v14, 16, v105
 v_and_b32 v15, 0xffff0000, v105
 v_lshlrev_b32 v16, 16, v109
 v_and_b32 v17, 0xffff0000, v109
 v_lshlrev_b32 v18, 16, v113
 v_and_b32 v19, 0xffff0000, v113
 v_lshlrev_b32 v20, 16, v117
 v_and_b32 v21, 0xffff0000, v117
 v_lshlrev_b32 v22, 16, v121
 v_and_b32 v23, 0xffff0000, v121
 v_lshlrev_b32 v24, 16, v125
 v_and_b32 v25, 0xffff0000, v125
 v_lshlrev_b32 v26, 16, v129
 v_and_b32 v27, 0xffff0000, v129
 v_lshlrev_b32 v28, 16, v133
 v_and_b32 v29, 0xffff0000, v133
 v_lshlrev_b32 v30, 16, v137
 v_and_b32 v31, 0xffff0000, v137
 v_lshlrev_b32 v32, 16, v141
 v_and_b32 v33, 0xffff0000, v141
 v_lshlrev_b32 v68, 16, v180
 v_lshlrev_b32 v69, 16, v182
 v_and_b32 v70, 0xffff0000, v180
 v_and_b32 v71, 0xffff0000, v182
 v_lshlrev_b32 v72, 16, v181
 v_lshlrev_b32 v73, 16, v183
 v_and_b32 v74, 0xffff0000, v181
 v_and_b32 v75, 0xffff0000, v183
 v_pk_mul_f32 v[36:37], v[12:13], v[74:75]
 v_pk_mul_f32 v[38:39], v[14:15], v[74:75]
 v_pk_mul_f32 v[40:41], v[16:17], v[74:75]
 v_pk_mul_f32 v[42:43], v[18:19], v[74:75]
 v_pk_mul_f32 v[44:45], v[20:21], v[74:75]
 v_pk_mul_f32 v[46:47], v[22:23], v[74:75]
 v_pk_mul_f32 v[48:49], v[24:25], v[74:75]
 v_pk_mul_f32 v[50:51], v[26:27], v[74:75]
 v_cvt_pk_bf16_f32 v84, v36, v37
 v_lshlrev_b32 v36, 16, v84
 v_and_b32 v37, 0xffff0000, v84
 v_cvt_pk_bf16_f32 v84, v38, v39
 v_lshlrev_b32 v38, 16, v84
 v_and_b32 v39, 0xffff0000, v84
 v_cvt_pk_bf16_f32 v84, v40, v41
 v_lshlrev_b32 v40, 16, v84
 v_and_b32 v41, 0xffff0000, v84
 v_cvt_pk_bf16_f32 v84, v42, v43
 v_lshlrev_b32 v42, 16, v84
 v_and_b32 v43, 0xffff0000, v84
 v_cvt_pk_bf16_f32 v84, v44, v45
 v_lshlrev_b32 v44, 16, v84
 v_and_b32 v45, 0xffff0000, v84
 v_cvt_pk_bf16_f32 v84, v46, v47
 v_lshlrev_b32 v46, 16, v84
 v_and_b32 v47, 0xffff0000, v84
 v_cvt_pk_bf16_f32 v84, v48, v49
 v_lshlrev_b32 v48, 16, v84
 v_and_b32 v49, 0xffff0000, v84
 v_cvt_pk_bf16_f32 v84, v50, v51
 v_lshlrev_b32 v50, 16, v84
 v_and_b32 v51, 0xffff0000, v84
 v_pk_mul_f32 v[52:53], v[14:15], v[72:73]
 v_pk_mul_f32 v[54:55], v[16:17], v[72:73]
 v_pk_mul_f32 v[56:57], v[18:19], v[72:73]
 v_pk_mul_f32 v[58:59], v[20:21], v[72:73]
 v_pk_mul_f32 v[60:61], v[22:23], v[72:73]
 v_pk_mul_f32 v[62:63], v[24:25], v[72:73]
 v_pk_mul_f32 v[64:65], v[26:27], v[72:73]
 v_pk_mul_f32 v[66:67], v[28:29], v[72:73]
 v_cvt_pk_bf16_f32 v84, v52, v53
 v_lshlrev_b32 v52, 16, v84
 v_and_b32 v53, 0xffff0000, v84
 v_cvt_pk_bf16_f32 v84, v54, v55
 v_lshlrev_b32 v54, 16, v84
 v_and_b32 v55, 0xffff0000, v84
 v_cvt_pk_bf16_f32 v84, v56, v57
 v_lshlrev_b32 v56, 16, v84
 v_and_b32 v57, 0xffff0000, v84
 v_cvt_pk_bf16_f32 v84, v58, v59
 v_lshlrev_b32 v58, 16, v84
 v_and_b32 v59, 0xffff0000, v84
 v_cvt_pk_bf16_f32 v84, v60, v61
 v_lshlrev_b32 v60, 16, v84
 v_and_b32 v61, 0xffff0000, v84
 v_cvt_pk_bf16_f32 v84, v62, v63
 v_lshlrev_b32 v62, 16, v84
 v_and_b32 v63, 0xffff0000, v84
 v_cvt_pk_bf16_f32 v84, v64, v65
 v_lshlrev_b32 v64, 16, v84
 v_and_b32 v65, 0xffff0000, v84
 v_cvt_pk_bf16_f32 v84, v66, v67
 v_lshlrev_b32 v66, 16, v84
 v_and_b32 v67, 0xffff0000, v84
 v_pk_add_f32 v[36:37], v[36:37], v[52:53]
 v_pk_add_f32 v[38:39], v[38:39], v[54:55]
 v_pk_add_f32 v[40:41], v[40:41], v[56:57]
 v_pk_add_f32 v[42:43], v[42:43], v[58:59]
 v_pk_add_f32 v[44:45], v[44:45], v[60:61]
 v_pk_add_f32 v[46:47], v[46:47], v[62:63]
 v_pk_add_f32 v[48:49], v[48:49], v[64:65]
 v_pk_add_f32 v[50:51], v[50:51], v[66:67]
 v_cvt_pk_bf16_f32 v84, v36, v37
 v_lshlrev_b32 v36, 16, v84
 v_and_b32 v37, 0xffff0000, v84
 v_cvt_pk_bf16_f32 v84, v38, v39
 v_lshlrev_b32 v38, 16, v84
 v_and_b32 v39, 0xffff0000, v84
 v_cvt_pk_bf16_f32 v84, v40, v41
 v_lshlrev_b32 v40, 16, v84
 v_and_b32 v41, 0xffff0000, v84
 v_cvt_pk_bf16_f32 v84, v42, v43
 v_lshlrev_b32 v42, 16, v84
 v_and_b32 v43, 0xffff0000, v84
 v_cvt_pk_bf16_f32 v84, v44, v45
 v_lshlrev_b32 v44, 16, v84
 v_and_b32 v45, 0xffff0000, v84
 v_cvt_pk_bf16_f32 v84, v46, v47
 v_lshlrev_b32 v46, 16, v84
 v_and_b32 v47, 0xffff0000, v84
 v_cvt_pk_bf16_f32 v84, v48, v49
 v_lshlrev_b32 v48, 16, v84
 v_and_b32 v49, 0xffff0000, v84
 v_cvt_pk_bf16_f32 v84, v50, v51
 v_lshlrev_b32 v50, 16, v84
 v_and_b32 v51, 0xffff0000, v84
 v_pk_mul_f32 v[52:53], v[16:17], v[70:71]
 v_pk_mul_f32 v[54:55], v[18:19], v[70:71]
 v_pk_mul_f32 v[56:57], v[20:21], v[70:71]
 v_pk_mul_f32 v[58:59], v[22:23], v[70:71]
 v_pk_mul_f32 v[60:61], v[24:25], v[70:71]
 v_pk_mul_f32 v[62:63], v[26:27], v[70:71]
 v_pk_mul_f32 v[64:65], v[28:29], v[70:71]
 v_pk_mul_f32 v[66:67], v[30:31], v[70:71]
 v_cvt_pk_bf16_f32 v84, v52, v53
 v_lshlrev_b32 v52, 16, v84
 v_and_b32 v53, 0xffff0000, v84
 v_cvt_pk_bf16_f32 v84, v54, v55
 v_lshlrev_b32 v54, 16, v84
 v_and_b32 v55, 0xffff0000, v84
 v_cvt_pk_bf16_f32 v84, v56, v57
 v_lshlrev_b32 v56, 16, v84
 v_and_b32 v57, 0xffff0000, v84
 v_cvt_pk_bf16_f32 v84, v58, v59
 v_lshlrev_b32 v58, 16, v84
 v_and_b32 v59, 0xffff0000, v84
 v_cvt_pk_bf16_f32 v84, v60, v61
 v_lshlrev_b32 v60, 16, v84
 v_and_b32 v61, 0xffff0000, v84
 v_cvt_pk_bf16_f32 v84, v62, v63
 v_lshlrev_b32 v62, 16, v84
 v_and_b32 v63, 0xffff0000, v84
 v_cvt_pk_bf16_f32 v84, v64, v65
 v_lshlrev_b32 v64, 16, v84
 v_and_b32 v65, 0xffff0000, v84
 v_cvt_pk_bf16_f32 v84, v66, v67
 v_lshlrev_b32 v66, 16, v84
 v_and_b32 v67, 0xffff0000, v84
 v_pk_add_f32 v[36:37], v[36:37], v[52:53]
 v_pk_add_f32 v[38:39], v[38:39], v[54:55]
 v_pk_add_f32 v[40:41], v[40:41], v[56:57]
 v_pk_add_f32 v[42:43], v[42:43], v[58:59]
 v_pk_add_f32 v[44:45], v[44:45], v[60:61]
 v_pk_add_f32 v[46:47], v[46:47], v[62:63]
 v_pk_add_f32 v[48:49], v[48:49], v[64:65]
 v_pk_add_f32 v[50:51], v[50:51], v[66:67]
 v_cvt_pk_bf16_f32 v84, v36, v37
 v_lshlrev_b32 v36, 16, v84
 v_and_b32 v37, 0xffff0000, v84
 v_cvt_pk_bf16_f32 v84, v38, v39
 v_lshlrev_b32 v38, 16, v84
 v_and_b32 v39, 0xffff0000, v84
 v_cvt_pk_bf16_f32 v84, v40, v41
 v_lshlrev_b32 v40, 16, v84
 v_and_b32 v41, 0xffff0000, v84
 v_cvt_pk_bf16_f32 v84, v42, v43
 v_lshlrev_b32 v42, 16, v84
 v_and_b32 v43, 0xffff0000, v84
 v_cvt_pk_bf16_f32 v84, v44, v45
 v_lshlrev_b32 v44, 16, v84
 v_and_b32 v45, 0xffff0000, v84
 v_cvt_pk_bf16_f32 v84, v46, v47
 v_lshlrev_b32 v46, 16, v84
 v_and_b32 v47, 0xffff0000, v84
 v_cvt_pk_bf16_f32 v84, v48, v49
 v_lshlrev_b32 v48, 16, v84
 v_and_b32 v49, 0xffff0000, v84
 v_cvt_pk_bf16_f32 v84, v50, v51
 v_lshlrev_b32 v50, 16, v84
 v_and_b32 v51, 0xffff0000, v84
 v_pk_mul_f32 v[52:53], v[18:19], v[68:69]
 v_pk_mul_f32 v[54:55], v[20:21], v[68:69]
 v_pk_mul_f32 v[56:57], v[22:23], v[68:69]
 v_pk_mul_f32 v[58:59], v[24:25], v[68:69]
 v_pk_mul_f32 v[60:61], v[26:27], v[68:69]
 v_pk_mul_f32 v[62:63], v[28:29], v[68:69]
 v_pk_mul_f32 v[64:65], v[30:31], v[68:69]
 v_pk_mul_f32 v[66:67], v[32:33], v[68:69]
 v_cvt_pk_bf16_f32 v84, v52, v53
 v_lshlrev_b32 v52, 16, v84
 v_and_b32 v53, 0xffff0000, v84
 v_cvt_pk_bf16_f32 v84, v54, v55
 v_lshlrev_b32 v54, 16, v84
 v_and_b32 v55, 0xffff0000, v84
 v_cvt_pk_bf16_f32 v84, v56, v57
 v_lshlrev_b32 v56, 16, v84
 v_and_b32 v57, 0xffff0000, v84
 v_cvt_pk_bf16_f32 v84, v58, v59
 v_lshlrev_b32 v58, 16, v84
 v_and_b32 v59, 0xffff0000, v84
 v_cvt_pk_bf16_f32 v84, v60, v61
 v_lshlrev_b32 v60, 16, v84
 v_and_b32 v61, 0xffff0000, v84
 v_cvt_pk_bf16_f32 v84, v62, v63
 v_lshlrev_b32 v62, 16, v84
 v_and_b32 v63, 0xffff0000, v84
 v_cvt_pk_bf16_f32 v84, v64, v65
 v_lshlrev_b32 v64, 16, v84
 v_and_b32 v65, 0xffff0000, v84
 v_cvt_pk_bf16_f32 v84, v66, v67
 v_lshlrev_b32 v66, 16, v84
 v_and_b32 v67, 0xffff0000, v84
 v_pk_add_f32 v[36:37], v[36:37], v[52:53]
 v_pk_add_f32 v[38:39], v[38:39], v[54:55]
 v_pk_add_f32 v[40:41], v[40:41], v[56:57]
 v_pk_add_f32 v[42:43], v[42:43], v[58:59]
 v_pk_add_f32 v[44:45], v[44:45], v[60:61]
 v_pk_add_f32 v[46:47], v[46:47], v[62:63]
 v_pk_add_f32 v[48:49], v[48:49], v[64:65]
 v_pk_add_f32 v[50:51], v[50:51], v[66:67]
 v_cvt_pk_bf16_f32 v84, v36, v37
 v_lshlrev_b32 v36, 16, v84
 v_and_b32 v37, 0xffff0000, v84
 v_cvt_pk_bf16_f32 v84, v38, v39
 v_lshlrev_b32 v38, 16, v84
 v_and_b32 v39, 0xffff0000, v84
 v_cvt_pk_bf16_f32 v84, v40, v41
 v_lshlrev_b32 v40, 16, v84
 v_and_b32 v41, 0xffff0000, v84
 v_cvt_pk_bf16_f32 v84, v42, v43
 v_lshlrev_b32 v42, 16, v84
 v_and_b32 v43, 0xffff0000, v84
 v_cvt_pk_bf16_f32 v84, v44, v45
 v_lshlrev_b32 v44, 16, v84
 v_and_b32 v45, 0xffff0000, v84
 v_cvt_pk_bf16_f32 v84, v46, v47
 v_lshlrev_b32 v46, 16, v84
 v_and_b32 v47, 0xffff0000, v84
 v_cvt_pk_bf16_f32 v84, v48, v49
 v_lshlrev_b32 v48, 16, v84
 v_and_b32 v49, 0xffff0000, v84
 v_cvt_pk_bf16_f32 v84, v50, v51
 v_lshlrev_b32 v50, 16, v84
 v_and_b32 v51, 0xffff0000, v84
 v_lshlrev_b32 v12, 16, v145
 v_and_b32 v13, 0xffff0000, v145
 v_lshlrev_b32 v14, 16, v149
 v_and_b32 v15, 0xffff0000, v149
 v_lshlrev_b32 v16, 16, v153
 v_and_b32 v17, 0xffff0000, v153
 v_lshlrev_b32 v18, 16, v157
 v_and_b32 v19, 0xffff0000, v157
 v_lshlrev_b32 v20, 16, v161
 v_and_b32 v21, 0xffff0000, v161
 v_lshlrev_b32 v22, 16, v165
 v_and_b32 v23, 0xffff0000, v165
 v_lshlrev_b32 v24, 16, v169
 v_and_b32 v25, 0xffff0000, v169
 v_lshlrev_b32 v26, 16, v173
 v_and_b32 v27, 0xffff0000, v173
 v_pk_mul_f32 v[36:37], v[36:37], v[12:13]
 v_pk_mul_f32 v[38:39], v[38:39], v[14:15]
 v_pk_mul_f32 v[40:41], v[40:41], v[16:17]
 v_pk_mul_f32 v[42:43], v[42:43], v[18:19]
 v_pk_mul_f32 v[44:45], v[44:45], v[20:21]
 v_pk_mul_f32 v[46:47], v[46:47], v[22:23]
 v_pk_mul_f32 v[48:49], v[48:49], v[24:25]
 v_pk_mul_f32 v[50:51], v[50:51], v[26:27]
 v_cvt_pk_bf16_f32 v76, v50, v48
 v_cvt_pk_bf16_f32 v77, v46, v44
 v_cvt_pk_bf16_f32 v78, v42, v40
 v_cvt_pk_bf16_f32 v79, v38, v36
 s_add_u32 s3, s70, 8192
 buffer_store_dwordx4 v[76:79], v94, s[4:7], s3 offen sc1
 v_cvt_pk_bf16_f32 v80, v51, v49
 v_cvt_pk_bf16_f32 v81, v47, v45
 v_cvt_pk_bf16_f32 v82, v43, v41
 v_cvt_pk_bf16_f32 v83, v39, v37
 s_add_u32 s3, s70, 12288
 buffer_store_dwordx4 v[80:83], v94, s[4:7], s3 offen sc1
 v_lshlrev_b32 v12, 16, v102
 v_and_b32 v13, 0xffff0000, v102
 v_lshlrev_b32 v14, 16, v106
 v_and_b32 v15, 0xffff0000, v106
 v_lshlrev_b32 v16, 16, v110
 v_and_b32 v17, 0xffff0000, v110
 v_lshlrev_b32 v18, 16, v114
 v_and_b32 v19, 0xffff0000, v114
 v_lshlrev_b32 v20, 16, v118
 v_and_b32 v21, 0xffff0000, v118
 v_lshlrev_b32 v22, 16, v122
 v_and_b32 v23, 0xffff0000, v122
 v_lshlrev_b32 v24, 16, v126
 v_and_b32 v25, 0xffff0000, v126
 v_lshlrev_b32 v26, 16, v130
 v_and_b32 v27, 0xffff0000, v130
 v_lshlrev_b32 v28, 16, v134
 v_and_b32 v29, 0xffff0000, v134
 v_lshlrev_b32 v30, 16, v138
 v_and_b32 v31, 0xffff0000, v138
 v_lshlrev_b32 v32, 16, v142
 v_and_b32 v33, 0xffff0000, v142
 v_lshlrev_b32 v68, 16, v184
 v_lshlrev_b32 v69, 16, v186
 v_and_b32 v70, 0xffff0000, v184
 v_and_b32 v71, 0xffff0000, v186
 v_lshlrev_b32 v72, 16, v185
 v_lshlrev_b32 v73, 16, v187
 v_and_b32 v74, 0xffff0000, v185
 v_and_b32 v75, 0xffff0000, v187
 v_pk_mul_f32 v[36:37], v[12:13], v[74:75]
 v_pk_mul_f32 v[38:39], v[14:15], v[74:75]
 v_pk_mul_f32 v[40:41], v[16:17], v[74:75]
 v_pk_mul_f32 v[42:43], v[18:19], v[74:75]
 v_pk_mul_f32 v[44:45], v[20:21], v[74:75]
 v_pk_mul_f32 v[46:47], v[22:23], v[74:75]
 v_pk_mul_f32 v[48:49], v[24:25], v[74:75]
 v_pk_mul_f32 v[50:51], v[26:27], v[74:75]
 v_cvt_pk_bf16_f32 v84, v36, v37
 v_lshlrev_b32 v36, 16, v84
 v_and_b32 v37, 0xffff0000, v84
 v_cvt_pk_bf16_f32 v84, v38, v39
 v_lshlrev_b32 v38, 16, v84
 v_and_b32 v39, 0xffff0000, v84
 v_cvt_pk_bf16_f32 v84, v40, v41
 v_lshlrev_b32 v40, 16, v84
 v_and_b32 v41, 0xffff0000, v84
 v_cvt_pk_bf16_f32 v84, v42, v43
 v_lshlrev_b32 v42, 16, v84
 v_and_b32 v43, 0xffff0000, v84
 v_cvt_pk_bf16_f32 v84, v44, v45
 v_lshlrev_b32 v44, 16, v84
 v_and_b32 v45, 0xffff0000, v84
 v_cvt_pk_bf16_f32 v84, v46, v47
 v_lshlrev_b32 v46, 16, v84
 v_and_b32 v47, 0xffff0000, v84
 v_cvt_pk_bf16_f32 v84, v48, v49
 v_lshlrev_b32 v48, 16, v84
 v_and_b32 v49, 0xffff0000, v84
 v_cvt_pk_bf16_f32 v84, v50, v51
 v_lshlrev_b32 v50, 16, v84
 v_and_b32 v51, 0xffff0000, v84
 v_pk_mul_f32 v[52:53], v[14:15], v[72:73]
 v_pk_mul_f32 v[54:55], v[16:17], v[72:73]
 v_pk_mul_f32 v[56:57], v[18:19], v[72:73]
 v_pk_mul_f32 v[58:59], v[20:21], v[72:73]
 v_pk_mul_f32 v[60:61], v[22:23], v[72:73]
 v_pk_mul_f32 v[62:63], v[24:25], v[72:73]
 v_pk_mul_f32 v[64:65], v[26:27], v[72:73]
 v_pk_mul_f32 v[66:67], v[28:29], v[72:73]
 v_cvt_pk_bf16_f32 v84, v52, v53
 v_lshlrev_b32 v52, 16, v84
 v_and_b32 v53, 0xffff0000, v84
 v_cvt_pk_bf16_f32 v84, v54, v55
 v_lshlrev_b32 v54, 16, v84
 v_and_b32 v55, 0xffff0000, v84
 v_cvt_pk_bf16_f32 v84, v56, v57
 v_lshlrev_b32 v56, 16, v84
 v_and_b32 v57, 0xffff0000, v84
 v_cvt_pk_bf16_f32 v84, v58, v59
 v_lshlrev_b32 v58, 16, v84
 v_and_b32 v59, 0xffff0000, v84
 v_cvt_pk_bf16_f32 v84, v60, v61
 v_lshlrev_b32 v60, 16, v84
 v_and_b32 v61, 0xffff0000, v84
 v_cvt_pk_bf16_f32 v84, v62, v63
 v_lshlrev_b32 v62, 16, v84
 v_and_b32 v63, 0xffff0000, v84
 v_cvt_pk_bf16_f32 v84, v64, v65
 v_lshlrev_b32 v64, 16, v84
 v_and_b32 v65, 0xffff0000, v84
 v_cvt_pk_bf16_f32 v84, v66, v67
 v_lshlrev_b32 v66, 16, v84
 v_and_b32 v67, 0xffff0000, v84
 v_pk_add_f32 v[36:37], v[36:37], v[52:53]
 v_pk_add_f32 v[38:39], v[38:39], v[54:55]
 v_pk_add_f32 v[40:41], v[40:41], v[56:57]
 v_pk_add_f32 v[42:43], v[42:43], v[58:59]
 v_pk_add_f32 v[44:45], v[44:45], v[60:61]
 v_pk_add_f32 v[46:47], v[46:47], v[62:63]
 v_pk_add_f32 v[48:49], v[48:49], v[64:65]
 v_pk_add_f32 v[50:51], v[50:51], v[66:67]
 v_cvt_pk_bf16_f32 v84, v36, v37
 v_lshlrev_b32 v36, 16, v84
 v_and_b32 v37, 0xffff0000, v84
 v_cvt_pk_bf16_f32 v84, v38, v39
 v_lshlrev_b32 v38, 16, v84
 v_and_b32 v39, 0xffff0000, v84
 v_cvt_pk_bf16_f32 v84, v40, v41
 v_lshlrev_b32 v40, 16, v84
 v_and_b32 v41, 0xffff0000, v84
 v_cvt_pk_bf16_f32 v84, v42, v43
 v_lshlrev_b32 v42, 16, v84
 v_and_b32 v43, 0xffff0000, v84
 v_cvt_pk_bf16_f32 v84, v44, v45
 v_lshlrev_b32 v44, 16, v84
 v_and_b32 v45, 0xffff0000, v84
 v_cvt_pk_bf16_f32 v84, v46, v47
 v_lshlrev_b32 v46, 16, v84
 v_and_b32 v47, 0xffff0000, v84
 v_cvt_pk_bf16_f32 v84, v48, v49
 v_lshlrev_b32 v48, 16, v84
 v_and_b32 v49, 0xffff0000, v84
 v_cvt_pk_bf16_f32 v84, v50, v51
 v_lshlrev_b32 v50, 16, v84
 v_and_b32 v51, 0xffff0000, v84
 v_pk_mul_f32 v[52:53], v[16:17], v[70:71]
 v_pk_mul_f32 v[54:55], v[18:19], v[70:71]
 v_pk_mul_f32 v[56:57], v[20:21], v[70:71]
 v_pk_mul_f32 v[58:59], v[22:23], v[70:71]
 v_pk_mul_f32 v[60:61], v[24:25], v[70:71]
 v_pk_mul_f32 v[62:63], v[26:27], v[70:71]
 v_pk_mul_f32 v[64:65], v[28:29], v[70:71]
 v_pk_mul_f32 v[66:67], v[30:31], v[70:71]
 v_cvt_pk_bf16_f32 v84, v52, v53
 v_lshlrev_b32 v52, 16, v84
 v_and_b32 v53, 0xffff0000, v84
 v_cvt_pk_bf16_f32 v84, v54, v55
 v_lshlrev_b32 v54, 16, v84
 v_and_b32 v55, 0xffff0000, v84
 v_cvt_pk_bf16_f32 v84, v56, v57
 v_lshlrev_b32 v56, 16, v84
 v_and_b32 v57, 0xffff0000, v84
 v_cvt_pk_bf16_f32 v84, v58, v59
 v_lshlrev_b32 v58, 16, v84
 v_and_b32 v59, 0xffff0000, v84
 v_cvt_pk_bf16_f32 v84, v60, v61
 v_lshlrev_b32 v60, 16, v84
 v_and_b32 v61, 0xffff0000, v84
 v_cvt_pk_bf16_f32 v84, v62, v63
 v_lshlrev_b32 v62, 16, v84
 v_and_b32 v63, 0xffff0000, v84
 v_cvt_pk_bf16_f32 v84, v64, v65
 v_lshlrev_b32 v64, 16, v84
 v_and_b32 v65, 0xffff0000, v84
 v_cvt_pk_bf16_f32 v84, v66, v67
 v_lshlrev_b32 v66, 16, v84
 v_and_b32 v67, 0xffff0000, v84
 v_pk_add_f32 v[36:37], v[36:37], v[52:53]
 v_pk_add_f32 v[38:39], v[38:39], v[54:55]
 v_pk_add_f32 v[40:41], v[40:41], v[56:57]
 v_pk_add_f32 v[42:43], v[42:43], v[58:59]
 v_pk_add_f32 v[44:45], v[44:45], v[60:61]
 v_pk_add_f32 v[46:47], v[46:47], v[62:63]
 v_pk_add_f32 v[48:49], v[48:49], v[64:65]
 v_pk_add_f32 v[50:51], v[50:51], v[66:67]
 v_cvt_pk_bf16_f32 v84, v36, v37
 v_lshlrev_b32 v36, 16, v84
 v_and_b32 v37, 0xffff0000, v84
 v_cvt_pk_bf16_f32 v84, v38, v39
 v_lshlrev_b32 v38, 16, v84
 v_and_b32 v39, 0xffff0000, v84
 v_cvt_pk_bf16_f32 v84, v40, v41
 v_lshlrev_b32 v40, 16, v84
 v_and_b32 v41, 0xffff0000, v84
 v_cvt_pk_bf16_f32 v84, v42, v43
 v_lshlrev_b32 v42, 16, v84
 v_and_b32 v43, 0xffff0000, v84
 v_cvt_pk_bf16_f32 v84, v44, v45
 v_lshlrev_b32 v44, 16, v84
 v_and_b32 v45, 0xffff0000, v84
 v_cvt_pk_bf16_f32 v84, v46, v47
 v_lshlrev_b32 v46, 16, v84
 v_and_b32 v47, 0xffff0000, v84
 v_cvt_pk_bf16_f32 v84, v48, v49
 v_lshlrev_b32 v48, 16, v84
 v_and_b32 v49, 0xffff0000, v84
 v_cvt_pk_bf16_f32 v84, v50, v51
 v_lshlrev_b32 v50, 16, v84
 v_and_b32 v51, 0xffff0000, v84
 v_pk_mul_f32 v[52:53], v[18:19], v[68:69]
 v_pk_mul_f32 v[54:55], v[20:21], v[68:69]
 v_pk_mul_f32 v[56:57], v[22:23], v[68:69]
 v_pk_mul_f32 v[58:59], v[24:25], v[68:69]
 v_pk_mul_f32 v[60:61], v[26:27], v[68:69]
 v_pk_mul_f32 v[62:63], v[28:29], v[68:69]
 v_pk_mul_f32 v[64:65], v[30:31], v[68:69]
 v_pk_mul_f32 v[66:67], v[32:33], v[68:69]
 v_cvt_pk_bf16_f32 v84, v52, v53
 v_lshlrev_b32 v52, 16, v84
 v_and_b32 v53, 0xffff0000, v84
 v_cvt_pk_bf16_f32 v84, v54, v55
 v_lshlrev_b32 v54, 16, v84
 v_and_b32 v55, 0xffff0000, v84
 v_cvt_pk_bf16_f32 v84, v56, v57
 v_lshlrev_b32 v56, 16, v84
 v_and_b32 v57, 0xffff0000, v84
 v_cvt_pk_bf16_f32 v84, v58, v59
 v_lshlrev_b32 v58, 16, v84
 v_and_b32 v59, 0xffff0000, v84
 v_cvt_pk_bf16_f32 v84, v60, v61
 v_lshlrev_b32 v60, 16, v84
 v_and_b32 v61, 0xffff0000, v84
 v_cvt_pk_bf16_f32 v84, v62, v63
 v_lshlrev_b32 v62, 16, v84
 v_and_b32 v63, 0xffff0000, v84
 v_cvt_pk_bf16_f32 v84, v64, v65
 v_lshlrev_b32 v64, 16, v84
 v_and_b32 v65, 0xffff0000, v84
 v_cvt_pk_bf16_f32 v84, v66, v67
 v_lshlrev_b32 v66, 16, v84
 v_and_b32 v67, 0xffff0000, v84
 v_pk_add_f32 v[36:37], v[36:37], v[52:53]
 v_pk_add_f32 v[38:39], v[38:39], v[54:55]
 v_pk_add_f32 v[40:41], v[40:41], v[56:57]
 v_pk_add_f32 v[42:43], v[42:43], v[58:59]
 v_pk_add_f32 v[44:45], v[44:45], v[60:61]
 v_pk_add_f32 v[46:47], v[46:47], v[62:63]
 v_pk_add_f32 v[48:49], v[48:49], v[64:65]
 v_pk_add_f32 v[50:51], v[50:51], v[66:67]
 v_cvt_pk_bf16_f32 v84, v36, v37
 v_lshlrev_b32 v36, 16, v84
 v_and_b32 v37, 0xffff0000, v84
 v_cvt_pk_bf16_f32 v84, v38, v39
 v_lshlrev_b32 v38, 16, v84
 v_and_b32 v39, 0xffff0000, v84
 v_cvt_pk_bf16_f32 v84, v40, v41
 v_lshlrev_b32 v40, 16, v84
 v_and_b32 v41, 0xffff0000, v84
 v_cvt_pk_bf16_f32 v84, v42, v43
 v_lshlrev_b32 v42, 16, v84
 v_and_b32 v43, 0xffff0000, v84
 v_cvt_pk_bf16_f32 v84, v44, v45
 v_lshlrev_b32 v44, 16, v84
 v_and_b32 v45, 0xffff0000, v84
 v_cvt_pk_bf16_f32 v84, v46, v47
 v_lshlrev_b32 v46, 16, v84
 v_and_b32 v47, 0xffff0000, v84
 v_cvt_pk_bf16_f32 v84, v48, v49
 v_lshlrev_b32 v48, 16, v84
 v_and_b32 v49, 0xffff0000, v84
 v_cvt_pk_bf16_f32 v84, v50, v51
 v_lshlrev_b32 v50, 16, v84
 v_and_b32 v51, 0xffff0000, v84
 v_lshlrev_b32 v12, 16, v146
 v_and_b32 v13, 0xffff0000, v146
 v_lshlrev_b32 v14, 16, v150
 v_and_b32 v15, 0xffff0000, v150
 v_lshlrev_b32 v16, 16, v154
 v_and_b32 v17, 0xffff0000, v154
 v_lshlrev_b32 v18, 16, v158
 v_and_b32 v19, 0xffff0000, v158
 v_lshlrev_b32 v20, 16, v162
 v_and_b32 v21, 0xffff0000, v162
 v_lshlrev_b32 v22, 16, v166
 v_and_b32 v23, 0xffff0000, v166
 v_lshlrev_b32 v24, 16, v170
 v_and_b32 v25, 0xffff0000, v170
 v_lshlrev_b32 v26, 16, v174
 v_and_b32 v27, 0xffff0000, v174
 v_pk_mul_f32 v[36:37], v[36:37], v[12:13]
 v_pk_mul_f32 v[38:39], v[38:39], v[14:15]
 v_pk_mul_f32 v[40:41], v[40:41], v[16:17]
 v_pk_mul_f32 v[42:43], v[42:43], v[18:19]
 v_pk_mul_f32 v[44:45], v[44:45], v[20:21]
 v_pk_mul_f32 v[46:47], v[46:47], v[22:23]
 v_pk_mul_f32 v[48:49], v[48:49], v[24:25]
 v_pk_mul_f32 v[50:51], v[50:51], v[26:27]
 v_cvt_pk_bf16_f32 v76, v50, v48
 v_cvt_pk_bf16_f32 v77, v46, v44
 v_cvt_pk_bf16_f32 v78, v42, v40
 v_cvt_pk_bf16_f32 v79, v38, v36
 s_add_u32 s3, s70, 16384
 buffer_store_dwordx4 v[76:79], v94, s[4:7], s3 offen sc1
 v_cvt_pk_bf16_f32 v80, v51, v49
 v_cvt_pk_bf16_f32 v81, v47, v45
 v_cvt_pk_bf16_f32 v82, v43, v41
 v_cvt_pk_bf16_f32 v83, v39, v37
 s_add_u32 s3, s70, 20480
 buffer_store_dwordx4 v[80:83], v94, s[4:7], s3 offen sc1
 v_lshlrev_b32 v12, 16, v103
 v_and_b32 v13, 0xffff0000, v103
 v_lshlrev_b32 v14, 16, v107
 v_and_b32 v15, 0xffff0000, v107
 v_lshlrev_b32 v16, 16, v111
 v_and_b32 v17, 0xffff0000, v111
 v_lshlrev_b32 v18, 16, v115
 v_and_b32 v19, 0xffff0000, v115
 v_lshlrev_b32 v20, 16, v119
 v_and_b32 v21, 0xffff0000, v119
 v_lshlrev_b32 v22, 16, v123
 v_and_b32 v23, 0xffff0000, v123
 v_lshlrev_b32 v24, 16, v127
 v_and_b32 v25, 0xffff0000, v127
 v_lshlrev_b32 v26, 16, v131
 v_and_b32 v27, 0xffff0000, v131
 v_lshlrev_b32 v28, 16, v135
 v_and_b32 v29, 0xffff0000, v135
 v_lshlrev_b32 v30, 16, v139
 v_and_b32 v31, 0xffff0000, v139
 v_lshlrev_b32 v32, 16, v143
 v_and_b32 v33, 0xffff0000, v143
 v_lshlrev_b32 v68, 16, v188
 v_lshlrev_b32 v69, 16, v190
 v_and_b32 v70, 0xffff0000, v188
 v_and_b32 v71, 0xffff0000, v190
 v_lshlrev_b32 v72, 16, v189
 v_lshlrev_b32 v73, 16, v191
 v_and_b32 v74, 0xffff0000, v189
 v_and_b32 v75, 0xffff0000, v191
 v_pk_mul_f32 v[36:37], v[12:13], v[74:75]
 v_pk_mul_f32 v[38:39], v[14:15], v[74:75]
 v_pk_mul_f32 v[40:41], v[16:17], v[74:75]
 v_pk_mul_f32 v[42:43], v[18:19], v[74:75]
 v_pk_mul_f32 v[44:45], v[20:21], v[74:75]
 v_pk_mul_f32 v[46:47], v[22:23], v[74:75]
 v_pk_mul_f32 v[48:49], v[24:25], v[74:75]
 v_pk_mul_f32 v[50:51], v[26:27], v[74:75]
 v_cvt_pk_bf16_f32 v84, v36, v37
 v_lshlrev_b32 v36, 16, v84
 v_and_b32 v37, 0xffff0000, v84
 v_cvt_pk_bf16_f32 v84, v38, v39
 v_lshlrev_b32 v38, 16, v84
 v_and_b32 v39, 0xffff0000, v84
 v_cvt_pk_bf16_f32 v84, v40, v41
 v_lshlrev_b32 v40, 16, v84
 v_and_b32 v41, 0xffff0000, v84
 v_cvt_pk_bf16_f32 v84, v42, v43
 v_lshlrev_b32 v42, 16, v84
 v_and_b32 v43, 0xffff0000, v84
 v_cvt_pk_bf16_f32 v84, v44, v45
 v_lshlrev_b32 v44, 16, v84
 v_and_b32 v45, 0xffff0000, v84
 v_cvt_pk_bf16_f32 v84, v46, v47
 v_lshlrev_b32 v46, 16, v84
 v_and_b32 v47, 0xffff0000, v84
 v_cvt_pk_bf16_f32 v84, v48, v49
 v_lshlrev_b32 v48, 16, v84
 v_and_b32 v49, 0xffff0000, v84
 v_cvt_pk_bf16_f32 v84, v50, v51
 v_lshlrev_b32 v50, 16, v84
 v_and_b32 v51, 0xffff0000, v84
 v_pk_mul_f32 v[52:53], v[14:15], v[72:73]
 v_pk_mul_f32 v[54:55], v[16:17], v[72:73]
 v_pk_mul_f32 v[56:57], v[18:19], v[72:73]
 v_pk_mul_f32 v[58:59], v[20:21], v[72:73]
 v_pk_mul_f32 v[60:61], v[22:23], v[72:73]
 v_pk_mul_f32 v[62:63], v[24:25], v[72:73]
 v_pk_mul_f32 v[64:65], v[26:27], v[72:73]
 v_pk_mul_f32 v[66:67], v[28:29], v[72:73]
 v_cvt_pk_bf16_f32 v84, v52, v53
 v_lshlrev_b32 v52, 16, v84
 v_and_b32 v53, 0xffff0000, v84
 v_cvt_pk_bf16_f32 v84, v54, v55
 v_lshlrev_b32 v54, 16, v84
 v_and_b32 v55, 0xffff0000, v84
 v_cvt_pk_bf16_f32 v84, v56, v57
 v_lshlrev_b32 v56, 16, v84
 v_and_b32 v57, 0xffff0000, v84
 v_cvt_pk_bf16_f32 v84, v58, v59
 v_lshlrev_b32 v58, 16, v84
 v_and_b32 v59, 0xffff0000, v84
 v_cvt_pk_bf16_f32 v84, v60, v61
 v_lshlrev_b32 v60, 16, v84
 v_and_b32 v61, 0xffff0000, v84
 v_cvt_pk_bf16_f32 v84, v62, v63
 v_lshlrev_b32 v62, 16, v84
 v_and_b32 v63, 0xffff0000, v84
 v_cvt_pk_bf16_f32 v84, v64, v65
 v_lshlrev_b32 v64, 16, v84
 v_and_b32 v65, 0xffff0000, v84
 v_cvt_pk_bf16_f32 v84, v66, v67
 v_lshlrev_b32 v66, 16, v84
 v_and_b32 v67, 0xffff0000, v84
 v_pk_add_f32 v[36:37], v[36:37], v[52:53]
 v_pk_add_f32 v[38:39], v[38:39], v[54:55]
 v_pk_add_f32 v[40:41], v[40:41], v[56:57]
 v_pk_add_f32 v[42:43], v[42:43], v[58:59]
 v_pk_add_f32 v[44:45], v[44:45], v[60:61]
 v_pk_add_f32 v[46:47], v[46:47], v[62:63]
 v_pk_add_f32 v[48:49], v[48:49], v[64:65]
 v_pk_add_f32 v[50:51], v[50:51], v[66:67]
 v_cvt_pk_bf16_f32 v84, v36, v37
 v_lshlrev_b32 v36, 16, v84
 v_and_b32 v37, 0xffff0000, v84
 v_cvt_pk_bf16_f32 v84, v38, v39
 v_lshlrev_b32 v38, 16, v84
 v_and_b32 v39, 0xffff0000, v84
 v_cvt_pk_bf16_f32 v84, v40, v41
 v_lshlrev_b32 v40, 16, v84
 v_and_b32 v41, 0xffff0000, v84
 v_cvt_pk_bf16_f32 v84, v42, v43
 v_lshlrev_b32 v42, 16, v84
 v_and_b32 v43, 0xffff0000, v84
 v_cvt_pk_bf16_f32 v84, v44, v45
 v_lshlrev_b32 v44, 16, v84
 v_and_b32 v45, 0xffff0000, v84
 v_cvt_pk_bf16_f32 v84, v46, v47
 v_lshlrev_b32 v46, 16, v84
 v_and_b32 v47, 0xffff0000, v84
 v_cvt_pk_bf16_f32 v84, v48, v49
 v_lshlrev_b32 v48, 16, v84
 v_and_b32 v49, 0xffff0000, v84
 v_cvt_pk_bf16_f32 v84, v50, v51
 v_lshlrev_b32 v50, 16, v84
 v_and_b32 v51, 0xffff0000, v84
 v_pk_mul_f32 v[52:53], v[16:17], v[70:71]
 v_pk_mul_f32 v[54:55], v[18:19], v[70:71]
 v_pk_mul_f32 v[56:57], v[20:21], v[70:71]
 v_pk_mul_f32 v[58:59], v[22:23], v[70:71]
 v_pk_mul_f32 v[60:61], v[24:25], v[70:71]
 v_pk_mul_f32 v[62:63], v[26:27], v[70:71]
 v_pk_mul_f32 v[64:65], v[28:29], v[70:71]
 v_pk_mul_f32 v[66:67], v[30:31], v[70:71]
 v_cvt_pk_bf16_f32 v84, v52, v53
 v_lshlrev_b32 v52, 16, v84
 v_and_b32 v53, 0xffff0000, v84
 v_cvt_pk_bf16_f32 v84, v54, v55
 v_lshlrev_b32 v54, 16, v84
 v_and_b32 v55, 0xffff0000, v84
 v_cvt_pk_bf16_f32 v84, v56, v57
 v_lshlrev_b32 v56, 16, v84
 v_and_b32 v57, 0xffff0000, v84
 v_cvt_pk_bf16_f32 v84, v58, v59
 v_lshlrev_b32 v58, 16, v84
 v_and_b32 v59, 0xffff0000, v84
 v_cvt_pk_bf16_f32 v84, v60, v61
 v_lshlrev_b32 v60, 16, v84
 v_and_b32 v61, 0xffff0000, v84
 v_cvt_pk_bf16_f32 v84, v62, v63
 v_lshlrev_b32 v62, 16, v84
 v_and_b32 v63, 0xffff0000, v84
 v_cvt_pk_bf16_f32 v84, v64, v65
 v_lshlrev_b32 v64, 16, v84
 v_and_b32 v65, 0xffff0000, v84
 v_cvt_pk_bf16_f32 v84, v66, v67
 v_lshlrev_b32 v66, 16, v84
 v_and_b32 v67, 0xffff0000, v84
 v_pk_add_f32 v[36:37], v[36:37], v[52:53]
 v_pk_add_f32 v[38:39], v[38:39], v[54:55]
 v_pk_add_f32 v[40:41], v[40:41], v[56:57]
 v_pk_add_f32 v[42:43], v[42:43], v[58:59]
 v_pk_add_f32 v[44:45], v[44:45], v[60:61]
 v_pk_add_f32 v[46:47], v[46:47], v[62:63]
 v_pk_add_f32 v[48:49], v[48:49], v[64:65]
 v_pk_add_f32 v[50:51], v[50:51], v[66:67]
 v_cvt_pk_bf16_f32 v84, v36, v37
 v_lshlrev_b32 v36, 16, v84
 v_and_b32 v37, 0xffff0000, v84
 v_cvt_pk_bf16_f32 v84, v38, v39
 v_lshlrev_b32 v38, 16, v84
 v_and_b32 v39, 0xffff0000, v84
 v_cvt_pk_bf16_f32 v84, v40, v41
 v_lshlrev_b32 v40, 16, v84
 v_and_b32 v41, 0xffff0000, v84
 v_cvt_pk_bf16_f32 v84, v42, v43
 v_lshlrev_b32 v42, 16, v84
 v_and_b32 v43, 0xffff0000, v84
 v_cvt_pk_bf16_f32 v84, v44, v45
 v_lshlrev_b32 v44, 16, v84
 v_and_b32 v45, 0xffff0000, v84
 v_cvt_pk_bf16_f32 v84, v46, v47
 v_lshlrev_b32 v46, 16, v84
 v_and_b32 v47, 0xffff0000, v84
 v_cvt_pk_bf16_f32 v84, v48, v49
 v_lshlrev_b32 v48, 16, v84
 v_and_b32 v49, 0xffff0000, v84
 v_cvt_pk_bf16_f32 v84, v50, v51
 v_lshlrev_b32 v50, 16, v84
 v_and_b32 v51, 0xffff0000, v84
 v_pk_mul_f32 v[52:53], v[18:19], v[68:69]
 v_pk_mul_f32 v[54:55], v[20:21], v[68:69]
 v_pk_mul_f32 v[56:57], v[22:23], v[68:69]
 v_pk_mul_f32 v[58:59], v[24:25], v[68:69]
 v_pk_mul_f32 v[60:61], v[26:27], v[68:69]
 v_pk_mul_f32 v[62:63], v[28:29], v[68:69]
 v_pk_mul_f32 v[64:65], v[30:31], v[68:69]
 v_pk_mul_f32 v[66:67], v[32:33], v[68:69]
 v_cvt_pk_bf16_f32 v84, v52, v53
 v_lshlrev_b32 v52, 16, v84
 v_and_b32 v53, 0xffff0000, v84
 v_cvt_pk_bf16_f32 v84, v54, v55
 v_lshlrev_b32 v54, 16, v84
 v_and_b32 v55, 0xffff0000, v84
 v_cvt_pk_bf16_f32 v84, v56, v57
 v_lshlrev_b32 v56, 16, v84
 v_and_b32 v57, 0xffff0000, v84
 v_cvt_pk_bf16_f32 v84, v58, v59
 v_lshlrev_b32 v58, 16, v84
 v_and_b32 v59, 0xffff0000, v84
 v_cvt_pk_bf16_f32 v84, v60, v61
 v_lshlrev_b32 v60, 16, v84
 v_and_b32 v61, 0xffff0000, v84
 v_cvt_pk_bf16_f32 v84, v62, v63
 v_lshlrev_b32 v62, 16, v84
 v_and_b32 v63, 0xffff0000, v84
 v_cvt_pk_bf16_f32 v84, v64, v65
 v_lshlrev_b32 v64, 16, v84
 v_and_b32 v65, 0xffff0000, v84
 v_cvt_pk_bf16_f32 v84, v66, v67
 v_lshlrev_b32 v66, 16, v84
 v_and_b32 v67, 0xffff0000, v84
 v_pk_add_f32 v[36:37], v[36:37], v[52:53]
 v_pk_add_f32 v[38:39], v[38:39], v[54:55]
 v_pk_add_f32 v[40:41], v[40:41], v[56:57]
 v_pk_add_f32 v[42:43], v[42:43], v[58:59]
 v_pk_add_f32 v[44:45], v[44:45], v[60:61]
 v_pk_add_f32 v[46:47], v[46:47], v[62:63]
 v_pk_add_f32 v[48:49], v[48:49], v[64:65]
 v_pk_add_f32 v[50:51], v[50:51], v[66:67]
 v_cvt_pk_bf16_f32 v84, v36, v37
 v_lshlrev_b32 v36, 16, v84
 v_and_b32 v37, 0xffff0000, v84
 v_cvt_pk_bf16_f32 v84, v38, v39
 v_lshlrev_b32 v38, 16, v84
 v_and_b32 v39, 0xffff0000, v84
 v_cvt_pk_bf16_f32 v84, v40, v41
 v_lshlrev_b32 v40, 16, v84
 v_and_b32 v41, 0xffff0000, v84
 v_cvt_pk_bf16_f32 v84, v42, v43
 v_lshlrev_b32 v42, 16, v84
 v_and_b32 v43, 0xffff0000, v84
 v_cvt_pk_bf16_f32 v84, v44, v45
 v_lshlrev_b32 v44, 16, v84
 v_and_b32 v45, 0xffff0000, v84
 v_cvt_pk_bf16_f32 v84, v46, v47
 v_lshlrev_b32 v46, 16, v84
 v_and_b32 v47, 0xffff0000, v84
 v_cvt_pk_bf16_f32 v84, v48, v49
 v_lshlrev_b32 v48, 16, v84
 v_and_b32 v49, 0xffff0000, v84
 v_cvt_pk_bf16_f32 v84, v50, v51
 v_lshlrev_b32 v50, 16, v84
 v_and_b32 v51, 0xffff0000, v84
 v_lshlrev_b32 v12, 16, v147
 v_and_b32 v13, 0xffff0000, v147
 v_lshlrev_b32 v14, 16, v151
 v_and_b32 v15, 0xffff0000, v151
 v_lshlrev_b32 v16, 16, v155
 v_and_b32 v17, 0xffff0000, v155
 v_lshlrev_b32 v18, 16, v159
 v_and_b32 v19, 0xffff0000, v159
 v_lshlrev_b32 v20, 16, v163
 v_and_b32 v21, 0xffff0000, v163
 v_lshlrev_b32 v22, 16, v167
 v_and_b32 v23, 0xffff0000, v167
 v_lshlrev_b32 v24, 16, v171
 v_and_b32 v25, 0xffff0000, v171
 v_lshlrev_b32 v26, 16, v175
 v_and_b32 v27, 0xffff0000, v175
 v_pk_mul_f32 v[36:37], v[36:37], v[12:13]
 v_pk_mul_f32 v[38:39], v[38:39], v[14:15]
 v_pk_mul_f32 v[40:41], v[40:41], v[16:17]
 v_pk_mul_f32 v[42:43], v[42:43], v[18:19]
 v_pk_mul_f32 v[44:45], v[44:45], v[20:21]
 v_pk_mul_f32 v[46:47], v[46:47], v[22:23]
 v_pk_mul_f32 v[48:49], v[48:49], v[24:25]
 v_pk_mul_f32 v[50:51], v[50:51], v[26:27]
 v_cvt_pk_bf16_f32 v76, v50, v48
 v_cvt_pk_bf16_f32 v77, v46, v44
 v_cvt_pk_bf16_f32 v78, v42, v40
 v_cvt_pk_bf16_f32 v79, v38, v36
 s_add_u32 s3, s70, 24576
 buffer_store_dwordx4 v[76:79], v94, s[4:7], s3 offen sc1
 v_cvt_pk_bf16_f32 v80, v51, v49
 v_cvt_pk_bf16_f32 v81, v47, v45
 v_cvt_pk_bf16_f32 v82, v43, v41
 v_cvt_pk_bf16_f32 v83, v39, v37
 s_add_u32 s3, s70, 28672
 buffer_store_dwordx4 v[80:83], v94, s[4:7], s3 offen sc1
 s_cmp_eq_u32 s83, 1
 s_cbranch_scc1 L_k3_25
 s_waitcnt vmcnt(0)
 s_barrier
 s_cmp_lg_u32 s50, 3
 s_cbranch_scc1 L_ar_26
 s_mov_b32 s96, s44
 s_and_b32 s97, s45, 0xffff
 s_mov_b32 s98, 256
 s_mov_b32 s99, 0x00020000
 v_mov_b32 v1, 1
 s_mov_b64 exec, 1
 buffer_atomic_add v1, off, s[96:99], 0 offset:80 sc0
 s_waitcnt vmcnt(0)
 v_cmp_eq_u32 vcc, 39, v1
 s_cbranch_vccz L_aw_27
 buffer_store_dword v1, off, s[96:99], 0 offset:208 sc1
L_aw_27:
 s_mov_b64 exec, -1
L_ar_26:
 s_branch L_help_conv
L_k3_25:
 s_waitcnt vmcnt(0)
 s_barrier
 s_cmp_lg_u32 s50, 3
 s_cbranch_scc1 L_ar_28
 s_mov_b32 s96, s44
 s_and_b32 s97, s45, 0xffff
 s_mov_b32 s98, 256
 s_mov_b32 s99, 0x00020000
 v_mov_b32 v1, 1
 s_mov_b64 exec, 1
 buffer_atomic_add v1, off, s[96:99], 0 offset:68 sc0
 s_waitcnt vmcnt(0)
 v_cmp_eq_u32 vcc, 39, v1
 s_cbranch_vccz L_aw_29
 buffer_store_dword v1, off, s[96:99], 0 offset:196 sc1
L_aw_29:
 s_mov_b64 exec, -1
L_ar_28:
 s_mov_b32 s8, s26
 s_and_b32 s9, s27, 0xffff
 s_mov_b32 s10, 5242880
 s_mov_b32 s11, 0x00020000
 s_mul_i32 s57, s50, 40960
 s_and_b32 s55, s53, 3
 s_add_u32 s64, s55, 0
 s_sub_u32 s3, s64, 4
 s_cmp_ge_u32 s64, 4
 s_cselect_b32 s64, s3, s64
 s_add_u32 s65, s55, 1
 s_sub_u32 s3, s65, 4
 s_cmp_ge_u32 s65, 4
 s_cselect_b32 s65, s3, s65
 s_add_u32 s66, s55, 2
 s_sub_u32 s3, s66, 4
 s_cmp_ge_u32 s66, 4
 s_cselect_b32 s66, s3, s66
 s_add_u32 s67, s55, 3
 s_sub_u32 s3, s67, 4
 s_cmp_ge_u32 s67, 4
 s_cselect_b32 s67, s3, s67
 s_mul_i32 s55, s52, 655360
 s_lshl_b32 s3, s53, 8
 s_add_u32 s55, s55, s3
 v_lshrrev_b32 v4, 4, v0
 s_mov_b32 s3, 1280
 v_mul_lo_u32 v4, v4, s3
 v_lshrrev_b32 v3, 3, v0
 v_and_b32 v3, 6, v3
 v_xor_b32 v3, v3, v0
 v_and_b32 v3, 15, v3
 v_lshl_add_u32 v4, v3, 4, v4
 v_xor_b32 v5, 128, v4
 s_lshl_b32 s57, s50, 13
 s_mul_i32 s3, s50, 40960
 s_add_u32 s55, s55, s3
 s_mul_i32 s51, s64, 163840
 s_add_u32 s51, s51, s55
 s_add_u32 m0, s57, 0
 s_nop 0
 buffer_load_dwordx4 v4, s[8:11], s51 offen lds
 s_add_u32 s51, s51, 5120
 s_add_u32 m0, s57, 1024
 s_nop 0
 buffer_load_dwordx4 v5, s[8:11], s51 offen lds
 s_add_u32 s51, s51, 5120
 s_add_u32 m0, s57, 2048
 s_nop 0
 buffer_load_dwordx4 v4, s[8:11], s51 offen lds
 s_add_u32 s51, s51, 5120
 s_add_u32 m0, s57, 3072
 s_nop 0
 buffer_load_dwordx4 v5, s[8:11], s51 offen lds
 s_add_u32 s51, s51, 5120
 s_add_u32 m0, s57, 4096
 s_nop 0
 buffer_load_dwordx4 v4, s[8:11], s51 offen lds
 s_add_u32 s51, s51, 5120
 s_add_u32 m0, s57, 5120
 s_nop 0
 buffer_load_dwordx4 v5, s[8:11], s51 offen lds
 s_add_u32 s51, s51, 5120
 s_add_u32 m0, s57, 6144
 s_nop 0
 buffer_load_dwordx4 v4, s[8:11], s51 offen lds
 s_add_u32 s51, s51, 5120
 s_add_u32 m0, s57, 7168
 s_nop 0
 buffer_load_dwordx4 v5, s[8:11], s51 offen lds
 s_add_u32 s51, s51, 5120
 s_mul_i32 s51, s65, 163840
 s_add_u32 s51, s51, s55
 s_add_u32 m0, s57, 32768
 s_nop 0
 buffer_load_dwordx4 v4, s[8:11], s51 offen lds
 s_add_u32 s51, s51, 5120
 s_add_u32 m0, s57, 33792
 s_nop 0
 buffer_load_dwordx4 v5, s[8:11], s51 offen lds
 s_add_u32 s51, s51, 5120
 s_add_u32 m0, s57, 34816
 s_nop 0
 buffer_load_dwordx4 v4, s[8:11], s51 offen lds
 s_add_u32 s51, s51, 5120
 s_add_u32 m0, s57, 35840
 s_nop 0
 buffer_load_dwordx4 v5, s[8:11], s51 offen lds
 s_add_u32 s51, s51, 5120
 s_add_u32 m0, s57, 36864
 s_nop 0
 buffer_load_dwordx4 v4, s[8:11], s51 offen lds
 s_add_u32 s51, s51, 5120
 s_add_u32 m0, s57, 37888
 s_nop 0
 buffer_load_dwordx4 v5, s[8:11], s51 offen lds
 s_add_u32 s51, s51, 5120
 s_add_u32 m0, s57, 38912
 s_nop 0
 buffer_load_dwordx4 v4, s[8:11], s51 offen lds
 s_add_u32 s51, s51, 5120
 s_add_u32 m0, s57, 39936
 s_nop 0
 buffer_load_dwordx4 v5, s[8:11], s51 offen lds
 s_add_u32 s51, s51, 5120
 s_mul_i32 s51, s66, 163840
 s_add_u32 s51, s51, s55
 s_add_u32 m0, s57, 65536
 s_nop 0
 buffer_load_dwordx4 v4, s[8:11], s51 offen lds
 s_add_u32 s51, s51, 5120
 s_add_u32 m0, s57, 66560
 s_nop 0
 buffer_load_dwordx4 v5, s[8:11], s51 offen lds
 s_add_u32 s51, s51, 5120
 s_add_u32 m0, s57, 67584
 s_nop 0
 buffer_load_dwordx4 v4, s[8:11], s51 offen lds
 s_add_u32 s51, s51, 5120
 s_add_u32 m0, s57, 68608
 s_nop 0
 buffer_load_dwordx4 v5, s[8:11], s51 offen lds
 s_add_u32 s51, s51, 5120
 s_add_u32 m0, s57, 69632
 s_nop 0
 buffer_load_dwordx4 v4, s[8:11], s51 offen lds
 s_add_u32 s51, s51, 5120
 s_add_u32 m0, s57, 70656
 s_nop 0
 buffer_load_dwordx4 v5, s[8:11], s51 offen lds
 s_add_u32 s51, s51, 5120
 s_add_u32 m0, s57, 71680
 s_nop 0
 buffer_load_dwordx4 v4, s[8:11], s51 offen lds
 s_add_u32 s51, s51, 5120
 s_add_u32 m0, s57, 72704
 s_nop 0
 buffer_load_dwordx4 v5, s[8:11], s51 offen lds
 s_add_u32 s51, s51, 5120
 s_mul_i32 s51, s67, 163840
 s_add_u32 s51, s51, s55
 s_add_u32 m0, s57, 98304
 s_nop 0
 buffer_load_dwordx4 v4, s[8:11], s51 offen lds
 s_add_u32 s51, s51, 5120
 s_add_u32 m0, s57, 99328
 s_nop 0
 buffer_load_dwordx4 v5, s[8:11], s51 offen lds
 s_add_u32 s51, s51, 5120
 s_add_u32 m0, s57, 100352
 s_nop 0
 buffer_load_dwordx4 v4, s[8:11], s51 offen lds
 s_add_u32 s51, s51, 5120
 s_add_u32 m0, s57, 101376
 s_nop 0
 buffer_load_dwordx4 v5, s[8:11], s51 offen lds
 s_add_u32 s51, s51, 5120
 s_add_u32 m0, s57, 102400
 s_nop 0
 buffer_load_dwordx4 v4, s[8:11], s51 offen lds
 s_add_u32 s51, s51, 5120
 s_add_u32 m0, s57, 103424
 s_nop 0
 buffer_load_dwordx4 v5, s[8:11], s51 offen lds
 s_add_u32 s51, s51, 5120
 s_add_u32 m0, s57, 104448
 s_nop 0
 buffer_load_dwordx4 v4, s[8:11], s51 offen lds
 s_add_u32 s51, s51, 5120
 s_add_u32 m0, s57, 105472
 s_nop 0
 buffer_load_dwordx4 v5, s[8:11], s51 offen lds
 s_add_u32 s51, s51, 5120
 v_lshrrev_b32 v2, 3, v0
 v_and_b32 v2, 4, v2
 v_bfe_u32 v3, v0, 2, 2
 v_or_b32 v2, v2, v3
 v_bfe_u32 v3, v0, 4, 1
 v_xor_b32 v3, v3, v2
 s_lshl_b32 s3, s50, 1
 v_xor_b32 v3, s3, v3
 v_lshlrev_b32 v2, 8, v2
 v_lshl_add_u32 v2, v3, 5, v2
 v_and_b32 v3, 3, v0
 v_lshl_add_u32 v2, v3, 3, v2
 s_waitcnt vmcnt(24)
 s_barrier
 ds_read_b64_tr_b16 a[0:1], v2 offset:0
 ds_read_b64_tr_b16 a[2:3], v2 offset:4096
 ds_read_b64_tr_b16 a[4:5], v2 offset:2048
 ds_read_b64_tr_b16 a[6:7], v2 offset:6144
 ds_read_b64_tr_b16 a[8:9], v2 offset:8192
 ds_read_b64_tr_b16 a[10:11], v2 offset:12288
 ds_read_b64_tr_b16 a[12:13], v2 offset:10240
 ds_read_b64_tr_b16 a[14:15], v2 offset:14336
 ds_read_b64_tr_b16 a[16:17], v2 offset:16384
 ds_read_b64_tr_b16 a[18:19], v2 offset:20480
 ds_read_b64_tr_b16 a[20:21], v2 offset:18432
 ds_read_b64_tr_b16 a[22:23], v2 offset:22528
 ds_read_b64_tr_b16 a[24:25], v2 offset:24576
 ds_read_b64_tr_b16 a[26:27], v2 offset:28672
 ds_read_b64_tr_b16 a[28:29], v2 offset:26624
 ds_read_b64_tr_b16 a[30:31], v2 offset:30720
 v_add_u32 v2, 0x8000, v2
 s_waitcnt vmcnt(16)
 s_barrier
 ds_read_b64_tr_b16 a[32:33], v2 offset:0
 ds_read_b64_tr_b16 a[34:35], v2 offset:4096
 ds_read_b64_tr_b16 a[36:37], v2 offset:2048
 ds_read_b64_tr_b16 a[38:39], v2 offset:6144
 ds_read_b64_tr_b16 a[40:41], v2 offset:8192
 ds_read_b64_tr_b16 a[42:43], v2 offset:12288
 ds_read_b64_tr_b16 a[44:45], v2 offset:10240
 ds_read_b64_tr_b16 a[46:47], v2 offset:14336
 ds_read_b64_tr_b16 a[48:49], v2 offset:16384
 ds_read_b64_tr_b16 a[50:51], v2 offset:20480
 ds_read_b64_tr_b16 a[52:53], v2 offset:18432
 ds_read_b64_tr_b16 a[54:55], v2 offset:22528
 ds_read_b64_tr_b16 a[56:57], v2 offset:24576
 ds_read_b64_tr_b16 a[58:59], v2 offset:28672
 ds_read_b64_tr_b16 a[60:61], v2 offset:26624
 ds_read_b64_tr_b16 a[62:63], v2 offset:30720
 v_add_u32 v2, 0x8000, v2
 s_waitcnt vmcnt(8)
 s_barrier
 ds_read_b64_tr_b16 a[64:65], v2 offset:0
 ds_read_b64_tr_b16 a[66:67], v2 offset:4096
 ds_read_b64_tr_b16 a[68:69], v2 offset:2048
 ds_read_b64_tr_b16 a[70:71], v2 offset:6144
 ds_read_b64_tr_b16 a[72:73], v2 offset:8192
 ds_read_b64_tr_b16 a[74:75], v2 offset:12288
 ds_read_b64_tr_b16 a[76:77], v2 offset:10240
 ds_read_b64_tr_b16 a[78:79], v2 offset:14336
 ds_read_b64_tr_b16 a[80:81], v2 offset:16384
 ds_read_b64_tr_b16 a[82:83], v2 offset:20480
 ds_read_b64_tr_b16 a[84:85], v2 offset:18432
 ds_read_b64_tr_b16 a[86:87], v2 offset:22528
 ds_read_b64_tr_b16 a[88:89], v2 offset:24576
 ds_read_b64_tr_b16 a[90:91], v2 offset:28672
 ds_read_b64_tr_b16 a[92:93], v2 offset:26624
 ds_read_b64_tr_b16 a[94:95], v2 offset:30720
 v_add_u32 v2, 0x8000, v2
 s_waitcnt vmcnt(0)
 s_barrier
 ds_read_b64_tr_b16 a[96:97], v2 offset:0
 ds_read_b64_tr_b16 a[98:99], v2 offset:4096
 ds_read_b64_tr_b16 a[100:101], v2 offset:2048
 ds_read_b64_tr_b16 a[102:103], v2 offset:6144
 ds_read_b64_tr_b16 a[104:105], v2 offset:8192
 ds_read_b64_tr_b16 a[106:107], v2 offset:12288
 ds_read_b64_tr_b16 a[108:109], v2 offset:10240
 ds_read_b64_tr_b16 a[110:111], v2 offset:14336
 ds_read_b64_tr_b16 a[112:113], v2 offset:16384
 ds_read_b64_tr_b16 a[114:115], v2 offset:20480
 ds_read_b64_tr_b16 a[116:117], v2 offset:18432
 ds_read_b64_tr_b16 a[118:119], v2 offset:22528
 ds_read_b64_tr_b16 a[120:121], v2 offset:24576
 ds_read_b64_tr_b16 a[122:123], v2 offset:28672
 ds_read_b64_tr_b16 a[124:125], v2 offset:26624
 ds_read_b64_tr_b16 a[126:127], v2 offset:30720
 v_add_u32 v2, 0x8000, v2
 s_waitcnt lgkmcnt(0)
 s_barrier
L_help_conv:
 s_cmp_ge_u32 s82, 72
 s_cbranch_scc1 L_help_ln2
 s_cmp_ge_u32 s82, 64
 s_cbranch_scc1 L_help_done
 s_lshl_b32 s70, s82, 2
 s_add_u32 s70, s70, s50
 s_add_u32 s70, s70, 384
 s_mul_i32 s71, s50, 13312
 s_mov_b32 s69, 640
 s_mov_b32 s8, s38
 s_and_b32 s9, s39, 0xffff
 s_mov_b32 s10, 2621440
 s_mov_b32 s11, 0x00020000
 s_mov_b32 s12, s40
 s_and_b32 s13, s41, 0xffff
 s_mov_b32 s14, 1280
 s_mov_b32 s15, 0x00020000
 v_lshlrev_b32 v130, 4, v0
 s_lshl_b32 s73, s70, 12
 s_add_u32 s74, s73, 2
 buffer_load_dwordx4 v[96:99], v130, s[8:11], s73 offen offset:0
 buffer_load_dwordx4 v[100:103], v130, s[8:11], s73 offen offset:1024
 buffer_load_dwordx4 v[112:115], v130, s[8:11], s74 offen offset:0
 buffer_load_dwordx4 v[116:119], v130, s[8:11], s74 offen offset:1024
 s_lshl_b32 s3, s70, 1
 buffer_load_ushort v128, off, s[12:15], s3
 s_getpc_b64 s[76:77]
L_ca_30:
 s_add_u32 s76, s76, L_conv0-L_ca_30
 s_addc_u32 s77, s77, -1
 s_swappc_b64 s[76:77], s[76:77]
 s_waitcnt vmcnt(0)
 s_barrier
 s_cmp_lg_u32 s50, 3
 s_cbranch_scc1 L_ar_31
 s_mov_b32 s96, s44
 s_and_b32 s97, s45, 0xffff
 s_mov_b32 s98, 256
 s_mov_b32 s99, 0x00020000
 v_mov_b32 v1, 1
 s_mov_b64 exec, 1
 buffer_atomic_add v1, off, s[96:99], 0 offset:8 sc0
 s_waitcnt vmcnt(0)
 v_cmp_eq_u32 vcc, 159, v1
 s_cbranch_vccz L_aw_32
 buffer_store_dword v1, off, s[96:99], 0 offset:136 sc1
L_aw_32:
 s_mov_b64 exec, -1
L_ar_31:
L_help_done:
 s_cmp_lg_u32 s50, 0
 s_cbranch_scc1 L_ww_33
 s_mov_b32 s96, s44
 s_and_b32 s97, s45, 0xffff
 s_mov_b32 s98, 256
 s_mov_b32 s99, 0x00020000
 v_mov_b32 v1, 132
 s_mov_b32 s51, 0
 s_mov_b64 exec, 1
L_wb_34:
 buffer_load_dword v2, v1, s[96:99], 0 offen sc1
 s_waitcnt vmcnt(0)
 v_cmp_eq_u32 vcc, 0, v2
 s_cbranch_vccz L_wbd_35
 s_sleep 2
 s_add_u32 s51, s51, 1
 s_cmp_lt_u32 s51, 131072
 s_cbranch_scc1 L_wb_34
 s_branch L_bail
L_wbd_35:
 s_mov_b64 exec, -1
L_ww_33:
 s_barrier
 s_cmp_eq_u32 s83, 0
 s_cbranch_scc1 L_t4
 s_cmp_eq_u32 s83, 1
 s_cbranch_scc1 L_wo
 s_branch L_att
L_qkvq:
 s_mul_i32 s57, s50, 40960
 s_mul_i32 s62, s52, 3
 s_add_u32 s62, s62, s53
 s_mul_i32 s3, s62, 13108
 s_lshr_b32 s3, s3, 16
 s_mul_i32 s3, s3, 5
 s_sub_u32 s55, s62, s3
 s_add_u32 s64, s55, 0
 s_sub_u32 s3, s64, 5
 s_cmp_ge_u32 s64, 5
 s_cselect_b32 s64, s3, s64
 s_add_u32 s65, s55, 1
 s_sub_u32 s3, s65, 5
 s_cmp_ge_u32 s65, 5
 s_cselect_b32 s65, s3, s65
 s_add_u32 s66, s55, 2
 s_sub_u32 s3, s66, 5
 s_cmp_ge_u32 s66, 5
 s_cselect_b32 s66, s3, s66
 s_add_u32 s67, s55, 3
 s_sub_u32 s3, s67, 5
 s_cmp_ge_u32 s67, 5
 s_cselect_b32 s67, s3, s67
 s_add_u32 s68, s55, 4
 s_sub_u32 s3, s68, 5
 s_cmp_ge_u32 s68, 5
 s_cselect_b32 s68, s3, s68
 s_lshl_b32 s55, s52, 8
 v_lshrrev_b32 v4, 4, v0
 s_mov_b32 s3, 8192
 v_mul_lo_u32 v4, v4, s3
 v_lshrrev_b32 v3, 3, v0
 v_and_b32 v3, 6, v3
 v_xor_b32 v3, v3, v0
 v_and_b32 v3, 15, v3
 v_lshl_add_u32 v4, v3, 4, v4
 v_xor_b32 v5, 128, v4
 s_lshl_b32 s57, s50, 13
 s_mul_i32 s3, s50, 262144
 s_add_u32 s55, s55, s3
 s_mul_i32 s51, s64, 1048576
 s_add_u32 s51, s51, s55
 s_add_u32 m0, s57, 0
 s_nop 0
 buffer_load_dwordx4 v4, s[8:11], s51 offen lds
 s_add_u32 s51, s51, 32768
 s_add_u32 m0, s57, 1024
 s_nop 0
 buffer_load_dwordx4 v5, s[8:11], s51 offen lds
 s_add_u32 s51, s51, 32768
 s_add_u32 m0, s57, 2048
 s_nop 0
 buffer_load_dwordx4 v4, s[8:11], s51 offen lds
 s_add_u32 s51, s51, 32768
 s_add_u32 m0, s57, 3072
 s_nop 0
 buffer_load_dwordx4 v5, s[8:11], s51 offen lds
 s_add_u32 s51, s51, 32768
 s_add_u32 m0, s57, 4096
 s_nop 0
 buffer_load_dwordx4 v4, s[8:11], s51 offen lds
 s_add_u32 s51, s51, 32768
 s_add_u32 m0, s57, 5120
 s_nop 0
 buffer_load_dwordx4 v5, s[8:11], s51 offen lds
 s_add_u32 s51, s51, 32768
 s_add_u32 m0, s57, 6144
 s_nop 0
 buffer_load_dwordx4 v4, s[8:11], s51 offen lds
 s_add_u32 s51, s51, 32768
 s_add_u32 m0, s57, 7168
 s_nop 0
 buffer_load_dwordx4 v5, s[8:11], s51 offen lds
 s_add_u32 s51, s51, 32768
 s_mul_i32 s51, s65, 1048576
 s_add_u32 s51, s51, s55
 s_add_u32 m0, s57, 32768
 s_nop 0
 buffer_load_dwordx4 v4, s[8:11], s51 offen lds
 s_add_u32 s51, s51, 32768
 s_add_u32 m0, s57, 33792
 s_nop 0
 buffer_load_dwordx4 v5, s[8:11], s51 offen lds
 s_add_u32 s51, s51, 32768
 s_add_u32 m0, s57, 34816
 s_nop 0
 buffer_load_dwordx4 v4, s[8:11], s51 offen lds
 s_add_u32 s51, s51, 32768
 s_add_u32 m0, s57, 35840
 s_nop 0
 buffer_load_dwordx4 v5, s[8:11], s51 offen lds
 s_add_u32 s51, s51, 32768
 s_add_u32 m0, s57, 36864
 s_nop 0
 buffer_load_dwordx4 v4, s[8:11], s51 offen lds
 s_add_u32 s51, s51, 32768
 s_add_u32 m0, s57, 37888
 s_nop 0
 buffer_load_dwordx4 v5, s[8:11], s51 offen lds
 s_add_u32 s51, s51, 32768
 s_add_u32 m0, s57, 38912
 s_nop 0
 buffer_load_dwordx4 v4, s[8:11], s51 offen lds
 s_add_u32 s51, s51, 32768
 s_add_u32 m0, s57, 39936
 s_nop 0
 buffer_load_dwordx4 v5, s[8:11], s51 offen lds
 s_add_u32 s51, s51, 32768
 s_mul_i32 s51, s66, 1048576
 s_add_u32 s51, s51, s55
 s_add_u32 m0, s57, 65536
 s_nop 0
 buffer_load_dwordx4 v4, s[8:11], s51 offen lds
 s_add_u32 s51, s51, 32768
 s_add_u32 m0, s57, 66560
 s_nop 0
 buffer_load_dwordx4 v5, s[8:11], s51 offen lds
 s_add_u32 s51, s51, 32768
 s_add_u32 m0, s57, 67584
 s_nop 0
 buffer_load_dwordx4 v4, s[8:11], s51 offen lds
 s_add_u32 s51, s51, 32768
 s_add_u32 m0, s57, 68608
 s_nop 0
 buffer_load_dwordx4 v5, s[8:11], s51 offen lds
 s_add_u32 s51, s51, 32768
 s_add_u32 m0, s57, 69632
 s_nop 0
 buffer_load_dwordx4 v4, s[8:11], s51 offen lds
 s_add_u32 s51, s51, 32768
 s_add_u32 m0, s57, 70656
 s_nop 0
 buffer_load_dwordx4 v5, s[8:11], s51 offen lds
 s_add_u32 s51, s51, 32768
 s_add_u32 m0, s57, 71680
 s_nop 0
 buffer_load_dwordx4 v4, s[8:11], s51 offen lds
 s_add_u32 s51, s51, 32768
 s_add_u32 m0, s57, 72704
 s_nop 0
 buffer_load_dwordx4 v5, s[8:11], s51 offen lds
 s_add_u32 s51, s51, 32768
 s_mul_i32 s51, s67, 1048576
 s_add_u32 s51, s51, s55
 s_add_u32 m0, s57, 98304
 s_nop 0
 buffer_load_dwordx4 v4, s[8:11], s51 offen lds
 s_add_u32 s51, s51, 32768
 s_add_u32 m0, s57, 99328
 s_nop 0
 buffer_load_dwordx4 v5, s[8:11], s51 offen lds
 s_add_u32 s51, s51, 32768
 s_add_u32 m0, s57, 100352
 s_nop 0
 buffer_load_dwordx4 v4, s[8:11], s51 offen lds
 s_add_u32 s51, s51, 32768
 s_add_u32 m0, s57, 101376
 s_nop 0
 buffer_load_dwordx4 v5, s[8:11], s51 offen lds
 s_add_u32 s51, s51, 32768
 s_add_u32 m0, s57, 102400
 s_nop 0
 buffer_load_dwordx4 v4, s[8:11], s51 offen lds
 s_add_u32 s51, s51, 32768
 s_add_u32 m0, s57, 103424
 s_nop 0
 buffer_load_dwordx4 v5, s[8:11], s51 offen lds
 s_add_u32 s51, s51, 32768
 s_add_u32 m0, s57, 104448
 s_nop 0
 buffer_load_dwordx4 v4, s[8:11], s51 offen lds
 s_add_u32 s51, s51, 32768
 s_add_u32 m0, s57, 105472
 s_nop 0
 buffer_load_dwordx4 v5, s[8:11], s51 offen lds
 s_add_u32 s51, s51, 32768
 s_mul_i32 s51, s68, 1048576
 s_add_u32 s51, s51, s55
 s_add_u32 m0, s57, 131072
 s_nop 0
 buffer_load_dwordx4 v4, s[8:11], s51 offen lds
 s_add_u32 s51, s51, 32768
 s_add_u32 m0, s57, 132096
 s_nop 0
 buffer_load_dwordx4 v5, s[8:11], s51 offen lds
 s_add_u32 s51, s51, 32768
 s_add_u32 m0, s57, 133120
 s_nop 0
 buffer_load_dwordx4 v4, s[8:11], s51 offen lds
 s_add_u32 s51, s51, 32768
 s_add_u32 m0, s57, 134144
 s_nop 0
 buffer_load_dwordx4 v5, s[8:11], s51 offen lds
 s_add_u32 s51, s51, 32768
 s_add_u32 m0, s57, 135168
 s_nop 0
 buffer_load_dwordx4 v4, s[8:11], s51 offen lds
 s_add_u32 s51, s51, 32768
 s_add_u32 m0, s57, 136192
 s_nop 0
 buffer_load_dwordx4 v5, s[8:11], s51 offen lds
 s_add_u32 s51, s51, 32768
 s_add_u32 m0, s57, 137216
 s_nop 0
 buffer_load_dwordx4 v4, s[8:11], s51 offen lds
 s_add_u32 s51, s51, 32768
 s_add_u32 m0, s57, 138240
 s_nop 0
 buffer_load_dwordx4 v5, s[8:11], s51 offen lds
 s_add_u32 s51, s51, 32768
 s_mov_b32 s96, s44
 s_and_b32 s97, s45, 0xffff
 s_mov_b32 s98, 256
 s_mov_b32 s99, 0x00020000
 buffer_load_dword v30, off, s[96:99], 0 offset:132 sc1
 v_lshrrev_b32 v2, 3, v0
 v_and_b32 v2, 4, v2
 v_bfe_u32 v3, v0, 2, 2
 v_or_b32 v2, v2, v3
 v_bfe_u32 v3, v0, 4, 1
 v_xor_b32 v3, v3, v2
 s_lshl_b32 s3, s50, 1
 v_xor_b32 v3, s3, v3
 v_lshlrev_b32 v2, 8, v2
 v_lshl_add_u32 v2, v3, 5, v2
 v_and_b32 v3, 3, v0
 v_lshl_add_u32 v2, v3, 3, v2
 s_waitcnt vmcnt(32)
 s_barrier
 ds_read_b64_tr_b16 a[0:1], v2 offset:0
 ds_read_b64_tr_b16 a[2:3], v2 offset:4096
 ds_read_b64_tr_b16 a[4:5], v2 offset:2048
 ds_read_b64_tr_b16 a[6:7], v2 offset:6144
 ds_read_b64_tr_b16 a[8:9], v2 offset:8192
 ds_read_b64_tr_b16 a[10:11], v2 offset:12288
 ds_read_b64_tr_b16 a[12:13], v2 offset:10240
 ds_read_b64_tr_b16 a[14:15], v2 offset:14336
 ds_read_b64_tr_b16 a[16:17], v2 offset:16384
 ds_read_b64_tr_b16 a[18:19], v2 offset:20480
 ds_read_b64_tr_b16 a[20:21], v2 offset:18432
 ds_read_b64_tr_b16 a[22:23], v2 offset:22528
 ds_read_b64_tr_b16 a[24:25], v2 offset:24576
 ds_read_b64_tr_b16 a[26:27], v2 offset:28672
 ds_read_b64_tr_b16 a[28:29], v2 offset:26624
 ds_read_b64_tr_b16 a[30:31], v2 offset:30720
 v_add_u32 v2, 0x8000, v2
 s_waitcnt vmcnt(24)
 s_barrier
 ds_read_b64_tr_b16 a[32:33], v2 offset:0
 ds_read_b64_tr_b16 a[34:35], v2 offset:4096
 ds_read_b64_tr_b16 a[36:37], v2 offset:2048
 ds_read_b64_tr_b16 a[38:39], v2 offset:6144
 ds_read_b64_tr_b16 a[40:41], v2 offset:8192
 ds_read_b64_tr_b16 a[42:43], v2 offset:12288
 ds_read_b64_tr_b16 a[44:45], v2 offset:10240
 ds_read_b64_tr_b16 a[46:47], v2 offset:14336
 ds_read_b64_tr_b16 a[48:49], v2 offset:16384
 ds_read_b64_tr_b16 a[50:51], v2 offset:20480
 ds_read_b64_tr_b16 a[52:53], v2 offset:18432
 ds_read_b64_tr_b16 a[54:55], v2 offset:22528
 ds_read_b64_tr_b16 a[56:57], v2 offset:24576
 ds_read_b64_tr_b16 a[58:59], v2 offset:28672
 ds_read_b64_tr_b16 a[60:61], v2 offset:26624
 ds_read_b64_tr_b16 a[62:63], v2 offset:30720
 v_add_u32 v2, 0x8000, v2
 s_waitcnt vmcnt(16)
 s_barrier
 ds_read_b64_tr_b16 a[64:65], v2 offset:0
 ds_read_b64_tr_b16 a[66:67], v2 offset:4096
 ds_read_b64_tr_b16 a[68:69], v2 offset:2048
 ds_read_b64_tr_b16 a[70:71], v2 offset:6144
 ds_read_b64_tr_b16 a[72:73], v2 offset:8192
 ds_read_b64_tr_b16 a[74:75], v2 offset:12288
 ds_read_b64_tr_b16 a[76:77], v2 offset:10240
 ds_read_b64_tr_b16 a[78:79], v2 offset:14336
 ds_read_b64_tr_b16 a[80:81], v2 offset:16384
 ds_read_b64_tr_b16 a[82:83], v2 offset:20480
 ds_read_b64_tr_b16 a[84:85], v2 offset:18432
 ds_read_b64_tr_b16 a[86:87], v2 offset:22528
 ds_read_b64_tr_b16 a[88:89], v2 offset:24576
 ds_read_b64_tr_b16 a[90:91], v2 offset:28672
 ds_read_b64_tr_b16 a[92:93], v2 offset:26624
 ds_read_b64_tr_b16 a[94:95], v2 offset:30720
 v_add_u32 v2, 0x8000, v2
 s_waitcnt vmcnt(8)
 s_barrier
 ds_read_b64_tr_b16 a[96:97], v2 offset:0
 ds_read_b64_tr_b16 a[98:99], v2 offset:4096
 ds_read_b64_tr_b16 a[100:101], v2 offset:2048
 ds_read_b64_tr_b16 a[102:103], v2 offset:6144
 ds_read_b64_tr_b16 a[104:105], v2 offset:8192
 ds_read_b64_tr_b16 a[106:107], v2 offset:12288
 ds_read_b64_tr_b16 a[108:109], v2 offset:10240
 ds_read_b64_tr_b16 a[110:111], v2 offset:14336
 ds_read_b64_tr_b16 a[112:113], v2 offset:16384
 ds_read_b64_tr_b16 a[114:115], v2 offset:20480
 ds_read_b64_tr_b16 a[116:117], v2 offset:18432
 ds_read_b64_tr_b16 a[118:119], v2 offset:22528
 ds_read_b64_tr_b16 a[120:121], v2 offset:24576
 ds_read_b64_tr_b16 a[122:123], v2 offset:28672
 ds_read_b64_tr_b16 a[124:125], v2 offset:26624
 ds_read_b64_tr_b16 a[126:127], v2 offset:30720
 v_add_u32 v2, 0x8000, v2
 s_waitcnt vmcnt(0)
 s_barrier
 ds_read_b64_tr_b16 a[128:129], v2 offset:0
 ds_read_b64_tr_b16 a[130:131], v2 offset:4096
 ds_read_b64_tr_b16 a[132:133], v2 offset:2048
 ds_read_b64_tr_b16 a[134:135], v2 offset:6144
 ds_read_b64_tr_b16 a[136:137], v2 offset:8192
 ds_read_b64_tr_b16 a[138:139], v2 offset:12288
 ds_read_b64_tr_b16 a[140:141], v2 offset:10240
 ds_read_b64_tr_b16 a[142:143], v2 offset:14336
 ds_read_b64_tr_b16 a[144:145], v2 offset:16384
 ds_read_b64_tr_b16 a[146:147], v2 offset:20480
 ds_read_b64_tr_b16 a[148:149], v2 offset:18432
 ds_read_b64_tr_b16 a[150:151], v2 offset:22528
 ds_read_b64_tr_b16 a[152:153], v2 offset:24576
 ds_read_b64_tr_b16 a[154:155], v2 offset:28672
 ds_read_b64_tr_b16 a[156:157], v2 offset:26624
 ds_read_b64_tr_b16 a[158:159], v2 offset:30720
 v_add_u32 v2, 0x8000, v2
 s_waitcnt lgkmcnt(0)
 s_barrier
 v_cmp_eq_u32 vcc, 0, v30
 s_cbranch_vccz L_qa_36
 s_mov_b32 s96, s44
 s_and_b32 s97, s45, 0xffff
 s_mov_b32 s98, 256
 s_mov_b32 s99, 0x00020000
 v_mov_b32 v1, 132
 s_mov_b32 s51, 0
 s_mov_b64 exec, 1
L_wb_37:
 buffer_load_dword v2, v1, s[96:99], 0 offen sc1
 s_waitcnt vmcnt(0)
 v_cmp_eq_u32 vcc, 0, v2
 s_cbranch_vccz L_wbd_38
 s_sleep 2
 s_add_u32 s51, s51, 1
 s_cmp_lt_u32 s51, 131072
 s_cbranch_scc1 L_wb_37
 s_branch L_bail
L_wbd_38:
 s_mov_b64 exec, -1
L_qa_36:
 s_lshl_b32 s64, s64, 8
 s_lshl_b32 s65, s65, 8
 s_lshl_b32 s66, s66, 8
 s_lshl_b32 s67, s67, 8
 s_lshl_b32 s68, s68, 8
 s_cmp_eq_u32 s53, 0
 s_cselect_b32 s78, 2, 3
 s_mov_b32 s79, 0
 v_lshrrev_b32 v1, 4, v0
 s_mov_b32 s3, 1280
 v_mul_lo_u32 v1, v1, s3
 v_and_b32 v3, 15, v0
 v_lshl_add_u32 v1, v3, 4, v1
 v_add_u32 v6, 5120, v1
 v_mov_b32 v24, v6
 v_and_b32 v2, 31, v0
 v_lshlrev_b32 v2, 8, v2
 v_lshrrev_b32 v4, 5, v0
 v_xor_b32 v4, v4, v3
 v_xor_b32 v8, 0, v4
 v_lshl_add_u32 v8, v8, 4, v2
 v_add_u32 v16, 40960, v8
 v_xor_b32 v9, 2, v4
 v_lshl_add_u32 v9, v9, 4, v2
 v_add_u32 v17, 40960, v9
 v_xor_b32 v10, 4, v4
 v_lshl_add_u32 v10, v10, 4, v2
 v_add_u32 v18, 40960, v10
 v_xor_b32 v11, 6, v4
 v_lshl_add_u32 v11, v11, 4, v2
 v_add_u32 v19, 40960, v11
 v_xor_b32 v12, 8, v4
 v_lshl_add_u32 v12, v12, 4, v2
 v_add_u32 v20, 40960, v12
 v_xor_b32 v13, 10, v4
 v_lshl_add_u32 v13, v13, 4, v2
 v_add_u32 v21, 40960, v13
 v_xor_b32 v14, 12, v4
 v_lshl_add_u32 v14, v14, 4, v2
 v_add_u32 v22, 40960, v14
 v_xor_b32 v15, 14, v4
 v_lshl_add_u32 v15, v15, 4, v2
 v_add_u32 v23, 40960, v15
 v_lshrrev_b32 v4, 5, v0
 v_lshlrev_b32 v4, 8, v4
 v_lshl_add_u32 v4, v3, 4, v4
 v_and_b32 v2, 16, v0
 v_lshl_add_u32 v4, v2, 8, v4
 s_lshl_b32 s3, s50, 10
 v_add_u32 v4, s3, v4
 v_mul_u32_u24 v5, 24576, v0
 v_mov_b32 v7, 163776
 v_mul_u32_u24 v30, 16384, v0
 s_lshl_b32 s75, s62, 2
 s_add_u32 s75, s75, s50
 s_and_b32 s100, s52, 1
 s_lshl_b32 s100, s100, 13
 s_lshl_b32 s58, s52, 14
 s_add_u32 s58, s58, s100
 s_add_u32 s58, s58, 8388608
 s_cmp_eq_u32 s53, 0
 s_cselect_b32 s82, 8192, 0
 s_lshl_b32 s59, s52, 8
 s_add_u32 s59, s59, 8192
 s_lshl_b32 s56, s50, 11
 s_mov_b32 s54, 0
 s_mov_b32 s61, 0
 s_mov_b32 s70, s75
 s_mul_i32 s55, s54, 40960
 s_mul_i32 s3, s50, 10240
 s_add_u32 s55, s55, s3
 s_add_u32 s55, s55, 226492416
 s_add_u32 m0, s56, 0
 s_add_u32 s3, s55, s64
 buffer_load_dwordx4 v1, s[4:7], s3 offen sc1 lds
 s_add_u32 m0, s56, 1024
 s_add_u32 s3, s55, s64
 buffer_load_dwordx4 v24, s[4:7], s3 offen sc1 lds
 s_add_u32 m0, s56, 8192
 s_add_u32 s3, s55, s65
 buffer_load_dwordx4 v1, s[4:7], s3 offen sc1 lds
 s_add_u32 m0, s56, 9216
 s_add_u32 s3, s55, s65
 buffer_load_dwordx4 v24, s[4:7], s3 offen sc1 lds
 s_add_u32 m0, s56, 16384
 s_add_u32 s3, s55, s66
 buffer_load_dwordx4 v1, s[4:7], s3 offen sc1 lds
 s_add_u32 m0, s56, 17408
 s_add_u32 s3, s55, s66
 buffer_load_dwordx4 v24, s[4:7], s3 offen sc1 lds
 s_add_u32 m0, s56, 24576
 s_add_u32 s3, s55, s67
 buffer_load_dwordx4 v1, s[4:7], s3 offen sc1 lds
 s_add_u32 m0, s56, 25600
 s_add_u32 s3, s55, s67
 buffer_load_dwordx4 v24, s[4:7], s3 offen sc1 lds
 s_add_u32 m0, s56, 32768
 s_add_u32 s3, s55, s68
 buffer_load_dwordx4 v1, s[4:7], s3 offen sc1 lds
 s_add_u32 m0, s56, 33792
 s_add_u32 s3, s55, s68
 buffer_load_dwordx4 v24, s[4:7], s3 offen sc1 lds
 s_waitcnt vmcnt(0)
L_qkvq_pre:
 s_barrier
 s_mov_b32 s60, s54
 s_add_u32 s54, s54, 1
 s_mul_i32 s55, s54, 40960
 s_mul_i32 s3, s50, 10240
 s_add_u32 s55, s55, s3
 s_add_u32 s55, s55, 226492416
 ds_read_b128 v[32:35], v8 offset:0
 ds_read_b128 v[36:39], v9 offset:0
 ds_read_b128 v[40:43], v10 offset:0
 ds_read_b128 v[44:47], v11 offset:0
 s_waitcnt lgkmcnt(3)
 v_mfma_f32_32x32x16_bf16 v[64:79], a[0:3], v[32:35], 0
 ds_read_b128 v[48:51], v12 offset:0
 s_add_u32 m0, s56, 40960
 s_add_u32 s3, s55, s64
 buffer_load_dwordx4 v1, s[4:7], s3 offen sc1 lds
 s_waitcnt lgkmcnt(3)
 v_mfma_f32_32x32x16_bf16 v[64:79], a[4:7], v[36:39], v[64:79]
 ds_read_b128 v[52:55], v13 offset:0
 s_waitcnt lgkmcnt(3)
 v_mfma_f32_32x32x16_bf16 v[64:79], a[8:11], v[40:43], v[64:79]
 ds_read_b128 v[56:59], v14 offset:0
 s_waitcnt lgkmcnt(3)
 v_mfma_f32_32x32x16_bf16 v[64:79], a[12:15], v[44:47], v[64:79]
 ds_read_b128 v[60:63], v15 offset:0
 s_add_u32 m0, s56, 41984
 s_add_u32 s3, s55, s64
 buffer_load_dwordx4 v24, s[4:7], s3 offen sc1 lds
 s_waitcnt lgkmcnt(3)
 v_mfma_f32_32x32x16_bf16 v[64:79], a[16:19], v[48:51], v[64:79]
 ds_read_b128 v[32:35], v8 offset:8192
 s_waitcnt lgkmcnt(3)
 v_mfma_f32_32x32x16_bf16 v[64:79], a[20:23], v[52:55], v[64:79]
 ds_read_b128 v[36:39], v9 offset:8192
 s_waitcnt lgkmcnt(3)
 v_mfma_f32_32x32x16_bf16 v[64:79], a[24:27], v[56:59], v[64:79]
 ds_read_b128 v[40:43], v10 offset:8192
 s_add_u32 m0, s56, 49152
 s_add_u32 s3, s55, s65
 buffer_load_dwordx4 v1, s[4:7], s3 offen sc1 lds
 s_waitcnt lgkmcnt(3)
 v_mfma_f32_32x32x16_bf16 v[64:79], a[28:31], v[60:63], v[64:79]
 ds_read_b128 v[44:47], v11 offset:8192
 s_waitcnt lgkmcnt(3)
 v_mfma_f32_32x32x16_bf16 v[64:79], a[32:35], v[32:35], v[64:79]
 ds_read_b128 v[48:51], v12 offset:8192
 s_waitcnt lgkmcnt(3)
 v_mfma_f32_32x32x16_bf16 v[64:79], a[36:39], v[36:39], v[64:79]
 ds_read_b128 v[52:55], v13 offset:8192
 s_add_u32 m0, s56, 50176
 s_add_u32 s3, s55, s65
 buffer_load_dwordx4 v24, s[4:7], s3 offen sc1 lds
 s_waitcnt lgkmcnt(3)
 v_mfma_f32_32x32x16_bf16 v[64:79], a[40:43], v[40:43], v[64:79]
 ds_read_b128 v[56:59], v14 offset:8192
 s_waitcnt lgkmcnt(3)
 v_mfma_f32_32x32x16_bf16 v[64:79], a[44:47], v[44:47], v[64:79]
 ds_read_b128 v[60:63], v15 offset:8192
 s_waitcnt lgkmcnt(3)
 v_mfma_f32_32x32x16_bf16 v[64:79], a[48:51], v[48:51], v[64:79]
 ds_read_b128 v[32:35], v8 offset:16384
 s_add_u32 m0, s56, 57344
 s_add_u32 s3, s55, s66
 buffer_load_dwordx4 v1, s[4:7], s3 offen sc1 lds
 s_waitcnt lgkmcnt(3)
 v_mfma_f32_32x32x16_bf16 v[64:79], a[52:55], v[52:55], v[64:79]
 ds_read_b128 v[36:39], v9 offset:16384
 s_waitcnt lgkmcnt(3)
 v_mfma_f32_32x32x16_bf16 v[64:79], a[56:59], v[56:59], v[64:79]
 ds_read_b128 v[40:43], v10 offset:16384
 s_waitcnt lgkmcnt(3)
 v_mfma_f32_32x32x16_bf16 v[64:79], a[60:63], v[60:63], v[64:79]
 ds_read_b128 v[44:47], v11 offset:16384
 s_add_u32 m0, s56, 58368
 s_add_u32 s3, s55, s66
 buffer_load_dwordx4 v24, s[4:7], s3 offen sc1 lds
 s_waitcnt lgkmcnt(3)
 v_mfma_f32_32x32x16_bf16 v[64:79], a[64:67], v[32:35], v[64:79]
 ds_read_b128 v[48:51], v12 offset:16384
 s_waitcnt lgkmcnt(3)
 v_mfma_f32_32x32x16_bf16 v[64:79], a[68:71], v[36:39], v[64:79]
 ds_read_b128 v[52:55], v13 offset:16384
 s_waitcnt lgkmcnt(3)
 v_mfma_f32_32x32x16_bf16 v[64:79], a[72:75], v[40:43], v[64:79]
 ds_read_b128 v[56:59], v14 offset:16384
 s_add_u32 m0, s56, 65536
 s_add_u32 s3, s55, s67
 buffer_load_dwordx4 v1, s[4:7], s3 offen sc1 lds
 s_waitcnt lgkmcnt(3)
 v_mfma_f32_32x32x16_bf16 v[64:79], a[76:79], v[44:47], v[64:79]
 ds_read_b128 v[60:63], v15 offset:16384
 s_waitcnt vmcnt(7)
 s_cmp_eq_u32 s61, 0
 s_cbranch_scc1 L_pf_39
 s_lshl_b32 s3, s61, 2
 s_add_u32 s3, s3, s59
 s_sub_u32 s3, s3, 4
 v_mov_b32 v3, 1
 s_mov_b64 exec, s[78:79]
 buffer_atomic_add v3, v30, s[4:7], s3 offen
 s_mov_b64 exec, -1
 s_mov_b32 s61, 0
L_pf_39:
 s_waitcnt lgkmcnt(3)
 v_mfma_f32_32x32x16_bf16 v[64:79], a[80:83], v[48:51], v[64:79]
 ds_read_b128 v[32:35], v8 offset:24576
 s_waitcnt lgkmcnt(3)
 v_mfma_f32_32x32x16_bf16 v[64:79], a[84:87], v[52:55], v[64:79]
 ds_read_b128 v[36:39], v9 offset:24576
 s_add_u32 m0, s56, 66560
 s_add_u32 s3, s55, s67
 buffer_load_dwordx4 v24, s[4:7], s3 offen sc1 lds
 s_waitcnt lgkmcnt(3)
 v_mfma_f32_32x32x16_bf16 v[64:79], a[88:91], v[56:59], v[64:79]
 ds_read_b128 v[40:43], v10 offset:24576
 s_waitcnt lgkmcnt(3)
 v_mfma_f32_32x32x16_bf16 v[64:79], a[92:95], v[60:63], v[64:79]
 ds_read_b128 v[44:47], v11 offset:24576
 s_waitcnt lgkmcnt(3)
 v_mfma_f32_32x32x16_bf16 v[64:79], a[96:99], v[32:35], v[64:79]
 ds_read_b128 v[48:51], v12 offset:24576
 s_add_u32 m0, s56, 73728
 s_add_u32 s3, s55, s68
 buffer_load_dwordx4 v1, s[4:7], s3 offen sc1 lds
 s_waitcnt lgkmcnt(3)
 v_mfma_f32_32x32x16_bf16 v[64:79], a[100:103], v[36:39], v[64:79]
 ds_read_b128 v[52:55], v13 offset:24576
 s_waitcnt lgkmcnt(3)
 v_mfma_f32_32x32x16_bf16 v[64:79], a[104:107], v[40:43], v[64:79]
 ds_read_b128 v[56:59], v14 offset:24576
 s_waitcnt lgkmcnt(3)
 v_mfma_f32_32x32x16_bf16 v[64:79], a[108:111], v[44:47], v[64:79]
 ds_read_b128 v[60:63], v15 offset:24576
 s_add_u32 m0, s56, 74752
 s_add_u32 s3, s55, s68
 buffer_load_dwordx4 v24, s[4:7], s3 offen sc1 lds
 s_waitcnt lgkmcnt(3)
 v_mfma_f32_32x32x16_bf16 v[64:79], a[112:115], v[48:51], v[64:79]
 ds_read_b128 v[32:35], v8 offset:32768
 s_waitcnt lgkmcnt(3)
 v_mfma_f32_32x32x16_bf16 v[64:79], a[116:119], v[52:55], v[64:79]
 ds_read_b128 v[36:39], v9 offset:32768
 s_waitcnt lgkmcnt(3)
 v_mfma_f32_32x32x16_bf16 v[64:79], a[120:123], v[56:59], v[64:79]
 ds_read_b128 v[40:43], v10 offset:32768
 s_waitcnt lgkmcnt(3)
 v_mfma_f32_32x32x16_bf16 v[64:79], a[124:127], v[60:63], v[64:79]
 ds_read_b128 v[44:47], v11 offset:32768
 s_waitcnt lgkmcnt(3)
 v_mfma_f32_32x32x16_bf16 v[64:79], a[128:131], v[32:35], v[64:79]
 ds_read_b128 v[48:51], v12 offset:32768
 s_waitcnt lgkmcnt(3)
 v_mfma_f32_32x32x16_bf16 v[64:79], a[132:135], v[36:39], v[64:79]
 ds_read_b128 v[52:55], v13 offset:32768
 s_waitcnt lgkmcnt(3)
 v_mfma_f32_32x32x16_bf16 v[64:79], a[136:139], v[40:43], v[64:79]
 ds_read_b128 v[56:59], v14 offset:32768
 s_waitcnt lgkmcnt(3)
 v_mfma_f32_32x32x16_bf16 v[64:79], a[140:143], v[44:47], v[64:79]
 ds_read_b128 v[60:63], v15 offset:32768
 s_waitcnt lgkmcnt(3)
 v_mfma_f32_32x32x16_bf16 v[64:79], a[144:147], v[48:51], v[64:79]
 s_waitcnt lgkmcnt(2)
 v_mfma_f32_32x32x16_bf16 v[64:79], a[148:151], v[52:55], v[64:79]
 s_waitcnt lgkmcnt(1)
 v_mfma_f32_32x32x16_bf16 v[64:79], a[152:155], v[56:59], v[64:79]
 s_waitcnt lgkmcnt(0)
 v_mfma_f32_32x32x16_bf16 v[64:79], a[156:159], v[60:63], v[64:79]
 s_lshl_b32 s3, s60, 19
 s_add_u32 s3, s3, s58
 s_xor_b32 s3, s3, s82
 s_nop 8
 v_cvt_pk_bf16_f32 v80, v64, v65
 v_cvt_pk_bf16_f32 v81, v66, v67
 v_cvt_pk_bf16_f32 v82, v72, v73
 v_cvt_pk_bf16_f32 v83, v74, v75
 buffer_store_dwordx4 v[80:83], v4, s[4:7], s3 offen offset:0 sc1
 v_cvt_pk_bf16_f32 v84, v68, v69
 v_cvt_pk_bf16_f32 v85, v70, v71
 v_cvt_pk_bf16_f32 v86, v76, v77
 v_cvt_pk_bf16_f32 v87, v78, v79
 buffer_store_dwordx4 v[84:87], v4, s[4:7], s3 offen offset:512 sc1
 s_mov_b32 s61, s54
 s_cmp_lg_u32 s54, 1
 s_cbranch_scc1 L_f1_40
 s_waitcnt vmcnt(0)
 s_cmp_eq_u32 s61, 0
 s_cbranch_scc1 L_pf_41
 s_lshl_b32 s3, s61, 2
 s_add_u32 s3, s3, s59
 s_sub_u32 s3, s3, 4
 v_mov_b32 v3, 1
 s_mov_b64 exec, s[78:79]
 buffer_atomic_add v3, v30, s[4:7], s3 offen
 s_mov_b64 exec, -1
 s_mov_b32 s61, 0
L_pf_41:
 s_mov_b32 s8, s38
 s_and_b32 s9, s39, 0xffff
 s_mov_b32 s10, 2621440
 s_mov_b32 s11, 0x00020000
 s_mov_b32 s12, s40
 s_and_b32 s13, s41, 0xffff
 s_mov_b32 s14, 1280
 s_mov_b32 s15, 0x00020000
 v_lshlrev_b32 v130, 4, v0
 s_lshl_b32 s73, s70, 12
 s_add_u32 s74, s73, 2
 buffer_load_dwordx4 v[96:99], v130, s[8:11], s73 offen offset:0
 buffer_load_dwordx4 v[100:103], v130, s[8:11], s73 offen offset:1024
 buffer_load_dwordx4 v[112:115], v130, s[8:11], s74 offen offset:0
 buffer_load_dwordx4 v[116:119], v130, s[8:11], s74 offen offset:1024
 s_lshl_b32 s3, s70, 1
 buffer_load_ushort v128, off, s[12:15], s3
 s_branch L_f2_42
L_f1_40:
 s_waitcnt vmcnt(2)
L_f2_42:
 s_barrier
 s_mov_b32 s60, s54
 s_add_u32 s54, s54, 1
 s_mul_i32 s55, s54, 40960
 s_mul_i32 s3, s50, 10240
 s_add_u32 s55, s55, s3
 s_add_u32 s55, s55, 226492416
 ds_read_b128 v[32:35], v16 offset:0
 ds_read_b128 v[36:39], v17 offset:0
 ds_read_b128 v[40:43], v18 offset:0
 ds_read_b128 v[44:47], v19 offset:0
 s_waitcnt lgkmcnt(3)
 v_mfma_f32_32x32x16_bf16 v[64:79], a[0:3], v[32:35], 0
 ds_read_b128 v[48:51], v20 offset:0
 s_add_u32 m0, s56, 0
 s_add_u32 s3, s55, s64
 buffer_load_dwordx4 v1, s[4:7], s3 offen sc1 lds
 s_waitcnt lgkmcnt(3)
 v_mfma_f32_32x32x16_bf16 v[64:79], a[4:7], v[36:39], v[64:79]
 ds_read_b128 v[52:55], v21 offset:0
 s_waitcnt lgkmcnt(3)
 v_mfma_f32_32x32x16_bf16 v[64:79], a[8:11], v[40:43], v[64:79]
 ds_read_b128 v[56:59], v22 offset:0
 s_waitcnt lgkmcnt(3)
 v_mfma_f32_32x32x16_bf16 v[64:79], a[12:15], v[44:47], v[64:79]
 ds_read_b128 v[60:63], v23 offset:0
 s_add_u32 m0, s56, 1024
 s_add_u32 s3, s55, s64
 buffer_load_dwordx4 v24, s[4:7], s3 offen sc1 lds
 s_waitcnt lgkmcnt(3)
 v_mfma_f32_32x32x16_bf16 v[64:79], a[16:19], v[48:51], v[64:79]
 ds_read_b128 v[32:35], v16 offset:8192
 s_waitcnt lgkmcnt(3)
 v_mfma_f32_32x32x16_bf16 v[64:79], a[20:23], v[52:55], v[64:79]
 ds_read_b128 v[36:39], v17 offset:8192
 s_waitcnt lgkmcnt(3)
 v_mfma_f32_32x32x16_bf16 v[64:79], a[24:27], v[56:59], v[64:79]
 ds_read_b128 v[40:43], v18 offset:8192
 s_add_u32 m0, s56, 8192
 s_add_u32 s3, s55, s65
 buffer_load_dwordx4 v1, s[4:7], s3 offen sc1 lds
 s_waitcnt lgkmcnt(3)
 v_mfma_f32_32x32x16_bf16 v[64:79], a[28:31], v[60:63], v[64:79]
 ds_read_b128 v[44:47], v19 offset:8192
 s_waitcnt lgkmcnt(3)
 v_mfma_f32_32x32x16_bf16 v[64:79], a[32:35], v[32:35], v[64:79]
 ds_read_b128 v[48:51], v20 offset:8192
 s_waitcnt lgkmcnt(3)
 v_mfma_f32_32x32x16_bf16 v[64:79], a[36:39], v[36:39], v[64:79]
 ds_read_b128 v[52:55], v21 offset:8192
 s_add_u32 m0, s56, 9216
 s_add_u32 s3, s55, s65
 buffer_load_dwordx4 v24, s[4:7], s3 offen sc1 lds
 s_waitcnt lgkmcnt(3)
 v_mfma_f32_32x32x16_bf16 v[64:79], a[40:43], v[40:43], v[64:79]
 ds_read_b128 v[56:59], v22 offset:8192
 s_waitcnt lgkmcnt(3)
 v_mfma_f32_32x32x16_bf16 v[64:79], a[44:47], v[44:47], v[64:79]
 ds_read_b128 v[60:63], v23 offset:8192
 s_waitcnt lgkmcnt(3)
 v_mfma_f32_32x32x16_bf16 v[64:79], a[48:51], v[48:51], v[64:79]
 ds_read_b128 v[32:35], v16 offset:16384
 s_add_u32 m0, s56, 16384
 s_add_u32 s3, s55, s66
 buffer_load_dwordx4 v1, s[4:7], s3 offen sc1 lds
 s_waitcnt lgkmcnt(3)
 v_mfma_f32_32x32x16_bf16 v[64:79], a[52:55], v[52:55], v[64:79]
 ds_read_b128 v[36:39], v17 offset:16384
 s_waitcnt lgkmcnt(3)
 v_mfma_f32_32x32x16_bf16 v[64:79], a[56:59], v[56:59], v[64:79]
 ds_read_b128 v[40:43], v18 offset:16384
 s_waitcnt lgkmcnt(3)
 v_mfma_f32_32x32x16_bf16 v[64:79], a[60:63], v[60:63], v[64:79]
 ds_read_b128 v[44:47], v19 offset:16384
 s_add_u32 m0, s56, 17408
 s_add_u32 s3, s55, s66
 buffer_load_dwordx4 v24, s[4:7], s3 offen sc1 lds
 s_waitcnt lgkmcnt(3)
 v_mfma_f32_32x32x16_bf16 v[64:79], a[64:67], v[32:35], v[64:79]
 ds_read_b128 v[48:51], v20 offset:16384
 s_waitcnt lgkmcnt(3)
 v_mfma_f32_32x32x16_bf16 v[64:79], a[68:71], v[36:39], v[64:79]
 ds_read_b128 v[52:55], v21 offset:16384
 s_waitcnt lgkmcnt(3)
 v_mfma_f32_32x32x16_bf16 v[64:79], a[72:75], v[40:43], v[64:79]
 ds_read_b128 v[56:59], v22 offset:16384
 s_add_u32 m0, s56, 24576
 s_add_u32 s3, s55, s67
 buffer_load_dwordx4 v1, s[4:7], s3 offen sc1 lds
 s_waitcnt lgkmcnt(3)
 v_mfma_f32_32x32x16_bf16 v[64:79], a[76:79], v[44:47], v[64:79]
 ds_read_b128 v[60:63], v23 offset:16384
 s_waitcnt vmcnt(7)
 s_cmp_eq_u32 s61, 0
 s_cbranch_scc1 L_pf_43
 s_lshl_b32 s3, s61, 2
 s_add_u32 s3, s3, s59
 s_sub_u32 s3, s3, 4
 v_mov_b32 v3, 1
 s_mov_b64 exec, s[78:79]
 buffer_atomic_add v3, v30, s[4:7], s3 offen
 s_mov_b64 exec, -1
 s_mov_b32 s61, 0
L_pf_43:
 s_waitcnt lgkmcnt(3)
 v_mfma_f32_32x32x16_bf16 v[64:79], a[80:83], v[48:51], v[64:79]
 ds_read_b128 v[32:35], v16 offset:24576
 s_waitcnt lgkmcnt(3)
 v_mfma_f32_32x32x16_bf16 v[64:79], a[84:87], v[52:55], v[64:79]
 ds_read_b128 v[36:39], v17 offset:24576
 s_add_u32 m0, s56, 25600
 s_add_u32 s3, s55, s67
 buffer_load_dwordx4 v24, s[4:7], s3 offen sc1 lds
 s_waitcnt lgkmcnt(3)
 v_mfma_f32_32x32x16_bf16 v[64:79], a[88:91], v[56:59], v[64:79]
 ds_read_b128 v[40:43], v18 offset:24576
 s_waitcnt lgkmcnt(3)
 v_mfma_f32_32x32x16_bf16 v[64:79], a[92:95], v[60:63], v[64:79]
 ds_read_b128 v[44:47], v19 offset:24576
 s_waitcnt lgkmcnt(3)
 v_mfma_f32_32x32x16_bf16 v[64:79], a[96:99], v[32:35], v[64:79]
 ds_read_b128 v[48:51], v20 offset:24576
 s_add_u32 m0, s56, 32768
 s_add_u32 s3, s55, s68
 buffer_load_dwordx4 v1, s[4:7], s3 offen sc1 lds
 s_waitcnt lgkmcnt(3)
 v_mfma_f32_32x32x16_bf16 v[64:79], a[100:103], v[36:39], v[64:79]
 ds_read_b128 v[52:55], v21 offset:24576
 s_waitcnt lgkmcnt(3)
 v_mfma_f32_32x32x16_bf16 v[64:79], a[104:107], v[40:43], v[64:79]
 ds_read_b128 v[56:59], v22 offset:24576
 s_waitcnt lgkmcnt(3)
 v_mfma_f32_32x32x16_bf16 v[64:79], a[108:111], v[44:47], v[64:79]
 ds_read_b128 v[60:63], v23 offset:24576
 s_add_u32 m0, s56, 33792
 s_add_u32 s3, s55, s68
 buffer_load_dwordx4 v24, s[4:7], s3 offen sc1 lds
 s_waitcnt lgkmcnt(3)
 v_mfma_f32_32x32x16_bf16 v[64:79], a[112:115], v[48:51], v[64:79]
 ds_read_b128 v[32:35], v16 offset:32768
 s_waitcnt lgkmcnt(3)
 v_mfma_f32_32x32x16_bf16 v[64:79], a[116:119], v[52:55], v[64:79]
 ds_read_b128 v[36:39], v17 offset:32768
 s_waitcnt lgkmcnt(3)
 v_mfma_f32_32x32x16_bf16 v[64:79], a[120:123], v[56:59], v[64:79]
 ds_read_b128 v[40:43], v18 offset:32768
 s_waitcnt lgkmcnt(3)
 v_mfma_f32_32x32x16_bf16 v[64:79], a[124:127], v[60:63], v[64:79]
 ds_read_b128 v[44:47], v19 offset:32768
 s_waitcnt lgkmcnt(3)
 v_mfma_f32_32x32x16_bf16 v[64:79], a[128:131], v[32:35], v[64:79]
 ds_read_b128 v[48:51], v20 offset:32768
 s_waitcnt lgkmcnt(3)
 v_mfma_f32_32x32x16_bf16 v[64:79], a[132:135], v[36:39], v[64:79]
 ds_read_b128 v[52:55], v21 offset:32768
 s_waitcnt lgkmcnt(3)
 v_mfma_f32_32x32x16_bf16 v[64:79], a[136:139], v[40:43], v[64:79]
 ds_read_b128 v[56:59], v22 offset:32768
 s_waitcnt lgkmcnt(3)
 v_mfma_f32_32x32x16_bf16 v[64:79], a[140:143], v[44:47], v[64:79]
 ds_read_b128 v[60:63], v23 offset:32768
 s_waitcnt lgkmcnt(3)
 v_mfma_f32_32x32x16_bf16 v[64:79], a[144:147], v[48:51], v[64:79]
 s_waitcnt lgkmcnt(2)
 v_mfma_f32_32x32x16_bf16 v[64:79], a[148:151], v[52:55], v[64:79]
 s_waitcnt lgkmcnt(1)
 v_mfma_f32_32x32x16_bf16 v[64:79], a[152:155], v[56:59], v[64:79]
 s_waitcnt lgkmcnt(0)
 v_mfma_f32_32x32x16_bf16 v[64:79], a[156:159], v[60:63], v[64:79]
 s_lshl_b32 s3, s60, 19
 s_add_u32 s3, s3, s58
 s_xor_b32 s3, s3, s82
 s_nop 8
 v_cvt_pk_bf16_f32 v88, v64, v65
 v_cvt_pk_bf16_f32 v89, v66, v67
 v_cvt_pk_bf16_f32 v90, v72, v73
 v_cvt_pk_bf16_f32 v91, v74, v75
 buffer_store_dwordx4 v[88:91], v4, s[4:7], s3 offen offset:0 sc1
 v_cvt_pk_bf16_f32 v92, v68, v69
 v_cvt_pk_bf16_f32 v93, v70, v71
 v_cvt_pk_bf16_f32 v94, v76, v77
 v_cvt_pk_bf16_f32 v95, v78, v79
 buffer_store_dwordx4 v[92:95], v4, s[4:7], s3 offen offset:512 sc1
 s_mov_b32 s61, s54
 s_waitcnt vmcnt(2)
 s_cmp_lg_u32 s54, 4
 s_cbranch_scc1 L_cv_44
 s_waitcnt vmcnt(0)
 s_cmp_eq_u32 s61, 0
 s_cbranch_scc1 L_pf_45
 s_lshl_b32 s3, s61, 2
 s_add_u32 s3, s3, s59
 s_sub_u32 s3, s3, 4
 v_mov_b32 v3, 1
 s_mov_b64 exec, s[78:79]
 buffer_atomic_add v3, v30, s[4:7], s3 offen
 s_mov_b64 exec, -1
 s_mov_b32 s61, 0
L_pf_45:
 s_mul_i32 s71, s50, 13312
 s_add_u32 s71, s71, 81920
 s_mov_b32 s70, s75
 s_mov_b32 s69, 640
 s_getpc_b64 s[76:77]
L_ca_46:
 s_add_u32 s76, s76, L_conv0-L_ca_46
 s_addc_u32 s77, s77, -1
 s_swappc_b64 s[76:77], s[76:77]
 s_waitcnt vmcnt(0)
 s_barrier
 s_cmp_lg_u32 s50, 3
 s_cbranch_scc1 L_ar_47
 s_mov_b32 s96, s44
 s_and_b32 s97, s45, 0xffff
 s_mov_b32 s98, 256
 s_mov_b32 s99, 0x00020000
 v_mov_b32 v1, 1
 s_mov_b64 exec, 1
 buffer_atomic_add v1, off, s[96:99], 0 offset:8 sc0
 s_waitcnt vmcnt(0)
 v_cmp_eq_u32 vcc, 159, v1
 s_cbranch_vccz L_aw_48
 buffer_store_dword v1, off, s[96:99], 0 offset:136 sc1
L_aw_48:
 s_mov_b64 exec, -1
L_ar_47:
 v_lshrrev_b32 v1, 4, v0
 s_mov_b32 s3, 1280
 v_mul_lo_u32 v1, v1, s3
 v_and_b32 v3, 15, v0
 v_lshl_add_u32 v1, v3, 4, v1
 v_add_u32 v6, 5120, v1
 v_mov_b32 v24, v6
 v_and_b32 v2, 31, v0
 v_lshlrev_b32 v2, 8, v2
 v_lshrrev_b32 v4, 5, v0
 v_xor_b32 v4, v4, v3
 v_xor_b32 v8, 0, v4
 v_lshl_add_u32 v8, v8, 4, v2
 v_add_u32 v16, 40960, v8
 v_xor_b32 v9, 2, v4
 v_lshl_add_u32 v9, v9, 4, v2
 v_add_u32 v17, 40960, v9
 v_xor_b32 v10, 4, v4
 v_lshl_add_u32 v10, v10, 4, v2
 v_add_u32 v18, 40960, v10
 v_xor_b32 v11, 6, v4
 v_lshl_add_u32 v11, v11, 4, v2
 v_add_u32 v19, 40960, v11
 v_xor_b32 v12, 8, v4
 v_lshl_add_u32 v12, v12, 4, v2
 v_add_u32 v20, 40960, v12
 v_xor_b32 v13, 10, v4
 v_lshl_add_u32 v13, v13, 4, v2
 v_add_u32 v21, 40960, v13
 v_xor_b32 v14, 12, v4
 v_lshl_add_u32 v14, v14, 4, v2
 v_add_u32 v22, 40960, v14
 v_xor_b32 v15, 14, v4
 v_lshl_add_u32 v15, v15, 4, v2
 v_add_u32 v23, 40960, v15
 v_lshrrev_b32 v4, 5, v0
 v_lshlrev_b32 v4, 8, v4
 v_lshl_add_u32 v4, v3, 4, v4
 v_and_b32 v2, 16, v0
 v_lshl_add_u32 v4, v2, 8, v4
 s_lshl_b32 s3, s50, 10
 v_add_u32 v4, s3, v4
 v_mul_u32_u24 v5, 24576, v0
 v_mov_b32 v7, 163776
 v_mul_u32_u24 v30, 16384, v0
L_cv_44:
 s_cmp_lg_u32 s54, 10
 s_cbranch_scc1 L_cb_49
 s_cmp_lg_u32 s50, 0
 s_cbranch_scc1 L_ww_50
 s_mov_b32 s96, s44
 s_and_b32 s97, s45, 0xffff
 s_mov_b32 s98, 256
 s_mov_b32 s99, 0x00020000
 v_mov_b32 v25, 200
 s_mov_b32 s51, 0
 s_mov_b64 exec, 1
L_wb_51:
 buffer_load_dword v26, v25, s[96:99], 0 offen sc1
 s_waitcnt vmcnt(0)
 v_cmp_eq_u32 vcc, 0, v26
 s_cbranch_vccz L_wbd_52
 s_sleep 2
 s_add_u32 s51, s51, 1
 s_cmp_lt_u32 s51, 131072
 s_cbranch_scc1 L_wb_51
 s_branch L_bail
L_wbd_52:
 s_mov_b64 exec, -1
L_ww_50:
 s_barrier
L_cb_49:
 s_cmp_lt_u32 s54, 16
 s_cbranch_scc1 L_qkvq_pre
 s_waitcnt vmcnt(0)
 s_cmp_eq_u32 s61, 0
 s_cbranch_scc1 L_pf_54
 s_lshl_b32 s3, s61, 2
 s_add_u32 s3, s3, s59
 s_sub_u32 s3, s3, 4
 v_mov_b32 v3, 1
 s_mov_b64 exec, s[78:79]
 buffer_atomic_add v3, v30, s[4:7], s3 offen
 s_mov_b64 exec, -1
 s_mov_b32 s61, 0
L_pf_54:
 s_lshl_b32 s62, s62, 8
 s_add_u32 s62, s62, 126976
 s_add_u32 s63, s59, 8128
L_qkvq_block:
 s_lshl_b32 s55, s54, 2
 s_add_u32 s55, s55, s62
 s_sub_u32 s55, s55, 64
 s_cmp_lg_u32 s50, 0
 s_cselect_b32 s3, 268435456, s55
 v_mov_b32 v6, 8
 s_mov_b64 exec, 15
 v_mov_b32 v6, 0
 buffer_atomic_add v6, v5, s[4:7], s3 offen sc0
 s_mov_b64 exec, -1
 s_waitcnt vmcnt(0)
 s_cmp_eq_u32 s61, 0
 s_cbranch_scc1 L_pf_57
 s_lshl_b32 s3, s61, 2
 s_add_u32 s3, s3, s59
 s_sub_u32 s3, s3, 4
 v_mov_b32 v3, 1
 s_mov_b64 exec, s[78:79]
 buffer_atomic_add v3, v30, s[4:7], s3 offen
 s_mov_b64 exec, -1
 s_mov_b32 s61, 0
L_pf_57:
 s_cmp_lg_u32 s50, 0
 s_cbranch_scc1 L_w_55
 v_cmp_gt_u32 vcc, 8, v6
 s_cbranch_vccz L_w_55
 s_mov_b32 s51, 0
 s_mov_b64 exec, 15
 v_mov_b32 v28, 0
 buffer_atomic_add v28, v5, s[4:7], s55 offen sc0
 s_sleep 5
L_wc_58:
 v_mov_b32 v29, 0
 buffer_atomic_add v29, v5, s[4:7], s55 offen sc0
 s_waitcnt vmcnt(1)
 v_cmp_gt_u32 vcc, 8, v28
 s_cbranch_vccz L_wcd_59
 v_mov_b32 v28, 0
 buffer_atomic_add v28, v5, s[4:7], s55 offen sc0
 s_waitcnt vmcnt(1)
 v_cmp_gt_u32 vcc, 8, v29
 s_cbranch_vccz L_wcd_59
 s_add_u32 s51, s51, 1
 s_cmp_lt_u32 s51, 131072
 s_cbranch_scc1 L_wc_58
 s_branch L_bail
L_wcd_59:
 s_mov_b64 exec, -1
L_w_55:
 s_barrier
 s_branch L_qkvq_loop
L_qkvq_fast:
 s_cmp_lg_u32 s54, 32
 s_cbranch_scc1 L_c2_61
 s_cmp_lg_u32 s50, 0
 s_cbranch_scc1 L_ww_62
 s_mov_b32 s96, s44
 s_and_b32 s97, s45, 0xffff
 s_mov_b32 s98, 256
 s_mov_b32 s99, 0x00020000
 v_mov_b32 v25, 140
 s_mov_b32 s51, 0
 s_mov_b64 exec, 1
L_wb_63:
 buffer_load_dword v26, v25, s[96:99], 0 offen sc1
 s_waitcnt vmcnt(0)
 v_cmp_eq_u32 vcc, 0, v26
 s_cbranch_vccz L_wbd_64
 s_sleep 2
 s_add_u32 s51, s51, 1
 s_cmp_lt_u32 s51, 131072
 s_cbranch_scc1 L_wb_63
 s_branch L_bail
L_wbd_64:
 s_mov_b64 exec, -1
L_ww_62:
 s_barrier
L_c2_61:
 s_sub_u32 s60, s54, 16
 s_lshl_b32 s70, s54, 2
 s_add_u32 s70, s70, s62
 s_sub_u32 s70, s70, 60
 s_cmp_lg_u32 s50, 0
 s_cselect_b32 s70, 268435456, s70
 s_min_u32 s51, s54, 63
 s_mul_i32 s55, s51, 40960
 s_mul_i32 s3, s50, 10240
 s_add_u32 s55, s55, s3
 s_add_u32 s55, s55, 226492416
 ds_read_b128 v[32:35], v16 offset:0
 ds_read_b128 v[36:39], v17 offset:0
 ds_read_b128 v[40:43], v18 offset:0
 ds_read_b128 v[44:47], v19 offset:0
 s_waitcnt lgkmcnt(3)
 v_mfma_f32_32x32x16_bf16 v[64:79], a[0:3], v[32:35], 0
 ds_read_b128 v[48:51], v20 offset:0
 s_add_u32 m0, s56, 0
 s_add_u32 s3, s55, s64
 buffer_load_dwordx4 v1, s[4:7], s3 offen sc1 lds
 s_waitcnt lgkmcnt(3)
 v_mfma_f32_32x32x16_bf16 v[64:79], a[4:7], v[36:39], v[64:79]
 ds_read_b128 v[52:55], v21 offset:0
 s_waitcnt lgkmcnt(3)
 v_mfma_f32_32x32x16_bf16 v[64:79], a[8:11], v[40:43], v[64:79]
 ds_read_b128 v[56:59], v22 offset:0
 s_waitcnt lgkmcnt(3)
 v_mfma_f32_32x32x16_bf16 v[64:79], a[12:15], v[44:47], v[64:79]
 ds_read_b128 v[60:63], v23 offset:0
 s_add_u32 m0, s56, 1024
 s_add_u32 s3, s55, s64
 buffer_load_dwordx4 v24, s[4:7], s3 offen sc1 lds
 s_waitcnt lgkmcnt(3)
 v_mfma_f32_32x32x16_bf16 v[64:79], a[16:19], v[48:51], v[64:79]
 ds_read_b128 v[32:35], v16 offset:8192
 s_waitcnt lgkmcnt(3)
 v_mfma_f32_32x32x16_bf16 v[64:79], a[20:23], v[52:55], v[64:79]
 ds_read_b128 v[36:39], v17 offset:8192
 s_waitcnt lgkmcnt(3)
 v_mfma_f32_32x32x16_bf16 v[64:79], a[24:27], v[56:59], v[64:79]
 ds_read_b128 v[40:43], v18 offset:8192
 s_add_u32 m0, s56, 8192
 s_add_u32 s3, s55, s65
 buffer_load_dwordx4 v1, s[4:7], s3 offen sc1 lds
 s_waitcnt lgkmcnt(3)
 v_mfma_f32_32x32x16_bf16 v[64:79], a[28:31], v[60:63], v[64:79]
 ds_read_b128 v[44:47], v19 offset:8192
 s_waitcnt lgkmcnt(3)
 v_mfma_f32_32x32x16_bf16 v[64:79], a[32:35], v[32:35], v[64:79]
 ds_read_b128 v[48:51], v20 offset:8192
 s_waitcnt lgkmcnt(3)
 v_mfma_f32_32x32x16_bf16 v[64:79], a[36:39], v[36:39], v[64:79]
 ds_read_b128 v[52:55], v21 offset:8192
 s_add_u32 m0, s56, 9216
 s_add_u32 s3, s55, s65
 buffer_load_dwordx4 v24, s[4:7], s3 offen sc1 lds
 s_waitcnt lgkmcnt(3)
 v_mfma_f32_32x32x16_bf16 v[64:79], a[40:43], v[40:43], v[64:79]
 ds_read_b128 v[56:59], v22 offset:8192
 s_waitcnt lgkmcnt(3)
 v_mfma_f32_32x32x16_bf16 v[64:79], a[44:47], v[44:47], v[64:79]
 ds_read_b128 v[60:63], v23 offset:8192
 s_waitcnt lgkmcnt(3)
 v_mfma_f32_32x32x16_bf16 v[64:79], a[48:51], v[48:51], v[64:79]
 ds_read_b128 v[32:35], v16 offset:16384
 s_add_u32 m0, s56, 16384
 s_add_u32 s3, s55, s66
 buffer_load_dwordx4 v1, s[4:7], s3 offen sc1 lds
 s_waitcnt lgkmcnt(3)
 v_mfma_f32_32x32x16_bf16 v[64:79], a[52:55], v[52:55], v[64:79]
 ds_read_b128 v[36:39], v17 offset:16384
 s_waitcnt lgkmcnt(3)
 v_mfma_f32_32x32x16_bf16 v[64:79], a[56:59], v[56:59], v[64:79]
 ds_read_b128 v[40:43], v18 offset:16384
 s_waitcnt lgkmcnt(3)
 v_mfma_f32_32x32x16_bf16 v[64:79], a[60:63], v[60:63], v[64:79]
 ds_read_b128 v[44:47], v19 offset:16384
 s_add_u32 m0, s56, 17408
 s_add_u32 s3, s55, s66
 buffer_load_dwordx4 v24, s[4:7], s3 offen sc1 lds
 s_waitcnt lgkmcnt(3)
 v_mfma_f32_32x32x16_bf16 v[64:79], a[64:67], v[32:35], v[64:79]
 ds_read_b128 v[48:51], v20 offset:16384
 s_waitcnt lgkmcnt(3)
 v_mfma_f32_32x32x16_bf16 v[64:79], a[68:71], v[36:39], v[64:79]
 ds_read_b128 v[52:55], v21 offset:16384
 s_waitcnt lgkmcnt(3)
 v_mfma_f32_32x32x16_bf16 v[64:79], a[72:75], v[40:43], v[64:79]
 ds_read_b128 v[56:59], v22 offset:16384
 s_add_u32 m0, s56, 24576
 s_add_u32 s3, s55, s67
 buffer_load_dwordx4 v1, s[4:7], s3 offen sc1 lds
 s_waitcnt lgkmcnt(3)
 v_mfma_f32_32x32x16_bf16 v[64:79], a[76:79], v[44:47], v[64:79]
 ds_read_b128 v[60:63], v23 offset:16384
 s_waitcnt lgkmcnt(3)
 v_mfma_f32_32x32x16_bf16 v[64:79], a[80:83], v[48:51], v[64:79]
 ds_read_b128 v[32:35], v16 offset:24576
 s_waitcnt lgkmcnt(3)
 v_mfma_f32_32x32x16_bf16 v[64:79], a[84:87], v[52:55], v[64:79]
 ds_read_b128 v[36:39], v17 offset:24576
 s_add_u32 m0, s56, 25600
 s_add_u32 s3, s55, s67
 buffer_load_dwordx4 v24, s[4:7], s3 offen sc1 lds
 s_waitcnt lgkmcnt(3)
 v_mfma_f32_32x32x16_bf16 v[64:79], a[88:91], v[56:59], v[64:79]
 ds_read_b128 v[40:43], v18 offset:24576
 s_waitcnt lgkmcnt(3)
 v_mfma_f32_32x32x16_bf16 v[64:79], a[92:95], v[60:63], v[64:79]
 ds_read_b128 v[44:47], v19 offset:24576
 s_waitcnt lgkmcnt(3)
 v_mfma_f32_32x32x16_bf16 v[64:79], a[96:99], v[32:35], v[64:79]
 ds_read_b128 v[48:51], v20 offset:24576
 s_add_u32 m0, s56, 32768
 s_add_u32 s3, s55, s68
 buffer_load_dwordx4 v1, s[4:7], s3 offen sc1 lds
 s_waitcnt lgkmcnt(3)
 v_mfma_f32_32x32x16_bf16 v[64:79], a[100:103], v[36:39], v[64:79]
 ds_read_b128 v[52:55], v21 offset:24576
 s_waitcnt lgkmcnt(3)
 v_mfma_f32_32x32x16_bf16 v[64:79], a[104:107], v[40:43], v[64:79]
 ds_read_b128 v[56:59], v22 offset:24576
 s_waitcnt lgkmcnt(3)
 v_mfma_f32_32x32x16_bf16 v[64:79], a[108:111], v[44:47], v[64:79]
 ds_read_b128 v[60:63], v23 offset:24576
 s_add_u32 m0, s56, 33792
 s_add_u32 s3, s55, s68
 buffer_load_dwordx4 v24, s[4:7], s3 offen sc1 lds
 s_waitcnt lgkmcnt(3)
 v_mfma_f32_32x32x16_bf16 v[64:79], a[112:115], v[48:51], v[64:79]
 ds_read_b128 v[32:35], v16 offset:32768
 s_waitcnt lgkmcnt(3)
 v_mfma_f32_32x32x16_bf16 v[64:79], a[116:119], v[52:55], v[64:79]
 ds_read_b128 v[36:39], v17 offset:32768
 v_mov_b32 v6, 8
 s_mov_b64 exec, 15
 v_mov_b32 v6, 0
 buffer_atomic_add v6, v5, s[4:7], s70 offen sc0
 s_mov_b64 exec, -1
 s_waitcnt lgkmcnt(3)
 v_mfma_f32_32x32x16_bf16 v[64:79], a[120:123], v[56:59], v[64:79]
 ds_read_b128 v[40:43], v18 offset:32768
 s_waitcnt lgkmcnt(3)
 v_mfma_f32_32x32x16_bf16 v[64:79], a[124:127], v[60:63], v[64:79]
 ds_read_b128 v[44:47], v19 offset:32768
 s_waitcnt lgkmcnt(3)
 v_mfma_f32_32x32x16_bf16 v[64:79], a[128:131], v[32:35], v[64:79]
 ds_read_b128 v[48:51], v20 offset:32768
 s_waitcnt lgkmcnt(3)
 v_mfma_f32_32x32x16_bf16 v[64:79], a[132:135], v[36:39], v[64:79]
 ds_read_b128 v[52:55], v21 offset:32768
 s_waitcnt lgkmcnt(3)
 v_mfma_f32_32x32x16_bf16 v[64:79], a[136:139], v[40:43], v[64:79]
 ds_read_b128 v[56:59], v22 offset:32768
 s_waitcnt lgkmcnt(3)
 v_mfma_f32_32x32x16_bf16 v[64:79], a[140:143], v[44:47], v[64:79]
 ds_read_b128 v[60:63], v23 offset:32768
 s_waitcnt lgkmcnt(3)
 v_mfma_f32_32x32x16_bf16 v[64:79], a[144:147], v[48:51], v[64:79]
 s_waitcnt lgkmcnt(2)
 v_mfma_f32_32x32x16_bf16 v[64:79], a[148:151], v[52:55], v[64:79]
 s_waitcnt lgkmcnt(1)
 v_mfma_f32_32x32x16_bf16 v[64:79], a[152:155], v[56:59], v[64:79]
 s_waitcnt lgkmcnt(0)
 v_mfma_f32_32x32x16_bf16 v[64:79], a[156:159], v[60:63], v[64:79]
 s_lshl_b32 s3, s60, 19
 s_add_u32 s3, s3, s58
 s_xor_b32 s3, s3, s82
 s_add_u32 s3, s3, 33554432
 s_nop 8
 v_cvt_pk_bf16_f32 v88, v64, v65
 v_cvt_pk_bf16_f32 v89, v66, v67
 v_cvt_pk_bf16_f32 v90, v72, v73
 v_cvt_pk_bf16_f32 v91, v74, v75
 buffer_store_dwordx4 v[88:91], v4, s[4:7], s3 offen offset:0 sc1
 v_cvt_pk_bf16_f32 v92, v68, v69
 v_cvt_pk_bf16_f32 v93, v70, v71
 v_cvt_pk_bf16_f32 v94, v76, v77
 v_cvt_pk_bf16_f32 v95, v78, v79
 buffer_store_dwordx4 v[92:95], v4, s[4:7], s3 offen offset:512 sc1
 s_branch L_qkvq_mid
L_qkvq_loop:
 s_cmp_lg_u32 s54, 32
 s_cbranch_scc1 L_c2_65
 s_cmp_lg_u32 s50, 0
 s_cbranch_scc1 L_ww_66
 s_mov_b32 s96, s44
 s_and_b32 s97, s45, 0xffff
 s_mov_b32 s98, 256
 s_mov_b32 s99, 0x00020000
 v_mov_b32 v25, 140
 s_mov_b32 s51, 0
 s_mov_b64 exec, 1
L_wb_67:
 buffer_load_dword v26, v25, s[96:99], 0 offen sc1
 s_waitcnt vmcnt(0)
 v_cmp_eq_u32 vcc, 0, v26
 s_cbranch_vccz L_wbd_68
 s_sleep 2
 s_add_u32 s51, s51, 1
 s_cmp_lt_u32 s51, 131072
 s_cbranch_scc1 L_wb_67
 s_branch L_bail
L_wbd_68:
 s_mov_b64 exec, -1
L_ww_66:
 s_barrier
L_c2_65:
 s_sub_u32 s60, s54, 16
 s_mul_i32 s55, s60, 40960
 s_mul_i32 s3, s50, 10240
 s_add_u32 s55, s55, s3
 s_add_u32 s55, s55, 229113856
 s_add_u32 m0, s56, 40960
 s_add_u32 s3, s55, s64
 buffer_load_dwordx4 v1, s[4:7], s3 offen sc1 lds
 s_add_u32 m0, s56, 41984
 s_add_u32 s3, s55, s64
 buffer_load_dwordx4 v24, s[4:7], s3 offen sc1 lds
 s_add_u32 m0, s56, 49152
 s_add_u32 s3, s55, s65
 buffer_load_dwordx4 v1, s[4:7], s3 offen sc1 lds
 s_add_u32 m0, s56, 50176
 s_add_u32 s3, s55, s65
 buffer_load_dwordx4 v24, s[4:7], s3 offen sc1 lds
 s_add_u32 m0, s56, 57344
 s_add_u32 s3, s55, s66
 buffer_load_dwordx4 v1, s[4:7], s3 offen sc1 lds
 s_add_u32 m0, s56, 58368
 s_add_u32 s3, s55, s66
 buffer_load_dwordx4 v24, s[4:7], s3 offen sc1 lds
 s_add_u32 m0, s56, 65536
 s_add_u32 s3, s55, s67
 buffer_load_dwordx4 v1, s[4:7], s3 offen sc1 lds
 s_add_u32 m0, s56, 66560
 s_add_u32 s3, s55, s67
 buffer_load_dwordx4 v24, s[4:7], s3 offen sc1 lds
 s_add_u32 m0, s56, 73728
 s_add_u32 s3, s55, s68
 buffer_load_dwordx4 v1, s[4:7], s3 offen sc1 lds
 s_add_u32 m0, s56, 74752
 s_add_u32 s3, s55, s68
 buffer_load_dwordx4 v24, s[4:7], s3 offen sc1 lds
 s_lshl_b32 s70, s54, 2
 s_add_u32 s70, s70, s62
 s_sub_u32 s70, s70, 60
 s_cmp_lg_u32 s50, 0
 s_cselect_b32 s70, 268435456, s70
 s_min_u32 s51, s54, 63
 s_mul_i32 s55, s51, 40960
 s_mul_i32 s3, s50, 10240
 s_add_u32 s55, s55, s3
 s_add_u32 s55, s55, 226492416
 s_waitcnt vmcnt(8)
 s_barrier
 ds_read_b128 v[32:35], v16 offset:0
 ds_read_b128 v[36:39], v17 offset:0
 ds_read_b128 v[40:43], v18 offset:0
 ds_read_b128 v[44:47], v19 offset:0
 s_waitcnt lgkmcnt(3)
 v_mfma_f32_32x32x16_bf16 v[64:79], a[0:3], v[32:35], 0
 ds_read_b128 v[48:51], v20 offset:0
 s_add_u32 m0, s56, 0
 s_add_u32 s3, s55, s64
 buffer_load_dwordx4 v1, s[4:7], s3 offen sc1 lds
 s_waitcnt lgkmcnt(3)
 v_mfma_f32_32x32x16_bf16 v[64:79], a[4:7], v[36:39], v[64:79]
 ds_read_b128 v[52:55], v21 offset:0
 s_waitcnt lgkmcnt(3)
 v_mfma_f32_32x32x16_bf16 v[64:79], a[8:11], v[40:43], v[64:79]
 ds_read_b128 v[56:59], v22 offset:0
 s_waitcnt lgkmcnt(3)
 v_mfma_f32_32x32x16_bf16 v[64:79], a[12:15], v[44:47], v[64:79]
 ds_read_b128 v[60:63], v23 offset:0
 s_add_u32 m0, s56, 1024
 s_add_u32 s3, s55, s64
 buffer_load_dwordx4 v24, s[4:7], s3 offen sc1 lds
 s_waitcnt lgkmcnt(3)
 v_mfma_f32_32x32x16_bf16 v[64:79], a[16:19], v[48:51], v[64:79]
 s_waitcnt vmcnt(8)
 s_barrier
 ds_read_b128 v[32:35], v16 offset:8192
 s_waitcnt lgkmcnt(3)
 v_mfma_f32_32x32x16_bf16 v[64:79], a[20:23], v[52:55], v[64:79]
 ds_read_b128 v[36:39], v17 offset:8192
 s_waitcnt lgkmcnt(3)
 v_mfma_f32_32x32x16_bf16 v[64:79], a[24:27], v[56:59], v[64:79]
 ds_read_b128 v[40:43], v18 offset:8192
 s_add_u32 m0, s56, 8192
 s_add_u32 s3, s55, s65
 buffer_load_dwordx4 v1, s[4:7], s3 offen sc1 lds
 s_waitcnt lgkmcnt(3)
 v_mfma_f32_32x32x16_bf16 v[64:79], a[28:31], v[60:63], v[64:79]
 ds_read_b128 v[44:47], v19 offset:8192
 s_waitcnt lgkmcnt(3)
 v_mfma_f32_32x32x16_bf16 v[64:79], a[32:35], v[32:35], v[64:79]
 ds_read_b128 v[48:51], v20 offset:8192
 s_waitcnt lgkmcnt(3)
 v_mfma_f32_32x32x16_bf16 v[64:79], a[36:39], v[36:39], v[64:79]
 ds_read_b128 v[52:55], v21 offset:8192
 s_add_u32 m0, s56, 9216
 s_add_u32 s3, s55, s65
 buffer_load_dwordx4 v24, s[4:7], s3 offen sc1 lds
 s_waitcnt lgkmcnt(3)
 v_mfma_f32_32x32x16_bf16 v[64:79], a[40:43], v[40:43], v[64:79]
 ds_read_b128 v[56:59], v22 offset:8192
 s_waitcnt lgkmcnt(3)
 v_mfma_f32_32x32x16_bf16 v[64:79], a[44:47], v[44:47], v[64:79]
 ds_read_b128 v[60:63], v23 offset:8192
 s_waitcnt lgkmcnt(3)
 v_mfma_f32_32x32x16_bf16 v[64:79], a[48:51], v[48:51], v[64:79]
 s_waitcnt vmcnt(8)
 s_barrier
 ds_read_b128 v[32:35], v16 offset:16384
 s_add_u32 m0, s56, 16384
 s_add_u32 s3, s55, s66
 buffer_load_dwordx4 v1, s[4:7], s3 offen sc1 lds
 s_waitcnt lgkmcnt(3)
 v_mfma_f32_32x32x16_bf16 v[64:79], a[52:55], v[52:55], v[64:79]
 ds_read_b128 v[36:39], v17 offset:16384
 s_waitcnt lgkmcnt(3)
 v_mfma_f32_32x32x16_bf16 v[64:79], a[56:59], v[56:59], v[64:79]
 ds_read_b128 v[40:43], v18 offset:16384
 s_waitcnt lgkmcnt(3)
 v_mfma_f32_32x32x16_bf16 v[64:79], a[60:63], v[60:63], v[64:79]
 ds_read_b128 v[44:47], v19 offset:16384
 s_add_u32 m0, s56, 17408
 s_add_u32 s3, s55, s66
 buffer_load_dwordx4 v24, s[4:7], s3 offen sc1 lds
 s_waitcnt lgkmcnt(3)
 v_mfma_f32_32x32x16_bf16 v[64:79], a[64:67], v[32:35], v[64:79]
 ds_read_b128 v[48:51], v20 offset:16384
 s_waitcnt lgkmcnt(3)
 v_mfma_f32_32x32x16_bf16 v[64:79], a[68:71], v[36:39], v[64:79]
 ds_read_b128 v[52:55], v21 offset:16384
 s_waitcnt lgkmcnt(3)
 v_mfma_f32_32x32x16_bf16 v[64:79], a[72:75], v[40:43], v[64:79]
 ds_read_b128 v[56:59], v22 offset:16384
 s_add_u32 m0, s56, 24576
 s_add_u32 s3, s55, s67
 buffer_load_dwordx4 v1, s[4:7], s3 offen sc1 lds
 s_waitcnt lgkmcnt(3)
 v_mfma_f32_32x32x16_bf16 v[64:79], a[76:79], v[44:47], v[64:79]
 ds_read_b128 v[60:63], v23 offset:16384
 s_waitcnt lgkmcnt(3)
 v_mfma_f32_32x32x16_bf16 v[64:79], a[80:83], v[48:51], v[64:79]
 s_waitcnt vmcnt(9)
 s_barrier
 ds_read_b128 v[32:35], v16 offset:24576
 s_waitcnt lgkmcnt(3)
 v_mfma_f32_32x32x16_bf16 v[64:79], a[84:87], v[52:55], v[64:79]
 ds_read_b128 v[36:39], v17 offset:24576
 s_add_u32 m0, s56, 25600
 s_add_u32 s3, s55, s67
 buffer_load_dwordx4 v24, s[4:7], s3 offen sc1 lds
 s_waitcnt lgkmcnt(3)
 v_mfma_f32_32x32x16_bf16 v[64:79], a[88:91], v[56:59], v[64:79]
 ds_read_b128 v[40:43], v18 offset:24576
 s_waitcnt lgkmcnt(3)
 v_mfma_f32_32x32x16_bf16 v[64:79], a[92:95], v[60:63], v[64:79]
 ds_read_b128 v[44:47], v19 offset:24576
 s_waitcnt lgkmcnt(3)
 v_mfma_f32_32x32x16_bf16 v[64:79], a[96:99], v[32:35], v[64:79]
 ds_read_b128 v[48:51], v20 offset:24576
 s_add_u32 m0, s56, 32768
 s_add_u32 s3, s55, s68
 buffer_load_dwordx4 v1, s[4:7], s3 offen sc1 lds
 s_waitcnt lgkmcnt(3)
 v_mfma_f32_32x32x16_bf16 v[64:79], a[100:103], v[36:39], v[64:79]
 ds_read_b128 v[52:55], v21 offset:24576
 s_waitcnt lgkmcnt(3)
 v_mfma_f32_32x32x16_bf16 v[64:79], a[104:107], v[40:43], v[64:79]
 ds_read_b128 v[56:59], v22 offset:24576
 s_waitcnt lgkmcnt(3)
 v_mfma_f32_32x32x16_bf16 v[64:79], a[108:111], v[44:47], v[64:79]
 ds_read_b128 v[60:63], v23 offset:24576
 s_add_u32 m0, s56, 33792
 s_add_u32 s3, s55, s68
 buffer_load_dwordx4 v24, s[4:7], s3 offen sc1 lds
 s_waitcnt lgkmcnt(3)
 v_mfma_f32_32x32x16_bf16 v[64:79], a[112:115], v[48:51], v[64:79]
 s_waitcnt vmcnt(10)
 s_barrier
 ds_read_b128 v[32:35], v16 offset:32768
 s_waitcnt lgkmcnt(3)
 v_mfma_f32_32x32x16_bf16 v[64:79], a[116:119], v[52:55], v[64:79]
 ds_read_b128 v[36:39], v17 offset:32768
 v_mov_b32 v6, 8
 s_mov_b64 exec, 15
 v_mov_b32 v6, 0
 buffer_atomic_add v6, v5, s[4:7], s70 offen sc0
 s_mov_b64 exec, -1
 s_waitcnt lgkmcnt(3)
 v_mfma_f32_32x32x16_bf16 v[64:79], a[120:123], v[56:59], v[64:79]
 ds_read_b128 v[40:43], v18 offset:32768
 s_waitcnt lgkmcnt(3)
 v_mfma_f32_32x32x16_bf16 v[64:79], a[124:127], v[60:63], v[64:79]
 ds_read_b128 v[44:47], v19 offset:32768
 s_waitcnt lgkmcnt(3)
 v_mfma_f32_32x32x16_bf16 v[64:79], a[128:131], v[32:35], v[64:79]
 ds_read_b128 v[48:51], v20 offset:32768
 s_waitcnt lgkmcnt(3)
 v_mfma_f32_32x32x16_bf16 v[64:79], a[132:135], v[36:39], v[64:79]
 ds_read_b128 v[52:55], v21 offset:32768
 s_waitcnt lgkmcnt(3)
 v_mfma_f32_32x32x16_bf16 v[64:79], a[136:139], v[40:43], v[64:79]
 ds_read_b128 v[56:59], v22 offset:32768
 s_waitcnt lgkmcnt(3)
 v_mfma_f32_32x32x16_bf16 v[64:79], a[140:143], v[44:47], v[64:79]
 ds_read_b128 v[60:63], v23 offset:32768
 s_waitcnt lgkmcnt(3)
 v_mfma_f32_32x32x16_bf16 v[64:79], a[144:147], v[48:51], v[64:79]
 s_waitcnt lgkmcnt(2)
 v_mfma_f32_32x32x16_bf16 v[64:79], a[148:151], v[52:55], v[64:79]
 s_waitcnt lgkmcnt(1)
 v_mfma_f32_32x32x16_bf16 v[64:79], a[152:155], v[56:59], v[64:79]
 s_waitcnt lgkmcnt(0)
 v_mfma_f32_32x32x16_bf16 v[64:79], a[156:159], v[60:63], v[64:79]
 s_lshl_b32 s3, s60, 19
 s_add_u32 s3, s3, s58
 s_xor_b32 s3, s3, s82
 s_add_u32 s3, s3, 33554432
 s_nop 8
 v_cvt_pk_bf16_f32 v88, v64, v65
 v_cvt_pk_bf16_f32 v89, v66, v67
 v_cvt_pk_bf16_f32 v90, v72, v73
 v_cvt_pk_bf16_f32 v91, v74, v75
 buffer_store_dwordx4 v[88:91], v4, s[4:7], s3 offen offset:0 sc1
 v_cvt_pk_bf16_f32 v92, v68, v69
 v_cvt_pk_bf16_f32 v93, v70, v71
 v_cvt_pk_bf16_f32 v94, v76, v77
 v_cvt_pk_bf16_f32 v95, v78, v79
 buffer_store_dwordx4 v[92:95], v4, s[4:7], s3 offen offset:512 sc1
L_qkvq_mid:
 s_cmp_ge_u32 s54, 64
 s_cbranch_scc1 L_n0_60
 s_waitcnt vmcnt(2)
 s_cmp_lg_u32 s50, 0
 s_cbranch_scc1 L_w_69
 v_cmp_gt_u32 vcc, 8, v6
 s_nop 1
 v_mov_b32 v3, vcc_lo
 ds_write_b32 v7, v3
 s_waitcnt lgkmcnt(0)
L_w_69:
 s_barrier
 ds_read_b32 v3, v7
 s_waitcnt lgkmcnt(0)
 v_readfirstlane_b32 s3, v3
 s_mov_b32 s69, s3
 s_add_u32 s51, s60, 1
 s_mov_b32 s60, s54
 s_mul_i32 s55, s51, 40960
 s_mul_i32 s3, s50, 10240
 s_add_u32 s55, s55, s3
 s_add_u32 s55, s55, 229113856
 s_cmp_eq_u32 s69, 0
 s_cselect_b32 s55, s55, 268435456
 ds_read_b128 v[32:35], v8 offset:0
 ds_read_b128 v[36:39], v9 offset:0
 ds_read_b128 v[40:43], v10 offset:0
 ds_read_b128 v[44:47], v11 offset:0
 s_waitcnt lgkmcnt(3)
 v_mfma_f32_32x32x16_bf16 v[64:79], a[0:3], v[32:35], 0
 ds_read_b128 v[48:51], v12 offset:0
 s_add_u32 m0, s56, 40960
 s_add_u32 s3, s55, s64
 buffer_load_dwordx4 v1, s[4:7], s3 offen sc1 lds
 s_waitcnt lgkmcnt(3)
 v_mfma_f32_32x32x16_bf16 v[64:79], a[4:7], v[36:39], v[64:79]
 ds_read_b128 v[52:55], v13 offset:0
 s_waitcnt lgkmcnt(3)
 v_mfma_f32_32x32x16_bf16 v[64:79], a[8:11], v[40:43], v[64:79]
 ds_read_b128 v[56:59], v14 offset:0
 s_waitcnt lgkmcnt(3)
 v_mfma_f32_32x32x16_bf16 v[64:79], a[12:15], v[44:47], v[64:79]
 ds_read_b128 v[60:63], v15 offset:0
 s_add_u32 m0, s56, 41984
 s_add_u32 s3, s55, s64
 buffer_load_dwordx4 v24, s[4:7], s3 offen sc1 lds
 s_waitcnt lgkmcnt(3)
 v_mfma_f32_32x32x16_bf16 v[64:79], a[16:19], v[48:51], v[64:79]
 ds_read_b128 v[32:35], v8 offset:8192
 s_waitcnt lgkmcnt(3)
 v_mfma_f32_32x32x16_bf16 v[64:79], a[20:23], v[52:55], v[64:79]
 ds_read_b128 v[36:39], v9 offset:8192
 s_waitcnt lgkmcnt(3)
 v_mfma_f32_32x32x16_bf16 v[64:79], a[24:27], v[56:59], v[64:79]
 ds_read_b128 v[40:43], v10 offset:8192
 s_add_u32 m0, s56, 49152
 s_add_u32 s3, s55, s65
 buffer_load_dwordx4 v1, s[4:7], s3 offen sc1 lds
 s_waitcnt lgkmcnt(3)
 v_mfma_f32_32x32x16_bf16 v[64:79], a[28:31], v[60:63], v[64:79]
 ds_read_b128 v[44:47], v11 offset:8192
 s_waitcnt lgkmcnt(3)
 v_mfma_f32_32x32x16_bf16 v[64:79], a[32:35], v[32:35], v[64:79]
 ds_read_b128 v[48:51], v12 offset:8192
 s_waitcnt lgkmcnt(3)
 v_mfma_f32_32x32x16_bf16 v[64:79], a[36:39], v[36:39], v[64:79]
 ds_read_b128 v[52:55], v13 offset:8192
 s_add_u32 m0, s56, 50176
 s_add_u32 s3, s55, s65
 buffer_load_dwordx4 v24, s[4:7], s3 offen sc1 lds
 s_waitcnt lgkmcnt(3)
 v_mfma_f32_32x32x16_bf16 v[64:79], a[40:43], v[40:43], v[64:79]
 ds_read_b128 v[56:59], v14 offset:8192
 s_waitcnt lgkmcnt(3)
 v_mfma_f32_32x32x16_bf16 v[64:79], a[44:47], v[44:47], v[64:79]
 ds_read_b128 v[60:63], v15 offset:8192
 s_waitcnt lgkmcnt(3)
 v_mfma_f32_32x32x16_bf16 v[64:79], a[48:51], v[48:51], v[64:79]
 ds_read_b128 v[32:35], v8 offset:16384
 s_add_u32 m0, s56, 57344
 s_add_u32 s3, s55, s66
 buffer_load_dwordx4 v1, s[4:7], s3 offen sc1 lds
 s_waitcnt lgkmcnt(3)
 v_mfma_f32_32x32x16_bf16 v[64:79], a[52:55], v[52:55], v[64:79]
 ds_read_b128 v[36:39], v9 offset:16384
 s_waitcnt lgkmcnt(3)
 v_mfma_f32_32x32x16_bf16 v[64:79], a[56:59], v[56:59], v[64:79]
 ds_read_b128 v[40:43], v10 offset:16384
 s_waitcnt lgkmcnt(3)
 v_mfma_f32_32x32x16_bf16 v[64:79], a[60:63], v[60:63], v[64:79]
 ds_read_b128 v[44:47], v11 offset:16384
 s_add_u32 m0, s56, 58368
 s_add_u32 s3, s55, s66
 buffer_load_dwordx4 v24, s[4:7], s3 offen sc1 lds
 s_waitcnt lgkmcnt(3)
 v_mfma_f32_32x32x16_bf16 v[64:79], a[64:67], v[32:35], v[64:79]
 ds_read_b128 v[48:51], v12 offset:16384
 s_waitcnt lgkmcnt(3)
 v_mfma_f32_32x32x16_bf16 v[64:79], a[68:71], v[36:39], v[64:79]
 ds_read_b128 v[52:55], v13 offset:16384
 s_waitcnt vmcnt(6)
 s_lshl_b32 s3, s54, 2
 s_add_u32 s3, s3, s63
 v_mov_b32 v3, 1
 s_mov_b64 exec, s[78:79]
 buffer_atomic_add v3, v30, s[4:7], s3 offen
 s_mov_b64 exec, -1
 s_cmp_eq_u32 s61, 0
 s_cbranch_scc1 L_pf_70
 s_lshl_b32 s3, s61, 2
 s_add_u32 s3, s3, s59
 s_sub_u32 s3, s3, 4
 v_mov_b32 v3, 1
 s_mov_b64 exec, s[78:79]
 buffer_atomic_add v3, v30, s[4:7], s3 offen
 s_mov_b64 exec, -1
 s_mov_b32 s61, 0
L_pf_70:
 s_waitcnt lgkmcnt(3)
 v_mfma_f32_32x32x16_bf16 v[64:79], a[72:75], v[40:43], v[64:79]
 ds_read_b128 v[56:59], v14 offset:16384
 s_add_u32 m0, s56, 65536
 s_add_u32 s3, s55, s67
 buffer_load_dwordx4 v1, s[4:7], s3 offen sc1 lds
 s_waitcnt lgkmcnt(3)
 v_mfma_f32_32x32x16_bf16 v[64:79], a[76:79], v[44:47], v[64:79]
 ds_read_b128 v[60:63], v15 offset:16384
 s_waitcnt lgkmcnt(3)
 v_mfma_f32_32x32x16_bf16 v[64:79], a[80:83], v[48:51], v[64:79]
 ds_read_b128 v[32:35], v8 offset:24576
 s_waitcnt lgkmcnt(3)
 v_mfma_f32_32x32x16_bf16 v[64:79], a[84:87], v[52:55], v[64:79]
 ds_read_b128 v[36:39], v9 offset:24576
 s_add_u32 m0, s56, 66560
 s_add_u32 s3, s55, s67
 buffer_load_dwordx4 v24, s[4:7], s3 offen sc1 lds
 s_waitcnt lgkmcnt(3)
 v_mfma_f32_32x32x16_bf16 v[64:79], a[88:91], v[56:59], v[64:79]
 ds_read_b128 v[40:43], v10 offset:24576
 s_waitcnt lgkmcnt(3)
 v_mfma_f32_32x32x16_bf16 v[64:79], a[92:95], v[60:63], v[64:79]
 ds_read_b128 v[44:47], v11 offset:24576
 s_waitcnt lgkmcnt(3)
 v_mfma_f32_32x32x16_bf16 v[64:79], a[96:99], v[32:35], v[64:79]
 ds_read_b128 v[48:51], v12 offset:24576
 s_add_u32 m0, s56, 73728
 s_add_u32 s3, s55, s68
 buffer_load_dwordx4 v1, s[4:7], s3 offen sc1 lds
 s_waitcnt lgkmcnt(3)
 v_mfma_f32_32x32x16_bf16 v[64:79], a[100:103], v[36:39], v[64:79]
 ds_read_b128 v[52:55], v13 offset:24576
 s_waitcnt lgkmcnt(3)
 v_mfma_f32_32x32x16_bf16 v[64:79], a[104:107], v[40:43], v[64:79]
 ds_read_b128 v[56:59], v14 offset:24576
 s_waitcnt lgkmcnt(3)
 v_mfma_f32_32x32x16_bf16 v[64:79], a[108:111], v[44:47], v[64:79]
 ds_read_b128 v[60:63], v15 offset:24576
 s_add_u32 m0, s56, 74752
 s_add_u32 s3, s55, s68
 buffer_load_dwordx4 v24, s[4:7], s3 offen sc1 lds
 v_mov_b32 v6, 8
 s_mov_b64 exec, 15
 v_mov_b32 v6, 0
 buffer_atomic_add v6, v5, s[4:7], s70 offen sc0
 s_mov_b64 exec, -1
 s_waitcnt lgkmcnt(3)
 v_mfma_f32_32x32x16_bf16 v[64:79], a[112:115], v[48:51], v[64:79]
 ds_read_b128 v[32:35], v8 offset:32768
 s_waitcnt lgkmcnt(3)
 v_mfma_f32_32x32x16_bf16 v[64:79], a[116:119], v[52:55], v[64:79]
 ds_read_b128 v[36:39], v9 offset:32768
 s_waitcnt lgkmcnt(3)
 v_mfma_f32_32x32x16_bf16 v[64:79], a[120:123], v[56:59], v[64:79]
 ds_read_b128 v[40:43], v10 offset:32768
 s_waitcnt lgkmcnt(3)
 v_mfma_f32_32x32x16_bf16 v[64:79], a[124:127], v[60:63], v[64:79]
 ds_read_b128 v[44:47], v11 offset:32768
 s_waitcnt lgkmcnt(3)
 v_mfma_f32_32x32x16_bf16 v[64:79], a[128:131], v[32:35], v[64:79]
 ds_read_b128 v[48:51], v12 offset:32768
 s_waitcnt lgkmcnt(3)
 v_mfma_f32_32x32x16_bf16 v[64:79], a[132:135], v[36:39], v[64:79]
 ds_read_b128 v[52:55], v13 offset:32768
 s_waitcnt lgkmcnt(3)
 v_mfma_f32_32x32x16_bf16 v[64:79], a[136:139], v[40:43], v[64:79]
 ds_read_b128 v[56:59], v14 offset:32768
 s_waitcnt lgkmcnt(3)
 v_mfma_f32_32x32x16_bf16 v[64:79], a[140:143], v[44:47], v[64:79]
 ds_read_b128 v[60:63], v15 offset:32768
 s_waitcnt lgkmcnt(3)
 v_mfma_f32_32x32x16_bf16 v[64:79], a[144:147], v[48:51], v[64:79]
 s_waitcnt lgkmcnt(2)
 v_mfma_f32_32x32x16_bf16 v[64:79], a[148:151], v[52:55], v[64:79]
 s_waitcnt lgkmcnt(1)
 v_mfma_f32_32x32x16_bf16 v[64:79], a[152:155], v[56:59], v[64:79]
 s_waitcnt lgkmcnt(0)
 v_mfma_f32_32x32x16_bf16 v[64:79], a[156:159], v[60:63], v[64:79]
 s_lshl_b32 s3, s60, 19
 s_add_u32 s3, s3, s58
 s_xor_b32 s3, s3, s82
 s_nop 8
 v_cvt_pk_bf16_f32 v80, v64, v65
 v_cvt_pk_bf16_f32 v81, v66, v67
 v_cvt_pk_bf16_f32 v82, v72, v73
 v_cvt_pk_bf16_f32 v83, v74, v75
 buffer_store_dwordx4 v[80:83], v4, s[4:7], s3 offen offset:0 sc1
 v_cvt_pk_bf16_f32 v84, v68, v69
 v_cvt_pk_bf16_f32 v85, v70, v71
 v_cvt_pk_bf16_f32 v86, v76, v77
 v_cvt_pk_bf16_f32 v87, v78, v79
 buffer_store_dwordx4 v[84:87], v4, s[4:7], s3 offen offset:512 sc1
 s_add_u32 s54, s54, 1
 s_mov_b32 s61, s54
 s_waitcnt vmcnt(2)
 s_cmp_lg_u32 s50, 0
 s_cbranch_scc1 L_w_71
 v_cmp_gt_u32 vcc, 8, v6
 s_nop 1
 v_mov_b32 v3, vcc_lo
 ds_write_b32 v7, v3
 s_waitcnt lgkmcnt(0)
L_w_71:
 s_barrier
 ds_read_b32 v3, v7
 s_waitcnt lgkmcnt(0)
 v_readfirstlane_b32 s3, v3
 s_cmp_eq_u32 s69, 0
 s_cbranch_scc1 L_qkvq_fast
 s_cmp_eq_u32 s3, 0
 s_cbranch_scc1 L_qkvq_loop
 s_branch L_qkvq_block
L_n0_60:
 s_waitcnt vmcnt(0)
 s_lshl_b32 s3, s54, 2
 s_add_u32 s3, s3, s63
 v_mov_b32 v3, 1
 s_mov_b64 exec, s[78:79]
 buffer_atomic_add v3, v30, s[4:7], s3 offen
 s_mov_b64 exec, -1
 s_add_u32 s54, s54, 1
 s_cmp_lt_u32 s54, 80
 s_cbranch_scc1 L_qkvq_block
 s_endpgm
L_qkvv:
 s_mul_i32 s57, s50, 40960
 s_mul_i32 s62, s52, 3
 s_add_u32 s62, s62, s53
 s_mul_i32 s3, s62, 13108
 s_lshr_b32 s3, s3, 16
 s_mul_i32 s3, s3, 5
 s_sub_u32 s55, s62, s3
 s_add_u32 s64, s55, 0
 s_sub_u32 s3, s64, 5
 s_cmp_ge_u32 s64, 5
 s_cselect_b32 s64, s3, s64
 s_add_u32 s65, s55, 1
 s_sub_u32 s3, s65, 5
 s_cmp_ge_u32 s65, 5
 s_cselect_b32 s65, s3, s65
 s_add_u32 s66, s55, 2
 s_sub_u32 s3, s66, 5
 s_cmp_ge_u32 s66, 5
 s_cselect_b32 s66, s3, s66
 s_add_u32 s67, s55, 3
 s_sub_u32 s3, s67, 5
 s_cmp_ge_u32 s67, 5
 s_cselect_b32 s67, s3, s67
 s_add_u32 s68, s55, 4
 s_sub_u32 s3, s68, 5
 s_cmp_ge_u32 s68, 5
 s_cselect_b32 s68, s3, s68
 s_lshl_b32 s55, s52, 8
 v_lshrrev_b32 v4, 4, v0
 s_mov_b32 s3, 8192
 v_mul_lo_u32 v4, v4, s3
 v_lshrrev_b32 v3, 3, v0
 v_and_b32 v3, 6, v3
 v_xor_b32 v3, v3, v0
 v_and_b32 v3, 15, v3
 v_lshl_add_u32 v4, v3, 4, v4
 v_xor_b32 v5, 128, v4
 s_lshl_b32 s57, s50, 13
 s_mul_i32 s3, s50, 262144
 s_add_u32 s55, s55, s3
 s_mul_i32 s51, s64, 1048576
 s_add_u32 s51, s51, s55
 s_add_u32 m0, s57, 0
 s_nop 0
 buffer_load_dwordx4 v4, s[8:11], s51 offen lds
 s_add_u32 s51, s51, 32768
 s_add_u32 m0, s57, 1024
 s_nop 0
 buffer_load_dwordx4 v5, s[8:11], s51 offen lds
 s_add_u32 s51, s51, 32768
 s_add_u32 m0, s57, 2048
 s_nop 0
 buffer_load_dwordx4 v4, s[8:11], s51 offen lds
 s_add_u32 s51, s51, 32768
 s_add_u32 m0, s57, 3072
 s_nop 0
 buffer_load_dwordx4 v5, s[8:11], s51 offen lds
 s_add_u32 s51, s51, 32768
 s_add_u32 m0, s57, 4096
 s_nop 0
 buffer_load_dwordx4 v4, s[8:11], s51 offen lds
 s_add_u32 s51, s51, 32768
 s_add_u32 m0, s57, 5120
 s_nop 0
 buffer_load_dwordx4 v5, s[8:11], s51 offen lds
 s_add_u32 s51, s51, 32768
 s_add_u32 m0, s57, 6144
 s_nop 0
 buffer_load_dwordx4 v4, s[8:11], s51 offen lds
 s_add_u32 s51, s51, 32768
 s_add_u32 m0, s57, 7168
 s_nop 0
 buffer_load_dwordx4 v5, s[8:11], s51 offen lds
 s_add_u32 s51, s51, 32768
 s_mul_i32 s51, s65, 1048576
 s_add_u32 s51, s51, s55
 s_add_u32 m0, s57, 32768
 s_nop 0
 buffer_load_dwordx4 v4, s[8:11], s51 offen lds
 s_add_u32 s51, s51, 32768
 s_add_u32 m0, s57, 33792
 s_nop 0
 buffer_load_dwordx4 v5, s[8:11], s51 offen lds
 s_add_u32 s51, s51, 32768
 s_add_u32 m0, s57, 34816
 s_nop 0
 buffer_load_dwordx4 v4, s[8:11], s51 offen lds
 s_add_u32 s51, s51, 32768
 s_add_u32 m0, s57, 35840
 s_nop 0
 buffer_load_dwordx4 v5, s[8:11], s51 offen lds
 s_add_u32 s51, s51, 32768
 s_add_u32 m0, s57, 36864
 s_nop 0
 buffer_load_dwordx4 v4, s[8:11], s51 offen lds
 s_add_u32 s51, s51, 32768
 s_add_u32 m0, s57, 37888
 s_nop 0
 buffer_load_dwordx4 v5, s[8:11], s51 offen lds
 s_add_u32 s51, s51, 32768
 s_add_u32 m0, s57, 38912
 s_nop 0
 buffer_load_dwordx4 v4, s[8:11], s51 offen lds
 s_add_u32 s51, s51, 32768
 s_add_u32 m0, s57, 39936
 s_nop 0
 buffer_load_dwordx4 v5, s[8:11], s51 offen lds
 s_add_u32 s51, s51, 32768
 s_mul_i32 s51, s66, 1048576
 s_add_u32 s51, s51, s55
 s_add_u32 m0, s57, 65536
 s_nop 0
 buffer_load_dwordx4 v4, s[8:11], s51 offen lds
 s_add_u32 s51, s51, 32768
 s_add_u32 m0, s57, 66560
 s_nop 0
 buffer_load_dwordx4 v5, s[8:11], s51 offen lds
 s_add_u32 s51, s51, 32768
 s_add_u32 m0, s57, 67584
 s_nop 0
 buffer_load_dwordx4 v4, s[8:11], s51 offen lds
 s_add_u32 s51, s51, 32768
 s_add_u32 m0, s57, 68608
 s_nop 0
 buffer_load_dwordx4 v5, s[8:11], s51 offen lds
 s_add_u32 s51, s51, 32768
 s_add_u32 m0, s57, 69632
 s_nop 0
 buffer_load_dwordx4 v4, s[8:11], s51 offen lds
 s_add_u32 s51, s51, 32768
 s_add_u32 m0, s57, 70656
 s_nop 0
 buffer_load_dwordx4 v5, s[8:11], s51 offen lds
 s_add_u32 s51, s51, 32768
 s_add_u32 m0, s57, 71680
 s_nop 0
 buffer_load_dwordx4 v4, s[8:11], s51 offen lds
 s_add_u32 s51, s51, 32768
 s_add_u32 m0, s57, 72704
 s_nop 0
 buffer_load_dwordx4 v5, s[8:11], s51 offen lds
 s_add_u32 s51, s51, 32768
 s_mul_i32 s51, s67, 1048576
 s_add_u32 s51, s51, s55
 s_add_u32 m0, s57, 98304
 s_nop 0
 buffer_load_dwordx4 v4, s[8:11], s51 offen lds
 s_add_u32 s51, s51, 32768
 s_add_u32 m0, s57, 99328
 s_nop 0
 buffer_load_dwordx4 v5, s[8:11], s51 offen lds
 s_add_u32 s51, s51, 32768
 s_add_u32 m0, s57, 100352
 s_nop 0
 buffer_load_dwordx4 v4, s[8:11], s51 offen lds
 s_add_u32 s51, s51, 32768
 s_add_u32 m0, s57, 101376
 s_nop 0
 buffer_load_dwordx4 v5, s[8:11], s51 offen lds
 s_add_u32 s51, s51, 32768
 s_add_u32 m0, s57, 102400
 s_nop 0
 buffer_load_dwordx4 v4, s[8:11], s51 offen lds
 s_add_u32 s51, s51, 32768
 s_add_u32 m0, s57, 103424
 s_nop 0
 buffer_load_dwordx4 v5, s[8:11], s51 offen lds
 s_add_u32 s51, s51, 32768
 s_add_u32 m0, s57, 104448
 s_nop 0
 buffer_load_dwordx4 v4, s[8:11], s51 offen lds
 s_add_u32 s51, s51, 32768
 s_add_u32 m0, s57, 105472
 s_nop 0
 buffer_load_dwordx4 v5, s[8:11], s51 offen lds
 s_add_u32 s51, s51, 32768
 s_mul_i32 s51, s68, 1048576
 s_add_u32 s51, s51, s55
 s_add_u32 m0, s57, 131072
 s_nop 0
 buffer_load_dwordx4 v4, s[8:11], s51 offen lds
 s_add_u32 s51, s51, 32768
 s_add_u32 m0, s57, 132096
 s_nop 0
 buffer_load_dwordx4 v5, s[8:11], s51 offen lds
 s_add_u32 s51, s51, 32768
 s_add_u32 m0, s57, 133120
 s_nop 0
 buffer_load_dwordx4 v4, s[8:11], s51 offen lds
 s_add_u32 s51, s51, 32768
 s_add_u32 m0, s57, 134144
 s_nop 0
 buffer_load_dwordx4 v5, s[8:11], s51 offen lds
 s_add_u32 s51, s51, 32768
 s_add_u32 m0, s57, 135168
 s_nop 0
 buffer_load_dwordx4 v4, s[8:11], s51 offen lds
 s_add_u32 s51, s51, 32768
 s_add_u32 m0, s57, 136192
 s_nop 0
 buffer_load_dwordx4 v5, s[8:11], s51 offen lds
 s_add_u32 s51, s51, 32768
 s_add_u32 m0, s57, 137216
 s_nop 0
 buffer_load_dwordx4 v4, s[8:11], s51 offen lds
 s_add_u32 s51, s51, 32768
 s_add_u32 m0, s57, 138240
 s_nop 0
 buffer_load_dwordx4 v5, s[8:11], s51 offen lds
 s_add_u32 s51, s51, 32768
 s_mov_b32 s96, s44
 s_and_b32 s97, s45, 0xffff
 s_mov_b32 s98, 256
 s_mov_b32 s99, 0x00020000
 buffer_load_dword v30, off, s[96:99], 0 offset:132 sc1
 v_lshrrev_b32 v2, 3, v0
 v_and_b32 v2, 4, v2
 v_bfe_u32 v3, v0, 2, 2
 v_or_b32 v2, v2, v3
 v_bfe_u32 v3, v0, 4, 1
 v_xor_b32 v3, v3, v2
 s_lshl_b32 s3, s50, 1
 v_xor_b32 v3, s3, v3
 v_lshlrev_b32 v2, 8, v2
 v_lshl_add_u32 v2, v3, 5, v2
 v_and_b32 v3, 3, v0
 v_lshl_add_u32 v2, v3, 3, v2
 s_waitcnt vmcnt(32)
 s_barrier
 ds_read_b64_tr_b16 a[0:1], v2 offset:0
 ds_read_b64_tr_b16 a[2:3], v2 offset:4096
 ds_read_b64_tr_b16 a[4:5], v2 offset:2048
 ds_read_b64_tr_b16 a[6:7], v2 offset:6144
 ds_read_b64_tr_b16 a[8:9], v2 offset:8192
 ds_read_b64_tr_b16 a[10:11], v2 offset:12288
 ds_read_b64_tr_b16 a[12:13], v2 offset:10240
 ds_read_b64_tr_b16 a[14:15], v2 offset:14336
 ds_read_b64_tr_b16 a[16:17], v2 offset:16384
 ds_read_b64_tr_b16 a[18:19], v2 offset:20480
 ds_read_b64_tr_b16 a[20:21], v2 offset:18432
 ds_read_b64_tr_b16 a[22:23], v2 offset:22528
 ds_read_b64_tr_b16 a[24:25], v2 offset:24576
 ds_read_b64_tr_b16 a[26:27], v2 offset:28672
 ds_read_b64_tr_b16 a[28:29], v2 offset:26624
 ds_read_b64_tr_b16 a[30:31], v2 offset:30720
 v_add_u32 v2, 0x8000, v2
 s_waitcnt vmcnt(24)
 s_barrier
 ds_read_b64_tr_b16 a[32:33], v2 offset:0
 ds_read_b64_tr_b16 a[34:35], v2 offset:4096
 ds_read_b64_tr_b16 a[36:37], v2 offset:2048
 ds_read_b64_tr_b16 a[38:39], v2 offset:6144
 ds_read_b64_tr_b16 a[40:41], v2 offset:8192
 ds_read_b64_tr_b16 a[42:43], v2 offset:12288
 ds_read_b64_tr_b16 a[44:45], v2 offset:10240
 ds_read_b64_tr_b16 a[46:47], v2 offset:14336
 ds_read_b64_tr_b16 a[48:49], v2 offset:16384
 ds_read_b64_tr_b16 a[50:51], v2 offset:20480
 ds_read_b64_tr_b16 a[52:53], v2 offset:18432
 ds_read_b64_tr_b16 a[54:55], v2 offset:22528
 ds_read_b64_tr_b16 a[56:57], v2 offset:24576
 ds_read_b64_tr_b16 a[58:59], v2 offset:28672
 ds_read_b64_tr_b16 a[60:61], v2 offset:26624
 ds_read_b64_tr_b16 a[62:63], v2 offset:30720
 v_add_u32 v2, 0x8000, v2
 s_waitcnt vmcnt(16)
 s_barrier
 ds_read_b64_tr_b16 a[64:65], v2 offset:0
 ds_read_b64_tr_b16 a[66:67], v2 offset:4096
 ds_read_b64_tr_b16 a[68:69], v2 offset:2048
 ds_read_b64_tr_b16 a[70:71], v2 offset:6144
 ds_read_b64_tr_b16 a[72:73], v2 offset:8192
 ds_read_b64_tr_b16 a[74:75], v2 offset:12288
 ds_read_b64_tr_b16 a[76:77], v2 offset:10240
 ds_read_b64_tr_b16 a[78:79], v2 offset:14336
 ds_read_b64_tr_b16 a[80:81], v2 offset:16384
 ds_read_b64_tr_b16 a[82:83], v2 offset:20480
 ds_read_b64_tr_b16 a[84:85], v2 offset:18432
 ds_read_b64_tr_b16 a[86:87], v2 offset:22528
 ds_read_b64_tr_b16 a[88:89], v2 offset:24576
 ds_read_b64_tr_b16 a[90:91], v2 offset:28672
 ds_read_b64_tr_b16 a[92:93], v2 offset:26624
 ds_read_b64_tr_b16 a[94:95], v2 offset:30720
 v_add_u32 v2, 0x8000, v2
 s_waitcnt vmcnt(8)
 s_barrier
 ds_read_b64_tr_b16 a[96:97], v2 offset:0
 ds_read_b64_tr_b16 a[98:99], v2 offset:4096
 ds_read_b64_tr_b16 a[100:101], v2 offset:2048
 ds_read_b64_tr_b16 a[102:103], v2 offset:6144
 ds_read_b64_tr_b16 a[104:105], v2 offset:8192
 ds_read_b64_tr_b16 a[106:107], v2 offset:12288
 ds_read_b64_tr_b16 a[108:109], v2 offset:10240
 ds_read_b64_tr_b16 a[110:111], v2 offset:14336
 ds_read_b64_tr_b16 a[112:113], v2 offset:16384
 ds_read_b64_tr_b16 a[114:115], v2 offset:20480
 ds_read_b64_tr_b16 a[116:117], v2 offset:18432
 ds_read_b64_tr_b16 a[118:119], v2 offset:22528
 ds_read_b64_tr_b16 a[120:121], v2 offset:24576
 ds_read_b64_tr_b16 a[122:123], v2 offset:28672
 ds_read_b64_tr_b16 a[124:125], v2 offset:26624
 ds_read_b64_tr_b16 a[126:127], v2 offset:30720
 v_add_u32 v2, 0x8000, v2
 s_waitcnt vmcnt(0)
 s_barrier
 ds_read_b64_tr_b16 a[128:129], v2 offset:0
 ds_read_b64_tr_b16 a[130:131], v2 offset:4096
 ds_read_b64_tr_b16 a[132:133], v2 offset:2048
 ds_read_b64_tr_b16 a[134:135], v2 offset:6144
 ds_read_b64_tr_b16 a[136:137], v2 offset:8192
 ds_read_b64_tr_b16 a[138:139], v2 offset:12288
 ds_read_b64_tr_b16 a[140:141], v2 offset:10240
 ds_read_b64_tr_b16 a[142:143], v2 offset:14336
 ds_read_b64_tr_b16 a[144:145], v2 offset:16384
 ds_read_b64_tr_b16 a[146:147], v2 offset:20480
 ds_read_b64_tr_b16 a[148:149], v2 offset:18432
 ds_read_b64_tr_b16 a[150:151], v2 offset:22528
 ds_read_b64_tr_b16 a[152:153], v2 offset:24576
 ds_read_b64_tr_b16 a[154:155], v2 offset:28672
 ds_read_b64_tr_b16 a[156:157], v2 offset:26624
 ds_read_b64_tr_b16 a[158:159], v2 offset:30720
 v_add_u32 v2, 0x8000, v2
 s_waitcnt lgkmcnt(0)
 s_barrier
 v_cmp_eq_u32 vcc, 0, v30
 s_cbranch_vccz L_qa_72
 s_mov_b32 s96, s44
 s_and_b32 s97, s45, 0xffff
 s_mov_b32 s98, 256
 s_mov_b32 s99, 0x00020000
 v_mov_b32 v1, 132
 s_mov_b32 s51, 0
 s_mov_b64 exec, 1
L_wb_73:
 buffer_load_dword v2, v1, s[96:99], 0 offen sc1
 s_waitcnt vmcnt(0)
 v_cmp_eq_u32 vcc, 0, v2
 s_cbranch_vccz L_wbd_74
 s_sleep 2
 s_add_u32 s51, s51, 1
 s_cmp_lt_u32 s51, 131072
 s_cbranch_scc1 L_wb_73
 s_branch L_bail
L_wbd_74:
 s_mov_b64 exec, -1
L_qa_72:
 s_lshl_b32 s64, s64, 8
 s_lshl_b32 s65, s65, 8
 s_lshl_b32 s66, s66, 8
 s_lshl_b32 s67, s67, 8
 s_lshl_b32 s68, s68, 8
 s_cmp_eq_u32 s53, 0
 s_cselect_b32 s78, 2, 3
 s_mov_b32 s79, 0
 v_lshrrev_b32 v1, 4, v0
 s_mov_b32 s3, 1280
 v_mul_lo_u32 v1, v1, s3
 v_and_b32 v3, 15, v0
 v_lshl_add_u32 v1, v3, 4, v1
 v_add_u32 v6, 5120, v1
 v_mov_b32 v24, v6
 v_and_b32 v2, 31, v0
 v_lshlrev_b32 v2, 8, v2
 v_lshrrev_b32 v4, 5, v0
 v_xor_b32 v4, v4, v3
 v_xor_b32 v8, 0, v4
 v_lshl_add_u32 v8, v8, 4, v2
 v_add_u32 v16, 40960, v8
 v_xor_b32 v9, 2, v4
 v_lshl_add_u32 v9, v9, 4, v2
 v_add_u32 v17, 40960, v9
 v_xor_b32 v10, 4, v4
 v_lshl_add_u32 v10, v10, 4, v2
 v_add_u32 v18, 40960, v10
 v_xor_b32 v11, 6, v4
 v_lshl_add_u32 v11, v11, 4, v2
 v_add_u32 v19, 40960, v11
 v_xor_b32 v12, 8, v4
 v_lshl_add_u32 v12, v12, 4, v2
 v_add_u32 v20, 40960, v12
 v_xor_b32 v13, 10, v4
 v_lshl_add_u32 v13, v13, 4, v2
 v_add_u32 v21, 40960, v13
 v_xor_b32 v14, 12, v4
 v_lshl_add_u32 v14, v14, 4, v2
 v_add_u32 v22, 40960, v14
 v_xor_b32 v15, 14, v4
 v_lshl_add_u32 v15, v15, 4, v2
 v_add_u32 v23, 40960, v15
 v_lshrrev_b32 v4, 5, v0
 v_lshlrev_b32 v4, 8, v4
 v_lshl_add_u32 v4, v3, 4, v4
 v_and_b32 v2, 16, v0
 v_lshl_add_u32 v4, v2, 6, v4
 s_lshl_b32 s3, s50, 11
 v_add_u32 v4, s3, v4
 v_mul_u32_u24 v5, 24576, v0
 v_mov_b32 v7, 163776
 v_mul_u32_u24 v30, 16384, v0
 s_lshl_b32 s75, s62, 2
 s_add_u32 s75, s75, s50
 s_and_b32 s100, s52, 1
 s_lshl_b32 s100, s100, 13
 s_lshl_b32 s58, s52, 14
 s_add_u32 s58, s58, s100
 s_add_u32 s58, s58, 75497472
 s_cmp_eq_u32 s53, 0
 s_cselect_b32 s82, 8192, 0
 s_lshl_b32 s59, s52, 8
 s_add_u32 s59, s59, 8192
 s_lshl_b32 s56, s50, 11
 s_mov_b32 s54, 0
 s_mov_b32 s61, 0
 s_mov_b32 s70, s75
 s_mul_i32 s55, s54, 40960
 s_mul_i32 s3, s50, 10240
 s_add_u32 s55, s55, s3
 s_add_u32 s55, s55, 226492416
 s_add_u32 m0, s56, 0
 s_add_u32 s3, s55, s64
 buffer_load_dwordx4 v1, s[4:7], s3 offen sc1 lds
 s_add_u32 m0, s56, 1024
 s_add_u32 s3, s55, s64
 buffer_load_dwordx4 v24, s[4:7], s3 offen sc1 lds
 s_add_u32 m0, s56, 8192
 s_add_u32 s3, s55, s65
 buffer_load_dwordx4 v1, s[4:7], s3 offen sc1 lds
 s_add_u32 m0, s56, 9216
 s_add_u32 s3, s55, s65
 buffer_load_dwordx4 v24, s[4:7], s3 offen sc1 lds
 s_add_u32 m0, s56, 16384
 s_add_u32 s3, s55, s66
 buffer_load_dwordx4 v1, s[4:7], s3 offen sc1 lds
 s_add_u32 m0, s56, 17408
 s_add_u32 s3, s55, s66
 buffer_load_dwordx4 v24, s[4:7], s3 offen sc1 lds
 s_add_u32 m0, s56, 24576
 s_add_u32 s3, s55, s67
 buffer_load_dwordx4 v1, s[4:7], s3 offen sc1 lds
 s_add_u32 m0, s56, 25600
 s_add_u32 s3, s55, s67
 buffer_load_dwordx4 v24, s[4:7], s3 offen sc1 lds
 s_add_u32 m0, s56, 32768
 s_add_u32 s3, s55, s68
 buffer_load_dwordx4 v1, s[4:7], s3 offen sc1 lds
 s_add_u32 m0, s56, 33792
 s_add_u32 s3, s55, s68
 buffer_load_dwordx4 v24, s[4:7], s3 offen sc1 lds
 s_waitcnt vmcnt(0)
L_qkvv_pre:
 s_barrier
 s_mov_b32 s60, s54
 s_add_u32 s54, s54, 1
 s_mul_i32 s55, s54, 40960
 s_mul_i32 s3, s50, 10240
 s_add_u32 s55, s55, s3
 s_add_u32 s55, s55, 226492416
 ds_read_b128 v[32:35], v8 offset:0
 ds_read_b128 v[36:39], v9 offset:0
 ds_read_b128 v[40:43], v10 offset:0
 ds_read_b128 v[44:47], v11 offset:0
 s_waitcnt lgkmcnt(3)
 v_mfma_f32_32x32x16_bf16 v[64:79], v[32:35], a[0:3], 0
 ds_read_b128 v[48:51], v12 offset:0
 s_add_u32 m0, s56, 40960
 s_add_u32 s3, s55, s64
 buffer_load_dwordx4 v1, s[4:7], s3 offen sc1 lds
 s_waitcnt lgkmcnt(3)
 v_mfma_f32_32x32x16_bf16 v[64:79], v[36:39], a[4:7], v[64:79]
 ds_read_b128 v[52:55], v13 offset:0
 s_waitcnt lgkmcnt(3)
 v_mfma_f32_32x32x16_bf16 v[64:79], v[40:43], a[8:11], v[64:79]
 ds_read_b128 v[56:59], v14 offset:0
 s_waitcnt lgkmcnt(3)
 v_mfma_f32_32x32x16_bf16 v[64:79], v[44:47], a[12:15], v[64:79]
 ds_read_b128 v[60:63], v15 offset:0
 s_add_u32 m0, s56, 41984
 s_add_u32 s3, s55, s64
 buffer_load_dwordx4 v24, s[4:7], s3 offen sc1 lds
 s_waitcnt lgkmcnt(3)
 v_mfma_f32_32x32x16_bf16 v[64:79], v[48:51], a[16:19], v[64:79]
 ds_read_b128 v[32:35], v8 offset:8192
 s_waitcnt lgkmcnt(3)
 v_mfma_f32_32x32x16_bf16 v[64:79], v[52:55], a[20:23], v[64:79]
 ds_read_b128 v[36:39], v9 offset:8192
 s_waitcnt lgkmcnt(3)
 v_mfma_f32_32x32x16_bf16 v[64:79], v[56:59], a[24:27], v[64:79]
 ds_read_b128 v[40:43], v10 offset:8192
 s_add_u32 m0, s56, 49152
 s_add_u32 s3, s55, s65
 buffer_load_dwordx4 v1, s[4:7], s3 offen sc1 lds
 s_waitcnt lgkmcnt(3)
 v_mfma_f32_32x32x16_bf16 v[64:79], v[60:63], a[28:31], v[64:79]
 ds_read_b128 v[44:47], v11 offset:8192
 s_waitcnt lgkmcnt(3)
 v_mfma_f32_32x32x16_bf16 v[64:79], v[32:35], a[32:35], v[64:79]
 ds_read_b128 v[48:51], v12 offset:8192
 s_waitcnt lgkmcnt(3)
 v_mfma_f32_32x32x16_bf16 v[64:79], v[36:39], a[36:39], v[64:79]
 ds_read_b128 v[52:55], v13 offset:8192
 s_add_u32 m0, s56, 50176
 s_add_u32 s3, s55, s65
 buffer_load_dwordx4 v24, s[4:7], s3 offen sc1 lds
 s_waitcnt lgkmcnt(3)
 v_mfma_f32_32x32x16_bf16 v[64:79], v[40:43], a[40:43], v[64:79]
 ds_read_b128 v[56:59], v14 offset:8192
 s_waitcnt lgkmcnt(3)
 v_mfma_f32_32x32x16_bf16 v[64:79], v[44:47], a[44:47], v[64:79]
 ds_read_b128 v[60:63], v15 offset:8192
 s_waitcnt lgkmcnt(3)
 v_mfma_f32_32x32x16_bf16 v[64:79], v[48:51], a[48:51], v[64:79]
 ds_read_b128 v[32:35], v8 offset:16384
 s_add_u32 m0, s56, 57344
 s_add_u32 s3, s55, s66
 buffer_load_dwordx4 v1, s[4:7], s3 offen sc1 lds
 s_waitcnt lgkmcnt(3)
 v_mfma_f32_32x32x16_bf16 v[64:79], v[52:55], a[52:55], v[64:79]
 ds_read_b128 v[36:39], v9 offset:16384
 s_waitcnt lgkmcnt(3)
 v_mfma_f32_32x32x16_bf16 v[64:79], v[56:59], a[56:59], v[64:79]
 ds_read_b128 v[40:43], v10 offset:16384
 s_waitcnt lgkmcnt(3)
 v_mfma_f32_32x32x16_bf16 v[64:79], v[60:63], a[60:63], v[64:79]
 ds_read_b128 v[44:47], v11 offset:16384
 s_add_u32 m0, s56, 58368
 s_add_u32 s3, s55, s66
 buffer_load_dwordx4 v24, s[4:7], s3 offen sc1 lds
 s_waitcnt lgkmcnt(3)
 v_mfma_f32_32x32x16_bf16 v[64:79], v[32:35], a[64:67], v[64:79]
 ds_read_b128 v[48:51], v12 offset:16384
 s_waitcnt lgkmcnt(3)
 v_mfma_f32_32x32x16_bf16 v[64:79], v[36:39], a[68:71], v[64:79]
 ds_read_b128 v[52:55], v13 offset:16384
 s_waitcnt lgkmcnt(3)
 v_mfma_f32_32x32x16_bf16 v[64:79], v[40:43], a[72:75], v[64:79]
 ds_read_b128 v[56:59], v14 offset:16384
 s_add_u32 m0, s56, 65536
 s_add_u32 s3, s55, s67
 buffer_load_dwordx4 v1, s[4:7], s3 offen sc1 lds
 s_waitcnt lgkmcnt(3)
 v_mfma_f32_32x32x16_bf16 v[64:79], v[44:47], a[76:79], v[64:79]
 ds_read_b128 v[60:63], v15 offset:16384
 s_waitcnt vmcnt(7)
 s_cmp_eq_u32 s61, 0
 s_cbranch_scc1 L_pf_75
 s_lshl_b32 s3, s61, 2
 s_add_u32 s3, s3, s59
 s_sub_u32 s3, s3, 4
 v_mov_b32 v3, 1
 s_mov_b64 exec, s[78:79]
 buffer_atomic_add v3, v30, s[4:7], s3 offen
 s_mov_b64 exec, -1
 s_mov_b32 s61, 0
L_pf_75:
 s_waitcnt lgkmcnt(3)
 v_mfma_f32_32x32x16_bf16 v[64:79], v[48:51], a[80:83], v[64:79]
 ds_read_b128 v[32:35], v8 offset:24576
 s_waitcnt lgkmcnt(3)
 v_mfma_f32_32x32x16_bf16 v[64:79], v[52:55], a[84:87], v[64:79]
 ds_read_b128 v[36:39], v9 offset:24576
 s_add_u32 m0, s56, 66560
 s_add_u32 s3, s55, s67
 buffer_load_dwordx4 v24, s[4:7], s3 offen sc1 lds
 s_waitcnt lgkmcnt(3)
 v_mfma_f32_32x32x16_bf16 v[64:79], v[56:59], a[88:91], v[64:79]
 ds_read_b128 v[40:43], v10 offset:24576
 s_waitcnt lgkmcnt(3)
 v_mfma_f32_32x32x16_bf16 v[64:79], v[60:63], a[92:95], v[64:79]
 ds_read_b128 v[44:47], v11 offset:24576
 s_waitcnt lgkmcnt(3)
 v_mfma_f32_32x32x16_bf16 v[64:79], v[32:35], a[96:99], v[64:79]
 ds_read_b128 v[48:51], v12 offset:24576
 s_add_u32 m0, s56, 73728
 s_add_u32 s3, s55, s68
 buffer_load_dwordx4 v1, s[4:7], s3 offen sc1 lds
 s_waitcnt lgkmcnt(3)
 v_mfma_f32_32x32x16_bf16 v[64:79], v[36:39], a[100:103], v[64:79]
 ds_read_b128 v[52:55], v13 offset:24576
 s_waitcnt lgkmcnt(3)
 v_mfma_f32_32x32x16_bf16 v[64:79], v[40:43], a[104:107], v[64:79]
 ds_read_b128 v[56:59], v14 offset:24576
 s_waitcnt lgkmcnt(3)
 v_mfma_f32_32x32x16_bf16 v[64:79], v[44:47], a[108:111], v[64:79]
 ds_read_b128 v[60:63], v15 offset:24576
 s_add_u32 m0, s56, 74752
 s_add_u32 s3, s55, s68
 buffer_load_dwordx4 v24, s[4:7], s3 offen sc1 lds
 s_waitcnt lgkmcnt(3)
 v_mfma_f32_32x32x16_bf16 v[64:79], v[48:51], a[112:115], v[64:79]
 ds_read_b128 v[32:35], v8 offset:32768
 s_waitcnt lgkmcnt(3)
 v_mfma_f32_32x32x16_bf16 v[64:79], v[52:55], a[116:119], v[64:79]
 ds_read_b128 v[36:39], v9 offset:32768
 s_waitcnt lgkmcnt(3)
 v_mfma_f32_32x32x16_bf16 v[64:79], v[56:59], a[120:123], v[64:79]
 ds_read_b128 v[40:43], v10 offset:32768
 s_waitcnt lgkmcnt(3)
 v_mfma_f32_32x32x16_bf16 v[64:79], v[60:63], a[124:127], v[64:79]
 ds_read_b128 v[44:47], v11 offset:32768
 s_waitcnt lgkmcnt(3)
 v_mfma_f32_32x32x16_bf16 v[64:79], v[32:35], a[128:131], v[64:79]
 ds_read_b128 v[48:51], v12 offset:32768
 s_waitcnt lgkmcnt(3)
 v_mfma_f32_32x32x16_bf16 v[64:79], v[36:39], a[132:135], v[64:79]
 ds_read_b128 v[52:55], v13 offset:32768
 s_waitcnt lgkmcnt(3)
 v_mfma_f32_32x32x16_bf16 v[64:79], v[40:43], a[136:139], v[64:79]
 ds_read_b128 v[56:59], v14 offset:32768
 s_waitcnt lgkmcnt(3)
 v_mfma_f32_32x32x16_bf16 v[64:79], v[44:47], a[140:143], v[64:79]
 ds_read_b128 v[60:63], v15 offset:32768
 s_waitcnt lgkmcnt(3)
 v_mfma_f32_32x32x16_bf16 v[64:79], v[48:51], a[144:147], v[64:79]
 s_waitcnt lgkmcnt(2)
 v_mfma_f32_32x32x16_bf16 v[64:79], v[52:55], a[148:151], v[64:79]
 s_waitcnt lgkmcnt(1)
 v_mfma_f32_32x32x16_bf16 v[64:79], v[56:59], a[152:155], v[64:79]
 s_waitcnt lgkmcnt(0)
 v_mfma_f32_32x32x16_bf16 v[64:79], v[60:63], a[156:159], v[64:79]
 s_lshl_b32 s3, s60, 19
 s_add_u32 s3, s3, s58
 s_xor_b32 s3, s3, s82
 s_nop 8
 v_cvt_pk_bf16_f32 v80, v64, v65
 v_cvt_pk_bf16_f32 v81, v66, v67
 v_cvt_pk_bf16_f32 v82, v72, v73
 v_cvt_pk_bf16_f32 v83, v74, v75
 buffer_store_dwordx4 v[80:83], v4, s[4:7], s3 offen offset:0 sc1
 v_cvt_pk_bf16_f32 v84, v68, v69
 v_cvt_pk_bf16_f32 v85, v70, v71
 v_cvt_pk_bf16_f32 v86, v76, v77
 v_cvt_pk_bf16_f32 v87, v78, v79
 buffer_store_dwordx4 v[84:87], v4, s[4:7], s3 offen offset:512 sc1
 s_mov_b32 s61, s54
 s_cmp_lg_u32 s54, 1
 s_cbranch_scc1 L_f1_76
 s_waitcnt vmcnt(0)
 s_cmp_eq_u32 s61, 0
 s_cbranch_scc1 L_pf_77
 s_lshl_b32 s3, s61, 2
 s_add_u32 s3, s3, s59
 s_sub_u32 s3, s3, 4
 v_mov_b32 v3, 1
 s_mov_b64 exec, s[78:79]
 buffer_atomic_add v3, v30, s[4:7], s3 offen
 s_mov_b64 exec, -1
 s_mov_b32 s61, 0
L_pf_77:
 s_mov_b32 s8, s38
 s_and_b32 s9, s39, 0xffff
 s_mov_b32 s10, 2621440
 s_mov_b32 s11, 0x00020000
 s_mov_b32 s12, s40
 s_and_b32 s13, s41, 0xffff
 s_mov_b32 s14, 1280
 s_mov_b32 s15, 0x00020000
 v_lshlrev_b32 v130, 4, v0
 s_lshl_b32 s73, s70, 12
 s_add_u32 s74, s73, 2
 buffer_load_dwordx4 v[96:99], v130, s[8:11], s73 offen offset:0
 buffer_load_dwordx4 v[100:103], v130, s[8:11], s73 offen offset:1024
 buffer_load_dwordx4 v[112:115], v130, s[8:11], s74 offen offset:0
 buffer_load_dwordx4 v[116:119], v130, s[8:11], s74 offen offset:1024
 s_lshl_b32 s3, s70, 1
 buffer_load_ushort v128, off, s[12:15], s3
 s_branch L_f2_78
L_f1_76:
 s_waitcnt vmcnt(2)
L_f2_78:
 s_barrier
 s_mov_b32 s60, s54
 s_add_u32 s54, s54, 1
 s_mul_i32 s55, s54, 40960
 s_mul_i32 s3, s50, 10240
 s_add_u32 s55, s55, s3
 s_add_u32 s55, s55, 226492416
 ds_read_b128 v[32:35], v16 offset:0
 ds_read_b128 v[36:39], v17 offset:0
 ds_read_b128 v[40:43], v18 offset:0
 ds_read_b128 v[44:47], v19 offset:0
 s_waitcnt lgkmcnt(3)
 v_mfma_f32_32x32x16_bf16 v[64:79], v[32:35], a[0:3], 0
 ds_read_b128 v[48:51], v20 offset:0
 s_add_u32 m0, s56, 0
 s_add_u32 s3, s55, s64
 buffer_load_dwordx4 v1, s[4:7], s3 offen sc1 lds
 s_waitcnt lgkmcnt(3)
 v_mfma_f32_32x32x16_bf16 v[64:79], v[36:39], a[4:7], v[64:79]
 ds_read_b128 v[52:55], v21 offset:0
 s_waitcnt lgkmcnt(3)
 v_mfma_f32_32x32x16_bf16 v[64:79], v[40:43], a[8:11], v[64:79]
 ds_read_b128 v[56:59], v22 offset:0
 s_waitcnt lgkmcnt(3)
 v_mfma_f32_32x32x16_bf16 v[64:79], v[44:47], a[12:15], v[64:79]
 ds_read_b128 v[60:63], v23 offset:0
 s_add_u32 m0, s56, 1024
 s_add_u32 s3, s55, s64
 buffer_load_dwordx4 v24, s[4:7], s3 offen sc1 lds
 s_waitcnt lgkmcnt(3)
 v_mfma_f32_32x32x16_bf16 v[64:79], v[48:51], a[16:19], v[64:79]
 ds_read_b128 v[32:35], v16 offset:8192
 s_waitcnt lgkmcnt(3)
 v_mfma_f32_32x32x16_bf16 v[64:79], v[52:55], a[20:23], v[64:79]
 ds_read_b128 v[36:39], v17 offset:8192
 s_waitcnt lgkmcnt(3)
 v_mfma_f32_32x32x16_bf16 v[64:79], v[56:59], a[24:27], v[64:79]
 ds_read_b128 v[40:43], v18 offset:8192
 s_add_u32 m0, s56, 8192
 s_add_u32 s3, s55, s65
 buffer_load_dwordx4 v1, s[4:7], s3 offen sc1 lds
 s_waitcnt lgkmcnt(3)
 v_mfma_f32_32x32x16_bf16 v[64:79], v[60:63], a[28:31], v[64:79]
 ds_read_b128 v[44:47], v19 offset:8192
 s_waitcnt lgkmcnt(3)
 v_mfma_f32_32x32x16_bf16 v[64:79], v[32:35], a[32:35], v[64:79]
 ds_read_b128 v[48:51], v20 offset:8192
 s_waitcnt lgkmcnt(3)
 v_mfma_f32_32x32x16_bf16 v[64:79], v[36:39], a[36:39], v[64:79]
 ds_read_b128 v[52:55], v21 offset:8192
 s_add_u32 m0, s56, 9216
 s_add_u32 s3, s55, s65
 buffer_load_dwordx4 v24, s[4:7], s3 offen sc1 lds
 s_waitcnt lgkmcnt(3)
 v_mfma_f32_32x32x16_bf16 v[64:79], v[40:43], a[40:43], v[64:79]
 ds_read_b128 v[56:59], v22 offset:8192
 s_waitcnt lgkmcnt(3)
 v_mfma_f32_32x32x16_bf16 v[64:79], v[44:47], a[44:47], v[64:79]
 ds_read_b128 v[60:63], v23 offset:8192
 s_waitcnt lgkmcnt(3)
 v_mfma_f32_32x32x16_bf16 v[64:79], v[48:51], a[48:51], v[64:79]
 ds_read_b128 v[32:35], v16 offset:16384
 s_add_u32 m0, s56, 16384
 s_add_u32 s3, s55, s66
 buffer_load_dwordx4 v1, s[4:7], s3 offen sc1 lds
 s_waitcnt lgkmcnt(3)
 v_mfma_f32_32x32x16_bf16 v[64:79], v[52:55], a[52:55], v[64:79]
 ds_read_b128 v[36:39], v17 offset:16384
 s_waitcnt lgkmcnt(3)
 v_mfma_f32_32x32x16_bf16 v[64:79], v[56:59], a[56:59], v[64:79]
 ds_read_b128 v[40:43], v18 offset:16384
 s_waitcnt lgkmcnt(3)
 v_mfma_f32_32x32x16_bf16 v[64:79], v[60:63], a[60:63], v[64:79]
 ds_read_b128 v[44:47], v19 offset:16384
 s_add_u32 m0, s56, 17408
 s_add_u32 s3, s55, s66
 buffer_load_dwordx4 v24, s[4:7], s3 offen sc1 lds
 s_waitcnt lgkmcnt(3)
 v_mfma_f32_32x32x16_bf16 v[64:79], v[32:35], a[64:67], v[64:79]
 ds_read_b128 v[48:51], v20 offset:16384
 s_waitcnt lgkmcnt(3)
 v_mfma_f32_32x32x16_bf16 v[64:79], v[36:39], a[68:71], v[64:79]
 ds_read_b128 v[52:55], v21 offset:16384
 s_waitcnt lgkmcnt(3)
 v_mfma_f32_32x32x16_bf16 v[64:79], v[40:43], a[72:75], v[64:79]
 ds_read_b128 v[56:59], v22 offset:16384
 s_add_u32 m0, s56, 24576
 s_add_u32 s3, s55, s67
 buffer_load_dwordx4 v1, s[4:7], s3 offen sc1 lds
 s_waitcnt lgkmcnt(3)
 v_mfma_f32_32x32x16_bf16 v[64:79], v[44:47], a[76:79], v[64:79]
 ds_read_b128 v[60:63], v23 offset:16384
 s_waitcnt vmcnt(7)
 s_cmp_eq_u32 s61, 0
 s_cbranch_scc1 L_pf_79
 s_lshl_b32 s3, s61, 2
 s_add_u32 s3, s3, s59
 s_sub_u32 s3, s3, 4
 v_mov_b32 v3, 1
 s_mov_b64 exec, s[78:79]
 buffer_atomic_add v3, v30, s[4:7], s3 offen
 s_mov_b64 exec, -1
 s_mov_b32 s61, 0
L_pf_79:
 s_waitcnt lgkmcnt(3)
 v_mfma_f32_32x32x16_bf16 v[64:79], v[48:51], a[80:83], v[64:79]
 ds_read_b128 v[32:35], v16 offset:24576
 s_waitcnt lgkmcnt(3)
 v_mfma_f32_32x32x16_bf16 v[64:79], v[52:55], a[84:87], v[64:79]
 ds_read_b128 v[36:39], v17 offset:24576
 s_add_u32 m0, s56, 25600
 s_add_u32 s3, s55, s67
 buffer_load_dwordx4 v24, s[4:7], s3 offen sc1 lds
 s_waitcnt lgkmcnt(3)
 v_mfma_f32_32x32x16_bf16 v[64:79], v[56:59], a[88:91], v[64:79]
 ds_read_b128 v[40:43], v18 offset:24576
 s_waitcnt lgkmcnt(3)
 v_mfma_f32_32x32x16_bf16 v[64:79], v[60:63], a[92:95], v[64:79]
 ds_read_b128 v[44:47], v19 offset:24576
 s_waitcnt lgkmcnt(3)
 v_mfma_f32_32x32x16_bf16 v[64:79], v[32:35], a[96:99], v[64:79]
 ds_read_b128 v[48:51], v20 offset:24576
 s_add_u32 m0, s56, 32768
 s_add_u32 s3, s55, s68
 buffer_load_dwordx4 v1, s[4:7], s3 offen sc1 lds
 s_waitcnt lgkmcnt(3)
 v_mfma_f32_32x32x16_bf16 v[64:79], v[36:39], a[100:103], v[64:79]
 ds_read_b128 v[52:55], v21 offset:24576
 s_waitcnt lgkmcnt(3)
 v_mfma_f32_32x32x16_bf16 v[64:79], v[40:43], a[104:107], v[64:79]
 ds_read_b128 v[56:59], v22 offset:24576
 s_waitcnt lgkmcnt(3)
 v_mfma_f32_32x32x16_bf16 v[64:79], v[44:47], a[108:111], v[64:79]
 ds_read_b128 v[60:63], v23 offset:24576
 s_add_u32 m0, s56, 33792
 s_add_u32 s3, s55, s68
 buffer_load_dwordx4 v24, s[4:7], s3 offen sc1 lds
 s_waitcnt lgkmcnt(3)
 v_mfma_f32_32x32x16_bf16 v[64:79], v[48:51], a[112:115], v[64:79]
 ds_read_b128 v[32:35], v16 offset:32768
 s_waitcnt lgkmcnt(3)
 v_mfma_f32_32x32x16_bf16 v[64:79], v[52:55], a[116:119], v[64:79]
 ds_read_b128 v[36:39], v17 offset:32768
 s_waitcnt lgkmcnt(3)
 v_mfma_f32_32x32x16_bf16 v[64:79], v[56:59], a[120:123], v[64:79]
 ds_read_b128 v[40:43], v18 offset:32768
 s_waitcnt lgkmcnt(3)
 v_mfma_f32_32x32x16_bf16 v[64:79], v[60:63], a[124:127], v[64:79]
 ds_read_b128 v[44:47], v19 offset:32768
 s_waitcnt lgkmcnt(3)
 v_mfma_f32_32x32x16_bf16 v[64:79], v[32:35], a[128:131], v[64:79]
 ds_read_b128 v[48:51], v20 offset:32768
 s_waitcnt lgkmcnt(3)
 v_mfma_f32_32x32x16_bf16 v[64:79], v[36:39], a[132:135], v[64:79]
 ds_read_b128 v[52:55], v21 offset:32768
 s_waitcnt lgkmcnt(3)
 v_mfma_f32_32x32x16_bf16 v[64:79], v[40:43], a[136:139], v[64:79]
 ds_read_b128 v[56:59], v22 offset:32768
 s_waitcnt lgkmcnt(3)
 v_mfma_f32_32x32x16_bf16 v[64:79], v[44:47], a[140:143], v[64:79]
 ds_read_b128 v[60:63], v23 offset:32768
 s_waitcnt lgkmcnt(3)
 v_mfma_f32_32x32x16_bf16 v[64:79], v[48:51], a[144:147], v[64:79]
 s_waitcnt lgkmcnt(2)
 v_mfma_f32_32x32x16_bf16 v[64:79], v[52:55], a[148:151], v[64:79]
 s_waitcnt lgkmcnt(1)
 v_mfma_f32_32x32x16_bf16 v[64:79], v[56:59], a[152:155], v[64:79]
 s_waitcnt lgkmcnt(0)
 v_mfma_f32_32x32x16_bf16 v[64:79], v[60:63], a[156:159], v[64:79]
 s_lshl_b32 s3, s60, 19
 s_add_u32 s3, s3, s58
 s_xor_b32 s3, s3, s82
 s_nop 8
 v_cvt_pk_bf16_f32 v88, v64, v65
 v_cvt_pk_bf16_f32 v89, v66, v67
 v_cvt_pk_bf16_f32 v90, v72, v73
 v_cvt_pk_bf16_f32 v91, v74, v75
 buffer_store_dwordx4 v[88:91], v4, s[4:7], s3 offen offset:0 sc1
 v_cvt_pk_bf16_f32 v92, v68, v69
 v_cvt_pk_bf16_f32 v93, v70, v71
 v_cvt_pk_bf16_f32 v94, v76, v77
 v_cvt_pk_bf16_f32 v95, v78, v79
 buffer_store_dwordx4 v[92:95], v4, s[4:7], s3 offen offset:512 sc1
 s_mov_b32 s61, s54
 s_waitcnt vmcnt(2)
 s_cmp_lg_u32 s54, 4
 s_cbranch_scc1 L_cv_80
 s_waitcnt vmcnt(0)
 s_cmp_eq_u32 s61, 0
 s_cbranch_scc1 L_pf_81
 s_lshl_b32 s3, s61, 2
 s_add_u32 s3, s3, s59
 s_sub_u32 s3, s3, 4
 v_mov_b32 v3, 1
 s_mov_b64 exec, s[78:79]
 buffer_atomic_add v3, v30, s[4:7], s3 offen
 s_mov_b64 exec, -1
 s_mov_b32 s61, 0
L_pf_81:
 s_mul_i32 s71, s50, 13312
 s_add_u32 s71, s71, 81920
 s_mov_b32 s70, s75
 s_mov_b32 s69, 640
 s_getpc_b64 s[76:77]
L_ca_82:
 s_add_u32 s76, s76, L_conv0-L_ca_82
 s_addc_u32 s77, s77, -1
 s_swappc_b64 s[76:77], s[76:77]
 s_waitcnt vmcnt(0)
 s_barrier
 s_cmp_lg_u32 s50, 3
 s_cbranch_scc1 L_ar_83
 s_mov_b32 s96, s44
 s_and_b32 s97, s45, 0xffff
 s_mov_b32 s98, 256
 s_mov_b32 s99, 0x00020000
 v_mov_b32 v1, 1
 s_mov_b64 exec, 1
 buffer_atomic_add v1, off, s[96:99], 0 offset:8 sc0
 s_waitcnt vmcnt(0)
 v_cmp_eq_u32 vcc, 159, v1
 s_cbranch_vccz L_aw_84
 buffer_store_dword v1, off, s[96:99], 0 offset:136 sc1
L_aw_84:
 s_mov_b64 exec, -1
L_ar_83:
 v_lshrrev_b32 v1, 4, v0
 s_mov_b32 s3, 1280
 v_mul_lo_u32 v1, v1, s3
 v_and_b32 v3, 15, v0
 v_lshl_add_u32 v1, v3, 4, v1
 v_add_u32 v6, 5120, v1
 v_mov_b32 v24, v6
 v_and_b32 v2, 31, v0
 v_lshlrev_b32 v2, 8, v2
 v_lshrrev_b32 v4, 5, v0
 v_xor_b32 v4, v4, v3
 v_xor_b32 v8, 0, v4
 v_lshl_add_u32 v8, v8, 4, v2
 v_add_u32 v16, 40960, v8
 v_xor_b32 v9, 2, v4
 v_lshl_add_u32 v9, v9, 4, v2
 v_add_u32 v17, 40960, v9
 v_xor_b32 v10, 4, v4
 v_lshl_add_u32 v10, v10, 4, v2
 v_add_u32 v18, 40960, v10
 v_xor_b32 v11, 6, v4
 v_lshl_add_u32 v11, v11, 4, v2
 v_add_u32 v19, 40960, v11
 v_xor_b32 v12, 8, v4
 v_lshl_add_u32 v12, v12, 4, v2
 v_add_u32 v20, 40960, v12
 v_xor_b32 v13, 10, v4
 v_lshl_add_u32 v13, v13, 4, v2
 v_add_u32 v21, 40960, v13
 v_xor_b32 v14, 12, v4
 v_lshl_add_u32 v14, v14, 4, v2
 v_add_u32 v22, 40960, v14
 v_xor_b32 v15, 14, v4
 v_lshl_add_u32 v15, v15, 4, v2
 v_add_u32 v23, 40960, v15
 v_lshrrev_b32 v4, 5, v0
 v_lshlrev_b32 v4, 8, v4
 v_lshl_add_u32 v4, v3, 4, v4
 v_and_b32 v2, 16, v0
 v_lshl_add_u32 v4, v2, 6, v4
 s_lshl_b32 s3, s50, 11
 v_add_u32 v4, s3, v4
 v_mul_u32_u24 v5, 24576, v0
 v_mov_b32 v7, 163776
 v_mul_u32_u24 v30, 16384, v0
L_cv_80:
 s_cmp_lg_u32 s54, 10
 s_cbranch_scc1 L_cb_85
 s_cmp_lg_u32 s50, 0
 s_cbranch_scc1 L_ww_86
 s_mov_b32 s96, s44
 s_and_b32 s97, s45, 0xffff
 s_mov_b32 s98, 256
 s_mov_b32 s99, 0x00020000
 v_mov_b32 v25, 200
 s_mov_b32 s51, 0
 s_mov_b64 exec, 1
L_wb_87:
 buffer_load_dword v26, v25, s[96:99], 0 offen sc1
 s_waitcnt vmcnt(0)
 v_cmp_eq_u32 vcc, 0, v26
 s_cbranch_vccz L_wbd_88
 s_sleep 2
 s_add_u32 s51, s51, 1
 s_cmp_lt_u32 s51, 131072
 s_cbranch_scc1 L_wb_87
 s_branch L_bail
L_wbd_88:
 s_mov_b64 exec, -1
L_ww_86:
 s_barrier
L_cb_85:
 s_cmp_lt_u32 s54, 16
 s_cbranch_scc1 L_qkvv_pre
 s_waitcnt vmcnt(0)
 s_cmp_eq_u32 s61, 0
 s_cbranch_scc1 L_pf_90
 s_lshl_b32 s3, s61, 2
 s_add_u32 s3, s3, s59
 s_sub_u32 s3, s3, 4
 v_mov_b32 v3, 1
 s_mov_b64 exec, s[78:79]
 buffer_atomic_add v3, v30, s[4:7], s3 offen
 s_mov_b64 exec, -1
 s_mov_b32 s61, 0
L_pf_90:
 s_lshl_b32 s62, s62, 8
 s_add_u32 s62, s62, 126976
 s_add_u32 s63, s59, 8128
L_qkvv_block:
 s_lshl_b32 s55, s54, 2
 s_add_u32 s55, s55, s62
 s_sub_u32 s55, s55, 64
 s_cmp_lg_u32 s50, 0
 s_cselect_b32 s3, 268435456, s55
 v_mov_b32 v6, 8
 s_mov_b64 exec, 15
 v_mov_b32 v6, 0
 buffer_atomic_add v6, v5, s[4:7], s3 offen sc0
 s_mov_b64 exec, -1
 s_waitcnt vmcnt(0)
 s_cmp_eq_u32 s61, 0
 s_cbranch_scc1 L_pf_93
 s_lshl_b32 s3, s61, 2
 s_add_u32 s3, s3, s59
 s_sub_u32 s3, s3, 4
 v_mov_b32 v3, 1
 s_mov_b64 exec, s[78:79]
 buffer_atomic_add v3, v30, s[4:7], s3 offen
 s_mov_b64 exec, -1
 s_mov_b32 s61, 0
L_pf_93:
 s_cmp_lg_u32 s50, 0
 s_cbranch_scc1 L_w_91
 v_cmp_gt_u32 vcc, 8, v6
 s_cbranch_vccz L_w_91
 s_mov_b32 s51, 0
 s_mov_b64 exec, 15
 v_mov_b32 v28, 0
 buffer_atomic_add v28, v5, s[4:7], s55 offen sc0
 s_sleep 5
L_wc_94:
 v_mov_b32 v29, 0
 buffer_atomic_add v29, v5, s[4:7], s55 offen sc0
 s_waitcnt vmcnt(1)
 v_cmp_gt_u32 vcc, 8, v28
 s_cbranch_vccz L_wcd_95
 v_mov_b32 v28, 0
 buffer_atomic_add v28, v5, s[4:7], s55 offen sc0
 s_waitcnt vmcnt(1)
 v_cmp_gt_u32 vcc, 8, v29
 s_cbranch_vccz L_wcd_95
 s_add_u32 s51, s51, 1
 s_cmp_lt_u32 s51, 131072
 s_cbranch_scc1 L_wc_94
 s_branch L_bail
L_wcd_95:
 s_mov_b64 exec, -1
L_w_91:
 s_barrier
 s_branch L_qkvv_loop
L_qkvv_fast:
 s_cmp_lg_u32 s54, 32
 s_cbranch_scc1 L_c2_97
 s_cmp_lg_u32 s50, 0
 s_cbranch_scc1 L_ww_98
 s_mov_b32 s96, s44
 s_and_b32 s97, s45, 0xffff
 s_mov_b32 s98, 256
 s_mov_b32 s99, 0x00020000
 v_mov_b32 v25, 140
 s_mov_b32 s51, 0
 s_mov_b64 exec, 1
L_wb_99:
 buffer_load_dword v26, v25, s[96:99], 0 offen sc1
 s_waitcnt vmcnt(0)
 v_cmp_eq_u32 vcc, 0, v26
 s_cbranch_vccz L_wbd_100
 s_sleep 2
 s_add_u32 s51, s51, 1
 s_cmp_lt_u32 s51, 131072
 s_cbranch_scc1 L_wb_99
 s_branch L_bail
L_wbd_100:
 s_mov_b64 exec, -1
L_ww_98:
 s_barrier
L_c2_97:
 s_sub_u32 s60, s54, 16
 s_lshl_b32 s70, s54, 2
 s_add_u32 s70, s70, s62
 s_sub_u32 s70, s70, 60
 s_cmp_lg_u32 s50, 0
 s_cselect_b32 s70, 268435456, s70
 s_min_u32 s51, s54, 63
 s_mul_i32 s55, s51, 40960
 s_mul_i32 s3, s50, 10240
 s_add_u32 s55, s55, s3
 s_add_u32 s55, s55, 226492416
 ds_read_b128 v[32:35], v16 offset:0
 ds_read_b128 v[36:39], v17 offset:0
 ds_read_b128 v[40:43], v18 offset:0
 ds_read_b128 v[44:47], v19 offset:0
 s_waitcnt lgkmcnt(3)
 v_mfma_f32_32x32x16_bf16 v[64:79], v[32:35], a[0:3], 0
 ds_read_b128 v[48:51], v20 offset:0
 s_add_u32 m0, s56, 0
 s_add_u32 s3, s55, s64
 buffer_load_dwordx4 v1, s[4:7], s3 offen sc1 lds
 s_waitcnt lgkmcnt(3)
 v_mfma_f32_32x32x16_bf16 v[64:79], v[36:39], a[4:7], v[64:79]
 ds_read_b128 v[52:55], v21 offset:0
 s_waitcnt lgkmcnt(3)
 v_mfma_f32_32x32x16_bf16 v[64:79], v[40:43], a[8:11], v[64:79]
 ds_read_b128 v[56:59], v22 offset:0
 s_waitcnt lgkmcnt(3)
 v_mfma_f32_32x32x16_bf16 v[64:79], v[44:47], a[12:15], v[64:79]
 ds_read_b128 v[60:63], v23 offset:0
 s_add_u32 m0, s56, 1024
 s_add_u32 s3, s55, s64
 buffer_load_dwordx4 v24, s[4:7], s3 offen sc1 lds
 s_waitcnt lgkmcnt(3)
 v_mfma_f32_32x32x16_bf16 v[64:79], v[48:51], a[16:19], v[64:79]
 ds_read_b128 v[32:35], v16 offset:8192
 s_waitcnt lgkmcnt(3)
 v_mfma_f32_32x32x16_bf16 v[64:79], v[52:55], a[20:23], v[64:79]
 ds_read_b128 v[36:39], v17 offset:8192
 s_waitcnt lgkmcnt(3)
 v_mfma_f32_32x32x16_bf16 v[64:79], v[56:59], a[24:27], v[64:79]
 ds_read_b128 v[40:43], v18 offset:8192
 s_add_u32 m0, s56, 8192
 s_add_u32 s3, s55, s65
 buffer_load_dwordx4 v1, s[4:7], s3 offen sc1 lds
 s_waitcnt lgkmcnt(3)
 v_mfma_f32_32x32x16_bf16 v[64:79], v[60:63], a[28:31], v[64:79]
 ds_read_b128 v[44:47], v19 offset:8192
 s_waitcnt lgkmcnt(3)
 v_mfma_f32_32x32x16_bf16 v[64:79], v[32:35], a[32:35], v[64:79]
 ds_read_b128 v[48:51], v20 offset:8192
 s_waitcnt lgkmcnt(3)
 v_mfma_f32_32x32x16_bf16 v[64:79], v[36:39], a[36:39], v[64:79]
 ds_read_b128 v[52:55], v21 offset:8192
 s_add_u32 m0, s56, 9216
 s_add_u32 s3, s55, s65
 buffer_load_dwordx4 v24, s[4:7], s3 offen sc1 lds
 s_waitcnt lgkmcnt(3)
 v_mfma_f32_32x32x16_bf16 v[64:79], v[40:43], a[40:43], v[64:79]
 ds_read_b128 v[56:59], v22 offset:8192
 s_waitcnt lgkmcnt(3)
 v_mfma_f32_32x32x16_bf16 v[64:79], v[44:47], a[44:47], v[64:79]
 ds_read_b128 v[60:63], v23 offset:8192
 s_waitcnt lgkmcnt(3)
 v_mfma_f32_32x32x16_bf16 v[64:79], v[48:51], a[48:51], v[64:79]
 ds_read_b128 v[32:35], v16 offset:16384
 s_add_u32 m0, s56, 16384
 s_add_u32 s3, s55, s66
 buffer_load_dwordx4 v1, s[4:7], s3 offen sc1 lds
 s_waitcnt lgkmcnt(3)
 v_mfma_f32_32x32x16_bf16 v[64:79], v[52:55], a[52:55], v[64:79]
 ds_read_b128 v[36:39], v17 offset:16384
 s_waitcnt lgkmcnt(3)
 v_mfma_f32_32x32x16_bf16 v[64:79], v[56:59], a[56:59], v[64:79]
 ds_read_b128 v[40:43], v18 offset:16384
 s_waitcnt lgkmcnt(3)
 v_mfma_f32_32x32x16_bf16 v[64:79], v[60:63], a[60:63], v[64:79]
 ds_read_b128 v[44:47], v19 offset:16384
 s_add_u32 m0, s56, 17408
 s_add_u32 s3, s55, s66
 buffer_load_dwordx4 v24, s[4:7], s3 offen sc1 lds
 s_waitcnt lgkmcnt(3)
 v_mfma_f32_32x32x16_bf16 v[64:79], v[32:35], a[64:67], v[64:79]
 ds_read_b128 v[48:51], v20 offset:16384
 s_waitcnt lgkmcnt(3)
 v_mfma_f32_32x32x16_bf16 v[64:79], v[36:39], a[68:71], v[64:79]
 ds_read_b128 v[52:55], v21 offset:16384
 s_waitcnt lgkmcnt(3)
 v_mfma_f32_32x32x16_bf16 v[64:79], v[40:43], a[72:75], v[64:79]
 ds_read_b128 v[56:59], v22 offset:16384
 s_add_u32 m0, s56, 24576
 s_add_u32 s3, s55, s67
 buffer_load_dwordx4 v1, s[4:7], s3 offen sc1 lds
 s_waitcnt lgkmcnt(3)
 v_mfma_f32_32x32x16_bf16 v[64:79], v[44:47], a[76:79], v[64:79]
 ds_read_b128 v[60:63], v23 offset:16384
 s_waitcnt lgkmcnt(3)
 v_mfma_f32_32x32x16_bf16 v[64:79], v[48:51], a[80:83], v[64:79]
 ds_read_b128 v[32:35], v16 offset:24576
 s_waitcnt lgkmcnt(3)
 v_mfma_f32_32x32x16_bf16 v[64:79], v[52:55], a[84:87], v[64:79]
 ds_read_b128 v[36:39], v17 offset:24576
 s_add_u32 m0, s56, 25600
 s_add_u32 s3, s55, s67
 buffer_load_dwordx4 v24, s[4:7], s3 offen sc1 lds
 s_waitcnt lgkmcnt(3)
 v_mfma_f32_32x32x16_bf16 v[64:79], v[56:59], a[88:91], v[64:79]
 ds_read_b128 v[40:43], v18 offset:24576
 s_waitcnt lgkmcnt(3)
 v_mfma_f32_32x32x16_bf16 v[64:79], v[60:63], a[92:95], v[64:79]
 ds_read_b128 v[44:47], v19 offset:24576
 s_waitcnt lgkmcnt(3)
 v_mfma_f32_32x32x16_bf16 v[64:79], v[32:35], a[96:99], v[64:79]
 ds_read_b128 v[48:51], v20 offset:24576
 s_add_u32 m0, s56, 32768
 s_add_u32 s3, s55, s68
 buffer_load_dwordx4 v1, s[4:7], s3 offen sc1 lds
 s_waitcnt lgkmcnt(3)
 v_mfma_f32_32x32x16_bf16 v[64:79], v[36:39], a[100:103], v[64:79]
 ds_read_b128 v[52:55], v21 offset:24576
 s_waitcnt lgkmcnt(3)
 v_mfma_f32_32x32x16_bf16 v[64:79], v[40:43], a[104:107], v[64:79]
 ds_read_b128 v[56:59], v22 offset:24576
 s_waitcnt lgkmcnt(3)
 v_mfma_f32_32x32x16_bf16 v[64:79], v[44:47], a[108:111], v[64:79]
 ds_read_b128 v[60:63], v23 offset:24576
 s_add_u32 m0, s56, 33792
 s_add_u32 s3, s55, s68
 buffer_load_dwordx4 v24, s[4:7], s3 offen sc1 lds
 s_waitcnt lgkmcnt(3)
 v_mfma_f32_32x32x16_bf16 v[64:79], v[48:51], a[112:115], v[64:79]
 ds_read_b128 v[32:35], v16 offset:32768
 s_waitcnt lgkmcnt(3)
 v_mfma_f32_32x32x16_bf16 v[64:79], v[52:55], a[116:119], v[64:79]
 ds_read_b128 v[36:39], v17 offset:32768
 v_mov_b32 v6, 8
 s_mov_b64 exec, 15
 v_mov_b32 v6, 0
 buffer_atomic_add v6, v5, s[4:7], s70 offen sc0
 s_mov_b64 exec, -1
 s_waitcnt lgkmcnt(3)
 v_mfma_f32_32x32x16_bf16 v[64:79], v[56:59], a[120:123], v[64:79]
 ds_read_b128 v[40:43], v18 offset:32768
 s_waitcnt lgkmcnt(3)
 v_mfma_f32_32x32x16_bf16 v[64:79], v[60:63], a[124:127], v[64:79]
 ds_read_b128 v[44:47], v19 offset:32768
 s_waitcnt lgkmcnt(3)
 v_mfma_f32_32x32x16_bf16 v[64:79], v[32:35], a[128:131], v[64:79]
 ds_read_b128 v[48:51], v20 offset:32768
 s_waitcnt lgkmcnt(3)
 v_mfma_f32_32x32x16_bf16 v[64:79], v[36:39], a[132:135], v[64:79]
 ds_read_b128 v[52:55], v21 offset:32768
 s_waitcnt lgkmcnt(3)
 v_mfma_f32_32x32x16_bf16 v[64:79], v[40:43], a[136:139], v[64:79]
 ds_read_b128 v[56:59], v22 offset:32768
 s_waitcnt lgkmcnt(3)
 v_mfma_f32_32x32x16_bf16 v[64:79], v[44:47], a[140:143], v[64:79]
 ds_read_b128 v[60:63], v23 offset:32768
 s_waitcnt lgkmcnt(3)
 v_mfma_f32_32x32x16_bf16 v[64:79], v[48:51], a[144:147], v[64:79]
 s_waitcnt lgkmcnt(2)
 v_mfma_f32_32x32x16_bf16 v[64:79], v[52:55], a[148:151], v[64:79]
 s_waitcnt lgkmcnt(1)
 v_mfma_f32_32x32x16_bf16 v[64:79], v[56:59], a[152:155], v[64:79]
 s_waitcnt lgkmcnt(0)
 v_mfma_f32_32x32x16_bf16 v[64:79], v[60:63], a[156:159], v[64:79]
 s_lshl_b32 s3, s60, 19
 s_add_u32 s3, s3, s58
 s_xor_b32 s3, s3, s82
 s_add_u32 s3, s3, 33554432
 s_nop 8
 v_cvt_pk_bf16_f32 v88, v64, v65
 v_cvt_pk_bf16_f32 v89, v66, v67
 v_cvt_pk_bf16_f32 v90, v72, v73
 v_cvt_pk_bf16_f32 v91, v74, v75
 buffer_store_dwordx4 v[88:91], v4, s[4:7], s3 offen offset:0 sc1
 v_cvt_pk_bf16_f32 v92, v68, v69
 v_cvt_pk_bf16_f32 v93, v70, v71
 v_cvt_pk_bf16_f32 v94, v76, v77
 v_cvt_pk_bf16_f32 v95, v78, v79
 buffer_store_dwordx4 v[92:95], v4, s[4:7], s3 offen offset:512 sc1
 s_branch L_qkvv_mid
L_qkvv_loop:
 s_cmp_lg_u32 s54, 32
 s_cbranch_scc1 L_c2_101
 s_cmp_lg_u32 s50, 0
 s_cbranch_scc1 L_ww_102
 s_mov_b32 s96, s44
 s_and_b32 s97, s45, 0xffff
 s_mov_b32 s98, 256
 s_mov_b32 s99, 0x00020000
 v_mov_b32 v25, 140
 s_mov_b32 s51, 0
 s_mov_b64 exec, 1
L_wb_103:
 buffer_load_dword v26, v25, s[96:99], 0 offen sc1
 s_waitcnt vmcnt(0)
 v_cmp_eq_u32 vcc, 0, v26
 s_cbranch_vccz L_wbd_104
 s_sleep 2
 s_add_u32 s51, s51, 1
 s_cmp_lt_u32 s51, 131072
 s_cbranch_scc1 L_wb_103
 s_branch L_bail
L_wbd_104:
 s_mov_b64 exec, -1
L_ww_102:
 s_barrier
L_c2_101:
 s_sub_u32 s60, s54, 16
 s_mul_i32 s55, s60, 40960
 s_mul_i32 s3, s50, 10240
 s_add_u32 s55, s55, s3
 s_add_u32 s55, s55, 229113856
 s_add_u32 m0, s56, 40960
 s_add_u32 s3, s55, s64
 buffer_load_dwordx4 v1, s[4:7], s3 offen sc1 lds
 s_add_u32 m0, s56, 41984
 s_add_u32 s3, s55, s64
 buffer_load_dwordx4 v24, s[4:7], s3 offen sc1 lds
 s_add_u32 m0, s56, 49152
 s_add_u32 s3, s55, s65
 buffer_load_dwordx4 v1, s[4:7], s3 offen sc1 lds
 s_add_u32 m0, s56, 50176
 s_add_u32 s3, s55, s65
 buffer_load_dwordx4 v24, s[4:7], s3 offen sc1 lds
 s_add_u32 m0, s56, 57344
 s_add_u32 s3, s55, s66
 buffer_load_dwordx4 v1, s[4:7], s3 offen sc1 lds
 s_add_u32 m0, s56, 58368
 s_add_u32 s3, s55, s66
 buffer_load_dwordx4 v24, s[4:7], s3 offen sc1 lds
 s_add_u32 m0, s56, 65536
 s_add_u32 s3, s55, s67
 buffer_load_dwordx4 v1, s[4:7], s3 offen sc1 lds
 s_add_u32 m0, s56, 66560
 s_add_u32 s3, s55, s67
 buffer_load_dwordx4 v24, s[4:7], s3 offen sc1 lds
 s_add_u32 m0, s56, 73728
 s_add_u32 s3, s55, s68
 buffer_load_dwordx4 v1, s[4:7], s3 offen sc1 lds
 s_add_u32 m0, s56, 74752
 s_add_u32 s3, s55, s68
 buffer_load_dwordx4 v24, s[4:7], s3 offen sc1 lds
 s_lshl_b32 s70, s54, 2
 s_add_u32 s70, s70, s62
 s_sub_u32 s70, s70, 60
 s_cmp_lg_u32 s50, 0
 s_cselect_b32 s70, 268435456, s70
 s_min_u32 s51, s54, 63
 s_mul_i32 s55, s51, 40960
 s_mul_i32 s3, s50, 10240
 s_add_u32 s55, s55, s3
 s_add_u32 s55, s55, 226492416
 s_waitcnt vmcnt(8)
 s_barrier
 ds_read_b128 v[32:35], v16 offset:0
 ds_read_b128 v[36:39], v17 offset:0
 ds_read_b128 v[40:43], v18 offset:0
 ds_read_b128 v[44:47], v19 offset:0
 s_waitcnt lgkmcnt(3)
 v_mfma_f32_32x32x16_bf16 v[64:79], v[32:35], a[0:3], 0
 ds_read_b128 v[48:51], v20 offset:0
 s_add_u32 m0, s56, 0
 s_add_u32 s3, s55, s64
 buffer_load_dwordx4 v1, s[4:7], s3 offen sc1 lds
 s_waitcnt lgkmcnt(3)
 v_mfma_f32_32x32x16_bf16 v[64:79], v[36:39], a[4:7], v[64:79]
 ds_read_b128 v[52:55], v21 offset:0
 s_waitcnt lgkmcnt(3)
 v_mfma_f32_32x32x16_bf16 v[64:79], v[40:43], a[8:11], v[64:79]
 ds_read_b128 v[56:59], v22 offset:0
 s_waitcnt lgkmcnt(3)
 v_mfma_f32_32x32x16_bf16 v[64:79], v[44:47], a[12:15], v[64:79]
 ds_read_b128 v[60:63], v23 offset:0
 s_add_u32 m0, s56, 1024
 s_add_u32 s3, s55, s64
 buffer_load_dwordx4 v24, s[4:7], s3 offen sc1 lds
 s_waitcnt lgkmcnt(3)
 v_mfma_f32_32x32x16_bf16 v[64:79], v[48:51], a[16:19], v[64:79]
 s_waitcnt vmcnt(8)
 s_barrier
 ds_read_b128 v[32:35], v16 offset:8192
 s_waitcnt lgkmcnt(3)
 v_mfma_f32_32x32x16_bf16 v[64:79], v[52:55], a[20:23], v[64:79]
 ds_read_b128 v[36:39], v17 offset:8192
 s_waitcnt lgkmcnt(3)
 v_mfma_f32_32x32x16_bf16 v[64:79], v[56:59], a[24:27], v[64:79]
 ds_read_b128 v[40:43], v18 offset:8192
 s_add_u32 m0, s56, 8192
 s_add_u32 s3, s55, s65
 buffer_load_dwordx4 v1, s[4:7], s3 offen sc1 lds
 s_waitcnt lgkmcnt(3)
 v_mfma_f32_32x32x16_bf16 v[64:79], v[60:63], a[28:31], v[64:79]
 ds_read_b128 v[44:47], v19 offset:8192
 s_waitcnt lgkmcnt(3)
 v_mfma_f32_32x32x16_bf16 v[64:79], v[32:35], a[32:35], v[64:79]
 ds_read_b128 v[48:51], v20 offset:8192
 s_waitcnt lgkmcnt(3)
 v_mfma_f32_32x32x16_bf16 v[64:79], v[36:39], a[36:39], v[64:79]
 ds_read_b128 v[52:55], v21 offset:8192
 s_add_u32 m0, s56, 9216
 s_add_u32 s3, s55, s65
 buffer_load_dwordx4 v24, s[4:7], s3 offen sc1 lds
 s_waitcnt lgkmcnt(3)
 v_mfma_f32_32x32x16_bf16 v[64:79], v[40:43], a[40:43], v[64:79]
 ds_read_b128 v[56:59], v22 offset:8192
 s_waitcnt lgkmcnt(3)
 v_mfma_f32_32x32x16_bf16 v[64:79], v[44:47], a[44:47], v[64:79]
 ds_read_b128 v[60:63], v23 offset:8192
 s_waitcnt lgkmcnt(3)
 v_mfma_f32_32x32x16_bf16 v[64:79], v[48:51], a[48:51], v[64:79]
 s_waitcnt vmcnt(8)
 s_barrier
 ds_read_b128 v[32:35], v16 offset:16384
 s_add_u32 m0, s56, 16384
 s_add_u32 s3, s55, s66
 buffer_load_dwordx4 v1, s[4:7], s3 offen sc1 lds
 s_waitcnt lgkmcnt(3)
 v_mfma_f32_32x32x16_bf16 v[64:79], v[52:55], a[52:55], v[64:79]
 ds_read_b128 v[36:39], v17 offset:16384
 s_waitcnt lgkmcnt(3)
 v_mfma_f32_32x32x16_bf16 v[64:79], v[56:59], a[56:59], v[64:79]
 ds_read_b128 v[40:43], v18 offset:16384
 s_waitcnt lgkmcnt(3)
 v_mfma_f32_32x32x16_bf16 v[64:79], v[60:63], a[60:63], v[64:79]
 ds_read_b128 v[44:47], v19 offset:16384
 s_add_u32 m0, s56, 17408
 s_add_u32 s3, s55, s66
 buffer_load_dwordx4 v24, s[4:7], s3 offen sc1 lds
 s_waitcnt lgkmcnt(3)
 v_mfma_f32_32x32x16_bf16 v[64:79], v[32:35], a[64:67], v[64:79]
 ds_read_b128 v[48:51], v20 offset:16384
 s_waitcnt lgkmcnt(3)
 v_mfma_f32_32x32x16_bf16 v[64:79], v[36:39], a[68:71], v[64:79]
 ds_read_b128 v[52:55], v21 offset:16384
 s_waitcnt lgkmcnt(3)
 v_mfma_f32_32x32x16_bf16 v[64:79], v[40:43], a[72:75], v[64:79]
 ds_read_b128 v[56:59], v22 offset:16384
 s_add_u32 m0, s56, 24576
 s_add_u32 s3, s55, s67
 buffer_load_dwordx4 v1, s[4:7], s3 offen sc1 lds
 s_waitcnt lgkmcnt(3)
 v_mfma_f32_32x32x16_bf16 v[64:79], v[44:47], a[76:79], v[64:79]
 ds_read_b128 v[60:63], v23 offset:16384
 s_waitcnt lgkmcnt(3)
 v_mfma_f32_32x32x16_bf16 v[64:79], v[48:51], a[80:83], v[64:79]
 s_waitcnt vmcnt(9)
 s_barrier
 ds_read_b128 v[32:35], v16 offset:24576
 s_waitcnt lgkmcnt(3)
 v_mfma_f32_32x32x16_bf16 v[64:79], v[52:55], a[84:87], v[64:79]
 ds_read_b128 v[36:39], v17 offset:24576
 s_add_u32 m0, s56, 25600
 s_add_u32 s3, s55, s67
 buffer_load_dwordx4 v24, s[4:7], s3 offen sc1 lds
 s_waitcnt lgkmcnt(3)
 v_mfma_f32_32x32x16_bf16 v[64:79], v[56:59], a[88:91], v[64:79]
 ds_read_b128 v[40:43], v18 offset:24576
 s_waitcnt lgkmcnt(3)
 v_mfma_f32_32x32x16_bf16 v[64:79], v[60:63], a[92:95], v[64:79]
 ds_read_b128 v[44:47], v19 offset:24576
 s_waitcnt lgkmcnt(3)
 v_mfma_f32_32x32x16_bf16 v[64:79], v[32:35], a[96:99], v[64:79]
 ds_read_b128 v[48:51], v20 offset:24576
 s_add_u32 m0, s56, 32768
 s_add_u32 s3, s55, s68
 buffer_load_dwordx4 v1, s[4:7], s3 offen sc1 lds
 s_waitcnt lgkmcnt(3)
 v_mfma_f32_32x32x16_bf16 v[64:79], v[36:39], a[100:103], v[64:79]
 ds_read_b128 v[52:55], v21 offset:24576
 s_waitcnt lgkmcnt(3)
 v_mfma_f32_32x32x16_bf16 v[64:79], v[40:43], a[104:107], v[64:79]
 ds_read_b128 v[56:59], v22 offset:24576
 s_waitcnt lgkmcnt(3)
 v_mfma_f32_32x32x16_bf16 v[64:79], v[44:47], a[108:111], v[64:79]
 ds_read_b128 v[60:63], v23 offset:24576
 s_add_u32 m0, s56, 33792
 s_add_u32 s3, s55, s68
 buffer_load_dwordx4 v24, s[4:7], s3 offen sc1 lds
 s_waitcnt lgkmcnt(3)
 v_mfma_f32_32x32x16_bf16 v[64:79], v[48:51], a[112:115], v[64:79]
 s_waitcnt vmcnt(10)
 s_barrier
 ds_read_b128 v[32:35], v16 offset:32768
 s_waitcnt lgkmcnt(3)
 v_mfma_f32_32x32x16_bf16 v[64:79], v[52:55], a[116:119], v[64:79]
 ds_read_b128 v[36:39], v17 offset:32768
 v_mov_b32 v6, 8
 s_mov_b64 exec, 15
 v_mov_b32 v6, 0
 buffer_atomic_add v6, v5, s[4:7], s70 offen sc0
 s_mov_b64 exec, -1
 s_waitcnt lgkmcnt(3)
 v_mfma_f32_32x32x16_bf16 v[64:79], v[56:59], a[120:123], v[64:79]
 ds_read_b128 v[40:43], v18 offset:32768
 s_waitcnt lgkmcnt(3)
 v_mfma_f32_32x32x16_bf16 v[64:79], v[60:63], a[124:127], v[64:79]
 ds_read_b128 v[44:47], v19 offset:32768
 s_waitcnt lgkmcnt(3)
 v_mfma_f32_32x32x16_bf16 v[64:79], v[32:35], a[128:131], v[64:79]
 ds_read_b128 v[48:51], v20 offset:32768
 s_waitcnt lgkmcnt(3)
 v_mfma_f32_32x32x16_bf16 v[64:79], v[36:39], a[132:135], v[64:79]
 ds_read_b128 v[52:55], v21 offset:32768
 s_waitcnt lgkmcnt(3)
 v_mfma_f32_32x32x16_bf16 v[64:79], v[40:43], a[136:139], v[64:79]
 ds_read_b128 v[56:59], v22 offset:32768
 s_waitcnt lgkmcnt(3)
 v_mfma_f32_32x32x16_bf16 v[64:79], v[44:47], a[140:143], v[64:79]
 ds_read_b128 v[60:63], v23 offset:32768
 s_waitcnt lgkmcnt(3)
 v_mfma_f32_32x32x16_bf16 v[64:79], v[48:51], a[144:147], v[64:79]
 s_waitcnt lgkmcnt(2)
 v_mfma_f32_32x32x16_bf16 v[64:79], v[52:55], a[148:151], v[64:79]
 s_waitcnt lgkmcnt(1)
 v_mfma_f32_32x32x16_bf16 v[64:79], v[56:59], a[152:155], v[64:79]
 s_waitcnt lgkmcnt(0)
 v_mfma_f32_32x32x16_bf16 v[64:79], v[60:63], a[156:159], v[64:79]
 s_lshl_b32 s3, s60, 19
 s_add_u32 s3, s3, s58
 s_xor_b32 s3, s3, s82
 s_add_u32 s3, s3, 33554432
 s_nop 8
 v_cvt_pk_bf16_f32 v88, v64, v65
 v_cvt_pk_bf16_f32 v89, v66, v67
 v_cvt_pk_bf16_f32 v90, v72, v73
 v_cvt_pk_bf16_f32 v91, v74, v75
 buffer_store_dwordx4 v[88:91], v4, s[4:7], s3 offen offset:0 sc1
 v_cvt_pk_bf16_f32 v92, v68, v69
 v_cvt_pk_bf16_f32 v93, v70, v71
 v_cvt_pk_bf16_f32 v94, v76, v77
 v_cvt_pk_bf16_f32 v95, v78, v79
 buffer_store_dwordx4 v[92:95], v4, s[4:7], s3 offen offset:512 sc1
L_qkvv_mid:
 s_cmp_ge_u32 s54, 64
 s_cbranch_scc1 L_n0_96
 s_waitcnt vmcnt(2)
 s_cmp_lg_u32 s50, 0
 s_cbranch_scc1 L_w_105
 v_cmp_gt_u32 vcc, 8, v6
 s_nop 1
 v_mov_b32 v3, vcc_lo
 ds_write_b32 v7, v3
 s_waitcnt lgkmcnt(0)
L_w_105:
 s_barrier
 ds_read_b32 v3, v7
 s_waitcnt lgkmcnt(0)
 v_readfirstlane_b32 s3, v3
 s_mov_b32 s69, s3
 s_add_u32 s51, s60, 1
 s_mov_b32 s60, s54
 s_mul_i32 s55, s51, 40960
 s_mul_i32 s3, s50, 10240
 s_add_u32 s55, s55, s3
 s_add_u32 s55, s55, 229113856
 s_cmp_eq_u32 s69, 0
 s_cselect_b32 s55, s55, 268435456
 ds_read_b128 v[32:35], v8 offset:0
 ds_read_b128 v[36:39], v9 offset:0
 ds_read_b128 v[40:43], v10 offset:0
 ds_read_b128 v[44:47], v11 offset:0
 s_waitcnt lgkmcnt(3)
 v_mfma_f32_32x32x16_bf16 v[64:79], v[32:35], a[0:3], 0
 ds_read_b128 v[48:51], v12 offset:0
 s_add_u32 m0, s56, 40960
 s_add_u32 s3, s55, s64
 buffer_load_dwordx4 v1, s[4:7], s3 offen sc1 lds
 s_waitcnt lgkmcnt(3)
 v_mfma_f32_32x32x16_bf16 v[64:79], v[36:39], a[4:7], v[64:79]
 ds_read_b128 v[52:55], v13 offset:0
 s_waitcnt lgkmcnt(3)
 v_mfma_f32_32x32x16_bf16 v[64:79], v[40:43], a[8:11], v[64:79]
 ds_read_b128 v[56:59], v14 offset:0
 s_waitcnt lgkmcnt(3)
 v_mfma_f32_32x32x16_bf16 v[64:79], v[44:47], a[12:15], v[64:79]
 ds_read_b128 v[60:63], v15 offset:0
 s_add_u32 m0, s56, 41984
 s_add_u32 s3, s55, s64
 buffer_load_dwordx4 v24, s[4:7], s3 offen sc1 lds
 s_waitcnt lgkmcnt(3)
 v_mfma_f32_32x32x16_bf16 v[64:79], v[48:51], a[16:19], v[64:79]
 ds_read_b128 v[32:35], v8 offset:8192
 s_waitcnt lgkmcnt(3)
 v_mfma_f32_32x32x16_bf16 v[64:79], v[52:55], a[20:23], v[64:79]
 ds_read_b128 v[36:39], v9 offset:8192
 s_waitcnt lgkmcnt(3)
 v_mfma_f32_32x32x16_bf16 v[64:79], v[56:59], a[24:27], v[64:79]
 ds_read_b128 v[40:43], v10 offset:8192
 s_add_u32 m0, s56, 49152
 s_add_u32 s3, s55, s65
 buffer_load_dwordx4 v1, s[4:7], s3 offen sc1 lds
 s_waitcnt lgkmcnt(3)
 v_mfma_f32_32x32x16_bf16 v[64:79], v[60:63], a[28:31], v[64:79]
 ds_read_b128 v[44:47], v11 offset:8192
 s_waitcnt lgkmcnt(3)
 v_mfma_f32_32x32x16_bf16 v[64:79], v[32:35], a[32:35], v[64:79]
 ds_read_b128 v[48:51], v12 offset:8192
 s_waitcnt lgkmcnt(3)
 v_mfma_f32_32x32x16_bf16 v[64:79], v[36:39], a[36:39], v[64:79]
 ds_read_b128 v[52:55], v13 offset:8192
 s_add_u32 m0, s56, 50176
 s_add_u32 s3, s55, s65
 buffer_load_dwordx4 v24, s[4:7], s3 offen sc1 lds
 s_waitcnt lgkmcnt(3)
 v_mfma_f32_32x32x16_bf16 v[64:79], v[40:43], a[40:43], v[64:79]
 ds_read_b128 v[56:59], v14 offset:8192
 s_waitcnt lgkmcnt(3)
 v_mfma_f32_32x32x16_bf16 v[64:79], v[44:47], a[44:47], v[64:79]
 ds_read_b128 v[60:63], v15 offset:8192
 s_waitcnt lgkmcnt(3)
 v_mfma_f32_32x32x16_bf16 v[64:79], v[48:51], a[48:51], v[64:79]
 ds_read_b128 v[32:35], v8 offset:16384
 s_add_u32 m0, s56, 57344
 s_add_u32 s3, s55, s66
 buffer_load_dwordx4 v1, s[4:7], s3 offen sc1 lds
 s_waitcnt lgkmcnt(3)
 v_mfma_f32_32x32x16_bf16 v[64:79], v[52:55], a[52:55], v[64:79]
 ds_read_b128 v[36:39], v9 offset:16384
 s_waitcnt lgkmcnt(3)
 v_mfma_f32_32x32x16_bf16 v[64:79], v[56:59], a[56:59], v[64:79]
 ds_read_b128 v[40:43], v10 offset:16384
 s_waitcnt lgkmcnt(3)
 v_mfma_f32_32x32x16_bf16 v[64:79], v[60:63], a[60:63], v[64:79]
 ds_read_b128 v[44:47], v11 offset:16384
 s_add_u32 m0, s56, 58368
 s_add_u32 s3, s55, s66
 buffer_load_dwordx4 v24, s[4:7], s3 offen sc1 lds
 s_waitcnt lgkmcnt(3)
 v_mfma_f32_32x32x16_bf16 v[64:79], v[32:35], a[64:67], v[64:79]
 ds_read_b128 v[48:51], v12 offset:16384
 s_waitcnt lgkmcnt(3)
 v_mfma_f32_32x32x16_bf16 v[64:79], v[36:39], a[68:71], v[64:79]
 ds_read_b128 v[52:55], v13 offset:16384
 s_waitcnt vmcnt(6)
 s_lshl_b32 s3, s54, 2
 s_add_u32 s3, s3, s63
 v_mov_b32 v3, 1
 s_mov_b64 exec, s[78:79]
 buffer_atomic_add v3, v30, s[4:7], s3 offen
 s_mov_b64 exec, -1
 s_cmp_eq_u32 s61, 0
 s_cbranch_scc1 L_pf_106
 s_lshl_b32 s3, s61, 2
 s_add_u32 s3, s3, s59
 s_sub_u32 s3, s3, 4
 v_mov_b32 v3, 1
 s_mov_b64 exec, s[78:79]
 buffer_atomic_add v3, v30, s[4:7], s3 offen
 s_mov_b64 exec, -1
 s_mov_b32 s61, 0
L_pf_106:
 s_waitcnt lgkmcnt(3)
 v_mfma_f32_32x32x16_bf16 v[64:79], v[40:43], a[72:75], v[64:79]
 ds_read_b128 v[56:59], v14 offset:16384
 s_add_u32 m0, s56, 65536
 s_add_u32 s3, s55, s67
 buffer_load_dwordx4 v1, s[4:7], s3 offen sc1 lds
 s_waitcnt lgkmcnt(3)
 v_mfma_f32_32x32x16_bf16 v[64:79], v[44:47], a[76:79], v[64:79]
 ds_read_b128 v[60:63], v15 offset:16384
 s_waitcnt lgkmcnt(3)
 v_mfma_f32_32x32x16_bf16 v[64:79], v[48:51], a[80:83], v[64:79]
 ds_read_b128 v[32:35], v8 offset:24576
 s_waitcnt lgkmcnt(3)
 v_mfma_f32_32x32x16_bf16 v[64:79], v[52:55], a[84:87], v[64:79]
 ds_read_b128 v[36:39], v9 offset:24576
 s_add_u32 m0, s56, 66560
 s_add_u32 s3, s55, s67
 buffer_load_dwordx4 v24, s[4:7], s3 offen sc1 lds
 s_waitcnt lgkmcnt(3)
 v_mfma_f32_32x32x16_bf16 v[64:79], v[56:59], a[88:91], v[64:79]
 ds_read_b128 v[40:43], v10 offset:24576
 s_waitcnt lgkmcnt(3)
 v_mfma_f32_32x32x16_bf16 v[64:79], v[60:63], a[92:95], v[64:79]
 ds_read_b128 v[44:47], v11 offset:24576
 s_waitcnt lgkmcnt(3)
 v_mfma_f32_32x32x16_bf16 v[64:79], v[32:35], a[96:99], v[64:79]
 ds_read_b128 v[48:51], v12 offset:24576
 s_add_u32 m0, s56, 73728
 s_add_u32 s3, s55, s68
 buffer_load_dwordx4 v1, s[4:7], s3 offen sc1 lds
 s_waitcnt lgkmcnt(3)
 v_mfma_f32_32x32x16_bf16 v[64:79], v[36:39], a[100:103], v[64:79]
 ds_read_b128 v[52:55], v13 offset:24576
 s_waitcnt lgkmcnt(3)
 v_mfma_f32_32x32x16_bf16 v[64:79], v[40:43], a[104:107], v[64:79]
 ds_read_b128 v[56:59], v14 offset:24576
 s_waitcnt lgkmcnt(3)
 v_mfma_f32_32x32x16_bf16 v[64:79], v[44:47], a[108:111], v[64:79]
 ds_read_b128 v[60:63], v15 offset:24576
 s_add_u32 m0, s56, 74752
 s_add_u32 s3, s55, s68
 buffer_load_dwordx4 v24, s[4:7], s3 offen sc1 lds
 v_mov_b32 v6, 8
 s_mov_b64 exec, 15
 v_mov_b32 v6, 0
 buffer_atomic_add v6, v5, s[4:7], s70 offen sc0
 s_mov_b64 exec, -1
 s_waitcnt lgkmcnt(3)
 v_mfma_f32_32x32x16_bf16 v[64:79], v[48:51], a[112:115], v[64:79]
 ds_read_b128 v[32:35], v8 offset:32768
 s_waitcnt lgkmcnt(3)
 v_mfma_f32_32x32x16_bf16 v[64:79], v[52:55], a[116:119], v[64:79]
 ds_read_b128 v[36:39], v9 offset:32768
 s_waitcnt lgkmcnt(3)
 v_mfma_f32_32x32x16_bf16 v[64:79], v[56:59], a[120:123], v[64:79]
 ds_read_b128 v[40:43], v10 offset:32768
 s_waitcnt lgkmcnt(3)
 v_mfma_f32_32x32x16_bf16 v[64:79], v[60:63], a[124:127], v[64:79]
 ds_read_b128 v[44:47], v11 offset:32768
 s_waitcnt lgkmcnt(3)
 v_mfma_f32_32x32x16_bf16 v[64:79], v[32:35], a[128:131], v[64:79]
 ds_read_b128 v[48:51], v12 offset:32768
 s_waitcnt lgkmcnt(3)
 v_mfma_f32_32x32x16_bf16 v[64:79], v[36:39], a[132:135], v[64:79]
 ds_read_b128 v[52:55], v13 offset:32768
 s_waitcnt lgkmcnt(3)
 v_mfma_f32_32x32x16_bf16 v[64:79], v[40:43], a[136:139], v[64:79]
 ds_read_b128 v[56:59], v14 offset:32768
 s_waitcnt lgkmcnt(3)
 v_mfma_f32_32x32x16_bf16 v[64:79], v[44:47], a[140:143], v[64:79]
 ds_read_b128 v[60:63], v15 offset:32768
 s_waitcnt lgkmcnt(3)
 v_mfma_f32_32x32x16_bf16 v[64:79], v[48:51], a[144:147], v[64:79]
 s_waitcnt lgkmcnt(2)
 v_mfma_f32_32x32x16_bf16 v[64:79], v[52:55], a[148:151], v[64:79]
 s_waitcnt lgkmcnt(1)
 v_mfma_f32_32x32x16_bf16 v[64:79], v[56:59], a[152:155], v[64:79]
 s_waitcnt lgkmcnt(0)
 v_mfma_f32_32x32x16_bf16 v[64:79], v[60:63], a[156:159], v[64:79]
 s_lshl_b32 s3, s60, 19
 s_add_u32 s3, s3, s58
 s_xor_b32 s3, s3, s82
 s_nop 8
 v_cvt_pk_bf16_f32 v80, v64, v65
 v_cvt_pk_bf16_f32 v81, v66, v67
 v_cvt_pk_bf16_f32 v82, v72, v73
 v_cvt_pk_bf16_f32 v83, v74, v75
 buffer_store_dwordx4 v[80:83], v4, s[4:7], s3 offen offset:0 sc1
 v_cvt_pk_bf16_f32 v84, v68, v69
 v_cvt_pk_bf16_f32 v85, v70, v71
 v_cvt_pk_bf16_f32 v86, v76, v77
 v_cvt_pk_bf16_f32 v87, v78, v79
 buffer_store_dwordx4 v[84:87], v4, s[4:7], s3 offen offset:512 sc1
 s_add_u32 s54, s54, 1
 s_mov_b32 s61, s54
 s_waitcnt vmcnt(2)
 s_cmp_lg_u32 s50, 0
 s_cbranch_scc1 L_w_107
 v_cmp_gt_u32 vcc, 8, v6
 s_nop 1
 v_mov_b32 v3, vcc_lo
 ds_write_b32 v7, v3
 s_waitcnt lgkmcnt(0)
L_w_107:
 s_barrier
 ds_read_b32 v3, v7
 s_waitcnt lgkmcnt(0)
 v_readfirstlane_b32 s3, v3
 s_cmp_eq_u32 s69, 0
 s_cbranch_scc1 L_qkvv_fast
 s_cmp_eq_u32 s3, 0
 s_cbranch_scc1 L_qkvv_loop
 s_branch L_qkvv_block
L_n0_96:
 s_waitcnt vmcnt(0)
 s_lshl_b32 s3, s54, 2
 s_add_u32 s3, s3, s63
 v_mov_b32 v3, 1
 s_mov_b64 exec, s[78:79]
 buffer_atomic_add v3, v30, s[4:7], s3 offen
 s_mov_b64 exec, -1
 s_add_u32 s54, s54, 1
 s_cmp_lt_u32 s54, 80
 s_cbranch_scc1 L_qkvv_block
 s_endpgm
L_att:
 s_mul_i32 s3, s50, 24
 s_add_u32 s3, s3, s82
 s_sub_u32 s3, s3, 72
 s_cmp_lt_u32 s3, 64
 s_cbranch_scc1 L_att_go
 s_mov_b32 s60, s3
 s_mul_i32 s71, s50, 13312
 s_mov_b32 s70, s60
 s_mov_b32 s69, 96
 s_mov_b32 s96, s44
 s_and_b32 s97, s45, 0xffff
 s_mov_b32 s98, 256
 s_mov_b32 s99, 0x00020000
 v_mov_b32 v1, 196
 s_mov_b32 s51, 0
 s_mov_b64 exec, 1
L_wb_108:
 buffer_load_dword v2, v1, s[96:99], 0 offen sc1
 s_waitcnt vmcnt(0)
 v_cmp_eq_u32 vcc, 0, v2
 s_cbranch_vccz L_wbd_109
 s_sleep 2
 s_add_u32 s51, s51, 1
 s_cmp_lt_u32 s51, 131072
 s_cbranch_scc1 L_wb_108
 s_branch L_bail
L_wbd_109:
 s_mov_b64 exec, -1
 s_mov_b32 s96, s44
 s_and_b32 s97, s45, 0xffff
 s_mov_b32 s98, 256
 s_mov_b32 s99, 0x00020000
 v_mov_b32 v1, 208
 s_mov_b32 s51, 0
 s_mov_b64 exec, 1
L_wb_110:
 buffer_load_dword v2, v1, s[96:99], 0 offen sc1
 s_waitcnt vmcnt(0)
 v_cmp_eq_u32 vcc, 0, v2
 s_cbranch_vccz L_wbd_111
 s_sleep 2
 s_add_u32 s51, s51, 1
 s_cmp_lt_u32 s51, 131072
 s_cbranch_scc1 L_wb_110
 s_branch L_bail
L_wbd_111:
 s_mov_b64 exec, -1
 s_mov_b32 s8, s38
 s_and_b32 s9, s39, 0xffff
 s_mov_b32 s10, 2621440
 s_mov_b32 s11, 0x00020000
 s_mov_b32 s12, s40
 s_and_b32 s13, s41, 0xffff
 s_mov_b32 s14, 1280
 s_mov_b32 s15, 0x00020000
 v_lshlrev_b32 v130, 4, v0
 s_lshl_b32 s73, s70, 12
 s_add_u32 s74, s73, 2
 buffer_load_dwordx4 v[96:99], v130, s[8:11], s73 offen offset:0
 buffer_load_dwordx4 v[100:103], v130, s[8:11], s73 offen offset:1024
 buffer_load_dwordx4 v[104:107], v130, s[8:11], s73 offen offset:2048
 buffer_load_dwordx4 v[108:111], v130, s[8:11], s73 offen offset:3072
 buffer_load_dwordx4 v[112:115], v130, s[8:11], s74 offen offset:0
 buffer_load_dwordx4 v[116:119], v130, s[8:11], s74 offen offset:1024
 buffer_load_dwordx4 v[120:123], v130, s[8:11], s74 offen offset:2048
 buffer_load_dwordx4 v[124:127], v130, s[8:11], s74 offen offset:3072
 s_lshl_b32 s3, s70, 1
 buffer_load_ushort v128, off, s[12:15], s3
 s_lshl_b32 s3, s70, 12
 s_add_u32 s3, s3, 231735296
 buffer_load_dwordx4 v[240:243], v130, s[4:7], s3 offen offset:0 sc1
 buffer_load_dwordx4 v[244:247], v130, s[4:7], s3 offen offset:1024 sc1
 buffer_load_dwordx4 v[248:251], v130, s[4:7], s3 offen offset:2048 sc1
 buffer_load_dwordx4 v[252:255], v130, s[4:7], s3 offen offset:3072 sc1
 s_getpc_b64 s[76:77]
L_ca_112:
 s_add_u32 s76, s76, L_conv1-L_ca_112
 s_addc_u32 s77, s77, -1
 s_swappc_b64 s[76:77], s[76:77]
 s_waitcnt vmcnt(0)
 s_mov_b32 s96, s44
 s_and_b32 s97, s45, 0xffff
 s_mov_b32 s98, 256
 s_mov_b32 s99, 0x00020000
 v_mov_b32 v1, 1
 s_mov_b64 exec, 1
 buffer_atomic_add v1, off, s[96:99], 0 offset:76 sc0
 s_waitcnt vmcnt(0)
 v_cmp_eq_u32 vcc, 95, v1
 s_cbranch_vccz L_aw_113
 buffer_store_dword v1, off, s[96:99], 0 offset:204 sc1
L_aw_113:
 s_mov_b64 exec, -1
 s_endpgm
L_att_go:
 s_and_b32 s53, s3, 1
 s_lshr_b32 s52, s3, 1
 v_lshlrev_b32 v1, 4, v0
 v_add_u32 v2, 4096, v1
 v_mov_b32 v5, 0
 v_lshlrev_b32 v30, 3, v0
 v_and_b32 v6, 0x1e0, v30
 v_and_b32 v3, 16, v1
 v_add_u32 v6, v6, v3
 s_lshl_b32 s3, s53, 5
 s_add_u32 s3, s3, s52
 s_lshl_b32 s61, s3, 8
 s_add_u32 s61, s61, 24576
 s_lshl_b32 s66, s3, 7
 s_add_u32 s66, s66, 0
 s_lshl_b32 s57, s53, 11
 s_add_u32 s57, s57, s52
 s_and_b32 s100, s57, 1
 s_lshl_b32 s100, s100, 13
 s_lshl_b32 s57, s57, 14
 s_add_u32 s57, s57, s100
 s_add_u32 s57, s57, 8388608
 s_mul_i32 s58, s53, 524288
 s_lshl_b32 s3, s52, 12
 s_add_u32 s58, s58, s3
 s_add_u32 s58, s58, 1114112
 s_add_u32 s59, s57, 67108864
 s_lshl_b32 s60, s53, 8
 s_add_u32 s60, s60, 40960
 s_lshr_b32 s3, s52, 2
 s_mul_i32 s3, s3, 2560
 v_lshl_add_u32 v31, v0, 9, s3
 v_mov_b32 v208, -1
 v_mov_b32 v209, -1
 v_mov_b32 v210, -1
 v_mov_b32 v211, -1
 v_lshrrev_b32 v3, 4, v0
 v_lshlrev_b32 v7, 9, v3
 v_and_b32 v4, 15, v0
 v_lshl_add_u32 v7, v4, 4, v7
 v_mov_b32 v88, 0xff61b1e6
 v_lshlrev_b32 v3, 2, v3
 v_add_u32 v89, 0, v3
 v_cmp_gt_u32 vcc, v89, v4
 s_nop 1
 v_cndmask_b32 v12, 0, v88, vcc
 v_add_u32 v89, 1, v3
 v_cmp_gt_u32 vcc, v89, v4
 s_nop 1
 v_cndmask_b32 v13, 0, v88, vcc
 v_add_u32 v89, 2, v3
 v_cmp_gt_u32 vcc, v89, v4
 s_nop 1
 v_cndmask_b32 v14, 0, v88, vcc
 v_add_u32 v89, 3, v3
 v_cmp_gt_u32 vcc, v89, v4
 s_nop 1
 v_cndmask_b32 v15, 0, v88, vcc
 v_mov_b32 v152, 0
 v_mov_b32 v153, 0
 v_mov_b32 v154, 0
 v_mov_b32 v155, 0
 v_mov_b32 v156, 0
 v_mov_b32 v157, 0
 v_mov_b32 v158, 0
 v_mov_b32 v159, 0
 v_mov_b32 v160, 0
 v_mov_b32 v161, 0
 v_mov_b32 v162, 0
 v_mov_b32 v163, 0
 v_mov_b32 v164, 0
 v_mov_b32 v165, 0
 v_mov_b32 v166, 0
 v_mov_b32 v167, 0
 v_mov_b32 v168, 0
 v_mov_b32 v169, 0
 v_mov_b32 v170, 0
 v_mov_b32 v171, 0
 v_mov_b32 v172, 0
 v_mov_b32 v173, 0
 v_mov_b32 v174, 0
 v_mov_b32 v175, 0
 s_mov_b32 s62, 0x3db504f3
 s_mov_b32 s63, 0x3fb8aa3b
 s_mov_b32 s54, 0
 s_mov_b32 s51, 0
 s_mov_b64 exec, 1
L_wc_114:
 v_mov_b32 v3, 0
 buffer_atomic_add v3, v5, s[4:7], s61 offen sc0
 s_waitcnt vmcnt(0)
 v_cmp_gt_u32 vcc, 12, v3
 s_cbranch_vccz L_wcd_115
 s_sleep 16
 s_add_u32 s51, s51, 1
 s_cmp_lt_u32 s51, 131072
 s_cbranch_scc1 L_wc_114
 s_branch L_bail
L_wcd_115:
 s_mov_b64 exec, -1
 s_lshl_b32 s56, s54, 19
 s_add_u32 s56, s56, s57
 s_cmp_lt_u32 s54, 64
 s_cselect_b32 s56, s56, 268435456
 s_xor_b32 s3, s56, 8192
 buffer_load_dwordx4 a[0:3], v1, s[4:7], s3 offen offset:0 sc1
 buffer_load_dwordx4 a[4:7], v1, s[4:7], s3 offen offset:1024 sc1
 buffer_load_dwordx4 a[8:11], v1, s[4:7], s3 offen offset:2048 sc1
 buffer_load_dwordx4 a[12:15], v1, s[4:7], s3 offen offset:3072 sc1
 buffer_load_dwordx4 a[16:19], v2, s[4:7], s3 offen offset:0 sc1
 buffer_load_dwordx4 a[20:23], v2, s[4:7], s3 offen offset:1024 sc1
 buffer_load_dwordx4 a[24:27], v2, s[4:7], s3 offen offset:2048 sc1
 buffer_load_dwordx4 a[28:31], v2, s[4:7], s3 offen offset:3072 sc1
 s_mov_b32 s3, s56
 buffer_load_dwordx4 a[32:35], v1, s[4:7], s3 offen offset:0 sc1
 buffer_load_dwordx4 a[36:39], v1, s[4:7], s3 offen offset:1024 sc1
 buffer_load_dwordx4 a[40:43], v1, s[4:7], s3 offen offset:2048 sc1
 buffer_load_dwordx4 a[44:47], v1, s[4:7], s3 offen offset:3072 sc1
 buffer_load_dwordx4 a[48:51], v2, s[4:7], s3 offen offset:0 sc1
 buffer_load_dwordx4 a[52:55], v2, s[4:7], s3 offen offset:1024 sc1
 buffer_load_dwordx4 a[56:59], v2, s[4:7], s3 offen offset:2048 sc1
 buffer_load_dwordx4 a[60:63], v2, s[4:7], s3 offen offset:3072 sc1
 s_add_u32 s3, s56, 67108864
 buffer_load_dwordx4 a[64:67], v1, s[4:7], s3 offen offset:0 sc1
 buffer_load_dwordx4 a[68:71], v1, s[4:7], s3 offen offset:1024 sc1
 buffer_load_dwordx4 a[72:75], v1, s[4:7], s3 offen offset:2048 sc1
 buffer_load_dwordx4 a[76:79], v1, s[4:7], s3 offen offset:3072 sc1
 buffer_load_dwordx4 a[80:83], v2, s[4:7], s3 offen offset:0 sc1
 buffer_load_dwordx4 a[84:87], v2, s[4:7], s3 offen offset:1024 sc1
 buffer_load_dwordx4 a[88:91], v2, s[4:7], s3 offen offset:2048 sc1
 buffer_load_dwordx4 a[92:95], v2, s[4:7], s3 offen offset:3072 sc1
L_att_loop:
 s_and_b32 s3, s54, 3
 s_lshl_b32 s65, s3, 17
 s_add_u32 s65, s65, s58
 v_mov_b32 v29, 0
 s_mov_b64 exec, 1
 buffer_atomic_add v29, off, s[4:7], s61 offset:4 sc0
 s_mov_b64 exec, -1
 buffer_load_dwordx4 v[32:35], v6, s[4:7], s65 offen offset:0 sc1
 buffer_load_dwordx4 v[36:39], v6, s[4:7], s65 offen offset:512 sc1
 buffer_load_dwordx4 v[40:43], v6, s[4:7], s65 offen offset:1024 sc1
 buffer_load_dwordx4 v[44:47], v6, s[4:7], s65 offen offset:1536 sc1
 buffer_load_dwordx2 v[48:49], v30, s[4:7], s65 offen offset:2048 sc1
 buffer_load_dwordx2 v[50:51], v30, s[4:7], s65 offen offset:2560 sc1
 buffer_load_dwordx2 v[52:53], v30, s[4:7], s65 offen offset:3072 sc1
 buffer_load_dwordx2 v[54:55], v30, s[4:7], s65 offen offset:3584 sc1
 s_lshl_b32 s55, s54, 19
 s_add_u32 s55, s55, s59
 s_xor_b32 s55, s55, 8192
 s_cmp_lt_u32 s54, 63
 s_cselect_b32 s64, 12, 0
 s_waitcnt vmcnt(17)
 v_mfma_f32_16x16x32_bf16 v[68:71], a[32:35], a[0:3], v[12:15]
 v_mfma_f32_16x16x32_bf16 v[68:71], a[36:39], a[4:7], v[68:71]
 v_mfma_f32_16x16x32_bf16 v[68:71], a[40:43], a[8:11], v[68:71]
 v_mfma_f32_16x16x32_bf16 v[68:71], a[44:47], a[12:15], v[68:71]
 v_mfma_f32_16x16x32_bf16 v[80:83], a[32:35], a[16:19], 0
 v_mfma_f32_16x16x32_bf16 v[80:83], a[36:39], a[20:23], v[80:83]
 v_mfma_f32_16x16x32_bf16 v[80:83], a[40:43], a[24:27], v[80:83]
 v_mfma_f32_16x16x32_bf16 v[80:83], a[44:47], a[28:31], v[80:83]
 v_mfma_f32_16x16x32_bf16 v[84:87], a[48:51], a[16:19], v[12:15]
 v_mfma_f32_16x16x32_bf16 v[84:87], a[52:55], a[20:23], v[84:87]
 v_mfma_f32_16x16x32_bf16 v[84:87], a[56:59], a[24:27], v[84:87]
 v_mfma_f32_16x16x32_bf16 v[84:87], a[60:63], a[28:31], v[84:87]
 s_nop 7
 v_cvt_pk_bf16_f32 v3, v68, v69
 v_lshlrev_b32 v68, 16, v3
 v_and_b32 v69, 0xffff0000, v3
 v_cvt_pk_bf16_f32 v3, v70, v71
 v_lshlrev_b32 v70, 16, v3
 v_and_b32 v71, 0xffff0000, v3
 v_cvt_pk_bf16_f32 v3, v80, v81
 v_lshlrev_b32 v80, 16, v3
 v_and_b32 v81, 0xffff0000, v3
 v_cvt_pk_bf16_f32 v3, v82, v83
 v_lshlrev_b32 v82, 16, v3
 v_and_b32 v83, 0xffff0000, v3
 v_cvt_pk_bf16_f32 v3, v84, v85
 v_lshlrev_b32 v84, 16, v3
 v_and_b32 v85, 0xffff0000, v3
 v_cvt_pk_bf16_f32 v3, v86, v87
 v_lshlrev_b32 v86, 16, v3
 v_and_b32 v87, 0xffff0000, v3
 v_mul_f32 v68, s62, v68
 v_mul_f32 v69, s62, v69
 v_mul_f32 v70, s62, v70
 v_mul_f32 v71, s62, v71
 v_mul_f32 v80, s62, v80
 v_mul_f32 v81, s62, v81
 v_mul_f32 v82, s62, v82
 v_mul_f32 v83, s62, v83
 v_mul_f32 v84, s62, v84
 v_mul_f32 v85, s62, v85
 v_mul_f32 v86, s62, v86
 v_mul_f32 v87, s62, v87
 v_cvt_pk_bf16_f32 v3, v68, v69
 v_lshlrev_b32 v68, 16, v3
 v_and_b32 v69, 0xffff0000, v3
 v_cvt_pk_bf16_f32 v3, v70, v71
 v_lshlrev_b32 v70, 16, v3
 v_and_b32 v71, 0xffff0000, v3
 v_cvt_pk_bf16_f32 v3, v80, v81
 v_lshlrev_b32 v80, 16, v3
 v_and_b32 v81, 0xffff0000, v3
 v_cvt_pk_bf16_f32 v3, v82, v83
 v_lshlrev_b32 v82, 16, v3
 v_and_b32 v83, 0xffff0000, v3
 v_cvt_pk_bf16_f32 v3, v84, v85
 v_lshlrev_b32 v84, 16, v3
 v_and_b32 v85, 0xffff0000, v3
 v_cvt_pk_bf16_f32 v3, v86, v87
 v_lshlrev_b32 v86, 16, v3
 v_and_b32 v87, 0xffff0000, v3
 v_max3_f32 v16, v68, v69, v70
 v_max_f32 v16, v16, v71
 v_max3_f32 v17, v80, v81, v82
 v_max3_f32 v17, v17, v83, v84
 v_max3_f32 v17, v17, v85, v86
 v_max_f32 v17, v17, v87
 v_mov_b32 v22, v16
 v_mov_b32 v23, v17
 s_nop 0
 v_permlane16_swap_b32 v16, v22
 v_permlane16_swap_b32 v17, v23
 v_max_f32 v16, v16, v22
 v_max_f32 v17, v17, v23
 v_mov_b32 v22, v16
 v_mov_b32 v23, v17
 s_nop 0
 v_permlane32_swap_b32 v16, v22
 v_permlane32_swap_b32 v17, v23
 v_max_f32 v16, v16, v22
 v_max_f32 v17, v17, v23
 v_mul_f32 v22, s63, v16
 v_fma_f32 v68, v68, s63, -v22
 v_fma_f32 v69, v69, s63, -v22
 v_fma_f32 v70, v70, s63, -v22
 v_fma_f32 v71, v71, s63, -v22
 v_mul_f32 v23, s63, v17
 v_fma_f32 v80, v80, s63, -v23
 v_fma_f32 v81, v81, s63, -v23
 v_fma_f32 v82, v82, s63, -v23
 v_fma_f32 v83, v83, s63, -v23
 v_fma_f32 v84, v84, s63, -v23
 v_fma_f32 v85, v85, s63, -v23
 v_fma_f32 v86, v86, s63, -v23
 v_fma_f32 v87, v87, s63, -v23
 v_exp_f32 v68, v68
 v_exp_f32 v69, v69
 v_exp_f32 v70, v70
 v_exp_f32 v71, v71
 v_exp_f32 v80, v80
 v_exp_f32 v81, v81
 v_exp_f32 v82, v82
 v_exp_f32 v83, v83
 v_exp_f32 v84, v84
 v_exp_f32 v85, v85
 v_exp_f32 v86, v86
 v_exp_f32 v87, v87
 v_add_f32 v18, v68, v69
 v_add_f32 v18, v18, v70
 v_add_f32 v18, v18, v71
 v_add_f32 v19, v80, v81
 v_add_f32 v19, v19, v82
 v_add_f32 v19, v19, v83
 v_add_f32 v19, v19, v84
 v_add_f32 v19, v19, v85
 v_add_f32 v19, v19, v86
 v_add_f32 v19, v19, v87
 s_mov_b32 s51, 0
 s_waitcnt vmcnt(4)
 v_max_u32 v3, v32, v34
 v_max3_u32 v3, v3, v36, v38
 v_max3_u32 v3, v3, v40, v42
 v_max3_u32 v3, v3, v44, v46
 v_cmp_eq_u32 vcc, -1, v3
 s_cbranch_vccz L_pkd_117
L_pk_116:
 s_sleep 2
 buffer_load_dwordx4 v[32:35], v6, s[4:7], s65 offen offset:0 sc1
 buffer_load_dwordx4 v[36:39], v6, s[4:7], s65 offen offset:512 sc1
 buffer_load_dwordx4 v[40:43], v6, s[4:7], s65 offen offset:1024 sc1
 buffer_load_dwordx4 v[44:47], v6, s[4:7], s65 offen offset:1536 sc1
 s_waitcnt vmcnt(0)
 v_max_u32 v3, v32, v34
 v_max3_u32 v3, v3, v36, v38
 v_max3_u32 v3, v3, v40, v42
 v_max3_u32 v3, v3, v44, v46
 v_cmp_eq_u32 vcc, -1, v3
 s_cbranch_vccz L_pke_118
 s_add_u32 s51, s51, 1
 s_cmp_lt_u32 s51, 131072
 s_cbranch_scc1 L_pk_116
 s_branch L_bail
L_pke_118:
 s_mov_b32 s51, 1
L_pkd_117:
 v_mfma_f32_16x16x32_bf16 v[64:67], v[32:35], a[0:3], 0
 v_mfma_f32_16x16x32_bf16 v[64:67], v[36:39], a[4:7], v[64:67]
 v_mfma_f32_16x16x32_bf16 v[64:67], v[40:43], a[8:11], v[64:67]
 v_mfma_f32_16x16x32_bf16 v[64:67], v[44:47], a[12:15], v[64:67]
 v_mfma_f32_16x16x32_bf16 v[76:79], v[32:35], a[16:19], 0
 v_mfma_f32_16x16x32_bf16 v[76:79], v[36:39], a[20:23], v[76:79]
 v_mfma_f32_16x16x32_bf16 v[76:79], v[40:43], a[24:27], v[76:79]
 v_mfma_f32_16x16x32_bf16 v[76:79], v[44:47], a[28:31], v[76:79]
 v_readfirstlane_b32 s68, v29
 s_nop 6
 v_cvt_pk_bf16_f32 v3, v64, v65
 v_lshlrev_b32 v64, 16, v3
 v_and_b32 v65, 0xffff0000, v3
 v_cvt_pk_bf16_f32 v3, v76, v77
 v_lshlrev_b32 v76, 16, v3
 v_and_b32 v77, 0xffff0000, v3
 v_mul_f32 v64, s62, v64
 v_mul_f32 v65, s62, v65
 v_mul_f32 v76, s62, v76
 v_mul_f32 v77, s62, v77
 v_cvt_pk_bf16_f32 v3, v64, v65
 v_lshlrev_b32 v64, 16, v3
 v_and_b32 v65, 0xffff0000, v3
 v_cvt_pk_bf16_f32 v3, v76, v77
 v_lshlrev_b32 v76, 16, v3
 v_and_b32 v77, 0xffff0000, v3
 s_cmp_eq_u32 s51, 0
 s_cbranch_scc1 L_nv_119
 buffer_load_dwordx2 v[48:49], v30, s[4:7], s65 offen offset:2048 sc1
 buffer_load_dwordx2 v[50:51], v30, s[4:7], s65 offen offset:2560 sc1
 buffer_load_dwordx2 v[52:53], v30, s[4:7], s65 offen offset:3072 sc1
 buffer_load_dwordx2 v[54:55], v30, s[4:7], s65 offen offset:3584 sc1
L_nv_119:
 v_mov_b32 v29, 0
 s_mov_b64 exec, 1
 buffer_atomic_add v29, off, s[4:7], s61 offset:4 sc0
 s_mov_b64 exec, -1
 s_add_u32 s67, s54, 1
 s_cmp_ge_u32 s68, s64
 s_cselect_b32 s67, s67, 64
 s_lshl_b32 s56, s67, 19
 s_add_u32 s56, s56, s57
 s_cmp_lt_u32 s67, 64
 s_cselect_b32 s56, s56, 268435456
 s_xor_b32 s3, s56, 8192
 buffer_load_dwordx4 a[0:3], v1, s[4:7], s3 offen offset:0 sc1
 buffer_load_dwordx4 a[4:7], v1, s[4:7], s3 offen offset:1024 sc1
 buffer_load_dwordx4 a[8:11], v1, s[4:7], s3 offen offset:2048 sc1
 buffer_load_dwordx4 a[12:15], v1, s[4:7], s3 offen offset:3072 sc1
 buffer_load_dwordx4 a[16:19], v2, s[4:7], s3 offen offset:0 sc1
 buffer_load_dwordx4 a[20:23], v2, s[4:7], s3 offen offset:1024 sc1
 buffer_load_dwordx4 a[24:27], v2, s[4:7], s3 offen offset:2048 sc1
 buffer_load_dwordx4 a[28:31], v2, s[4:7], s3 offen offset:3072 sc1
 s_mov_b32 s3, s56
 buffer_load_dwordx4 a[32:35], v1, s[4:7], s3 offen offset:0 sc1
 buffer_load_dwordx4 a[36:39], v1, s[4:7], s3 offen offset:1024 sc1
 buffer_load_dwordx4 a[40:43], v1, s[4:7], s3 offen offset:2048 sc1
 buffer_load_dwordx4 a[44:47], v1, s[4:7], s3 offen offset:3072 sc1
 buffer_load_dwordx4 a[48:51], v2, s[4:7], s3 offen offset:0 sc1
 buffer_load_dwordx4 a[52:55], v2, s[4:7], s3 offen offset:1024 sc1
 buffer_load_dwordx4 a[56:59], v2, s[4:7], s3 offen offset:2048 sc1
 buffer_load_dwordx4 a[60:63], v2, s[4:7], s3 offen offset:3072 sc1
 v_max3_f32 v20, v64, v65, v16
 v_max3_f32 v21, v76, v77, v17
 v_mov_b32 v22, v20
 v_mov_b32 v23, v21
 s_nop 0
 v_permlane16_swap_b32 v20, v22
 v_permlane16_swap_b32 v21, v23
 v_max_f32 v20, v20, v22
 v_max_f32 v21, v21, v23
 v_mov_b32 v22, v20
 v_mov_b32 v23, v21
 s_nop 0
 v_permlane32_swap_b32 v20, v22
 v_permlane32_swap_b32 v21, v23
 v_max_f32 v20, v20, v22
 v_max_f32 v21, v21, v23
 v_mul_f32 v20, s63, v20
 v_fma_f32 v24, v16, s63, -v20
 v_fma_f32 v64, v64, s63, -v20
 v_fma_f32 v65, v65, s63, -v20
 v_mul_f32 v21, s63, v21
 v_fma_f32 v26, v17, s63, -v21
 v_fma_f32 v76, v76, s63, -v21
 v_fma_f32 v77, v77, s63, -v21
 v_exp_f32 v24, v24
 v_exp_f32 v64, v64
 v_exp_f32 v65, v65
 v_exp_f32 v26, v26
 v_exp_f32 v76, v76
 v_exp_f32 v77, v77
 s_nop 0
 v_fma_f32 v18, v18, v24, v64
 v_add_f32 v18, v18, v65
 v_fma_f32 v19, v19, v26, v76
 v_add_f32 v19, v19, v77
 v_mov_b32 v22, v18
 v_mov_b32 v23, v19
 s_nop 0
 v_permlane16_swap_b32 v18, v22
 v_permlane16_swap_b32 v19, v23
 v_add_f32 v18, v18, v22
 v_add_f32 v19, v19, v23
 v_mov_b32 v22, v18
 v_mov_b32 v23, v19
 s_nop 0
 v_permlane32_swap_b32 v18, v22
 v_permlane32_swap_b32 v19, v23
 v_add_f32 v18, v18, v22
 v_add_f32 v19, v19, v23
 v_rcp_f32 v18, v18
 v_rcp_f32 v19, v19
 v_mul_f32 v24, v24, v18
 v_mul_f32 v26, v26, v19
 v_pk_mul_f32 v[68:69], v[68:69], v[24:25] op_sel_hi:[1,0]
 v_cvt_pk_bf16_f32 v168, v68, v69
 v_pk_mul_f32 v[70:71], v[70:71], v[24:25] op_sel_hi:[1,0]
 v_cvt_pk_bf16_f32 v169, v70, v71
 v_mul_f32 v64, v64, v18
 v_mul_f32 v65, v65, v18
 v_cvt_pk_bf16_f32 v152, v64, v65
 v_cvt_pk_bf16_f32 v155, v64, v65
 v_mfma_f32_16x16x32_bf16 v[88:91], a[64:67], v[168:171], 0
 v_pk_mul_f32 v[80:81], v[80:81], v[26:27] op_sel_hi:[1,0]
 v_cvt_pk_bf16_f32 v172, v80, v81
 v_mfma_f32_16x16x32_bf16 v[92:95], a[68:71], v[168:171], 0
 v_pk_mul_f32 v[82:83], v[82:83], v[26:27] op_sel_hi:[1,0]
 v_cvt_pk_bf16_f32 v173, v82, v83
 v_mfma_f32_16x16x32_bf16 v[96:99], a[72:75], v[168:171], 0
 v_pk_mul_f32 v[84:85], v[84:85], v[26:27] op_sel_hi:[1,0]
 v_cvt_pk_bf16_f32 v174, v84, v85
 v_mfma_f32_16x16x32_bf16 v[100:103], a[76:79], v[168:171], 0
 v_pk_mul_f32 v[86:87], v[86:87], v[26:27] op_sel_hi:[1,0]
 v_cvt_pk_bf16_f32 v175, v86, v87
 v_mfma_f32_16x16x32_bf16 v[104:107], a[80:83], v[168:171], 0
 v_mul_f32 v76, v76, v19
 v_mul_f32 v77, v77, v19
 v_mfma_f32_16x16x32_bf16 v[108:111], a[84:87], v[168:171], 0
 v_cvt_pk_bf16_f32 v160, v76, v77
 v_cvt_pk_bf16_f32 v163, v76, v77
 v_mfma_f32_16x16x32_bf16 v[112:115], a[88:91], v[168:171], 0
 v_mfma_f32_16x16x32_bf16 v[116:119], a[92:95], v[168:171], 0
 v_mfma_f32_16x16x32_bf16 v[120:123], a[64:67], v[172:175], 0
 v_mfma_f32_16x16x32_bf16 v[124:127], a[68:71], v[172:175], 0
 v_mfma_f32_16x16x32_bf16 v[128:131], a[72:75], v[172:175], 0
 v_mfma_f32_16x16x32_bf16 v[132:135], a[76:79], v[172:175], 0
 v_mfma_f32_16x16x32_bf16 v[136:139], a[80:83], v[172:175], 0
 v_mfma_f32_16x16x32_bf16 v[140:143], a[84:87], v[172:175], 0
 v_mfma_f32_16x16x32_bf16 v[144:147], a[88:91], v[172:175], 0
 v_mfma_f32_16x16x32_bf16 v[148:151], a[92:95], v[172:175], 0
 s_waitcnt vmcnt(17)
L_pv_120:
 v_max_u32 v3, v48, v50
 v_max3_u32 v3, v3, v52, v54
 v_cmp_eq_u32 vcc, -1, v3
 s_cbranch_vccz L_pvd_121
 buffer_load_dwordx2 v[48:49], v30, s[4:7], s65 offen offset:2048 sc1
 buffer_load_dwordx2 v[50:51], v30, s[4:7], s65 offen offset:2560 sc1
 buffer_load_dwordx2 v[52:53], v30, s[4:7], s65 offen offset:3072 sc1
 buffer_load_dwordx2 v[54:55], v30, s[4:7], s65 offen offset:3584 sc1
 s_waitcnt vmcnt(0)
 s_add_u32 s51, s51, 1
 s_cmp_lt_u32 s51, 131072
 s_cbranch_scc1 L_pv_120
 s_branch L_bail
L_pvd_121:
 v_mfma_f32_16x16x16_bf16 v[88:91], v[48:49], v[152:153], v[88:91]
 v_mfma_f32_16x16x16_bf16 v[92:95], v[48:49], v[154:155], v[92:95]
 v_mfma_f32_16x16x16_bf16 v[96:99], v[50:51], v[152:153], v[96:99]
 v_mfma_f32_16x16x16_bf16 v[100:103], v[50:51], v[154:155], v[100:103]
 v_mfma_f32_16x16x16_bf16 v[104:107], v[52:53], v[152:153], v[104:107]
 v_mfma_f32_16x16x16_bf16 v[108:111], v[52:53], v[154:155], v[108:111]
 v_mfma_f32_16x16x16_bf16 v[112:115], v[54:55], v[152:153], v[112:115]
 v_mfma_f32_16x16x16_bf16 v[116:119], v[54:55], v[154:155], v[116:119]
 v_mfma_f32_16x16x16_bf16 v[120:123], v[48:49], v[160:161], v[120:123]
 v_mfma_f32_16x16x16_bf16 v[124:127], v[48:49], v[162:163], v[124:127]
 v_cvt_pk_bf16_f32 v176, v88, v89
 v_cvt_pk_bf16_f32 v177, v90, v91
 v_mfma_f32_16x16x16_bf16 v[128:131], v[50:51], v[160:161], v[128:131]
 v_cvt_pk_bf16_f32 v178, v92, v93
 v_cvt_pk_bf16_f32 v179, v94, v95
 v_mfma_f32_16x16x16_bf16 v[132:135], v[50:51], v[162:163], v[132:135]
 s_add_u32 s3, s55, 0
 buffer_store_dwordx4 v[176:179], v7, s[4:7], s3 offen offset:0 sc1
 v_cvt_pk_bf16_f32 v180, v96, v97
 v_mfma_f32_16x16x16_bf16 v[136:139], v[52:53], v[160:161], v[136:139]
 v_cvt_pk_bf16_f32 v181, v98, v99
 v_cvt_pk_bf16_f32 v182, v100, v101
 v_mfma_f32_16x16x16_bf16 v[140:143], v[52:53], v[162:163], v[140:143]
 v_cvt_pk_bf16_f32 v183, v102, v103
 s_add_u32 s3, s55, 2048
 buffer_store_dwordx4 v[180:183], v7, s[4:7], s3 offen offset:0 sc1
 v_mfma_f32_16x16x16_bf16 v[144:147], v[54:55], v[160:161], v[144:147]
 v_cvt_pk_bf16_f32 v184, v104, v105
 v_cvt_pk_bf16_f32 v185, v106, v107
 v_mfma_f32_16x16x16_bf16 v[148:151], v[54:55], v[162:163], v[148:151]
 v_cvt_pk_bf16_f32 v186, v108, v109
 v_cvt_pk_bf16_f32 v187, v110, v111
 s_add_u32 s3, s55, 4096
 buffer_store_dwordx4 v[184:187], v7, s[4:7], s3 offen offset:0 sc1
 v_cvt_pk_bf16_f32 v188, v112, v113
 v_cvt_pk_bf16_f32 v189, v114, v115
 v_cvt_pk_bf16_f32 v190, v116, v117
 v_cvt_pk_bf16_f32 v191, v118, v119
 s_add_u32 s3, s55, 6144
 buffer_store_dwordx4 v[188:191], v7, s[4:7], s3 offen offset:0 sc1
 v_cvt_pk_bf16_f32 v192, v120, v121
 v_cvt_pk_bf16_f32 v193, v122, v123
 v_cvt_pk_bf16_f32 v194, v124, v125
 v_cvt_pk_bf16_f32 v195, v126, v127
 s_add_u32 s3, s55, 0
 buffer_store_dwordx4 v[192:195], v7, s[4:7], s3 offen offset:256 sc1
 v_cvt_pk_bf16_f32 v196, v128, v129
 v_cvt_pk_bf16_f32 v197, v130, v131
 v_cvt_pk_bf16_f32 v198, v132, v133
 v_cvt_pk_bf16_f32 v199, v134, v135
 s_add_u32 s3, s55, 2048
 buffer_store_dwordx4 v[196:199], v7, s[4:7], s3 offen offset:256 sc1
 v_cvt_pk_bf16_f32 v200, v136, v137
 v_cvt_pk_bf16_f32 v201, v138, v139
 v_cvt_pk_bf16_f32 v202, v140, v141
 v_cvt_pk_bf16_f32 v203, v142, v143
 s_add_u32 s3, s55, 4096
 buffer_store_dwordx4 v[200:203], v7, s[4:7], s3 offen offset:256 sc1
 v_cvt_pk_bf16_f32 v204, v144, v145
 v_cvt_pk_bf16_f32 v205, v146, v147
 v_cvt_pk_bf16_f32 v206, v148, v149
 v_cvt_pk_bf16_f32 v207, v150, v151
 s_add_u32 s3, s55, 6144
 buffer_store_dwordx4 v[204:207], v7, s[4:7], s3 offen offset:256 sc1
 buffer_store_dwordx4 v[208:211], v1, s[4:7], s65 offen offset:0 sc1
 buffer_store_dwordx4 v[208:211], v1, s[4:7], s65 offen offset:1024 sc1
 buffer_store_dwordx4 v[208:211], v1, s[4:7], s65 offen offset:2048 sc1
 buffer_store_dwordx4 v[208:211], v1, s[4:7], s65 offen offset:3072 sc1
 s_add_u32 s54, s54, 1
 s_add_u32 s61, s61, 4
 s_cmp_lt_u32 s68, s64
 s_cbranch_scc1 L_aq_124
 s_lshl_b32 s56, s54, 19
 s_add_u32 s56, s56, s57
 s_cmp_lt_u32 s54, 64
 s_cselect_b32 s56, s56, 268435456
 s_add_u32 s3, s56, 67108864
 buffer_load_dwordx4 a[64:67], v1, s[4:7], s3 offen offset:0 sc1
 buffer_load_dwordx4 a[68:71], v1, s[4:7], s3 offen offset:1024 sc1
 buffer_load_dwordx4 a[72:75], v1, s[4:7], s3 offen offset:2048 sc1
 buffer_load_dwordx4 a[76:79], v1, s[4:7], s3 offen offset:3072 sc1
 buffer_load_dwordx4 a[80:83], v2, s[4:7], s3 offen offset:0 sc1
 buffer_load_dwordx4 a[84:87], v2, s[4:7], s3 offen offset:1024 sc1
 buffer_load_dwordx4 a[88:91], v2, s[4:7], s3 offen offset:2048 sc1
 buffer_load_dwordx4 a[92:95], v2, s[4:7], s3 offen offset:3072 sc1
 s_waitcnt vmcnt(12)
 v_mov_b32 v3, 1
 s_mov_b64 exec, 31
 buffer_atomic_add v3, v31, s[4:7], s60 offen
 s_mov_b64 exec, -1
 s_waitcnt vmcnt(9)
 v_mov_b32 v3, 1
 s_mov_b64 exec, 1
 buffer_atomic_add v3, v5, s[4:7], s66 offen
 s_mov_b64 exec, -1
 s_branch L_ak_123
L_aq_124:
 s_waitcnt vmcnt(12)
 v_readfirstlane_b32 s3, v29
 s_nop 3
 s_cmp_ge_u32 s3, s64
 s_cbranch_scc1 L_aj_122
 s_waitcnt vmcnt(4)
 v_mov_b32 v3, 1
 s_mov_b64 exec, 31
 buffer_atomic_add v3, v31, s[4:7], s60 offen
 s_mov_b64 exec, -1
 s_waitcnt vmcnt(1)
 v_mov_b32 v3, 1
 s_mov_b64 exec, 1
 buffer_atomic_add v3, v5, s[4:7], s66 offen
 s_mov_b64 exec, -1
 s_mov_b32 s51, 0
 s_mov_b64 exec, 1
L_wc_125:
 v_mov_b32 v3, 0
 buffer_atomic_add v3, v5, s[4:7], s61 offen sc0
 s_waitcnt vmcnt(0)
 v_cmp_gt_u32 vcc, s64, v3
 s_cbranch_vccz L_wcd_126
 s_sleep 4
 s_add_u32 s51, s51, 1
 s_cmp_lt_u32 s51, 131072
 s_cbranch_scc1 L_wc_125
 s_branch L_bail
L_wcd_126:
 s_mov_b64 exec, -1
 s_lshl_b32 s56, s54, 19
 s_add_u32 s56, s56, s57
 s_cmp_lt_u32 s54, 64
 s_cselect_b32 s56, s56, 268435456
 s_xor_b32 s3, s56, 8192
 buffer_load_dwordx4 a[0:3], v1, s[4:7], s3 offen offset:0 sc1
 buffer_load_dwordx4 a[4:7], v1, s[4:7], s3 offen offset:1024 sc1
 buffer_load_dwordx4 a[8:11], v1, s[4:7], s3 offen offset:2048 sc1
 buffer_load_dwordx4 a[12:15], v1, s[4:7], s3 offen offset:3072 sc1
 buffer_load_dwordx4 a[16:19], v2, s[4:7], s3 offen offset:0 sc1
 buffer_load_dwordx4 a[20:23], v2, s[4:7], s3 offen offset:1024 sc1
 buffer_load_dwordx4 a[24:27], v2, s[4:7], s3 offen offset:2048 sc1
 buffer_load_dwordx4 a[28:31], v2, s[4:7], s3 offen offset:3072 sc1
 s_mov_b32 s3, s56
 buffer_load_dwordx4 a[32:35], v1, s[4:7], s3 offen offset:0 sc1
 buffer_load_dwordx4 a[36:39], v1, s[4:7], s3 offen offset:1024 sc1
 buffer_load_dwordx4 a[40:43], v1, s[4:7], s3 offen offset:2048 sc1
 buffer_load_dwordx4 a[44:47], v1, s[4:7], s3 offen offset:3072 sc1
 buffer_load_dwordx4 a[48:51], v2, s[4:7], s3 offen offset:0 sc1
 buffer_load_dwordx4 a[52:55], v2, s[4:7], s3 offen offset:1024 sc1
 buffer_load_dwordx4 a[56:59], v2, s[4:7], s3 offen offset:2048 sc1
 buffer_load_dwordx4 a[60:63], v2, s[4:7], s3 offen offset:3072 sc1
 s_add_u32 s3, s56, 67108864
 buffer_load_dwordx4 a[64:67], v1, s[4:7], s3 offen offset:0 sc1
 buffer_load_dwordx4 a[68:71], v1, s[4:7], s3 offen offset:1024 sc1
 buffer_load_dwordx4 a[72:75], v1, s[4:7], s3 offen offset:2048 sc1
 buffer_load_dwordx4 a[76:79], v1, s[4:7], s3 offen offset:3072 sc1
 buffer_load_dwordx4 a[80:83], v2, s[4:7], s3 offen offset:0 sc1
 buffer_load_dwordx4 a[84:87], v2, s[4:7], s3 offen offset:1024 sc1
 buffer_load_dwordx4 a[88:91], v2, s[4:7], s3 offen offset:2048 sc1
 buffer_load_dwordx4 a[92:95], v2, s[4:7], s3 offen offset:3072 sc1
 s_branch L_ak_123
L_aj_122:
 s_lshl_b32 s56, s54, 19
 s_add_u32 s56, s56, s57
 s_cmp_lt_u32 s54, 64
 s_cselect_b32 s56, s56, 268435456
 s_xor_b32 s3, s56, 8192
 buffer_load_dwordx4 a[0:3], v1, s[4:7], s3 offen offset:0 sc1
 buffer_load_dwordx4 a[4:7], v1, s[4:7], s3 offen offset:1024 sc1
 buffer_load_dwordx4 a[8:11], v1, s[4:7], s3 offen offset:2048 sc1
 buffer_load_dwordx4 a[12:15], v1, s[4:7], s3 offen offset:3072 sc1
 buffer_load_dwordx4 a[16:19], v2, s[4:7], s3 offen offset:0 sc1
 buffer_load_dwordx4 a[20:23], v2, s[4:7], s3 offen offset:1024 sc1
 buffer_load_dwordx4 a[24:27], v2, s[4:7], s3 offen offset:2048 sc1
 buffer_load_dwordx4 a[28:31], v2, s[4:7], s3 offen offset:3072 sc1
 s_mov_b32 s3, s56
 buffer_load_dwordx4 a[32:35], v1, s[4:7], s3 offen offset:0 sc1
 buffer_load_dwordx4 a[36:39], v1, s[4:7], s3 offen offset:1024 sc1
 buffer_load_dwordx4 a[40:43], v1, s[4:7], s3 offen offset:2048 sc1
 buffer_load_dwordx4 a[44:47], v1, s[4:7], s3 offen offset:3072 sc1
 buffer_load_dwordx4 a[48:51], v2, s[4:7], s3 offen offset:0 sc1
 buffer_load_dwordx4 a[52:55], v2, s[4:7], s3 offen offset:1024 sc1
 buffer_load_dwordx4 a[56:59], v2, s[4:7], s3 offen offset:2048 sc1
 buffer_load_dwordx4 a[60:63], v2, s[4:7], s3 offen offset:3072 sc1
 s_add_u32 s3, s56, 67108864
 buffer_load_dwordx4 a[64:67], v1, s[4:7], s3 offen offset:0 sc1
 buffer_load_dwordx4 a[68:71], v1, s[4:7], s3 offen offset:1024 sc1
 buffer_load_dwordx4 a[72:75], v1, s[4:7], s3 offen offset:2048 sc1
 buffer_load_dwordx4 a[76:79], v1, s[4:7], s3 offen offset:3072 sc1
 buffer_load_dwordx4 a[80:83], v2, s[4:7], s3 offen offset:0 sc1
 buffer_load_dwordx4 a[84:87], v2, s[4:7], s3 offen offset:1024 sc1
 buffer_load_dwordx4 a[88:91], v2, s[4:7], s3 offen offset:2048 sc1
 buffer_load_dwordx4 a[92:95], v2, s[4:7], s3 offen offset:3072 sc1
 s_waitcnt vmcnt(28)
 v_mov_b32 v3, 1
 s_mov_b64 exec, 31
 buffer_atomic_add v3, v31, s[4:7], s60 offen
 s_mov_b64 exec, -1
 s_waitcnt vmcnt(25)
 v_mov_b32 v3, 1
 s_mov_b64 exec, 1
 buffer_atomic_add v3, v5, s[4:7], s66 offen
 s_mov_b64 exec, -1
L_ak_123:
 s_add_u32 s60, s60, 4
 s_cmp_lt_u32 s54, 64
 s_cbranch_scc1 L_att_loop
 s_endpgm
L_wo:
 s_and_b32 s100, s64, 1
 s_lshl_b32 s100, s100, 13
 s_lshl_b32 s64, s64, 14
 s_add_u32 s64, s64, s100
 s_xor_b32 s64, s64, 8192
 s_and_b32 s100, s65, 1
 s_lshl_b32 s100, s100, 13
 s_lshl_b32 s65, s65, 14
 s_add_u32 s65, s65, s100
 s_xor_b32 s65, s65, 8192
 s_and_b32 s100, s66, 1
 s_lshl_b32 s100, s100, 13
 s_lshl_b32 s66, s66, 14
 s_add_u32 s66, s66, s100
 s_xor_b32 s66, s66, 8192
 s_and_b32 s100, s67, 1
 s_lshl_b32 s100, s100, 13
 s_lshl_b32 s67, s67, 14
 s_add_u32 s67, s67, s100
 s_xor_b32 s67, s67, 8192
 v_lshlrev_b32 v7, 4, v0
 v_lshrrev_b32 v4, 5, v0
 s_mov_b32 s3, 10240
 v_mul_lo_u32 v4, v4, s3
 v_and_b32 v3, 31, v0
 v_lshl_add_u32 v4, v3, 2, v4
 s_lshl_b32 s3, s53, 9
 s_lshl_b32 s55, s50, 7
 s_add_u32 s3, s3, s55
 v_add_u32 v4, s3, v4
 s_mul_i32 s58, s52, 81920
 s_add_u32 s58, s58, 142606336
 v_lshlrev_b32 v8, 9, v0
 s_mul_i32 s3, s52, 5
 s_add_u32 s3, s3, s53
 s_and_b32 s55, s3, 3
 s_mul_i32 s55, s55, 16384
 v_add_u32 v8, s55, v8
 s_lshl_b32 s3, s3, 9
 s_add_u32 s3, s3, 40960
 v_mul_u32_u24 v5, 224, v0
 v_add_u32 v5, s3, v5
 v_mov_b32 v6, 0
 v_mov_b32 v10, 163776
 s_lshl_b32 s56, s50, 11
 s_mov_b32 s54, 0
 s_mov_b32 s61, -1
L_wo_loop:
 s_cmp_lt_u32 s54, 64
 s_cselect_b32 s3, 4, 0
 v_writelane_b32 v6, s3, 0
 s_cmp_ge_u32 s54, 8
 s_cselect_b32 s3, 4, 0
 v_writelane_b32 v6, s3, 1
 s_lshl_b32 s55, s54, 2
 s_cmp_lg_u32 s50, 0
 s_cselect_b32 s3, 268435456, s55
 v_mov_b32 v9, 0
 s_mov_b64 exec, 3
 buffer_atomic_add v9, v5, s[4:7], s3 offen sc0
 s_mov_b64 exec, -1
 s_waitcnt vmcnt(1)
 s_barrier
 s_cmp_lg_u32 s50, 1
 s_cbranch_scc1 L_sg_127
 s_cmp_ge_u32 s61, 64
 s_cbranch_scc1 L_sg_127
 s_lshl_b32 s3, s61, 2
 s_add_u32 s3, s3, 61696
 v_mov_b32 v3, 1
 s_mov_b32 exec_hi, 0
 buffer_atomic_add v3, v8, s[4:7], s3 offen
 s_mov_b64 exec, -1
L_sg_127:
 s_cmp_ge_u32 s54, 72
 s_cbranch_scc1 L_bail
 s_cmp_lg_u32 s50, 0
 s_cbranch_scc1 L_w_128
 s_waitcnt vmcnt(0)
 v_cmp_gt_u32 vcc, v6, v9
 s_cbranch_vccz L_w_128
 s_mov_b32 s51, 0
 s_mov_b64 exec, 3
 v_mov_b32 v12, 0
 buffer_atomic_add v12, v5, s[4:7], s55 offen sc0
 s_sleep 5
L_wc_129:
 v_mov_b32 v13, 0
 buffer_atomic_add v13, v5, s[4:7], s55 offen sc0
 s_waitcnt vmcnt(1)
 v_cmp_gt_u32 vcc, v6, v12
 s_cbranch_vccz L_wcd_130
 v_mov_b32 v12, 0
 buffer_atomic_add v12, v5, s[4:7], s55 offen sc0
 s_waitcnt vmcnt(1)
 v_cmp_gt_u32 vcc, v6, v13
 s_cbranch_vccz L_wcd_130
 s_add_u32 s51, s51, 1
 s_cmp_lt_u32 s51, 131072
 s_cbranch_scc1 L_wc_129
 s_branch L_bail
L_wcd_130:
 s_mov_b64 exec, -1
L_w_128:
 s_barrier
 s_sub_u32 s61, s54, 8
 s_cmp_ge_u32 s54, 64
 s_cbranch_scc1 L_tail_131
 s_lshl_b32 s3, s52, 16
 s_add_u32 s3, s3, s56
 s_add_u32 s3, s3, 75497472
 s_lshl_b32 s55, s54, 19
 s_add_u32 s55, s55, s3
 s_cmp_lt_u32 s54, 64
 s_cselect_b32 s55, s55, 268435456
 s_add_u32 m0, s56, 0
 s_add_u32 s3, s55, s64
 buffer_load_dwordx4 v7, s[4:7], s3 offen offset:0 sc1 lds
 s_add_u32 m0, s56, 0
 s_add_u32 s3, s55, s64
 buffer_load_dwordx4 v7, s[4:7], s3 offen offset:1024 sc1 lds
 s_add_u32 m0, s56, 8192
 s_add_u32 s3, s55, s65
 buffer_load_dwordx4 v7, s[4:7], s3 offen offset:0 sc1 lds
 s_add_u32 m0, s56, 8192
 s_add_u32 s3, s55, s65
 buffer_load_dwordx4 v7, s[4:7], s3 offen offset:1024 sc1 lds
 s_add_u32 m0, s56, 16384
 s_add_u32 s3, s55, s66
 buffer_load_dwordx4 v7, s[4:7], s3 offen offset:0 sc1 lds
 s_add_u32 m0, s56, 16384
 s_add_u32 s3, s55, s66
 buffer_load_dwordx4 v7, s[4:7], s3 offen offset:1024 sc1 lds
 s_add_u32 m0, s56, 24576
 s_add_u32 s3, s55, s67
 buffer_load_dwordx4 v7, s[4:7], s3 offen offset:0 sc1 lds
 s_add_u32 m0, s56, 24576
 s_add_u32 s3, s55, s67
 buffer_load_dwordx4 v7, s[4:7], s3 offen offset:1024 sc1 lds
 s_mov_b32 s60, s54
 s_lshl_b32 s3, s52, 16
 s_add_u32 s3, s3, s56
 s_add_u32 s3, s3, 109051904
 s_lshl_b32 s55, s61, 19
 s_add_u32 s55, s55, s3
 s_cmp_lt_u32 s61, 64
 s_cselect_b32 s55, s55, 268435456
 s_waitcnt vmcnt(6)
 s_barrier
 ds_read_b128 v[32:35], v7 offset:0
 ds_read_b128 v[36:39], v7 offset:1024
 ds_read_b128 v[40:43], v7 offset:2048
 ds_read_b128 v[44:47], v7 offset:3072
 s_waitcnt lgkmcnt(3)
 v_mfma_f32_32x32x16_bf16 v[64:79], v[32:35], a[0:3], 0
 ds_read_b128 v[48:51], v7 offset:4096
 s_add_u32 m0, s56, 32768
 s_add_u32 s3, s55, s64
 buffer_load_dwordx4 v7, s[4:7], s3 offen offset:0 sc1 lds
 s_waitcnt lgkmcnt(3)
 v_mfma_f32_32x32x16_bf16 v[64:79], v[36:39], a[4:7], v[64:79]
 ds_read_b128 v[52:55], v7 offset:5120
 s_waitcnt lgkmcnt(3)
 v_mfma_f32_32x32x16_bf16 v[64:79], v[40:43], a[8:11], v[64:79]
 ds_read_b128 v[56:59], v7 offset:6144
 s_waitcnt lgkmcnt(3)
 v_mfma_f32_32x32x16_bf16 v[64:79], v[44:47], a[12:15], v[64:79]
 ds_read_b128 v[60:63], v7 offset:7168
 s_add_u32 m0, s56, 32768
 s_add_u32 s3, s55, s64
 buffer_load_dwordx4 v7, s[4:7], s3 offen offset:1024 sc1 lds
 s_waitcnt lgkmcnt(3)
 v_mfma_f32_32x32x16_bf16 v[64:79], v[48:51], a[16:19], v[64:79]
 s_waitcnt vmcnt(6)
 s_barrier
 ds_read_b128 v[32:35], v7 offset:8192
 s_waitcnt lgkmcnt(3)
 v_mfma_f32_32x32x16_bf16 v[64:79], v[52:55], a[20:23], v[64:79]
 ds_read_b128 v[36:39], v7 offset:9216
 s_waitcnt lgkmcnt(3)
 v_mfma_f32_32x32x16_bf16 v[64:79], v[56:59], a[24:27], v[64:79]
 ds_read_b128 v[40:43], v7 offset:10240
 s_add_u32 m0, s56, 40960
 s_add_u32 s3, s55, s65
 buffer_load_dwordx4 v7, s[4:7], s3 offen offset:0 sc1 lds
 s_waitcnt lgkmcnt(3)
 v_mfma_f32_32x32x16_bf16 v[64:79], v[60:63], a[28:31], v[64:79]
 ds_read_b128 v[44:47], v7 offset:11264
 s_waitcnt lgkmcnt(3)
 v_mfma_f32_32x32x16_bf16 v[64:79], v[32:35], a[32:35], v[64:79]
 ds_read_b128 v[48:51], v7 offset:12288
 s_waitcnt lgkmcnt(3)
 v_mfma_f32_32x32x16_bf16 v[64:79], v[36:39], a[36:39], v[64:79]
 ds_read_b128 v[52:55], v7 offset:13312
 s_add_u32 m0, s56, 40960
 s_add_u32 s3, s55, s65
 buffer_load_dwordx4 v7, s[4:7], s3 offen offset:1024 sc1 lds
 s_waitcnt lgkmcnt(3)
 v_mfma_f32_32x32x16_bf16 v[64:79], v[40:43], a[40:43], v[64:79]
 ds_read_b128 v[56:59], v7 offset:14336
 s_waitcnt lgkmcnt(3)
 v_mfma_f32_32x32x16_bf16 v[64:79], v[44:47], a[44:47], v[64:79]
 ds_read_b128 v[60:63], v7 offset:15360
 s_waitcnt lgkmcnt(3)
 v_mfma_f32_32x32x16_bf16 v[64:79], v[48:51], a[48:51], v[64:79]
 s_waitcnt vmcnt(6)
 s_barrier
 ds_read_b128 v[32:35], v7 offset:16384
 s_add_u32 m0, s56, 49152
 s_add_u32 s3, s55, s66
 buffer_load_dwordx4 v7, s[4:7], s3 offen offset:0 sc1 lds
 s_waitcnt lgkmcnt(3)
 v_mfma_f32_32x32x16_bf16 v[64:79], v[52:55], a[52:55], v[64:79]
 ds_read_b128 v[36:39], v7 offset:17408
 s_waitcnt lgkmcnt(3)
 v_mfma_f32_32x32x16_bf16 v[64:79], v[56:59], a[56:59], v[64:79]
 ds_read_b128 v[40:43], v7 offset:18432
 s_waitcnt lgkmcnt(3)
 v_mfma_f32_32x32x16_bf16 v[64:79], v[60:63], a[60:63], v[64:79]
 ds_read_b128 v[44:47], v7 offset:19456
 s_add_u32 m0, s56, 49152
 s_add_u32 s3, s55, s66
 buffer_load_dwordx4 v7, s[4:7], s3 offen offset:1024 sc1 lds
 s_waitcnt lgkmcnt(3)
 v_mfma_f32_32x32x16_bf16 v[64:79], v[32:35], a[64:67], v[64:79]
 ds_read_b128 v[48:51], v7 offset:20480
 s_waitcnt lgkmcnt(3)
 v_mfma_f32_32x32x16_bf16 v[64:79], v[36:39], a[68:71], v[64:79]
 ds_read_b128 v[52:55], v7 offset:21504
 s_waitcnt lgkmcnt(3)
 v_mfma_f32_32x32x16_bf16 v[64:79], v[40:43], a[72:75], v[64:79]
 ds_read_b128 v[56:59], v7 offset:22528
 s_add_u32 m0, s56, 57344
 s_add_u32 s3, s55, s67
 buffer_load_dwordx4 v7, s[4:7], s3 offen offset:0 sc1 lds
 s_waitcnt lgkmcnt(3)
 v_mfma_f32_32x32x16_bf16 v[64:79], v[44:47], a[76:79], v[64:79]
 ds_read_b128 v[60:63], v7 offset:23552
 s_waitcnt lgkmcnt(3)
 v_mfma_f32_32x32x16_bf16 v[64:79], v[48:51], a[80:83], v[64:79]
 s_waitcnt vmcnt(7)
 s_barrier
 ds_read_b128 v[32:35], v7 offset:24576
 s_waitcnt lgkmcnt(3)
 v_mfma_f32_32x32x16_bf16 v[64:79], v[52:55], a[84:87], v[64:79]
 ds_read_b128 v[36:39], v7 offset:25600
 s_add_u32 m0, s56, 57344
 s_add_u32 s3, s55, s67
 buffer_load_dwordx4 v7, s[4:7], s3 offen offset:1024 sc1 lds
 s_waitcnt lgkmcnt(3)
 v_mfma_f32_32x32x16_bf16 v[64:79], v[56:59], a[88:91], v[64:79]
 ds_read_b128 v[40:43], v7 offset:26624
 s_waitcnt lgkmcnt(3)
 v_mfma_f32_32x32x16_bf16 v[64:79], v[60:63], a[92:95], v[64:79]
 ds_read_b128 v[44:47], v7 offset:27648
 s_waitcnt lgkmcnt(3)
 v_mfma_f32_32x32x16_bf16 v[64:79], v[32:35], a[96:99], v[64:79]
 ds_read_b128 v[48:51], v7 offset:28672
 s_waitcnt lgkmcnt(3)
 v_mfma_f32_32x32x16_bf16 v[64:79], v[36:39], a[100:103], v[64:79]
 ds_read_b128 v[52:55], v7 offset:29696
 s_waitcnt lgkmcnt(3)
 v_mfma_f32_32x32x16_bf16 v[64:79], v[40:43], a[104:107], v[64:79]
 ds_read_b128 v[56:59], v7 offset:30720
 s_waitcnt lgkmcnt(3)
 v_mfma_f32_32x32x16_bf16 v[64:79], v[44:47], a[108:111], v[64:79]
 ds_read_b128 v[60:63], v7 offset:31744
 s_waitcnt lgkmcnt(3)
 v_mfma_f32_32x32x16_bf16 v[64:79], v[48:51], a[112:115], v[64:79]
 s_waitcnt lgkmcnt(2)
 v_mfma_f32_32x32x16_bf16 v[64:79], v[52:55], a[116:119], v[64:79]
 s_waitcnt lgkmcnt(1)
 v_mfma_f32_32x32x16_bf16 v[64:79], v[56:59], a[120:123], v[64:79]
 s_waitcnt lgkmcnt(0)
 v_mfma_f32_32x32x16_bf16 v[64:79], v[60:63], a[124:127], v[64:79]
 s_mul_i32 s55, s60, 655360
 s_add_u32 s55, s55, s58
 s_cmp_lt_u32 s60, 64
 s_cselect_b32 s55, s55, 268435456
 s_nop 7
 s_add_u32 s3, s55, 0
 buffer_store_dword v64, v4, s[4:7], s3 offen sc1
 s_add_u32 s3, s55, 2560
 buffer_store_dword v65, v4, s[4:7], s3 offen sc1
 s_add_u32 s3, s55, 5120
 buffer_store_dword v66, v4, s[4:7], s3 offen sc1
 s_add_u32 s3, s55, 7680
 buffer_store_dword v67, v4, s[4:7], s3 offen sc1
 s_add_u32 s3, s55, 20480
 buffer_store_dword v68, v4, s[4:7], s3 offen sc1
 s_add_u32 s3, s55, 23040
 buffer_store_dword v69, v4, s[4:7], s3 offen sc1
 s_add_u32 s3, s55, 25600
 buffer_store_dword v70, v4, s[4:7], s3 offen sc1
 s_add_u32 s3, s55, 28160
 buffer_store_dword v71, v4, s[4:7], s3 offen sc1
 s_add_u32 s3, s55, 40960
 buffer_store_dword v72, v4, s[4:7], s3 offen sc1
 s_add_u32 s3, s55, 43520
 buffer_store_dword v73, v4, s[4:7], s3 offen sc1
 s_add_u32 s3, s55, 46080
 buffer_store_dword v74, v4, s[4:7], s3 offen sc1
 s_add_u32 s3, s55, 48640
 buffer_store_dword v75, v4, s[4:7], s3 offen sc1
 s_add_u32 s3, s55, 61440
 buffer_store_dword v76, v4, s[4:7], s3 offen sc1
 s_add_u32 s3, s55, 64000
 buffer_store_dword v77, v4, s[4:7], s3 offen sc1
 s_add_u32 s3, s55, 66560
 buffer_store_dword v78, v4, s[4:7], s3 offen sc1
 s_add_u32 s3, s55, 69120
 buffer_store_dword v79, v4, s[4:7], s3 offen sc1
L_wo_mid:
 s_add_u32 s62, s54, 1
 s_cmp_lt_u32 s62, 64
 s_cselect_b32 s3, 4, 0
 v_writelane_b32 v6, s3, 0
 s_cmp_ge_u32 s62, 8
 s_cselect_b32 s3, 4, 0
 v_writelane_b32 v6, s3, 1
 s_lshl_b32 s55, s62, 2
 s_cmp_lg_u32 s50, 0
 s_cselect_b32 s3, 268435456, s55
 v_mov_b32 v9, 0
 s_mov_b64 exec, 3
 buffer_atomic_add v9, v5, s[4:7], s3 offen sc0
 s_mov_b64 exec, -1
 s_waitcnt vmcnt(17)
 s_barrier
 s_mov_b32 s60, s61
 ds_read_b128 v[32:35], v7 offset:32768
 ds_read_b128 v[36:39], v7 offset:33792
 ds_read_b128 v[40:43], v7 offset:34816
 ds_read_b128 v[44:47], v7 offset:35840
 s_waitcnt lgkmcnt(3)
 v_mfma_f32_32x32x16_bf16 v[80:95], v[32:35], a[0:3], 0
 ds_read_b128 v[48:51], v7 offset:36864
 s_waitcnt lgkmcnt(3)
 v_mfma_f32_32x32x16_bf16 v[80:95], v[36:39], a[4:7], v[80:95]
 ds_read_b128 v[52:55], v7 offset:37888
 s_waitcnt lgkmcnt(3)
 v_mfma_f32_32x32x16_bf16 v[80:95], v[40:43], a[8:11], v[80:95]
 ds_read_b128 v[56:59], v7 offset:38912
 s_waitcnt lgkmcnt(3)
 v_mfma_f32_32x32x16_bf16 v[80:95], v[44:47], a[12:15], v[80:95]
 ds_read_b128 v[60:63], v7 offset:39936
 s_waitcnt lgkmcnt(3)
 v_mfma_f32_32x32x16_bf16 v[80:95], v[48:51], a[16:19], v[80:95]
 ds_read_b128 v[32:35], v7 offset:40960
 s_waitcnt lgkmcnt(3)
 v_mfma_f32_32x32x16_bf16 v[80:95], v[52:55], a[20:23], v[80:95]
 ds_read_b128 v[36:39], v7 offset:41984
 s_waitcnt lgkmcnt(3)
 v_mfma_f32_32x32x16_bf16 v[80:95], v[56:59], a[24:27], v[80:95]
 ds_read_b128 v[40:43], v7 offset:43008
 s_waitcnt lgkmcnt(3)
 v_mfma_f32_32x32x16_bf16 v[80:95], v[60:63], a[28:31], v[80:95]
 ds_read_b128 v[44:47], v7 offset:44032
 s_waitcnt lgkmcnt(3)
 v_mfma_f32_32x32x16_bf16 v[80:95], v[32:35], a[32:35], v[80:95]
 ds_read_b128 v[48:51], v7 offset:45056
 s_waitcnt lgkmcnt(3)
 v_mfma_f32_32x32x16_bf16 v[80:95], v[36:39], a[36:39], v[80:95]
 ds_read_b128 v[52:55], v7 offset:46080
 s_waitcnt lgkmcnt(3)
 v_mfma_f32_32x32x16_bf16 v[80:95], v[40:43], a[40:43], v[80:95]
 ds_read_b128 v[56:59], v7 offset:47104
 s_waitcnt lgkmcnt(3)
 v_mfma_f32_32x32x16_bf16 v[80:95], v[44:47], a[44:47], v[80:95]
 ds_read_b128 v[60:63], v7 offset:48128
 s_waitcnt lgkmcnt(3)
 v_mfma_f32_32x32x16_bf16 v[80:95], v[48:51], a[48:51], v[80:95]
 ds_read_b128 v[32:35], v7 offset:49152
 s_waitcnt lgkmcnt(3)
 v_mfma_f32_32x32x16_bf16 v[80:95], v[52:55], a[52:55], v[80:95]
 ds_read_b128 v[36:39], v7 offset:50176
 s_waitcnt lgkmcnt(3)
 v_mfma_f32_32x32x16_bf16 v[80:95], v[56:59], a[56:59], v[80:95]
 ds_read_b128 v[40:43], v7 offset:51200
 s_waitcnt lgkmcnt(3)
 v_mfma_f32_32x32x16_bf16 v[80:95], v[60:63], a[60:63], v[80:95]
 ds_read_b128 v[44:47], v7 offset:52224
 s_waitcnt vmcnt(0)
 s_cmp_lg_u32 s50, 0
 s_cbranch_scc1 L_hs_133
 v_cmp_gt_u32 vcc, v6, v9
 s_nop 1
 v_mov_b32 v3, vcc_lo
 ds_write_b32 v10, v3
 s_waitcnt lgkmcnt(0)
L_hs_133:
 s_barrier
 ds_read_b32 v9, v10
 s_cmp_lg_u32 s50, 1
 s_cbranch_scc1 L_sg_134
 s_cmp_ge_u32 s54, 64
 s_cbranch_scc1 L_sg_134
 s_lshl_b32 s3, s54, 2
 s_add_u32 s3, s3, 61440
 v_mov_b32 v3, 1
 s_mov_b32 exec_hi, 0
 buffer_atomic_add v3, v8, s[4:7], s3 offen
 s_mov_b64 exec, -1
L_sg_134:
 s_waitcnt lgkmcnt(0)
 v_readfirstlane_b32 s3, v9
 s_nop 3
 s_cmp_eq_u32 s3, 0
 s_cselect_b32 s62, s62, 64
 s_lshl_b32 s3, s52, 16
 s_add_u32 s3, s3, s56
 s_add_u32 s3, s3, 75497472
 s_lshl_b32 s55, s62, 19
 s_add_u32 s55, s55, s3
 s_cmp_lt_u32 s62, 64
 s_cselect_b32 s55, s55, 268435456
 s_waitcnt lgkmcnt(3)
 v_mfma_f32_32x32x16_bf16 v[80:95], v[32:35], a[64:67], v[80:95]
 ds_read_b128 v[48:51], v7 offset:53248
 s_add_u32 m0, s56, 0
 s_add_u32 s3, s55, s64
 buffer_load_dwordx4 v7, s[4:7], s3 offen offset:0 sc1 lds
 s_waitcnt lgkmcnt(3)
 v_mfma_f32_32x32x16_bf16 v[80:95], v[36:39], a[68:71], v[80:95]
 ds_read_b128 v[52:55], v7 offset:54272
 s_waitcnt lgkmcnt(3)
 v_mfma_f32_32x32x16_bf16 v[80:95], v[40:43], a[72:75], v[80:95]
 ds_read_b128 v[56:59], v7 offset:55296
 s_add_u32 m0, s56, 0
 s_add_u32 s3, s55, s64
 buffer_load_dwordx4 v7, s[4:7], s3 offen offset:1024 sc1 lds
 s_waitcnt lgkmcnt(3)
 v_mfma_f32_32x32x16_bf16 v[80:95], v[44:47], a[76:79], v[80:95]
 ds_read_b128 v[60:63], v7 offset:56320
 s_waitcnt lgkmcnt(3)
 v_mfma_f32_32x32x16_bf16 v[80:95], v[48:51], a[80:83], v[80:95]
 ds_read_b128 v[32:35], v7 offset:57344
 s_add_u32 m0, s56, 8192
 s_add_u32 s3, s55, s65
 buffer_load_dwordx4 v7, s[4:7], s3 offen offset:0 sc1 lds
 s_waitcnt lgkmcnt(3)
 v_mfma_f32_32x32x16_bf16 v[80:95], v[52:55], a[84:87], v[80:95]
 ds_read_b128 v[36:39], v7 offset:58368
 s_waitcnt lgkmcnt(3)
 v_mfma_f32_32x32x16_bf16 v[80:95], v[56:59], a[88:91], v[80:95]
 ds_read_b128 v[40:43], v7 offset:59392
 s_add_u32 m0, s56, 8192
 s_add_u32 s3, s55, s65
 buffer_load_dwordx4 v7, s[4:7], s3 offen offset:1024 sc1 lds
 s_waitcnt lgkmcnt(3)
 v_mfma_f32_32x32x16_bf16 v[80:95], v[60:63], a[92:95], v[80:95]
 ds_read_b128 v[44:47], v7 offset:60416
 s_waitcnt lgkmcnt(3)
 v_mfma_f32_32x32x16_bf16 v[80:95], v[32:35], a[96:99], v[80:95]
 ds_read_b128 v[48:51], v7 offset:61440
 s_add_u32 m0, s56, 16384
 s_add_u32 s3, s55, s66
 buffer_load_dwordx4 v7, s[4:7], s3 offen offset:0 sc1 lds
 s_waitcnt lgkmcnt(3)
 v_mfma_f32_32x32x16_bf16 v[80:95], v[36:39], a[100:103], v[80:95]
 ds_read_b128 v[52:55], v7 offset:62464
 s_waitcnt lgkmcnt(3)
 v_mfma_f32_32x32x16_bf16 v[80:95], v[40:43], a[104:107], v[80:95]
 ds_read_b128 v[56:59], v7 offset:63488
 s_add_u32 m0, s56, 16384
 s_add_u32 s3, s55, s66
 buffer_load_dwordx4 v7, s[4:7], s3 offen offset:1024 sc1 lds
 s_waitcnt lgkmcnt(3)
 v_mfma_f32_32x32x16_bf16 v[80:95], v[44:47], a[108:111], v[80:95]
 ds_read_b128 v[60:63], v7 offset:64512
 s_waitcnt lgkmcnt(3)
 v_mfma_f32_32x32x16_bf16 v[80:95], v[48:51], a[112:115], v[80:95]
 s_add_u32 m0, s56, 24576
 s_add_u32 s3, s55, s67
 buffer_load_dwordx4 v7, s[4:7], s3 offen offset:0 sc1 lds
 s_waitcnt lgkmcnt(2)
 v_mfma_f32_32x32x16_bf16 v[80:95], v[52:55], a[116:119], v[80:95]
 s_waitcnt lgkmcnt(1)
 v_mfma_f32_32x32x16_bf16 v[80:95], v[56:59], a[120:123], v[80:95]
 s_add_u32 m0, s56, 24576
 s_add_u32 s3, s55, s67
 buffer_load_dwordx4 v7, s[4:7], s3 offen offset:1024 sc1 lds
 s_waitcnt lgkmcnt(0)
 v_mfma_f32_32x32x16_bf16 v[80:95], v[60:63], a[124:127], v[80:95]
 s_mul_i32 s55, s60, 655360
 s_add_u32 s55, s55, s58
 s_add_u32 s55, s55, 41943040
 s_cmp_lt_u32 s60, 64
 s_cselect_b32 s55, s55, 268435456
 s_nop 7
 s_add_u32 s3, s55, 0
 buffer_store_dword v80, v4, s[4:7], s3 offen sc1
 s_add_u32 s3, s55, 2560
 buffer_store_dword v81, v4, s[4:7], s3 offen sc1
 s_add_u32 s3, s55, 5120
 buffer_store_dword v82, v4, s[4:7], s3 offen sc1
 s_add_u32 s3, s55, 7680
 buffer_store_dword v83, v4, s[4:7], s3 offen sc1
 s_add_u32 s3, s55, 20480
 buffer_store_dword v84, v4, s[4:7], s3 offen sc1
 s_add_u32 s3, s55, 23040
 buffer_store_dword v85, v4, s[4:7], s3 offen sc1
 s_add_u32 s3, s55, 25600
 buffer_store_dword v86, v4, s[4:7], s3 offen sc1
 s_add_u32 s3, s55, 28160
 buffer_store_dword v87, v4, s[4:7], s3 offen sc1
 s_add_u32 s3, s55, 40960
 buffer_store_dword v88, v4, s[4:7], s3 offen sc1
 s_add_u32 s3, s55, 43520
 buffer_store_dword v89, v4, s[4:7], s3 offen sc1
 s_add_u32 s3, s55, 46080
 buffer_store_dword v90, v4, s[4:7], s3 offen sc1
 s_add_u32 s3, s55, 48640
 buffer_store_dword v91, v4, s[4:7], s3 offen sc1
 s_add_u32 s3, s55, 61440
 buffer_store_dword v92, v4, s[4:7], s3 offen sc1
 s_add_u32 s3, s55, 64000
 buffer_store_dword v93, v4, s[4:7], s3 offen sc1
 s_add_u32 s3, s55, 66560
 buffer_store_dword v94, v4, s[4:7], s3 offen sc1
 s_add_u32 s3, s55, 69120
 buffer_store_dword v95, v4, s[4:7], s3 offen sc1
 s_cmp_ge_u32 s62, 64
 s_cbranch_scc1 L_e_132
 s_mov_b32 s54, s62
 s_mov_b32 s63, s61
 s_sub_u32 s61, s54, 8
 s_mov_b32 s60, s54
 s_waitcnt vmcnt(16)
 s_barrier
 s_lshl_b32 s3, s52, 16
 s_add_u32 s3, s3, s56
 s_add_u32 s3, s3, 109051904
 s_lshl_b32 s55, s61, 19
 s_add_u32 s55, s55, s3
 s_cmp_lt_u32 s61, 64
 s_cselect_b32 s55, s55, 268435456
 ds_read_b128 v[32:35], v7 offset:0
 ds_read_b128 v[36:39], v7 offset:1024
 ds_read_b128 v[40:43], v7 offset:2048
 ds_read_b128 v[44:47], v7 offset:3072
 s_waitcnt lgkmcnt(3)
 v_mfma_f32_32x32x16_bf16 v[64:79], v[32:35], a[0:3], 0
 ds_read_b128 v[48:51], v7 offset:4096
 s_add_u32 m0, s56, 32768
 s_add_u32 s3, s55, s64
 buffer_load_dwordx4 v7, s[4:7], s3 offen offset:0 sc1 lds
 s_waitcnt lgkmcnt(3)
 v_mfma_f32_32x32x16_bf16 v[64:79], v[36:39], a[4:7], v[64:79]
 ds_read_b128 v[52:55], v7 offset:5120
 s_waitcnt lgkmcnt(3)
 v_mfma_f32_32x32x16_bf16 v[64:79], v[40:43], a[8:11], v[64:79]
 ds_read_b128 v[56:59], v7 offset:6144
 s_waitcnt lgkmcnt(3)
 v_mfma_f32_32x32x16_bf16 v[64:79], v[44:47], a[12:15], v[64:79]
 ds_read_b128 v[60:63], v7 offset:7168
 s_add_u32 m0, s56, 32768
 s_add_u32 s3, s55, s64
 buffer_load_dwordx4 v7, s[4:7], s3 offen offset:1024 sc1 lds
 s_waitcnt lgkmcnt(3)
 v_mfma_f32_32x32x16_bf16 v[64:79], v[48:51], a[16:19], v[64:79]
 ds_read_b128 v[32:35], v7 offset:8192
 s_waitcnt lgkmcnt(3)
 v_mfma_f32_32x32x16_bf16 v[64:79], v[52:55], a[20:23], v[64:79]
 ds_read_b128 v[36:39], v7 offset:9216
 s_waitcnt lgkmcnt(3)
 v_mfma_f32_32x32x16_bf16 v[64:79], v[56:59], a[24:27], v[64:79]
 ds_read_b128 v[40:43], v7 offset:10240
 s_add_u32 m0, s56, 40960
 s_add_u32 s3, s55, s65
 buffer_load_dwordx4 v7, s[4:7], s3 offen offset:0 sc1 lds
 s_waitcnt lgkmcnt(3)
 v_mfma_f32_32x32x16_bf16 v[64:79], v[60:63], a[28:31], v[64:79]
 ds_read_b128 v[44:47], v7 offset:11264
 s_waitcnt lgkmcnt(3)
 v_mfma_f32_32x32x16_bf16 v[64:79], v[32:35], a[32:35], v[64:79]
 ds_read_b128 v[48:51], v7 offset:12288
 s_waitcnt lgkmcnt(3)
 v_mfma_f32_32x32x16_bf16 v[64:79], v[36:39], a[36:39], v[64:79]
 ds_read_b128 v[52:55], v7 offset:13312
 s_add_u32 m0, s56, 40960
 s_add_u32 s3, s55, s65
 buffer_load_dwordx4 v7, s[4:7], s3 offen offset:1024 sc1 lds
 s_waitcnt lgkmcnt(3)
 v_mfma_f32_32x32x16_bf16 v[64:79], v[40:43], a[40:43], v[64:79]
 ds_read_b128 v[56:59], v7 offset:14336
 s_waitcnt lgkmcnt(3)
 v_mfma_f32_32x32x16_bf16 v[64:79], v[44:47], a[44:47], v[64:79]
 ds_read_b128 v[60:63], v7 offset:15360
 s_waitcnt lgkmcnt(3)
 v_mfma_f32_32x32x16_bf16 v[64:79], v[48:51], a[48:51], v[64:79]
 ds_read_b128 v[32:35], v7 offset:16384
 s_add_u32 m0, s56, 49152
 s_add_u32 s3, s55, s66
 buffer_load_dwordx4 v7, s[4:7], s3 offen offset:0 sc1 lds
 s_waitcnt lgkmcnt(3)
 v_mfma_f32_32x32x16_bf16 v[64:79], v[52:55], a[52:55], v[64:79]
 ds_read_b128 v[36:39], v7 offset:17408
 s_waitcnt lgkmcnt(3)
 v_mfma_f32_32x32x16_bf16 v[64:79], v[56:59], a[56:59], v[64:79]
 ds_read_b128 v[40:43], v7 offset:18432
 s_waitcnt lgkmcnt(3)
 v_mfma_f32_32x32x16_bf16 v[64:79], v[60:63], a[60:63], v[64:79]
 ds_read_b128 v[44:47], v7 offset:19456
 s_add_u32 m0, s56, 49152
 s_add_u32 s3, s55, s66
 buffer_load_dwordx4 v7, s[4:7], s3 offen offset:1024 sc1 lds
 s_waitcnt vmcnt(6)
 s_barrier
 s_cmp_lg_u32 s50, 1
 s_cbranch_scc1 L_sg_135
 s_cmp_ge_u32 s63, 64
 s_cbranch_scc1 L_sg_135
 s_lshl_b32 s3, s63, 2
 s_add_u32 s3, s3, 61696
 v_mov_b32 v3, 1
 s_mov_b32 exec_hi, 0
 buffer_atomic_add v3, v8, s[4:7], s3 offen
 s_mov_b64 exec, -1
L_sg_135:
 s_waitcnt lgkmcnt(3)
 v_mfma_f32_32x32x16_bf16 v[64:79], v[32:35], a[64:67], v[64:79]
 ds_read_b128 v[48:51], v7 offset:20480
 s_waitcnt lgkmcnt(3)
 v_mfma_f32_32x32x16_bf16 v[64:79], v[36:39], a[68:71], v[64:79]
 ds_read_b128 v[52:55], v7 offset:21504
 s_waitcnt lgkmcnt(3)
 v_mfma_f32_32x32x16_bf16 v[64:79], v[40:43], a[72:75], v[64:79]
 ds_read_b128 v[56:59], v7 offset:22528
 s_add_u32 m0, s56, 57344
 s_add_u32 s3, s55, s67
 buffer_load_dwordx4 v7, s[4:7], s3 offen offset:0 sc1 lds
 s_waitcnt lgkmcnt(3)
 v_mfma_f32_32x32x16_bf16 v[64:79], v[44:47], a[76:79], v[64:79]
 ds_read_b128 v[60:63], v7 offset:23552
 s_waitcnt lgkmcnt(3)
 v_mfma_f32_32x32x16_bf16 v[64:79], v[48:51], a[80:83], v[64:79]
 ds_read_b128 v[32:35], v7 offset:24576
 s_waitcnt lgkmcnt(3)
 v_mfma_f32_32x32x16_bf16 v[64:79], v[52:55], a[84:87], v[64:79]
 ds_read_b128 v[36:39], v7 offset:25600
 s_add_u32 m0, s56, 57344
 s_add_u32 s3, s55, s67
 buffer_load_dwordx4 v7, s[4:7], s3 offen offset:1024 sc1 lds
 s_waitcnt lgkmcnt(3)
 v_mfma_f32_32x32x16_bf16 v[64:79], v[56:59], a[88:91], v[64:79]
 ds_read_b128 v[40:43], v7 offset:26624
 s_waitcnt lgkmcnt(3)
 v_mfma_f32_32x32x16_bf16 v[64:79], v[60:63], a[92:95], v[64:79]
 ds_read_b128 v[44:47], v7 offset:27648
 s_waitcnt lgkmcnt(3)
 v_mfma_f32_32x32x16_bf16 v[64:79], v[32:35], a[96:99], v[64:79]
 ds_read_b128 v[48:51], v7 offset:28672
 s_waitcnt lgkmcnt(3)
 v_mfma_f32_32x32x16_bf16 v[64:79], v[36:39], a[100:103], v[64:79]
 ds_read_b128 v[52:55], v7 offset:29696
 s_waitcnt lgkmcnt(3)
 v_mfma_f32_32x32x16_bf16 v[64:79], v[40:43], a[104:107], v[64:79]
 ds_read_b128 v[56:59], v7 offset:30720
 s_waitcnt lgkmcnt(3)
 v_mfma_f32_32x32x16_bf16 v[64:79], v[44:47], a[108:111], v[64:79]
 ds_read_b128 v[60:63], v7 offset:31744
 s_waitcnt lgkmcnt(3)
 v_mfma_f32_32x32x16_bf16 v[64:79], v[48:51], a[112:115], v[64:79]
 s_waitcnt lgkmcnt(2)
 v_mfma_f32_32x32x16_bf16 v[64:79], v[52:55], a[116:119], v[64:79]
 s_waitcnt lgkmcnt(1)
 v_mfma_f32_32x32x16_bf16 v[64:79], v[56:59], a[120:123], v[64:79]
 s_waitcnt lgkmcnt(0)
 v_mfma_f32_32x32x16_bf16 v[64:79], v[60:63], a[124:127], v[64:79]
 s_mul_i32 s55, s60, 655360
 s_add_u32 s55, s55, s58
 s_cmp_lt_u32 s60, 64
 s_cselect_b32 s55, s55, 268435456
 s_nop 7
 s_add_u32 s3, s55, 0
 buffer_store_dword v64, v4, s[4:7], s3 offen sc1
 s_add_u32 s3, s55, 2560
 buffer_store_dword v65, v4, s[4:7], s3 offen sc1
 s_add_u32 s3, s55, 5120
 buffer_store_dword v66, v4, s[4:7], s3 offen sc1
 s_add_u32 s3, s55, 7680
 buffer_store_dword v67, v4, s[4:7], s3 offen sc1
 s_add_u32 s3, s55, 20480
 buffer_store_dword v68, v4, s[4:7], s3 offen sc1
 s_add_u32 s3, s55, 23040
 buffer_store_dword v69, v4, s[4:7], s3 offen sc1
 s_add_u32 s3, s55, 25600
 buffer_store_dword v70, v4, s[4:7], s3 offen sc1
 s_add_u32 s3, s55, 28160
 buffer_store_dword v71, v4, s[4:7], s3 offen sc1
 s_add_u32 s3, s55, 40960
 buffer_store_dword v72, v4, s[4:7], s3 offen sc1
 s_add_u32 s3, s55, 43520
 buffer_store_dword v73, v4, s[4:7], s3 offen sc1
 s_add_u32 s3, s55, 46080
 buffer_store_dword v74, v4, s[4:7], s3 offen sc1
 s_add_u32 s3, s55, 48640
 buffer_store_dword v75, v4, s[4:7], s3 offen sc1
 s_add_u32 s3, s55, 61440
 buffer_store_dword v76, v4, s[4:7], s3 offen sc1
 s_add_u32 s3, s55, 64000
 buffer_store_dword v77, v4, s[4:7], s3 offen sc1
 s_add_u32 s3, s55, 66560
 buffer_store_dword v78, v4, s[4:7], s3 offen sc1
 s_add_u32 s3, s55, 69120
 buffer_store_dword v79, v4, s[4:7], s3 offen sc1
 s_branch L_wo_mid
L_tail_131:
 s_lshl_b32 s3, s52, 16
 s_add_u32 s3, s3, s56
 s_add_u32 s3, s3, 109051904
 s_lshl_b32 s55, s61, 19
 s_add_u32 s55, s55, s3
 s_cmp_lt_u32 s61, 64
 s_cselect_b32 s55, s55, 268435456
 s_add_u32 m0, s56, 32768
 s_add_u32 s3, s55, s64
 buffer_load_dwordx4 v7, s[4:7], s3 offen offset:0 sc1 lds
 s_add_u32 m0, s56, 32768
 s_add_u32 s3, s55, s64
 buffer_load_dwordx4 v7, s[4:7], s3 offen offset:1024 sc1 lds
 s_add_u32 m0, s56, 40960
 s_add_u32 s3, s55, s65
 buffer_load_dwordx4 v7, s[4:7], s3 offen offset:0 sc1 lds
 s_add_u32 m0, s56, 40960
 s_add_u32 s3, s55, s65
 buffer_load_dwordx4 v7, s[4:7], s3 offen offset:1024 sc1 lds
 s_add_u32 m0, s56, 49152
 s_add_u32 s3, s55, s66
 buffer_load_dwordx4 v7, s[4:7], s3 offen offset:0 sc1 lds
 s_add_u32 m0, s56, 49152
 s_add_u32 s3, s55, s66
 buffer_load_dwordx4 v7, s[4:7], s3 offen offset:1024 sc1 lds
 s_add_u32 m0, s56, 57344
 s_add_u32 s3, s55, s67
 buffer_load_dwordx4 v7, s[4:7], s3 offen offset:0 sc1 lds
 s_add_u32 m0, s56, 57344
 s_add_u32 s3, s55, s67
 buffer_load_dwordx4 v7, s[4:7], s3 offen offset:1024 sc1 lds
 s_mov_b32 s60, s61
 s_waitcnt vmcnt(6)
 s_barrier
 ds_read_b128 v[32:35], v7 offset:32768
 ds_read_b128 v[36:39], v7 offset:33792
 ds_read_b128 v[40:43], v7 offset:34816
 ds_read_b128 v[44:47], v7 offset:35840
 s_waitcnt lgkmcnt(3)
 v_mfma_f32_32x32x16_bf16 v[80:95], v[32:35], a[0:3], 0
 ds_read_b128 v[48:51], v7 offset:36864
 s_waitcnt lgkmcnt(3)
 v_mfma_f32_32x32x16_bf16 v[80:95], v[36:39], a[4:7], v[80:95]
 ds_read_b128 v[52:55], v7 offset:37888
 s_waitcnt lgkmcnt(3)
 v_mfma_f32_32x32x16_bf16 v[80:95], v[40:43], a[8:11], v[80:95]
 ds_read_b128 v[56:59], v7 offset:38912
 s_waitcnt lgkmcnt(3)
 v_mfma_f32_32x32x16_bf16 v[80:95], v[44:47], a[12:15], v[80:95]
 ds_read_b128 v[60:63], v7 offset:39936
 s_waitcnt lgkmcnt(3)
 v_mfma_f32_32x32x16_bf16 v[80:95], v[48:51], a[16:19], v[80:95]
 s_waitcnt vmcnt(4)
 s_barrier
 ds_read_b128 v[32:35], v7 offset:40960
 s_waitcnt lgkmcnt(3)
 v_mfma_f32_32x32x16_bf16 v[80:95], v[52:55], a[20:23], v[80:95]
 ds_read_b128 v[36:39], v7 offset:41984
 s_waitcnt lgkmcnt(3)
 v_mfma_f32_32x32x16_bf16 v[80:95], v[56:59], a[24:27], v[80:95]
 ds_read_b128 v[40:43], v7 offset:43008
 s_waitcnt lgkmcnt(3)
 v_mfma_f32_32x32x16_bf16 v[80:95], v[60:63], a[28:31], v[80:95]
 ds_read_b128 v[44:47], v7 offset:44032
 s_waitcnt lgkmcnt(3)
 v_mfma_f32_32x32x16_bf16 v[80:95], v[32:35], a[32:35], v[80:95]
 ds_read_b128 v[48:51], v7 offset:45056
 s_waitcnt lgkmcnt(3)
 v_mfma_f32_32x32x16_bf16 v[80:95], v[36:39], a[36:39], v[80:95]
 ds_read_b128 v[52:55], v7 offset:46080
 s_waitcnt lgkmcnt(3)
 v_mfma_f32_32x32x16_bf16 v[80:95], v[40:43], a[40:43], v[80:95]
 ds_read_b128 v[56:59], v7 offset:47104
 s_waitcnt lgkmcnt(3)
 v_mfma_f32_32x32x16_bf16 v[80:95], v[44:47], a[44:47], v[80:95]
 ds_read_b128 v[60:63], v7 offset:48128
 s_waitcnt lgkmcnt(3)
 v_mfma_f32_32x32x16_bf16 v[80:95], v[48:51], a[48:51], v[80:95]
 s_waitcnt vmcnt(2)
 s_barrier
 ds_read_b128 v[32:35], v7 offset:49152
 s_waitcnt lgkmcnt(3)
 v_mfma_f32_32x32x16_bf16 v[80:95], v[52:55], a[52:55], v[80:95]
 ds_read_b128 v[36:39], v7 offset:50176
 s_waitcnt lgkmcnt(3)
 v_mfma_f32_32x32x16_bf16 v[80:95], v[56:59], a[56:59], v[80:95]
 ds_read_b128 v[40:43], v7 offset:51200
 s_waitcnt lgkmcnt(3)
 v_mfma_f32_32x32x16_bf16 v[80:95], v[60:63], a[60:63], v[80:95]
 ds_read_b128 v[44:47], v7 offset:52224
 s_waitcnt lgkmcnt(3)
 v_mfma_f32_32x32x16_bf16 v[80:95], v[32:35], a[64:67], v[80:95]
 ds_read_b128 v[48:51], v7 offset:53248
 s_waitcnt lgkmcnt(3)
 v_mfma_f32_32x32x16_bf16 v[80:95], v[36:39], a[68:71], v[80:95]
 ds_read_b128 v[52:55], v7 offset:54272
 s_waitcnt lgkmcnt(3)
 v_mfma_f32_32x32x16_bf16 v[80:95], v[40:43], a[72:75], v[80:95]
 ds_read_b128 v[56:59], v7 offset:55296
 s_waitcnt lgkmcnt(3)
 v_mfma_f32_32x32x16_bf16 v[80:95], v[44:47], a[76:79], v[80:95]
 ds_read_b128 v[60:63], v7 offset:56320
 s_waitcnt lgkmcnt(3)
 v_mfma_f32_32x32x16_bf16 v[80:95], v[48:51], a[80:83], v[80:95]
 s_waitcnt vmcnt(0)
 s_barrier
 ds_read_b128 v[32:35], v7 offset:57344
 s_waitcnt lgkmcnt(3)
 v_mfma_f32_32x32x16_bf16 v[80:95], v[52:55], a[84:87], v[80:95]
 ds_read_b128 v[36:39], v7 offset:58368
 s_waitcnt lgkmcnt(3)
 v_mfma_f32_32x32x16_bf16 v[80:95], v[56:59], a[88:91], v[80:95]
 ds_read_b128 v[40:43], v7 offset:59392
 s_waitcnt lgkmcnt(3)
 v_mfma_f32_32x32x16_bf16 v[80:95], v[60:63], a[92:95], v[80:95]
 ds_read_b128 v[44:47], v7 offset:60416
 s_waitcnt lgkmcnt(3)
 v_mfma_f32_32x32x16_bf16 v[80:95], v[32:35], a[96:99], v[80:95]
 ds_read_b128 v[48:51], v7 offset:61440
 s_waitcnt lgkmcnt(3)
 v_mfma_f32_32x32x16_bf16 v[80:95], v[36:39], a[100:103], v[80:95]
 ds_read_b128 v[52:55], v7 offset:62464
 s_waitcnt lgkmcnt(3)
 v_mfma_f32_32x32x16_bf16 v[80:95], v[40:43], a[104:107], v[80:95]
 ds_read_b128 v[56:59], v7 offset:63488
 s_waitcnt lgkmcnt(3)
 v_mfma_f32_32x32x16_bf16 v[80:95], v[44:47], a[108:111], v[80:95]
 ds_read_b128 v[60:63], v7 offset:64512
 s_waitcnt lgkmcnt(3)
 v_mfma_f32_32x32x16_bf16 v[80:95], v[48:51], a[112:115], v[80:95]
 s_waitcnt lgkmcnt(2)
 v_mfma_f32_32x32x16_bf16 v[80:95], v[52:55], a[116:119], v[80:95]
 s_waitcnt lgkmcnt(1)
 v_mfma_f32_32x32x16_bf16 v[80:95], v[56:59], a[120:123], v[80:95]
 s_waitcnt lgkmcnt(0)
 v_mfma_f32_32x32x16_bf16 v[80:95], v[60:63], a[124:127], v[80:95]
 s_mul_i32 s55, s60, 655360
 s_add_u32 s55, s55, s58
 s_add_u32 s55, s55, 41943040
 s_cmp_lt_u32 s60, 64
 s_cselect_b32 s55, s55, 268435456
 s_nop 7
 s_add_u32 s3, s55, 0
 buffer_store_dword v80, v4, s[4:7], s3 offen sc1
 s_add_u32 s3, s55, 2560
 buffer_store_dword v81, v4, s[4:7], s3 offen sc1
 s_add_u32 s3, s55, 5120
 buffer_store_dword v82, v4, s[4:7], s3 offen sc1
 s_add_u32 s3, s55, 7680
 buffer_store_dword v83, v4, s[4:7], s3 offen sc1
 s_add_u32 s3, s55, 20480
 buffer_store_dword v84, v4, s[4:7], s3 offen sc1
 s_add_u32 s3, s55, 23040
 buffer_store_dword v85, v4, s[4:7], s3 offen sc1
 s_add_u32 s3, s55, 25600
 buffer_store_dword v86, v4, s[4:7], s3 offen sc1
 s_add_u32 s3, s55, 28160
 buffer_store_dword v87, v4, s[4:7], s3 offen sc1
 s_add_u32 s3, s55, 40960
 buffer_store_dword v88, v4, s[4:7], s3 offen sc1
 s_add_u32 s3, s55, 43520
 buffer_store_dword v89, v4, s[4:7], s3 offen sc1
 s_add_u32 s3, s55, 46080
 buffer_store_dword v90, v4, s[4:7], s3 offen sc1
 s_add_u32 s3, s55, 48640
 buffer_store_dword v91, v4, s[4:7], s3 offen sc1
 s_add_u32 s3, s55, 61440
 buffer_store_dword v92, v4, s[4:7], s3 offen sc1
 s_add_u32 s3, s55, 64000
 buffer_store_dword v93, v4, s[4:7], s3 offen sc1
 s_add_u32 s3, s55, 66560
 buffer_store_dword v94, v4, s[4:7], s3 offen sc1
 s_add_u32 s3, s55, 69120
 buffer_store_dword v95, v4, s[4:7], s3 offen sc1
L_e_132:
 s_add_u32 s54, s54, 1
 s_branch L_wo_loop
L_t4:
 s_lshr_b32 s53, s50, 1
 s_and_b32 s54, s50, 1
 v_lshlrev_b32 v1, 4, v0
 v_mov_b32 v72, 0
 s_lshl_b32 s3, s50, 2
 s_add_u32 s3, s3, 163776
 v_mov_b32 v73, s3
 ds_write_b32 v73, v72
 s_cmp_lg_u32 s50, 0
 s_cbranch_scc1 L_ww_136
 s_mov_b32 s96, s44
 s_and_b32 s97, s45, 0xffff
 s_mov_b32 s98, 256
 s_mov_b32 s99, 0x00020000
 v_mov_b32 v12, 136
 s_mov_b32 s51, 0
 s_mov_b64 exec, 1
L_wb_137:
 buffer_load_dword v13, v12, s[96:99], 0 offen sc1
 s_waitcnt vmcnt(0)
 v_cmp_eq_u32 vcc, 0, v13
 s_cbranch_vccz L_wbd_138
 s_sleep 2
 s_add_u32 s51, s51, 1
 s_cmp_lt_u32 s51, 131072
 s_cbranch_scc1 L_wb_137
 s_branch L_bail
L_wbd_138:
 s_mov_b64 exec, -1
L_ww_136:
 s_barrier
 s_mul_i32 s55, s52, 40960
 s_mul_i32 s56, s50, 10240
 s_add_u32 s55, s55, s56
 s_add_u32 s55, s55, 234356736
 s_add_u32 m0, s56, 0
 s_add_u32 s3, s55, 0
 buffer_load_dwordx4 v1, s[4:7], s3 offen offset:0 sc1 lds
 buffer_load_dwordx4 v1, s[4:7], s3 offen offset:1024 sc1 lds
 s_add_u32 m0, s56, 2048
 s_add_u32 s3, s55, 2048
 buffer_load_dwordx4 v1, s[4:7], s3 offen offset:0 sc1 lds
 buffer_load_dwordx4 v1, s[4:7], s3 offen offset:1024 sc1 lds
 s_add_u32 m0, s56, 4096
 s_add_u32 s3, s55, 4096
 buffer_load_dwordx4 v1, s[4:7], s3 offen offset:0 sc1 lds
 buffer_load_dwordx4 v1, s[4:7], s3 offen offset:1024 sc1 lds
 s_add_u32 m0, s56, 6144
 s_add_u32 s3, s55, 6144
 buffer_load_dwordx4 v1, s[4:7], s3 offen offset:0 sc1 lds
 buffer_load_dwordx4 v1, s[4:7], s3 offen offset:1024 sc1 lds
 s_add_u32 m0, s56, 8192
 s_add_u32 s3, s55, 8192
 buffer_load_dwordx4 v1, s[4:7], s3 offen offset:0 sc1 lds
 buffer_load_dwordx4 v1, s[4:7], s3 offen offset:1024 sc1 lds
 s_waitcnt vmcnt(0) lgkmcnt(0)
 s_barrier
 s_cmp_eq_u32 s53, 0
 s_cbranch_scc1 L_e0_139
 s_lshl_b32 s60, s52, 1
 s_and_b32 s3, s50, 1
 s_add_u32 s60, s60, s3
 s_mul_i32 s71, s3, 13312
 s_add_u32 s71, s71, 131072
 s_add_u32 s72, s60, 1024
 s_mov_b32 s8, s16
 s_and_b32 s9, s17, 0xffff
 s_mov_b32 s10, 2621440
 s_mov_b32 s11, 0x00020000
 v_lshlrev_b32 v1, 4, v0
 v_lshlrev_b32 v2, 3, v0
 v_cmp_lt_u32 vcc, 31, v0
 v_mov_b32 v3, 268435456
 s_nop 1
 v_cndmask_b32 v7, v2, v3, vcc
 s_mov_b32 s63, 0x3acccccd
 s_mov_b32 s68, 0x3727c5ac
 s_add_u32 s3, s72, 0
 s_mul_i32 s3, s3, 1280
 buffer_load_dwordx2 v[48:49], v2, s[8:11], s3 offen offset:0
 buffer_load_dwordx2 v[50:51], v2, s[8:11], s3 offen offset:512
 buffer_load_dwordx2 v[52:53], v7, s[8:11], s3 offen offset:1024
 s_waitcnt vmcnt(0)
L_ln_140:
 v_lshlrev_b32 v12, 16, v48
 v_and_b32 v13, 0xffff0000, v48
 v_lshlrev_b32 v14, 16, v49
 v_and_b32 v15, 0xffff0000, v49
 v_lshlrev_b32 v16, 16, v50
 v_and_b32 v17, 0xffff0000, v50
 v_lshlrev_b32 v18, 16, v51
 v_and_b32 v19, 0xffff0000, v51
 v_lshlrev_b32 v20, 16, v52
 v_and_b32 v21, 0xffff0000, v52
 v_lshlrev_b32 v22, 16, v53
 v_and_b32 v23, 0xffff0000, v53
 s_add_u32 s3, s72, 64
 s_mul_i32 s3, s3, 1280
 buffer_load_dwordx2 v[48:49], v2, s[8:11], s3 offen offset:0
 buffer_load_dwordx2 v[50:51], v2, s[8:11], s3 offen offset:512
 buffer_load_dwordx2 v[52:53], v7, s[8:11], s3 offen offset:1024
 s_and_b32 s3, s72, 15
 v_lshrrev_b32 v4, 3, v0
 v_lshlrev_b32 v4, 2, v4
 v_and_b32 v9, 3, v0
 v_add_u32 v4, v4, v9
 v_xor_b32 v4, s3, v4
 v_lshlrev_b32 v4, 4, v4
 v_and_b32 v9, 4, v0
 v_lshl_add_u32 v4, v9, 1, v4
 v_cndmask_b32 v8, v4, v3, vcc
 v_readfirstlane_b32 s3, v12
 s_nop 1
 v_subrev_f32 v36, s3, v12
 v_subrev_f32 v37, s3, v13
 v_subrev_f32 v38, s3, v14
 v_subrev_f32 v39, s3, v15
 v_subrev_f32 v40, s3, v16
 v_subrev_f32 v41, s3, v17
 v_subrev_f32 v42, s3, v18
 v_subrev_f32 v43, s3, v19
 v_mov_b32 v44, 0
 v_mov_b32 v45, 0
 v_mov_b32 v46, 0
 v_mov_b32 v47, 0
 s_mov_b32 exec_hi, 0
 v_subrev_f32 v44, s3, v20
 v_subrev_f32 v45, s3, v21
 v_subrev_f32 v46, s3, v22
 v_subrev_f32 v47, s3, v23
 s_mov_b32 exec_hi, -1
 v_pk_mul_f32 v[10:11], v[36:37], v[36:37]
 v_pk_fma_f32 v[10:11], v[38:39], v[38:39], v[10:11]
 v_pk_fma_f32 v[10:11], v[40:41], v[40:41], v[10:11]
 v_pk_fma_f32 v[10:11], v[42:43], v[42:43], v[10:11]
 v_pk_fma_f32 v[10:11], v[44:45], v[44:45], v[10:11]
 v_pk_fma_f32 v[10:11], v[46:47], v[46:47], v[10:11]
 v_pk_add_f32 v[36:37], v[36:37], v[38:39]
 v_pk_add_f32 v[36:37], v[36:37], v[40:41]
 v_pk_add_f32 v[36:37], v[36:37], v[42:43]
 v_pk_add_f32 v[36:37], v[36:37], v[44:45]
 v_pk_add_f32 v[36:37], v[36:37], v[46:47]
 v_add_f32 v11, v10, v11
 v_add_f32 v10, v36, v37
 s_nop 0
 v_add_f32_dpp v11, v11, v11 quad_perm:[1,0,3,2] row_mask:0xf bank_mask:0xf
 v_add_f32_dpp v10, v10, v10 quad_perm:[1,0,3,2] row_mask:0xf bank_mask:0xf
 s_nop 0
 v_add_f32_dpp v11, v11, v11 quad_perm:[2,3,0,1] row_mask:0xf bank_mask:0xf
 v_add_f32_dpp v10, v10, v10 quad_perm:[2,3,0,1] row_mask:0xf bank_mask:0xf
 s_nop 0
 v_add_f32_dpp v11, v11, v11 row_half_mirror row_mask:0xf bank_mask:0xf
 v_add_f32_dpp v10, v10, v10 row_half_mirror row_mask:0xf bank_mask:0xf
 s_nop 0
 v_add_f32_dpp v11, v11, v11 row_mirror row_mask:0xf bank_mask:0xf
 v_add_f32_dpp v10, v10, v10 row_mirror row_mask:0xf bank_mask:0xf
 v_mov_b32 v37, v11
 v_mov_b32 v36, v10
 s_nop 0
 v_permlane16_swap_b32 v11, v37
 v_permlane16_swap_b32 v10, v36
 v_pk_add_f32 v[10:11], v[10:11], v[36:37]
 v_mov_b32 v37, v11
 v_mov_b32 v36, v10
 s_nop 0
 v_permlane32_swap_b32 v11, v37
 v_permlane32_swap_b32 v10, v36
 v_pk_add_f32 v[10:11], v[10:11], v[36:37]
 v_mul_f32 v10, s63, v10
 v_mul_f32 v11, s63, v11
 v_fma_f32 v11, -v10, v10, v11
 v_max_f32 v11, 0, v11
 v_add_f32 v10, s3, v10
 v_cvt_pk_bf16_f32 v9, v10, v11
 v_lshlrev_b32 v10, 16, v9
 v_and_b32 v11, 0xffff0000, v9
 v_add_f32 v11, s68, v11
 v_cvt_pk_bf16_f32 v11, v11, v11
 v_and_b32 v11, 0xffff0000, v11
 v_sqrt_f32 v11, v11
 s_nop 0
 v_pk_add_f32 v[36:37], v[12:13], v[10:11] op_sel_hi:[1,0] neg_lo:[0,1] neg_hi:[0,1]
 v_pk_add_f32 v[38:39], v[14:15], v[10:11] op_sel_hi:[1,0] neg_lo:[0,1] neg_hi:[0,1]
 v_pk_add_f32 v[40:41], v[16:17], v[10:11] op_sel_hi:[1,0] neg_lo:[0,1] neg_hi:[0,1]
 v_pk_add_f32 v[42:43], v[18:19], v[10:11] op_sel_hi:[1,0] neg_lo:[0,1] neg_hi:[0,1]
 v_pk_add_f32 v[44:45], v[20:21], v[10:11] op_sel_hi:[1,0] neg_lo:[0,1] neg_hi:[0,1]
 v_pk_add_f32 v[46:47], v[22:23], v[10:11] op_sel_hi:[1,0] neg_lo:[0,1] neg_hi:[0,1]
 v_cvt_pk_bf16_f32 v11, v11, v11
 v_and_b32 v11, 0xffff0000, v11
 v_rcp_f32 v11, v11
 v_cvt_pk_bf16_f32 v9, v36, v37
 v_lshlrev_b32 v36, 16, v9
 v_and_b32 v37, 0xffff0000, v9
 v_cvt_pk_bf16_f32 v9, v38, v39
 v_lshlrev_b32 v38, 16, v9
 v_and_b32 v39, 0xffff0000, v9
 v_cvt_pk_bf16_f32 v9, v40, v41
 v_lshlrev_b32 v40, 16, v9
 v_and_b32 v41, 0xffff0000, v9
 v_cvt_pk_bf16_f32 v9, v42, v43
 v_lshlrev_b32 v42, 16, v9
 v_and_b32 v43, 0xffff0000, v9
 v_cvt_pk_bf16_f32 v9, v44, v45
 v_lshlrev_b32 v44, 16, v9
 v_and_b32 v45, 0xffff0000, v9
 v_cvt_pk_bf16_f32 v9, v46, v47
 v_lshlrev_b32 v46, 16, v9
 v_and_b32 v47, 0xffff0000, v9
 v_pk_mul_f32 v[36:37], v[36:37], v[10:11] op_sel:[0,1] op_sel_hi:[1,1]
 v_pk_mul_f32 v[38:39], v[38:39], v[10:11] op_sel:[0,1] op_sel_hi:[1,1]
 v_pk_mul_f32 v[40:41], v[40:41], v[10:11] op_sel:[0,1] op_sel_hi:[1,1]
 v_pk_mul_f32 v[42:43], v[42:43], v[10:11] op_sel:[0,1] op_sel_hi:[1,1]
 v_pk_mul_f32 v[44:45], v[44:45], v[10:11] op_sel:[0,1] op_sel_hi:[1,1]
 v_pk_mul_f32 v[46:47], v[46:47], v[10:11] op_sel:[0,1] op_sel_hi:[1,1]
 v_cvt_pk_bf16_f32 v24, v36, v37
 v_cvt_pk_bf16_f32 v25, v38, v39
 v_cvt_pk_bf16_f32 v26, v40, v41
 v_cvt_pk_bf16_f32 v27, v42, v43
 v_cvt_pk_bf16_f32 v28, v44, v45
 v_cvt_pk_bf16_f32 v29, v46, v47
 s_mul_i32 s3, s72, 1280
 s_add_u32 s3, s3, 226492416
 buffer_store_dwordx2 v[24:25], v4, s[4:7], s3 offen offset:0 sc1
 buffer_store_dwordx2 v[26:27], v4, s[4:7], s3 offen offset:512 sc1
 buffer_store_dwordx2 v[28:29], v8, s[4:7], s3 offen offset:1024 sc1
 s_add_u32 s72, s72, 64
 s_waitcnt vmcnt(3)
 s_cmp_lt_u32 s72, 2048
 s_cbranch_scc1 L_ln_140
 s_waitcnt vmcnt(0)
 s_mov_b32 s96, s44
 s_and_b32 s97, s45, 0xffff
 s_mov_b32 s98, 256
 s_mov_b32 s99, 0x00020000
 v_mov_b32 v1, 1
 s_mov_b64 exec, 1
 buffer_atomic_add v1, off, s[96:99], 0 offset:12 sc0
 s_waitcnt vmcnt(0)
 v_cmp_eq_u32 vcc, 63, v1
 s_cbranch_vccz L_aw_141
 buffer_store_dword v1, off, s[96:99], 0 offset:140 sc1
L_aw_141:
 s_mov_b64 exec, -1
 s_mov_b32 s70, s60
 s_mov_b32 s69, 96
 s_mov_b32 s96, s44
 s_and_b32 s97, s45, 0xffff
 s_mov_b32 s98, 256
 s_mov_b32 s99, 0x00020000
 v_mov_b32 v1, 196
 s_mov_b32 s51, 0
 s_mov_b64 exec, 1
L_wb_142:
 buffer_load_dword v2, v1, s[96:99], 0 offen sc1
 s_waitcnt vmcnt(0)
 v_cmp_eq_u32 vcc, 0, v2
 s_cbranch_vccz L_wbd_143
 s_sleep 2
 s_add_u32 s51, s51, 1
 s_cmp_lt_u32 s51, 131072
 s_cbranch_scc1 L_wb_142
 s_branch L_bail
L_wbd_143:
 s_mov_b64 exec, -1
 s_mov_b32 s96, s44
 s_and_b32 s97, s45, 0xffff
 s_mov_b32 s98, 256
 s_mov_b32 s99, 0x00020000
 v_mov_b32 v1, 208
 s_mov_b32 s51, 0
 s_mov_b64 exec, 1
L_wb_144:
 buffer_load_dword v2, v1, s[96:99], 0 offen sc1
 s_waitcnt vmcnt(0)
 v_cmp_eq_u32 vcc, 0, v2
 s_cbranch_vccz L_wbd_145
 s_sleep 2
 s_add_u32 s51, s51, 1
 s_cmp_lt_u32 s51, 131072
 s_cbranch_scc1 L_wb_144
 s_branch L_bail
L_wbd_145:
 s_mov_b64 exec, -1
 s_mov_b32 s8, s38
 s_and_b32 s9, s39, 0xffff
 s_mov_b32 s10, 2621440
 s_mov_b32 s11, 0x00020000
 s_mov_b32 s12, s40
 s_and_b32 s13, s41, 0xffff
 s_mov_b32 s14, 1280
 s_mov_b32 s15, 0x00020000
 v_lshlrev_b32 v130, 4, v0
 s_lshl_b32 s73, s70, 12
 s_add_u32 s74, s73, 2
 buffer_load_dwordx4 v[96:99], v130, s[8:11], s73 offen offset:0
 buffer_load_dwordx4 v[100:103], v130, s[8:11], s73 offen offset:1024
 buffer_load_dwordx4 v[104:107], v130, s[8:11], s73 offen offset:2048
 buffer_load_dwordx4 v[108:111], v130, s[8:11], s73 offen offset:3072
 buffer_load_dwordx4 v[112:115], v130, s[8:11], s74 offen offset:0
 buffer_load_dwordx4 v[116:119], v130, s[8:11], s74 offen offset:1024
 buffer_load_dwordx4 v[120:123], v130, s[8:11], s74 offen offset:2048
 buffer_load_dwordx4 v[124:127], v130, s[8:11], s74 offen offset:3072
 s_lshl_b32 s3, s70, 1
 buffer_load_ushort v128, off, s[12:15], s3
 s_lshl_b32 s3, s70, 12
 s_add_u32 s3, s3, 231735296
 buffer_load_dwordx4 v[240:243], v130, s[4:7], s3 offen offset:0 sc1
 buffer_load_dwordx4 v[244:247], v130, s[4:7], s3 offen offset:1024 sc1
 buffer_load_dwordx4 v[248:251], v130, s[4:7], s3 offen offset:2048 sc1
 buffer_load_dwordx4 v[252:255], v130, s[4:7], s3 offen offset:3072 sc1
 s_getpc_b64 s[76:77]
L_ca_146:
 s_add_u32 s76, s76, L_conv1-L_ca_146
 s_addc_u32 s77, s77, -1
 s_swappc_b64 s[76:77], s[76:77]
 s_waitcnt vmcnt(0)
 s_mov_b32 s96, s44
 s_and_b32 s97, s45, 0xffff
 s_mov_b32 s98, 256
 s_mov_b32 s99, 0x00020000
 v_mov_b32 v1, 1
 s_mov_b64 exec, 1
 buffer_atomic_add v1, off, s[96:99], 0 offset:76 sc0
 s_waitcnt vmcnt(0)
 v_cmp_eq_u32 vcc, 95, v1
 s_cbranch_vccz L_aw_147
 buffer_store_dword v1, off, s[96:99], 0 offset:204 sc1
L_aw_147:
 s_mov_b64 exec, -1
 s_mov_b32 s96, s44
 s_and_b32 s97, s45, 0xffff
 s_mov_b32 s98, 256
 s_mov_b32 s99, 0x00020000
 v_mov_b32 v1, 204
 s_mov_b32 s51, 0
 s_mov_b64 exec, 1
L_wb_148:
 buffer_load_dword v2, v1, s[96:99], 0 offen sc1
 s_waitcnt vmcnt(0)
 v_cmp_eq_u32 vcc, 0, v2
 s_cbranch_vccz L_wbd_149
 s_sleep 2
 s_add_u32 s51, s51, 1
 s_cmp_lt_u32 s51, 131072
 s_cbranch_scc1 L_wb_148
 s_branch L_bail
L_wbd_149:
 s_mov_b64 exec, -1
 v_lshlrev_b32 v1, 4, v0
 s_mul_i32 s55, s52, 40960
 s_mul_i32 s56, s54, 20480
 s_add_u32 s55, s55, s56
 s_add_u32 s55, s55, 235667456
 s_add_u32 m0, s56, 40960
 s_add_u32 s3, s55, 0
 buffer_load_dwordx4 v1, s[4:7], s3 offen offset:0 sc1 lds
 buffer_load_dwordx4 v1, s[4:7], s3 offen offset:1024 sc1 lds
 s_add_u32 m0, s56, 43008
 s_add_u32 s3, s55, 2048
 buffer_load_dwordx4 v1, s[4:7], s3 offen offset:0 sc1 lds
 buffer_load_dwordx4 v1, s[4:7], s3 offen offset:1024 sc1 lds
 s_add_u32 m0, s56, 45056
 s_add_u32 s3, s55, 4096
 buffer_load_dwordx4 v1, s[4:7], s3 offen offset:0 sc1 lds
 buffer_load_dwordx4 v1, s[4:7], s3 offen offset:1024 sc1 lds
 s_add_u32 m0, s56, 47104
 s_add_u32 s3, s55, 6144
 buffer_load_dwordx4 v1, s[4:7], s3 offen offset:0 sc1 lds
 buffer_load_dwordx4 v1, s[4:7], s3 offen offset:1024 sc1 lds
 s_add_u32 m0, s56, 49152
 s_add_u32 s3, s55, 8192
 buffer_load_dwordx4 v1, s[4:7], s3 offen offset:0 sc1 lds
 buffer_load_dwordx4 v1, s[4:7], s3 offen offset:1024 sc1 lds
 s_add_u32 m0, s56, 51200
 s_add_u32 s3, s55, 10240
 buffer_load_dwordx4 v1, s[4:7], s3 offen offset:0 sc1 lds
 buffer_load_dwordx4 v1, s[4:7], s3 offen offset:1024 sc1 lds
 s_add_u32 m0, s56, 53248
 s_add_u32 s3, s55, 12288
 buffer_load_dwordx4 v1, s[4:7], s3 offen offset:0 sc1 lds
 buffer_load_dwordx4 v1, s[4:7], s3 offen offset:1024 sc1 lds
 s_add_u32 m0, s56, 55296
 s_add_u32 s3, s55, 14336
 buffer_load_dwordx4 v1, s[4:7], s3 offen offset:0 sc1 lds
 buffer_load_dwordx4 v1, s[4:7], s3 offen offset:1024 sc1 lds
 s_add_u32 m0, s56, 57344
 s_add_u32 s3, s55, 16384
 buffer_load_dwordx4 v1, s[4:7], s3 offen offset:0 sc1 lds
 buffer_load_dwordx4 v1, s[4:7], s3 offen offset:1024 sc1 lds
 s_add_u32 m0, s56, 59392
 s_add_u32 s3, s55, 18432
 buffer_load_dwordx4 v1, s[4:7], s3 offen offset:0 sc1 lds
 buffer_load_dwordx4 v1, s[4:7], s3 offen offset:1024 sc1 lds
 s_waitcnt vmcnt(0) lgkmcnt(0)
 s_lshl_b32 s3, s50, 2
 s_add_u32 s3, s3, 163776
 v_mov_b32 v73, s3
 v_mov_b32 v72, 1
 ds_write_b32 v73, v72
L_e0_139:
 s_lshl_b32 s3, s54, 2
 s_add_u32 s3, s3, 163776
 v_mov_b32 v73, s3
 s_mov_b32 s8, s16
 s_and_b32 s9, s17, 0xffff
 s_mov_b32 s10, 2621440
 s_mov_b32 s11, 0x00020000
 s_mov_b32 s12, s42
 s_and_b32 s13, s43, 0xffff
 s_mov_b32 s14, 2621440
 s_mov_b32 s15, 0x00020000
 v_lshlrev_b32 v1, 4, v0
 v_lshlrev_b32 v2, 3, v0
 v_cmp_lt_u32 vcc, 31, v0
 v_mov_b32 v3, 268435456
 s_nop 1
 v_cndmask_b32 v6, v1, v3, vcc
 v_cndmask_b32 v7, v2, v3, vcc
 s_and_b32 s3, s52, 15
 v_lshrrev_b32 v4, 3, v0
 v_lshlrev_b32 v4, 2, v4
 v_and_b32 v10, 3, v0
 v_add_u32 v4, v4, v10
 v_xor_b32 v4, s3, v4
 v_lshlrev_b32 v4, 4, v4
 v_and_b32 v10, 4, v0
 v_lshl_add_u32 v4, v10, 1, v4
 v_cndmask_b32 v8, v4, v3, vcc
 s_lshl_b32 s3, s52, 9
 s_lshl_b32 s55, s53, 8
 s_add_u32 s3, s3, s55
 s_add_u32 s3, s3, 61440
 v_mul_u32_u24 v5, 16384, v0
 v_add_u32 v5, s3, v5
 s_sub_u32 s3, s3, 4
 v_writelane_b32 v5, s3, 4
 v_lshlrev_b32 v68, 8, v0
 s_mov_b32 s57, 0x3acccccd
 s_mov_b32 s58, 0x3727c5ac
L_t4_loop:
 s_lshl_b32 s60, s54, 5
 s_add_u32 s60, s60, s52
 s_mul_i32 s60, s60, 1280
 s_cmp_eq_u32 s53, 0
 s_cselect_b32 s3, s60, 268435456
 buffer_load_dwordx2 v[48:49], v2, s[8:11], s3 offen offset:0
 buffer_load_dwordx2 v[50:51], v2, s[8:11], s3 offen offset:512
 buffer_load_dwordx2 v[52:53], v7, s[8:11], s3 offen offset:1024
 s_and_b32 s3, s54, 62
 s_cmp_lg_u32 s3, 32
 s_cbranch_scc1 L_yhd_151
 v_mov_b32 v3, 163784
 s_mov_b32 s51, 0
L_yh_150:
 ds_read_b64 v[24:25], v3
 s_waitcnt lgkmcnt(0)
 v_and_b32 v24, v24, v25
 v_cmp_eq_u32 vcc, 0, v24
 s_cbranch_vccz L_yhd_151
 s_sleep 8
 s_add_u32 s51, s51, 1
 s_cmp_lt_u32 s51, 131072
 s_cbranch_scc1 L_yh_150
 s_branch L_bail
L_yhd_151:
 s_and_b32 s3, s54, 7
 s_lshl_b32 s3, s3, 3
 s_bfe_u32 s55, s54, 0x20003
 s_lshl_b32 s55, s55, 1
 s_add_u32 s3, s3, s55
 s_lshr_b32 s55, s54, 5
 s_mul_i32 s55, s55, 40960
 s_add_u32 s3, s3, s55
 v_lshlrev_b32 v72, 8, v0
 v_add_u32 v72, s3, v72
 ds_read_u16 v24, v72 offset:0
 ds_read_u16 v25, v72 offset:64
 ds_read_u16 v26, v72 offset:128
 ds_read_u16 v27, v72 offset:192
 ds_read_u16 v28, v72 offset:16384
 ds_read_u16 v29, v72 offset:16448
 ds_read_u16 v30, v72 offset:16512
 ds_read_u16 v31, v72 offset:16576
 v_mov_b32 v32, 0
 v_mov_b32 v33, 0
 v_mov_b32 v34, 0
 v_mov_b32 v35, 0
 s_mov_b32 exec_hi, 0
 ds_read_u16 v32, v72 offset:32768
 ds_read_u16 v33, v72 offset:32832
 ds_read_u16 v34, v72 offset:32896
 ds_read_u16 v35, v72 offset:32960
 s_mov_b32 exec_hi, -1
 s_waitcnt vmcnt(0) lgkmcnt(0)
 v_lshlrev_b32 v24, 16, v24
 v_lshlrev_b32 v25, 16, v25
 v_lshlrev_b32 v26, 16, v26
 v_lshlrev_b32 v27, 16, v27
 v_lshlrev_b32 v28, 16, v28
 v_lshlrev_b32 v29, 16, v29
 v_lshlrev_b32 v30, 16, v30
 v_lshlrev_b32 v31, 16, v31
 v_lshlrev_b32 v32, 16, v32
 v_lshlrev_b32 v33, 16, v33
 v_lshlrev_b32 v34, 16, v34
 v_lshlrev_b32 v35, 16, v35
 v_lshlrev_b32 v12, 16, v48
 v_and_b32 v13, 0xffff0000, v48
 v_lshlrev_b32 v14, 16, v49
 v_and_b32 v15, 0xffff0000, v49
 v_lshlrev_b32 v16, 16, v50
 v_and_b32 v17, 0xffff0000, v50
 v_lshlrev_b32 v18, 16, v51
 v_and_b32 v19, 0xffff0000, v51
 v_lshlrev_b32 v20, 16, v52
 v_and_b32 v21, 0xffff0000, v52
 v_lshlrev_b32 v22, 16, v53
 v_and_b32 v23, 0xffff0000, v53
 s_lshl_b32 s55, s54, 2
 s_mov_b32 s51, 0
 s_mov_b64 exec, 31
L_tw_152:
 v_mov_b32 v3, 0
 buffer_atomic_add v3, v5, s[4:7], s55 offen sc0
 s_waitcnt vmcnt(0)
 v_cmp_gt_u32 vcc, 10, v3
 s_and_b32 s3, vcc_lo, 15
 s_cbranch_scc0 L_twd_153
 s_bitcmp0_b32 vcc_lo, 4
 s_cbranch_scc1 L_twf_154
 s_cmp_eq_u32 s54, 0
 s_cbranch_scc1 L_twf_154
 s_sleep 24
L_twf_154:
 s_sleep 8
 s_add_u32 s51, s51, 1
 s_cmp_lt_u32 s51, 131072
 s_cbranch_scc1 L_tw_152
 s_branch L_bail
L_twd_153:
 s_mov_b64 exec, -1
 s_lshl_b32 s55, s53, 6
 s_add_u32 s55, s55, s54
 s_mul_i32 s55, s55, 655360
 s_mul_i32 s3, s52, 2560
 s_add_u32 s55, s55, s3
 s_add_u32 s55, s55, 142606336
 buffer_load_dwordx4 v[80:83], v1, s[4:7], s55 offen offset:0 sc1 nt
 buffer_load_dwordx4 v[84:87], v1, s[4:7], s55 offen offset:1024 sc1 nt
 buffer_load_dwordx4 v[88:91], v6, s[4:7], s55 offen offset:2048 sc1 nt
 s_add_u32 s55, s55, 81920
 buffer_load_dwordx4 v[92:95], v1, s[4:7], s55 offen offset:0 sc1 nt
 buffer_load_dwordx4 v[96:99], v1, s[4:7], s55 offen offset:1024 sc1 nt
 buffer_load_dwordx4 v[100:103], v6, s[4:7], s55 offen offset:2048 sc1 nt
 s_add_u32 s55, s55, 81920
 buffer_load_dwordx4 v[104:107], v1, s[4:7], s55 offen offset:0 sc1 nt
 buffer_load_dwordx4 v[108:111], v1, s[4:7], s55 offen offset:1024 sc1 nt
 buffer_load_dwordx4 v[112:115], v6, s[4:7], s55 offen offset:2048 sc1 nt
 s_add_u32 s55, s55, 81920
 buffer_load_dwordx4 v[116:119], v1, s[4:7], s55 offen offset:0 sc1 nt
 buffer_load_dwordx4 v[120:123], v1, s[4:7], s55 offen offset:1024 sc1 nt
 buffer_load_dwordx4 v[124:127], v6, s[4:7], s55 offen offset:2048 sc1 nt
 s_add_u32 s55, s55, 81920
 buffer_load_dwordx4 v[128:131], v1, s[4:7], s55 offen offset:0 sc1 nt
 buffer_load_dwordx4 v[132:135], v1, s[4:7], s55 offen offset:1024 sc1 nt
 buffer_load_dwordx4 v[136:139], v6, s[4:7], s55 offen offset:2048 sc1 nt
 s_add_u32 s55, s55, 81920
 buffer_load_dwordx4 v[140:143], v1, s[4:7], s55 offen offset:0 sc1 nt
 buffer_load_dwordx4 v[144:147], v1, s[4:7], s55 offen offset:1024 sc1 nt
 buffer_load_dwordx4 v[148:151], v6, s[4:7], s55 offen offset:2048 sc1 nt
 s_add_u32 s55, s55, 81920
 buffer_load_dwordx4 v[152:155], v1, s[4:7], s55 offen offset:0 sc1 nt
 buffer_load_dwordx4 v[156:159], v1, s[4:7], s55 offen offset:1024 sc1 nt
 buffer_load_dwordx4 v[160:163], v6, s[4:7], s55 offen offset:2048 sc1 nt
 s_add_u32 s55, s55, 81920
 buffer_load_dwordx4 v[164:167], v1, s[4:7], s55 offen offset:0 sc1 nt
 buffer_load_dwordx4 v[168:171], v1, s[4:7], s55 offen offset:1024 sc1 nt
 buffer_load_dwordx4 v[172:175], v6, s[4:7], s55 offen offset:2048 sc1 nt
 s_add_u32 s55, s55, 81920
 s_and_b32 s56, s54, 31
 s_mul_i32 s56, s56, 1536
 s_add_u32 s56, s56, 81920
 v_add_u32 v3, s56, v2
 s_cmp_eq_u32 s53, 0
 s_cbranch_scc1 L_l0_155
 ds_read_b64 v[48:49], v3 offset:0
 ds_read_b64 v[50:51], v3 offset:512
 ds_read_b64 v[52:53], v3 offset:1024
 s_waitcnt lgkmcnt(0)
 v_lshlrev_b32 v12, 16, v48
 v_and_b32 v13, 0xffff0000, v48
 v_lshlrev_b32 v14, 16, v49
 v_and_b32 v15, 0xffff0000, v49
 v_lshlrev_b32 v16, 16, v50
 v_and_b32 v17, 0xffff0000, v50
 v_lshlrev_b32 v18, 16, v51
 v_and_b32 v19, 0xffff0000, v51
 v_lshlrev_b32 v20, 16, v52
 v_and_b32 v21, 0xffff0000, v52
 v_lshlrev_b32 v22, 16, v53
 v_and_b32 v23, 0xffff0000, v53
 s_add_u32 s3, s54, 1
 v_mov_b32 v10, s3
 ds_write_b32 v73, v10
L_l0_155:
 s_waitcnt vmcnt(18)
 v_pk_add_f32 v[80:81], v[80:81], v[92:93]
 v_pk_add_f32 v[82:83], v[82:83], v[94:95]
 v_pk_add_f32 v[84:85], v[84:85], v[96:97]
 v_pk_add_f32 v[86:87], v[86:87], v[98:99]
 v_pk_add_f32 v[88:89], v[88:89], v[100:101]
 v_pk_add_f32 v[90:91], v[90:91], v[102:103]
 s_waitcnt vmcnt(15)
 v_pk_add_f32 v[80:81], v[80:81], v[104:105]
 v_pk_add_f32 v[82:83], v[82:83], v[106:107]
 v_pk_add_f32 v[84:85], v[84:85], v[108:109]
 v_pk_add_f32 v[86:87], v[86:87], v[110:111]
 v_pk_add_f32 v[88:89], v[88:89], v[112:113]
 v_pk_add_f32 v[90:91], v[90:91], v[114:115]
 s_waitcnt vmcnt(12)
 v_pk_add_f32 v[80:81], v[80:81], v[116:117]
 v_pk_add_f32 v[82:83], v[82:83], v[118:119]
 v_pk_add_f32 v[84:85], v[84:85], v[120:121]
 v_pk_add_f32 v[86:87], v[86:87], v[122:123]
 v_pk_add_f32 v[88:89], v[88:89], v[124:125]
 v_pk_add_f32 v[90:91], v[90:91], v[126:127]
 s_waitcnt vmcnt(9)
 v_pk_add_f32 v[80:81], v[80:81], v[128:129]
 v_pk_add_f32 v[82:83], v[82:83], v[130:131]
 v_pk_add_f32 v[84:85], v[84:85], v[132:133]
 v_pk_add_f32 v[86:87], v[86:87], v[134:135]
 v_pk_add_f32 v[88:89], v[88:89], v[136:137]
 v_pk_add_f32 v[90:91], v[90:91], v[138:139]
 s_waitcnt vmcnt(6)
 v_pk_add_f32 v[80:81], v[80:81], v[140:141]
 v_pk_add_f32 v[82:83], v[82:83], v[142:143]
 v_pk_add_f32 v[84:85], v[84:85], v[144:145]
 v_pk_add_f32 v[86:87], v[86:87], v[146:147]
 v_pk_add_f32 v[88:89], v[88:89], v[148:149]
 v_pk_add_f32 v[90:91], v[90:91], v[150:151]
 s_waitcnt vmcnt(3)
 v_pk_add_f32 v[80:81], v[80:81], v[152:153]
 v_pk_add_f32 v[82:83], v[82:83], v[154:155]
 v_pk_add_f32 v[84:85], v[84:85], v[156:157]
 v_pk_add_f32 v[86:87], v[86:87], v[158:159]
 v_pk_add_f32 v[88:89], v[88:89], v[160:161]
 v_pk_add_f32 v[90:91], v[90:91], v[162:163]
 s_waitcnt vmcnt(0)
 v_pk_add_f32 v[80:81], v[80:81], v[164:165]
 v_pk_add_f32 v[82:83], v[82:83], v[166:167]
 v_pk_add_f32 v[84:85], v[84:85], v[168:169]
 v_pk_add_f32 v[86:87], v[86:87], v[170:171]
 v_pk_add_f32 v[88:89], v[88:89], v[172:173]
 v_pk_add_f32 v[90:91], v[90:91], v[174:175]
 v_cvt_pk_bf16_f32 v9, v80, v81
 v_lshlrev_b32 v80, 16, v9
 v_and_b32 v81, 0xffff0000, v9
 v_cvt_pk_bf16_f32 v9, v82, v83
 v_lshlrev_b32 v82, 16, v9
 v_and_b32 v83, 0xffff0000, v9
 v_cvt_pk_bf16_f32 v9, v84, v85
 v_lshlrev_b32 v84, 16, v9
 v_and_b32 v85, 0xffff0000, v9
 v_cvt_pk_bf16_f32 v9, v86, v87
 v_lshlrev_b32 v86, 16, v9
 v_and_b32 v87, 0xffff0000, v9
 v_cvt_pk_bf16_f32 v9, v88, v89
 v_lshlrev_b32 v88, 16, v9
 v_and_b32 v89, 0xffff0000, v9
 v_cvt_pk_bf16_f32 v9, v90, v91
 v_lshlrev_b32 v90, 16, v9
 v_and_b32 v91, 0xffff0000, v9
 v_pk_add_f32 v[12:13], v[12:13], v[80:81]
 v_pk_add_f32 v[14:15], v[14:15], v[82:83]
 v_pk_add_f32 v[16:17], v[16:17], v[84:85]
 v_pk_add_f32 v[18:19], v[18:19], v[86:87]
 v_pk_add_f32 v[20:21], v[20:21], v[88:89]
 v_pk_add_f32 v[22:23], v[22:23], v[90:91]
 v_cvt_pk_bf16_f32 v9, v12, v13
 v_lshlrev_b32 v12, 16, v9
 v_and_b32 v13, 0xffff0000, v9
 v_cvt_pk_bf16_f32 v9, v14, v15
 v_lshlrev_b32 v14, 16, v9
 v_and_b32 v15, 0xffff0000, v9
 v_cvt_pk_bf16_f32 v9, v16, v17
 v_lshlrev_b32 v16, 16, v9
 v_and_b32 v17, 0xffff0000, v9
 v_cvt_pk_bf16_f32 v9, v18, v19
 v_lshlrev_b32 v18, 16, v9
 v_and_b32 v19, 0xffff0000, v9
 v_cvt_pk_bf16_f32 v9, v20, v21
 v_lshlrev_b32 v20, 16, v9
 v_and_b32 v21, 0xffff0000, v9
 v_cvt_pk_bf16_f32 v9, v22, v23
 v_lshlrev_b32 v22, 16, v9
 v_and_b32 v23, 0xffff0000, v9
 v_readfirstlane_b32 s3, v12
 s_nop 1
 v_subrev_f32 v36, s3, v12
 v_subrev_f32 v37, s3, v13
 v_subrev_f32 v38, s3, v14
 v_subrev_f32 v39, s3, v15
 v_subrev_f32 v40, s3, v16
 v_subrev_f32 v41, s3, v17
 v_subrev_f32 v42, s3, v18
 v_subrev_f32 v43, s3, v19
 v_mov_b32 v44, 0
 v_mov_b32 v45, 0
 v_mov_b32 v46, 0
 v_mov_b32 v47, 0
 s_mov_b32 exec_hi, 0
 v_subrev_f32 v44, s3, v20
 v_subrev_f32 v45, s3, v21
 v_subrev_f32 v46, s3, v22
 v_subrev_f32 v47, s3, v23
 s_mov_b32 exec_hi, -1
 v_pk_mul_f32 v[10:11], v[36:37], v[36:37]
 v_pk_fma_f32 v[10:11], v[38:39], v[38:39], v[10:11]
 v_pk_fma_f32 v[10:11], v[40:41], v[40:41], v[10:11]
 v_pk_fma_f32 v[10:11], v[42:43], v[42:43], v[10:11]
 v_pk_fma_f32 v[10:11], v[44:45], v[44:45], v[10:11]
 v_pk_fma_f32 v[10:11], v[46:47], v[46:47], v[10:11]
 v_pk_add_f32 v[36:37], v[36:37], v[38:39]
 v_pk_add_f32 v[36:37], v[36:37], v[40:41]
 v_pk_add_f32 v[36:37], v[36:37], v[42:43]
 v_pk_add_f32 v[36:37], v[36:37], v[44:45]
 v_pk_add_f32 v[36:37], v[36:37], v[46:47]
 v_add_f32 v11, v10, v11
 v_add_f32 v10, v36, v37
 s_nop 0
 v_add_f32_dpp v11, v11, v11 quad_perm:[1,0,3,2] row_mask:0xf bank_mask:0xf
 v_add_f32_dpp v10, v10, v10 quad_perm:[1,0,3,2] row_mask:0xf bank_mask:0xf
 s_nop 0
 v_add_f32_dpp v11, v11, v11 quad_perm:[2,3,0,1] row_mask:0xf bank_mask:0xf
 v_add_f32_dpp v10, v10, v10 quad_perm:[2,3,0,1] row_mask:0xf bank_mask:0xf
 s_nop 0
 v_add_f32_dpp v11, v11, v11 row_half_mirror row_mask:0xf bank_mask:0xf
 v_add_f32_dpp v10, v10, v10 row_half_mirror row_mask:0xf bank_mask:0xf
 s_nop 0
 v_add_f32_dpp v11, v11, v11 row_mirror row_mask:0xf bank_mask:0xf
 v_add_f32_dpp v10, v10, v10 row_mirror row_mask:0xf bank_mask:0xf
 v_mov_b32 v37, v11
 v_mov_b32 v36, v10
 s_nop 0
 v_permlane16_swap_b32 v11, v37
 v_permlane16_swap_b32 v10, v36
 v_pk_add_f32 v[10:11], v[10:11], v[36:37]
 v_mov_b32 v37, v11
 v_mov_b32 v36, v10
 s_nop 0
 v_permlane32_swap_b32 v11, v37
 v_permlane32_swap_b32 v10, v36
 v_pk_add_f32 v[10:11], v[10:11], v[36:37]
 v_mul_f32 v10, s57, v10
 v_mul_f32 v11, s57, v11
 v_fma_f32 v11, -v10, v10, v11
 v_max_f32 v11, 0, v11
 v_add_f32 v10, s3, v10
 v_cvt_pk_bf16_f32 v9, v10, v11
 v_lshlrev_b32 v10, 16, v9
 v_and_b32 v11, 0xffff0000, v9
 v_add_f32 v11, s58, v11
 v_cvt_pk_bf16_f32 v11, v11, v11
 v_and_b32 v11, 0xffff0000, v11
 v_sqrt_f32 v11, v11
 s_nop 0
 v_pk_add_f32 v[36:37], v[12:13], v[10:11] op_sel_hi:[1,0] neg_lo:[0,1] neg_hi:[0,1]
 v_pk_add_f32 v[38:39], v[14:15], v[10:11] op_sel_hi:[1,0] neg_lo:[0,1] neg_hi:[0,1]
 v_pk_add_f32 v[40:41], v[16:17], v[10:11] op_sel_hi:[1,0] neg_lo:[0,1] neg_hi:[0,1]
 v_pk_add_f32 v[42:43], v[18:19], v[10:11] op_sel_hi:[1,0] neg_lo:[0,1] neg_hi:[0,1]
 v_pk_add_f32 v[44:45], v[20:21], v[10:11] op_sel_hi:[1,0] neg_lo:[0,1] neg_hi:[0,1]
 v_pk_add_f32 v[46:47], v[22:23], v[10:11] op_sel_hi:[1,0] neg_lo:[0,1] neg_hi:[0,1]
 v_cvt_pk_bf16_f32 v11, v11, v11
 v_and_b32 v11, 0xffff0000, v11
 v_rcp_f32 v11, v11
 v_cvt_pk_bf16_f32 v9, v36, v37
 v_lshlrev_b32 v36, 16, v9
 v_and_b32 v37, 0xffff0000, v9
 v_cvt_pk_bf16_f32 v9, v38, v39
 v_lshlrev_b32 v38, 16, v9
 v_and_b32 v39, 0xffff0000, v9
 v_cvt_pk_bf16_f32 v9, v40, v41
 v_lshlrev_b32 v40, 16, v9
 v_and_b32 v41, 0xffff0000, v9
 v_cvt_pk_bf16_f32 v9, v42, v43
 v_lshlrev_b32 v42, 16, v9
 v_and_b32 v43, 0xffff0000, v9
 v_cvt_pk_bf16_f32 v9, v44, v45
 v_lshlrev_b32 v44, 16, v9
 v_and_b32 v45, 0xffff0000, v9
 v_cvt_pk_bf16_f32 v9, v46, v47
 v_lshlrev_b32 v46, 16, v9
 v_and_b32 v47, 0xffff0000, v9
 v_pk_mul_f32 v[36:37], v[36:37], v[10:11] op_sel:[0,1] op_sel_hi:[1,1]
 v_pk_mul_f32 v[38:39], v[38:39], v[10:11] op_sel:[0,1] op_sel_hi:[1,1]
 v_pk_mul_f32 v[40:41], v[40:41], v[10:11] op_sel:[0,1] op_sel_hi:[1,1]
 v_pk_mul_f32 v[42:43], v[42:43], v[10:11] op_sel:[0,1] op_sel_hi:[1,1]
 v_pk_mul_f32 v[44:45], v[44:45], v[10:11] op_sel:[0,1] op_sel_hi:[1,1]
 v_pk_mul_f32 v[46:47], v[46:47], v[10:11] op_sel:[0,1] op_sel_hi:[1,1]
 v_cvt_pk_bf16_f32 v9, v36, v37
 v_lshlrev_b32 v36, 16, v9
 v_and_b32 v37, 0xffff0000, v9
 v_cvt_pk_bf16_f32 v9, v38, v39
 v_lshlrev_b32 v38, 16, v9
 v_and_b32 v39, 0xffff0000, v9
 v_cvt_pk_bf16_f32 v9, v40, v41
 v_lshlrev_b32 v40, 16, v9
 v_and_b32 v41, 0xffff0000, v9
 v_cvt_pk_bf16_f32 v9, v42, v43
 v_lshlrev_b32 v42, 16, v9
 v_and_b32 v43, 0xffff0000, v9
 v_cvt_pk_bf16_f32 v9, v44, v45
 v_lshlrev_b32 v44, 16, v9
 v_and_b32 v45, 0xffff0000, v9
 v_cvt_pk_bf16_f32 v9, v46, v47
 v_lshlrev_b32 v46, 16, v9
 v_and_b32 v47, 0xffff0000, v9
 v_pk_mul_f32 v[36:37], v[36:37], v[24:25]
 v_pk_mul_f32 v[38:39], v[38:39], v[26:27]
 v_pk_mul_f32 v[40:41], v[40:41], v[28:29]
 v_pk_mul_f32 v[42:43], v[42:43], v[30:31]
 v_pk_mul_f32 v[44:45], v[44:45], v[32:33]
 v_pk_mul_f32 v[46:47], v[46:47], v[34:35]
 v_cvt_pk_bf16_f32 v9, v36, v37
 v_lshlrev_b32 v36, 16, v9
 v_and_b32 v37, 0xffff0000, v9
 v_cvt_pk_bf16_f32 v9, v38, v39
 v_lshlrev_b32 v38, 16, v9
 v_and_b32 v39, 0xffff0000, v9
 v_cvt_pk_bf16_f32 v9, v40, v41
 v_lshlrev_b32 v40, 16, v9
 v_and_b32 v41, 0xffff0000, v9
 v_cvt_pk_bf16_f32 v9, v42, v43
 v_lshlrev_b32 v42, 16, v9
 v_and_b32 v43, 0xffff0000, v9
 v_cvt_pk_bf16_f32 v9, v44, v45
 v_lshlrev_b32 v44, 16, v9
 v_and_b32 v45, 0xffff0000, v9
 v_cvt_pk_bf16_f32 v9, v46, v47
 v_lshlrev_b32 v46, 16, v9
 v_and_b32 v47, 0xffff0000, v9
 v_pk_add_f32 v[12:13], v[12:13], v[36:37]
 v_pk_add_f32 v[14:15], v[14:15], v[38:39]
 v_pk_add_f32 v[16:17], v[16:17], v[40:41]
 v_pk_add_f32 v[18:19], v[18:19], v[42:43]
 v_pk_add_f32 v[20:21], v[20:21], v[44:45]
 v_pk_add_f32 v[22:23], v[22:23], v[46:47]
 v_cvt_pk_bf16_f32 v60, v12, v13
 v_cvt_pk_bf16_f32 v61, v14, v15
 v_cvt_pk_bf16_f32 v62, v16, v17
 v_cvt_pk_bf16_f32 v63, v18, v19
 v_cvt_pk_bf16_f32 v64, v20, v21
 v_cvt_pk_bf16_f32 v65, v22, v23
 s_cmp_lg_u32 s53, 0
 s_cbranch_scc1 L_l1_156
 s_cmp_lt_u32 s54, 32
 s_cbranch_scc1 L_rgd_159
 s_sub_u32 s55, s54, 31
 s_mov_b32 s51, 0
L_rg_158:
 ds_read_b32 v10, v73
 s_waitcnt lgkmcnt(0)
 v_cmp_gt_u32 vcc, s55, v10
 s_cbranch_vccz L_rgd_159
 s_sleep 8
 s_add_u32 s51, s51, 1
 s_cmp_lt_u32 s51, 131072
 s_cbranch_scc1 L_rg_158
 s_branch L_bail
L_rgd_159:
 ds_write_b64 v3, v[60:61] offset:0
 ds_write_b64 v3, v[62:63] offset:512
 ds_write_b64 v3, v[64:65] offset:1024
 v_lshlrev_b32 v12, 16, v60
 v_and_b32 v13, 0xffff0000, v60
 v_lshlrev_b32 v14, 16, v61
 v_and_b32 v15, 0xffff0000, v61
 v_lshlrev_b32 v16, 16, v62
 v_and_b32 v17, 0xffff0000, v62
 v_lshlrev_b32 v18, 16, v63
 v_and_b32 v19, 0xffff0000, v63
 v_lshlrev_b32 v20, 16, v64
 v_and_b32 v21, 0xffff0000, v64
 v_lshlrev_b32 v22, 16, v65
 v_and_b32 v23, 0xffff0000, v65
 s_nop 0
 v_readfirstlane_b32 s3, v12
 s_nop 1
 v_subrev_f32 v36, s3, v12
 v_subrev_f32 v37, s3, v13
 v_subrev_f32 v38, s3, v14
 v_subrev_f32 v39, s3, v15
 v_subrev_f32 v40, s3, v16
 v_subrev_f32 v41, s3, v17
 v_subrev_f32 v42, s3, v18
 v_subrev_f32 v43, s3, v19
 v_mov_b32 v44, 0
 v_mov_b32 v45, 0
 v_mov_b32 v46, 0
 v_mov_b32 v47, 0
 s_mov_b32 exec_hi, 0
 v_subrev_f32 v44, s3, v20
 v_subrev_f32 v45, s3, v21
 v_subrev_f32 v46, s3, v22
 v_subrev_f32 v47, s3, v23
 s_mov_b32 exec_hi, -1
 v_pk_mul_f32 v[10:11], v[36:37], v[36:37]
 v_pk_fma_f32 v[10:11], v[38:39], v[38:39], v[10:11]
 v_pk_fma_f32 v[10:11], v[40:41], v[40:41], v[10:11]
 v_pk_fma_f32 v[10:11], v[42:43], v[42:43], v[10:11]
 v_pk_fma_f32 v[10:11], v[44:45], v[44:45], v[10:11]
 v_pk_fma_f32 v[10:11], v[46:47], v[46:47], v[10:11]
 v_pk_add_f32 v[36:37], v[36:37], v[38:39]
 v_pk_add_f32 v[36:37], v[36:37], v[40:41]
 v_pk_add_f32 v[36:37], v[36:37], v[42:43]
 v_pk_add_f32 v[36:37], v[36:37], v[44:45]
 v_pk_add_f32 v[36:37], v[36:37], v[46:47]
 v_add_f32 v11, v10, v11
 v_add_f32 v10, v36, v37
 s_nop 0
 v_add_f32_dpp v11, v11, v11 quad_perm:[1,0,3,2] row_mask:0xf bank_mask:0xf
 v_add_f32_dpp v10, v10, v10 quad_perm:[1,0,3,2] row_mask:0xf bank_mask:0xf
 s_nop 0
 v_add_f32_dpp v11, v11, v11 quad_perm:[2,3,0,1] row_mask:0xf bank_mask:0xf
 v_add_f32_dpp v10, v10, v10 quad_perm:[2,3,0,1] row_mask:0xf bank_mask:0xf
 s_nop 0
 v_add_f32_dpp v11, v11, v11 row_half_mirror row_mask:0xf bank_mask:0xf
 v_add_f32_dpp v10, v10, v10 row_half_mirror row_mask:0xf bank_mask:0xf
 s_nop 0
 v_add_f32_dpp v11, v11, v11 row_mirror row_mask:0xf bank_mask:0xf
 v_add_f32_dpp v10, v10, v10 row_mirror row_mask:0xf bank_mask:0xf
 v_mov_b32 v37, v11
 v_mov_b32 v36, v10
 s_nop 0
 v_permlane16_swap_b32 v11, v37
 v_permlane16_swap_b32 v10, v36
 v_pk_add_f32 v[10:11], v[10:11], v[36:37]
 v_mov_b32 v37, v11
 v_mov_b32 v36, v10
 s_nop 0
 v_permlane32_swap_b32 v11, v37
 v_permlane32_swap_b32 v10, v36
 v_pk_add_f32 v[10:11], v[10:11], v[36:37]
 v_mul_f32 v10, s57, v10
 v_mul_f32 v11, s57, v11
 v_fma_f32 v11, -v10, v10, v11
 v_max_f32 v11, 0, v11
 v_add_f32 v10, s3, v10
 v_cvt_pk_bf16_f32 v9, v10, v11
 v_lshlrev_b32 v10, 16, v9
 v_and_b32 v11, 0xffff0000, v9
 v_add_f32 v11, s58, v11
 v_cvt_pk_bf16_f32 v11, v11, v11
 v_and_b32 v11, 0xffff0000, v11
 v_sqrt_f32 v11, v11
 s_nop 0
 v_pk_add_f32 v[36:37], v[12:13], v[10:11] op_sel_hi:[1,0] neg_lo:[0,1] neg_hi:[0,1]
 v_pk_add_f32 v[38:39], v[14:15], v[10:11] op_sel_hi:[1,0] neg_lo:[0,1] neg_hi:[0,1]
 v_pk_add_f32 v[40:41], v[16:17], v[10:11] op_sel_hi:[1,0] neg_lo:[0,1] neg_hi:[0,1]
 v_pk_add_f32 v[42:43], v[18:19], v[10:11] op_sel_hi:[1,0] neg_lo:[0,1] neg_hi:[0,1]
 v_pk_add_f32 v[44:45], v[20:21], v[10:11] op_sel_hi:[1,0] neg_lo:[0,1] neg_hi:[0,1]
 v_pk_add_f32 v[46:47], v[22:23], v[10:11] op_sel_hi:[1,0] neg_lo:[0,1] neg_hi:[0,1]
 v_cvt_pk_bf16_f32 v11, v11, v11
 v_and_b32 v11, 0xffff0000, v11
 v_rcp_f32 v11, v11
 v_cvt_pk_bf16_f32 v9, v36, v37
 v_lshlrev_b32 v36, 16, v9
 v_and_b32 v37, 0xffff0000, v9
 v_cvt_pk_bf16_f32 v9, v38, v39
 v_lshlrev_b32 v38, 16, v9
 v_and_b32 v39, 0xffff0000, v9
 v_cvt_pk_bf16_f32 v9, v40, v41
 v_lshlrev_b32 v40, 16, v9
 v_and_b32 v41, 0xffff0000, v9
 v_cvt_pk_bf16_f32 v9, v42, v43
 v_lshlrev_b32 v42, 16, v9
 v_and_b32 v43, 0xffff0000, v9
 v_cvt_pk_bf16_f32 v9, v44, v45
 v_lshlrev_b32 v44, 16, v9
 v_and_b32 v45, 0xffff0000, v9
 v_cvt_pk_bf16_f32 v9, v46, v47
 v_lshlrev_b32 v46, 16, v9
 v_and_b32 v47, 0xffff0000, v9
 v_pk_mul_f32 v[36:37], v[36:37], v[10:11] op_sel:[0,1] op_sel_hi:[1,1]
 v_pk_mul_f32 v[38:39], v[38:39], v[10:11] op_sel:[0,1] op_sel_hi:[1,1]
 v_pk_mul_f32 v[40:41], v[40:41], v[10:11] op_sel:[0,1] op_sel_hi:[1,1]
 v_pk_mul_f32 v[42:43], v[42:43], v[10:11] op_sel:[0,1] op_sel_hi:[1,1]
 v_pk_mul_f32 v[44:45], v[44:45], v[10:11] op_sel:[0,1] op_sel_hi:[1,1]
 v_pk_mul_f32 v[46:47], v[46:47], v[10:11] op_sel:[0,1] op_sel_hi:[1,1]
 v_cvt_pk_bf16_f32 v48, v36, v37
 v_cvt_pk_bf16_f32 v49, v38, v39
 v_cvt_pk_bf16_f32 v50, v40, v41
 v_cvt_pk_bf16_f32 v51, v42, v43
 v_cvt_pk_bf16_f32 v52, v44, v45
 v_cvt_pk_bf16_f32 v53, v46, v47
 s_add_u32 s3, s60, 229113856
 buffer_store_dwordx2 v[48:49], v4, s[4:7], s3 offen offset:0 sc1
 buffer_store_dwordx2 v[50:51], v4, s[4:7], s3 offen offset:512 sc1
 buffer_store_dwordx2 v[52:53], v8, s[4:7], s3 offen offset:1024 sc1
 s_waitcnt vmcnt(0) lgkmcnt(0)
 s_and_b32 s55, s52, 3
 s_mul_i32 s55, s55, 24576
 s_lshl_b32 s3, s54, 2
 s_add_u32 s3, s3, s55
 s_add_u32 s3, s3, 126976
 v_mov_b32 v3, 1
 s_mov_b64 exec, -1
 buffer_atomic_add v3, v68, s[4:7], s3 offen
 s_mov_b64 exec, -1
 s_add_u32 s3, s3, 16384
 v_mov_b32 v3, 1
 s_mov_b32 exec_hi, 0
 buffer_atomic_add v3, v68, s[4:7], s3 offen
 s_mov_b64 exec, -1
 s_branch L_le_157
L_l1_156:
 buffer_store_dwordx2 v[60:61], v2, s[12:15], s60 offen offset:0 nt
 buffer_store_dwordx2 v[62:63], v2, s[12:15], s60 offen offset:512 nt
 buffer_store_dwordx2 v[64:65], v7, s[12:15], s60 offen offset:1024 nt
 s_waitcnt vmcnt(0)
L_le_157:
 s_add_u32 s54, s54, 2
 s_cmp_lt_u32 s54, 64
 s_cbranch_scc1 L_t4_loop
 s_cmp_lg_u32 s50, 3
 s_cbranch_scc1 L_bail
 s_endpgm
L_bail:
 s_endpgm
L_ch:
 s_mov_b32 s52, s49
 s_lshl_b32 s14, s53, 5
 s_add_u32 s14, s14, s52
 s_mul_i32 s63, s14, 49152
 s_mul_i32 s3, s50, 12288
 s_add_u32 s63, s63, s3
 s_add_u32 s63, s63, 2162688
 s_add_u32 s81, s63, 4096
 s_add_u32 s101, s63, 8192
 s_mul_i32 s60, s14, 10240
 s_lshl_b32 s3, s50, 11
 s_add_u32 s60, s60, s3
 s_add_u32 s60, s60, 225280
 s_lshl_b32 s12, s14, 8
 s_add_u32 s12, s12, 8192
 s_lshl_b32 s13, s14, 7
 s_add_u32 s13, s13, 0
 s_mul_i32 s62, s53, 524288
 s_lshl_b32 s3, s52, 12
 s_add_u32 s62, s62, s3
 s_add_u32 s62, s62, 1114112
 s_and_b32 s3, s52, 1
 s_lshl_b32 s3, s3, 13
 s_lshl_b32 s61, s52, 14
 s_add_u32 s61, s61, s3
 s_mul_i32 s3, s53, 33554432
 s_add_u32 s61, s61, s3
 s_add_u32 s61, s61, 8388608
 s_mov_b32 s56, 0x3e0293ee
 s_mov_b32 s54, 0
 s_mov_b32 s55, 1
 s_mov_b32 s68, 0x33333333
 s_mov_b32 s69, 0x33333333
 s_mov_b32 s70, 0xcccccccc
 s_mov_b32 s71, 0xcccccccc
 s_mov_b32 s72, 0x11111111
 s_mov_b32 s73, 0x11111111
 s_mov_b32 s74, 0x44444444
 s_mov_b32 s75, 0x44444444
 s_mov_b32 s76, 0x22222222
 s_mov_b32 s77, 0x22222222
 s_mov_b32 s78, 0x88888888
 s_mov_b32 s79, 0x88888888
 s_mov_b32 s82, 0xf0f0f0f0
 s_mov_b32 s83, 0xf0f0f0f0
 s_cmp_eq_u32 s50, 1
 s_cbranch_scc1 L_ch1
 s_cmp_eq_u32 s50, 2
 s_cbranch_scc1 L_ch2
 s_cmp_eq_u32 s50, 3
 s_cbranch_scc1 L_ch3
L_ch0:
 v_lshrrev_b32 v8, 4, v0
 s_mov_b32 s3, 1280
 v_mul_lo_u32 v8, v8, s3
 v_lshrrev_b32 v7, 3, v0
 v_and_b32 v7, 6, v7
 v_xor_b32 v7, v7, v0
 v_and_b32 v7, 15, v7
 v_lshl_add_u32 v8, v7, 4, v8
 v_xor_b32 v9, 128, v8
 v_lshrrev_b32 v10, 4, v0
 s_mov_b32 s3, 8192
 v_mul_lo_u32 v10, v10, s3
 v_lshrrev_b32 v7, 3, v0
 v_and_b32 v7, 6, v7
 v_xor_b32 v7, v7, v0
 v_and_b32 v7, 15, v7
 v_lshl_add_u32 v10, v7, 4, v10
 v_xor_b32 v11, 128, v10
 s_mov_b32 s8, s26
 s_and_b32 s9, s27, 0xffff
 s_mov_b32 s10, 5242880
 s_mul_i32 s14, s52, 163840
 s_add_u32 s14, s14, 0
 s_mov_b32 m0, 0
 s_nop 0
 buffer_load_dwordx4 v8, s[8:11], s14 offen lds
 s_add_u32 s14, s14, 5120
 s_mov_b32 m0, 1024
 s_nop 0
 buffer_load_dwordx4 v8, s[8:11], s14 offen lds
 s_add_u32 s14, s14, 5120
 s_mov_b32 m0, 2048
 s_nop 0
 buffer_load_dwordx4 v8, s[8:11], s14 offen lds
 s_add_u32 s14, s14, 5120
 s_mov_b32 m0, 3072
 s_nop 0
 buffer_load_dwordx4 v8, s[8:11], s14 offen lds
 s_add_u32 s14, s14, 5120
 s_mov_b32 m0, 4096
 s_nop 0
 buffer_load_dwordx4 v9, s[8:11], s14 offen lds
 s_add_u32 s14, s14, 5120
 s_mov_b32 m0, 5120
 s_nop 0
 buffer_load_dwordx4 v9, s[8:11], s14 offen lds
 s_add_u32 s14, s14, 5120
 s_mov_b32 m0, 6144
 s_nop 0
 buffer_load_dwordx4 v9, s[8:11], s14 offen lds
 s_add_u32 s14, s14, 5120
 s_mov_b32 m0, 7168
 s_nop 0
 buffer_load_dwordx4 v9, s[8:11], s14 offen lds
 s_mul_i32 s14, s52, 163840
 s_add_u32 s14, s14, 256
 s_mov_b32 m0, 32768
 s_nop 0
 buffer_load_dwordx4 v8, s[8:11], s14 offen lds
 s_add_u32 s14, s14, 5120
 s_mov_b32 m0, 33792
 s_nop 0
 buffer_load_dwordx4 v8, s[8:11], s14 offen lds
 s_add_u32 s14, s14, 5120
 s_mov_b32 m0, 34816
 s_nop 0
 buffer_load_dwordx4 v8, s[8:11], s14 offen lds
 s_add_u32 s14, s14, 5120
 s_mov_b32 m0, 35840
 s_nop 0
 buffer_load_dwordx4 v8, s[8:11], s14 offen lds
 s_add_u32 s14, s14, 5120
 s_mov_b32 m0, 36864
 s_nop 0
 buffer_load_dwordx4 v9, s[8:11], s14 offen lds
 s_add_u32 s14, s14, 5120
 s_mov_b32 m0, 37888
 s_nop 0
 buffer_load_dwordx4 v9, s[8:11], s14 offen lds
 s_add_u32 s14, s14, 5120
 s_mov_b32 m0, 38912
 s_nop 0
 buffer_load_dwordx4 v9, s[8:11], s14 offen lds
 s_add_u32 s14, s14, 5120
 s_mov_b32 m0, 39936
 s_nop 0
 buffer_load_dwordx4 v9, s[8:11], s14 offen lds
 s_mul_i32 s14, s52, 163840
 s_add_u32 s14, s14, 512
 s_mov_b32 m0, 65536
 s_nop 0
 buffer_load_dwordx4 v8, s[8:11], s14 offen lds
 s_add_u32 s14, s14, 5120
 s_mov_b32 m0, 66560
 s_nop 0
 buffer_load_dwordx4 v8, s[8:11], s14 offen lds
 s_add_u32 s14, s14, 5120
 s_mov_b32 m0, 67584
 s_nop 0
 buffer_load_dwordx4 v8, s[8:11], s14 offen lds
 s_add_u32 s14, s14, 5120
 s_mov_b32 m0, 68608
 s_nop 0
 buffer_load_dwordx4 v8, s[8:11], s14 offen lds
 s_add_u32 s14, s14, 5120
 s_mov_b32 m0, 69632
 s_nop 0
 buffer_load_dwordx4 v9, s[8:11], s14 offen lds
 s_add_u32 s14, s14, 5120
 s_mov_b32 m0, 70656
 s_nop 0
 buffer_load_dwordx4 v9, s[8:11], s14 offen lds
 s_add_u32 s14, s14, 5120
 s_mov_b32 m0, 71680
 s_nop 0
 buffer_load_dwordx4 v9, s[8:11], s14 offen lds
 s_add_u32 s14, s14, 5120
 s_mov_b32 m0, 72704
 s_nop 0
 buffer_load_dwordx4 v9, s[8:11], s14 offen lds
 s_mul_i32 s14, s52, 163840
 s_add_u32 s14, s14, 768
 s_mov_b32 m0, 98304
 s_nop 0
 buffer_load_dwordx4 v8, s[8:11], s14 offen lds
 s_add_u32 s14, s14, 5120
 s_mov_b32 m0, 99328
 s_nop 0
 buffer_load_dwordx4 v8, s[8:11], s14 offen lds
 s_add_u32 s14, s14, 5120
 s_mov_b32 m0, 100352
 s_nop 0
 buffer_load_dwordx4 v8, s[8:11], s14 offen lds
 s_add_u32 s14, s14, 5120
 s_mov_b32 m0, 101376
 s_nop 0
 buffer_load_dwordx4 v8, s[8:11], s14 offen lds
 s_add_u32 s14, s14, 5120
 s_mov_b32 m0, 102400
 s_nop 0
 buffer_load_dwordx4 v9, s[8:11], s14 offen lds
 s_add_u32 s14, s14, 5120
 s_mov_b32 m0, 103424
 s_nop 0
 buffer_load_dwordx4 v9, s[8:11], s14 offen lds
 s_add_u32 s14, s14, 5120
 s_mov_b32 m0, 104448
 s_nop 0
 buffer_load_dwordx4 v9, s[8:11], s14 offen lds
 s_add_u32 s14, s14, 5120
 s_mov_b32 m0, 105472
 s_nop 0
 buffer_load_dwordx4 v9, s[8:11], s14 offen lds
 s_mul_i32 s14, s52, 163840
 s_add_u32 s14, s14, 1024
 s_mov_b32 m0, 131072
 s_nop 0
 buffer_load_dwordx4 v8, s[8:11], s14 offen lds
 s_add_u32 s14, s14, 5120
 s_mov_b32 m0, 132096
 s_nop 0
 buffer_load_dwordx4 v8, s[8:11], s14 offen lds
 s_add_u32 s14, s14, 5120
 s_mov_b32 m0, 133120
 s_nop 0
 buffer_load_dwordx4 v8, s[8:11], s14 offen lds
 s_add_u32 s14, s14, 5120
 s_mov_b32 m0, 134144
 s_nop 0
 buffer_load_dwordx4 v8, s[8:11], s14 offen lds
 s_add_u32 s14, s14, 5120
 s_mov_b32 m0, 135168
 s_nop 0
 buffer_load_dwordx4 v9, s[8:11], s14 offen lds
 s_add_u32 s14, s14, 5120
 s_mov_b32 m0, 136192
 s_nop 0
 buffer_load_dwordx4 v9, s[8:11], s14 offen lds
 s_add_u32 s14, s14, 5120
 s_mov_b32 m0, 137216
 s_nop 0
 buffer_load_dwordx4 v9, s[8:11], s14 offen lds
 s_add_u32 s14, s14, 5120
 s_mov_b32 m0, 138240
 s_nop 0
 buffer_load_dwordx4 v9, s[8:11], s14 offen lds
 v_lshrrev_b32 v20, 4, v0
 v_bfe_u32 v21, v0, 2, 1
 v_bfe_u32 v22, v0, 3, 1
 v_and_b32 v23, 1, v20
 v_lshrrev_b32 v24, 1, v20
 v_and_b32 v25, 3, v0
 v_lshlrev_b32 v25, 3, v25
 v_lshl_add_u32 v26, v22, 1, v23
 v_lshl_add_u32 v27, v21, 2, v26
 v_lshl_add_u32 v26, v24, 2, v26
 v_lshl_add_u32 v26, v21, 4, v26
 v_xor_b32 v27, 0, v27
 v_lshl_add_u32 v27, v27, 5, v25
 v_lshl_add_u32 v12, v26, 8, v27
 v_lshl_add_u32 v26, v24, 2, v21
 v_lshl_add_u32 v26, v23, 4, v26
 v_lshl_add_u32 v27, v23, 2, v21
 v_lshl_add_u32 v27, v22, 1, v27
 v_lshl_add_u32 v27, v27, 5, v25
 v_lshl_add_u32 v14, v26, 8, v27
 v_lshlrev_b32 v1, 4, v0
 v_add_u32 v2, 65536, v1
 v_add_u32 v3, 114688, v1
 s_waitcnt vmcnt(32)
 s_barrier
 v_xor_b32 v16, 0, v14
 v_add_u32 v16, 0, v16
 v_xor_b32 v17, 64, v16
 ds_read_b64_tr_b16 a[0:1], v16 offset:0
 ds_read_b64_tr_b16 a[2:3], v17 offset:512
 ds_read_b64_tr_b16 a[4:5], v16 offset:2048
 ds_read_b64_tr_b16 a[6:7], v17 offset:2560
 v_xor_b32 v16, 0, v14
 v_add_u32 v16, 0, v16
 v_xor_b32 v17, 64, v16
 ds_read_b64_tr_b16 a[8:9], v16 offset:8192
 ds_read_b64_tr_b16 a[10:11], v17 offset:8704
 ds_read_b64_tr_b16 a[12:13], v16 offset:10240
 ds_read_b64_tr_b16 a[14:15], v17 offset:10752
 v_xor_b32 v16, 0, v14
 v_add_u32 v16, 0, v16
 v_xor_b32 v17, 64, v16
 ds_read_b64_tr_b16 a[16:17], v16 offset:16384
 ds_read_b64_tr_b16 a[18:19], v17 offset:16896
 ds_read_b64_tr_b16 a[20:21], v16 offset:18432
 ds_read_b64_tr_b16 a[22:23], v17 offset:18944
 v_xor_b32 v16, 0, v14
 v_add_u32 v16, 0, v16
 v_xor_b32 v17, 64, v16
 ds_read_b64_tr_b16 a[24:25], v16 offset:24576
 ds_read_b64_tr_b16 a[26:27], v17 offset:25088
 ds_read_b64_tr_b16 a[28:29], v16 offset:26624
 ds_read_b64_tr_b16 a[30:31], v17 offset:27136
 v_xor_b32 v16, 32, v14
 v_add_u32 v16, 0, v16
 v_xor_b32 v17, 64, v16
 ds_read_b64_tr_b16 a[32:33], v16 offset:0
 ds_read_b64_tr_b16 a[34:35], v17 offset:512
 ds_read_b64_tr_b16 a[36:37], v16 offset:2048
 ds_read_b64_tr_b16 a[38:39], v17 offset:2560
 v_xor_b32 v16, 32, v14
 v_add_u32 v16, 0, v16
 v_xor_b32 v17, 64, v16
 ds_read_b64_tr_b16 a[40:41], v16 offset:8192
 ds_read_b64_tr_b16 a[42:43], v17 offset:8704
 ds_read_b64_tr_b16 a[44:45], v16 offset:10240
 ds_read_b64_tr_b16 a[46:47], v17 offset:10752
 v_xor_b32 v16, 32, v14
 v_add_u32 v16, 0, v16
 v_xor_b32 v17, 64, v16
 ds_read_b64_tr_b16 a[48:49], v16 offset:16384
 ds_read_b64_tr_b16 a[50:51], v17 offset:16896
 ds_read_b64_tr_b16 a[52:53], v16 offset:18432
 ds_read_b64_tr_b16 a[54:55], v17 offset:18944
 v_xor_b32 v16, 32, v14
 v_add_u32 v16, 0, v16
 v_xor_b32 v17, 64, v16
 ds_read_b64_tr_b16 a[56:57], v16 offset:24576
 ds_read_b64_tr_b16 a[58:59], v17 offset:25088
 ds_read_b64_tr_b16 a[60:61], v16 offset:26624
 ds_read_b64_tr_b16 a[62:63], v17 offset:27136
 v_xor_b32 v16, 128, v14
 v_add_u32 v16, 0, v16
 v_xor_b32 v17, 64, v16
 ds_read_b64_tr_b16 a[64:65], v16 offset:0
 ds_read_b64_tr_b16 a[66:67], v17 offset:512
 ds_read_b64_tr_b16 a[68:69], v16 offset:2048
 ds_read_b64_tr_b16 a[70:71], v17 offset:2560
 v_xor_b32 v16, 128, v14
 v_add_u32 v16, 0, v16
 v_xor_b32 v17, 64, v16
 ds_read_b64_tr_b16 a[72:73], v16 offset:8192
 ds_read_b64_tr_b16 a[74:75], v17 offset:8704
 ds_read_b64_tr_b16 a[76:77], v16 offset:10240
 ds_read_b64_tr_b16 a[78:79], v17 offset:10752
 v_xor_b32 v16, 128, v14
 v_add_u32 v16, 0, v16
 v_xor_b32 v17, 64, v16
 ds_read_b64_tr_b16 a[80:81], v16 offset:16384
 ds_read_b64_tr_b16 a[82:83], v17 offset:16896
 ds_read_b64_tr_b16 a[84:85], v16 offset:18432
 ds_read_b64_tr_b16 a[86:87], v17 offset:18944
 v_xor_b32 v16, 128, v14
 v_add_u32 v16, 0, v16
 v_xor_b32 v17, 64, v16
 ds_read_b64_tr_b16 a[88:89], v16 offset:24576
 ds_read_b64_tr_b16 a[90:91], v17 offset:25088
 ds_read_b64_tr_b16 a[92:93], v16 offset:26624
 ds_read_b64_tr_b16 a[94:95], v17 offset:27136
 v_xor_b32 v16, 160, v14
 v_add_u32 v16, 0, v16
 v_xor_b32 v17, 64, v16
 ds_read_b64_tr_b16 a[96:97], v16 offset:0
 ds_read_b64_tr_b16 a[98:99], v17 offset:512
 ds_read_b64_tr_b16 a[100:101], v16 offset:2048
 ds_read_b64_tr_b16 a[102:103], v17 offset:2560
 v_xor_b32 v16, 160, v14
 v_add_u32 v16, 0, v16
 v_xor_b32 v17, 64, v16
 ds_read_b64_tr_b16 a[104:105], v16 offset:8192
 ds_read_b64_tr_b16 a[106:107], v17 offset:8704
 ds_read_b64_tr_b16 a[108:109], v16 offset:10240
 ds_read_b64_tr_b16 a[110:111], v17 offset:10752
 v_xor_b32 v16, 160, v14
 v_add_u32 v16, 0, v16
 v_xor_b32 v17, 64, v16
 ds_read_b64_tr_b16 a[112:113], v16 offset:16384
 ds_read_b64_tr_b16 a[114:115], v17 offset:16896
 ds_read_b64_tr_b16 a[116:117], v16 offset:18432
 ds_read_b64_tr_b16 a[118:119], v17 offset:18944
 v_xor_b32 v16, 160, v14
 v_add_u32 v16, 0, v16
 v_xor_b32 v17, 64, v16
 ds_read_b64_tr_b16 a[120:121], v16 offset:24576
 ds_read_b64_tr_b16 a[122:123], v17 offset:25088
 ds_read_b64_tr_b16 a[124:125], v16 offset:26624
 ds_read_b64_tr_b16 a[126:127], v17 offset:27136
 s_waitcnt lgkmcnt(0)
 s_barrier
 s_mov_b32 s8, s24
 s_and_b32 s9, s25, 0xffff
 s_mov_b32 s10, 5242880
 s_lshl_b32 s14, s52, 8
 s_add_u32 s14, s14, 0
 s_mov_b32 m0, 0
 s_nop 0
 buffer_load_dwordx4 v10, s[8:11], s14 offen lds
 s_add_u32 s14, s14, 32768
 s_mov_b32 m0, 1024
 s_nop 0
 buffer_load_dwordx4 v10, s[8:11], s14 offen lds
 s_add_u32 s14, s14, 32768
 s_mov_b32 m0, 2048
 s_nop 0
 buffer_load_dwordx4 v10, s[8:11], s14 offen lds
 s_add_u32 s14, s14, 32768
 s_mov_b32 m0, 3072
 s_nop 0
 buffer_load_dwordx4 v10, s[8:11], s14 offen lds
 s_add_u32 s14, s14, 32768
 s_mov_b32 m0, 4096
 s_nop 0
 buffer_load_dwordx4 v11, s[8:11], s14 offen lds
 s_add_u32 s14, s14, 32768
 s_mov_b32 m0, 5120
 s_nop 0
 buffer_load_dwordx4 v11, s[8:11], s14 offen lds
 s_add_u32 s14, s14, 32768
 s_mov_b32 m0, 6144
 s_nop 0
 buffer_load_dwordx4 v11, s[8:11], s14 offen lds
 s_add_u32 s14, s14, 32768
 s_mov_b32 m0, 7168
 s_nop 0
 buffer_load_dwordx4 v11, s[8:11], s14 offen lds
 s_waitcnt vmcnt(32)
 s_barrier
 s_waitcnt lgkmcnt(0)
 s_barrier
 s_lshl_b32 s14, s52, 8
 s_add_u32 s14, s14, 1048576
 s_mov_b32 m0, 32768
 s_nop 0
 buffer_load_dwordx4 v10, s[8:11], s14 offen lds
 s_add_u32 s14, s14, 32768
 s_mov_b32 m0, 33792
 s_nop 0
 buffer_load_dwordx4 v10, s[8:11], s14 offen lds
 s_add_u32 s14, s14, 32768
 s_mov_b32 m0, 34816
 s_nop 0
 buffer_load_dwordx4 v10, s[8:11], s14 offen lds
 s_add_u32 s14, s14, 32768
 s_mov_b32 m0, 35840
 s_nop 0
 buffer_load_dwordx4 v10, s[8:11], s14 offen lds
 s_add_u32 s14, s14, 32768
 s_mov_b32 m0, 36864
 s_nop 0
 buffer_load_dwordx4 v11, s[8:11], s14 offen lds
 s_add_u32 s14, s14, 32768
 s_mov_b32 m0, 37888
 s_nop 0
 buffer_load_dwordx4 v11, s[8:11], s14 offen lds
 s_add_u32 s14, s14, 32768
 s_mov_b32 m0, 38912
 s_nop 0
 buffer_load_dwordx4 v11, s[8:11], s14 offen lds
 s_add_u32 s14, s14, 32768
 s_mov_b32 m0, 39936
 s_nop 0
 buffer_load_dwordx4 v11, s[8:11], s14 offen lds
 s_waitcnt vmcnt(32)
 s_barrier
 s_waitcnt lgkmcnt(0)
 s_barrier
 s_lshl_b32 s14, s52, 8
 s_add_u32 s14, s14, 2097152
 s_mov_b32 m0, 65536
 s_nop 0
 buffer_load_dwordx4 v10, s[8:11], s14 offen lds
 s_add_u32 s14, s14, 32768
 s_mov_b32 m0, 66560
 s_nop 0
 buffer_load_dwordx4 v10, s[8:11], s14 offen lds
 s_add_u32 s14, s14, 32768
 s_mov_b32 m0, 67584
 s_nop 0
 buffer_load_dwordx4 v10, s[8:11], s14 offen lds
 s_add_u32 s14, s14, 32768
 s_mov_b32 m0, 68608
 s_nop 0
 buffer_load_dwordx4 v10, s[8:11], s14 offen lds
 s_add_u32 s14, s14, 32768
 s_mov_b32 m0, 69632
 s_nop 0
 buffer_load_dwordx4 v11, s[8:11], s14 offen lds
 s_add_u32 s14, s14, 32768
 s_mov_b32 m0, 70656
 s_nop 0
 buffer_load_dwordx4 v11, s[8:11], s14 offen lds
 s_add_u32 s14, s14, 32768
 s_mov_b32 m0, 71680
 s_nop 0
 buffer_load_dwordx4 v11, s[8:11], s14 offen lds
 s_add_u32 s14, s14, 32768
 s_mov_b32 m0, 72704
 s_nop 0
 buffer_load_dwordx4 v11, s[8:11], s14 offen lds
 s_waitcnt vmcnt(32)
 s_barrier
 s_waitcnt lgkmcnt(0)
 s_barrier
 s_lshl_b32 s14, s52, 8
 s_add_u32 s14, s14, 3145728
 s_mov_b32 m0, 98304
 s_nop 0
 buffer_load_dwordx4 v10, s[8:11], s14 offen lds
 s_add_u32 s14, s14, 32768
 s_mov_b32 m0, 99328
 s_nop 0
 buffer_load_dwordx4 v10, s[8:11], s14 offen lds
 s_add_u32 s14, s14, 32768
 s_mov_b32 m0, 100352
 s_nop 0
 buffer_load_dwordx4 v10, s[8:11], s14 offen lds
 s_add_u32 s14, s14, 32768
 s_mov_b32 m0, 101376
 s_nop 0
 buffer_load_dwordx4 v10, s[8:11], s14 offen lds
 s_add_u32 s14, s14, 32768
 s_mov_b32 m0, 102400
 s_nop 0
 buffer_load_dwordx4 v11, s[8:11], s14 offen lds
 s_add_u32 s14, s14, 32768
 s_mov_b32 m0, 103424
 s_nop 0
 buffer_load_dwordx4 v11, s[8:11], s14 offen lds
 s_add_u32 s14, s14, 32768
 s_mov_b32 m0, 104448
 s_nop 0
 buffer_load_dwordx4 v11, s[8:11], s14 offen lds
 s_add_u32 s14, s14, 32768
 s_mov_b32 m0, 105472
 s_nop 0
 buffer_load_dwordx4 v11, s[8:11], s14 offen lds
 s_waitcnt vmcnt(32)
 s_barrier
 v_xor_b32 v16, 0, v14
 v_add_u32 v16, 131072, v16
 v_xor_b32 v17, 64, v16
 ds_read_b64_tr_b16 a[128:129], v16 offset:0
 ds_read_b64_tr_b16 a[130:131], v17 offset:512
 ds_read_b64_tr_b16 a[132:133], v16 offset:2048
 ds_read_b64_tr_b16 a[134:135], v17 offset:2560
 v_xor_b32 v16, 0, v14
 v_add_u32 v16, 131072, v16
 v_xor_b32 v17, 64, v16
 ds_read_b64_tr_b16 a[136:137], v16 offset:8192
 ds_read_b64_tr_b16 a[138:139], v17 offset:8704
 ds_read_b64_tr_b16 a[140:141], v16 offset:10240
 ds_read_b64_tr_b16 a[142:143], v17 offset:10752
 v_xor_b32 v16, 0, v14
 v_add_u32 v16, 131072, v16
 v_xor_b32 v17, 64, v16
 ds_read_b64_tr_b16 a[144:145], v16 offset:16384
 ds_read_b64_tr_b16 a[146:147], v17 offset:16896
 ds_read_b64_tr_b16 a[148:149], v16 offset:18432
 ds_read_b64_tr_b16 a[150:151], v17 offset:18944
 v_xor_b32 v16, 0, v14
 v_add_u32 v16, 131072, v16
 v_xor_b32 v17, 64, v16
 ds_read_b64_tr_b16 a[152:153], v16 offset:24576
 ds_read_b64_tr_b16 a[154:155], v17 offset:25088
 ds_read_b64_tr_b16 a[156:157], v16 offset:26624
 ds_read_b64_tr_b16 a[158:159], v17 offset:27136
 s_waitcnt lgkmcnt(0)
 s_barrier
 s_lshl_b32 s14, s52, 8
 s_add_u32 s14, s14, 4194304
 s_mov_b32 m0, 131072
 s_nop 0
 buffer_load_dwordx4 v10, s[8:11], s14 offen lds
 s_add_u32 s14, s14, 32768
 s_mov_b32 m0, 132096
 s_nop 0
 buffer_load_dwordx4 v10, s[8:11], s14 offen lds
 s_add_u32 s14, s14, 32768
 s_mov_b32 m0, 133120
 s_nop 0
 buffer_load_dwordx4 v10, s[8:11], s14 offen lds
 s_add_u32 s14, s14, 32768
 s_mov_b32 m0, 134144
 s_nop 0
 buffer_load_dwordx4 v10, s[8:11], s14 offen lds
 s_add_u32 s14, s14, 32768
 s_mov_b32 m0, 135168
 s_nop 0
 buffer_load_dwordx4 v11, s[8:11], s14 offen lds
 s_add_u32 s14, s14, 32768
 s_mov_b32 m0, 136192
 s_nop 0
 buffer_load_dwordx4 v11, s[8:11], s14 offen lds
 s_add_u32 s14, s14, 32768
 s_mov_b32 m0, 137216
 s_nop 0
 buffer_load_dwordx4 v11, s[8:11], s14 offen lds
 s_add_u32 s14, s14, 32768
 s_mov_b32 m0, 138240
 s_nop 0
 buffer_load_dwordx4 v11, s[8:11], s14 offen lds
 s_waitcnt vmcnt(32)
 s_barrier
 v_xor_b32 v16, 0, v12
 v_add_u32 v16, 0, v16
 ds_read_b64_tr_b16 a[160:161], v16 offset:0
 ds_read_b64_tr_b16 a[162:163], v16 offset:8192
 ds_read_b64_tr_b16 a[164:165], v16 offset:2048
 ds_read_b64_tr_b16 a[166:167], v16 offset:10240
 v_xor_b32 v16, 32, v12
 v_add_u32 v16, 0, v16
 ds_read_b64_tr_b16 a[168:169], v16 offset:0
 ds_read_b64_tr_b16 a[170:171], v16 offset:8192
 ds_read_b64_tr_b16 a[172:173], v16 offset:2048
 ds_read_b64_tr_b16 a[174:175], v16 offset:10240
 v_xor_b32 v16, 0, v12
 v_add_u32 v16, 0, v16
 ds_read_b64_tr_b16 a[176:177], v16 offset:16384
 ds_read_b64_tr_b16 a[178:179], v16 offset:24576
 ds_read_b64_tr_b16 a[180:181], v16 offset:18432
 ds_read_b64_tr_b16 a[182:183], v16 offset:26624
 v_xor_b32 v16, 32, v12
 v_add_u32 v16, 0, v16
 ds_read_b64_tr_b16 a[184:185], v16 offset:16384
 ds_read_b64_tr_b16 a[186:187], v16 offset:24576
 ds_read_b64_tr_b16 a[188:189], v16 offset:18432
 ds_read_b64_tr_b16 a[190:191], v16 offset:26624
 s_waitcnt lgkmcnt(0)
 s_barrier
 s_mov_b32 s8, s22
 s_and_b32 s9, s23, 0xffff
 s_mov_b32 s10, 5242880
 s_lshl_b32 s14, s52, 8
 s_add_u32 s14, s14, 0
 s_mov_b32 m0, 0
 s_nop 0
 buffer_load_dwordx4 v10, s[8:11], s14 offen lds
 s_add_u32 s14, s14, 32768
 s_mov_b32 m0, 1024
 s_nop 0
 buffer_load_dwordx4 v10, s[8:11], s14 offen lds
 s_add_u32 s14, s14, 32768
 s_mov_b32 m0, 2048
 s_nop 0
 buffer_load_dwordx4 v10, s[8:11], s14 offen lds
 s_add_u32 s14, s14, 32768
 s_mov_b32 m0, 3072
 s_nop 0
 buffer_load_dwordx4 v10, s[8:11], s14 offen lds
 s_add_u32 s14, s14, 32768
 s_mov_b32 m0, 4096
 s_nop 0
 buffer_load_dwordx4 v11, s[8:11], s14 offen lds
 s_add_u32 s14, s14, 32768
 s_mov_b32 m0, 5120
 s_nop 0
 buffer_load_dwordx4 v11, s[8:11], s14 offen lds
 s_add_u32 s14, s14, 32768
 s_mov_b32 m0, 6144
 s_nop 0
 buffer_load_dwordx4 v11, s[8:11], s14 offen lds
 s_add_u32 s14, s14, 32768
 s_mov_b32 m0, 7168
 s_nop 0
 buffer_load_dwordx4 v11, s[8:11], s14 offen lds
 s_waitcnt vmcnt(32)
 s_barrier
 v_xor_b32 v16, 0, v12
 v_add_u32 v16, 32768, v16
 ds_read_b64_tr_b16 a[192:193], v16 offset:0
 ds_read_b64_tr_b16 a[194:195], v16 offset:8192
 ds_read_b64_tr_b16 a[196:197], v16 offset:2048
 ds_read_b64_tr_b16 a[198:199], v16 offset:10240
 v_xor_b32 v16, 32, v12
 v_add_u32 v16, 32768, v16
 ds_read_b64_tr_b16 a[200:201], v16 offset:0
 ds_read_b64_tr_b16 a[202:203], v16 offset:8192
 ds_read_b64_tr_b16 a[204:205], v16 offset:2048
 ds_read_b64_tr_b16 a[206:207], v16 offset:10240
 v_xor_b32 v16, 0, v12
 v_add_u32 v16, 32768, v16
 ds_read_b64_tr_b16 a[208:209], v16 offset:16384
 ds_read_b64_tr_b16 a[210:211], v16 offset:24576
 ds_read_b64_tr_b16 a[212:213], v16 offset:18432
 ds_read_b64_tr_b16 a[214:215], v16 offset:26624
 v_xor_b32 v16, 32, v12
 v_add_u32 v16, 32768, v16
 ds_read_b64_tr_b16 a[216:217], v16 offset:16384
 ds_read_b64_tr_b16 a[218:219], v16 offset:24576
 ds_read_b64_tr_b16 a[220:221], v16 offset:18432
 ds_read_b64_tr_b16 a[222:223], v16 offset:26624
 s_waitcnt lgkmcnt(0)
 s_barrier
 s_lshl_b32 s14, s52, 8
 s_add_u32 s14, s14, 1048576
 s_mov_b32 m0, 32768
 s_nop 0
 buffer_load_dwordx4 v10, s[8:11], s14 offen lds
 s_add_u32 s14, s14, 32768
 s_mov_b32 m0, 33792
 s_nop 0
 buffer_load_dwordx4 v10, s[8:11], s14 offen lds
 s_add_u32 s14, s14, 32768
 s_mov_b32 m0, 34816
 s_nop 0
 buffer_load_dwordx4 v10, s[8:11], s14 offen lds
 s_add_u32 s14, s14, 32768
 s_mov_b32 m0, 35840
 s_nop 0
 buffer_load_dwordx4 v10, s[8:11], s14 offen lds
 s_add_u32 s14, s14, 32768
 s_mov_b32 m0, 36864
 s_nop 0
 buffer_load_dwordx4 v11, s[8:11], s14 offen lds
 s_add_u32 s14, s14, 32768
 s_mov_b32 m0, 37888
 s_nop 0
 buffer_load_dwordx4 v11, s[8:11], s14 offen lds
 s_add_u32 s14, s14, 32768
 s_mov_b32 m0, 38912
 s_nop 0
 buffer_load_dwordx4 v11, s[8:11], s14 offen lds
 s_add_u32 s14, s14, 32768
 s_mov_b32 m0, 39936
 s_nop 0
 buffer_load_dwordx4 v11, s[8:11], s14 offen lds
 s_waitcnt vmcnt(32)
 s_barrier
 v_xor_b32 v16, 0, v12
 v_add_u32 v16, 65536, v16
 ds_read_b64_tr_b16 a[224:225], v16 offset:0
 ds_read_b64_tr_b16 a[226:227], v16 offset:8192
 ds_read_b64_tr_b16 a[228:229], v16 offset:2048
 ds_read_b64_tr_b16 a[230:231], v16 offset:10240
 v_xor_b32 v16, 32, v12
 v_add_u32 v16, 65536, v16
 ds_read_b64_tr_b16 a[232:233], v16 offset:0
 ds_read_b64_tr_b16 a[234:235], v16 offset:8192
 ds_read_b64_tr_b16 a[236:237], v16 offset:2048
 ds_read_b64_tr_b16 a[238:239], v16 offset:10240
 v_xor_b32 v16, 0, v12
 v_add_u32 v16, 65536, v16
 ds_read_b64_tr_b16 a[240:241], v16 offset:16384
 ds_read_b64_tr_b16 a[242:243], v16 offset:24576
 ds_read_b64_tr_b16 a[244:245], v16 offset:18432
 ds_read_b64_tr_b16 a[246:247], v16 offset:26624
 v_xor_b32 v16, 32, v12
 v_add_u32 v16, 65536, v16
 ds_read_b64_tr_b16 a[248:249], v16 offset:16384
 ds_read_b64_tr_b16 a[250:251], v16 offset:24576
 ds_read_b64_tr_b16 a[252:253], v16 offset:18432
 ds_read_b64_tr_b16 a[254:255], v16 offset:26624
 s_waitcnt lgkmcnt(0)
 s_barrier
 s_lshl_b32 s14, s52, 8
 s_add_u32 s14, s14, 2097152
 s_mov_b32 m0, 65536
 s_nop 0
 buffer_load_dwordx4 v10, s[8:11], s14 offen lds
 s_add_u32 s14, s14, 32768
 s_mov_b32 m0, 66560
 s_nop 0
 buffer_load_dwordx4 v10, s[8:11], s14 offen lds
 s_add_u32 s14, s14, 32768
 s_mov_b32 m0, 67584
 s_nop 0
 buffer_load_dwordx4 v10, s[8:11], s14 offen lds
 s_add_u32 s14, s14, 32768
 s_mov_b32 m0, 68608
 s_nop 0
 buffer_load_dwordx4 v10, s[8:11], s14 offen lds
 s_add_u32 s14, s14, 32768
 s_mov_b32 m0, 69632
 s_nop 0
 buffer_load_dwordx4 v11, s[8:11], s14 offen lds
 s_add_u32 s14, s14, 32768
 s_mov_b32 m0, 70656
 s_nop 0
 buffer_load_dwordx4 v11, s[8:11], s14 offen lds
 s_add_u32 s14, s14, 32768
 s_mov_b32 m0, 71680
 s_nop 0
 buffer_load_dwordx4 v11, s[8:11], s14 offen lds
 s_add_u32 s14, s14, 32768
 s_mov_b32 m0, 72704
 s_nop 0
 buffer_load_dwordx4 v11, s[8:11], s14 offen lds
 s_waitcnt vmcnt(32)
 s_barrier
 v_xor_b32 v16, 0, v12
 v_add_u32 v16, 98304, v16
 ds_read_b64_tr_b16 v[64:65], v16 offset:0
 ds_read_b64_tr_b16 v[66:67], v16 offset:8192
 ds_read_b64_tr_b16 v[68:69], v16 offset:2048
 ds_read_b64_tr_b16 v[70:71], v16 offset:10240
 v_xor_b32 v16, 32, v12
 v_add_u32 v16, 98304, v16
 ds_read_b64_tr_b16 v[72:73], v16 offset:0
 ds_read_b64_tr_b16 v[74:75], v16 offset:8192
 ds_read_b64_tr_b16 v[76:77], v16 offset:2048
 ds_read_b64_tr_b16 v[78:79], v16 offset:10240
 v_xor_b32 v16, 0, v12
 v_add_u32 v16, 98304, v16
 ds_read_b64_tr_b16 v[80:81], v16 offset:16384
 ds_read_b64_tr_b16 v[82:83], v16 offset:24576
 ds_read_b64_tr_b16 v[84:85], v16 offset:18432
 ds_read_b64_tr_b16 v[86:87], v16 offset:26624
 v_xor_b32 v16, 32, v12
 v_add_u32 v16, 98304, v16
 ds_read_b64_tr_b16 v[88:89], v16 offset:16384
 ds_read_b64_tr_b16 v[90:91], v16 offset:24576
 ds_read_b64_tr_b16 v[92:93], v16 offset:18432
 ds_read_b64_tr_b16 v[94:95], v16 offset:26624
 s_waitcnt lgkmcnt(0)
 s_barrier
 s_lshl_b32 s14, s52, 8
 s_add_u32 s14, s14, 3145728
 s_mov_b32 m0, 98304
 s_nop 0
 buffer_load_dwordx4 v10, s[8:11], s14 offen lds
 s_add_u32 s14, s14, 32768
 s_mov_b32 m0, 99328
 s_nop 0
 buffer_load_dwordx4 v10, s[8:11], s14 offen lds
 s_add_u32 s14, s14, 32768
 s_mov_b32 m0, 100352
 s_nop 0
 buffer_load_dwordx4 v10, s[8:11], s14 offen lds
 s_add_u32 s14, s14, 32768
 s_mov_b32 m0, 101376
 s_nop 0
 buffer_load_dwordx4 v10, s[8:11], s14 offen lds
 s_add_u32 s14, s14, 32768
 s_mov_b32 m0, 102400
 s_nop 0
 buffer_load_dwordx4 v11, s[8:11], s14 offen lds
 s_add_u32 s14, s14, 32768
 s_mov_b32 m0, 103424
 s_nop 0
 buffer_load_dwordx4 v11, s[8:11], s14 offen lds
 s_add_u32 s14, s14, 32768
 s_mov_b32 m0, 104448
 s_nop 0
 buffer_load_dwordx4 v11, s[8:11], s14 offen lds
 s_add_u32 s14, s14, 32768
 s_mov_b32 m0, 105472
 s_nop 0
 buffer_load_dwordx4 v11, s[8:11], s14 offen lds
 s_waitcnt vmcnt(32)
 s_barrier
 v_xor_b32 v16, 0, v12
 v_add_u32 v16, 131072, v16
 ds_read_b64_tr_b16 v[96:97], v16 offset:0
 ds_read_b64_tr_b16 v[98:99], v16 offset:8192
 ds_read_b64_tr_b16 v[100:101], v16 offset:2048
 ds_read_b64_tr_b16 v[102:103], v16 offset:10240
 v_xor_b32 v16, 32, v12
 v_add_u32 v16, 131072, v16
 ds_read_b64_tr_b16 v[104:105], v16 offset:0
 ds_read_b64_tr_b16 v[106:107], v16 offset:8192
 ds_read_b64_tr_b16 v[108:109], v16 offset:2048
 ds_read_b64_tr_b16 v[110:111], v16 offset:10240
 v_xor_b32 v16, 0, v12
 v_add_u32 v16, 131072, v16
 ds_read_b64_tr_b16 v[112:113], v16 offset:16384
 ds_read_b64_tr_b16 v[114:115], v16 offset:24576
 ds_read_b64_tr_b16 v[116:117], v16 offset:18432
 ds_read_b64_tr_b16 v[118:119], v16 offset:26624
 v_xor_b32 v16, 32, v12
 v_add_u32 v16, 131072, v16
 ds_read_b64_tr_b16 v[120:121], v16 offset:16384
 ds_read_b64_tr_b16 v[122:123], v16 offset:24576
 ds_read_b64_tr_b16 v[124:125], v16 offset:18432
 ds_read_b64_tr_b16 v[126:127], v16 offset:26624
 s_waitcnt lgkmcnt(0)
 s_barrier
 s_lshl_b32 s14, s52, 8
 s_add_u32 s14, s14, 4194304
 s_mov_b32 m0, 131072
 s_nop 0
 buffer_load_dwordx4 v10, s[8:11], s14 offen lds
 s_add_u32 s14, s14, 32768
 s_mov_b32 m0, 132096
 s_nop 0
 buffer_load_dwordx4 v10, s[8:11], s14 offen lds
 s_add_u32 s14, s14, 32768
 s_mov_b32 m0, 133120
 s_nop 0
 buffer_load_dwordx4 v10, s[8:11], s14 offen lds
 s_add_u32 s14, s14, 32768
 s_mov_b32 m0, 134144
 s_nop 0
 buffer_load_dwordx4 v10, s[8:11], s14 offen lds
 s_add_u32 s14, s14, 32768
 s_mov_b32 m0, 135168
 s_nop 0
 buffer_load_dwordx4 v11, s[8:11], s14 offen lds
 s_add_u32 s14, s14, 32768
 s_mov_b32 m0, 136192
 s_nop 0
 buffer_load_dwordx4 v11, s[8:11], s14 offen lds
 s_add_u32 s14, s14, 32768
 s_mov_b32 m0, 137216
 s_nop 0
 buffer_load_dwordx4 v11, s[8:11], s14 offen lds
 s_add_u32 s14, s14, 32768
 s_mov_b32 m0, 138240
 s_nop 0
 buffer_load_dwordx4 v11, s[8:11], s14 offen lds
 s_waitcnt vmcnt(32)
 s_barrier
 v_xor_b32 v16, 0, v12
 v_add_u32 v16, 0, v16
 ds_read_b64_tr_b16 v[32:33], v16 offset:0
 ds_read_b64_tr_b16 v[34:35], v16 offset:8192
 ds_read_b64_tr_b16 v[36:37], v16 offset:2048
 ds_read_b64_tr_b16 v[38:39], v16 offset:10240
 s_add_u32 s3, s63, 0
 s_waitcnt lgkmcnt(2)
 buffer_store_dwordx4 v[32:35], v1, s[4:7], s3 offen offset:0
 s_waitcnt lgkmcnt(0)
 buffer_store_dwordx4 v[36:39], v1, s[4:7], s3 offen offset:1024
 v_xor_b32 v16, 32, v12
 v_add_u32 v16, 0, v16
 ds_read_b64_tr_b16 v[40:41], v16 offset:0
 ds_read_b64_tr_b16 v[42:43], v16 offset:8192
 ds_read_b64_tr_b16 v[44:45], v16 offset:2048
 ds_read_b64_tr_b16 v[46:47], v16 offset:10240
 s_add_u32 s3, s63, 2048
 s_waitcnt lgkmcnt(2)
 buffer_store_dwordx4 v[40:43], v1, s[4:7], s3 offen offset:0
 s_waitcnt lgkmcnt(0)
 buffer_store_dwordx4 v[44:47], v1, s[4:7], s3 offen offset:1024
 v_xor_b32 v16, 0, v12
 v_add_u32 v16, 0, v16
 ds_read_b64_tr_b16 v[48:49], v16 offset:16384
 ds_read_b64_tr_b16 v[50:51], v16 offset:24576
 ds_read_b64_tr_b16 v[52:53], v16 offset:18432
 ds_read_b64_tr_b16 v[54:55], v16 offset:26624
 s_add_u32 s3, s63, 4096
 s_waitcnt lgkmcnt(2)
 buffer_store_dwordx4 v[48:51], v1, s[4:7], s3 offen offset:0
 s_waitcnt lgkmcnt(0)
 buffer_store_dwordx4 v[52:55], v1, s[4:7], s3 offen offset:1024
 v_xor_b32 v16, 32, v12
 v_add_u32 v16, 0, v16
 ds_read_b64_tr_b16 v[56:57], v16 offset:16384
 ds_read_b64_tr_b16 v[58:59], v16 offset:24576
 ds_read_b64_tr_b16 v[60:61], v16 offset:18432
 ds_read_b64_tr_b16 v[62:63], v16 offset:26624
 s_add_u32 s3, s63, 6144
 s_waitcnt lgkmcnt(2)
 buffer_store_dwordx4 v[56:59], v1, s[4:7], s3 offen offset:0
 s_waitcnt lgkmcnt(0)
 buffer_store_dwordx4 v[60:63], v1, s[4:7], s3 offen offset:1024
 s_waitcnt lgkmcnt(0)
 s_barrier
 s_mov_b32 s8, s20
 s_and_b32 s9, s21, 0xffff
 s_mov_b32 s10, 5242880
 s_lshl_b32 s14, s52, 8
 s_add_u32 s14, s14, 0
 s_mov_b32 m0, 0
 s_nop 0
 buffer_load_dwordx4 v10, s[8:11], s14 offen lds
 s_add_u32 s14, s14, 32768
 s_mov_b32 m0, 1024
 s_nop 0
 buffer_load_dwordx4 v10, s[8:11], s14 offen lds
 s_add_u32 s14, s14, 32768
 s_mov_b32 m0, 2048
 s_nop 0
 buffer_load_dwordx4 v10, s[8:11], s14 offen lds
 s_add_u32 s14, s14, 32768
 s_mov_b32 m0, 3072
 s_nop 0
 buffer_load_dwordx4 v10, s[8:11], s14 offen lds
 s_add_u32 s14, s14, 32768
 s_mov_b32 m0, 4096
 s_nop 0
 buffer_load_dwordx4 v11, s[8:11], s14 offen lds
 s_add_u32 s14, s14, 32768
 s_mov_b32 m0, 5120
 s_nop 0
 buffer_load_dwordx4 v11, s[8:11], s14 offen lds
 s_add_u32 s14, s14, 32768
 s_mov_b32 m0, 6144
 s_nop 0
 buffer_load_dwordx4 v11, s[8:11], s14 offen lds
 s_add_u32 s14, s14, 32768
 s_mov_b32 m0, 7168
 s_nop 0
 buffer_load_dwordx4 v11, s[8:11], s14 offen lds
 s_waitcnt vmcnt(40)
 s_barrier
 v_xor_b32 v16, 0, v12
 v_add_u32 v16, 32768, v16
 ds_read_b64_tr_b16 v[128:129], v16 offset:0
 ds_read_b64_tr_b16 v[130:131], v16 offset:8192
 ds_read_b64_tr_b16 v[132:133], v16 offset:2048
 ds_read_b64_tr_b16 v[134:135], v16 offset:10240
 v_xor_b32 v16, 32, v12
 v_add_u32 v16, 32768, v16
 ds_read_b64_tr_b16 v[136:137], v16 offset:0
 ds_read_b64_tr_b16 v[138:139], v16 offset:8192
 ds_read_b64_tr_b16 v[140:141], v16 offset:2048
 ds_read_b64_tr_b16 v[142:143], v16 offset:10240
 v_xor_b32 v16, 0, v12
 v_add_u32 v16, 32768, v16
 ds_read_b64_tr_b16 v[144:145], v16 offset:16384
 ds_read_b64_tr_b16 v[146:147], v16 offset:24576
 ds_read_b64_tr_b16 v[148:149], v16 offset:18432
 ds_read_b64_tr_b16 v[150:151], v16 offset:26624
 v_xor_b32 v16, 32, v12
 v_add_u32 v16, 32768, v16
 ds_read_b64_tr_b16 v[152:153], v16 offset:16384
 ds_read_b64_tr_b16 v[154:155], v16 offset:24576
 ds_read_b64_tr_b16 v[156:157], v16 offset:18432
 ds_read_b64_tr_b16 v[158:159], v16 offset:26624
 s_waitcnt lgkmcnt(0)
 s_barrier
 s_lshl_b32 s14, s52, 8
 s_add_u32 s14, s14, 1048576
 s_mov_b32 m0, 32768
 s_nop 0
 buffer_load_dwordx4 v10, s[8:11], s14 offen lds
 s_add_u32 s14, s14, 32768
 s_mov_b32 m0, 33792
 s_nop 0
 buffer_load_dwordx4 v10, s[8:11], s14 offen lds
 s_add_u32 s14, s14, 32768
 s_mov_b32 m0, 34816
 s_nop 0
 buffer_load_dwordx4 v10, s[8:11], s14 offen lds
 s_add_u32 s14, s14, 32768
 s_mov_b32 m0, 35840
 s_nop 0
 buffer_load_dwordx4 v10, s[8:11], s14 offen lds
 s_add_u32 s14, s14, 32768
 s_mov_b32 m0, 36864
 s_nop 0
 buffer_load_dwordx4 v11, s[8:11], s14 offen lds
 s_add_u32 s14, s14, 32768
 s_mov_b32 m0, 37888
 s_nop 0
 buffer_load_dwordx4 v11, s[8:11], s14 offen lds
 s_add_u32 s14, s14, 32768
 s_mov_b32 m0, 38912
 s_nop 0
 buffer_load_dwordx4 v11, s[8:11], s14 offen lds
 s_add_u32 s14, s14, 32768
 s_mov_b32 m0, 39936
 s_nop 0
 buffer_load_dwordx4 v11, s[8:11], s14 offen lds
 s_waitcnt vmcnt(40)
 s_barrier
 v_xor_b32 v16, 0, v12
 v_add_u32 v16, 65536, v16
 ds_read_b64_tr_b16 v[160:161], v16 offset:0
 ds_read_b64_tr_b16 v[162:163], v16 offset:8192
 ds_read_b64_tr_b16 v[164:165], v16 offset:2048
 ds_read_b64_tr_b16 v[166:167], v16 offset:10240
 v_xor_b32 v16, 32, v12
 v_add_u32 v16, 65536, v16
 ds_read_b64_tr_b16 v[168:169], v16 offset:0
 ds_read_b64_tr_b16 v[170:171], v16 offset:8192
 ds_read_b64_tr_b16 v[172:173], v16 offset:2048
 ds_read_b64_tr_b16 v[174:175], v16 offset:10240
 v_xor_b32 v16, 0, v12
 v_add_u32 v16, 65536, v16
 ds_read_b64_tr_b16 v[176:177], v16 offset:16384
 ds_read_b64_tr_b16 v[178:179], v16 offset:24576
 ds_read_b64_tr_b16 v[180:181], v16 offset:18432
 ds_read_b64_tr_b16 v[182:183], v16 offset:26624
 v_xor_b32 v16, 32, v12
 v_add_u32 v16, 65536, v16
 ds_read_b64_tr_b16 v[184:185], v16 offset:16384
 ds_read_b64_tr_b16 v[186:187], v16 offset:24576
 ds_read_b64_tr_b16 v[188:189], v16 offset:18432
 ds_read_b64_tr_b16 v[190:191], v16 offset:26624
 s_waitcnt lgkmcnt(0)
 s_barrier
 s_lshl_b32 s14, s52, 8
 s_add_u32 s14, s14, 2097152
 s_mov_b32 m0, 65536
 s_nop 0
 buffer_load_dwordx4 v10, s[8:11], s14 offen lds
 s_add_u32 s14, s14, 32768
 s_mov_b32 m0, 66560
 s_nop 0
 buffer_load_dwordx4 v10, s[8:11], s14 offen lds
 s_add_u32 s14, s14, 32768
 s_mov_b32 m0, 67584
 s_nop 0
 buffer_load_dwordx4 v10, s[8:11], s14 offen lds
 s_add_u32 s14, s14, 32768
 s_mov_b32 m0, 68608
 s_nop 0
 buffer_load_dwordx4 v10, s[8:11], s14 offen lds
 s_add_u32 s14, s14, 32768
 s_mov_b32 m0, 69632
 s_nop 0
 buffer_load_dwordx4 v11, s[8:11], s14 offen lds
 s_add_u32 s14, s14, 32768
 s_mov_b32 m0, 70656
 s_nop 0
 buffer_load_dwordx4 v11, s[8:11], s14 offen lds
 s_add_u32 s14, s14, 32768
 s_mov_b32 m0, 71680
 s_nop 0
 buffer_load_dwordx4 v11, s[8:11], s14 offen lds
 s_add_u32 s14, s14, 32768
 s_mov_b32 m0, 72704
 s_nop 0
 buffer_load_dwordx4 v11, s[8:11], s14 offen lds
 s_waitcnt vmcnt(40)
 s_barrier
 v_xor_b32 v16, 0, v12
 v_add_u32 v16, 98304, v16
 ds_read_b64_tr_b16 v[192:193], v16 offset:0
 ds_read_b64_tr_b16 v[194:195], v16 offset:8192
 ds_read_b64_tr_b16 v[196:197], v16 offset:2048
 ds_read_b64_tr_b16 v[198:199], v16 offset:10240
 v_xor_b32 v16, 32, v12
 v_add_u32 v16, 98304, v16
 ds_read_b64_tr_b16 v[32:33], v16 offset:0
 ds_read_b64_tr_b16 v[34:35], v16 offset:8192
 ds_read_b64_tr_b16 v[36:37], v16 offset:2048
 ds_read_b64_tr_b16 v[38:39], v16 offset:10240
 s_add_u32 s3, s63, 8192
 s_waitcnt lgkmcnt(2)
 buffer_store_dwordx4 v[32:35], v1, s[4:7], s3 offen offset:0
 s_waitcnt lgkmcnt(0)
 buffer_store_dwordx4 v[36:39], v1, s[4:7], s3 offen offset:1024
 v_xor_b32 v16, 0, v12
 v_add_u32 v16, 98304, v16
 ds_read_b64_tr_b16 v[200:201], v16 offset:16384
 ds_read_b64_tr_b16 v[202:203], v16 offset:24576
 ds_read_b64_tr_b16 v[204:205], v16 offset:18432
 ds_read_b64_tr_b16 v[206:207], v16 offset:26624
 v_xor_b32 v16, 32, v12
 v_add_u32 v16, 98304, v16
 ds_read_b64_tr_b16 v[208:209], v16 offset:16384
 ds_read_b64_tr_b16 v[210:211], v16 offset:24576
 ds_read_b64_tr_b16 v[212:213], v16 offset:18432
 ds_read_b64_tr_b16 v[214:215], v16 offset:26624
 s_waitcnt lgkmcnt(0)
 s_barrier
 s_lshl_b32 s14, s52, 8
 s_add_u32 s14, s14, 3145728
 s_mov_b32 m0, 98304
 s_nop 0
 buffer_load_dwordx4 v10, s[8:11], s14 offen lds
 s_add_u32 s14, s14, 32768
 s_mov_b32 m0, 99328
 s_nop 0
 buffer_load_dwordx4 v10, s[8:11], s14 offen lds
 s_add_u32 s14, s14, 32768
 s_mov_b32 m0, 100352
 s_nop 0
 buffer_load_dwordx4 v10, s[8:11], s14 offen lds
 s_add_u32 s14, s14, 32768
 s_mov_b32 m0, 101376
 s_nop 0
 buffer_load_dwordx4 v10, s[8:11], s14 offen lds
 s_add_u32 s14, s14, 32768
 s_mov_b32 m0, 102400
 s_nop 0
 buffer_load_dwordx4 v11, s[8:11], s14 offen lds
 s_add_u32 s14, s14, 32768
 s_mov_b32 m0, 103424
 s_nop 0
 buffer_load_dwordx4 v11, s[8:11], s14 offen lds
 s_add_u32 s14, s14, 32768
 s_mov_b32 m0, 104448
 s_nop 0
 buffer_load_dwordx4 v11, s[8:11], s14 offen lds
 s_add_u32 s14, s14, 32768
 s_mov_b32 m0, 105472
 s_nop 0
 buffer_load_dwordx4 v11, s[8:11], s14 offen lds
 s_waitcnt vmcnt(42)
 s_barrier
 v_xor_b32 v16, 0, v12
 v_add_u32 v16, 131072, v16
 ds_read_b64_tr_b16 v[216:217], v16 offset:0
 ds_read_b64_tr_b16 v[218:219], v16 offset:8192
 ds_read_b64_tr_b16 v[220:221], v16 offset:2048
 ds_read_b64_tr_b16 v[222:223], v16 offset:10240
 v_xor_b32 v16, 32, v12
 v_add_u32 v16, 131072, v16
 ds_read_b64_tr_b16 v[224:225], v16 offset:0
 ds_read_b64_tr_b16 v[226:227], v16 offset:8192
 ds_read_b64_tr_b16 v[228:229], v16 offset:2048
 ds_read_b64_tr_b16 v[230:231], v16 offset:10240
 v_xor_b32 v16, 0, v12
 v_add_u32 v16, 131072, v16
 ds_read_b64_tr_b16 v[232:233], v16 offset:16384
 ds_read_b64_tr_b16 v[234:235], v16 offset:24576
 ds_read_b64_tr_b16 v[236:237], v16 offset:18432
 ds_read_b64_tr_b16 v[238:239], v16 offset:26624
 v_xor_b32 v16, 32, v12
 v_add_u32 v16, 131072, v16
 ds_read_b64_tr_b16 v[40:41], v16 offset:16384
 ds_read_b64_tr_b16 v[42:43], v16 offset:24576
 ds_read_b64_tr_b16 v[44:45], v16 offset:18432
 ds_read_b64_tr_b16 v[46:47], v16 offset:26624
 s_add_u32 s3, s63, 10240
 s_waitcnt lgkmcnt(2)
 buffer_store_dwordx4 v[40:43], v1, s[4:7], s3 offen offset:0
 s_waitcnt lgkmcnt(0)
 buffer_store_dwordx4 v[44:47], v1, s[4:7], s3 offen offset:1024
 s_waitcnt lgkmcnt(0)
 s_barrier
 s_lshl_b32 s14, s52, 8
 s_add_u32 s14, s14, 4194304
 s_mov_b32 m0, 131072
 s_nop 0
 buffer_load_dwordx4 v10, s[8:11], s14 offen lds
 s_add_u32 s14, s14, 32768
 s_mov_b32 m0, 132096
 s_nop 0
 buffer_load_dwordx4 v10, s[8:11], s14 offen lds
 s_add_u32 s14, s14, 32768
 s_mov_b32 m0, 133120
 s_nop 0
 buffer_load_dwordx4 v10, s[8:11], s14 offen lds
 s_add_u32 s14, s14, 32768
 s_mov_b32 m0, 134144
 s_nop 0
 buffer_load_dwordx4 v10, s[8:11], s14 offen lds
 s_add_u32 s14, s14, 32768
 s_mov_b32 m0, 135168
 s_nop 0
 buffer_load_dwordx4 v11, s[8:11], s14 offen lds
 s_add_u32 s14, s14, 32768
 s_mov_b32 m0, 136192
 s_nop 0
 buffer_load_dwordx4 v11, s[8:11], s14 offen lds
 s_add_u32 s14, s14, 32768
 s_mov_b32 m0, 137216
 s_nop 0
 buffer_load_dwordx4 v11, s[8:11], s14 offen lds
 s_add_u32 s14, s14, 32768
 s_mov_b32 m0, 138240
 s_nop 0
 buffer_load_dwordx4 v11, s[8:11], s14 offen lds
 s_waitcnt vmcnt(36)
 s_barrier
 v_xor_b32 v16, 0, v12
 v_add_u32 v16, 0, v16
 ds_read_b64_tr_b16 v[240:241], v16 offset:0
 ds_read_b64_tr_b16 v[242:243], v16 offset:8192
 ds_read_b64_tr_b16 v[244:245], v16 offset:2048
 ds_read_b64_tr_b16 v[246:247], v16 offset:10240
 v_xor_b32 v16, 32, v12
 v_add_u32 v16, 0, v16
 ds_read_b64_tr_b16 v[248:249], v16 offset:0
 ds_read_b64_tr_b16 v[250:251], v16 offset:8192
 ds_read_b64_tr_b16 v[252:253], v16 offset:2048
 ds_read_b64_tr_b16 v[254:255], v16 offset:10240
 v_xor_b32 v16, 0, v12
 v_add_u32 v16, 0, v16
 ds_read_b64_tr_b16 v[32:33], v16 offset:16384
 ds_read_b64_tr_b16 v[34:35], v16 offset:24576
 ds_read_b64_tr_b16 v[36:37], v16 offset:18432
 ds_read_b64_tr_b16 v[38:39], v16 offset:26624
 v_xor_b32 v16, 32, v12
 v_add_u32 v16, 0, v16
 ds_read_b64_tr_b16 v[40:41], v16 offset:16384
 ds_read_b64_tr_b16 v[42:43], v16 offset:24576
 ds_read_b64_tr_b16 v[44:45], v16 offset:18432
 ds_read_b64_tr_b16 v[46:47], v16 offset:26624
 s_waitcnt lgkmcnt(0)
 s_barrier
 ds_write_b128 v1, v[224:227] offset:16384
 ds_write_b128 v1, v[228:231] offset:17408
 ds_write_b128 v1, v[216:219] offset:18432
 ds_write_b128 v1, v[220:223] offset:19456
 s_waitcnt lgkmcnt(0)
 v_mov_b32 v224, v32
 v_mov_b32 v225, v33
 v_mov_b32 v226, v34
 v_mov_b32 v227, v35
 v_mov_b32 v228, v36
 v_mov_b32 v229, v37
 v_mov_b32 v230, v38
 v_mov_b32 v231, v39
 v_mov_b32 v216, v40
 v_mov_b32 v217, v41
 v_mov_b32 v218, v42
 v_mov_b32 v219, v43
 v_mov_b32 v220, v44
 v_mov_b32 v221, v45
 v_mov_b32 v222, v46
 v_mov_b32 v223, v47
 s_waitcnt vmcnt(28)
 s_barrier
 v_xor_b32 v16, 0, v12
 v_add_u32 v16, 32768, v16
 ds_read_b64_tr_b16 v[32:33], v16 offset:0
 ds_read_b64_tr_b16 v[34:35], v16 offset:8192
 ds_read_b64_tr_b16 v[36:37], v16 offset:2048
 ds_read_b64_tr_b16 v[38:39], v16 offset:10240
 v_xor_b32 v16, 32, v12
 v_add_u32 v16, 32768, v16
 ds_read_b64_tr_b16 v[40:41], v16 offset:0
 ds_read_b64_tr_b16 v[42:43], v16 offset:8192
 ds_read_b64_tr_b16 v[44:45], v16 offset:2048
 ds_read_b64_tr_b16 v[46:47], v16 offset:10240
 v_xor_b32 v16, 0, v12
 v_add_u32 v16, 32768, v16
 ds_read_b64_tr_b16 v[48:49], v16 offset:16384
 ds_read_b64_tr_b16 v[50:51], v16 offset:24576
 ds_read_b64_tr_b16 v[52:53], v16 offset:18432
 ds_read_b64_tr_b16 v[54:55], v16 offset:26624
 v_xor_b32 v16, 32, v12
 v_add_u32 v16, 32768, v16
 ds_read_b64_tr_b16 v[56:57], v16 offset:16384
 ds_read_b64_tr_b16 v[58:59], v16 offset:24576
 ds_read_b64_tr_b16 v[60:61], v16 offset:18432
 ds_read_b64_tr_b16 v[62:63], v16 offset:26624
 s_waitcnt lgkmcnt(0)
 s_barrier
 ds_write_b128 v1, v[200:203] offset:32768
 ds_write_b128 v1, v[204:207] offset:33792
 ds_write_b128 v1, v[192:195] offset:34816
 ds_write_b128 v1, v[196:199] offset:35840
 ds_write_b128 v1, v[184:187] offset:36864
 ds_write_b128 v1, v[188:191] offset:37888
 ds_write_b128 v1, v[176:179] offset:38912
 ds_write_b128 v1, v[180:183] offset:39936
 s_waitcnt lgkmcnt(0)
 v_mov_b32 v200, v32
 v_mov_b32 v201, v33
 v_mov_b32 v202, v34
 v_mov_b32 v203, v35
 v_mov_b32 v204, v36
 v_mov_b32 v205, v37
 v_mov_b32 v206, v38
 v_mov_b32 v207, v39
 v_mov_b32 v192, v40
 v_mov_b32 v193, v41
 v_mov_b32 v194, v42
 v_mov_b32 v195, v43
 v_mov_b32 v196, v44
 v_mov_b32 v197, v45
 v_mov_b32 v198, v46
 v_mov_b32 v199, v47
 v_mov_b32 v184, v48
 v_mov_b32 v185, v49
 v_mov_b32 v186, v50
 v_mov_b32 v187, v51
 v_mov_b32 v188, v52
 v_mov_b32 v189, v53
 v_mov_b32 v190, v54
 v_mov_b32 v191, v55
 v_mov_b32 v176, v56
 v_mov_b32 v177, v57
 v_mov_b32 v178, v58
 v_mov_b32 v179, v59
 v_mov_b32 v180, v60
 v_mov_b32 v181, v61
 v_mov_b32 v182, v62
 v_mov_b32 v183, v63
 s_waitcnt vmcnt(20)
 s_barrier
 v_xor_b32 v16, 0, v12
 v_add_u32 v16, 65536, v16
 ds_read_b64_tr_b16 v[32:33], v16 offset:0
 ds_read_b64_tr_b16 v[34:35], v16 offset:8192
 ds_read_b64_tr_b16 v[36:37], v16 offset:2048
 ds_read_b64_tr_b16 v[38:39], v16 offset:10240
 v_xor_b32 v16, 32, v12
 v_add_u32 v16, 65536, v16
 ds_read_b64_tr_b16 v[40:41], v16 offset:0
 ds_read_b64_tr_b16 v[42:43], v16 offset:8192
 ds_read_b64_tr_b16 v[44:45], v16 offset:2048
 ds_read_b64_tr_b16 v[46:47], v16 offset:10240
 v_xor_b32 v16, 0, v12
 v_add_u32 v16, 65536, v16
 ds_read_b64_tr_b16 v[48:49], v16 offset:16384
 ds_read_b64_tr_b16 v[50:51], v16 offset:24576
 ds_read_b64_tr_b16 v[52:53], v16 offset:18432
 ds_read_b64_tr_b16 v[54:55], v16 offset:26624
 v_xor_b32 v16, 32, v12
 v_add_u32 v16, 65536, v16
 ds_read_b64_tr_b16 v[56:57], v16 offset:16384
 ds_read_b64_tr_b16 v[58:59], v16 offset:24576
 ds_read_b64_tr_b16 v[60:61], v16 offset:18432
 ds_read_b64_tr_b16 v[62:63], v16 offset:26624
 s_waitcnt lgkmcnt(0)
 s_barrier
 ds_write_b128 v2, v[160:163] offset:0
 ds_write_b128 v2, v[164:167] offset:1024
 ds_write_b128 v2, v[144:147] offset:2048
 ds_write_b128 v2, v[148:151] offset:3072
 ds_write_b128 v2, v[136:139] offset:4096
 ds_write_b128 v2, v[140:143] offset:5120
 ds_write_b128 v2, v[128:131] offset:6144
 ds_write_b128 v2, v[132:135] offset:7168
 s_waitcnt lgkmcnt(0)
 v_mov_b32 v160, v32
 v_mov_b32 v161, v33
 v_mov_b32 v162, v34
 v_mov_b32 v163, v35
 v_mov_b32 v164, v36
 v_mov_b32 v165, v37
 v_mov_b32 v166, v38
 v_mov_b32 v167, v39
 v_mov_b32 v144, v40
 v_mov_b32 v145, v41
 v_mov_b32 v146, v42
 v_mov_b32 v147, v43
 v_mov_b32 v148, v44
 v_mov_b32 v149, v45
 v_mov_b32 v150, v46
 v_mov_b32 v151, v47
 v_mov_b32 v136, v48
 v_mov_b32 v137, v49
 v_mov_b32 v138, v50
 v_mov_b32 v139, v51
 v_mov_b32 v140, v52
 v_mov_b32 v141, v53
 v_mov_b32 v142, v54
 v_mov_b32 v143, v55
 v_mov_b32 v128, v56
 v_mov_b32 v129, v57
 v_mov_b32 v130, v58
 v_mov_b32 v131, v59
 v_mov_b32 v132, v60
 v_mov_b32 v133, v61
 v_mov_b32 v134, v62
 v_mov_b32 v135, v63
 s_waitcnt vmcnt(10)
 s_barrier
 v_xor_b32 v16, 0, v12
 v_add_u32 v16, 98304, v16
 ds_read_b64_tr_b16 v[32:33], v16 offset:0
 ds_read_b64_tr_b16 v[34:35], v16 offset:8192
 ds_read_b64_tr_b16 v[36:37], v16 offset:2048
 ds_read_b64_tr_b16 v[38:39], v16 offset:10240
 v_xor_b32 v16, 32, v12
 v_add_u32 v16, 98304, v16
 ds_read_b64_tr_b16 v[40:41], v16 offset:0
 ds_read_b64_tr_b16 v[42:43], v16 offset:8192
 ds_read_b64_tr_b16 v[44:45], v16 offset:2048
 ds_read_b64_tr_b16 v[46:47], v16 offset:10240
 v_xor_b32 v16, 0, v12
 v_add_u32 v16, 98304, v16
 ds_read_b64_tr_b16 v[48:49], v16 offset:16384
 ds_read_b64_tr_b16 v[50:51], v16 offset:24576
 ds_read_b64_tr_b16 v[52:53], v16 offset:18432
 ds_read_b64_tr_b16 v[54:55], v16 offset:26624
 v_xor_b32 v16, 32, v12
 v_add_u32 v16, 98304, v16
 ds_read_b64_tr_b16 v[56:57], v16 offset:16384
 ds_read_b64_tr_b16 v[58:59], v16 offset:24576
 ds_read_b64_tr_b16 v[60:61], v16 offset:18432
 ds_read_b64_tr_b16 v[62:63], v16 offset:26624
 s_waitcnt lgkmcnt(0)
 s_barrier
 ds_write_b128 v2, a[144:147] offset:32768
 ds_write_b128 v2, a[148:151] offset:33792
 ds_write_b128 v2, a[136:139] offset:34816
 ds_write_b128 v2, a[140:143] offset:35840
 ds_write_b128 v2, a[96:99] offset:36864
 ds_write_b128 v2, a[100:103] offset:37888
 ds_write_b128 v2, a[88:91] offset:38912
 ds_write_b128 v2, a[92:95] offset:39936
 s_waitcnt lgkmcnt(0)
 v_accvgpr_write_b32 a144, v32
 v_accvgpr_write_b32 a145, v33
 v_accvgpr_write_b32 a146, v34
 v_accvgpr_write_b32 a147, v35
 v_accvgpr_write_b32 a148, v36
 v_accvgpr_write_b32 a149, v37
 v_accvgpr_write_b32 a150, v38
 v_accvgpr_write_b32 a151, v39
 v_accvgpr_write_b32 a136, v40
 v_accvgpr_write_b32 a137, v41
 v_accvgpr_write_b32 a138, v42
 v_accvgpr_write_b32 a139, v43
 v_accvgpr_write_b32 a140, v44
 v_accvgpr_write_b32 a141, v45
 v_accvgpr_write_b32 a142, v46
 v_accvgpr_write_b32 a143, v47
 v_accvgpr_write_b32 a96, v48
 v_accvgpr_write_b32 a97, v49
 v_accvgpr_write_b32 a98, v50
 v_accvgpr_write_b32 a99, v51
 v_accvgpr_write_b32 a100, v52
 v_accvgpr_write_b32 a101, v53
 v_accvgpr_write_b32 a102, v54
 v_accvgpr_write_b32 a103, v55
 v_accvgpr_write_b32 a88, v56
 v_accvgpr_write_b32 a89, v57
 v_accvgpr_write_b32 a90, v58
 v_accvgpr_write_b32 a91, v59
 v_accvgpr_write_b32 a92, v60
 v_accvgpr_write_b32 a93, v61
 v_accvgpr_write_b32 a94, v62
 v_accvgpr_write_b32 a95, v63
 s_waitcnt vmcnt(0)
 s_barrier
 v_xor_b32 v16, 0, v12
 v_add_u32 v16, 131072, v16
 ds_read_b64_tr_b16 v[32:33], v16 offset:0
 ds_read_b64_tr_b16 v[34:35], v16 offset:8192
 ds_read_b64_tr_b16 v[36:37], v16 offset:2048
 ds_read_b64_tr_b16 v[38:39], v16 offset:10240
 v_xor_b32 v16, 32, v12
 v_add_u32 v16, 131072, v16
 ds_read_b64_tr_b16 v[40:41], v16 offset:0
 ds_read_b64_tr_b16 v[42:43], v16 offset:8192
 ds_read_b64_tr_b16 v[44:45], v16 offset:2048
 ds_read_b64_tr_b16 v[46:47], v16 offset:10240
 v_xor_b32 v16, 0, v12
 v_add_u32 v16, 131072, v16
 ds_read_b64_tr_b16 v[48:49], v16 offset:16384
 ds_read_b64_tr_b16 v[50:51], v16 offset:24576
 ds_read_b64_tr_b16 v[52:53], v16 offset:18432
 ds_read_b64_tr_b16 v[54:55], v16 offset:26624
 v_xor_b32 v16, 32, v12
 v_add_u32 v16, 131072, v16
 ds_read_b64_tr_b16 v[56:57], v16 offset:16384
 ds_read_b64_tr_b16 v[58:59], v16 offset:24576
 ds_read_b64_tr_b16 v[60:61], v16 offset:18432
 ds_read_b64_tr_b16 v[62:63], v16 offset:26624
 s_waitcnt lgkmcnt(0)
 s_barrier
 ds_write_b128 v3, a[80:83] offset:16384
 ds_write_b128 v3, a[84:87] offset:17408
 ds_write_b128 v3, a[64:67] offset:18432
 ds_write_b128 v3, a[68:71] offset:19456
 ds_write_b128 v3, a[40:43] offset:20480
 ds_write_b128 v3, a[44:47] offset:21504
 ds_write_b128 v3, a[24:27] offset:22528
 ds_write_b128 v3, a[28:31] offset:23552
 s_waitcnt lgkmcnt(0)
 v_accvgpr_write_b32 a80, v32
 v_accvgpr_write_b32 a81, v33
 v_accvgpr_write_b32 a82, v34
 v_accvgpr_write_b32 a83, v35
 v_accvgpr_write_b32 a84, v36
 v_accvgpr_write_b32 a85, v37
 v_accvgpr_write_b32 a86, v38
 v_accvgpr_write_b32 a87, v39
 v_accvgpr_write_b32 a64, v40
 v_accvgpr_write_b32 a65, v41
 v_accvgpr_write_b32 a66, v42
 v_accvgpr_write_b32 a67, v43
 v_accvgpr_write_b32 a68, v44
 v_accvgpr_write_b32 a69, v45
 v_accvgpr_write_b32 a70, v46
 v_accvgpr_write_b32 a71, v47
 v_accvgpr_write_b32 a40, v48
 v_accvgpr_write_b32 a41, v49
 v_accvgpr_write_b32 a42, v50
 v_accvgpr_write_b32 a43, v51
 v_accvgpr_write_b32 a44, v52
 v_accvgpr_write_b32 a45, v53
 v_accvgpr_write_b32 a46, v54
 v_accvgpr_write_b32 a47, v55
 v_accvgpr_write_b32 a24, v56
 v_accvgpr_write_b32 a25, v57
 v_accvgpr_write_b32 a26, v58
 v_accvgpr_write_b32 a27, v59
 v_accvgpr_write_b32 a28, v60
 v_accvgpr_write_b32 a29, v61
 v_accvgpr_write_b32 a30, v62
 v_accvgpr_write_b32 a31, v63
 v_lshlrev_b32 v5, 3, v0
 v_and_b32 v6, 0x1e0, v5
 v_and_b32 v7, 1, v0
 v_lshl_add_u32 v6, v7, 4, v6
 v_and_b32 v7, 2, v0
 v_lshl_add_u32 v6, v7, 2, v6
 v_bfe_u32 v4, v0, 2, 2
 v_lshrrev_b32 v7, 4, v0
 v_cmp_eq_u32 vcc, v4, v7
 v_and_b32 v7, 16, v1
 v_mov_b32 v5, 0x3f80
 v_lshlrev_b32 v7, v7, v5
 v_cndmask_b32 v4, 0, v7, vcc
 v_mov_b32 v5, 0
 s_lshl_b32 s59, s53, 16
 s_add_u32 s59, s59, 983040
 s_mul_i32 s15, s53, 327680
 s_add_u32 s15, s15, 225280
 s_lshl_b32 s3, s52, 8
 s_add_u32 s15, s15, s3
 s_add_u32 s64, s15, 0
 s_add_u32 s65, s15, 81920
 s_add_u32 s66, s15, 163840
 s_add_u32 s67, s15, 245760
 s_lshr_b32 s14, s52, 2
 s_and_b32 s15, s52, 3
 s_mov_b32 s16, 0
 s_mov_b32 s84, 0x00ff00ff
 s_mov_b32 s85, 0
 s_lshl_b32 s57, s14, 10
 s_lshl_b32 s3, s15, 6
 s_add_u32 s57, s57, s3
 s_lshl_b32 s3, s16, 8
 s_add_u32 s57, s57, s3
 s_add_u32 s57, s57, s59
 s_add_u32 s59, s59, 0
 s_lshl_b32 s14, s14, 7
 s_mul_i32 s15, s15, 2560
 s_add_u32 s14, s14, s15
 s_lshl_b32 s3, s16, 3
 s_add_u32 s14, s14, s3
 s_mov_b32 s8, s18
 s_and_b32 s9, s19, 0xffff
 s_mov_b32 s10, 10240
 s_mov_b32 s11, 0x00020000
 v_bfe_u32 v40, v0, 4, 1
 v_mul_u32_u24 v40, 1280, v40
 v_and_b32 v41, 7, v0
 v_lshl_add_u32 v40, v41, 1, v40
 buffer_load_ushort v44, v40, s[8:11], s14 offen offset:0
 buffer_load_ushort v45, v40, s[8:11], s14 offen offset:32
 buffer_load_ushort v46, v40, s[8:11], s14 offen offset:64
 buffer_load_ushort v47, v40, s[8:11], s14 offen offset:96
 v_lshrrev_b32 v42, 7, v1
 v_mul_u32_u24 v42, 10240, v42
 v_and_b32 v7, 112, v1
 v_add_u32 v42, v42, v7
 v_and_b32 v43, 32, v1
 v_and_b32 v7, 64, v1
 v_lshl_add_u32 v43, v7, 2, v43
 v_bfe_u32 v7, v1, 8, 1
 v_lshl_add_u32 v43, v7, 4, v43
 v_bfe_u32 v7, v1, 4, 1
 v_lshl_add_u32 v43, v7, 3, v43
 s_waitcnt vmcnt(2)
 v_lshl_or_b32 v44, v45, 16, v44
 s_waitcnt vmcnt(0)
 v_lshl_or_b32 v45, v47, 16, v46
 s_add_u32 s16, s60, 8192
 s_waitcnt vmcnt(0) lgkmcnt(0)
 s_mov_b32 s96, s44
 s_and_b32 s97, s45, 0xffff
 s_mov_b32 s98, 256
 s_mov_b32 s99, 0x00020000
 v_mov_b32 v8, 132
 s_mov_b32 s51, 0
 s_mov_b64 exec, 1
L_wb_160:
 buffer_load_dword v9, v8, s[96:99], 0 offen sc1
 s_waitcnt vmcnt(0)
 v_cmp_eq_u32 vcc, 0, v9
 s_cbranch_vccz L_wbd_161
 s_sleep 2
 s_add_u32 s51, s51, 1
 s_cmp_lt_u32 s51, 131072
 s_cbranch_scc1 L_wb_160
 s_branch L_bail
L_wbd_161:
 s_mov_b64 exec, -1
 s_mov_b32 s96, s44
 s_and_b32 s97, s45, 0xffff
 s_mov_b32 s98, 256
 s_mov_b32 s99, 0x00020000
 v_mov_b32 v8, 212
 s_mov_b32 s51, 0
 s_mov_b64 exec, 1
L_wb_162:
 buffer_load_dword v9, v8, s[96:99], 0 offen sc1
 s_waitcnt vmcnt(0)
 v_cmp_eq_u32 vcc, 0, v9
 s_cbranch_vccz L_wbd_163
 s_sleep 2
 s_add_u32 s51, s51, 1
 s_cmp_lt_u32 s51, 131072
 s_cbranch_scc1 L_wb_162
 s_branch L_bail
L_wbd_163:
 s_mov_b64 exec, -1
 s_mov_b32 s96, s44
 s_and_b32 s97, s45, 0xffff
 s_mov_b32 s98, 256
 s_mov_b32 s99, 0x00020000
 v_lshlrev_b32 v8, 5, v0
 s_mov_b32 s51, 0
L_gl_164:
 buffer_load_dword v9, v8, s[96:99], 0 offen sc1
 s_waitcnt vmcnt(0)
 v_readlane_b32 s3, v9, s48
 s_mov_b32 s80, 0
 s_nop 2
 s_cmp_ge_u32 s3, 32
 s_cbranch_scc1 L_gld_165
 s_mov_b32 s80, 0
 v_readlane_b32 s3, v9, 0
 s_nop 3
 s_add_u32 s80, s80, s3
 v_readlane_b32 s3, v9, 1
 s_nop 3
 s_add_u32 s80, s80, s3
 v_readlane_b32 s3, v9, 2
 s_nop 3
 s_add_u32 s80, s80, s3
 v_readlane_b32 s3, v9, 3
 s_nop 3
 s_add_u32 s80, s80, s3
 v_readlane_b32 s3, v9, 4
 s_nop 3
 s_add_u32 s80, s80, s3
 v_readlane_b32 s3, v9, 5
 s_nop 3
 s_add_u32 s80, s80, s3
 v_readlane_b32 s3, v9, 6
 s_nop 3
 s_add_u32 s80, s80, s3
 v_readlane_b32 s3, v9, 7
 s_nop 3
 s_add_u32 s80, s80, s3
 s_cmp_ge_u32 s80, 256
 s_cbranch_scc1 L_gld_165
 s_sleep 4
 s_add_u32 s51, s51, 1
 s_cmp_lt_u32 s51, 131072
 s_cbranch_scc1 L_gl_164
 s_branch L_bail
L_gld_165:
 s_mov_b64 exec, s[84:85]
 buffer_store_dwordx2 v[44:45], v43, s[4:7], s57 offen sc1
 s_mov_b64 exec, -1
 v_and_b32 v7, 2, v0
 v_mul_u32_u24 v7, 0x5555, v7
 v_add_u32 v0, 0x4444, v7
 s_mov_b32 m0, 2048
 s_waitcnt vmcnt(0) lgkmcnt(0)
 s_barrier
 buffer_load_dwordx4 v[32:35], v1, s[4:7], s63 offen offset:0
 buffer_load_dwordx4 v[36:39], v1, s[4:7], s63 offen offset:1024
 buffer_load_dwordx4 v[40:43], v1, s[4:7], s63 offen offset:2048
 buffer_load_dwordx4 v[44:47], v1, s[4:7], s63 offen offset:3072
 buffer_load_dwordx4 v[48:51], v1, s[4:7], s81 offen offset:0
 buffer_load_dwordx4 v[52:55], v1, s[4:7], s81 offen offset:1024
 buffer_load_dwordx4 v[56:59], v1, s[4:7], s81 offen offset:2048
 buffer_load_dwordx4 v[60:63], v1, s[4:7], s81 offen offset:3072
 ds_read_b128 v[8:11], v3 offset:49152
 ds_read_b128 v[12:15], v3 offset:49152
 ds_read_b128 v[16:19], v3 offset:49152
 ds_read_b128 v[20:23], v3 offset:49152
 s_waitcnt vmcnt(0) lgkmcnt(0)
 s_cmp_lg_u32 s80, 0
 s_cbranch_scc1 L_ch0_s
.p2align 6
L_ch0_f:
 s_mov_b32 s51, 0
L_pm_166:
 buffer_load_dwordx4 v[24:27], v1, s[4:7], s59 offen offset:0 sc1
 buffer_load_dwordx4 v[28:31], v1, s[4:7], s59 offen offset:1024 sc1
 s_waitcnt vmcnt(1)
 ds_write_b128 v1, v[24:27] offset:0
 v_max_u32 v7, v24, v26
 s_waitcnt vmcnt(0)
 ds_write_b128 v1, v[28:31] offset:1024
 v_max3_u32 v7, v7, v28, v30
 v_cmp_eq_u32 vcc, -1, v7
 s_cbranch_vccnz L_rt_167
 v_smfmac_f32_16x16x64_bf16 v[16:19], v[24:27], v[32:39], v0
 ds_read_b128 v[32:35], v2 offset:6144
 ds_read_b128 v[36:39], v2 offset:7168
 v_smfmac_f32_16x16x64_bf16 v[20:23], v[24:27], v[40:47], v0
 ds_read_b128 v[40:43], v2 offset:4096
 ds_read_b128 v[44:47], v2 offset:5120
 v_smfmac_f32_16x16x64_bf16 v[16:19], v[28:31], v[48:55], v0
 v_smfmac_f32_16x16x64_bf16 v[20:23], v[28:31], v[56:63], v0
 s_waitcnt lgkmcnt(4)
 s_barrier
 buffer_load_dwordx4 v[56:59], v1, s[4:7], s101 offen offset:0
 v_smfmac_f32_16x16x64_bf16 v[8:11], v[24:27], v[240:247], v0
 v_smfmac_f32_16x16x64_bf16 v[12:15], v[24:27], v[248:255], v0
 ds_read_b128 v[24:27], v1 offset:2048
 buffer_load_dwordx4 v[60:63], v1, s[4:7], s101 offen offset:1024
 v_smfmac_f32_16x16x64_bf16 v[8:11], v[28:31], v[224:231], v0
 v_smfmac_f32_16x16x64_bf16 v[12:15], v[28:31], v[216:223], v0
 ds_read_b128 v[28:31], v1 offset:3072
 buffer_load_dwordx4 v[48:51], v1, s[4:7], s101 offen offset:2048
 s_waitcnt lgkmcnt(1)
 v_smfmac_f32_16x16x64_bf16 v[16:19], v[24:27], v[32:39], v0
 ds_read_b128 v[32:35], v2 offset:2048
 ds_read_b128 v[36:39], v2 offset:3072
 v_smfmac_f32_16x16x64_bf16 v[8:11], v[24:27], v[200:207], v0
 buffer_load_dwordx4 v[52:55], v1, s[4:7], s101 offen offset:3072
 v_smfmac_f32_16x16x64_bf16 v[12:15], v[24:27], v[192:199], v0
 v_smfmac_f32_16x16x64_bf16 v[20:23], v[24:27], v[40:47], v0
 ds_read_b128 v[40:43], v2 offset:0
 ds_read_b128 v[44:47], v2 offset:1024
 ds_read_b128 v[24:27], v1 offset:4096
 s_waitcnt lgkmcnt(5)
 v_smfmac_f32_16x16x64_bf16 v[8:11], v[28:31], v[184:191], v0
 v_smfmac_f32_16x16x64_bf16 v[12:15], v[28:31], v[176:183], v0
 s_waitcnt lgkmcnt(3)
 v_smfmac_f32_16x16x64_bf16 v[16:19], v[28:31], v[32:39], v0
 ds_read_b128 v[32:35], v1 offset:38912
 ds_read_b128 v[36:39], v1 offset:39936
 v_smfmac_f32_16x16x64_bf16 v[20:23], v[28:31], v[152:159], v0
 ds_read_b128 v[28:31], v1 offset:5120
 s_waitcnt lgkmcnt(3)
 v_smfmac_f32_16x16x64_bf16 v[8:11], v[24:27], v[160:167], v0
 v_smfmac_f32_16x16x64_bf16 v[16:19], v[24:27], v[40:47], v0
 ds_read_b128 v[40:43], v1 offset:36864
 ds_read_b128 v[44:47], v1 offset:37888
 v_smfmac_f32_16x16x64_bf16 v[12:15], v[24:27], v[144:151], v0
 v_smfmac_f32_16x16x64_bf16 v[20:23], v[24:27], v[168:175], v0
 ds_read_b128 v[24:27], v1 offset:6144
 s_waitcnt lgkmcnt(3)
 v_smfmac_f32_16x16x64_bf16 v[16:19], v[28:31], v[32:39], v0
 ds_read_b128 v[32:35], v1 offset:34816
 ds_read_b128 v[36:39], v1 offset:35840
 v_smfmac_f32_16x16x64_bf16 v[8:11], v[28:31], v[136:143], v0
 v_smfmac_f32_16x16x64_bf16 v[12:15], v[28:31], v[128:135], v0
 s_waitcnt lgkmcnt(3)
 v_smfmac_f32_16x16x64_bf16 v[20:23], v[28:31], v[40:47], v0
 ds_read_b128 v[40:43], v1 offset:32768
 ds_read_b128 v[44:47], v1 offset:33792
 ds_read_b128 v[28:31], v1 offset:7168
 s_waitcnt lgkmcnt(5)
 v_smfmac_f32_16x16x64_bf16 v[8:11], v[24:27], a[144:151], v0
 v_smfmac_f32_16x16x64_bf16 v[12:15], v[24:27], a[136:143], v0
 s_waitcnt lgkmcnt(3)
 v_smfmac_f32_16x16x64_bf16 v[16:19], v[24:27], v[32:39], v0
 ds_read_b128 v[32:35], v1 offset:18432
 ds_read_b128 v[36:39], v1 offset:19456
 s_waitcnt vmcnt(2)
 v_smfmac_f32_16x16x64_bf16 v[20:23], v[24:27], v[56:63], v0
 ds_read_b128 v[24:27], v1 offset:8192
 buffer_load_dwordx4 v[56:59], v1, s[4:7], s61 offen offset:0 sc1 nt
 s_waitcnt lgkmcnt(3)
 v_smfmac_f32_16x16x64_bf16 v[8:11], v[28:31], a[96:103], v0
 v_smfmac_f32_16x16x64_bf16 v[16:19], v[28:31], v[40:47], v0
 ds_read_b128 v[40:43], v1 offset:16384
 ds_read_b128 v[44:47], v1 offset:17408
 s_add_u32 s3, s61, 4096
 buffer_load_dwordx4 v[60:63], v1, s[4:7], s3 offen offset:0 sc1 nt
 v_smfmac_f32_16x16x64_bf16 v[12:15], v[28:31], a[88:95], v0
 v_smfmac_f32_16x16x64_bf16 v[20:23], v[28:31], v[208:215], v0
 ds_read_b128 v[28:31], v1 offset:9216
 s_waitcnt lgkmcnt(3)
 v_smfmac_f32_16x16x64_bf16 v[16:19], v[24:27], v[32:39], v0
 v_smfmac_f32_16x16x64_bf16 v[8:11], v[24:27], a[80:87], v0
 s_add_u32 s3, s61, 67108864
 buffer_load_dwordx4 v[32:35], v1, s[4:7], s3 offen offset:0 sc1 nt
 v_smfmac_f32_16x16x64_bf16 v[12:15], v[24:27], a[64:71], v0
 s_waitcnt lgkmcnt(1)
 v_smfmac_f32_16x16x64_bf16 v[20:23], v[24:27], v[40:47], v0
 ds_read_b128 v[40:43], v3 offset:49152
 ds_read_b128 v[44:47], v3 offset:49152
 buffer_load_dwordx4 v[36:39], v1, s[4:7], s3 offen offset:1024 sc1 nt
 s_waitcnt lgkmcnt(2)
 v_smfmac_f32_16x16x64_bf16 v[8:11], v[28:31], a[40:47], v0
 v_smfmac_f32_16x16x64_bf16 v[12:15], v[28:31], a[24:31], v0
 v_smfmac_f32_16x16x64_bf16 v[16:19], v[28:31], v[232:239], v0
 s_waitcnt vmcnt(4)
 v_smfmac_f32_16x16x64_bf16 v[20:23], v[28:31], v[48:55], v0
 ds_read_b128 v[52:55], v1 offset:0
 v_add_f32 v8, v8, v10
 v_add_f32 v11, v9, v11
 v_cvt_pk_bf16_f32 v9, v8, v11
 v_cvt_pk_bf16_f32 v8, v8, v11
 v_add_f32 v12, v12, v14
 v_add_f32 v15, v13, v15
 v_cvt_pk_bf16_f32 v13, v12, v15
 v_cvt_pk_bf16_f32 v12, v12, v15
 v_mfma_f32_16x16x16_bf16 v[8:11], v[8:9], v[4:5], 0
 v_mfma_f32_16x16x16_bf16 v[12:15], v[12:13], v[4:5], 0
 v_add_f32 v16, v16, v18
 v_add_f32 v19, v17, v19
 v_cvt_pk_bf16_f32 v17, v16, v19
 v_cvt_pk_bf16_f32 v16, v16, v19
 v_add_f32 v20, v20, v22
 v_add_f32 v23, v21, v23
 v_cvt_pk_bf16_f32 v21, v20, v23
 v_cvt_pk_bf16_f32 v20, v20, v23
 v_mfma_f32_16x16x16_bf16 v[16:19], v[16:17], v[4:5], 0
 v_mfma_f32_16x16x16_bf16 v[20:23], v[20:21], v[4:5], 0
 s_waitcnt lgkmcnt(2)
 v_smfmac_f32_16x16x64_bf16 v[40:43], v[24:27], v[96:103], v0
 s_waitcnt lgkmcnt(1)
 v_smfmac_f32_16x16x64_bf16 v[44:47], v[24:27], v[104:111], v0
 ds_read_b128 v[24:27], v1 offset:1024
 v_cvt_pk_bf16_f32 v15, v14, v15
 v_cvt_pk_bf16_f32 v14, v12, v13
 v_cvt_pk_bf16_f32 v13, v10, v11
 v_cvt_pk_bf16_f32 v12, v8, v9
 s_waitcnt vmcnt(3)
 s_nop 0
 v_mfma_f32_16x16x32_bf16 v[8:11], v[56:59], v[12:15], 0
 v_cvt_pk_bf16_f32 v23, v22, v23
 v_cvt_pk_bf16_f32 v22, v20, v21
 v_cvt_pk_bf16_f32 v21, v18, v19
 v_cvt_pk_bf16_f32 v20, v16, v17
 s_waitcnt vmcnt(2)
 v_mfma_f32_16x16x32_bf16 v[16:19], v[60:63], v[12:15], 0
 v_mfma_f32_16x16x32_bf16 v[48:51], v[20:23], v[12:15], 0
 v_smfmac_f32_16x16x64_bf16 v[40:43], v[28:31], v[112:119], v0
 v_smfmac_f32_16x16x64_bf16 v[44:47], v[28:31], v[120:127], v0
 ds_read_b128 v[28:31], v1 offset:2048
 s_waitcnt lgkmcnt(2)
 v_smfmac_f32_16x16x64_bf16 v[40:43], v[52:55], a[160:167], v0
 v_cndmask_b32 v8, v8, v16, s[70:71]
 v_cndmask_b32 v9, v9, v17, s[70:71]
 v_cndmask_b32 v10, v10, v18, s[70:71]
 v_cndmask_b32 v11, v11, v19, s[70:71]
 ds_write_b128 v1, v[8:11] offset:10240
 ds_write_b64 v1, v[48:49] offset:14336
 v_smfmac_f32_16x16x64_bf16 v[44:47], v[52:55], a[168:175], v0
 ds_read_b128 v[52:55], v1 offset:3072
 s_waitcnt lgkmcnt(4)
 v_smfmac_f32_16x16x64_bf16 v[40:43], v[24:27], a[176:183], v0
 v_smfmac_f32_16x16x64_bf16 v[44:47], v[24:27], a[184:191], v0
 ds_read_b128 v[24:27], v1 offset:4096
 s_waitcnt lgkmcnt(4)
 v_smfmac_f32_16x16x64_bf16 v[40:43], v[28:31], a[192:199], v0
 v_smfmac_f32_16x16x64_bf16 v[44:47], v[28:31], a[200:207], v0
 ds_read_b128 v[28:31], v1 offset:5120
 s_waitcnt lgkmcnt(2)
 v_smfmac_f32_16x16x64_bf16 v[40:43], v[52:55], a[208:215], v0
 v_smfmac_f32_16x16x64_bf16 v[44:47], v[52:55], a[216:223], v0
 ds_read_b128 v[52:55], v1 offset:6144
 s_barrier
 ds_read_b128 v[56:59], v1 offset:11264
 ds_read_b128 v[60:63], v1 offset:12288
 ds_read_b128 v[16:19], v1 offset:13312
 ds_read_b128 v[12:15], v1 offset:14336
 ds_read_b128 v[48:51], v1 offset:15360
 s_waitcnt lgkmcnt(7)
 v_smfmac_f32_16x16x64_bf16 v[40:43], v[24:27], a[224:231], v0
 s_mov_b64 exec, s[68:69]
 buffer_store_dwordx4 v[20:23], v6, s[4:7], s62 offen offset:0 sc1
 s_mov_b64 exec, -1
 v_smfmac_f32_16x16x64_bf16 v[44:47], v[24:27], a[232:239], v0
 ds_read_b128 v[24:27], v1 offset:7168
 s_waitcnt lgkmcnt(7)
 v_smfmac_f32_16x16x64_bf16 v[40:43], v[28:31], a[240:247], v0
 v_smfmac_f32_16x16x64_bf16 v[44:47], v[28:31], a[248:255], v0
 s_waitcnt lgkmcnt(6)
 v_smfmac_f32_16x16x64_bf16 v[40:43], v[52:55], v[64:71], v0
 v_smfmac_f32_16x16x64_bf16 v[44:47], v[52:55], v[72:79], v0
 s_waitcnt lgkmcnt(0)
 v_smfmac_f32_16x16x64_bf16 v[40:43], v[24:27], v[80:87], v0
 v_smfmac_f32_16x16x64_bf16 v[44:47], v[24:27], v[88:95], v0
 v_pk_add_f32 v[8:9], v[8:9], v[56:57]
 v_pk_add_f32 v[10:11], v[10:11], v[58:59]
 v_pk_add_f32 v[60:61], v[60:61], v[16:17]
 v_pk_add_f32 v[62:63], v[62:63], v[18:19]
 v_pk_add_f32 v[12:13], v[12:13], v[14:15]
 v_pk_add_f32 v[48:49], v[48:49], v[50:51]
 v_pk_add_f32 v[8:9], v[8:9], v[60:61]
 v_pk_add_f32 v[10:11], v[10:11], v[62:63]
 v_pk_add_f32 v[48:49], v[12:13], v[48:49]
 v_max3_f32 v50, v8, v9, v10
 v_max3_f32 v50, v50, v11, v48
 v_max_f32 v50, v50, v49
 v_add_f32 v40, v40, v42
 v_add_f32 v41, v41, v43
 v_max_f32_dpp v50, v50, v50 quad_perm:[2,3,0,1] row_mask:0xf bank_mask:0xf
 v_mov_b32 v51, v50
 v_add_f32 v44, v44, v46
 v_add_f32 v45, v45, v47
 v_permlane16_swap_b32 v50, v51
 v_max_f32 v50, v50, v51
 v_mov_b32 v51, v50
 v_cvt_pk_bf16_f32 v40, v40, v41
 v_cvt_pk_bf16_f32 v41, v44, v45
 v_permlane32_swap_b32 v50, v51
 v_max_f32 v50, v50, v51
 v_mul_f32 v50, s56, v50
 v_fma_f32 v48, v48, s56, -v50
 v_fma_f32 v49, v49, s56, -v50
 v_fma_f32 v8, v8, s56, -v50
 v_fma_f32 v9, v9, s56, -v50
 v_fma_f32 v10, v10, s56, -v50
 v_fma_f32 v11, v11, s56, -v50
 v_exp_f32 v48, v48
 v_lshrrev_b32 v51, 1, v1
 v_exp_f32 v49, v49
 ds_read_b128 v[56:59], v3 offset:18432
 ds_read_b128 v[60:63], v3 offset:19456
 v_exp_f32 v8, v8
 v_exp_f32 v9, v9
 ds_read_b128 v[24:27], v2 offset:36864
 ds_read_b128 v[28:31], v2 offset:37888
 v_exp_f32 v10, v10
 buffer_store_dwordx2 v[40:41], v51, s[4:7], s62 offen offset:2048 sc1
 v_exp_f32 v11, v11
 v_cvt_pk_bf16_f32 v14, v48, v49
 v_cvt_pk_bf16_f32 v12, v8, v9
 v_cvt_pk_bf16_f32 v13, v10, v11
 v_cndmask_b32 v52, 0, v14, s[68:69]
 v_cndmask_b32 v53, 0, v14, s[70:71]
 v_cndmask_b32 v22, 0, v12, s[70:71]
 v_cndmask_b32 v23, 0, v13, s[70:71]
 v_mfma_f32_16x16x16_bf16 v[44:47], v[40:41], v[52:53], 0
 v_cndmask_b32 v16, 0, v12, s[68:69]
 v_cndmask_b32 v17, 0, v13, s[68:69]
 v_mov_b32_dpp v18, v22 quad_perm:[2,3,0,1] row_mask:0xf bank_mask:0xf
 v_mov_b32_dpp v19, v23 quad_perm:[2,3,0,1] row_mask:0xf bank_mask:0xf
 v_mov_b32_dpp v20, v16 quad_perm:[2,3,0,1] row_mask:0xf bank_mask:0xf
 v_mov_b32_dpp v21, v17 quad_perm:[2,3,0,1] row_mask:0xf bank_mask:0xf
 s_waitcnt vmcnt(3)
 v_mfma_f32_16x16x32_bf16 v[44:47], v[32:35], v[16:19], v[44:47]
 v_add_f32 v54, v8, v9
 v_add_f32 v55, v48, v49
 s_waitcnt vmcnt(2)
 v_mfma_f32_16x16x32_bf16 v[44:47], v[36:39], v[20:23], v[44:47]
 v_add_f32 v54, v54, v10
 v_fma_f32 v55, v55, 0.5, v11
 v_add_f32 v54, v54, v55
 ds_read_b128 v[16:19], v3 offset:49152
 ds_read_b128 v[20:23], v3 offset:49152
 v_add_f32_dpp v54, v54, v54 quad_perm:[2,3,0,1] row_mask:0xf bank_mask:0xf
 v_mov_b32 v55, v54
 ds_read_b128 v[32:35], v3 offset:49152
 ds_read_b128 v[36:39], v3 offset:49152
 v_permlane16_swap_b32 v54, v55
 v_add_f32 v54, v54, v55
 v_mov_b32 v55, v54
 ds_read_b128 v[8:11], v3 offset:49152
 s_cmp_eq_u32 s54, 63
 v_permlane32_swap_b32 v54, v55
 v_add_f32 v54, v54, v55
 v_rcp_f32 v54, v54
 s_cbranch_scc1 L_ch0_end
 v_mul_f32 v44, v44, v54
 v_mul_f32 v45, v45, v54
 v_cvt_pk_bf16_f32 v42, v44, v45
 v_mul_f32 v46, v46, v54
 v_mul_f32 v47, v47, v54
 v_cvt_pk_bf16_f32 v43, v46, v47
 ds_write_b64 v6, v[42:43] offset:0
 v_and_b32 v40, -9, v6
 v_mov_b32_dpp v12, v42 quad_perm:[0,1,0,1] row_mask:0xf bank_mask:0xf
 v_mov_b32_dpp v14, v42 quad_perm:[2,3,2,3] row_mask:0xf bank_mask:0xf
 v_mov_b32_dpp v13, v43 quad_perm:[0,1,0,1] row_mask:0xf bank_mask:0xf
 v_mov_b32_dpp v15, v43 quad_perm:[2,3,2,3] row_mask:0xf bank_mask:0xf
 s_waitcnt lgkmcnt(5)
 s_nop 0
 v_smfmac_f32_16x16x64_bf16 v[16:19], v[12:15], a[0:7], v0
 s_waitcnt lgkmcnt(4)
 v_smfmac_f32_16x16x64_bf16 v[20:23], v[12:15], a[32:39], v0
 s_waitcnt lgkmcnt(0)
 s_barrier
 ds_read_b128 v[48:51], v40 offset:512
 ds_read_b128 v[52:55], v40 offset:1024
 ds_read_b128 v[44:47], v40 offset:1536
 v_smfmac_f32_16x16x64_bf16 v[32:35], v[12:15], v[56:63], v0
 ds_read_b128 v[56:59], v3 offset:22528
 ds_read_b128 v[60:63], v3 offset:23552
 s_mov_b32 m0, 8192
 v_smfmac_f32_16x16x64_bf16 v[36:39], v[12:15], v[24:31], v0
 ds_read_b128 v[24:27], v3 offset:20480
 ds_read_b128 v[28:31], v3 offset:21504
 buffer_load_dwordx4 v1, s[4:7], s63 offen offset:2048 lds
 v_smfmac_f32_16x16x64_bf16 v[8:11], v[12:15], a[128:135], v0
 s_mov_b32 m0, 8192
 s_waitcnt lgkmcnt(6)
 v_smfmac_f32_16x16x64_bf16 v[16:19], v[48:51], a[8:15], v0
 buffer_load_dwordx4 v1, s[4:7], s63 offen offset:3072 lds
 s_waitcnt lgkmcnt(5)
 v_smfmac_f32_16x16x64_bf16 v[16:19], v[52:55], a[16:23], v0
 s_mov_b32 m0, 14336
 s_waitcnt lgkmcnt(2)
 v_smfmac_f32_16x16x64_bf16 v[16:19], v[44:47], v[56:63], v0
 ds_read_b128 v[56:59], v3 offset:16384
 ds_read_b128 v[60:63], v3 offset:17408
 buffer_load_dwordx4 v1, s[4:7], s81 offen offset:0 lds
 s_waitcnt lgkmcnt(2)
 v_smfmac_f32_16x16x64_bf16 v[20:23], v[48:51], v[24:31], v0
 ds_read_b128 v[24:27], v2 offset:38912
 ds_read_b128 v[28:31], v2 offset:39936
 s_mov_b32 m0, 14336
 v_smfmac_f32_16x16x64_bf16 v[20:23], v[52:55], a[48:55], v0
 buffer_load_dwordx4 v1, s[4:7], s81 offen offset:1024 lds
 v_smfmac_f32_16x16x64_bf16 v[20:23], v[44:47], a[56:63], v0
 v_cvt_pk_bf16_f32 v16, v16, v17
 v_smfmac_f32_16x16x64_bf16 v[32:35], v[48:51], a[72:79], v0
 v_cvt_pk_bf16_f32 v17, v18, v19
 s_waitcnt lgkmcnt(2)
 v_smfmac_f32_16x16x64_bf16 v[32:35], v[52:55], v[56:63], v0
 ds_read_b128 v[56:59], v2 offset:34816
 ds_read_b128 v[60:63], v2 offset:35840
 v_and_or_b32 v16, v16, -2, s55
 s_waitcnt lgkmcnt(2)
 v_smfmac_f32_16x16x64_bf16 v[32:35], v[44:47], v[24:31], v0
 ds_read_b128 v[24:27], v2 offset:32768
 ds_read_b128 v[28:31], v2 offset:33792
 v_cvt_pk_bf16_f32 v18, v20, v21
 v_smfmac_f32_16x16x64_bf16 v[36:39], v[48:51], a[104:111], v0
 v_cvt_pk_bf16_f32 v19, v22, v23
 v_smfmac_f32_16x16x64_bf16 v[36:39], v[52:55], a[112:119], v0
 v_and_or_b32 v18, v18, -2, s55
 buffer_store_dwordx4 v[16:19], v1, s[4:7], s60 offen offset:0
 v_smfmac_f32_16x16x64_bf16 v[36:39], v[44:47], a[120:127], v0
 v_cvt_pk_bf16_f32 v32, v32, v33
 s_waitcnt lgkmcnt(2)
 v_smfmac_f32_16x16x64_bf16 v[8:11], v[48:51], v[56:63], v0
 v_cvt_pk_bf16_f32 v33, v34, v35
 s_waitcnt lgkmcnt(0)
 v_smfmac_f32_16x16x64_bf16 v[8:11], v[52:55], v[24:31], v0
 v_and_or_b32 v32, v32, -2, s55
 v_smfmac_f32_16x16x64_bf16 v[8:11], v[44:47], a[152:159], v0
 v_cvt_pk_bf16_f32 v34, v36, v37
 v_cvt_pk_bf16_f32 v35, v38, v39
 v_and_or_b32 v34, v34, -2, s55
 buffer_store_dwordx4 v[32:35], v1, s[4:7], s60 offen offset:1024
 s_nop 3
 v_cvt_pk_bf16_f32 v8, v8, v9
 v_cvt_pk_bf16_f32 v9, v10, v11
 v_and_or_b32 v8, v8, -2, s55
 buffer_store_dwordx2 v[8:9], v1, s[4:7], s16 offen offset:0
 buffer_load_dwordx4 v[32:35], v1, s[4:7], s63 offen offset:0
 buffer_load_dwordx4 v[36:39], v1, s[4:7], s63 offen offset:1024
 s_add_u32 s54, s54, 1
 s_add_u32 s61, s61, 524288
 s_and_b32 s3, s54, 3
 s_cselect_b32 s3, 1, -3
 s_lshl_b32 s3, s3, 17
 s_add_u32 s62, s62, s3
 s_and_b32 s3, s54, 3
 s_cselect_b32 s3, 1, -3
 s_lshl_b32 s3, s3, 14
 s_add_u32 s57, s57, s3
 s_add_u32 s59, s59, s3
 s_xor_b32 s58, s57, 32768
 v_lshrrev_b32 v56, 7, v1
 v_mul_u32_u24 v56, 10240, v56
 v_and_b32 v60, 112, v1
 v_add_u32 v56, v56, v60
 v_and_b32 v57, 32, v1
 v_and_b32 v60, 64, v1
 v_lshl_add_u32 v57, v60, 2, v57
 v_bfe_u32 v60, v1, 8, 1
 v_lshl_add_u32 v57, v60, 4, v57
 v_bfe_u32 v60, v1, 4, 1
 v_lshl_add_u32 v57, v60, 3, v57
 v_mov_b32 v60, 0x3f80
 v_mov_b32 v28, 0x3f800000
 v_cndmask_b32 v60, v60, v28, s[82:83]
 v_cndmask_b32 v28, 0, v60, s[72:73]
 v_cndmask_b32 v29, 0, v60, s[74:75]
 v_cndmask_b32 v30, 0, v60, s[76:77]
 v_cndmask_b32 v31, 0, v60, s[78:79]
 v_mov_b64 v[58:59], -1
 s_mov_b64 exec, s[84:85]
 buffer_store_dwordx2 v[58:59], v57, s[4:7], s58 offen
 s_mov_b64 exec, -1
 s_nop 15
 s_nop 15
 s_nop 15
 s_nop 15
 s_nop 15
 s_mov_b32 s51, 0
 buffer_load_dwordx4 v[8:11], v56, s[4:7], s64 offen sc1
 buffer_load_dwordx4 v[12:15], v56, s[4:7], s65 offen sc1
 buffer_load_dwordx4 v[16:19], v56, s[4:7], s66 offen sc1
 buffer_load_dwordx4 v[20:23], v56, s[4:7], s67 offen sc1
L_pp_168:
 s_waitcnt vmcnt(3)
 v_mfma_f32_16x16x32_bf16 v[24:27], v[28:31], v[8:11], 0
 v_bitop3_b32 v60, v8, v10, s55 bitop3:0x7e
 s_waitcnt vmcnt(2)
 v_mfma_f32_16x16x32_bf16 v[24:27], v[28:31], v[12:15], v[24:27]
 v_bitop3_b32 v61, v12, v14, s55 bitop3:0x7e
 s_waitcnt vmcnt(1)
 v_mfma_f32_16x16x32_bf16 v[24:27], v[28:31], v[16:19], v[24:27]
 v_bitop3_b32 v62, v16, v18, s55 bitop3:0x7e
 s_waitcnt vmcnt(0)
 v_mfma_f32_16x16x32_bf16 v[24:27], v[28:31], v[20:23], v[24:27]
 v_bitop3_b32 v63, v20, v22, s55 bitop3:0x7e
 v_or3_b32 v7, v60, v61, v62
 v_bitop3_b32 v7, v7, v63, 1 bitop3:0xa8
 v_cmp_ne_u32 vcc, 0, v7
 s_cbranch_vccnz L_rt_169
 s_nop 2
 v_add_f32_dpp v24, v24, v24 row_ror:8 row_mask:0xf bank_mask:0xf
 v_add_f32_dpp v25, v25, v25 row_ror:8 row_mask:0xf bank_mask:0xf
 v_add_f32_dpp v26, v26, v26 row_ror:8 row_mask:0xf bank_mask:0xf
 v_add_f32_dpp v27, v27, v27 row_ror:8 row_mask:0xf bank_mask:0xf
 s_mov_b64 exec, s[84:85]
 v_cvt_pk_bf16_f32 v24, v24, v25
 v_cvt_pk_bf16_f32 v25, v26, v27
 buffer_store_dwordx2 v[24:25], v57, s[4:7], s57 offen
 s_mov_b64 exec, -1
 s_xor_b32 s55, s55, 1
 ds_read_b128 v[40:43], v1 offset:10240
 ds_read_b128 v[44:47], v1 offset:11264
 ds_read_b128 v[48:51], v1 offset:14336
 ds_read_b128 v[52:55], v1 offset:15360
 buffer_load_dwordx4 v[56:59], v1, s[4:7], s81 offen offset:2048
 buffer_load_dwordx4 v[60:63], v1, s[4:7], s81 offen offset:3072
 ds_read_b128 v[8:11], v3 offset:49152
 ds_read_b128 v[12:15], v3 offset:49152
 ds_read_b128 v[16:19], v3 offset:49152
 ds_read_b128 v[20:23], v3 offset:49152
 s_waitcnt lgkmcnt(0)
 s_nop 15
 s_nop 15
 s_nop 7
 s_branch L_ch0_f
L_rt_167:
 s_add_u32 s51, s51, 1
 s_cmp_lt_u32 s51, 131072
 s_cbranch_scc1 L_pm_166
 s_branch L_bail
L_rt_169:
 buffer_load_dwordx4 v[8:11], v56, s[4:7], s64 offen sc1
 buffer_load_dwordx4 v[12:15], v56, s[4:7], s65 offen sc1
 buffer_load_dwordx4 v[16:19], v56, s[4:7], s66 offen sc1
 buffer_load_dwordx4 v[20:23], v56, s[4:7], s67 offen sc1
 s_add_u32 s51, s51, 1
 s_cmp_lt_u32 s51, 131072
 s_cbranch_scc1 L_pp_168
 s_branch L_bail
.p2align 6
L_ch0_s:
 s_mov_b32 s51, 0
L_pm_170:
 buffer_load_dwordx4 v[24:27], v1, s[4:7], s59 offen offset:0 sc1
 buffer_load_dwordx4 v[28:31], v1, s[4:7], s59 offen offset:1024 sc1
 s_waitcnt vmcnt(1)
 ds_write_b128 v1, v[24:27] offset:0
 v_max_u32 v7, v24, v26
 s_waitcnt vmcnt(0)
 ds_write_b128 v1, v[28:31] offset:1024
 v_max3_u32 v7, v7, v28, v30
 v_cmp_eq_u32 vcc, -1, v7
 s_cbranch_vccnz L_rt_171
 v_smfmac_f32_16x16x64_bf16 v[16:19], v[24:27], v[32:39], v0
 ds_read_b128 v[32:35], v2 offset:6144
 ds_read_b128 v[36:39], v2 offset:7168
 v_smfmac_f32_16x16x64_bf16 v[20:23], v[24:27], v[40:47], v0
 ds_read_b128 v[40:43], v2 offset:4096
 ds_read_b128 v[44:47], v2 offset:5120
 v_smfmac_f32_16x16x64_bf16 v[16:19], v[28:31], v[48:55], v0
 v_smfmac_f32_16x16x64_bf16 v[20:23], v[28:31], v[56:63], v0
 s_waitcnt lgkmcnt(4)
 s_barrier
 buffer_load_dwordx4 v[56:59], v1, s[4:7], s101 offen offset:0
 v_smfmac_f32_16x16x64_bf16 v[8:11], v[24:27], v[240:247], v0
 v_smfmac_f32_16x16x64_bf16 v[12:15], v[24:27], v[248:255], v0
 ds_read_b128 v[24:27], v1 offset:2048
 buffer_load_dwordx4 v[60:63], v1, s[4:7], s101 offen offset:1024
 v_smfmac_f32_16x16x64_bf16 v[8:11], v[28:31], v[224:231], v0
 v_smfmac_f32_16x16x64_bf16 v[12:15], v[28:31], v[216:223], v0
 ds_read_b128 v[28:31], v1 offset:3072
 buffer_load_dwordx4 v[48:51], v1, s[4:7], s101 offen offset:2048
 s_waitcnt lgkmcnt(1)
 v_smfmac_f32_16x16x64_bf16 v[16:19], v[24:27], v[32:39], v0
 ds_read_b128 v[32:35], v2 offset:2048
 ds_read_b128 v[36:39], v2 offset:3072
 v_smfmac_f32_16x16x64_bf16 v[8:11], v[24:27], v[200:207], v0
 buffer_load_dwordx4 v[52:55], v1, s[4:7], s101 offen offset:3072
 v_smfmac_f32_16x16x64_bf16 v[12:15], v[24:27], v[192:199], v0
 v_smfmac_f32_16x16x64_bf16 v[20:23], v[24:27], v[40:47], v0
 ds_read_b128 v[40:43], v2 offset:0
 ds_read_b128 v[44:47], v2 offset:1024
 ds_read_b128 v[24:27], v1 offset:4096
 s_waitcnt lgkmcnt(5)
 v_smfmac_f32_16x16x64_bf16 v[8:11], v[28:31], v[184:191], v0
 v_smfmac_f32_16x16x64_bf16 v[12:15], v[28:31], v[176:183], v0
 s_waitcnt lgkmcnt(3)
 v_smfmac_f32_16x16x64_bf16 v[16:19], v[28:31], v[32:39], v0
 ds_read_b128 v[32:35], v1 offset:38912
 ds_read_b128 v[36:39], v1 offset:39936
 v_smfmac_f32_16x16x64_bf16 v[20:23], v[28:31], v[152:159], v0
 ds_read_b128 v[28:31], v1 offset:5120
 s_waitcnt lgkmcnt(3)
 v_smfmac_f32_16x16x64_bf16 v[8:11], v[24:27], v[160:167], v0
 v_smfmac_f32_16x16x64_bf16 v[16:19], v[24:27], v[40:47], v0
 ds_read_b128 v[40:43], v1 offset:36864
 ds_read_b128 v[44:47], v1 offset:37888
 v_smfmac_f32_16x16x64_bf16 v[12:15], v[24:27], v[144:151], v0
 v_smfmac_f32_16x16x64_bf16 v[20:23], v[24:27], v[168:175], v0
 ds_read_b128 v[24:27], v1 offset:6144
 s_waitcnt lgkmcnt(3)
 v_smfmac_f32_16x16x64_bf16 v[16:19], v[28:31], v[32:39], v0
 ds_read_b128 v[32:35], v1 offset:34816
 ds_read_b128 v[36:39], v1 offset:35840
 v_smfmac_f32_16x16x64_bf16 v[8:11], v[28:31], v[136:143], v0
 v_smfmac_f32_16x16x64_bf16 v[12:15], v[28:31], v[128:135], v0
 s_waitcnt lgkmcnt(3)
 v_smfmac_f32_16x16x64_bf16 v[20:23], v[28:31], v[40:47], v0
 ds_read_b128 v[40:43], v1 offset:32768
 ds_read_b128 v[44:47], v1 offset:33792
 ds_read_b128 v[28:31], v1 offset:7168
 s_waitcnt lgkmcnt(5)
 v_smfmac_f32_16x16x64_bf16 v[8:11], v[24:27], a[144:151], v0
 v_smfmac_f32_16x16x64_bf16 v[12:15], v[24:27], a[136:143], v0
 s_waitcnt lgkmcnt(3)
 v_smfmac_f32_16x16x64_bf16 v[16:19], v[24:27], v[32:39], v0
 ds_read_b128 v[32:35], v1 offset:18432
 ds_read_b128 v[36:39], v1 offset:19456
 s_waitcnt vmcnt(2)
 v_smfmac_f32_16x16x64_bf16 v[20:23], v[24:27], v[56:63], v0
 ds_read_b128 v[24:27], v1 offset:8192
 buffer_load_dwordx4 v[56:59], v1, s[4:7], s61 offen offset:0 sc1 nt
 s_waitcnt lgkmcnt(3)
 v_smfmac_f32_16x16x64_bf16 v[8:11], v[28:31], a[96:103], v0
 v_smfmac_f32_16x16x64_bf16 v[16:19], v[28:31], v[40:47], v0
 ds_read_b128 v[40:43], v1 offset:16384
 ds_read_b128 v[44:47], v1 offset:17408
 s_add_u32 s3, s61, 4096
 buffer_load_dwordx4 v[60:63], v1, s[4:7], s3 offen offset:0 sc1 nt
 v_smfmac_f32_16x16x64_bf16 v[12:15], v[28:31], a[88:95], v0
 v_smfmac_f32_16x16x64_bf16 v[20:23], v[28:31], v[208:215], v0
 ds_read_b128 v[28:31], v1 offset:9216
 s_waitcnt lgkmcnt(3)
 v_smfmac_f32_16x16x64_bf16 v[16:19], v[24:27], v[32:39], v0
 v_smfmac_f32_16x16x64_bf16 v[8:11], v[24:27], a[80:87], v0
 s_add_u32 s3, s61, 67108864
 buffer_load_dwordx4 v[32:35], v1, s[4:7], s3 offen offset:0 sc1 nt
 v_smfmac_f32_16x16x64_bf16 v[12:15], v[24:27], a[64:71], v0
 s_waitcnt lgkmcnt(1)
 v_smfmac_f32_16x16x64_bf16 v[20:23], v[24:27], v[40:47], v0
 ds_read_b128 v[40:43], v3 offset:49152
 ds_read_b128 v[44:47], v3 offset:49152
 buffer_load_dwordx4 v[36:39], v1, s[4:7], s3 offen offset:1024 sc1 nt
 s_waitcnt lgkmcnt(2)
 v_smfmac_f32_16x16x64_bf16 v[8:11], v[28:31], a[40:47], v0
 v_smfmac_f32_16x16x64_bf16 v[12:15], v[28:31], a[24:31], v0
 v_smfmac_f32_16x16x64_bf16 v[16:19], v[28:31], v[232:239], v0
 s_waitcnt vmcnt(4)
 v_smfmac_f32_16x16x64_bf16 v[20:23], v[28:31], v[48:55], v0
 ds_read_b128 v[52:55], v1 offset:0
 v_add_f32 v8, v8, v10
 v_add_f32 v11, v9, v11
 v_cvt_pk_bf16_f32 v9, v8, v11
 v_cvt_pk_bf16_f32 v8, v8, v11
 v_add_f32 v12, v12, v14
 v_add_f32 v15, v13, v15
 v_cvt_pk_bf16_f32 v13, v12, v15
 v_cvt_pk_bf16_f32 v12, v12, v15
 v_mfma_f32_16x16x16_bf16 v[8:11], v[8:9], v[4:5], 0
 v_mfma_f32_16x16x16_bf16 v[12:15], v[12:13], v[4:5], 0
 v_add_f32 v16, v16, v18
 v_add_f32 v19, v17, v19
 v_cvt_pk_bf16_f32 v17, v16, v19
 v_cvt_pk_bf16_f32 v16, v16, v19
 v_add_f32 v20, v20, v22
 v_add_f32 v23, v21, v23
 v_cvt_pk_bf16_f32 v21, v20, v23
 v_cvt_pk_bf16_f32 v20, v20, v23
 v_mfma_f32_16x16x16_bf16 v[16:19], v[16:17], v[4:5], 0
 v_mfma_f32_16x16x16_bf16 v[20:23], v[20:21], v[4:5], 0
 s_waitcnt lgkmcnt(2)
 v_smfmac_f32_16x16x64_bf16 v[40:43], v[24:27], v[96:103], v0
 s_waitcnt lgkmcnt(1)
 v_smfmac_f32_16x16x64_bf16 v[44:47], v[24:27], v[104:111], v0
 ds_read_b128 v[24:27], v1 offset:1024
 v_cvt_pk_bf16_f32 v15, v14, v15
 v_cvt_pk_bf16_f32 v14, v12, v13
 v_cvt_pk_bf16_f32 v13, v10, v11
 v_cvt_pk_bf16_f32 v12, v8, v9
 s_waitcnt vmcnt(3)
 s_nop 0
 v_mfma_f32_16x16x32_bf16 v[8:11], v[56:59], v[12:15], 0
 v_cvt_pk_bf16_f32 v23, v22, v23
 v_cvt_pk_bf16_f32 v22, v20, v21
 v_cvt_pk_bf16_f32 v21, v18, v19
 v_cvt_pk_bf16_f32 v20, v16, v17
 s_waitcnt vmcnt(2)
 v_mfma_f32_16x16x32_bf16 v[16:19], v[60:63], v[12:15], 0
 v_mfma_f32_16x16x32_bf16 v[48:51], v[20:23], v[12:15], 0
 v_smfmac_f32_16x16x64_bf16 v[40:43], v[28:31], v[112:119], v0
 v_smfmac_f32_16x16x64_bf16 v[44:47], v[28:31], v[120:127], v0
 ds_read_b128 v[28:31], v1 offset:2048
 s_waitcnt lgkmcnt(2)
 v_smfmac_f32_16x16x64_bf16 v[40:43], v[52:55], a[160:167], v0
 v_cndmask_b32 v8, v8, v16, s[70:71]
 v_cndmask_b32 v9, v9, v17, s[70:71]
 v_cndmask_b32 v10, v10, v18, s[70:71]
 v_cndmask_b32 v11, v11, v19, s[70:71]
 ds_write_b128 v1, v[8:11] offset:10240
 ds_write_b64 v1, v[48:49] offset:14336
 v_smfmac_f32_16x16x64_bf16 v[44:47], v[52:55], a[168:175], v0
 ds_read_b128 v[52:55], v1 offset:3072
 s_waitcnt lgkmcnt(4)
 v_smfmac_f32_16x16x64_bf16 v[40:43], v[24:27], a[176:183], v0
 v_smfmac_f32_16x16x64_bf16 v[44:47], v[24:27], a[184:191], v0
 ds_read_b128 v[24:27], v1 offset:4096
 s_waitcnt lgkmcnt(4)
 v_smfmac_f32_16x16x64_bf16 v[40:43], v[28:31], a[192:199], v0
 v_smfmac_f32_16x16x64_bf16 v[44:47], v[28:31], a[200:207], v0
 ds_read_b128 v[28:31], v1 offset:5120
 s_waitcnt lgkmcnt(2)
 v_smfmac_f32_16x16x64_bf16 v[40:43], v[52:55], a[208:215], v0
 v_smfmac_f32_16x16x64_bf16 v[44:47], v[52:55], a[216:223], v0
 ds_read_b128 v[52:55], v1 offset:6144
 s_barrier
 ds_read_b128 v[56:59], v1 offset:11264
 ds_read_b128 v[60:63], v1 offset:12288
 ds_read_b128 v[16:19], v1 offset:13312
 ds_read_b128 v[12:15], v1 offset:14336
 ds_read_b128 v[48:51], v1 offset:15360
 s_waitcnt lgkmcnt(7)
 v_smfmac_f32_16x16x64_bf16 v[40:43], v[24:27], a[224:231], v0
 s_mov_b64 exec, s[68:69]
 buffer_store_dwordx4 v[20:23], v6, s[4:7], s62 offen offset:0 sc1
 s_mov_b64 exec, -1
 v_smfmac_f32_16x16x64_bf16 v[44:47], v[24:27], a[232:239], v0
 ds_read_b128 v[24:27], v1 offset:7168
 s_waitcnt lgkmcnt(7)
 v_smfmac_f32_16x16x64_bf16 v[40:43], v[28:31], a[240:247], v0
 v_smfmac_f32_16x16x64_bf16 v[44:47], v[28:31], a[248:255], v0
 s_waitcnt lgkmcnt(6)
 v_smfmac_f32_16x16x64_bf16 v[40:43], v[52:55], v[64:71], v0
 v_smfmac_f32_16x16x64_bf16 v[44:47], v[52:55], v[72:79], v0
 s_waitcnt lgkmcnt(0)
 v_smfmac_f32_16x16x64_bf16 v[40:43], v[24:27], v[80:87], v0
 v_smfmac_f32_16x16x64_bf16 v[44:47], v[24:27], v[88:95], v0
 v_pk_add_f32 v[8:9], v[8:9], v[56:57]
 v_pk_add_f32 v[10:11], v[10:11], v[58:59]
 v_pk_add_f32 v[60:61], v[60:61], v[16:17]
 v_pk_add_f32 v[62:63], v[62:63], v[18:19]
 v_pk_add_f32 v[12:13], v[12:13], v[14:15]
 v_pk_add_f32 v[48:49], v[48:49], v[50:51]
 v_pk_add_f32 v[8:9], v[8:9], v[60:61]
 v_pk_add_f32 v[10:11], v[10:11], v[62:63]
 v_pk_add_f32 v[48:49], v[12:13], v[48:49]
 v_max3_f32 v50, v8, v9, v10
 v_max3_f32 v50, v50, v11, v48
 v_max_f32 v50, v50, v49
 v_add_f32 v40, v40, v42
 v_add_f32 v41, v41, v43
 v_max_f32_dpp v50, v50, v50 quad_perm:[2,3,0,1] row_mask:0xf bank_mask:0xf
 v_mov_b32 v51, v50
 v_add_f32 v44, v44, v46
 v_add_f32 v45, v45, v47
 v_permlane16_swap_b32 v50, v51
 v_max_f32 v50, v50, v51
 v_mov_b32 v51, v50
 v_cvt_pk_bf16_f32 v40, v40, v41
 v_cvt_pk_bf16_f32 v41, v44, v45
 v_permlane32_swap_b32 v50, v51
 v_max_f32 v50, v50, v51
 v_mul_f32 v50, s56, v50
 v_fma_f32 v48, v48, s56, -v50
 v_fma_f32 v49, v49, s56, -v50
 v_fma_f32 v8, v8, s56, -v50
 v_fma_f32 v9, v9, s56, -v50
 v_fma_f32 v10, v10, s56, -v50
 v_fma_f32 v11, v11, s56, -v50
 v_exp_f32 v48, v48
 v_lshrrev_b32 v51, 1, v1
 v_exp_f32 v49, v49
 ds_read_b128 v[56:59], v3 offset:18432
 ds_read_b128 v[60:63], v3 offset:19456
 v_exp_f32 v8, v8
 v_exp_f32 v9, v9
 ds_read_b128 v[24:27], v2 offset:36864
 ds_read_b128 v[28:31], v2 offset:37888
 v_exp_f32 v10, v10
 buffer_store_dwordx2 v[40:41], v51, s[4:7], s62 offen offset:2048 sc1
 v_exp_f32 v11, v11
 v_cvt_pk_bf16_f32 v14, v48, v49
 v_cvt_pk_bf16_f32 v12, v8, v9
 v_cvt_pk_bf16_f32 v13, v10, v11
 v_cndmask_b32 v52, 0, v14, s[68:69]
 v_cndmask_b32 v53, 0, v14, s[70:71]
 v_cndmask_b32 v22, 0, v12, s[70:71]
 v_cndmask_b32 v23, 0, v13, s[70:71]
 v_mfma_f32_16x16x16_bf16 v[44:47], v[40:41], v[52:53], 0
 v_cndmask_b32 v16, 0, v12, s[68:69]
 v_cndmask_b32 v17, 0, v13, s[68:69]
 v_mov_b32_dpp v18, v22 quad_perm:[2,3,0,1] row_mask:0xf bank_mask:0xf
 v_mov_b32_dpp v19, v23 quad_perm:[2,3,0,1] row_mask:0xf bank_mask:0xf
 v_mov_b32_dpp v20, v16 quad_perm:[2,3,0,1] row_mask:0xf bank_mask:0xf
 v_mov_b32_dpp v21, v17 quad_perm:[2,3,0,1] row_mask:0xf bank_mask:0xf
 s_waitcnt vmcnt(3)
 v_mfma_f32_16x16x32_bf16 v[44:47], v[32:35], v[16:19], v[44:47]
 v_add_f32 v54, v8, v9
 v_add_f32 v55, v48, v49
 s_waitcnt vmcnt(2)
 v_mfma_f32_16x16x32_bf16 v[44:47], v[36:39], v[20:23], v[44:47]
 v_add_f32 v54, v54, v10
 v_fma_f32 v55, v55, 0.5, v11
 v_add_f32 v54, v54, v55
 ds_read_b128 v[16:19], v3 offset:49152
 ds_read_b128 v[20:23], v3 offset:49152
 v_add_f32_dpp v54, v54, v54 quad_perm:[2,3,0,1] row_mask:0xf bank_mask:0xf
 v_mov_b32 v55, v54
 ds_read_b128 v[32:35], v3 offset:49152
 ds_read_b128 v[36:39], v3 offset:49152
 v_permlane16_swap_b32 v54, v55
 v_add_f32 v54, v54, v55
 v_mov_b32 v55, v54
 ds_read_b128 v[8:11], v3 offset:49152
 s_cmp_eq_u32 s54, 63
 v_permlane32_swap_b32 v54, v55
 v_add_f32 v54, v54, v55
 v_rcp_f32 v54, v54
 s_cbranch_scc1 L_ch0_end
 v_mul_f32 v44, v44, v54
 v_mul_f32 v45, v45, v54
 v_cvt_pk_bf16_f32 v42, v44, v45
 v_mul_f32 v46, v46, v54
 v_mul_f32 v47, v47, v54
 v_cvt_pk_bf16_f32 v43, v46, v47
 ds_write_b64 v6, v[42:43] offset:0
 v_and_b32 v40, -9, v6
 v_mov_b32_dpp v12, v42 quad_perm:[0,1,0,1] row_mask:0xf bank_mask:0xf
 v_mov_b32_dpp v14, v42 quad_perm:[2,3,2,3] row_mask:0xf bank_mask:0xf
 v_mov_b32_dpp v13, v43 quad_perm:[0,1,0,1] row_mask:0xf bank_mask:0xf
 v_mov_b32_dpp v15, v43 quad_perm:[2,3,2,3] row_mask:0xf bank_mask:0xf
 s_waitcnt lgkmcnt(5)
 s_nop 0
 v_smfmac_f32_16x16x64_bf16 v[16:19], v[12:15], a[0:7], v0
 s_waitcnt lgkmcnt(4)
 v_smfmac_f32_16x16x64_bf16 v[20:23], v[12:15], a[32:39], v0
 s_waitcnt lgkmcnt(0)
 s_barrier
 ds_read_b128 v[48:51], v40 offset:512
 ds_read_b128 v[52:55], v40 offset:1024
 ds_read_b128 v[44:47], v40 offset:1536
 v_smfmac_f32_16x16x64_bf16 v[32:35], v[12:15], v[56:63], v0
 ds_read_b128 v[56:59], v3 offset:22528
 ds_read_b128 v[60:63], v3 offset:23552
 s_mov_b32 m0, 8192
 v_smfmac_f32_16x16x64_bf16 v[36:39], v[12:15], v[24:31], v0
 ds_read_b128 v[24:27], v3 offset:20480
 ds_read_b128 v[28:31], v3 offset:21504
 buffer_load_dwordx4 v1, s[4:7], s63 offen offset:2048 lds
 v_smfmac_f32_16x16x64_bf16 v[8:11], v[12:15], a[128:135], v0
 s_mov_b32 m0, 8192
 s_waitcnt lgkmcnt(6)
 v_smfmac_f32_16x16x64_bf16 v[16:19], v[48:51], a[8:15], v0
 buffer_load_dwordx4 v1, s[4:7], s63 offen offset:3072 lds
 s_waitcnt lgkmcnt(5)
 v_smfmac_f32_16x16x64_bf16 v[16:19], v[52:55], a[16:23], v0
 s_mov_b32 m0, 14336
 s_waitcnt lgkmcnt(2)
 v_smfmac_f32_16x16x64_bf16 v[16:19], v[44:47], v[56:63], v0
 ds_read_b128 v[56:59], v3 offset:16384
 ds_read_b128 v[60:63], v3 offset:17408
 buffer_load_dwordx4 v1, s[4:7], s81 offen offset:0 lds
 s_waitcnt lgkmcnt(2)
 v_smfmac_f32_16x16x64_bf16 v[20:23], v[48:51], v[24:31], v0
 ds_read_b128 v[24:27], v2 offset:38912
 ds_read_b128 v[28:31], v2 offset:39936
 s_mov_b32 m0, 14336
 v_smfmac_f32_16x16x64_bf16 v[20:23], v[52:55], a[48:55], v0
 buffer_load_dwordx4 v1, s[4:7], s81 offen offset:1024 lds
 v_smfmac_f32_16x16x64_bf16 v[20:23], v[44:47], a[56:63], v0
 v_cvt_pk_bf16_f32 v16, v16, v17
 v_smfmac_f32_16x16x64_bf16 v[32:35], v[48:51], a[72:79], v0
 v_cvt_pk_bf16_f32 v17, v18, v19
 s_waitcnt lgkmcnt(2)
 v_smfmac_f32_16x16x64_bf16 v[32:35], v[52:55], v[56:63], v0
 ds_read_b128 v[56:59], v2 offset:34816
 ds_read_b128 v[60:63], v2 offset:35840
 v_and_or_b32 v16, v16, -2, s55
 s_waitcnt lgkmcnt(2)
 v_smfmac_f32_16x16x64_bf16 v[32:35], v[44:47], v[24:31], v0
 ds_read_b128 v[24:27], v2 offset:32768
 ds_read_b128 v[28:31], v2 offset:33792
 v_cvt_pk_bf16_f32 v18, v20, v21
 v_smfmac_f32_16x16x64_bf16 v[36:39], v[48:51], a[104:111], v0
 v_cvt_pk_bf16_f32 v19, v22, v23
 v_smfmac_f32_16x16x64_bf16 v[36:39], v[52:55], a[112:119], v0
 v_and_or_b32 v18, v18, -2, s55
 buffer_store_dwordx4 v[16:19], v1, s[4:7], s60 offen offset:0 sc1
 v_smfmac_f32_16x16x64_bf16 v[36:39], v[44:47], a[120:127], v0
 v_cvt_pk_bf16_f32 v32, v32, v33
 s_waitcnt lgkmcnt(2)
 v_smfmac_f32_16x16x64_bf16 v[8:11], v[48:51], v[56:63], v0
 v_cvt_pk_bf16_f32 v33, v34, v35
 s_waitcnt lgkmcnt(0)
 v_smfmac_f32_16x16x64_bf16 v[8:11], v[52:55], v[24:31], v0
 v_and_or_b32 v32, v32, -2, s55
 v_smfmac_f32_16x16x64_bf16 v[8:11], v[44:47], a[152:159], v0
 v_cvt_pk_bf16_f32 v34, v36, v37
 v_cvt_pk_bf16_f32 v35, v38, v39
 v_and_or_b32 v34, v34, -2, s55
 buffer_store_dwordx4 v[32:35], v1, s[4:7], s60 offen offset:1024 sc1
 s_nop 3
 v_cvt_pk_bf16_f32 v8, v8, v9
 v_cvt_pk_bf16_f32 v9, v10, v11
 v_and_or_b32 v8, v8, -2, s55
 buffer_store_dwordx2 v[8:9], v1, s[4:7], s16 offen offset:0 sc1
 buffer_load_dwordx4 v[32:35], v1, s[4:7], s63 offen offset:0
 buffer_load_dwordx4 v[36:39], v1, s[4:7], s63 offen offset:1024
 s_add_u32 s54, s54, 1
 s_add_u32 s61, s61, 524288
 s_and_b32 s3, s54, 3
 s_cselect_b32 s3, 1, -3
 s_lshl_b32 s3, s3, 17
 s_add_u32 s62, s62, s3
 s_and_b32 s3, s54, 3
 s_cselect_b32 s3, 1, -3
 s_lshl_b32 s3, s3, 14
 s_add_u32 s57, s57, s3
 s_add_u32 s59, s59, s3
 s_xor_b32 s58, s57, 32768
 v_lshrrev_b32 v56, 7, v1
 v_mul_u32_u24 v56, 10240, v56
 v_and_b32 v60, 112, v1
 v_add_u32 v56, v56, v60
 v_and_b32 v57, 32, v1
 v_and_b32 v60, 64, v1
 v_lshl_add_u32 v57, v60, 2, v57
 v_bfe_u32 v60, v1, 8, 1
 v_lshl_add_u32 v57, v60, 4, v57
 v_bfe_u32 v60, v1, 4, 1
 v_lshl_add_u32 v57, v60, 3, v57
 v_mov_b32 v60, 0x3f80
 v_mov_b32 v28, 0x3f800000
 v_cndmask_b32 v60, v60, v28, s[82:83]
 v_cndmask_b32 v28, 0, v60, s[72:73]
 v_cndmask_b32 v29, 0, v60, s[74:75]
 v_cndmask_b32 v30, 0, v60, s[76:77]
 v_cndmask_b32 v31, 0, v60, s[78:79]
 v_mov_b64 v[58:59], -1
 s_mov_b64 exec, s[84:85]
 buffer_store_dwordx2 v[58:59], v57, s[4:7], s58 offen sc1
 s_mov_b64 exec, -1
 s_nop 15
 s_nop 15
 s_nop 15
 s_nop 15
 s_nop 15
 s_mov_b32 s51, 0
 buffer_load_dwordx4 v[8:11], v56, s[4:7], s64 offen sc1
 buffer_load_dwordx4 v[12:15], v56, s[4:7], s65 offen sc1
 buffer_load_dwordx4 v[16:19], v56, s[4:7], s66 offen sc1
 buffer_load_dwordx4 v[20:23], v56, s[4:7], s67 offen sc1
L_pp_172:
 s_waitcnt vmcnt(3)
 v_mfma_f32_16x16x32_bf16 v[24:27], v[28:31], v[8:11], 0
 v_bitop3_b32 v60, v8, v10, s55 bitop3:0x7e
 s_waitcnt vmcnt(2)
 v_mfma_f32_16x16x32_bf16 v[24:27], v[28:31], v[12:15], v[24:27]
 v_bitop3_b32 v61, v12, v14, s55 bitop3:0x7e
 s_waitcnt vmcnt(1)
 v_mfma_f32_16x16x32_bf16 v[24:27], v[28:31], v[16:19], v[24:27]
 v_bitop3_b32 v62, v16, v18, s55 bitop3:0x7e
 s_waitcnt vmcnt(0)
 v_mfma_f32_16x16x32_bf16 v[24:27], v[28:31], v[20:23], v[24:27]
 v_bitop3_b32 v63, v20, v22, s55 bitop3:0x7e
 v_or3_b32 v7, v60, v61, v62
 v_bitop3_b32 v7, v7, v63, 1 bitop3:0xa8
 v_cmp_ne_u32 vcc, 0, v7
 s_cbranch_vccnz L_rt_173
 s_nop 2
 v_add_f32_dpp v24, v24, v24 row_ror:8 row_mask:0xf bank_mask:0xf
 v_add_f32_dpp v25, v25, v25 row_ror:8 row_mask:0xf bank_mask:0xf
 v_add_f32_dpp v26, v26, v26 row_ror:8 row_mask:0xf bank_mask:0xf
 v_add_f32_dpp v27, v27, v27 row_ror:8 row_mask:0xf bank_mask:0xf
 s_mov_b64 exec, s[84:85]
 v_cvt_pk_bf16_f32 v24, v24, v25
 v_cvt_pk_bf16_f32 v25, v26, v27
 buffer_store_dwordx2 v[24:25], v57, s[4:7], s57 offen sc1
 s_mov_b64 exec, -1
 s_xor_b32 s55, s55, 1
 ds_read_b128 v[40:43], v1 offset:10240
 ds_read_b128 v[44:47], v1 offset:11264
 ds_read_b128 v[48:51], v1 offset:14336
 ds_read_b128 v[52:55], v1 offset:15360
 buffer_load_dwordx4 v[56:59], v1, s[4:7], s81 offen offset:2048
 buffer_load_dwordx4 v[60:63], v1, s[4:7], s81 offen offset:3072
 ds_read_b128 v[8:11], v3 offset:49152
 ds_read_b128 v[12:15], v3 offset:49152
 ds_read_b128 v[16:19], v3 offset:49152
 ds_read_b128 v[20:23], v3 offset:49152
 s_waitcnt lgkmcnt(0)
 s_nop 15
 s_nop 15
 s_nop 7
 s_branch L_ch0_s
L_rt_171:
 s_add_u32 s51, s51, 1
 s_cmp_lt_u32 s51, 131072
 s_cbranch_scc1 L_pm_170
 s_branch L_bail
L_rt_173:
 buffer_load_dwordx4 v[8:11], v56, s[4:7], s64 offen sc1
 buffer_load_dwordx4 v[12:15], v56, s[4:7], s65 offen sc1
 buffer_load_dwordx4 v[16:19], v56, s[4:7], s66 offen sc1
 buffer_load_dwordx4 v[20:23], v56, s[4:7], s67 offen sc1
 s_add_u32 s51, s51, 1
 s_cmp_lt_u32 s51, 131072
 s_cbranch_scc1 L_pp_172
 s_branch L_bail
L_ch0_end:
 s_waitcnt vmcnt(0)
 s_endpgm
L_ch1:
 v_lshrrev_b32 v8, 4, v0
 s_mov_b32 s3, 1280
 v_mul_lo_u32 v8, v8, s3
 v_lshrrev_b32 v7, 3, v0
 v_and_b32 v7, 6, v7
 v_xor_b32 v7, v7, v0
 v_and_b32 v7, 15, v7
 v_lshl_add_u32 v8, v7, 4, v8
 v_xor_b32 v9, 128, v8
 v_lshrrev_b32 v10, 4, v0
 s_mov_b32 s3, 8192
 v_mul_lo_u32 v10, v10, s3
 v_lshrrev_b32 v7, 3, v0
 v_and_b32 v7, 6, v7
 v_xor_b32 v7, v7, v0
 v_and_b32 v7, 15, v7
 v_lshl_add_u32 v10, v7, 4, v10
 v_xor_b32 v11, 128, v10
 s_mov_b32 s8, s26
 s_and_b32 s9, s27, 0xffff
 s_mov_b32 s10, 5242880
 s_mul_i32 s14, s52, 163840
 s_add_u32 s14, s14, 40960
 s_mov_b32 m0, 8192
 s_nop 0
 buffer_load_dwordx4 v8, s[8:11], s14 offen lds
 s_add_u32 s14, s14, 5120
 s_mov_b32 m0, 9216
 s_nop 0
 buffer_load_dwordx4 v8, s[8:11], s14 offen lds
 s_add_u32 s14, s14, 5120
 s_mov_b32 m0, 10240
 s_nop 0
 buffer_load_dwordx4 v8, s[8:11], s14 offen lds
 s_add_u32 s14, s14, 5120
 s_mov_b32 m0, 11264
 s_nop 0
 buffer_load_dwordx4 v8, s[8:11], s14 offen lds
 s_add_u32 s14, s14, 5120
 s_mov_b32 m0, 12288
 s_nop 0
 buffer_load_dwordx4 v9, s[8:11], s14 offen lds
 s_add_u32 s14, s14, 5120
 s_mov_b32 m0, 13312
 s_nop 0
 buffer_load_dwordx4 v9, s[8:11], s14 offen lds
 s_add_u32 s14, s14, 5120
 s_mov_b32 m0, 14336
 s_nop 0
 buffer_load_dwordx4 v9, s[8:11], s14 offen lds
 s_add_u32 s14, s14, 5120
 s_mov_b32 m0, 15360
 s_nop 0
 buffer_load_dwordx4 v9, s[8:11], s14 offen lds
 s_mul_i32 s14, s52, 163840
 s_add_u32 s14, s14, 41216
 s_mov_b32 m0, 40960
 s_nop 0
 buffer_load_dwordx4 v8, s[8:11], s14 offen lds
 s_add_u32 s14, s14, 5120
 s_mov_b32 m0, 41984
 s_nop 0
 buffer_load_dwordx4 v8, s[8:11], s14 offen lds
 s_add_u32 s14, s14, 5120
 s_mov_b32 m0, 43008
 s_nop 0
 buffer_load_dwordx4 v8, s[8:11], s14 offen lds
 s_add_u32 s14, s14, 5120
 s_mov_b32 m0, 44032
 s_nop 0
 buffer_load_dwordx4 v8, s[8:11], s14 offen lds
 s_add_u32 s14, s14, 5120
 s_mov_b32 m0, 45056
 s_nop 0
 buffer_load_dwordx4 v9, s[8:11], s14 offen lds
 s_add_u32 s14, s14, 5120
 s_mov_b32 m0, 46080
 s_nop 0
 buffer_load_dwordx4 v9, s[8:11], s14 offen lds
 s_add_u32 s14, s14, 5120
 s_mov_b32 m0, 47104
 s_nop 0
 buffer_load_dwordx4 v9, s[8:11], s14 offen lds
 s_add_u32 s14, s14, 5120
 s_mov_b32 m0, 48128
 s_nop 0
 buffer_load_dwordx4 v9, s[8:11], s14 offen lds
 s_mul_i32 s14, s52, 163840
 s_add_u32 s14, s14, 41472
 s_mov_b32 m0, 73728
 s_nop 0
 buffer_load_dwordx4 v8, s[8:11], s14 offen lds
 s_add_u32 s14, s14, 5120
 s_mov_b32 m0, 74752
 s_nop 0
 buffer_load_dwordx4 v8, s[8:11], s14 offen lds
 s_add_u32 s14, s14, 5120
 s_mov_b32 m0, 75776
 s_nop 0
 buffer_load_dwordx4 v8, s[8:11], s14 offen lds
 s_add_u32 s14, s14, 5120
 s_mov_b32 m0, 76800
 s_nop 0
 buffer_load_dwordx4 v8, s[8:11], s14 offen lds
 s_add_u32 s14, s14, 5120
 s_mov_b32 m0, 77824
 s_nop 0
 buffer_load_dwordx4 v9, s[8:11], s14 offen lds
 s_add_u32 s14, s14, 5120
 s_mov_b32 m0, 78848
 s_nop 0
 buffer_load_dwordx4 v9, s[8:11], s14 offen lds
 s_add_u32 s14, s14, 5120
 s_mov_b32 m0, 79872
 s_nop 0
 buffer_load_dwordx4 v9, s[8:11], s14 offen lds
 s_add_u32 s14, s14, 5120
 s_mov_b32 m0, 80896
 s_nop 0
 buffer_load_dwordx4 v9, s[8:11], s14 offen lds
 s_mul_i32 s14, s52, 163840
 s_add_u32 s14, s14, 41728
 s_mov_b32 m0, 106496
 s_nop 0
 buffer_load_dwordx4 v8, s[8:11], s14 offen lds
 s_add_u32 s14, s14, 5120
 s_mov_b32 m0, 107520
 s_nop 0
 buffer_load_dwordx4 v8, s[8:11], s14 offen lds
 s_add_u32 s14, s14, 5120
 s_mov_b32 m0, 108544
 s_nop 0
 buffer_load_dwordx4 v8, s[8:11], s14 offen lds
 s_add_u32 s14, s14, 5120
 s_mov_b32 m0, 109568
 s_nop 0
 buffer_load_dwordx4 v8, s[8:11], s14 offen lds
 s_add_u32 s14, s14, 5120
 s_mov_b32 m0, 110592
 s_nop 0
 buffer_load_dwordx4 v9, s[8:11], s14 offen lds
 s_add_u32 s14, s14, 5120
 s_mov_b32 m0, 111616
 s_nop 0
 buffer_load_dwordx4 v9, s[8:11], s14 offen lds
 s_add_u32 s14, s14, 5120
 s_mov_b32 m0, 112640
 s_nop 0
 buffer_load_dwordx4 v9, s[8:11], s14 offen lds
 s_add_u32 s14, s14, 5120
 s_mov_b32 m0, 113664
 s_nop 0
 buffer_load_dwordx4 v9, s[8:11], s14 offen lds
 s_mul_i32 s14, s52, 163840
 s_add_u32 s14, s14, 41984
 s_mov_b32 m0, 139264
 s_nop 0
 buffer_load_dwordx4 v8, s[8:11], s14 offen lds
 s_add_u32 s14, s14, 5120
 s_mov_b32 m0, 140288
 s_nop 0
 buffer_load_dwordx4 v8, s[8:11], s14 offen lds
 s_add_u32 s14, s14, 5120
 s_mov_b32 m0, 141312
 s_nop 0
 buffer_load_dwordx4 v8, s[8:11], s14 offen lds
 s_add_u32 s14, s14, 5120
 s_mov_b32 m0, 142336
 s_nop 0
 buffer_load_dwordx4 v8, s[8:11], s14 offen lds
 s_add_u32 s14, s14, 5120
 s_mov_b32 m0, 143360
 s_nop 0
 buffer_load_dwordx4 v9, s[8:11], s14 offen lds
 s_add_u32 s14, s14, 5120
 s_mov_b32 m0, 144384
 s_nop 0
 buffer_load_dwordx4 v9, s[8:11], s14 offen lds
 s_add_u32 s14, s14, 5120
 s_mov_b32 m0, 145408
 s_nop 0
 buffer_load_dwordx4 v9, s[8:11], s14 offen lds
 s_add_u32 s14, s14, 5120
 s_mov_b32 m0, 146432
 s_nop 0
 buffer_load_dwordx4 v9, s[8:11], s14 offen lds
 v_lshrrev_b32 v20, 4, v0
 v_bfe_u32 v21, v0, 2, 1
 v_bfe_u32 v22, v0, 3, 1
 v_and_b32 v23, 1, v20
 v_lshrrev_b32 v24, 1, v20
 v_and_b32 v25, 3, v0
 v_lshlrev_b32 v25, 3, v25
 v_lshl_add_u32 v26, v22, 1, v23
 v_lshl_add_u32 v27, v21, 2, v26
 v_lshl_add_u32 v26, v24, 2, v26
 v_lshl_add_u32 v26, v21, 4, v26
 v_xor_b32 v27, 2, v27
 v_lshl_add_u32 v27, v27, 5, v25
 v_lshl_add_u32 v12, v26, 8, v27
 v_lshl_add_u32 v26, v24, 2, v21
 v_lshl_add_u32 v26, v23, 4, v26
 v_lshl_add_u32 v27, v23, 2, v21
 v_lshl_add_u32 v27, v22, 1, v27
 v_lshl_add_u32 v27, v27, 5, v25
 v_lshl_add_u32 v14, v26, 8, v27
 v_lshlrev_b32 v1, 4, v0
 v_add_u32 v2, 65536, v1
 v_add_u32 v3, 114688, v1
 s_waitcnt vmcnt(32)
 s_barrier
 s_waitcnt lgkmcnt(0)
 s_barrier
 s_mov_b32 s8, s24
 s_and_b32 s9, s25, 0xffff
 s_mov_b32 s10, 5242880
 s_lshl_b32 s14, s52, 8
 s_add_u32 s14, s14, 262144
 s_mov_b32 m0, 8192
 s_nop 0
 buffer_load_dwordx4 v10, s[8:11], s14 offen lds
 s_add_u32 s14, s14, 32768
 s_mov_b32 m0, 9216
 s_nop 0
 buffer_load_dwordx4 v10, s[8:11], s14 offen lds
 s_add_u32 s14, s14, 32768
 s_mov_b32 m0, 10240
 s_nop 0
 buffer_load_dwordx4 v10, s[8:11], s14 offen lds
 s_add_u32 s14, s14, 32768
 s_mov_b32 m0, 11264
 s_nop 0
 buffer_load_dwordx4 v10, s[8:11], s14 offen lds
 s_add_u32 s14, s14, 32768
 s_mov_b32 m0, 12288
 s_nop 0
 buffer_load_dwordx4 v11, s[8:11], s14 offen lds
 s_add_u32 s14, s14, 32768
 s_mov_b32 m0, 13312
 s_nop 0
 buffer_load_dwordx4 v11, s[8:11], s14 offen lds
 s_add_u32 s14, s14, 32768
 s_mov_b32 m0, 14336
 s_nop 0
 buffer_load_dwordx4 v11, s[8:11], s14 offen lds
 s_add_u32 s14, s14, 32768
 s_mov_b32 m0, 15360
 s_nop 0
 buffer_load_dwordx4 v11, s[8:11], s14 offen lds
 s_waitcnt vmcnt(32)
 s_barrier
 v_xor_b32 v16, 0, v14
 v_add_u32 v16, 32768, v16
 v_xor_b32 v17, 64, v16
 ds_read_b64_tr_b16 a[0:1], v16 offset:0
 ds_read_b64_tr_b16 a[2:3], v17 offset:512
 ds_read_b64_tr_b16 a[4:5], v16 offset:2048
 ds_read_b64_tr_b16 a[6:7], v17 offset:2560
 v_xor_b32 v16, 0, v14
 v_add_u32 v16, 32768, v16
 v_xor_b32 v17, 64, v16
 ds_read_b64_tr_b16 a[8:9], v16 offset:8192
 ds_read_b64_tr_b16 a[10:11], v17 offset:8704
 ds_read_b64_tr_b16 a[12:13], v16 offset:10240
 ds_read_b64_tr_b16 a[14:15], v17 offset:10752
 v_xor_b32 v16, 0, v14
 v_add_u32 v16, 32768, v16
 v_xor_b32 v17, 64, v16
 ds_read_b64_tr_b16 a[16:17], v16 offset:16384
 ds_read_b64_tr_b16 a[18:19], v17 offset:16896
 ds_read_b64_tr_b16 a[20:21], v16 offset:18432
 ds_read_b64_tr_b16 a[22:23], v17 offset:18944
 v_xor_b32 v16, 0, v14
 v_add_u32 v16, 32768, v16
 v_xor_b32 v17, 64, v16
 ds_read_b64_tr_b16 a[24:25], v16 offset:24576
 ds_read_b64_tr_b16 a[26:27], v17 offset:25088
 ds_read_b64_tr_b16 a[28:29], v16 offset:26624
 ds_read_b64_tr_b16 a[30:31], v17 offset:27136
 v_xor_b32 v16, 32, v14
 v_add_u32 v16, 32768, v16
 v_xor_b32 v17, 64, v16
 ds_read_b64_tr_b16 a[32:33], v16 offset:0
 ds_read_b64_tr_b16 a[34:35], v17 offset:512
 ds_read_b64_tr_b16 a[36:37], v16 offset:2048
 ds_read_b64_tr_b16 a[38:39], v17 offset:2560
 v_xor_b32 v16, 32, v14
 v_add_u32 v16, 32768, v16
 v_xor_b32 v17, 64, v16
 ds_read_b64_tr_b16 a[40:41], v16 offset:8192
 ds_read_b64_tr_b16 a[42:43], v17 offset:8704
 ds_read_b64_tr_b16 a[44:45], v16 offset:10240
 ds_read_b64_tr_b16 a[46:47], v17 offset:10752
 v_xor_b32 v16, 32, v14
 v_add_u32 v16, 32768, v16
 v_xor_b32 v17, 64, v16
 ds_read_b64_tr_b16 a[48:49], v16 offset:16384
 ds_read_b64_tr_b16 a[50:51], v17 offset:16896
 ds_read_b64_tr_b16 a[52:53], v16 offset:18432
 ds_read_b64_tr_b16 a[54:55], v17 offset:18944
 v_xor_b32 v16, 32, v14
 v_add_u32 v16, 32768, v16
 v_xor_b32 v17, 64, v16
 ds_read_b64_tr_b16 a[56:57], v16 offset:24576
 ds_read_b64_tr_b16 a[58:59], v17 offset:25088
 ds_read_b64_tr_b16 a[60:61], v16 offset:26624
 ds_read_b64_tr_b16 a[62:63], v17 offset:27136
 v_xor_b32 v16, 128, v14
 v_add_u32 v16, 32768, v16
 v_xor_b32 v17, 64, v16
 ds_read_b64_tr_b16 a[64:65], v16 offset:0
 ds_read_b64_tr_b16 a[66:67], v17 offset:512
 ds_read_b64_tr_b16 a[68:69], v16 offset:2048
 ds_read_b64_tr_b16 a[70:71], v17 offset:2560
 v_xor_b32 v16, 128, v14
 v_add_u32 v16, 32768, v16
 v_xor_b32 v17, 64, v16
 ds_read_b64_tr_b16 a[72:73], v16 offset:8192
 ds_read_b64_tr_b16 a[74:75], v17 offset:8704
 ds_read_b64_tr_b16 a[76:77], v16 offset:10240
 ds_read_b64_tr_b16 a[78:79], v17 offset:10752
 v_xor_b32 v16, 128, v14
 v_add_u32 v16, 32768, v16
 v_xor_b32 v17, 64, v16
 ds_read_b64_tr_b16 a[80:81], v16 offset:16384
 ds_read_b64_tr_b16 a[82:83], v17 offset:16896
 ds_read_b64_tr_b16 a[84:85], v16 offset:18432
 ds_read_b64_tr_b16 a[86:87], v17 offset:18944
 v_xor_b32 v16, 128, v14
 v_add_u32 v16, 32768, v16
 v_xor_b32 v17, 64, v16
 ds_read_b64_tr_b16 a[88:89], v16 offset:24576
 ds_read_b64_tr_b16 a[90:91], v17 offset:25088
 ds_read_b64_tr_b16 a[92:93], v16 offset:26624
 ds_read_b64_tr_b16 a[94:95], v17 offset:27136
 v_xor_b32 v16, 160, v14
 v_add_u32 v16, 32768, v16
 v_xor_b32 v17, 64, v16
 ds_read_b64_tr_b16 a[96:97], v16 offset:0
 ds_read_b64_tr_b16 a[98:99], v17 offset:512
 ds_read_b64_tr_b16 a[100:101], v16 offset:2048
 ds_read_b64_tr_b16 a[102:103], v17 offset:2560
 v_xor_b32 v16, 160, v14
 v_add_u32 v16, 32768, v16
 v_xor_b32 v17, 64, v16
 ds_read_b64_tr_b16 a[104:105], v16 offset:8192
 ds_read_b64_tr_b16 a[106:107], v17 offset:8704
 ds_read_b64_tr_b16 a[108:109], v16 offset:10240
 ds_read_b64_tr_b16 a[110:111], v17 offset:10752
 v_xor_b32 v16, 160, v14
 v_add_u32 v16, 32768, v16
 v_xor_b32 v17, 64, v16
 ds_read_b64_tr_b16 a[112:113], v16 offset:16384
 ds_read_b64_tr_b16 a[114:115], v17 offset:16896
 ds_read_b64_tr_b16 a[116:117], v16 offset:18432
 ds_read_b64_tr_b16 a[118:119], v17 offset:18944
 v_xor_b32 v16, 160, v14
 v_add_u32 v16, 32768, v16
 v_xor_b32 v17, 64, v16
 ds_read_b64_tr_b16 a[120:121], v16 offset:24576
 ds_read_b64_tr_b16 a[122:123], v17 offset:25088
 ds_read_b64_tr_b16 a[124:125], v16 offset:26624
 ds_read_b64_tr_b16 a[126:127], v17 offset:27136
 s_waitcnt lgkmcnt(0)
 s_barrier
 s_lshl_b32 s14, s52, 8
 s_add_u32 s14, s14, 1310720
 s_mov_b32 m0, 40960
 s_nop 0
 buffer_load_dwordx4 v10, s[8:11], s14 offen lds
 s_add_u32 s14, s14, 32768
 s_mov_b32 m0, 41984
 s_nop 0
 buffer_load_dwordx4 v10, s[8:11], s14 offen lds
 s_add_u32 s14, s14, 32768
 s_mov_b32 m0, 43008
 s_nop 0
 buffer_load_dwordx4 v10, s[8:11], s14 offen lds
 s_add_u32 s14, s14, 32768
 s_mov_b32 m0, 44032
 s_nop 0
 buffer_load_dwordx4 v10, s[8:11], s14 offen lds
 s_add_u32 s14, s14, 32768
 s_mov_b32 m0, 45056
 s_nop 0
 buffer_load_dwordx4 v11, s[8:11], s14 offen lds
 s_add_u32 s14, s14, 32768
 s_mov_b32 m0, 46080
 s_nop 0
 buffer_load_dwordx4 v11, s[8:11], s14 offen lds
 s_add_u32 s14, s14, 32768
 s_mov_b32 m0, 47104
 s_nop 0
 buffer_load_dwordx4 v11, s[8:11], s14 offen lds
 s_add_u32 s14, s14, 32768
 s_mov_b32 m0, 48128
 s_nop 0
 buffer_load_dwordx4 v11, s[8:11], s14 offen lds
 s_waitcnt vmcnt(32)
 s_barrier
 s_waitcnt lgkmcnt(0)
 s_barrier
 s_lshl_b32 s14, s52, 8
 s_add_u32 s14, s14, 2359296
 s_mov_b32 m0, 73728
 s_nop 0
 buffer_load_dwordx4 v10, s[8:11], s14 offen lds
 s_add_u32 s14, s14, 32768
 s_mov_b32 m0, 74752
 s_nop 0
 buffer_load_dwordx4 v10, s[8:11], s14 offen lds
 s_add_u32 s14, s14, 32768
 s_mov_b32 m0, 75776
 s_nop 0
 buffer_load_dwordx4 v10, s[8:11], s14 offen lds
 s_add_u32 s14, s14, 32768
 s_mov_b32 m0, 76800
 s_nop 0
 buffer_load_dwordx4 v10, s[8:11], s14 offen lds
 s_add_u32 s14, s14, 32768
 s_mov_b32 m0, 77824
 s_nop 0
 buffer_load_dwordx4 v11, s[8:11], s14 offen lds
 s_add_u32 s14, s14, 32768
 s_mov_b32 m0, 78848
 s_nop 0
 buffer_load_dwordx4 v11, s[8:11], s14 offen lds
 s_add_u32 s14, s14, 32768
 s_mov_b32 m0, 79872
 s_nop 0
 buffer_load_dwordx4 v11, s[8:11], s14 offen lds
 s_add_u32 s14, s14, 32768
 s_mov_b32 m0, 80896
 s_nop 0
 buffer_load_dwordx4 v11, s[8:11], s14 offen lds
 s_waitcnt vmcnt(32)
 s_barrier
 s_waitcnt lgkmcnt(0)
 s_barrier
 s_lshl_b32 s14, s52, 8
 s_add_u32 s14, s14, 3407872
 s_mov_b32 m0, 106496
 s_nop 0
 buffer_load_dwordx4 v10, s[8:11], s14 offen lds
 s_add_u32 s14, s14, 32768
 s_mov_b32 m0, 107520
 s_nop 0
 buffer_load_dwordx4 v10, s[8:11], s14 offen lds
 s_add_u32 s14, s14, 32768
 s_mov_b32 m0, 108544
 s_nop 0
 buffer_load_dwordx4 v10, s[8:11], s14 offen lds
 s_add_u32 s14, s14, 32768
 s_mov_b32 m0, 109568
 s_nop 0
 buffer_load_dwordx4 v10, s[8:11], s14 offen lds
 s_add_u32 s14, s14, 32768
 s_mov_b32 m0, 110592
 s_nop 0
 buffer_load_dwordx4 v11, s[8:11], s14 offen lds
 s_add_u32 s14, s14, 32768
 s_mov_b32 m0, 111616
 s_nop 0
 buffer_load_dwordx4 v11, s[8:11], s14 offen lds
 s_add_u32 s14, s14, 32768
 s_mov_b32 m0, 112640
 s_nop 0
 buffer_load_dwordx4 v11, s[8:11], s14 offen lds
 s_add_u32 s14, s14, 32768
 s_mov_b32 m0, 113664
 s_nop 0
 buffer_load_dwordx4 v11, s[8:11], s14 offen lds
 s_waitcnt vmcnt(32)
 s_barrier
 v_xor_b32 v16, 32, v14
 v_add_u32 v16, 131072, v16
 v_xor_b32 v17, 64, v16
 ds_read_b64_tr_b16 a[128:129], v16 offset:0
 ds_read_b64_tr_b16 a[130:131], v17 offset:512
 ds_read_b64_tr_b16 a[132:133], v16 offset:2048
 ds_read_b64_tr_b16 a[134:135], v17 offset:2560
 v_xor_b32 v16, 32, v14
 v_add_u32 v16, 131072, v16
 v_xor_b32 v17, 64, v16
 ds_read_b64_tr_b16 a[136:137], v16 offset:8192
 ds_read_b64_tr_b16 a[138:139], v17 offset:8704
 ds_read_b64_tr_b16 a[140:141], v16 offset:10240
 ds_read_b64_tr_b16 a[142:143], v17 offset:10752
 v_xor_b32 v16, 32, v14
 v_add_u32 v16, 131072, v16
 v_xor_b32 v17, 64, v16
 ds_read_b64_tr_b16 a[144:145], v16 offset:16384
 ds_read_b64_tr_b16 a[146:147], v17 offset:16896
 ds_read_b64_tr_b16 a[148:149], v16 offset:18432
 ds_read_b64_tr_b16 a[150:151], v17 offset:18944
 v_xor_b32 v16, 32, v14
 v_add_u32 v16, 131072, v16
 v_xor_b32 v17, 64, v16
 ds_read_b64_tr_b16 a[152:153], v16 offset:24576
 ds_read_b64_tr_b16 a[154:155], v17 offset:25088
 ds_read_b64_tr_b16 a[156:157], v16 offset:26624
 ds_read_b64_tr_b16 a[158:159], v17 offset:27136
 s_waitcnt lgkmcnt(0)
 s_barrier
 s_lshl_b32 s14, s52, 8
 s_add_u32 s14, s14, 4456448
 s_mov_b32 m0, 139264
 s_nop 0
 buffer_load_dwordx4 v10, s[8:11], s14 offen lds
 s_add_u32 s14, s14, 32768
 s_mov_b32 m0, 140288
 s_nop 0
 buffer_load_dwordx4 v10, s[8:11], s14 offen lds
 s_add_u32 s14, s14, 32768
 s_mov_b32 m0, 141312
 s_nop 0
 buffer_load_dwordx4 v10, s[8:11], s14 offen lds
 s_add_u32 s14, s14, 32768
 s_mov_b32 m0, 142336
 s_nop 0
 buffer_load_dwordx4 v10, s[8:11], s14 offen lds
 s_add_u32 s14, s14, 32768
 s_mov_b32 m0, 143360
 s_nop 0
 buffer_load_dwordx4 v11, s[8:11], s14 offen lds
 s_add_u32 s14, s14, 32768
 s_mov_b32 m0, 144384
 s_nop 0
 buffer_load_dwordx4 v11, s[8:11], s14 offen lds
 s_add_u32 s14, s14, 32768
 s_mov_b32 m0, 145408
 s_nop 0
 buffer_load_dwordx4 v11, s[8:11], s14 offen lds
 s_add_u32 s14, s14, 32768
 s_mov_b32 m0, 146432
 s_nop 0
 buffer_load_dwordx4 v11, s[8:11], s14 offen lds
 s_waitcnt vmcnt(32)
 s_barrier
 v_xor_b32 v16, 0, v12
 v_add_u32 v16, 0, v16
 ds_read_b64_tr_b16 a[160:161], v16 offset:0
 ds_read_b64_tr_b16 a[162:163], v16 offset:8192
 ds_read_b64_tr_b16 a[164:165], v16 offset:2048
 ds_read_b64_tr_b16 a[166:167], v16 offset:10240
 v_xor_b32 v16, 32, v12
 v_add_u32 v16, 0, v16
 ds_read_b64_tr_b16 a[168:169], v16 offset:0
 ds_read_b64_tr_b16 a[170:171], v16 offset:8192
 ds_read_b64_tr_b16 a[172:173], v16 offset:2048
 ds_read_b64_tr_b16 a[174:175], v16 offset:10240
 v_xor_b32 v16, 0, v12
 v_add_u32 v16, 0, v16
 ds_read_b64_tr_b16 a[176:177], v16 offset:16384
 ds_read_b64_tr_b16 a[178:179], v16 offset:24576
 ds_read_b64_tr_b16 a[180:181], v16 offset:18432
 ds_read_b64_tr_b16 a[182:183], v16 offset:26624
 v_xor_b32 v16, 32, v12
 v_add_u32 v16, 0, v16
 ds_read_b64_tr_b16 a[184:185], v16 offset:16384
 ds_read_b64_tr_b16 a[186:187], v16 offset:24576
 ds_read_b64_tr_b16 a[188:189], v16 offset:18432
 ds_read_b64_tr_b16 a[190:191], v16 offset:26624
 s_waitcnt lgkmcnt(0)
 s_barrier
 s_mov_b32 s8, s22
 s_and_b32 s9, s23, 0xffff
 s_mov_b32 s10, 5242880
 s_lshl_b32 s14, s52, 8
 s_add_u32 s14, s14, 262144
 s_mov_b32 m0, 8192
 s_nop 0
 buffer_load_dwordx4 v10, s[8:11], s14 offen lds
 s_add_u32 s14, s14, 32768
 s_mov_b32 m0, 9216
 s_nop 0
 buffer_load_dwordx4 v10, s[8:11], s14 offen lds
 s_add_u32 s14, s14, 32768
 s_mov_b32 m0, 10240
 s_nop 0
 buffer_load_dwordx4 v10, s[8:11], s14 offen lds
 s_add_u32 s14, s14, 32768
 s_mov_b32 m0, 11264
 s_nop 0
 buffer_load_dwordx4 v10, s[8:11], s14 offen lds
 s_add_u32 s14, s14, 32768
 s_mov_b32 m0, 12288
 s_nop 0
 buffer_load_dwordx4 v11, s[8:11], s14 offen lds
 s_add_u32 s14, s14, 32768
 s_mov_b32 m0, 13312
 s_nop 0
 buffer_load_dwordx4 v11, s[8:11], s14 offen lds
 s_add_u32 s14, s14, 32768
 s_mov_b32 m0, 14336
 s_nop 0
 buffer_load_dwordx4 v11, s[8:11], s14 offen lds
 s_add_u32 s14, s14, 32768
 s_mov_b32 m0, 15360
 s_nop 0
 buffer_load_dwordx4 v11, s[8:11], s14 offen lds
 s_waitcnt vmcnt(32)
 s_barrier
 v_xor_b32 v16, 0, v12
 v_add_u32 v16, 32768, v16
 ds_read_b64_tr_b16 a[192:193], v16 offset:0
 ds_read_b64_tr_b16 a[194:195], v16 offset:8192
 ds_read_b64_tr_b16 a[196:197], v16 offset:2048
 ds_read_b64_tr_b16 a[198:199], v16 offset:10240
 v_xor_b32 v16, 32, v12
 v_add_u32 v16, 32768, v16
 ds_read_b64_tr_b16 a[200:201], v16 offset:0
 ds_read_b64_tr_b16 a[202:203], v16 offset:8192
 ds_read_b64_tr_b16 a[204:205], v16 offset:2048
 ds_read_b64_tr_b16 a[206:207], v16 offset:10240
 v_xor_b32 v16, 0, v12
 v_add_u32 v16, 32768, v16
 ds_read_b64_tr_b16 a[208:209], v16 offset:16384
 ds_read_b64_tr_b16 a[210:211], v16 offset:24576
 ds_read_b64_tr_b16 a[212:213], v16 offset:18432
 ds_read_b64_tr_b16 a[214:215], v16 offset:26624
 v_xor_b32 v16, 32, v12
 v_add_u32 v16, 32768, v16
 ds_read_b64_tr_b16 a[216:217], v16 offset:16384
 ds_read_b64_tr_b16 a[218:219], v16 offset:24576
 ds_read_b64_tr_b16 a[220:221], v16 offset:18432
 ds_read_b64_tr_b16 a[222:223], v16 offset:26624
 s_waitcnt lgkmcnt(0)
 s_barrier
 s_lshl_b32 s14, s52, 8
 s_add_u32 s14, s14, 1310720
 s_mov_b32 m0, 40960
 s_nop 0
 buffer_load_dwordx4 v10, s[8:11], s14 offen lds
 s_add_u32 s14, s14, 32768
 s_mov_b32 m0, 41984
 s_nop 0
 buffer_load_dwordx4 v10, s[8:11], s14 offen lds
 s_add_u32 s14, s14, 32768
 s_mov_b32 m0, 43008
 s_nop 0
 buffer_load_dwordx4 v10, s[8:11], s14 offen lds
 s_add_u32 s14, s14, 32768
 s_mov_b32 m0, 44032
 s_nop 0
 buffer_load_dwordx4 v10, s[8:11], s14 offen lds
 s_add_u32 s14, s14, 32768
 s_mov_b32 m0, 45056
 s_nop 0
 buffer_load_dwordx4 v11, s[8:11], s14 offen lds
 s_add_u32 s14, s14, 32768
 s_mov_b32 m0, 46080
 s_nop 0
 buffer_load_dwordx4 v11, s[8:11], s14 offen lds
 s_add_u32 s14, s14, 32768
 s_mov_b32 m0, 47104
 s_nop 0
 buffer_load_dwordx4 v11, s[8:11], s14 offen lds
 s_add_u32 s14, s14, 32768
 s_mov_b32 m0, 48128
 s_nop 0
 buffer_load_dwordx4 v11, s[8:11], s14 offen lds
 s_waitcnt vmcnt(32)
 s_barrier
 v_xor_b32 v16, 0, v12
 v_add_u32 v16, 65536, v16
 ds_read_b64_tr_b16 a[224:225], v16 offset:0
 ds_read_b64_tr_b16 a[226:227], v16 offset:8192
 ds_read_b64_tr_b16 a[228:229], v16 offset:2048
 ds_read_b64_tr_b16 a[230:231], v16 offset:10240
 v_xor_b32 v16, 32, v12
 v_add_u32 v16, 65536, v16
 ds_read_b64_tr_b16 a[232:233], v16 offset:0
 ds_read_b64_tr_b16 a[234:235], v16 offset:8192
 ds_read_b64_tr_b16 a[236:237], v16 offset:2048
 ds_read_b64_tr_b16 a[238:239], v16 offset:10240
 v_xor_b32 v16, 0, v12
 v_add_u32 v16, 65536, v16
 ds_read_b64_tr_b16 a[240:241], v16 offset:16384
 ds_read_b64_tr_b16 a[242:243], v16 offset:24576
 ds_read_b64_tr_b16 a[244:245], v16 offset:18432
 ds_read_b64_tr_b16 a[246:247], v16 offset:26624
 v_xor_b32 v16, 32, v12
 v_add_u32 v16, 65536, v16
 ds_read_b64_tr_b16 a[248:249], v16 offset:16384
 ds_read_b64_tr_b16 a[250:251], v16 offset:24576
 ds_read_b64_tr_b16 a[252:253], v16 offset:18432
 ds_read_b64_tr_b16 a[254:255], v16 offset:26624
 s_waitcnt lgkmcnt(0)
 s_barrier
 s_lshl_b32 s14, s52, 8
 s_add_u32 s14, s14, 2359296
 s_mov_b32 m0, 73728
 s_nop 0
 buffer_load_dwordx4 v10, s[8:11], s14 offen lds
 s_add_u32 s14, s14, 32768
 s_mov_b32 m0, 74752
 s_nop 0
 buffer_load_dwordx4 v10, s[8:11], s14 offen lds
 s_add_u32 s14, s14, 32768
 s_mov_b32 m0, 75776
 s_nop 0
 buffer_load_dwordx4 v10, s[8:11], s14 offen lds
 s_add_u32 s14, s14, 32768
 s_mov_b32 m0, 76800
 s_nop 0
 buffer_load_dwordx4 v10, s[8:11], s14 offen lds
 s_add_u32 s14, s14, 32768
 s_mov_b32 m0, 77824
 s_nop 0
 buffer_load_dwordx4 v11, s[8:11], s14 offen lds
 s_add_u32 s14, s14, 32768
 s_mov_b32 m0, 78848
 s_nop 0
 buffer_load_dwordx4 v11, s[8:11], s14 offen lds
 s_add_u32 s14, s14, 32768
 s_mov_b32 m0, 79872
 s_nop 0
 buffer_load_dwordx4 v11, s[8:11], s14 offen lds
 s_add_u32 s14, s14, 32768
 s_mov_b32 m0, 80896
 s_nop 0
 buffer_load_dwordx4 v11, s[8:11], s14 offen lds
 s_waitcnt vmcnt(32)
 s_barrier
 v_xor_b32 v16, 0, v12
 v_add_u32 v16, 98304, v16
 ds_read_b64_tr_b16 v[64:65], v16 offset:0
 ds_read_b64_tr_b16 v[66:67], v16 offset:8192
 ds_read_b64_tr_b16 v[68:69], v16 offset:2048
 ds_read_b64_tr_b16 v[70:71], v16 offset:10240
 v_xor_b32 v16, 32, v12
 v_add_u32 v16, 98304, v16
 ds_read_b64_tr_b16 v[72:73], v16 offset:0
 ds_read_b64_tr_b16 v[74:75], v16 offset:8192
 ds_read_b64_tr_b16 v[76:77], v16 offset:2048
 ds_read_b64_tr_b16 v[78:79], v16 offset:10240
 v_xor_b32 v16, 0, v12
 v_add_u32 v16, 98304, v16
 ds_read_b64_tr_b16 v[80:81], v16 offset:16384
 ds_read_b64_tr_b16 v[82:83], v16 offset:24576
 ds_read_b64_tr_b16 v[84:85], v16 offset:18432
 ds_read_b64_tr_b16 v[86:87], v16 offset:26624
 v_xor_b32 v16, 32, v12
 v_add_u32 v16, 98304, v16
 ds_read_b64_tr_b16 v[88:89], v16 offset:16384
 ds_read_b64_tr_b16 v[90:91], v16 offset:24576
 ds_read_b64_tr_b16 v[92:93], v16 offset:18432
 ds_read_b64_tr_b16 v[94:95], v16 offset:26624
 s_waitcnt lgkmcnt(0)
 s_barrier
 s_lshl_b32 s14, s52, 8
 s_add_u32 s14, s14, 3407872
 s_mov_b32 m0, 106496
 s_nop 0
 buffer_load_dwordx4 v10, s[8:11], s14 offen lds
 s_add_u32 s14, s14, 32768
 s_mov_b32 m0, 107520
 s_nop 0
 buffer_load_dwordx4 v10, s[8:11], s14 offen lds
 s_add_u32 s14, s14, 32768
 s_mov_b32 m0, 108544
 s_nop 0
 buffer_load_dwordx4 v10, s[8:11], s14 offen lds
 s_add_u32 s14, s14, 32768
 s_mov_b32 m0, 109568
 s_nop 0
 buffer_load_dwordx4 v10, s[8:11], s14 offen lds
 s_add_u32 s14, s14, 32768
 s_mov_b32 m0, 110592
 s_nop 0
 buffer_load_dwordx4 v11, s[8:11], s14 offen lds
 s_add_u32 s14, s14, 32768
 s_mov_b32 m0, 111616
 s_nop 0
 buffer_load_dwordx4 v11, s[8:11], s14 offen lds
 s_add_u32 s14, s14, 32768
 s_mov_b32 m0, 112640
 s_nop 0
 buffer_load_dwordx4 v11, s[8:11], s14 offen lds
 s_add_u32 s14, s14, 32768
 s_mov_b32 m0, 113664
 s_nop 0
 buffer_load_dwordx4 v11, s[8:11], s14 offen lds
 s_waitcnt vmcnt(32)
 s_barrier
 v_xor_b32 v16, 0, v12
 v_add_u32 v16, 131072, v16
 ds_read_b64_tr_b16 v[96:97], v16 offset:0
 ds_read_b64_tr_b16 v[98:99], v16 offset:8192
 ds_read_b64_tr_b16 v[100:101], v16 offset:2048
 ds_read_b64_tr_b16 v[102:103], v16 offset:10240
 v_xor_b32 v16, 32, v12
 v_add_u32 v16, 131072, v16
 ds_read_b64_tr_b16 v[104:105], v16 offset:0
 ds_read_b64_tr_b16 v[106:107], v16 offset:8192
 ds_read_b64_tr_b16 v[108:109], v16 offset:2048
 ds_read_b64_tr_b16 v[110:111], v16 offset:10240
 v_xor_b32 v16, 0, v12
 v_add_u32 v16, 131072, v16
 ds_read_b64_tr_b16 v[112:113], v16 offset:16384
 ds_read_b64_tr_b16 v[114:115], v16 offset:24576
 ds_read_b64_tr_b16 v[116:117], v16 offset:18432
 ds_read_b64_tr_b16 v[118:119], v16 offset:26624
 v_xor_b32 v16, 32, v12
 v_add_u32 v16, 131072, v16
 ds_read_b64_tr_b16 v[120:121], v16 offset:16384
 ds_read_b64_tr_b16 v[122:123], v16 offset:24576
 ds_read_b64_tr_b16 v[124:125], v16 offset:18432
 ds_read_b64_tr_b16 v[126:127], v16 offset:26624
 s_waitcnt lgkmcnt(0)
 s_barrier
 s_lshl_b32 s14, s52, 8
 s_add_u32 s14, s14, 4456448
 s_mov_b32 m0, 139264
 s_nop 0
 buffer_load_dwordx4 v10, s[8:11], s14 offen lds
 s_add_u32 s14, s14, 32768
 s_mov_b32 m0, 140288
 s_nop 0
 buffer_load_dwordx4 v10, s[8:11], s14 offen lds
 s_add_u32 s14, s14, 32768
 s_mov_b32 m0, 141312
 s_nop 0
 buffer_load_dwordx4 v10, s[8:11], s14 offen lds
 s_add_u32 s14, s14, 32768
 s_mov_b32 m0, 142336
 s_nop 0
 buffer_load_dwordx4 v10, s[8:11], s14 offen lds
 s_add_u32 s14, s14, 32768
 s_mov_b32 m0, 143360
 s_nop 0
 buffer_load_dwordx4 v11, s[8:11], s14 offen lds
 s_add_u32 s14, s14, 32768
 s_mov_b32 m0, 144384
 s_nop 0
 buffer_load_dwordx4 v11, s[8:11], s14 offen lds
 s_add_u32 s14, s14, 32768
 s_mov_b32 m0, 145408
 s_nop 0
 buffer_load_dwordx4 v11, s[8:11], s14 offen lds
 s_add_u32 s14, s14, 32768
 s_mov_b32 m0, 146432
 s_nop 0
 buffer_load_dwordx4 v11, s[8:11], s14 offen lds
 s_waitcnt vmcnt(32)
 s_barrier
 v_xor_b32 v16, 0, v12
 v_add_u32 v16, 0, v16
 ds_read_b64_tr_b16 v[128:129], v16 offset:0
 ds_read_b64_tr_b16 v[130:131], v16 offset:8192
 ds_read_b64_tr_b16 v[132:133], v16 offset:2048
 ds_read_b64_tr_b16 v[134:135], v16 offset:10240
 v_xor_b32 v16, 32, v12
 v_add_u32 v16, 0, v16
 ds_read_b64_tr_b16 v[136:137], v16 offset:0
 ds_read_b64_tr_b16 v[138:139], v16 offset:8192
 ds_read_b64_tr_b16 v[140:141], v16 offset:2048
 ds_read_b64_tr_b16 v[142:143], v16 offset:10240
 v_xor_b32 v16, 0, v12
 v_add_u32 v16, 0, v16
 ds_read_b64_tr_b16 v[144:145], v16 offset:16384
 ds_read_b64_tr_b16 v[146:147], v16 offset:24576
 ds_read_b64_tr_b16 v[148:149], v16 offset:18432
 ds_read_b64_tr_b16 v[150:151], v16 offset:26624
 v_xor_b32 v16, 32, v12
 v_add_u32 v16, 0, v16
 ds_read_b64_tr_b16 v[152:153], v16 offset:16384
 ds_read_b64_tr_b16 v[154:155], v16 offset:24576
 ds_read_b64_tr_b16 v[156:157], v16 offset:18432
 ds_read_b64_tr_b16 v[158:159], v16 offset:26624
 s_waitcnt lgkmcnt(0)
 s_barrier
 s_mov_b32 s8, s20
 s_and_b32 s9, s21, 0xffff
 s_mov_b32 s10, 5242880
 s_lshl_b32 s14, s52, 8
 s_add_u32 s14, s14, 262144
 s_mov_b32 m0, 8192
 s_nop 0
 buffer_load_dwordx4 v10, s[8:11], s14 offen lds
 s_add_u32 s14, s14, 32768
 s_mov_b32 m0, 9216
 s_nop 0
 buffer_load_dwordx4 v10, s[8:11], s14 offen lds
 s_add_u32 s14, s14, 32768
 s_mov_b32 m0, 10240
 s_nop 0
 buffer_load_dwordx4 v10, s[8:11], s14 offen lds
 s_add_u32 s14, s14, 32768
 s_mov_b32 m0, 11264
 s_nop 0
 buffer_load_dwordx4 v10, s[8:11], s14 offen lds
 s_add_u32 s14, s14, 32768
 s_mov_b32 m0, 12288
 s_nop 0
 buffer_load_dwordx4 v11, s[8:11], s14 offen lds
 s_add_u32 s14, s14, 32768
 s_mov_b32 m0, 13312
 s_nop 0
 buffer_load_dwordx4 v11, s[8:11], s14 offen lds
 s_add_u32 s14, s14, 32768
 s_mov_b32 m0, 14336
 s_nop 0
 buffer_load_dwordx4 v11, s[8:11], s14 offen lds
 s_add_u32 s14, s14, 32768
 s_mov_b32 m0, 15360
 s_nop 0
 buffer_load_dwordx4 v11, s[8:11], s14 offen lds
 s_waitcnt vmcnt(32)
 s_barrier
 v_xor_b32 v16, 0, v12
 v_add_u32 v16, 32768, v16
 ds_read_b64_tr_b16 v[32:33], v16 offset:0
 ds_read_b64_tr_b16 v[34:35], v16 offset:8192
 ds_read_b64_tr_b16 v[36:37], v16 offset:2048
 ds_read_b64_tr_b16 v[38:39], v16 offset:10240
 s_add_u32 s3, s63, 0
 s_waitcnt lgkmcnt(2)
 buffer_store_dwordx4 v[32:35], v1, s[4:7], s3 offen offset:0
 s_waitcnt lgkmcnt(0)
 buffer_store_dwordx4 v[36:39], v1, s[4:7], s3 offen offset:1024
 v_xor_b32 v16, 32, v12
 v_add_u32 v16, 32768, v16
 ds_read_b64_tr_b16 v[40:41], v16 offset:0
 ds_read_b64_tr_b16 v[42:43], v16 offset:8192
 ds_read_b64_tr_b16 v[44:45], v16 offset:2048
 ds_read_b64_tr_b16 v[46:47], v16 offset:10240
 s_add_u32 s3, s63, 2048
 s_waitcnt lgkmcnt(2)
 buffer_store_dwordx4 v[40:43], v1, s[4:7], s3 offen offset:0
 s_waitcnt lgkmcnt(0)
 buffer_store_dwordx4 v[44:47], v1, s[4:7], s3 offen offset:1024
 v_xor_b32 v16, 0, v12
 v_add_u32 v16, 32768, v16
 ds_read_b64_tr_b16 v[48:49], v16 offset:16384
 ds_read_b64_tr_b16 v[50:51], v16 offset:24576
 ds_read_b64_tr_b16 v[52:53], v16 offset:18432
 ds_read_b64_tr_b16 v[54:55], v16 offset:26624
 s_add_u32 s3, s63, 4096
 s_waitcnt lgkmcnt(2)
 buffer_store_dwordx4 v[48:51], v1, s[4:7], s3 offen offset:0
 s_waitcnt lgkmcnt(0)
 buffer_store_dwordx4 v[52:55], v1, s[4:7], s3 offen offset:1024
 v_xor_b32 v16, 32, v12
 v_add_u32 v16, 32768, v16
 ds_read_b64_tr_b16 v[56:57], v16 offset:16384
 ds_read_b64_tr_b16 v[58:59], v16 offset:24576
 ds_read_b64_tr_b16 v[60:61], v16 offset:18432
 ds_read_b64_tr_b16 v[62:63], v16 offset:26624
 s_add_u32 s3, s63, 6144
 s_waitcnt lgkmcnt(2)
 buffer_store_dwordx4 v[56:59], v1, s[4:7], s3 offen offset:0
 s_waitcnt lgkmcnt(0)
 buffer_store_dwordx4 v[60:63], v1, s[4:7], s3 offen offset:1024
 s_waitcnt lgkmcnt(0)
 s_barrier
 s_lshl_b32 s14, s52, 8
 s_add_u32 s14, s14, 1310720
 s_mov_b32 m0, 40960
 s_nop 0
 buffer_load_dwordx4 v10, s[8:11], s14 offen lds
 s_add_u32 s14, s14, 32768
 s_mov_b32 m0, 41984
 s_nop 0
 buffer_load_dwordx4 v10, s[8:11], s14 offen lds
 s_add_u32 s14, s14, 32768
 s_mov_b32 m0, 43008
 s_nop 0
 buffer_load_dwordx4 v10, s[8:11], s14 offen lds
 s_add_u32 s14, s14, 32768
 s_mov_b32 m0, 44032
 s_nop 0
 buffer_load_dwordx4 v10, s[8:11], s14 offen lds
 s_add_u32 s14, s14, 32768
 s_mov_b32 m0, 45056
 s_nop 0
 buffer_load_dwordx4 v11, s[8:11], s14 offen lds
 s_add_u32 s14, s14, 32768
 s_mov_b32 m0, 46080
 s_nop 0
 buffer_load_dwordx4 v11, s[8:11], s14 offen lds
 s_add_u32 s14, s14, 32768
 s_mov_b32 m0, 47104
 s_nop 0
 buffer_load_dwordx4 v11, s[8:11], s14 offen lds
 s_add_u32 s14, s14, 32768
 s_mov_b32 m0, 48128
 s_nop 0
 buffer_load_dwordx4 v11, s[8:11], s14 offen lds
 s_waitcnt vmcnt(40)
 s_barrier
 v_xor_b32 v16, 0, v12
 v_add_u32 v16, 65536, v16
 ds_read_b64_tr_b16 v[160:161], v16 offset:0
 ds_read_b64_tr_b16 v[162:163], v16 offset:8192
 ds_read_b64_tr_b16 v[164:165], v16 offset:2048
 ds_read_b64_tr_b16 v[166:167], v16 offset:10240
 v_xor_b32 v16, 32, v12
 v_add_u32 v16, 65536, v16
 ds_read_b64_tr_b16 v[168:169], v16 offset:0
 ds_read_b64_tr_b16 v[170:171], v16 offset:8192
 ds_read_b64_tr_b16 v[172:173], v16 offset:2048
 ds_read_b64_tr_b16 v[174:175], v16 offset:10240
 v_xor_b32 v16, 0, v12
 v_add_u32 v16, 65536, v16
 ds_read_b64_tr_b16 v[176:177], v16 offset:16384
 ds_read_b64_tr_b16 v[178:179], v16 offset:24576
 ds_read_b64_tr_b16 v[180:181], v16 offset:18432
 ds_read_b64_tr_b16 v[182:183], v16 offset:26624
 v_xor_b32 v16, 32, v12
 v_add_u32 v16, 65536, v16
 ds_read_b64_tr_b16 v[184:185], v16 offset:16384
 ds_read_b64_tr_b16 v[186:187], v16 offset:24576
 ds_read_b64_tr_b16 v[188:189], v16 offset:18432
 ds_read_b64_tr_b16 v[190:191], v16 offset:26624
 s_waitcnt lgkmcnt(0)
 s_barrier
 s_lshl_b32 s14, s52, 8
 s_add_u32 s14, s14, 2359296
 s_mov_b32 m0, 73728
 s_nop 0
 buffer_load_dwordx4 v10, s[8:11], s14 offen lds
 s_add_u32 s14, s14, 32768
 s_mov_b32 m0, 74752
 s_nop 0
 buffer_load_dwordx4 v10, s[8:11], s14 offen lds
 s_add_u32 s14, s14, 32768
 s_mov_b32 m0, 75776
 s_nop 0
 buffer_load_dwordx4 v10, s[8:11], s14 offen lds
 s_add_u32 s14, s14, 32768
 s_mov_b32 m0, 76800
 s_nop 0
 buffer_load_dwordx4 v10, s[8:11], s14 offen lds
 s_add_u32 s14, s14, 32768
 s_mov_b32 m0, 77824
 s_nop 0
 buffer_load_dwordx4 v11, s[8:11], s14 offen lds
 s_add_u32 s14, s14, 32768
 s_mov_b32 m0, 78848
 s_nop 0
 buffer_load_dwordx4 v11, s[8:11], s14 offen lds
 s_add_u32 s14, s14, 32768
 s_mov_b32 m0, 79872
 s_nop 0
 buffer_load_dwordx4 v11, s[8:11], s14 offen lds
 s_add_u32 s14, s14, 32768
 s_mov_b32 m0, 80896
 s_nop 0
 buffer_load_dwordx4 v11, s[8:11], s14 offen lds
 s_waitcnt vmcnt(40)
 s_barrier
 v_xor_b32 v16, 0, v12
 v_add_u32 v16, 98304, v16
 ds_read_b64_tr_b16 v[192:193], v16 offset:0
 ds_read_b64_tr_b16 v[194:195], v16 offset:8192
 ds_read_b64_tr_b16 v[196:197], v16 offset:2048
 ds_read_b64_tr_b16 v[198:199], v16 offset:10240
 v_xor_b32 v16, 32, v12
 v_add_u32 v16, 98304, v16
 ds_read_b64_tr_b16 v[32:33], v16 offset:0
 ds_read_b64_tr_b16 v[34:35], v16 offset:8192
 ds_read_b64_tr_b16 v[36:37], v16 offset:2048
 ds_read_b64_tr_b16 v[38:39], v16 offset:10240
 s_add_u32 s3, s63, 8192
 s_waitcnt lgkmcnt(2)
 buffer_store_dwordx4 v[32:35], v1, s[4:7], s3 offen offset:0
 s_waitcnt lgkmcnt(0)
 buffer_store_dwordx4 v[36:39], v1, s[4:7], s3 offen offset:1024
 v_xor_b32 v16, 0, v12
 v_add_u32 v16, 98304, v16
 ds_read_b64_tr_b16 v[200:201], v16 offset:16384
 ds_read_b64_tr_b16 v[202:203], v16 offset:24576
 ds_read_b64_tr_b16 v[204:205], v16 offset:18432
 ds_read_b64_tr_b16 v[206:207], v16 offset:26624
 v_xor_b32 v16, 32, v12
 v_add_u32 v16, 98304, v16
 ds_read_b64_tr_b16 v[208:209], v16 offset:16384
 ds_read_b64_tr_b16 v[210:211], v16 offset:24576
 ds_read_b64_tr_b16 v[212:213], v16 offset:18432
 ds_read_b64_tr_b16 v[214:215], v16 offset:26624
 s_waitcnt lgkmcnt(0)
 s_barrier
 s_lshl_b32 s14, s52, 8
 s_add_u32 s14, s14, 3407872
 s_mov_b32 m0, 106496
 s_nop 0
 buffer_load_dwordx4 v10, s[8:11], s14 offen lds
 s_add_u32 s14, s14, 32768
 s_mov_b32 m0, 107520
 s_nop 0
 buffer_load_dwordx4 v10, s[8:11], s14 offen lds
 s_add_u32 s14, s14, 32768
 s_mov_b32 m0, 108544
 s_nop 0
 buffer_load_dwordx4 v10, s[8:11], s14 offen lds
 s_add_u32 s14, s14, 32768
 s_mov_b32 m0, 109568
 s_nop 0
 buffer_load_dwordx4 v10, s[8:11], s14 offen lds
 s_add_u32 s14, s14, 32768
 s_mov_b32 m0, 110592
 s_nop 0
 buffer_load_dwordx4 v11, s[8:11], s14 offen lds
 s_add_u32 s14, s14, 32768
 s_mov_b32 m0, 111616
 s_nop 0
 buffer_load_dwordx4 v11, s[8:11], s14 offen lds
 s_add_u32 s14, s14, 32768
 s_mov_b32 m0, 112640
 s_nop 0
 buffer_load_dwordx4 v11, s[8:11], s14 offen lds
 s_add_u32 s14, s14, 32768
 s_mov_b32 m0, 113664
 s_nop 0
 buffer_load_dwordx4 v11, s[8:11], s14 offen lds
 s_waitcnt vmcnt(42)
 s_barrier
 v_xor_b32 v16, 0, v12
 v_add_u32 v16, 131072, v16
 ds_read_b64_tr_b16 v[216:217], v16 offset:0
 ds_read_b64_tr_b16 v[218:219], v16 offset:8192
 ds_read_b64_tr_b16 v[220:221], v16 offset:2048
 ds_read_b64_tr_b16 v[222:223], v16 offset:10240
 v_xor_b32 v16, 32, v12
 v_add_u32 v16, 131072, v16
 ds_read_b64_tr_b16 v[224:225], v16 offset:0
 ds_read_b64_tr_b16 v[226:227], v16 offset:8192
 ds_read_b64_tr_b16 v[228:229], v16 offset:2048
 ds_read_b64_tr_b16 v[230:231], v16 offset:10240
 v_xor_b32 v16, 0, v12
 v_add_u32 v16, 131072, v16
 ds_read_b64_tr_b16 v[232:233], v16 offset:16384
 ds_read_b64_tr_b16 v[234:235], v16 offset:24576
 ds_read_b64_tr_b16 v[236:237], v16 offset:18432
 ds_read_b64_tr_b16 v[238:239], v16 offset:26624
 v_xor_b32 v16, 32, v12
 v_add_u32 v16, 131072, v16
 ds_read_b64_tr_b16 v[40:41], v16 offset:16384
 ds_read_b64_tr_b16 v[42:43], v16 offset:24576
 ds_read_b64_tr_b16 v[44:45], v16 offset:18432
 ds_read_b64_tr_b16 v[46:47], v16 offset:26624
 s_add_u32 s3, s63, 10240
 s_waitcnt lgkmcnt(2)
 buffer_store_dwordx4 v[40:43], v1, s[4:7], s3 offen offset:0
 s_waitcnt lgkmcnt(0)
 buffer_store_dwordx4 v[44:47], v1, s[4:7], s3 offen offset:1024
 s_waitcnt lgkmcnt(0)
 s_barrier
 s_lshl_b32 s14, s52, 8
 s_add_u32 s14, s14, 4456448
 s_mov_b32 m0, 139264
 s_nop 0
 buffer_load_dwordx4 v10, s[8:11], s14 offen lds
 s_add_u32 s14, s14, 32768
 s_mov_b32 m0, 140288
 s_nop 0
 buffer_load_dwordx4 v10, s[8:11], s14 offen lds
 s_add_u32 s14, s14, 32768
 s_mov_b32 m0, 141312
 s_nop 0
 buffer_load_dwordx4 v10, s[8:11], s14 offen lds
 s_add_u32 s14, s14, 32768
 s_mov_b32 m0, 142336
 s_nop 0
 buffer_load_dwordx4 v10, s[8:11], s14 offen lds
 s_add_u32 s14, s14, 32768
 s_mov_b32 m0, 143360
 s_nop 0
 buffer_load_dwordx4 v11, s[8:11], s14 offen lds
 s_add_u32 s14, s14, 32768
 s_mov_b32 m0, 144384
 s_nop 0
 buffer_load_dwordx4 v11, s[8:11], s14 offen lds
 s_add_u32 s14, s14, 32768
 s_mov_b32 m0, 145408
 s_nop 0
 buffer_load_dwordx4 v11, s[8:11], s14 offen lds
 s_add_u32 s14, s14, 32768
 s_mov_b32 m0, 146432
 s_nop 0
 buffer_load_dwordx4 v11, s[8:11], s14 offen lds
 s_waitcnt vmcnt(44)
 s_barrier
 v_xor_b32 v16, 0, v12
 v_add_u32 v16, 0, v16
 ds_read_b64_tr_b16 v[240:241], v16 offset:0
 ds_read_b64_tr_b16 v[242:243], v16 offset:8192
 ds_read_b64_tr_b16 v[244:245], v16 offset:2048
 ds_read_b64_tr_b16 v[246:247], v16 offset:10240
 v_xor_b32 v16, 32, v12
 v_add_u32 v16, 0, v16
 ds_read_b64_tr_b16 v[248:249], v16 offset:0
 ds_read_b64_tr_b16 v[250:251], v16 offset:8192
 ds_read_b64_tr_b16 v[252:253], v16 offset:2048
 ds_read_b64_tr_b16 v[254:255], v16 offset:10240
 v_xor_b32 v16, 0, v12
 v_add_u32 v16, 0, v16
 ds_read_b64_tr_b16 v[32:33], v16 offset:16384
 ds_read_b64_tr_b16 v[34:35], v16 offset:24576
 ds_read_b64_tr_b16 v[36:37], v16 offset:18432
 ds_read_b64_tr_b16 v[38:39], v16 offset:26624
 v_xor_b32 v16, 32, v12
 v_add_u32 v16, 0, v16
 ds_read_b64_tr_b16 v[40:41], v16 offset:16384
 ds_read_b64_tr_b16 v[42:43], v16 offset:24576
 ds_read_b64_tr_b16 v[44:45], v16 offset:18432
 ds_read_b64_tr_b16 v[46:47], v16 offset:26624
 s_waitcnt lgkmcnt(0)
 s_barrier
 ds_write_b128 v1, v[224:227] offset:20480
 ds_write_b128 v1, v[228:231] offset:21504
 ds_write_b128 v1, v[216:219] offset:22528
 ds_write_b128 v1, v[220:223] offset:23552
 s_waitcnt lgkmcnt(0)
 v_mov_b32 v224, v32
 v_mov_b32 v225, v33
 v_mov_b32 v226, v34
 v_mov_b32 v227, v35
 v_mov_b32 v228, v36
 v_mov_b32 v229, v37
 v_mov_b32 v230, v38
 v_mov_b32 v231, v39
 v_mov_b32 v216, v40
 v_mov_b32 v217, v41
 v_mov_b32 v218, v42
 v_mov_b32 v219, v43
 v_mov_b32 v220, v44
 v_mov_b32 v221, v45
 v_mov_b32 v222, v46
 v_mov_b32 v223, v47
 s_waitcnt vmcnt(28)
 s_barrier
 v_xor_b32 v16, 0, v12
 v_add_u32 v16, 32768, v16
 ds_read_b64_tr_b16 v[32:33], v16 offset:0
 ds_read_b64_tr_b16 v[34:35], v16 offset:8192
 ds_read_b64_tr_b16 v[36:37], v16 offset:2048
 ds_read_b64_tr_b16 v[38:39], v16 offset:10240
 v_xor_b32 v16, 32, v12
 v_add_u32 v16, 32768, v16
 ds_read_b64_tr_b16 v[40:41], v16 offset:0
 ds_read_b64_tr_b16 v[42:43], v16 offset:8192
 ds_read_b64_tr_b16 v[44:45], v16 offset:2048
 ds_read_b64_tr_b16 v[46:47], v16 offset:10240
 v_xor_b32 v16, 0, v12
 v_add_u32 v16, 32768, v16
 ds_read_b64_tr_b16 v[48:49], v16 offset:16384
 ds_read_b64_tr_b16 v[50:51], v16 offset:24576
 ds_read_b64_tr_b16 v[52:53], v16 offset:18432
 ds_read_b64_tr_b16 v[54:55], v16 offset:26624
 v_xor_b32 v16, 32, v12
 v_add_u32 v16, 32768, v16
 ds_read_b64_tr_b16 v[56:57], v16 offset:16384
 ds_read_b64_tr_b16 v[58:59], v16 offset:24576
 ds_read_b64_tr_b16 v[60:61], v16 offset:18432
 ds_read_b64_tr_b16 v[62:63], v16 offset:26624
 s_waitcnt lgkmcnt(0)
 s_barrier
 ds_write_b128 v1, v[200:203] offset:40960
 ds_write_b128 v1, v[204:207] offset:41984
 ds_write_b128 v1, v[192:195] offset:43008
 ds_write_b128 v1, v[196:199] offset:44032
 ds_write_b128 v1, v[184:187] offset:45056
 ds_write_b128 v1, v[188:191] offset:46080
 ds_write_b128 v1, v[176:179] offset:47104
 ds_write_b128 v1, v[180:183] offset:48128
 s_waitcnt lgkmcnt(0)
 v_mov_b32 v200, v32
 v_mov_b32 v201, v33
 v_mov_b32 v202, v34
 v_mov_b32 v203, v35
 v_mov_b32 v204, v36
 v_mov_b32 v205, v37
 v_mov_b32 v206, v38
 v_mov_b32 v207, v39
 v_mov_b32 v192, v40
 v_mov_b32 v193, v41
 v_mov_b32 v194, v42
 v_mov_b32 v195, v43
 v_mov_b32 v196, v44
 v_mov_b32 v197, v45
 v_mov_b32 v198, v46
 v_mov_b32 v199, v47
 v_mov_b32 v184, v48
 v_mov_b32 v185, v49
 v_mov_b32 v186, v50
 v_mov_b32 v187, v51
 v_mov_b32 v188, v52
 v_mov_b32 v189, v53
 v_mov_b32 v190, v54
 v_mov_b32 v191, v55
 v_mov_b32 v176, v56
 v_mov_b32 v177, v57
 v_mov_b32 v178, v58
 v_mov_b32 v179, v59
 v_mov_b32 v180, v60
 v_mov_b32 v181, v61
 v_mov_b32 v182, v62
 v_mov_b32 v183, v63
 s_waitcnt vmcnt(20)
 s_barrier
 v_xor_b32 v16, 0, v12
 v_add_u32 v16, 65536, v16
 ds_read_b64_tr_b16 v[32:33], v16 offset:0
 ds_read_b64_tr_b16 v[34:35], v16 offset:8192
 ds_read_b64_tr_b16 v[36:37], v16 offset:2048
 ds_read_b64_tr_b16 v[38:39], v16 offset:10240
 v_xor_b32 v16, 32, v12
 v_add_u32 v16, 65536, v16
 ds_read_b64_tr_b16 v[40:41], v16 offset:0
 ds_read_b64_tr_b16 v[42:43], v16 offset:8192
 ds_read_b64_tr_b16 v[44:45], v16 offset:2048
 ds_read_b64_tr_b16 v[46:47], v16 offset:10240
 v_xor_b32 v16, 0, v12
 v_add_u32 v16, 65536, v16
 ds_read_b64_tr_b16 v[48:49], v16 offset:16384
 ds_read_b64_tr_b16 v[50:51], v16 offset:24576
 ds_read_b64_tr_b16 v[52:53], v16 offset:18432
 ds_read_b64_tr_b16 v[54:55], v16 offset:26624
 v_xor_b32 v16, 32, v12
 v_add_u32 v16, 65536, v16
 ds_read_b64_tr_b16 v[56:57], v16 offset:16384
 ds_read_b64_tr_b16 v[58:59], v16 offset:24576
 ds_read_b64_tr_b16 v[60:61], v16 offset:18432
 ds_read_b64_tr_b16 v[62:63], v16 offset:26624
 s_waitcnt lgkmcnt(0)
 s_barrier
 ds_write_b128 v2, v[160:163] offset:8192
 ds_write_b128 v2, v[164:167] offset:9216
 ds_write_b128 v2, v[144:147] offset:10240
 ds_write_b128 v2, v[148:151] offset:11264
 ds_write_b128 v2, v[136:139] offset:12288
 ds_write_b128 v2, v[140:143] offset:13312
 ds_write_b128 v2, v[128:131] offset:14336
 ds_write_b128 v2, v[132:135] offset:15360
 s_waitcnt lgkmcnt(0)
 v_mov_b32 v160, v32
 v_mov_b32 v161, v33
 v_mov_b32 v162, v34
 v_mov_b32 v163, v35
 v_mov_b32 v164, v36
 v_mov_b32 v165, v37
 v_mov_b32 v166, v38
 v_mov_b32 v167, v39
 v_mov_b32 v144, v40
 v_mov_b32 v145, v41
 v_mov_b32 v146, v42
 v_mov_b32 v147, v43
 v_mov_b32 v148, v44
 v_mov_b32 v149, v45
 v_mov_b32 v150, v46
 v_mov_b32 v151, v47
 v_mov_b32 v136, v48
 v_mov_b32 v137, v49
 v_mov_b32 v138, v50
 v_mov_b32 v139, v51
 v_mov_b32 v140, v52
 v_mov_b32 v141, v53
 v_mov_b32 v142, v54
 v_mov_b32 v143, v55
 v_mov_b32 v128, v56
 v_mov_b32 v129, v57
 v_mov_b32 v130, v58
 v_mov_b32 v131, v59
 v_mov_b32 v132, v60
 v_mov_b32 v133, v61
 v_mov_b32 v134, v62
 v_mov_b32 v135, v63
 s_waitcnt vmcnt(10)
 s_barrier
 v_xor_b32 v16, 0, v12
 v_add_u32 v16, 98304, v16
 ds_read_b64_tr_b16 v[32:33], v16 offset:0
 ds_read_b64_tr_b16 v[34:35], v16 offset:8192
 ds_read_b64_tr_b16 v[36:37], v16 offset:2048
 ds_read_b64_tr_b16 v[38:39], v16 offset:10240
 v_xor_b32 v16, 32, v12
 v_add_u32 v16, 98304, v16
 ds_read_b64_tr_b16 v[40:41], v16 offset:0
 ds_read_b64_tr_b16 v[42:43], v16 offset:8192
 ds_read_b64_tr_b16 v[44:45], v16 offset:2048
 ds_read_b64_tr_b16 v[46:47], v16 offset:10240
 v_xor_b32 v16, 0, v12
 v_add_u32 v16, 98304, v16
 ds_read_b64_tr_b16 v[48:49], v16 offset:16384
 ds_read_b64_tr_b16 v[50:51], v16 offset:24576
 ds_read_b64_tr_b16 v[52:53], v16 offset:18432
 ds_read_b64_tr_b16 v[54:55], v16 offset:26624
 v_xor_b32 v16, 32, v12
 v_add_u32 v16, 98304, v16
 ds_read_b64_tr_b16 v[56:57], v16 offset:16384
 ds_read_b64_tr_b16 v[58:59], v16 offset:24576
 ds_read_b64_tr_b16 v[60:61], v16 offset:18432
 ds_read_b64_tr_b16 v[62:63], v16 offset:26624
 s_waitcnt lgkmcnt(0)
 s_barrier
 ds_write_b128 v2, a[144:147] offset:40960
 ds_write_b128 v2, a[148:151] offset:41984
 ds_write_b128 v2, a[128:131] offset:43008
 ds_write_b128 v2, a[132:135] offset:44032
 ds_write_b128 v2, a[104:107] offset:45056
 ds_write_b128 v2, a[108:111] offset:46080
 ds_write_b128 v2, a[88:91] offset:47104
 ds_write_b128 v2, a[92:95] offset:48128
 s_waitcnt lgkmcnt(0)
 v_accvgpr_write_b32 a144, v32
 v_accvgpr_write_b32 a145, v33
 v_accvgpr_write_b32 a146, v34
 v_accvgpr_write_b32 a147, v35
 v_accvgpr_write_b32 a148, v36
 v_accvgpr_write_b32 a149, v37
 v_accvgpr_write_b32 a150, v38
 v_accvgpr_write_b32 a151, v39
 v_accvgpr_write_b32 a128, v40
 v_accvgpr_write_b32 a129, v41
 v_accvgpr_write_b32 a130, v42
 v_accvgpr_write_b32 a131, v43
 v_accvgpr_write_b32 a132, v44
 v_accvgpr_write_b32 a133, v45
 v_accvgpr_write_b32 a134, v46
 v_accvgpr_write_b32 a135, v47
 v_accvgpr_write_b32 a104, v48
 v_accvgpr_write_b32 a105, v49
 v_accvgpr_write_b32 a106, v50
 v_accvgpr_write_b32 a107, v51
 v_accvgpr_write_b32 a108, v52
 v_accvgpr_write_b32 a109, v53
 v_accvgpr_write_b32 a110, v54
 v_accvgpr_write_b32 a111, v55
 v_accvgpr_write_b32 a88, v56
 v_accvgpr_write_b32 a89, v57
 v_accvgpr_write_b32 a90, v58
 v_accvgpr_write_b32 a91, v59
 v_accvgpr_write_b32 a92, v60
 v_accvgpr_write_b32 a93, v61
 v_accvgpr_write_b32 a94, v62
 v_accvgpr_write_b32 a95, v63
 s_waitcnt vmcnt(0)
 s_barrier
 v_xor_b32 v16, 0, v12
 v_add_u32 v16, 131072, v16
 ds_read_b64_tr_b16 v[32:33], v16 offset:0
 ds_read_b64_tr_b16 v[34:35], v16 offset:8192
 ds_read_b64_tr_b16 v[36:37], v16 offset:2048
 ds_read_b64_tr_b16 v[38:39], v16 offset:10240
 v_xor_b32 v16, 32, v12
 v_add_u32 v16, 131072, v16
 ds_read_b64_tr_b16 v[40:41], v16 offset:0
 ds_read_b64_tr_b16 v[42:43], v16 offset:8192
 ds_read_b64_tr_b16 v[44:45], v16 offset:2048
 ds_read_b64_tr_b16 v[46:47], v16 offset:10240
 v_xor_b32 v16, 0, v12
 v_add_u32 v16, 131072, v16
 ds_read_b64_tr_b16 v[48:49], v16 offset:16384
 ds_read_b64_tr_b16 v[50:51], v16 offset:24576
 ds_read_b64_tr_b16 v[52:53], v16 offset:18432
 ds_read_b64_tr_b16 v[54:55], v16 offset:26624
 v_xor_b32 v16, 32, v12
 v_add_u32 v16, 131072, v16
 ds_read_b64_tr_b16 v[56:57], v16 offset:16384
 ds_read_b64_tr_b16 v[58:59], v16 offset:24576
 ds_read_b64_tr_b16 v[60:61], v16 offset:18432
 ds_read_b64_tr_b16 v[62:63], v16 offset:26624
 s_waitcnt lgkmcnt(0)
 s_barrier
 ds_write_b128 v3, a[80:83] offset:24576
 ds_write_b128 v3, a[84:87] offset:25600
 ds_write_b128 v3, a[72:75] offset:26624
 ds_write_b128 v3, a[76:79] offset:27648
 ds_write_b128 v3, a[32:35] offset:28672
 ds_write_b128 v3, a[36:39] offset:29696
 ds_write_b128 v3, a[24:27] offset:30720
 ds_write_b128 v3, a[28:31] offset:31744
 s_waitcnt lgkmcnt(0)
 v_accvgpr_write_b32 a80, v32
 v_accvgpr_write_b32 a81, v33
 v_accvgpr_write_b32 a82, v34
 v_accvgpr_write_b32 a83, v35
 v_accvgpr_write_b32 a84, v36
 v_accvgpr_write_b32 a85, v37
 v_accvgpr_write_b32 a86, v38
 v_accvgpr_write_b32 a87, v39
 v_accvgpr_write_b32 a72, v40
 v_accvgpr_write_b32 a73, v41
 v_accvgpr_write_b32 a74, v42
 v_accvgpr_write_b32 a75, v43
 v_accvgpr_write_b32 a76, v44
 v_accvgpr_write_b32 a77, v45
 v_accvgpr_write_b32 a78, v46
 v_accvgpr_write_b32 a79, v47
 v_accvgpr_write_b32 a32, v48
 v_accvgpr_write_b32 a33, v49
 v_accvgpr_write_b32 a34, v50
 v_accvgpr_write_b32 a35, v51
 v_accvgpr_write_b32 a36, v52
 v_accvgpr_write_b32 a37, v53
 v_accvgpr_write_b32 a38, v54
 v_accvgpr_write_b32 a39, v55
 v_accvgpr_write_b32 a24, v56
 v_accvgpr_write_b32 a25, v57
 v_accvgpr_write_b32 a26, v58
 v_accvgpr_write_b32 a27, v59
 v_accvgpr_write_b32 a28, v60
 v_accvgpr_write_b32 a29, v61
 v_accvgpr_write_b32 a30, v62
 v_accvgpr_write_b32 a31, v63
 v_lshlrev_b32 v5, 3, v0
 v_and_b32 v6, 0x1e0, v5
 v_and_b32 v7, 1, v0
 v_lshl_add_u32 v6, v7, 4, v6
 v_and_b32 v7, 2, v0
 v_lshl_add_u32 v6, v7, 2, v6
 v_bfe_u32 v4, v0, 2, 2
 v_lshrrev_b32 v7, 4, v0
 v_cmp_eq_u32 vcc, v4, v7
 v_and_b32 v7, 16, v1
 v_mov_b32 v5, 0x3f80
 v_lshlrev_b32 v7, v7, v5
 v_cndmask_b32 v4, 0, v7, vcc
 v_mov_b32 v5, 0
 s_lshl_b32 s59, s53, 16
 s_add_u32 s59, s59, 983040
 s_mul_i32 s15, s53, 327680
 s_add_u32 s15, s15, 225280
 s_lshl_b32 s3, s52, 8
 s_add_u32 s15, s15, s3
 s_add_u32 s64, s15, 128
 s_add_u32 s65, s15, 82048
 s_add_u32 s66, s15, 163968
 s_add_u32 s67, s15, 245888
 s_lshr_b32 s14, s52, 2
 s_and_b32 s15, s52, 3
 s_mov_b32 s16, 2
 s_mov_b32 s84, 0x00ff00ff
 s_mov_b32 s85, 0
 s_lshl_b32 s57, s14, 10
 s_lshl_b32 s3, s15, 6
 s_add_u32 s57, s57, s3
 s_lshl_b32 s3, s16, 8
 s_add_u32 s57, s57, s3
 s_add_u32 s57, s57, s59
 s_add_u32 s59, s59, 2048
 s_lshl_b32 s14, s14, 7
 s_mul_i32 s15, s15, 2560
 s_add_u32 s14, s14, s15
 s_lshl_b32 s3, s16, 3
 s_add_u32 s14, s14, s3
 s_mov_b32 s8, s18
 s_and_b32 s9, s19, 0xffff
 s_mov_b32 s10, 10240
 s_mov_b32 s11, 0x00020000
 v_bfe_u32 v40, v0, 4, 1
 v_mul_u32_u24 v40, 1280, v40
 v_and_b32 v41, 7, v0
 v_lshl_add_u32 v40, v41, 1, v40
 buffer_load_ushort v44, v40, s[8:11], s14 offen offset:0
 buffer_load_ushort v45, v40, s[8:11], s14 offen offset:32
 buffer_load_ushort v46, v40, s[8:11], s14 offen offset:64
 buffer_load_ushort v47, v40, s[8:11], s14 offen offset:96
 v_lshrrev_b32 v42, 7, v1
 v_mul_u32_u24 v42, 10240, v42
 v_and_b32 v7, 112, v1
 v_add_u32 v42, v42, v7
 v_and_b32 v43, 32, v1
 v_and_b32 v7, 64, v1
 v_lshl_add_u32 v43, v7, 2, v43
 v_bfe_u32 v7, v1, 8, 1
 v_lshl_add_u32 v43, v7, 4, v43
 v_bfe_u32 v7, v1, 4, 1
 v_lshl_add_u32 v43, v7, 3, v43
 s_waitcnt vmcnt(2)
 v_lshl_or_b32 v44, v45, 16, v44
 s_waitcnt vmcnt(0)
 v_lshl_or_b32 v45, v47, 16, v46
 s_add_u32 s16, s60, 6144
 s_waitcnt vmcnt(0) lgkmcnt(0)
 s_mov_b32 s96, s44
 s_and_b32 s97, s45, 0xffff
 s_mov_b32 s98, 256
 s_mov_b32 s99, 0x00020000
 v_mov_b32 v8, 132
 s_mov_b32 s51, 0
 s_mov_b64 exec, 1
L_wb_174:
 buffer_load_dword v9, v8, s[96:99], 0 offen sc1
 s_waitcnt vmcnt(0)
 v_cmp_eq_u32 vcc, 0, v9
 s_cbranch_vccz L_wbd_175
 s_sleep 2
 s_add_u32 s51, s51, 1
 s_cmp_lt_u32 s51, 131072
 s_cbranch_scc1 L_wb_174
 s_branch L_bail
L_wbd_175:
 s_mov_b64 exec, -1
 s_mov_b32 s96, s44
 s_and_b32 s97, s45, 0xffff
 s_mov_b32 s98, 256
 s_mov_b32 s99, 0x00020000
 v_mov_b32 v8, 212
 s_mov_b32 s51, 0
 s_mov_b64 exec, 1
L_wb_176:
 buffer_load_dword v9, v8, s[96:99], 0 offen sc1
 s_waitcnt vmcnt(0)
 v_cmp_eq_u32 vcc, 0, v9
 s_cbranch_vccz L_wbd_177
 s_sleep 2
 s_add_u32 s51, s51, 1
 s_cmp_lt_u32 s51, 131072
 s_cbranch_scc1 L_wb_176
 s_branch L_bail
L_wbd_177:
 s_mov_b64 exec, -1
 s_mov_b32 s96, s44
 s_and_b32 s97, s45, 0xffff
 s_mov_b32 s98, 256
 s_mov_b32 s99, 0x00020000
 v_lshlrev_b32 v8, 5, v0
 s_mov_b32 s51, 0
L_gl_178:
 buffer_load_dword v9, v8, s[96:99], 0 offen sc1
 s_waitcnt vmcnt(0)
 v_readlane_b32 s3, v9, s48
 s_mov_b32 s80, 0
 s_nop 2
 s_cmp_ge_u32 s3, 32
 s_cbranch_scc1 L_gld_179
 s_mov_b32 s80, 0
 v_readlane_b32 s3, v9, 0
 s_nop 3
 s_add_u32 s80, s80, s3
 v_readlane_b32 s3, v9, 1
 s_nop 3
 s_add_u32 s80, s80, s3
 v_readlane_b32 s3, v9, 2
 s_nop 3
 s_add_u32 s80, s80, s3
 v_readlane_b32 s3, v9, 3
 s_nop 3
 s_add_u32 s80, s80, s3
 v_readlane_b32 s3, v9, 4
 s_nop 3
 s_add_u32 s80, s80, s3
 v_readlane_b32 s3, v9, 5
 s_nop 3
 s_add_u32 s80, s80, s3
 v_readlane_b32 s3, v9, 6
 s_nop 3
 s_add_u32 s80, s80, s3
 v_readlane_b32 s3, v9, 7
 s_nop 3
 s_add_u32 s80, s80, s3
 s_cmp_ge_u32 s80, 256
 s_cbranch_scc1 L_gld_179
 s_sleep 4
 s_add_u32 s51, s51, 1
 s_cmp_lt_u32 s51, 131072
 s_cbranch_scc1 L_gl_178
 s_branch L_bail
L_gld_179:
 s_mov_b64 exec, s[84:85]
 buffer_store_dwordx2 v[44:45], v43, s[4:7], s57 offen sc1
 s_mov_b64 exec, -1
 v_and_b32 v7, 2, v0
 v_mul_u32_u24 v7, 0x5555, v7
 v_add_u32 v0, 0x4444, v7
 s_mov_b32 m0, 2048
 s_waitcnt vmcnt(0) lgkmcnt(0)
 s_barrier
 buffer_load_dwordx4 v[32:35], v1, s[4:7], s63 offen offset:0
 buffer_load_dwordx4 v[36:39], v1, s[4:7], s63 offen offset:1024
 buffer_load_dwordx4 v[40:43], v1, s[4:7], s63 offen offset:2048
 buffer_load_dwordx4 v[44:47], v1, s[4:7], s63 offen offset:3072
 buffer_load_dwordx4 v[48:51], v1, s[4:7], s81 offen offset:0
 buffer_load_dwordx4 v[52:55], v1, s[4:7], s81 offen offset:1024
 buffer_load_dwordx4 v[56:59], v1, s[4:7], s81 offen offset:2048
 buffer_load_dwordx4 v[60:63], v1, s[4:7], s81 offen offset:3072
 ds_read_b128 v[8:11], v3 offset:49152
 ds_read_b128 v[12:15], v3 offset:49152
 ds_read_b128 v[16:19], v3 offset:49152
 ds_read_b128 v[20:23], v3 offset:49152
 s_waitcnt vmcnt(0) lgkmcnt(0)
 s_cmp_lg_u32 s80, 0
 s_cbranch_scc1 L_ch1_s
.p2align 6
L_ch1_f:
 s_mov_b32 s51, 0
L_pm_180:
 buffer_load_dwordx4 v[24:27], v1, s[4:7], s59 offen offset:0 sc1
 buffer_load_dwordx4 v[28:31], v1, s[4:7], s59 offen offset:1024 sc1
 s_waitcnt vmcnt(1)
 ds_write_b128 v1, v[24:27] offset:2048
 v_max_u32 v7, v24, v26
 s_waitcnt vmcnt(0)
 ds_write_b128 v1, v[28:31] offset:3072
 v_max3_u32 v7, v7, v28, v30
 v_cmp_eq_u32 vcc, -1, v7
 s_cbranch_vccnz L_rt_181
 v_smfmac_f32_16x16x64_bf16 v[16:19], v[24:27], v[32:39], v0
 ds_read_b128 v[32:35], v2 offset:14336
 ds_read_b128 v[36:39], v2 offset:15360
 v_smfmac_f32_16x16x64_bf16 v[20:23], v[24:27], v[40:47], v0
 ds_read_b128 v[40:43], v2 offset:12288
 ds_read_b128 v[44:47], v2 offset:13312
 v_smfmac_f32_16x16x64_bf16 v[16:19], v[28:31], v[48:55], v0
 v_smfmac_f32_16x16x64_bf16 v[20:23], v[28:31], v[56:63], v0
 s_waitcnt lgkmcnt(4)
 s_barrier
 buffer_load_dwordx4 v[56:59], v1, s[4:7], s101 offen offset:0
 v_smfmac_f32_16x16x64_bf16 v[8:11], v[24:27], v[200:207], v0
 v_smfmac_f32_16x16x64_bf16 v[12:15], v[24:27], v[192:199], v0
 ds_read_b128 v[24:27], v1 offset:0
 buffer_load_dwordx4 v[60:63], v1, s[4:7], s101 offen offset:1024
 v_smfmac_f32_16x16x64_bf16 v[8:11], v[28:31], v[184:191], v0
 v_smfmac_f32_16x16x64_bf16 v[12:15], v[28:31], v[176:183], v0
 ds_read_b128 v[28:31], v1 offset:1024
 buffer_load_dwordx4 v[48:51], v1, s[4:7], s101 offen offset:2048
 s_waitcnt lgkmcnt(1)
 v_smfmac_f32_16x16x64_bf16 v[16:19], v[24:27], v[32:39], v0
 ds_read_b128 v[32:35], v2 offset:10240
 ds_read_b128 v[36:39], v2 offset:11264
 v_smfmac_f32_16x16x64_bf16 v[8:11], v[24:27], v[240:247], v0
 buffer_load_dwordx4 v[52:55], v1, s[4:7], s101 offen offset:3072
 v_smfmac_f32_16x16x64_bf16 v[12:15], v[24:27], v[248:255], v0
 v_smfmac_f32_16x16x64_bf16 v[20:23], v[24:27], v[40:47], v0
 ds_read_b128 v[40:43], v2 offset:8192
 ds_read_b128 v[44:47], v2 offset:9216
 ds_read_b128 v[24:27], v1 offset:4096
 s_waitcnt lgkmcnt(5)
 v_smfmac_f32_16x16x64_bf16 v[8:11], v[28:31], v[224:231], v0
 v_smfmac_f32_16x16x64_bf16 v[12:15], v[28:31], v[216:223], v0
 s_waitcnt lgkmcnt(3)
 v_smfmac_f32_16x16x64_bf16 v[16:19], v[28:31], v[32:39], v0
 ds_read_b128 v[32:35], v1 offset:47104
 ds_read_b128 v[36:39], v1 offset:48128
 v_smfmac_f32_16x16x64_bf16 v[20:23], v[28:31], v[152:159], v0
 ds_read_b128 v[28:31], v1 offset:5120
 s_waitcnt lgkmcnt(3)
 v_smfmac_f32_16x16x64_bf16 v[8:11], v[24:27], v[160:167], v0
 v_smfmac_f32_16x16x64_bf16 v[16:19], v[24:27], v[40:47], v0
 ds_read_b128 v[40:43], v1 offset:45056
 ds_read_b128 v[44:47], v1 offset:46080
 v_smfmac_f32_16x16x64_bf16 v[12:15], v[24:27], v[144:151], v0
 v_smfmac_f32_16x16x64_bf16 v[20:23], v[24:27], v[168:175], v0
 ds_read_b128 v[24:27], v1 offset:6144
 s_waitcnt lgkmcnt(3)
 v_smfmac_f32_16x16x64_bf16 v[16:19], v[28:31], v[32:39], v0
 ds_read_b128 v[32:35], v1 offset:43008
 ds_read_b128 v[36:39], v1 offset:44032
 v_smfmac_f32_16x16x64_bf16 v[8:11], v[28:31], v[136:143], v0
 v_smfmac_f32_16x16x64_bf16 v[12:15], v[28:31], v[128:135], v0
 s_waitcnt lgkmcnt(3)
 v_smfmac_f32_16x16x64_bf16 v[20:23], v[28:31], v[40:47], v0
 ds_read_b128 v[40:43], v1 offset:40960
 ds_read_b128 v[44:47], v1 offset:41984
 ds_read_b128 v[28:31], v1 offset:7168
 s_waitcnt lgkmcnt(5)
 v_smfmac_f32_16x16x64_bf16 v[8:11], v[24:27], a[144:151], v0
 v_smfmac_f32_16x16x64_bf16 v[12:15], v[24:27], a[128:135], v0
 s_waitcnt lgkmcnt(3)
 v_smfmac_f32_16x16x64_bf16 v[16:19], v[24:27], v[32:39], v0
 ds_read_b128 v[32:35], v1 offset:22528
 ds_read_b128 v[36:39], v1 offset:23552
 s_waitcnt vmcnt(2)
 v_smfmac_f32_16x16x64_bf16 v[20:23], v[24:27], v[56:63], v0
 ds_read_b128 v[24:27], v1 offset:8192
 buffer_load_dwordx4 v[56:59], v1, s[4:7], s61 offen offset:1024 sc1 nt
 s_waitcnt lgkmcnt(3)
 v_smfmac_f32_16x16x64_bf16 v[8:11], v[28:31], a[104:111], v0
 v_smfmac_f32_16x16x64_bf16 v[16:19], v[28:31], v[40:47], v0
 ds_read_b128 v[40:43], v1 offset:20480
 ds_read_b128 v[44:47], v1 offset:21504
 s_add_u32 s3, s61, 4096
 buffer_load_dwordx4 v[60:63], v1, s[4:7], s3 offen offset:1024 sc1 nt
 v_smfmac_f32_16x16x64_bf16 v[12:15], v[28:31], a[88:95], v0
 v_smfmac_f32_16x16x64_bf16 v[20:23], v[28:31], v[208:215], v0
 ds_read_b128 v[28:31], v1 offset:9216
 s_waitcnt lgkmcnt(3)
 v_smfmac_f32_16x16x64_bf16 v[16:19], v[24:27], v[32:39], v0
 v_smfmac_f32_16x16x64_bf16 v[8:11], v[24:27], a[80:87], v0
 s_add_u32 s3, s61, 67110912
 buffer_load_dwordx4 v[32:35], v1, s[4:7], s3 offen offset:0 sc1 nt
 v_smfmac_f32_16x16x64_bf16 v[12:15], v[24:27], a[72:79], v0
 s_waitcnt lgkmcnt(1)
 v_smfmac_f32_16x16x64_bf16 v[20:23], v[24:27], v[40:47], v0
 ds_read_b128 v[40:43], v3 offset:49152
 ds_read_b128 v[44:47], v3 offset:49152
 buffer_load_dwordx4 v[36:39], v1, s[4:7], s3 offen offset:1024 sc1 nt
 s_waitcnt lgkmcnt(2)
 v_smfmac_f32_16x16x64_bf16 v[8:11], v[28:31], a[32:39], v0
 v_smfmac_f32_16x16x64_bf16 v[12:15], v[28:31], a[24:31], v0
 v_lshlrev_b32 v7, 3, v1
 v_smfmac_f32_16x16x64_bf16 v[16:19], v[28:31], v[232:239], v0
 s_waitcnt vmcnt(4)
 v_smfmac_f32_16x16x64_bf16 v[20:23], v[28:31], v[48:55], v0
 s_add_u32 s3, s61, 524288
 buffer_load_dword v7, v7, s[4:7], s3 offen sc1
 ds_read_b128 v[52:55], v1 offset:0
 v_add_f32 v8, v8, v10
 v_add_f32 v11, v9, v11
 v_cvt_pk_bf16_f32 v9, v8, v11
 v_cvt_pk_bf16_f32 v8, v8, v11
 v_add_f32 v12, v12, v14
 v_add_f32 v15, v13, v15
 v_cvt_pk_bf16_f32 v13, v12, v15
 v_cvt_pk_bf16_f32 v12, v12, v15
 v_mfma_f32_16x16x16_bf16 v[8:11], v[8:9], v[4:5], 0
 v_mfma_f32_16x16x16_bf16 v[12:15], v[12:13], v[4:5], 0
 v_add_f32 v16, v16, v18
 v_add_f32 v19, v17, v19
 v_cvt_pk_bf16_f32 v17, v16, v19
 v_cvt_pk_bf16_f32 v16, v16, v19
 v_add_f32 v20, v20, v22
 v_add_f32 v23, v21, v23
 v_cvt_pk_bf16_f32 v21, v20, v23
 v_cvt_pk_bf16_f32 v20, v20, v23
 v_mfma_f32_16x16x16_bf16 v[16:19], v[16:17], v[4:5], 0
 v_mfma_f32_16x16x16_bf16 v[20:23], v[20:21], v[4:5], 0
 s_waitcnt lgkmcnt(2)
 v_smfmac_f32_16x16x64_bf16 v[40:43], v[24:27], v[96:103], v0
 s_waitcnt lgkmcnt(1)
 v_smfmac_f32_16x16x64_bf16 v[44:47], v[24:27], v[104:111], v0
 ds_read_b128 v[24:27], v1 offset:1024
 v_cvt_pk_bf16_f32 v15, v14, v15
 v_cvt_pk_bf16_f32 v14, v12, v13
 v_cvt_pk_bf16_f32 v13, v10, v11
 v_cvt_pk_bf16_f32 v12, v8, v9
 s_waitcnt vmcnt(4)
 s_nop 0
 v_mfma_f32_16x16x32_bf16 v[8:11], v[56:59], v[12:15], 0
 v_cvt_pk_bf16_f32 v23, v22, v23
 v_cvt_pk_bf16_f32 v22, v20, v21
 v_cvt_pk_bf16_f32 v21, v18, v19
 v_cvt_pk_bf16_f32 v20, v16, v17
 s_waitcnt vmcnt(3)
 v_mfma_f32_16x16x32_bf16 v[16:19], v[60:63], v[12:15], 0
 v_mfma_f32_16x16x32_bf16 v[48:51], v[20:23], v[12:15], 0
 v_smfmac_f32_16x16x64_bf16 v[40:43], v[28:31], v[112:119], v0
 v_smfmac_f32_16x16x64_bf16 v[44:47], v[28:31], v[120:127], v0
 ds_read_b128 v[28:31], v1 offset:2048
 s_waitcnt lgkmcnt(2)
 v_smfmac_f32_16x16x64_bf16 v[40:43], v[52:55], a[160:167], v0
 v_cndmask_b32 v8, v8, v16, s[70:71]
 v_cndmask_b32 v9, v9, v17, s[70:71]
 v_cndmask_b32 v10, v10, v18, s[70:71]
 v_cndmask_b32 v11, v11, v19, s[70:71]
 ds_write_b128 v1, v[8:11] offset:11264
 ds_write_b64 v1, v[48:49] offset:14344
 v_smfmac_f32_16x16x64_bf16 v[44:47], v[52:55], a[168:175], v0
 ds_read_b128 v[52:55], v1 offset:3072
 s_waitcnt lgkmcnt(4)
 v_smfmac_f32_16x16x64_bf16 v[40:43], v[24:27], a[176:183], v0
 v_smfmac_f32_16x16x64_bf16 v[44:47], v[24:27], a[184:191], v0
 ds_read_b128 v[24:27], v1 offset:4096
 s_waitcnt lgkmcnt(4)
 v_smfmac_f32_16x16x64_bf16 v[40:43], v[28:31], a[192:199], v0
 v_smfmac_f32_16x16x64_bf16 v[44:47], v[28:31], a[200:207], v0
 ds_read_b128 v[28:31], v1 offset:5120
 s_waitcnt lgkmcnt(2)
 v_smfmac_f32_16x16x64_bf16 v[40:43], v[52:55], a[208:215], v0
 v_smfmac_f32_16x16x64_bf16 v[44:47], v[52:55], a[216:223], v0
 ds_read_b128 v[52:55], v1 offset:6144
 s_barrier
 ds_read_b128 v[56:59], v1 offset:10240
 ds_read_b128 v[60:63], v1 offset:12288
 ds_read_b128 v[16:19], v1 offset:13312
 ds_read_b128 v[12:15], v1 offset:14336
 ds_read_b128 v[48:51], v1 offset:15360
 s_waitcnt lgkmcnt(7)
 v_smfmac_f32_16x16x64_bf16 v[40:43], v[24:27], a[224:231], v0
 s_mov_b64 exec, s[68:69]
 buffer_store_dwordx4 v[20:23], v6, s[4:7], s62 offen offset:512 sc1
 s_mov_b64 exec, -1
 v_smfmac_f32_16x16x64_bf16 v[44:47], v[24:27], a[232:239], v0
 ds_read_b128 v[24:27], v1 offset:7168
 s_waitcnt lgkmcnt(7)
 v_smfmac_f32_16x16x64_bf16 v[40:43], v[28:31], a[240:247], v0
 v_smfmac_f32_16x16x64_bf16 v[44:47], v[28:31], a[248:255], v0
 s_waitcnt lgkmcnt(6)
 v_smfmac_f32_16x16x64_bf16 v[40:43], v[52:55], v[64:71], v0
 v_smfmac_f32_16x16x64_bf16 v[44:47], v[52:55], v[72:79], v0
 s_waitcnt lgkmcnt(0)
 v_smfmac_f32_16x16x64_bf16 v[40:43], v[24:27], v[80:87], v0
 v_smfmac_f32_16x16x64_bf16 v[44:47], v[24:27], v[88:95], v0
 v_pk_add_f32 v[8:9], v[8:9], v[56:57]
 v_pk_add_f32 v[10:11], v[10:11], v[58:59]
 v_pk_add_f32 v[60:61], v[60:61], v[16:17]
 v_pk_add_f32 v[62:63], v[62:63], v[18:19]
 v_pk_add_f32 v[12:13], v[12:13], v[14:15]
 v_pk_add_f32 v[48:49], v[48:49], v[50:51]
 v_pk_add_f32 v[8:9], v[8:9], v[60:61]
 v_pk_add_f32 v[10:11], v[10:11], v[62:63]
 v_pk_add_f32 v[48:49], v[12:13], v[48:49]
 v_max3_f32 v50, v8, v9, v10
 v_max3_f32 v50, v50, v11, v48
 v_max_f32 v50, v50, v49
 v_add_f32 v40, v40, v42
 v_add_f32 v41, v41, v43
 v_max_f32_dpp v50, v50, v50 quad_perm:[2,3,0,1] row_mask:0xf bank_mask:0xf
 v_mov_b32 v51, v50
 v_add_f32 v44, v44, v46
 v_add_f32 v45, v45, v47
 v_permlane16_swap_b32 v50, v51
 v_max_f32 v50, v50, v51
 v_mov_b32 v51, v50
 v_cvt_pk_bf16_f32 v40, v40, v41
 v_cvt_pk_bf16_f32 v41, v44, v45
 v_permlane32_swap_b32 v50, v51
 v_max_f32 v50, v50, v51
 v_mul_f32 v50, s56, v50
 v_fma_f32 v48, v48, s56, -v50
 v_fma_f32 v49, v49, s56, -v50
 v_fma_f32 v8, v8, s56, -v50
 v_fma_f32 v9, v9, s56, -v50
 v_fma_f32 v10, v10, s56, -v50
 v_fma_f32 v11, v11, s56, -v50
 v_exp_f32 v48, v48
 v_lshrrev_b32 v51, 1, v1
 v_exp_f32 v49, v49
 ds_read_b128 v[56:59], v3 offset:26624
 ds_read_b128 v[60:63], v3 offset:27648
 v_exp_f32 v8, v8
 v_exp_f32 v9, v9
 ds_read_b128 v[24:27], v2 offset:45056
 ds_read_b128 v[28:31], v2 offset:46080
 v_exp_f32 v10, v10
 buffer_store_dwordx2 v[40:41], v51, s[4:7], s62 offen offset:2560 sc1
 v_exp_f32 v11, v11
 v_cvt_pk_bf16_f32 v14, v48, v49
 v_cvt_pk_bf16_f32 v12, v8, v9
 v_cvt_pk_bf16_f32 v13, v10, v11
 v_cndmask_b32 v52, 0, v14, s[68:69]
 v_cndmask_b32 v53, 0, v14, s[70:71]
 v_cndmask_b32 v22, 0, v12, s[70:71]
 v_cndmask_b32 v23, 0, v13, s[70:71]
 v_mfma_f32_16x16x16_bf16 v[44:47], v[40:41], v[52:53], 0
 v_cndmask_b32 v16, 0, v12, s[68:69]
 v_cndmask_b32 v17, 0, v13, s[68:69]
 v_mov_b32_dpp v18, v22 quad_perm:[2,3,0,1] row_mask:0xf bank_mask:0xf
 v_mov_b32_dpp v19, v23 quad_perm:[2,3,0,1] row_mask:0xf bank_mask:0xf
 v_mov_b32_dpp v20, v16 quad_perm:[2,3,0,1] row_mask:0xf bank_mask:0xf
 v_mov_b32_dpp v21, v17 quad_perm:[2,3,0,1] row_mask:0xf bank_mask:0xf
 s_waitcnt vmcnt(4)
 v_mfma_f32_16x16x32_bf16 v[44:47], v[32:35], v[16:19], v[44:47]
 v_add_f32 v54, v8, v9
 v_add_f32 v55, v48, v49
 s_waitcnt vmcnt(3)
 v_mfma_f32_16x16x32_bf16 v[44:47], v[36:39], v[20:23], v[44:47]
 v_add_f32 v54, v54, v10
 v_fma_f32 v55, v55, 0.5, v11
 v_add_f32 v54, v54, v55
 ds_read_b128 v[16:19], v3 offset:49152
 ds_read_b128 v[20:23], v3 offset:49152
 v_add_f32_dpp v54, v54, v54 quad_perm:[2,3,0,1] row_mask:0xf bank_mask:0xf
 v_mov_b32 v55, v54
 ds_read_b128 v[32:35], v3 offset:49152
 ds_read_b128 v[36:39], v3 offset:49152
 v_permlane16_swap_b32 v54, v55
 v_add_f32 v54, v54, v55
 v_mov_b32 v55, v54
 ds_read_b128 v[8:11], v3 offset:49152
 s_cmp_eq_u32 s54, 63
 v_permlane32_swap_b32 v54, v55
 v_add_f32 v54, v54, v55
 v_rcp_f32 v54, v54
 s_cbranch_scc1 L_ch1_end
 v_mul_f32 v44, v44, v54
 v_mul_f32 v45, v45, v54
 v_cvt_pk_bf16_f32 v42, v44, v45
 v_mul_f32 v46, v46, v54
 v_mul_f32 v47, v47, v54
 v_cvt_pk_bf16_f32 v43, v46, v47
 ds_write_b64 v6, v[42:43] offset:512
 v_and_b32 v40, -9, v6
 v_mov_b32_dpp v12, v42 quad_perm:[0,1,0,1] row_mask:0xf bank_mask:0xf
 v_mov_b32_dpp v14, v42 quad_perm:[2,3,2,3] row_mask:0xf bank_mask:0xf
 v_mov_b32_dpp v13, v43 quad_perm:[0,1,0,1] row_mask:0xf bank_mask:0xf
 v_mov_b32_dpp v15, v43 quad_perm:[2,3,2,3] row_mask:0xf bank_mask:0xf
 s_waitcnt lgkmcnt(5)
 s_nop 0
 v_smfmac_f32_16x16x64_bf16 v[16:19], v[12:15], a[8:15], v0
 s_waitcnt lgkmcnt(4)
 v_smfmac_f32_16x16x64_bf16 v[20:23], v[12:15], a[40:47], v0
 s_waitcnt lgkmcnt(0)
 s_barrier
 ds_read_b128 v[48:51], v40 offset:0
 ds_read_b128 v[52:55], v40 offset:1024
 ds_read_b128 v[44:47], v40 offset:1536
 v_smfmac_f32_16x16x64_bf16 v[32:35], v[12:15], v[56:63], v0
 ds_read_b128 v[56:59], v3 offset:30720
 ds_read_b128 v[60:63], v3 offset:31744
 s_mov_b32 m0, 10240
 v_smfmac_f32_16x16x64_bf16 v[36:39], v[12:15], v[24:31], v0
 ds_read_b128 v[24:27], v3 offset:28672
 ds_read_b128 v[28:31], v3 offset:29696
 buffer_load_dwordx4 v1, s[4:7], s63 offen offset:2048 lds
 v_smfmac_f32_16x16x64_bf16 v[8:11], v[12:15], a[136:143], v0
 s_mov_b32 m0, 10240
 s_waitcnt lgkmcnt(6)
 v_smfmac_f32_16x16x64_bf16 v[16:19], v[48:51], a[0:7], v0
 buffer_load_dwordx4 v1, s[4:7], s63 offen offset:3072 lds
 s_waitcnt lgkmcnt(5)
 v_smfmac_f32_16x16x64_bf16 v[16:19], v[52:55], a[16:23], v0
 s_mov_b32 m0, 2048
 s_waitcnt lgkmcnt(2)
 v_smfmac_f32_16x16x64_bf16 v[16:19], v[44:47], v[56:63], v0
 ds_read_b128 v[56:59], v3 offset:24576
 ds_read_b128 v[60:63], v3 offset:25600
 buffer_load_dwordx4 v1, s[4:7], s81 offen offset:0 lds
 s_waitcnt lgkmcnt(2)
 v_smfmac_f32_16x16x64_bf16 v[20:23], v[48:51], v[24:31], v0
 ds_read_b128 v[24:27], v2 offset:47104
 ds_read_b128 v[28:31], v2 offset:48128
 s_mov_b32 m0, 2048
 v_smfmac_f32_16x16x64_bf16 v[20:23], v[52:55], a[48:55], v0
 buffer_load_dwordx4 v1, s[4:7], s81 offen offset:1024 lds
 v_smfmac_f32_16x16x64_bf16 v[20:23], v[44:47], a[56:63], v0
 v_cvt_pk_bf16_f32 v16, v16, v17
 v_smfmac_f32_16x16x64_bf16 v[32:35], v[48:51], a[64:71], v0
 v_cvt_pk_bf16_f32 v17, v18, v19
 s_waitcnt lgkmcnt(2)
 v_smfmac_f32_16x16x64_bf16 v[32:35], v[52:55], v[56:63], v0
 ds_read_b128 v[56:59], v2 offset:43008
 ds_read_b128 v[60:63], v2 offset:44032
 v_and_or_b32 v16, v16, -2, s55
 s_waitcnt lgkmcnt(2)
 v_smfmac_f32_16x16x64_bf16 v[32:35], v[44:47], v[24:31], v0
 ds_read_b128 v[24:27], v2 offset:40960
 ds_read_b128 v[28:31], v2 offset:41984
 v_cvt_pk_bf16_f32 v18, v20, v21
 v_smfmac_f32_16x16x64_bf16 v[36:39], v[48:51], a[96:103], v0
 v_cvt_pk_bf16_f32 v19, v22, v23
 v_smfmac_f32_16x16x64_bf16 v[36:39], v[52:55], a[112:119], v0
 v_and_or_b32 v18, v18, -2, s55
 buffer_store_dwordx4 v[16:19], v1, s[4:7], s60 offen offset:0
 v_smfmac_f32_16x16x64_bf16 v[36:39], v[44:47], a[120:127], v0
 v_cvt_pk_bf16_f32 v32, v32, v33
 s_waitcnt lgkmcnt(2)
 v_smfmac_f32_16x16x64_bf16 v[8:11], v[48:51], v[56:63], v0
 v_cvt_pk_bf16_f32 v33, v34, v35
 s_waitcnt lgkmcnt(0)
 v_smfmac_f32_16x16x64_bf16 v[8:11], v[52:55], v[24:31], v0
 v_and_or_b32 v32, v32, -2, s55
 v_smfmac_f32_16x16x64_bf16 v[8:11], v[44:47], a[152:159], v0
 v_cvt_pk_bf16_f32 v34, v36, v37
 v_cvt_pk_bf16_f32 v35, v38, v39
 v_and_or_b32 v34, v34, -2, s55
 buffer_store_dwordx4 v[32:35], v1, s[4:7], s60 offen offset:1024
 s_nop 3
 v_cvt_pk_bf16_f32 v8, v8, v9
 v_cvt_pk_bf16_f32 v9, v10, v11
 v_and_or_b32 v8, v8, -2, s55
 buffer_store_dwordx2 v[8:9], v1, s[4:7], s16 offen offset:8
 buffer_load_dwordx4 v[32:35], v1, s[4:7], s63 offen offset:0
 buffer_load_dwordx4 v[36:39], v1, s[4:7], s63 offen offset:1024
 s_add_u32 s54, s54, 1
 s_add_u32 s61, s61, 524288
 s_and_b32 s3, s54, 3
 s_cselect_b32 s3, 1, -3
 s_lshl_b32 s3, s3, 17
 s_add_u32 s62, s62, s3
 s_and_b32 s3, s54, 3
 s_cselect_b32 s3, 1, -3
 s_lshl_b32 s3, s3, 14
 s_add_u32 s57, s57, s3
 s_add_u32 s59, s59, s3
 s_xor_b32 s58, s57, 32768
 v_lshrrev_b32 v56, 7, v1
 v_mul_u32_u24 v56, 10240, v56
 v_and_b32 v60, 112, v1
 v_add_u32 v56, v56, v60
 v_and_b32 v57, 32, v1
 v_and_b32 v60, 64, v1
 v_lshl_add_u32 v57, v60, 2, v57
 v_bfe_u32 v60, v1, 8, 1
 v_lshl_add_u32 v57, v60, 4, v57
 v_bfe_u32 v60, v1, 4, 1
 v_lshl_add_u32 v57, v60, 3, v57
 v_mov_b32 v60, 0x3f80
 v_mov_b32 v28, 0x3f800000
 v_cndmask_b32 v60, v60, v28, s[82:83]
 v_cndmask_b32 v28, 0, v60, s[72:73]
 v_cndmask_b32 v29, 0, v60, s[74:75]
 v_cndmask_b32 v30, 0, v60, s[76:77]
 v_cndmask_b32 v31, 0, v60, s[78:79]
 v_mov_b64 v[58:59], -1
 s_mov_b64 exec, s[84:85]
 buffer_store_dwordx2 v[58:59], v57, s[4:7], s58 offen
 s_mov_b64 exec, -1
 s_nop 15
 s_nop 15
 s_nop 15
 s_nop 15
 s_nop 15
 s_mov_b32 s51, 0
 buffer_load_dwordx4 v[8:11], v56, s[4:7], s64 offen sc1
 buffer_load_dwordx4 v[12:15], v56, s[4:7], s65 offen sc1
 buffer_load_dwordx4 v[16:19], v56, s[4:7], s66 offen sc1
 buffer_load_dwordx4 v[20:23], v56, s[4:7], s67 offen sc1
L_pp_182:
 s_waitcnt vmcnt(3)
 v_mfma_f32_16x16x32_bf16 v[24:27], v[28:31], v[8:11], 0
 v_bitop3_b32 v60, v8, v10, s55 bitop3:0x7e
 s_waitcnt vmcnt(2)
 v_mfma_f32_16x16x32_bf16 v[24:27], v[28:31], v[12:15], v[24:27]
 v_bitop3_b32 v61, v12, v14, s55 bitop3:0x7e
 s_waitcnt vmcnt(1)
 v_mfma_f32_16x16x32_bf16 v[24:27], v[28:31], v[16:19], v[24:27]
 v_bitop3_b32 v62, v16, v18, s55 bitop3:0x7e
 s_waitcnt vmcnt(0)
 v_mfma_f32_16x16x32_bf16 v[24:27], v[28:31], v[20:23], v[24:27]
 v_bitop3_b32 v63, v20, v22, s55 bitop3:0x7e
 v_or3_b32 v7, v60, v61, v62
 v_bitop3_b32 v7, v7, v63, 1 bitop3:0xa8
 v_cmp_ne_u32 vcc, 0, v7
 s_cbranch_vccnz L_rt_183
 s_nop 2
 v_add_f32_dpp v24, v24, v24 row_ror:8 row_mask:0xf bank_mask:0xf
 v_add_f32_dpp v25, v25, v25 row_ror:8 row_mask:0xf bank_mask:0xf
 v_add_f32_dpp v26, v26, v26 row_ror:8 row_mask:0xf bank_mask:0xf
 v_add_f32_dpp v27, v27, v27 row_ror:8 row_mask:0xf bank_mask:0xf
 s_mov_b64 exec, s[84:85]
 v_cvt_pk_bf16_f32 v24, v24, v25
 v_cvt_pk_bf16_f32 v25, v26, v27
 buffer_store_dwordx2 v[24:25], v57, s[4:7], s57 offen
 s_mov_b64 exec, -1
 s_xor_b32 s55, s55, 1
 ds_read_b128 v[40:43], v1 offset:12288
 ds_read_b128 v[44:47], v1 offset:13312
 ds_read_b128 v[48:51], v1 offset:2048
 ds_read_b128 v[52:55], v1 offset:3072
 buffer_load_dwordx4 v[56:59], v1, s[4:7], s81 offen offset:2048
 buffer_load_dwordx4 v[60:63], v1, s[4:7], s81 offen offset:3072
 ds_read_b128 v[8:11], v3 offset:49152
 ds_read_b128 v[12:15], v3 offset:49152
 ds_read_b128 v[16:19], v3 offset:49152
 ds_read_b128 v[20:23], v3 offset:49152
 s_waitcnt lgkmcnt(0)
 s_nop 15
 s_nop 15
 s_nop 7
 s_branch L_ch1_f
L_rt_181:
 s_add_u32 s51, s51, 1
 s_cmp_lt_u32 s51, 131072
 s_cbranch_scc1 L_pm_180
 s_branch L_bail
L_rt_183:
 buffer_load_dwordx4 v[8:11], v56, s[4:7], s64 offen sc1
 buffer_load_dwordx4 v[12:15], v56, s[4:7], s65 offen sc1
 buffer_load_dwordx4 v[16:19], v56, s[4:7], s66 offen sc1
 buffer_load_dwordx4 v[20:23], v56, s[4:7], s67 offen sc1
 s_add_u32 s51, s51, 1
 s_cmp_lt_u32 s51, 131072
 s_cbranch_scc1 L_pp_182
 s_branch L_bail
.p2align 6
L_ch1_s:
 s_mov_b32 s51, 0
L_pm_184:
 buffer_load_dwordx4 v[24:27], v1, s[4:7], s59 offen offset:0 sc1
 buffer_load_dwordx4 v[28:31], v1, s[4:7], s59 offen offset:1024 sc1
 s_waitcnt vmcnt(1)
 ds_write_b128 v1, v[24:27] offset:2048
 v_max_u32 v7, v24, v26
 s_waitcnt vmcnt(0)
 ds_write_b128 v1, v[28:31] offset:3072
 v_max3_u32 v7, v7, v28, v30
 v_cmp_eq_u32 vcc, -1, v7
 s_cbranch_vccnz L_rt_185
 v_smfmac_f32_16x16x64_bf16 v[16:19], v[24:27], v[32:39], v0
 ds_read_b128 v[32:35], v2 offset:14336
 ds_read_b128 v[36:39], v2 offset:15360
 v_smfmac_f32_16x16x64_bf16 v[20:23], v[24:27], v[40:47], v0
 ds_read_b128 v[40:43], v2 offset:12288
 ds_read_b128 v[44:47], v2 offset:13312
 v_smfmac_f32_16x16x64_bf16 v[16:19], v[28:31], v[48:55], v0
 v_smfmac_f32_16x16x64_bf16 v[20:23], v[28:31], v[56:63], v0
 s_waitcnt lgkmcnt(4)
 s_barrier
 buffer_load_dwordx4 v[56:59], v1, s[4:7], s101 offen offset:0
 v_smfmac_f32_16x16x64_bf16 v[8:11], v[24:27], v[200:207], v0
 v_smfmac_f32_16x16x64_bf16 v[12:15], v[24:27], v[192:199], v0
 ds_read_b128 v[24:27], v1 offset:0
 buffer_load_dwordx4 v[60:63], v1, s[4:7], s101 offen offset:1024
 v_smfmac_f32_16x16x64_bf16 v[8:11], v[28:31], v[184:191], v0
 v_smfmac_f32_16x16x64_bf16 v[12:15], v[28:31], v[176:183], v0
 ds_read_b128 v[28:31], v1 offset:1024
 buffer_load_dwordx4 v[48:51], v1, s[4:7], s101 offen offset:2048
 s_waitcnt lgkmcnt(1)
 v_smfmac_f32_16x16x64_bf16 v[16:19], v[24:27], v[32:39], v0
 ds_read_b128 v[32:35], v2 offset:10240
 ds_read_b128 v[36:39], v2 offset:11264
 v_smfmac_f32_16x16x64_bf16 v[8:11], v[24:27], v[240:247], v0
 buffer_load_dwordx4 v[52:55], v1, s[4:7], s101 offen offset:3072
 v_smfmac_f32_16x16x64_bf16 v[12:15], v[24:27], v[248:255], v0
 v_smfmac_f32_16x16x64_bf16 v[20:23], v[24:27], v[40:47], v0
 ds_read_b128 v[40:43], v2 offset:8192
 ds_read_b128 v[44:47], v2 offset:9216
 ds_read_b128 v[24:27], v1 offset:4096
 s_waitcnt lgkmcnt(5)
 v_smfmac_f32_16x16x64_bf16 v[8:11], v[28:31], v[224:231], v0
 v_smfmac_f32_16x16x64_bf16 v[12:15], v[28:31], v[216:223], v0
 s_waitcnt lgkmcnt(3)
 v_smfmac_f32_16x16x64_bf16 v[16:19], v[28:31], v[32:39], v0
 ds_read_b128 v[32:35], v1 offset:47104
 ds_read_b128 v[36:39], v1 offset:48128
 v_smfmac_f32_16x16x64_bf16 v[20:23], v[28:31], v[152:159], v0
 ds_read_b128 v[28:31], v1 offset:5120
 s_waitcnt lgkmcnt(3)
 v_smfmac_f32_16x16x64_bf16 v[8:11], v[24:27], v[160:167], v0
 v_smfmac_f32_16x16x64_bf16 v[16:19], v[24:27], v[40:47], v0
 ds_read_b128 v[40:43], v1 offset:45056
 ds_read_b128 v[44:47], v1 offset:46080
 v_smfmac_f32_16x16x64_bf16 v[12:15], v[24:27], v[144:151], v0
 v_smfmac_f32_16x16x64_bf16 v[20:23], v[24:27], v[168:175], v0
 ds_read_b128 v[24:27], v1 offset:6144
 s_waitcnt lgkmcnt(3)
 v_smfmac_f32_16x16x64_bf16 v[16:19], v[28:31], v[32:39], v0
 ds_read_b128 v[32:35], v1 offset:43008
 ds_read_b128 v[36:39], v1 offset:44032
 v_smfmac_f32_16x16x64_bf16 v[8:11], v[28:31], v[136:143], v0
 v_smfmac_f32_16x16x64_bf16 v[12:15], v[28:31], v[128:135], v0
 s_waitcnt lgkmcnt(3)
 v_smfmac_f32_16x16x64_bf16 v[20:23], v[28:31], v[40:47], v0
 ds_read_b128 v[40:43], v1 offset:40960
 ds_read_b128 v[44:47], v1 offset:41984
 ds_read_b128 v[28:31], v1 offset:7168
 s_waitcnt lgkmcnt(5)
 v_smfmac_f32_16x16x64_bf16 v[8:11], v[24:27], a[144:151], v0
 v_smfmac_f32_16x16x64_bf16 v[12:15], v[24:27], a[128:135], v0
 s_waitcnt lgkmcnt(3)
 v_smfmac_f32_16x16x64_bf16 v[16:19], v[24:27], v[32:39], v0
 ds_read_b128 v[32:35], v1 offset:22528
 ds_read_b128 v[36:39], v1 offset:23552
 s_waitcnt vmcnt(2)
 v_smfmac_f32_16x16x64_bf16 v[20:23], v[24:27], v[56:63], v0
 ds_read_b128 v[24:27], v1 offset:8192
 buffer_load_dwordx4 v[56:59], v1, s[4:7], s61 offen offset:1024 sc1 nt
 s_waitcnt lgkmcnt(3)
 v_smfmac_f32_16x16x64_bf16 v[8:11], v[28:31], a[104:111], v0
 v_smfmac_f32_16x16x64_bf16 v[16:19], v[28:31], v[40:47], v0
 ds_read_b128 v[40:43], v1 offset:20480
 ds_read_b128 v[44:47], v1 offset:21504
 s_add_u32 s3, s61, 4096
 buffer_load_dwordx4 v[60:63], v1, s[4:7], s3 offen offset:1024 sc1 nt
 v_smfmac_f32_16x16x64_bf16 v[12:15], v[28:31], a[88:95], v0
 v_smfmac_f32_16x16x64_bf16 v[20:23], v[28:31], v[208:215], v0
 ds_read_b128 v[28:31], v1 offset:9216
 s_waitcnt lgkmcnt(3)
 v_smfmac_f32_16x16x64_bf16 v[16:19], v[24:27], v[32:39], v0
 v_smfmac_f32_16x16x64_bf16 v[8:11], v[24:27], a[80:87], v0
 s_add_u32 s3, s61, 67110912
 buffer_load_dwordx4 v[32:35], v1, s[4:7], s3 offen offset:0 sc1 nt
 v_smfmac_f32_16x16x64_bf16 v[12:15], v[24:27], a[72:79], v0
 s_waitcnt lgkmcnt(1)
 v_smfmac_f32_16x16x64_bf16 v[20:23], v[24:27], v[40:47], v0
 ds_read_b128 v[40:43], v3 offset:49152
 ds_read_b128 v[44:47], v3 offset:49152
 buffer_load_dwordx4 v[36:39], v1, s[4:7], s3 offen offset:1024 sc1 nt
 s_waitcnt lgkmcnt(2)
 v_smfmac_f32_16x16x64_bf16 v[8:11], v[28:31], a[32:39], v0
 v_smfmac_f32_16x16x64_bf16 v[12:15], v[28:31], a[24:31], v0
 v_lshlrev_b32 v7, 3, v1
 v_smfmac_f32_16x16x64_bf16 v[16:19], v[28:31], v[232:239], v0
 s_waitcnt vmcnt(4)
 v_smfmac_f32_16x16x64_bf16 v[20:23], v[28:31], v[48:55], v0
 s_add_u32 s3, s61, 524288
 buffer_load_dword v7, v7, s[4:7], s3 offen sc1
 ds_read_b128 v[52:55], v1 offset:0
 v_add_f32 v8, v8, v10
 v_add_f32 v11, v9, v11
 v_cvt_pk_bf16_f32 v9, v8, v11
 v_cvt_pk_bf16_f32 v8, v8, v11
 v_add_f32 v12, v12, v14
 v_add_f32 v15, v13, v15
 v_cvt_pk_bf16_f32 v13, v12, v15
 v_cvt_pk_bf16_f32 v12, v12, v15
 v_mfma_f32_16x16x16_bf16 v[8:11], v[8:9], v[4:5], 0
 v_mfma_f32_16x16x16_bf16 v[12:15], v[12:13], v[4:5], 0
 v_add_f32 v16, v16, v18
 v_add_f32 v19, v17, v19
 v_cvt_pk_bf16_f32 v17, v16, v19
 v_cvt_pk_bf16_f32 v16, v16, v19
 v_add_f32 v20, v20, v22
 v_add_f32 v23, v21, v23
 v_cvt_pk_bf16_f32 v21, v20, v23
 v_cvt_pk_bf16_f32 v20, v20, v23
 v_mfma_f32_16x16x16_bf16 v[16:19], v[16:17], v[4:5], 0
 v_mfma_f32_16x16x16_bf16 v[20:23], v[20:21], v[4:5], 0
 s_waitcnt lgkmcnt(2)
 v_smfmac_f32_16x16x64_bf16 v[40:43], v[24:27], v[96:103], v0
 s_waitcnt lgkmcnt(1)
 v_smfmac_f32_16x16x64_bf16 v[44:47], v[24:27], v[104:111], v0
 ds_read_b128 v[24:27], v1 offset:1024
 v_cvt_pk_bf16_f32 v15, v14, v15
 v_cvt_pk_bf16_f32 v14, v12, v13
 v_cvt_pk_bf16_f32 v13, v10, v11
 v_cvt_pk_bf16_f32 v12, v8, v9
 s_waitcnt vmcnt(4)
 s_nop 0
 v_mfma_f32_16x16x32_bf16 v[8:11], v[56:59], v[12:15], 0
 v_cvt_pk_bf16_f32 v23, v22, v23
 v_cvt_pk_bf16_f32 v22, v20, v21
 v_cvt_pk_bf16_f32 v21, v18, v19
 v_cvt_pk_bf16_f32 v20, v16, v17
 s_waitcnt vmcnt(3)
 v_mfma_f32_16x16x32_bf16 v[16:19], v[60:63], v[12:15], 0
 v_mfma_f32_16x16x32_bf16 v[48:51], v[20:23], v[12:15], 0
 v_smfmac_f32_16x16x64_bf16 v[40:43], v[28:31], v[112:119], v0
 v_smfmac_f32_16x16x64_bf16 v[44:47], v[28:31], v[120:127], v0
 ds_read_b128 v[28:31], v1 offset:2048
 s_waitcnt lgkmcnt(2)
 v_smfmac_f32_16x16x64_bf16 v[40:43], v[52:55], a[160:167], v0
 v_cndmask_b32 v8, v8, v16, s[70:71]
 v_cndmask_b32 v9, v9, v17, s[70:71]
 v_cndmask_b32 v10, v10, v18, s[70:71]
 v_cndmask_b32 v11, v11, v19, s[70:71]
 ds_write_b128 v1, v[8:11] offset:11264
 ds_write_b64 v1, v[48:49] offset:14344
 v_smfmac_f32_16x16x64_bf16 v[44:47], v[52:55], a[168:175], v0
 ds_read_b128 v[52:55], v1 offset:3072
 s_waitcnt lgkmcnt(4)
 v_smfmac_f32_16x16x64_bf16 v[40:43], v[24:27], a[176:183], v0
 v_smfmac_f32_16x16x64_bf16 v[44:47], v[24:27], a[184:191], v0
 ds_read_b128 v[24:27], v1 offset:4096
 s_waitcnt lgkmcnt(4)
 v_smfmac_f32_16x16x64_bf16 v[40:43], v[28:31], a[192:199], v0
 v_smfmac_f32_16x16x64_bf16 v[44:47], v[28:31], a[200:207], v0
 ds_read_b128 v[28:31], v1 offset:5120
 s_waitcnt lgkmcnt(2)
 v_smfmac_f32_16x16x64_bf16 v[40:43], v[52:55], a[208:215], v0
 v_smfmac_f32_16x16x64_bf16 v[44:47], v[52:55], a[216:223], v0
 ds_read_b128 v[52:55], v1 offset:6144
 s_barrier
 ds_read_b128 v[56:59], v1 offset:10240
 ds_read_b128 v[60:63], v1 offset:12288
 ds_read_b128 v[16:19], v1 offset:13312
 ds_read_b128 v[12:15], v1 offset:14336
 ds_read_b128 v[48:51], v1 offset:15360
 s_waitcnt lgkmcnt(7)
 v_smfmac_f32_16x16x64_bf16 v[40:43], v[24:27], a[224:231], v0
 s_mov_b64 exec, s[68:69]
 buffer_store_dwordx4 v[20:23], v6, s[4:7], s62 offen offset:512 sc1
 s_mov_b64 exec, -1
 v_smfmac_f32_16x16x64_bf16 v[44:47], v[24:27], a[232:239], v0
 ds_read_b128 v[24:27], v1 offset:7168
 s_waitcnt lgkmcnt(7)
 v_smfmac_f32_16x16x64_bf16 v[40:43], v[28:31], a[240:247], v0
 v_smfmac_f32_16x16x64_bf16 v[44:47], v[28:31], a[248:255], v0
 s_waitcnt lgkmcnt(6)
 v_smfmac_f32_16x16x64_bf16 v[40:43], v[52:55], v[64:71], v0
 v_smfmac_f32_16x16x64_bf16 v[44:47], v[52:55], v[72:79], v0
 s_waitcnt lgkmcnt(0)
 v_smfmac_f32_16x16x64_bf16 v[40:43], v[24:27], v[80:87], v0
 v_smfmac_f32_16x16x64_bf16 v[44:47], v[24:27], v[88:95], v0
 v_pk_add_f32 v[8:9], v[8:9], v[56:57]
 v_pk_add_f32 v[10:11], v[10:11], v[58:59]
 v_pk_add_f32 v[60:61], v[60:61], v[16:17]
 v_pk_add_f32 v[62:63], v[62:63], v[18:19]
 v_pk_add_f32 v[12:13], v[12:13], v[14:15]
 v_pk_add_f32 v[48:49], v[48:49], v[50:51]
 v_pk_add_f32 v[8:9], v[8:9], v[60:61]
 v_pk_add_f32 v[10:11], v[10:11], v[62:63]
 v_pk_add_f32 v[48:49], v[12:13], v[48:49]
 v_max3_f32 v50, v8, v9, v10
 v_max3_f32 v50, v50, v11, v48
 v_max_f32 v50, v50, v49
 v_add_f32 v40, v40, v42
 v_add_f32 v41, v41, v43
 v_max_f32_dpp v50, v50, v50 quad_perm:[2,3,0,1] row_mask:0xf bank_mask:0xf
 v_mov_b32 v51, v50
 v_add_f32 v44, v44, v46
 v_add_f32 v45, v45, v47
 v_permlane16_swap_b32 v50, v51
 v_max_f32 v50, v50, v51
 v_mov_b32 v51, v50
 v_cvt_pk_bf16_f32 v40, v40, v41
 v_cvt_pk_bf16_f32 v41, v44, v45
 v_permlane32_swap_b32 v50, v51
 v_max_f32 v50, v50, v51
 v_mul_f32 v50, s56, v50
 v_fma_f32 v48, v48, s56, -v50
 v_fma_f32 v49, v49, s56, -v50
 v_fma_f32 v8, v8, s56, -v50
 v_fma_f32 v9, v9, s56, -v50
 v_fma_f32 v10, v10, s56, -v50
 v_fma_f32 v11, v11, s56, -v50
 v_exp_f32 v48, v48
 v_lshrrev_b32 v51, 1, v1
 v_exp_f32 v49, v49
 ds_read_b128 v[56:59], v3 offset:26624
 ds_read_b128 v[60:63], v3 offset:27648
 v_exp_f32 v8, v8
 v_exp_f32 v9, v9
 ds_read_b128 v[24:27], v2 offset:45056
 ds_read_b128 v[28:31], v2 offset:46080
 v_exp_f32 v10, v10
 buffer_store_dwordx2 v[40:41], v51, s[4:7], s62 offen offset:2560 sc1
 v_exp_f32 v11, v11
 v_cvt_pk_bf16_f32 v14, v48, v49
 v_cvt_pk_bf16_f32 v12, v8, v9
 v_cvt_pk_bf16_f32 v13, v10, v11
 v_cndmask_b32 v52, 0, v14, s[68:69]
 v_cndmask_b32 v53, 0, v14, s[70:71]
 v_cndmask_b32 v22, 0, v12, s[70:71]
 v_cndmask_b32 v23, 0, v13, s[70:71]
 v_mfma_f32_16x16x16_bf16 v[44:47], v[40:41], v[52:53], 0
 v_cndmask_b32 v16, 0, v12, s[68:69]
 v_cndmask_b32 v17, 0, v13, s[68:69]
 v_mov_b32_dpp v18, v22 quad_perm:[2,3,0,1] row_mask:0xf bank_mask:0xf
 v_mov_b32_dpp v19, v23 quad_perm:[2,3,0,1] row_mask:0xf bank_mask:0xf
 v_mov_b32_dpp v20, v16 quad_perm:[2,3,0,1] row_mask:0xf bank_mask:0xf
 v_mov_b32_dpp v21, v17 quad_perm:[2,3,0,1] row_mask:0xf bank_mask:0xf
 s_waitcnt vmcnt(4)
 v_mfma_f32_16x16x32_bf16 v[44:47], v[32:35], v[16:19], v[44:47]
 v_add_f32 v54, v8, v9
 v_add_f32 v55, v48, v49
 s_waitcnt vmcnt(3)
 v_mfma_f32_16x16x32_bf16 v[44:47], v[36:39], v[20:23], v[44:47]
 v_add_f32 v54, v54, v10
 v_fma_f32 v55, v55, 0.5, v11
 v_add_f32 v54, v54, v55
 ds_read_b128 v[16:19], v3 offset:49152
 ds_read_b128 v[20:23], v3 offset:49152
 v_add_f32_dpp v54, v54, v54 quad_perm:[2,3,0,1] row_mask:0xf bank_mask:0xf
 v_mov_b32 v55, v54
 ds_read_b128 v[32:35], v3 offset:49152
 ds_read_b128 v[36:39], v3 offset:49152
 v_permlane16_swap_b32 v54, v55
 v_add_f32 v54, v54, v55
 v_mov_b32 v55, v54
 ds_read_b128 v[8:11], v3 offset:49152
 s_cmp_eq_u32 s54, 63
 v_permlane32_swap_b32 v54, v55
 v_add_f32 v54, v54, v55
 v_rcp_f32 v54, v54
 s_cbranch_scc1 L_ch1_end
 v_mul_f32 v44, v44, v54
 v_mul_f32 v45, v45, v54
 v_cvt_pk_bf16_f32 v42, v44, v45
 v_mul_f32 v46, v46, v54
 v_mul_f32 v47, v47, v54
 v_cvt_pk_bf16_f32 v43, v46, v47
 ds_write_b64 v6, v[42:43] offset:512
 v_and_b32 v40, -9, v6
 v_mov_b32_dpp v12, v42 quad_perm:[0,1,0,1] row_mask:0xf bank_mask:0xf
 v_mov_b32_dpp v14, v42 quad_perm:[2,3,2,3] row_mask:0xf bank_mask:0xf
 v_mov_b32_dpp v13, v43 quad_perm:[0,1,0,1] row_mask:0xf bank_mask:0xf
 v_mov_b32_dpp v15, v43 quad_perm:[2,3,2,3] row_mask:0xf bank_mask:0xf
 s_waitcnt lgkmcnt(5)
 s_nop 0
 v_smfmac_f32_16x16x64_bf16 v[16:19], v[12:15], a[8:15], v0
 s_waitcnt lgkmcnt(4)
 v_smfmac_f32_16x16x64_bf16 v[20:23], v[12:15], a[40:47], v0
 s_waitcnt lgkmcnt(0)
 s_barrier
 ds_read_b128 v[48:51], v40 offset:0
 ds_read_b128 v[52:55], v40 offset:1024
 ds_read_b128 v[44:47], v40 offset:1536
 v_smfmac_f32_16x16x64_bf16 v[32:35], v[12:15], v[56:63], v0
 ds_read_b128 v[56:59], v3 offset:30720
 ds_read_b128 v[60:63], v3 offset:31744
 s_mov_b32 m0, 10240
 v_smfmac_f32_16x16x64_bf16 v[36:39], v[12:15], v[24:31], v0
 ds_read_b128 v[24:27], v3 offset:28672
 ds_read_b128 v[28:31], v3 offset:29696
 buffer_load_dwordx4 v1, s[4:7], s63 offen offset:2048 lds
 v_smfmac_f32_16x16x64_bf16 v[8:11], v[12:15], a[136:143], v0
 s_mov_b32 m0, 10240
 s_waitcnt lgkmcnt(6)
 v_smfmac_f32_16x16x64_bf16 v[16:19], v[48:51], a[0:7], v0
 buffer_load_dwordx4 v1, s[4:7], s63 offen offset:3072 lds
 s_waitcnt lgkmcnt(5)
 v_smfmac_f32_16x16x64_bf16 v[16:19], v[52:55], a[16:23], v0
 s_mov_b32 m0, 2048
 s_waitcnt lgkmcnt(2)
 v_smfmac_f32_16x16x64_bf16 v[16:19], v[44:47], v[56:63], v0
 ds_read_b128 v[56:59], v3 offset:24576
 ds_read_b128 v[60:63], v3 offset:25600
 buffer_load_dwordx4 v1, s[4:7], s81 offen offset:0 lds
 s_waitcnt lgkmcnt(2)
 v_smfmac_f32_16x16x64_bf16 v[20:23], v[48:51], v[24:31], v0
 ds_read_b128 v[24:27], v2 offset:47104
 ds_read_b128 v[28:31], v2 offset:48128
 s_mov_b32 m0, 2048
 v_smfmac_f32_16x16x64_bf16 v[20:23], v[52:55], a[48:55], v0
 buffer_load_dwordx4 v1, s[4:7], s81 offen offset:1024 lds
 v_smfmac_f32_16x16x64_bf16 v[20:23], v[44:47], a[56:63], v0
 v_cvt_pk_bf16_f32 v16, v16, v17
 v_smfmac_f32_16x16x64_bf16 v[32:35], v[48:51], a[64:71], v0
 v_cvt_pk_bf16_f32 v17, v18, v19
 s_waitcnt lgkmcnt(2)
 v_smfmac_f32_16x16x64_bf16 v[32:35], v[52:55], v[56:63], v0
 ds_read_b128 v[56:59], v2 offset:43008
 ds_read_b128 v[60:63], v2 offset:44032
 v_and_or_b32 v16, v16, -2, s55
 s_waitcnt lgkmcnt(2)
 v_smfmac_f32_16x16x64_bf16 v[32:35], v[44:47], v[24:31], v0
 ds_read_b128 v[24:27], v2 offset:40960
 ds_read_b128 v[28:31], v2 offset:41984
 v_cvt_pk_bf16_f32 v18, v20, v21
 v_smfmac_f32_16x16x64_bf16 v[36:39], v[48:51], a[96:103], v0
 v_cvt_pk_bf16_f32 v19, v22, v23
 v_smfmac_f32_16x16x64_bf16 v[36:39], v[52:55], a[112:119], v0
 v_and_or_b32 v18, v18, -2, s55
 buffer_store_dwordx4 v[16:19], v1, s[4:7], s60 offen offset:0 sc1
 v_smfmac_f32_16x16x64_bf16 v[36:39], v[44:47], a[120:127], v0
 v_cvt_pk_bf16_f32 v32, v32, v33
 s_waitcnt lgkmcnt(2)
 v_smfmac_f32_16x16x64_bf16 v[8:11], v[48:51], v[56:63], v0
 v_cvt_pk_bf16_f32 v33, v34, v35
 s_waitcnt lgkmcnt(0)
 v_smfmac_f32_16x16x64_bf16 v[8:11], v[52:55], v[24:31], v0
 v_and_or_b32 v32, v32, -2, s55
 v_smfmac_f32_16x16x64_bf16 v[8:11], v[44:47], a[152:159], v0
 v_cvt_pk_bf16_f32 v34, v36, v37
 v_cvt_pk_bf16_f32 v35, v38, v39
 v_and_or_b32 v34, v34, -2, s55
 buffer_store_dwordx4 v[32:35], v1, s[4:7], s60 offen offset:1024 sc1
 s_nop 3
 v_cvt_pk_bf16_f32 v8, v8, v9
 v_cvt_pk_bf16_f32 v9, v10, v11
 v_and_or_b32 v8, v8, -2, s55
 buffer_store_dwordx2 v[8:9], v1, s[4:7], s16 offen offset:8 sc1
 buffer_load_dwordx4 v[32:35], v1, s[4:7], s63 offen offset:0
 buffer_load_dwordx4 v[36:39], v1, s[4:7], s63 offen offset:1024
 s_add_u32 s54, s54, 1
 s_add_u32 s61, s61, 524288
 s_and_b32 s3, s54, 3
 s_cselect_b32 s3, 1, -3
 s_lshl_b32 s3, s3, 17
 s_add_u32 s62, s62, s3
 s_and_b32 s3, s54, 3
 s_cselect_b32 s3, 1, -3
 s_lshl_b32 s3, s3, 14
 s_add_u32 s57, s57, s3
 s_add_u32 s59, s59, s3
 s_xor_b32 s58, s57, 32768
 v_lshrrev_b32 v56, 7, v1
 v_mul_u32_u24 v56, 10240, v56
 v_and_b32 v60, 112, v1
 v_add_u32 v56, v56, v60
 v_and_b32 v57, 32, v1
 v_and_b32 v60, 64, v1
 v_lshl_add_u32 v57, v60, 2, v57
 v_bfe_u32 v60, v1, 8, 1
 v_lshl_add_u32 v57, v60, 4, v57
 v_bfe_u32 v60, v1, 4, 1
 v_lshl_add_u32 v57, v60, 3, v57
 v_mov_b32 v60, 0x3f80
 v_mov_b32 v28, 0x3f800000
 v_cndmask_b32 v60, v60, v28, s[82:83]
 v_cndmask_b32 v28, 0, v60, s[72:73]
 v_cndmask_b32 v29, 0, v60, s[74:75]
 v_cndmask_b32 v30, 0, v60, s[76:77]
 v_cndmask_b32 v31, 0, v60, s[78:79]
 v_mov_b64 v[58:59], -1
 s_mov_b64 exec, s[84:85]
 buffer_store_dwordx2 v[58:59], v57, s[4:7], s58 offen sc1
 s_mov_b64 exec, -1
 s_nop 15
 s_nop 15
 s_nop 15
 s_nop 15
 s_nop 15
 s_mov_b32 s51, 0
 buffer_load_dwordx4 v[8:11], v56, s[4:7], s64 offen sc1
 buffer_load_dwordx4 v[12:15], v56, s[4:7], s65 offen sc1
 buffer_load_dwordx4 v[16:19], v56, s[4:7], s66 offen sc1
 buffer_load_dwordx4 v[20:23], v56, s[4:7], s67 offen sc1
L_pp_186:
 s_waitcnt vmcnt(3)
 v_mfma_f32_16x16x32_bf16 v[24:27], v[28:31], v[8:11], 0
 v_bitop3_b32 v60, v8, v10, s55 bitop3:0x7e
 s_waitcnt vmcnt(2)
 v_mfma_f32_16x16x32_bf16 v[24:27], v[28:31], v[12:15], v[24:27]
 v_bitop3_b32 v61, v12, v14, s55 bitop3:0x7e
 s_waitcnt vmcnt(1)
 v_mfma_f32_16x16x32_bf16 v[24:27], v[28:31], v[16:19], v[24:27]
 v_bitop3_b32 v62, v16, v18, s55 bitop3:0x7e
 s_waitcnt vmcnt(0)
 v_mfma_f32_16x16x32_bf16 v[24:27], v[28:31], v[20:23], v[24:27]
 v_bitop3_b32 v63, v20, v22, s55 bitop3:0x7e
 v_or3_b32 v7, v60, v61, v62
 v_bitop3_b32 v7, v7, v63, 1 bitop3:0xa8
 v_cmp_ne_u32 vcc, 0, v7
 s_cbranch_vccnz L_rt_187
 s_nop 2
 v_add_f32_dpp v24, v24, v24 row_ror:8 row_mask:0xf bank_mask:0xf
 v_add_f32_dpp v25, v25, v25 row_ror:8 row_mask:0xf bank_mask:0xf
 v_add_f32_dpp v26, v26, v26 row_ror:8 row_mask:0xf bank_mask:0xf
 v_add_f32_dpp v27, v27, v27 row_ror:8 row_mask:0xf bank_mask:0xf
 s_mov_b64 exec, s[84:85]
 v_cvt_pk_bf16_f32 v24, v24, v25
 v_cvt_pk_bf16_f32 v25, v26, v27
 buffer_store_dwordx2 v[24:25], v57, s[4:7], s57 offen sc1
 s_mov_b64 exec, -1
 s_xor_b32 s55, s55, 1
 ds_read_b128 v[40:43], v1 offset:12288
 ds_read_b128 v[44:47], v1 offset:13312
 ds_read_b128 v[48:51], v1 offset:2048
 ds_read_b128 v[52:55], v1 offset:3072
 buffer_load_dwordx4 v[56:59], v1, s[4:7], s81 offen offset:2048
 buffer_load_dwordx4 v[60:63], v1, s[4:7], s81 offen offset:3072
 ds_read_b128 v[8:11], v3 offset:49152
 ds_read_b128 v[12:15], v3 offset:49152
 ds_read_b128 v[16:19], v3 offset:49152
 ds_read_b128 v[20:23], v3 offset:49152
 s_waitcnt lgkmcnt(0)
 s_nop 15
 s_nop 15
 s_nop 7
 s_branch L_ch1_s
L_rt_185:
 s_add_u32 s51, s51, 1
 s_cmp_lt_u32 s51, 131072
 s_cbranch_scc1 L_pm_184
 s_branch L_bail
L_rt_187:
 buffer_load_dwordx4 v[8:11], v56, s[4:7], s64 offen sc1
 buffer_load_dwordx4 v[12:15], v56, s[4:7], s65 offen sc1
 buffer_load_dwordx4 v[16:19], v56, s[4:7], s66 offen sc1
 buffer_load_dwordx4 v[20:23], v56, s[4:7], s67 offen sc1
 s_add_u32 s51, s51, 1
 s_cmp_lt_u32 s51, 131072
 s_cbranch_scc1 L_pp_186
 s_branch L_bail
L_ch1_end:
 s_waitcnt vmcnt(0)
 s_endpgm
L_ch2:
 v_lshrrev_b32 v8, 4, v0
 s_mov_b32 s3, 1280
 v_mul_lo_u32 v8, v8, s3
 v_lshrrev_b32 v7, 3, v0
 v_and_b32 v7, 6, v7
 v_xor_b32 v7, v7, v0
 v_and_b32 v7, 15, v7
 v_lshl_add_u32 v8, v7, 4, v8
 v_xor_b32 v9, 128, v8
 v_lshrrev_b32 v10, 4, v0
 s_mov_b32 s3, 8192
 v_mul_lo_u32 v10, v10, s3
 v_lshrrev_b32 v7, 3, v0
 v_and_b32 v7, 6, v7
 v_xor_b32 v7, v7, v0
 v_and_b32 v7, 15, v7
 v_lshl_add_u32 v10, v7, 4, v10
 v_xor_b32 v11, 128, v10
 s_mov_b32 s8, s26
 s_and_b32 s9, s27, 0xffff
 s_mov_b32 s10, 5242880
 s_mul_i32 s14, s52, 163840
 s_add_u32 s14, s14, 81920
 s_mov_b32 m0, 16384
 s_nop 0
 buffer_load_dwordx4 v8, s[8:11], s14 offen lds
 s_add_u32 s14, s14, 5120
 s_mov_b32 m0, 17408
 s_nop 0
 buffer_load_dwordx4 v8, s[8:11], s14 offen lds
 s_add_u32 s14, s14, 5120
 s_mov_b32 m0, 18432
 s_nop 0
 buffer_load_dwordx4 v8, s[8:11], s14 offen lds
 s_add_u32 s14, s14, 5120
 s_mov_b32 m0, 19456
 s_nop 0
 buffer_load_dwordx4 v8, s[8:11], s14 offen lds
 s_add_u32 s14, s14, 5120
 s_mov_b32 m0, 20480
 s_nop 0
 buffer_load_dwordx4 v9, s[8:11], s14 offen lds
 s_add_u32 s14, s14, 5120
 s_mov_b32 m0, 21504
 s_nop 0
 buffer_load_dwordx4 v9, s[8:11], s14 offen lds
 s_add_u32 s14, s14, 5120
 s_mov_b32 m0, 22528
 s_nop 0
 buffer_load_dwordx4 v9, s[8:11], s14 offen lds
 s_add_u32 s14, s14, 5120
 s_mov_b32 m0, 23552
 s_nop 0
 buffer_load_dwordx4 v9, s[8:11], s14 offen lds
 s_mul_i32 s14, s52, 163840
 s_add_u32 s14, s14, 82176
 s_mov_b32 m0, 49152
 s_nop 0
 buffer_load_dwordx4 v8, s[8:11], s14 offen lds
 s_add_u32 s14, s14, 5120
 s_mov_b32 m0, 50176
 s_nop 0
 buffer_load_dwordx4 v8, s[8:11], s14 offen lds
 s_add_u32 s14, s14, 5120
 s_mov_b32 m0, 51200
 s_nop 0
 buffer_load_dwordx4 v8, s[8:11], s14 offen lds
 s_add_u32 s14, s14, 5120
 s_mov_b32 m0, 52224
 s_nop 0
 buffer_load_dwordx4 v8, s[8:11], s14 offen lds
 s_add_u32 s14, s14, 5120
 s_mov_b32 m0, 53248
 s_nop 0
 buffer_load_dwordx4 v9, s[8:11], s14 offen lds
 s_add_u32 s14, s14, 5120
 s_mov_b32 m0, 54272
 s_nop 0
 buffer_load_dwordx4 v9, s[8:11], s14 offen lds
 s_add_u32 s14, s14, 5120
 s_mov_b32 m0, 55296
 s_nop 0
 buffer_load_dwordx4 v9, s[8:11], s14 offen lds
 s_add_u32 s14, s14, 5120
 s_mov_b32 m0, 56320
 s_nop 0
 buffer_load_dwordx4 v9, s[8:11], s14 offen lds
 s_mul_i32 s14, s52, 163840
 s_add_u32 s14, s14, 82432
 s_mov_b32 m0, 81920
 s_nop 0
 buffer_load_dwordx4 v8, s[8:11], s14 offen lds
 s_add_u32 s14, s14, 5120
 s_mov_b32 m0, 82944
 s_nop 0
 buffer_load_dwordx4 v8, s[8:11], s14 offen lds
 s_add_u32 s14, s14, 5120
 s_mov_b32 m0, 83968
 s_nop 0
 buffer_load_dwordx4 v8, s[8:11], s14 offen lds
 s_add_u32 s14, s14, 5120
 s_mov_b32 m0, 84992
 s_nop 0
 buffer_load_dwordx4 v8, s[8:11], s14 offen lds
 s_add_u32 s14, s14, 5120
 s_mov_b32 m0, 86016
 s_nop 0
 buffer_load_dwordx4 v9, s[8:11], s14 offen lds
 s_add_u32 s14, s14, 5120
 s_mov_b32 m0, 87040
 s_nop 0
 buffer_load_dwordx4 v9, s[8:11], s14 offen lds
 s_add_u32 s14, s14, 5120
 s_mov_b32 m0, 88064
 s_nop 0
 buffer_load_dwordx4 v9, s[8:11], s14 offen lds
 s_add_u32 s14, s14, 5120
 s_mov_b32 m0, 89088
 s_nop 0
 buffer_load_dwordx4 v9, s[8:11], s14 offen lds
 s_mul_i32 s14, s52, 163840
 s_add_u32 s14, s14, 82688
 s_mov_b32 m0, 114688
 s_nop 0
 buffer_load_dwordx4 v8, s[8:11], s14 offen lds
 s_add_u32 s14, s14, 5120
 s_mov_b32 m0, 115712
 s_nop 0
 buffer_load_dwordx4 v8, s[8:11], s14 offen lds
 s_add_u32 s14, s14, 5120
 s_mov_b32 m0, 116736
 s_nop 0
 buffer_load_dwordx4 v8, s[8:11], s14 offen lds
 s_add_u32 s14, s14, 5120
 s_mov_b32 m0, 117760
 s_nop 0
 buffer_load_dwordx4 v8, s[8:11], s14 offen lds
 s_add_u32 s14, s14, 5120
 s_mov_b32 m0, 118784
 s_nop 0
 buffer_load_dwordx4 v9, s[8:11], s14 offen lds
 s_add_u32 s14, s14, 5120
 s_mov_b32 m0, 119808
 s_nop 0
 buffer_load_dwordx4 v9, s[8:11], s14 offen lds
 s_add_u32 s14, s14, 5120
 s_mov_b32 m0, 120832
 s_nop 0
 buffer_load_dwordx4 v9, s[8:11], s14 offen lds
 s_add_u32 s14, s14, 5120
 s_mov_b32 m0, 121856
 s_nop 0
 buffer_load_dwordx4 v9, s[8:11], s14 offen lds
 s_mul_i32 s14, s52, 163840
 s_add_u32 s14, s14, 82944
 s_mov_b32 m0, 147456
 s_nop 0
 buffer_load_dwordx4 v8, s[8:11], s14 offen lds
 s_add_u32 s14, s14, 5120
 s_mov_b32 m0, 148480
 s_nop 0
 buffer_load_dwordx4 v8, s[8:11], s14 offen lds
 s_add_u32 s14, s14, 5120
 s_mov_b32 m0, 149504
 s_nop 0
 buffer_load_dwordx4 v8, s[8:11], s14 offen lds
 s_add_u32 s14, s14, 5120
 s_mov_b32 m0, 150528
 s_nop 0
 buffer_load_dwordx4 v8, s[8:11], s14 offen lds
 s_add_u32 s14, s14, 5120
 s_mov_b32 m0, 151552
 s_nop 0
 buffer_load_dwordx4 v9, s[8:11], s14 offen lds
 s_add_u32 s14, s14, 5120
 s_mov_b32 m0, 152576
 s_nop 0
 buffer_load_dwordx4 v9, s[8:11], s14 offen lds
 s_add_u32 s14, s14, 5120
 s_mov_b32 m0, 153600
 s_nop 0
 buffer_load_dwordx4 v9, s[8:11], s14 offen lds
 s_add_u32 s14, s14, 5120
 s_mov_b32 m0, 154624
 s_nop 0
 buffer_load_dwordx4 v9, s[8:11], s14 offen lds
 v_lshrrev_b32 v20, 4, v0
 v_bfe_u32 v21, v0, 2, 1
 v_bfe_u32 v22, v0, 3, 1
 v_and_b32 v23, 1, v20
 v_lshrrev_b32 v24, 1, v20
 v_and_b32 v25, 3, v0
 v_lshlrev_b32 v25, 3, v25
 v_lshl_add_u32 v26, v22, 1, v23
 v_lshl_add_u32 v27, v21, 2, v26
 v_lshl_add_u32 v26, v24, 2, v26
 v_lshl_add_u32 v26, v21, 4, v26
 v_xor_b32 v27, 4, v27
 v_lshl_add_u32 v27, v27, 5, v25
 v_lshl_add_u32 v12, v26, 8, v27
 v_lshl_add_u32 v26, v24, 2, v21
 v_lshl_add_u32 v26, v23, 4, v26
 v_lshl_add_u32 v27, v23, 2, v21
 v_lshl_add_u32 v27, v22, 1, v27
 v_lshl_add_u32 v27, v27, 5, v25
 v_lshl_add_u32 v14, v26, 8, v27
 v_lshlrev_b32 v1, 4, v0
 v_add_u32 v2, 65536, v1
 v_add_u32 v3, 114688, v1
 s_waitcnt vmcnt(32)
 s_barrier
 s_waitcnt lgkmcnt(0)
 s_barrier
 s_mov_b32 s8, s24
 s_and_b32 s9, s25, 0xffff
 s_mov_b32 s10, 5242880
 s_lshl_b32 s14, s52, 8
 s_add_u32 s14, s14, 524288
 s_mov_b32 m0, 16384
 s_nop 0
 buffer_load_dwordx4 v10, s[8:11], s14 offen lds
 s_add_u32 s14, s14, 32768
 s_mov_b32 m0, 17408
 s_nop 0
 buffer_load_dwordx4 v10, s[8:11], s14 offen lds
 s_add_u32 s14, s14, 32768
 s_mov_b32 m0, 18432
 s_nop 0
 buffer_load_dwordx4 v10, s[8:11], s14 offen lds
 s_add_u32 s14, s14, 32768
 s_mov_b32 m0, 19456
 s_nop 0
 buffer_load_dwordx4 v10, s[8:11], s14 offen lds
 s_add_u32 s14, s14, 32768
 s_mov_b32 m0, 20480
 s_nop 0
 buffer_load_dwordx4 v11, s[8:11], s14 offen lds
 s_add_u32 s14, s14, 32768
 s_mov_b32 m0, 21504
 s_nop 0
 buffer_load_dwordx4 v11, s[8:11], s14 offen lds
 s_add_u32 s14, s14, 32768
 s_mov_b32 m0, 22528
 s_nop 0
 buffer_load_dwordx4 v11, s[8:11], s14 offen lds
 s_add_u32 s14, s14, 32768
 s_mov_b32 m0, 23552
 s_nop 0
 buffer_load_dwordx4 v11, s[8:11], s14 offen lds
 s_waitcnt vmcnt(32)
 s_barrier
 s_waitcnt lgkmcnt(0)
 s_barrier
 s_lshl_b32 s14, s52, 8
 s_add_u32 s14, s14, 1572864
 s_mov_b32 m0, 49152
 s_nop 0
 buffer_load_dwordx4 v10, s[8:11], s14 offen lds
 s_add_u32 s14, s14, 32768
 s_mov_b32 m0, 50176
 s_nop 0
 buffer_load_dwordx4 v10, s[8:11], s14 offen lds
 s_add_u32 s14, s14, 32768
 s_mov_b32 m0, 51200
 s_nop 0
 buffer_load_dwordx4 v10, s[8:11], s14 offen lds
 s_add_u32 s14, s14, 32768
 s_mov_b32 m0, 52224
 s_nop 0
 buffer_load_dwordx4 v10, s[8:11], s14 offen lds
 s_add_u32 s14, s14, 32768
 s_mov_b32 m0, 53248
 s_nop 0
 buffer_load_dwordx4 v11, s[8:11], s14 offen lds
 s_add_u32 s14, s14, 32768
 s_mov_b32 m0, 54272
 s_nop 0
 buffer_load_dwordx4 v11, s[8:11], s14 offen lds
 s_add_u32 s14, s14, 32768
 s_mov_b32 m0, 55296
 s_nop 0
 buffer_load_dwordx4 v11, s[8:11], s14 offen lds
 s_add_u32 s14, s14, 32768
 s_mov_b32 m0, 56320
 s_nop 0
 buffer_load_dwordx4 v11, s[8:11], s14 offen lds
 s_waitcnt vmcnt(32)
 s_barrier
 v_xor_b32 v16, 0, v14
 v_add_u32 v16, 65536, v16
 v_xor_b32 v17, 64, v16
 ds_read_b64_tr_b16 a[0:1], v16 offset:0
 ds_read_b64_tr_b16 a[2:3], v17 offset:512
 ds_read_b64_tr_b16 a[4:5], v16 offset:2048
 ds_read_b64_tr_b16 a[6:7], v17 offset:2560
 v_xor_b32 v16, 0, v14
 v_add_u32 v16, 65536, v16
 v_xor_b32 v17, 64, v16
 ds_read_b64_tr_b16 a[8:9], v16 offset:8192
 ds_read_b64_tr_b16 a[10:11], v17 offset:8704
 ds_read_b64_tr_b16 a[12:13], v16 offset:10240
 ds_read_b64_tr_b16 a[14:15], v17 offset:10752
 v_xor_b32 v16, 0, v14
 v_add_u32 v16, 65536, v16
 v_xor_b32 v17, 64, v16
 ds_read_b64_tr_b16 a[16:17], v16 offset:16384
 ds_read_b64_tr_b16 a[18:19], v17 offset:16896
 ds_read_b64_tr_b16 a[20:21], v16 offset:18432
 ds_read_b64_tr_b16 a[22:23], v17 offset:18944
 v_xor_b32 v16, 0, v14
 v_add_u32 v16, 65536, v16
 v_xor_b32 v17, 64, v16
 ds_read_b64_tr_b16 a[24:25], v16 offset:24576
 ds_read_b64_tr_b16 a[26:27], v17 offset:25088
 ds_read_b64_tr_b16 a[28:29], v16 offset:26624
 ds_read_b64_tr_b16 a[30:31], v17 offset:27136
 v_xor_b32 v16, 32, v14
 v_add_u32 v16, 65536, v16
 v_xor_b32 v17, 64, v16
 ds_read_b64_tr_b16 a[32:33], v16 offset:0
 ds_read_b64_tr_b16 a[34:35], v17 offset:512
 ds_read_b64_tr_b16 a[36:37], v16 offset:2048
 ds_read_b64_tr_b16 a[38:39], v17 offset:2560
 v_xor_b32 v16, 32, v14
 v_add_u32 v16, 65536, v16
 v_xor_b32 v17, 64, v16
 ds_read_b64_tr_b16 a[40:41], v16 offset:8192
 ds_read_b64_tr_b16 a[42:43], v17 offset:8704
 ds_read_b64_tr_b16 a[44:45], v16 offset:10240
 ds_read_b64_tr_b16 a[46:47], v17 offset:10752
 v_xor_b32 v16, 32, v14
 v_add_u32 v16, 65536, v16
 v_xor_b32 v17, 64, v16
 ds_read_b64_tr_b16 a[48:49], v16 offset:16384
 ds_read_b64_tr_b16 a[50:51], v17 offset:16896
 ds_read_b64_tr_b16 a[52:53], v16 offset:18432
 ds_read_b64_tr_b16 a[54:55], v17 offset:18944
 v_xor_b32 v16, 32, v14
 v_add_u32 v16, 65536, v16
 v_xor_b32 v17, 64, v16
 ds_read_b64_tr_b16 a[56:57], v16 offset:24576
 ds_read_b64_tr_b16 a[58:59], v17 offset:25088
 ds_read_b64_tr_b16 a[60:61], v16 offset:26624
 ds_read_b64_tr_b16 a[62:63], v17 offset:27136
 v_xor_b32 v16, 128, v14
 v_add_u32 v16, 65536, v16
 v_xor_b32 v17, 64, v16
 ds_read_b64_tr_b16 a[64:65], v16 offset:0
 ds_read_b64_tr_b16 a[66:67], v17 offset:512
 ds_read_b64_tr_b16 a[68:69], v16 offset:2048
 ds_read_b64_tr_b16 a[70:71], v17 offset:2560
 v_xor_b32 v16, 128, v14
 v_add_u32 v16, 65536, v16
 v_xor_b32 v17, 64, v16
 ds_read_b64_tr_b16 a[72:73], v16 offset:8192
 ds_read_b64_tr_b16 a[74:75], v17 offset:8704
 ds_read_b64_tr_b16 a[76:77], v16 offset:10240
 ds_read_b64_tr_b16 a[78:79], v17 offset:10752
 v_xor_b32 v16, 128, v14
 v_add_u32 v16, 65536, v16
 v_xor_b32 v17, 64, v16
 ds_read_b64_tr_b16 a[80:81], v16 offset:16384
 ds_read_b64_tr_b16 a[82:83], v17 offset:16896
 ds_read_b64_tr_b16 a[84:85], v16 offset:18432
 ds_read_b64_tr_b16 a[86:87], v17 offset:18944
 v_xor_b32 v16, 128, v14
 v_add_u32 v16, 65536, v16
 v_xor_b32 v17, 64, v16
 ds_read_b64_tr_b16 a[88:89], v16 offset:24576
 ds_read_b64_tr_b16 a[90:91], v17 offset:25088
 ds_read_b64_tr_b16 a[92:93], v16 offset:26624
 ds_read_b64_tr_b16 a[94:95], v17 offset:27136
 v_xor_b32 v16, 160, v14
 v_add_u32 v16, 65536, v16
 v_xor_b32 v17, 64, v16
 ds_read_b64_tr_b16 a[96:97], v16 offset:0
 ds_read_b64_tr_b16 a[98:99], v17 offset:512
 ds_read_b64_tr_b16 a[100:101], v16 offset:2048
 ds_read_b64_tr_b16 a[102:103], v17 offset:2560
 v_xor_b32 v16, 160, v14
 v_add_u32 v16, 65536, v16
 v_xor_b32 v17, 64, v16
 ds_read_b64_tr_b16 a[104:105], v16 offset:8192
 ds_read_b64_tr_b16 a[106:107], v17 offset:8704
 ds_read_b64_tr_b16 a[108:109], v16 offset:10240
 ds_read_b64_tr_b16 a[110:111], v17 offset:10752
 v_xor_b32 v16, 160, v14
 v_add_u32 v16, 65536, v16
 v_xor_b32 v17, 64, v16
 ds_read_b64_tr_b16 a[112:113], v16 offset:16384
 ds_read_b64_tr_b16 a[114:115], v17 offset:16896
 ds_read_b64_tr_b16 a[116:117], v16 offset:18432
 ds_read_b64_tr_b16 a[118:119], v17 offset:18944
 v_xor_b32 v16, 160, v14
 v_add_u32 v16, 65536, v16
 v_xor_b32 v17, 64, v16
 ds_read_b64_tr_b16 a[120:121], v16 offset:24576
 ds_read_b64_tr_b16 a[122:123], v17 offset:25088
 ds_read_b64_tr_b16 a[124:125], v16 offset:26624
 ds_read_b64_tr_b16 a[126:127], v17 offset:27136
 s_waitcnt lgkmcnt(0)
 s_barrier
 s_lshl_b32 s14, s52, 8
 s_add_u32 s14, s14, 2621440
 s_mov_b32 m0, 81920
 s_nop 0
 buffer_load_dwordx4 v10, s[8:11], s14 offen lds
 s_add_u32 s14, s14, 32768
 s_mov_b32 m0, 82944
 s_nop 0
 buffer_load_dwordx4 v10, s[8:11], s14 offen lds
 s_add_u32 s14, s14, 32768
 s_mov_b32 m0, 83968
 s_nop 0
 buffer_load_dwordx4 v10, s[8:11], s14 offen lds
 s_add_u32 s14, s14, 32768
 s_mov_b32 m0, 84992
 s_nop 0
 buffer_load_dwordx4 v10, s[8:11], s14 offen lds
 s_add_u32 s14, s14, 32768
 s_mov_b32 m0, 86016
 s_nop 0
 buffer_load_dwordx4 v11, s[8:11], s14 offen lds
 s_add_u32 s14, s14, 32768
 s_mov_b32 m0, 87040
 s_nop 0
 buffer_load_dwordx4 v11, s[8:11], s14 offen lds
 s_add_u32 s14, s14, 32768
 s_mov_b32 m0, 88064
 s_nop 0
 buffer_load_dwordx4 v11, s[8:11], s14 offen lds
 s_add_u32 s14, s14, 32768
 s_mov_b32 m0, 89088
 s_nop 0
 buffer_load_dwordx4 v11, s[8:11], s14 offen lds
 s_waitcnt vmcnt(32)
 s_barrier
 s_waitcnt lgkmcnt(0)
 s_barrier
 s_lshl_b32 s14, s52, 8
 s_add_u32 s14, s14, 3670016
 s_mov_b32 m0, 114688
 s_nop 0
 buffer_load_dwordx4 v10, s[8:11], s14 offen lds
 s_add_u32 s14, s14, 32768
 s_mov_b32 m0, 115712
 s_nop 0
 buffer_load_dwordx4 v10, s[8:11], s14 offen lds
 s_add_u32 s14, s14, 32768
 s_mov_b32 m0, 116736
 s_nop 0
 buffer_load_dwordx4 v10, s[8:11], s14 offen lds
 s_add_u32 s14, s14, 32768
 s_mov_b32 m0, 117760
 s_nop 0
 buffer_load_dwordx4 v10, s[8:11], s14 offen lds
 s_add_u32 s14, s14, 32768
 s_mov_b32 m0, 118784
 s_nop 0
 buffer_load_dwordx4 v11, s[8:11], s14 offen lds
 s_add_u32 s14, s14, 32768
 s_mov_b32 m0, 119808
 s_nop 0
 buffer_load_dwordx4 v11, s[8:11], s14 offen lds
 s_add_u32 s14, s14, 32768
 s_mov_b32 m0, 120832
 s_nop 0
 buffer_load_dwordx4 v11, s[8:11], s14 offen lds
 s_add_u32 s14, s14, 32768
 s_mov_b32 m0, 121856
 s_nop 0
 buffer_load_dwordx4 v11, s[8:11], s14 offen lds
 s_waitcnt vmcnt(32)
 s_barrier
 v_xor_b32 v16, 128, v14
 v_add_u32 v16, 131072, v16
 v_xor_b32 v17, 64, v16
 ds_read_b64_tr_b16 a[128:129], v16 offset:0
 ds_read_b64_tr_b16 a[130:131], v17 offset:512
 ds_read_b64_tr_b16 a[132:133], v16 offset:2048
 ds_read_b64_tr_b16 a[134:135], v17 offset:2560
 v_xor_b32 v16, 128, v14
 v_add_u32 v16, 131072, v16
 v_xor_b32 v17, 64, v16
 ds_read_b64_tr_b16 a[136:137], v16 offset:8192
 ds_read_b64_tr_b16 a[138:139], v17 offset:8704
 ds_read_b64_tr_b16 a[140:141], v16 offset:10240
 ds_read_b64_tr_b16 a[142:143], v17 offset:10752
 v_xor_b32 v16, 128, v14
 v_add_u32 v16, 131072, v16
 v_xor_b32 v17, 64, v16
 ds_read_b64_tr_b16 a[144:145], v16 offset:16384
 ds_read_b64_tr_b16 a[146:147], v17 offset:16896
 ds_read_b64_tr_b16 a[148:149], v16 offset:18432
 ds_read_b64_tr_b16 a[150:151], v17 offset:18944
 v_xor_b32 v16, 128, v14
 v_add_u32 v16, 131072, v16
 v_xor_b32 v17, 64, v16
 ds_read_b64_tr_b16 a[152:153], v16 offset:24576
 ds_read_b64_tr_b16 a[154:155], v17 offset:25088
 ds_read_b64_tr_b16 a[156:157], v16 offset:26624
 ds_read_b64_tr_b16 a[158:159], v17 offset:27136
 s_waitcnt lgkmcnt(0)
 s_barrier
 s_lshl_b32 s14, s52, 8
 s_add_u32 s14, s14, 4718592
 s_mov_b32 m0, 147456
 s_nop 0
 buffer_load_dwordx4 v10, s[8:11], s14 offen lds
 s_add_u32 s14, s14, 32768
 s_mov_b32 m0, 148480
 s_nop 0
 buffer_load_dwordx4 v10, s[8:11], s14 offen lds
 s_add_u32 s14, s14, 32768
 s_mov_b32 m0, 149504
 s_nop 0
 buffer_load_dwordx4 v10, s[8:11], s14 offen lds
 s_add_u32 s14, s14, 32768
 s_mov_b32 m0, 150528
 s_nop 0
 buffer_load_dwordx4 v10, s[8:11], s14 offen lds
 s_add_u32 s14, s14, 32768
 s_mov_b32 m0, 151552
 s_nop 0
 buffer_load_dwordx4 v11, s[8:11], s14 offen lds
 s_add_u32 s14, s14, 32768
 s_mov_b32 m0, 152576
 s_nop 0
 buffer_load_dwordx4 v11, s[8:11], s14 offen lds
 s_add_u32 s14, s14, 32768
 s_mov_b32 m0, 153600
 s_nop 0
 buffer_load_dwordx4 v11, s[8:11], s14 offen lds
 s_add_u32 s14, s14, 32768
 s_mov_b32 m0, 154624
 s_nop 0
 buffer_load_dwordx4 v11, s[8:11], s14 offen lds
 s_waitcnt vmcnt(32)
 s_barrier
 v_xor_b32 v16, 0, v12
 v_add_u32 v16, 0, v16
 ds_read_b64_tr_b16 a[160:161], v16 offset:0
 ds_read_b64_tr_b16 a[162:163], v16 offset:8192
 ds_read_b64_tr_b16 a[164:165], v16 offset:2048
 ds_read_b64_tr_b16 a[166:167], v16 offset:10240
 v_xor_b32 v16, 32, v12
 v_add_u32 v16, 0, v16
 ds_read_b64_tr_b16 a[168:169], v16 offset:0
 ds_read_b64_tr_b16 a[170:171], v16 offset:8192
 ds_read_b64_tr_b16 a[172:173], v16 offset:2048
 ds_read_b64_tr_b16 a[174:175], v16 offset:10240
 v_xor_b32 v16, 0, v12
 v_add_u32 v16, 0, v16
 ds_read_b64_tr_b16 a[176:177], v16 offset:16384
 ds_read_b64_tr_b16 a[178:179], v16 offset:24576
 ds_read_b64_tr_b16 a[180:181], v16 offset:18432
 ds_read_b64_tr_b16 a[182:183], v16 offset:26624
 v_xor_b32 v16, 32, v12
 v_add_u32 v16, 0, v16
 ds_read_b64_tr_b16 a[184:185], v16 offset:16384
 ds_read_b64_tr_b16 a[186:187], v16 offset:24576
 ds_read_b64_tr_b16 a[188:189], v16 offset:18432
 ds_read_b64_tr_b16 a[190:191], v16 offset:26624
 s_waitcnt lgkmcnt(0)
 s_barrier
 s_mov_b32 s8, s22
 s_and_b32 s9, s23, 0xffff
 s_mov_b32 s10, 5242880
 s_lshl_b32 s14, s52, 8
 s_add_u32 s14, s14, 524288
 s_mov_b32 m0, 16384
 s_nop 0
 buffer_load_dwordx4 v10, s[8:11], s14 offen lds
 s_add_u32 s14, s14, 32768
 s_mov_b32 m0, 17408
 s_nop 0
 buffer_load_dwordx4 v10, s[8:11], s14 offen lds
 s_add_u32 s14, s14, 32768
 s_mov_b32 m0, 18432
 s_nop 0
 buffer_load_dwordx4 v10, s[8:11], s14 offen lds
 s_add_u32 s14, s14, 32768
 s_mov_b32 m0, 19456
 s_nop 0
 buffer_load_dwordx4 v10, s[8:11], s14 offen lds
 s_add_u32 s14, s14, 32768
 s_mov_b32 m0, 20480
 s_nop 0
 buffer_load_dwordx4 v11, s[8:11], s14 offen lds
 s_add_u32 s14, s14, 32768
 s_mov_b32 m0, 21504
 s_nop 0
 buffer_load_dwordx4 v11, s[8:11], s14 offen lds
 s_add_u32 s14, s14, 32768
 s_mov_b32 m0, 22528
 s_nop 0
 buffer_load_dwordx4 v11, s[8:11], s14 offen lds
 s_add_u32 s14, s14, 32768
 s_mov_b32 m0, 23552
 s_nop 0
 buffer_load_dwordx4 v11, s[8:11], s14 offen lds
 s_waitcnt vmcnt(32)
 s_barrier
 v_xor_b32 v16, 0, v12
 v_add_u32 v16, 32768, v16
 ds_read_b64_tr_b16 a[192:193], v16 offset:0
 ds_read_b64_tr_b16 a[194:195], v16 offset:8192
 ds_read_b64_tr_b16 a[196:197], v16 offset:2048
 ds_read_b64_tr_b16 a[198:199], v16 offset:10240
 v_xor_b32 v16, 32, v12
 v_add_u32 v16, 32768, v16
 ds_read_b64_tr_b16 a[200:201], v16 offset:0
 ds_read_b64_tr_b16 a[202:203], v16 offset:8192
 ds_read_b64_tr_b16 a[204:205], v16 offset:2048
 ds_read_b64_tr_b16 a[206:207], v16 offset:10240
 v_xor_b32 v16, 0, v12
 v_add_u32 v16, 32768, v16
 ds_read_b64_tr_b16 a[208:209], v16 offset:16384
 ds_read_b64_tr_b16 a[210:211], v16 offset:24576
 ds_read_b64_tr_b16 a[212:213], v16 offset:18432
 ds_read_b64_tr_b16 a[214:215], v16 offset:26624
 v_xor_b32 v16, 32, v12
 v_add_u32 v16, 32768, v16
 ds_read_b64_tr_b16 a[216:217], v16 offset:16384
 ds_read_b64_tr_b16 a[218:219], v16 offset:24576
 ds_read_b64_tr_b16 a[220:221], v16 offset:18432
 ds_read_b64_tr_b16 a[222:223], v16 offset:26624
 s_waitcnt lgkmcnt(0)
 s_barrier
 s_lshl_b32 s14, s52, 8
 s_add_u32 s14, s14, 1572864
 s_mov_b32 m0, 49152
 s_nop 0
 buffer_load_dwordx4 v10, s[8:11], s14 offen lds
 s_add_u32 s14, s14, 32768
 s_mov_b32 m0, 50176
 s_nop 0
 buffer_load_dwordx4 v10, s[8:11], s14 offen lds
 s_add_u32 s14, s14, 32768
 s_mov_b32 m0, 51200
 s_nop 0
 buffer_load_dwordx4 v10, s[8:11], s14 offen lds
 s_add_u32 s14, s14, 32768
 s_mov_b32 m0, 52224
 s_nop 0
 buffer_load_dwordx4 v10, s[8:11], s14 offen lds
 s_add_u32 s14, s14, 32768
 s_mov_b32 m0, 53248
 s_nop 0
 buffer_load_dwordx4 v11, s[8:11], s14 offen lds
 s_add_u32 s14, s14, 32768
 s_mov_b32 m0, 54272
 s_nop 0
 buffer_load_dwordx4 v11, s[8:11], s14 offen lds
 s_add_u32 s14, s14, 32768
 s_mov_b32 m0, 55296
 s_nop 0
 buffer_load_dwordx4 v11, s[8:11], s14 offen lds
 s_add_u32 s14, s14, 32768
 s_mov_b32 m0, 56320
 s_nop 0
 buffer_load_dwordx4 v11, s[8:11], s14 offen lds
 s_waitcnt vmcnt(32)
 s_barrier
 v_xor_b32 v16, 0, v12
 v_add_u32 v16, 65536, v16
 ds_read_b64_tr_b16 a[224:225], v16 offset:0
 ds_read_b64_tr_b16 a[226:227], v16 offset:8192
 ds_read_b64_tr_b16 a[228:229], v16 offset:2048
 ds_read_b64_tr_b16 a[230:231], v16 offset:10240
 v_xor_b32 v16, 32, v12
 v_add_u32 v16, 65536, v16
 ds_read_b64_tr_b16 a[232:233], v16 offset:0
 ds_read_b64_tr_b16 a[234:235], v16 offset:8192
 ds_read_b64_tr_b16 a[236:237], v16 offset:2048
 ds_read_b64_tr_b16 a[238:239], v16 offset:10240
 v_xor_b32 v16, 0, v12
 v_add_u32 v16, 65536, v16
 ds_read_b64_tr_b16 a[240:241], v16 offset:16384
 ds_read_b64_tr_b16 a[242:243], v16 offset:24576
 ds_read_b64_tr_b16 a[244:245], v16 offset:18432
 ds_read_b64_tr_b16 a[246:247], v16 offset:26624
 v_xor_b32 v16, 32, v12
 v_add_u32 v16, 65536, v16
 ds_read_b64_tr_b16 a[248:249], v16 offset:16384
 ds_read_b64_tr_b16 a[250:251], v16 offset:24576
 ds_read_b64_tr_b16 a[252:253], v16 offset:18432
 ds_read_b64_tr_b16 a[254:255], v16 offset:26624
 s_waitcnt lgkmcnt(0)
 s_barrier
 s_lshl_b32 s14, s52, 8
 s_add_u32 s14, s14, 2621440
 s_mov_b32 m0, 81920
 s_nop 0
 buffer_load_dwordx4 v10, s[8:11], s14 offen lds
 s_add_u32 s14, s14, 32768
 s_mov_b32 m0, 82944
 s_nop 0
 buffer_load_dwordx4 v10, s[8:11], s14 offen lds
 s_add_u32 s14, s14, 32768
 s_mov_b32 m0, 83968
 s_nop 0
 buffer_load_dwordx4 v10, s[8:11], s14 offen lds
 s_add_u32 s14, s14, 32768
 s_mov_b32 m0, 84992
 s_nop 0
 buffer_load_dwordx4 v10, s[8:11], s14 offen lds
 s_add_u32 s14, s14, 32768
 s_mov_b32 m0, 86016
 s_nop 0
 buffer_load_dwordx4 v11, s[8:11], s14 offen lds
 s_add_u32 s14, s14, 32768
 s_mov_b32 m0, 87040
 s_nop 0
 buffer_load_dwordx4 v11, s[8:11], s14 offen lds
 s_add_u32 s14, s14, 32768
 s_mov_b32 m0, 88064
 s_nop 0
 buffer_load_dwordx4 v11, s[8:11], s14 offen lds
 s_add_u32 s14, s14, 32768
 s_mov_b32 m0, 89088
 s_nop 0
 buffer_load_dwordx4 v11, s[8:11], s14 offen lds
 s_waitcnt vmcnt(32)
 s_barrier
 v_xor_b32 v16, 0, v12
 v_add_u32 v16, 98304, v16
 ds_read_b64_tr_b16 v[64:65], v16 offset:0
 ds_read_b64_tr_b16 v[66:67], v16 offset:8192
 ds_read_b64_tr_b16 v[68:69], v16 offset:2048
 ds_read_b64_tr_b16 v[70:71], v16 offset:10240
 v_xor_b32 v16, 32, v12
 v_add_u32 v16, 98304, v16
 ds_read_b64_tr_b16 v[72:73], v16 offset:0
 ds_read_b64_tr_b16 v[74:75], v16 offset:8192
 ds_read_b64_tr_b16 v[76:77], v16 offset:2048
 ds_read_b64_tr_b16 v[78:79], v16 offset:10240
 v_xor_b32 v16, 0, v12
 v_add_u32 v16, 98304, v16
 ds_read_b64_tr_b16 v[80:81], v16 offset:16384
 ds_read_b64_tr_b16 v[82:83], v16 offset:24576
 ds_read_b64_tr_b16 v[84:85], v16 offset:18432
 ds_read_b64_tr_b16 v[86:87], v16 offset:26624
 v_xor_b32 v16, 32, v12
 v_add_u32 v16, 98304, v16
 ds_read_b64_tr_b16 v[88:89], v16 offset:16384
 ds_read_b64_tr_b16 v[90:91], v16 offset:24576
 ds_read_b64_tr_b16 v[92:93], v16 offset:18432
 ds_read_b64_tr_b16 v[94:95], v16 offset:26624
 s_waitcnt lgkmcnt(0)
 s_barrier
 s_lshl_b32 s14, s52, 8
 s_add_u32 s14, s14, 3670016
 s_mov_b32 m0, 114688
 s_nop 0
 buffer_load_dwordx4 v10, s[8:11], s14 offen lds
 s_add_u32 s14, s14, 32768
 s_mov_b32 m0, 115712
 s_nop 0
 buffer_load_dwordx4 v10, s[8:11], s14 offen lds
 s_add_u32 s14, s14, 32768
 s_mov_b32 m0, 116736
 s_nop 0
 buffer_load_dwordx4 v10, s[8:11], s14 offen lds
 s_add_u32 s14, s14, 32768
 s_mov_b32 m0, 117760
 s_nop 0
 buffer_load_dwordx4 v10, s[8:11], s14 offen lds
 s_add_u32 s14, s14, 32768
 s_mov_b32 m0, 118784
 s_nop 0
 buffer_load_dwordx4 v11, s[8:11], s14 offen lds
 s_add_u32 s14, s14, 32768
 s_mov_b32 m0, 119808
 s_nop 0
 buffer_load_dwordx4 v11, s[8:11], s14 offen lds
 s_add_u32 s14, s14, 32768
 s_mov_b32 m0, 120832
 s_nop 0
 buffer_load_dwordx4 v11, s[8:11], s14 offen lds
 s_add_u32 s14, s14, 32768
 s_mov_b32 m0, 121856
 s_nop 0
 buffer_load_dwordx4 v11, s[8:11], s14 offen lds
 s_waitcnt vmcnt(32)
 s_barrier
 v_xor_b32 v16, 0, v12
 v_add_u32 v16, 131072, v16
 ds_read_b64_tr_b16 v[96:97], v16 offset:0
 ds_read_b64_tr_b16 v[98:99], v16 offset:8192
 ds_read_b64_tr_b16 v[100:101], v16 offset:2048
 ds_read_b64_tr_b16 v[102:103], v16 offset:10240
 v_xor_b32 v16, 32, v12
 v_add_u32 v16, 131072, v16
 ds_read_b64_tr_b16 v[104:105], v16 offset:0
 ds_read_b64_tr_b16 v[106:107], v16 offset:8192
 ds_read_b64_tr_b16 v[108:109], v16 offset:2048
 ds_read_b64_tr_b16 v[110:111], v16 offset:10240
 v_xor_b32 v16, 0, v12
 v_add_u32 v16, 131072, v16
 ds_read_b64_tr_b16 v[112:113], v16 offset:16384
 ds_read_b64_tr_b16 v[114:115], v16 offset:24576
 ds_read_b64_tr_b16 v[116:117], v16 offset:18432
 ds_read_b64_tr_b16 v[118:119], v16 offset:26624
 v_xor_b32 v16, 32, v12
 v_add_u32 v16, 131072, v16
 ds_read_b64_tr_b16 v[120:121], v16 offset:16384
 ds_read_b64_tr_b16 v[122:123], v16 offset:24576
 ds_read_b64_tr_b16 v[124:125], v16 offset:18432
 ds_read_b64_tr_b16 v[126:127], v16 offset:26624
 s_waitcnt lgkmcnt(0)
 s_barrier
 s_lshl_b32 s14, s52, 8
 s_add_u32 s14, s14, 4718592
 s_mov_b32 m0, 147456
 s_nop 0
 buffer_load_dwordx4 v10, s[8:11], s14 offen lds
 s_add_u32 s14, s14, 32768
 s_mov_b32 m0, 148480
 s_nop 0
 buffer_load_dwordx4 v10, s[8:11], s14 offen lds
 s_add_u32 s14, s14, 32768
 s_mov_b32 m0, 149504
 s_nop 0
 buffer_load_dwordx4 v10, s[8:11], s14 offen lds
 s_add_u32 s14, s14, 32768
 s_mov_b32 m0, 150528
 s_nop 0
 buffer_load_dwordx4 v10, s[8:11], s14 offen lds
 s_add_u32 s14, s14, 32768
 s_mov_b32 m0, 151552
 s_nop 0
 buffer_load_dwordx4 v11, s[8:11], s14 offen lds
 s_add_u32 s14, s14, 32768
 s_mov_b32 m0, 152576
 s_nop 0
 buffer_load_dwordx4 v11, s[8:11], s14 offen lds
 s_add_u32 s14, s14, 32768
 s_mov_b32 m0, 153600
 s_nop 0
 buffer_load_dwordx4 v11, s[8:11], s14 offen lds
 s_add_u32 s14, s14, 32768
 s_mov_b32 m0, 154624
 s_nop 0
 buffer_load_dwordx4 v11, s[8:11], s14 offen lds
 s_waitcnt vmcnt(32)
 s_barrier
 v_xor_b32 v16, 0, v12
 v_add_u32 v16, 0, v16
 ds_read_b64_tr_b16 v[128:129], v16 offset:0
 ds_read_b64_tr_b16 v[130:131], v16 offset:8192
 ds_read_b64_tr_b16 v[132:133], v16 offset:2048
 ds_read_b64_tr_b16 v[134:135], v16 offset:10240
 v_xor_b32 v16, 32, v12
 v_add_u32 v16, 0, v16
 ds_read_b64_tr_b16 v[136:137], v16 offset:0
 ds_read_b64_tr_b16 v[138:139], v16 offset:8192
 ds_read_b64_tr_b16 v[140:141], v16 offset:2048
 ds_read_b64_tr_b16 v[142:143], v16 offset:10240
 v_xor_b32 v16, 0, v12
 v_add_u32 v16, 0, v16
 ds_read_b64_tr_b16 v[144:145], v16 offset:16384
 ds_read_b64_tr_b16 v[146:147], v16 offset:24576
 ds_read_b64_tr_b16 v[148:149], v16 offset:18432
 ds_read_b64_tr_b16 v[150:151], v16 offset:26624
 v_xor_b32 v16, 32, v12
 v_add_u32 v16, 0, v16
 ds_read_b64_tr_b16 v[152:153], v16 offset:16384
 ds_read_b64_tr_b16 v[154:155], v16 offset:24576
 ds_read_b64_tr_b16 v[156:157], v16 offset:18432
 ds_read_b64_tr_b16 v[158:159], v16 offset:26624
 s_waitcnt lgkmcnt(0)
 s_barrier
 s_mov_b32 s8, s20
 s_and_b32 s9, s21, 0xffff
 s_mov_b32 s10, 5242880
 s_lshl_b32 s14, s52, 8
 s_add_u32 s14, s14, 524288
 s_mov_b32 m0, 16384
 s_nop 0
 buffer_load_dwordx4 v10, s[8:11], s14 offen lds
 s_add_u32 s14, s14, 32768
 s_mov_b32 m0, 17408
 s_nop 0
 buffer_load_dwordx4 v10, s[8:11], s14 offen lds
 s_add_u32 s14, s14, 32768
 s_mov_b32 m0, 18432
 s_nop 0
 buffer_load_dwordx4 v10, s[8:11], s14 offen lds
 s_add_u32 s14, s14, 32768
 s_mov_b32 m0, 19456
 s_nop 0
 buffer_load_dwordx4 v10, s[8:11], s14 offen lds
 s_add_u32 s14, s14, 32768
 s_mov_b32 m0, 20480
 s_nop 0
 buffer_load_dwordx4 v11, s[8:11], s14 offen lds
 s_add_u32 s14, s14, 32768
 s_mov_b32 m0, 21504
 s_nop 0
 buffer_load_dwordx4 v11, s[8:11], s14 offen lds
 s_add_u32 s14, s14, 32768
 s_mov_b32 m0, 22528
 s_nop 0
 buffer_load_dwordx4 v11, s[8:11], s14 offen lds
 s_add_u32 s14, s14, 32768
 s_mov_b32 m0, 23552
 s_nop 0
 buffer_load_dwordx4 v11, s[8:11], s14 offen lds
 s_waitcnt vmcnt(32)
 s_barrier
 v_xor_b32 v16, 0, v12
 v_add_u32 v16, 32768, v16
 ds_read_b64_tr_b16 v[160:161], v16 offset:0
 ds_read_b64_tr_b16 v[162:163], v16 offset:8192
 ds_read_b64_tr_b16 v[164:165], v16 offset:2048
 ds_read_b64_tr_b16 v[166:167], v16 offset:10240
 v_xor_b32 v16, 32, v12
 v_add_u32 v16, 32768, v16
 ds_read_b64_tr_b16 v[168:169], v16 offset:0
 ds_read_b64_tr_b16 v[170:171], v16 offset:8192
 ds_read_b64_tr_b16 v[172:173], v16 offset:2048
 ds_read_b64_tr_b16 v[174:175], v16 offset:10240
 v_xor_b32 v16, 0, v12
 v_add_u32 v16, 32768, v16
 ds_read_b64_tr_b16 v[176:177], v16 offset:16384
 ds_read_b64_tr_b16 v[178:179], v16 offset:24576
 ds_read_b64_tr_b16 v[180:181], v16 offset:18432
 ds_read_b64_tr_b16 v[182:183], v16 offset:26624
 v_xor_b32 v16, 32, v12
 v_add_u32 v16, 32768, v16
 ds_read_b64_tr_b16 v[32:33], v16 offset:16384
 ds_read_b64_tr_b16 v[34:35], v16 offset:24576
 ds_read_b64_tr_b16 v[36:37], v16 offset:18432
 ds_read_b64_tr_b16 v[38:39], v16 offset:26624
 s_add_u32 s3, s63, 0
 s_waitcnt lgkmcnt(2)
 buffer_store_dwordx4 v[32:35], v1, s[4:7], s3 offen offset:0
 s_waitcnt lgkmcnt(0)
 buffer_store_dwordx4 v[36:39], v1, s[4:7], s3 offen offset:1024
 s_waitcnt lgkmcnt(0)
 s_barrier
 s_lshl_b32 s14, s52, 8
 s_add_u32 s14, s14, 1572864
 s_mov_b32 m0, 49152
 s_nop 0
 buffer_load_dwordx4 v10, s[8:11], s14 offen lds
 s_add_u32 s14, s14, 32768
 s_mov_b32 m0, 50176
 s_nop 0
 buffer_load_dwordx4 v10, s[8:11], s14 offen lds
 s_add_u32 s14, s14, 32768
 s_mov_b32 m0, 51200
 s_nop 0
 buffer_load_dwordx4 v10, s[8:11], s14 offen lds
 s_add_u32 s14, s14, 32768
 s_mov_b32 m0, 52224
 s_nop 0
 buffer_load_dwordx4 v10, s[8:11], s14 offen lds
 s_add_u32 s14, s14, 32768
 s_mov_b32 m0, 53248
 s_nop 0
 buffer_load_dwordx4 v11, s[8:11], s14 offen lds
 s_add_u32 s14, s14, 32768
 s_mov_b32 m0, 54272
 s_nop 0
 buffer_load_dwordx4 v11, s[8:11], s14 offen lds
 s_add_u32 s14, s14, 32768
 s_mov_b32 m0, 55296
 s_nop 0
 buffer_load_dwordx4 v11, s[8:11], s14 offen lds
 s_add_u32 s14, s14, 32768
 s_mov_b32 m0, 56320
 s_nop 0
 buffer_load_dwordx4 v11, s[8:11], s14 offen lds
 s_waitcnt vmcnt(34)
 s_barrier
 v_xor_b32 v16, 0, v12
 v_add_u32 v16, 65536, v16
 ds_read_b64_tr_b16 v[40:41], v16 offset:0
 ds_read_b64_tr_b16 v[42:43], v16 offset:8192
 ds_read_b64_tr_b16 v[44:45], v16 offset:2048
 ds_read_b64_tr_b16 v[46:47], v16 offset:10240
 s_add_u32 s3, s63, 2048
 s_waitcnt lgkmcnt(2)
 buffer_store_dwordx4 v[40:43], v1, s[4:7], s3 offen offset:0
 s_waitcnt lgkmcnt(0)
 buffer_store_dwordx4 v[44:47], v1, s[4:7], s3 offen offset:1024
 v_xor_b32 v16, 32, v12
 v_add_u32 v16, 65536, v16
 ds_read_b64_tr_b16 v[48:49], v16 offset:0
 ds_read_b64_tr_b16 v[50:51], v16 offset:8192
 ds_read_b64_tr_b16 v[52:53], v16 offset:2048
 ds_read_b64_tr_b16 v[54:55], v16 offset:10240
 s_add_u32 s3, s63, 4096
 s_waitcnt lgkmcnt(2)
 buffer_store_dwordx4 v[48:51], v1, s[4:7], s3 offen offset:0
 s_waitcnt lgkmcnt(0)
 buffer_store_dwordx4 v[52:55], v1, s[4:7], s3 offen offset:1024
 v_xor_b32 v16, 0, v12
 v_add_u32 v16, 65536, v16
 ds_read_b64_tr_b16 v[56:57], v16 offset:16384
 ds_read_b64_tr_b16 v[58:59], v16 offset:24576
 ds_read_b64_tr_b16 v[60:61], v16 offset:18432
 ds_read_b64_tr_b16 v[62:63], v16 offset:26624
 s_add_u32 s3, s63, 6144
 s_waitcnt lgkmcnt(2)
 buffer_store_dwordx4 v[56:59], v1, s[4:7], s3 offen offset:0
 s_waitcnt lgkmcnt(0)
 buffer_store_dwordx4 v[60:63], v1, s[4:7], s3 offen offset:1024
 v_xor_b32 v16, 32, v12
 v_add_u32 v16, 65536, v16
 ds_read_b64_tr_b16 v[32:33], v16 offset:16384
 ds_read_b64_tr_b16 v[34:35], v16 offset:24576
 ds_read_b64_tr_b16 v[36:37], v16 offset:18432
 ds_read_b64_tr_b16 v[38:39], v16 offset:26624
 s_add_u32 s3, s63, 8192
 s_waitcnt lgkmcnt(2)
 buffer_store_dwordx4 v[32:35], v1, s[4:7], s3 offen offset:0
 s_waitcnt lgkmcnt(0)
 buffer_store_dwordx4 v[36:39], v1, s[4:7], s3 offen offset:1024
 s_waitcnt lgkmcnt(0)
 s_barrier
 s_lshl_b32 s14, s52, 8
 s_add_u32 s14, s14, 2621440
 s_mov_b32 m0, 81920
 s_nop 0
 buffer_load_dwordx4 v10, s[8:11], s14 offen lds
 s_add_u32 s14, s14, 32768
 s_mov_b32 m0, 82944
 s_nop 0
 buffer_load_dwordx4 v10, s[8:11], s14 offen lds
 s_add_u32 s14, s14, 32768
 s_mov_b32 m0, 83968
 s_nop 0
 buffer_load_dwordx4 v10, s[8:11], s14 offen lds
 s_add_u32 s14, s14, 32768
 s_mov_b32 m0, 84992
 s_nop 0
 buffer_load_dwordx4 v10, s[8:11], s14 offen lds
 s_add_u32 s14, s14, 32768
 s_mov_b32 m0, 86016
 s_nop 0
 buffer_load_dwordx4 v11, s[8:11], s14 offen lds
 s_add_u32 s14, s14, 32768
 s_mov_b32 m0, 87040
 s_nop 0
 buffer_load_dwordx4 v11, s[8:11], s14 offen lds
 s_add_u32 s14, s14, 32768
 s_mov_b32 m0, 88064
 s_nop 0
 buffer_load_dwordx4 v11, s[8:11], s14 offen lds
 s_add_u32 s14, s14, 32768
 s_mov_b32 m0, 89088
 s_nop 0
 buffer_load_dwordx4 v11, s[8:11], s14 offen lds
 s_waitcnt vmcnt(42)
 s_barrier
 v_xor_b32 v16, 0, v12
 v_add_u32 v16, 98304, v16
 ds_read_b64_tr_b16 v[184:185], v16 offset:0
 ds_read_b64_tr_b16 v[186:187], v16 offset:8192
 ds_read_b64_tr_b16 v[188:189], v16 offset:2048
 ds_read_b64_tr_b16 v[190:191], v16 offset:10240
 v_xor_b32 v16, 32, v12
 v_add_u32 v16, 98304, v16
 ds_read_b64_tr_b16 v[192:193], v16 offset:0
 ds_read_b64_tr_b16 v[194:195], v16 offset:8192
 ds_read_b64_tr_b16 v[196:197], v16 offset:2048
 ds_read_b64_tr_b16 v[198:199], v16 offset:10240
 v_xor_b32 v16, 0, v12
 v_add_u32 v16, 98304, v16
 ds_read_b64_tr_b16 v[200:201], v16 offset:16384
 ds_read_b64_tr_b16 v[202:203], v16 offset:24576
 ds_read_b64_tr_b16 v[204:205], v16 offset:18432
 ds_read_b64_tr_b16 v[206:207], v16 offset:26624
 v_xor_b32 v16, 32, v12
 v_add_u32 v16, 98304, v16
 ds_read_b64_tr_b16 v[208:209], v16 offset:16384
 ds_read_b64_tr_b16 v[210:211], v16 offset:24576
 ds_read_b64_tr_b16 v[212:213], v16 offset:18432
 ds_read_b64_tr_b16 v[214:215], v16 offset:26624
 s_waitcnt lgkmcnt(0)
 s_barrier
 s_lshl_b32 s14, s52, 8
 s_add_u32 s14, s14, 3670016
 s_mov_b32 m0, 114688
 s_nop 0
 buffer_load_dwordx4 v10, s[8:11], s14 offen lds
 s_add_u32 s14, s14, 32768
 s_mov_b32 m0, 115712
 s_nop 0
 buffer_load_dwordx4 v10, s[8:11], s14 offen lds
 s_add_u32 s14, s14, 32768
 s_mov_b32 m0, 116736
 s_nop 0
 buffer_load_dwordx4 v10, s[8:11], s14 offen lds
 s_add_u32 s14, s14, 32768
 s_mov_b32 m0, 117760
 s_nop 0
 buffer_load_dwordx4 v10, s[8:11], s14 offen lds
 s_add_u32 s14, s14, 32768
 s_mov_b32 m0, 118784
 s_nop 0
 buffer_load_dwordx4 v11, s[8:11], s14 offen lds
 s_add_u32 s14, s14, 32768
 s_mov_b32 m0, 119808
 s_nop 0
 buffer_load_dwordx4 v11, s[8:11], s14 offen lds
 s_add_u32 s14, s14, 32768
 s_mov_b32 m0, 120832
 s_nop 0
 buffer_load_dwordx4 v11, s[8:11], s14 offen lds
 s_add_u32 s14, s14, 32768
 s_mov_b32 m0, 121856
 s_nop 0
 buffer_load_dwordx4 v11, s[8:11], s14 offen lds
 s_waitcnt vmcnt(42)
 s_barrier
 v_xor_b32 v16, 0, v12
 v_add_u32 v16, 131072, v16
 ds_read_b64_tr_b16 v[216:217], v16 offset:0
 ds_read_b64_tr_b16 v[218:219], v16 offset:8192
 ds_read_b64_tr_b16 v[220:221], v16 offset:2048
 ds_read_b64_tr_b16 v[222:223], v16 offset:10240
 v_xor_b32 v16, 32, v12
 v_add_u32 v16, 131072, v16
 ds_read_b64_tr_b16 v[224:225], v16 offset:0
 ds_read_b64_tr_b16 v[226:227], v16 offset:8192
 ds_read_b64_tr_b16 v[228:229], v16 offset:2048
 ds_read_b64_tr_b16 v[230:231], v16 offset:10240
 v_xor_b32 v16, 0, v12
 v_add_u32 v16, 131072, v16
 ds_read_b64_tr_b16 v[232:233], v16 offset:16384
 ds_read_b64_tr_b16 v[234:235], v16 offset:24576
 ds_read_b64_tr_b16 v[236:237], v16 offset:18432
 ds_read_b64_tr_b16 v[238:239], v16 offset:26624
 v_xor_b32 v16, 32, v12
 v_add_u32 v16, 131072, v16
 ds_read_b64_tr_b16 v[40:41], v16 offset:16384
 ds_read_b64_tr_b16 v[42:43], v16 offset:24576
 ds_read_b64_tr_b16 v[44:45], v16 offset:18432
 ds_read_b64_tr_b16 v[46:47], v16 offset:26624
 s_add_u32 s3, s63, 10240
 s_waitcnt lgkmcnt(2)
 buffer_store_dwordx4 v[40:43], v1, s[4:7], s3 offen offset:0
 s_waitcnt lgkmcnt(0)
 buffer_store_dwordx4 v[44:47], v1, s[4:7], s3 offen offset:1024
 s_waitcnt lgkmcnt(0)
 s_barrier
 s_lshl_b32 s14, s52, 8
 s_add_u32 s14, s14, 4718592
 s_mov_b32 m0, 147456
 s_nop 0
 buffer_load_dwordx4 v10, s[8:11], s14 offen lds
 s_add_u32 s14, s14, 32768
 s_mov_b32 m0, 148480
 s_nop 0
 buffer_load_dwordx4 v10, s[8:11], s14 offen lds
 s_add_u32 s14, s14, 32768
 s_mov_b32 m0, 149504
 s_nop 0
 buffer_load_dwordx4 v10, s[8:11], s14 offen lds
 s_add_u32 s14, s14, 32768
 s_mov_b32 m0, 150528
 s_nop 0
 buffer_load_dwordx4 v10, s[8:11], s14 offen lds
 s_add_u32 s14, s14, 32768
 s_mov_b32 m0, 151552
 s_nop 0
 buffer_load_dwordx4 v11, s[8:11], s14 offen lds
 s_add_u32 s14, s14, 32768
 s_mov_b32 m0, 152576
 s_nop 0
 buffer_load_dwordx4 v11, s[8:11], s14 offen lds
 s_add_u32 s14, s14, 32768
 s_mov_b32 m0, 153600
 s_nop 0
 buffer_load_dwordx4 v11, s[8:11], s14 offen lds
 s_add_u32 s14, s14, 32768
 s_mov_b32 m0, 154624
 s_nop 0
 buffer_load_dwordx4 v11, s[8:11], s14 offen lds
 s_waitcnt vmcnt(44)
 s_barrier
 v_xor_b32 v16, 0, v12
 v_add_u32 v16, 0, v16
 ds_read_b64_tr_b16 v[240:241], v16 offset:0
 ds_read_b64_tr_b16 v[242:243], v16 offset:8192
 ds_read_b64_tr_b16 v[244:245], v16 offset:2048
 ds_read_b64_tr_b16 v[246:247], v16 offset:10240
 v_xor_b32 v16, 32, v12
 v_add_u32 v16, 0, v16
 ds_read_b64_tr_b16 v[248:249], v16 offset:0
 ds_read_b64_tr_b16 v[250:251], v16 offset:8192
 ds_read_b64_tr_b16 v[252:253], v16 offset:2048
 ds_read_b64_tr_b16 v[254:255], v16 offset:10240
 v_xor_b32 v16, 0, v12
 v_add_u32 v16, 0, v16
 ds_read_b64_tr_b16 v[32:33], v16 offset:16384
 ds_read_b64_tr_b16 v[34:35], v16 offset:24576
 ds_read_b64_tr_b16 v[36:37], v16 offset:18432
 ds_read_b64_tr_b16 v[38:39], v16 offset:26624
 v_xor_b32 v16, 32, v12
 v_add_u32 v16, 0, v16
 ds_read_b64_tr_b16 v[40:41], v16 offset:16384
 ds_read_b64_tr_b16 v[42:43], v16 offset:24576
 ds_read_b64_tr_b16 v[44:45], v16 offset:18432
 ds_read_b64_tr_b16 v[46:47], v16 offset:26624
 s_waitcnt lgkmcnt(0)
 s_barrier
 ds_write_b128 v1, v[224:227] offset:24576
 ds_write_b128 v1, v[228:231] offset:25600
 ds_write_b128 v1, v[216:219] offset:26624
 ds_write_b128 v1, v[220:223] offset:27648
 s_waitcnt lgkmcnt(0)
 v_mov_b32 v224, v32
 v_mov_b32 v225, v33
 v_mov_b32 v226, v34
 v_mov_b32 v227, v35
 v_mov_b32 v228, v36
 v_mov_b32 v229, v37
 v_mov_b32 v230, v38
 v_mov_b32 v231, v39
 v_mov_b32 v216, v40
 v_mov_b32 v217, v41
 v_mov_b32 v218, v42
 v_mov_b32 v219, v43
 v_mov_b32 v220, v44
 v_mov_b32 v221, v45
 v_mov_b32 v222, v46
 v_mov_b32 v223, v47
 s_waitcnt vmcnt(34)
 s_barrier
 v_xor_b32 v16, 0, v12
 v_add_u32 v16, 32768, v16
 ds_read_b64_tr_b16 v[32:33], v16 offset:0
 ds_read_b64_tr_b16 v[34:35], v16 offset:8192
 ds_read_b64_tr_b16 v[36:37], v16 offset:2048
 ds_read_b64_tr_b16 v[38:39], v16 offset:10240
 v_xor_b32 v16, 32, v12
 v_add_u32 v16, 32768, v16
 ds_read_b64_tr_b16 v[40:41], v16 offset:0
 ds_read_b64_tr_b16 v[42:43], v16 offset:8192
 ds_read_b64_tr_b16 v[44:45], v16 offset:2048
 ds_read_b64_tr_b16 v[46:47], v16 offset:10240
 v_xor_b32 v16, 0, v12
 v_add_u32 v16, 32768, v16
 ds_read_b64_tr_b16 v[48:49], v16 offset:16384
 ds_read_b64_tr_b16 v[50:51], v16 offset:24576
 ds_read_b64_tr_b16 v[52:53], v16 offset:18432
 ds_read_b64_tr_b16 v[54:55], v16 offset:26624
 v_xor_b32 v16, 32, v12
 v_add_u32 v16, 32768, v16
 ds_read_b64_tr_b16 v[56:57], v16 offset:16384
 ds_read_b64_tr_b16 v[58:59], v16 offset:24576
 ds_read_b64_tr_b16 v[60:61], v16 offset:18432
 ds_read_b64_tr_b16 v[62:63], v16 offset:26624
 s_waitcnt lgkmcnt(0)
 s_barrier
 ds_write_b128 v1, v[208:211] offset:49152
 ds_write_b128 v1, v[212:215] offset:50176
 ds_write_b128 v1, v[200:203] offset:51200
 ds_write_b128 v1, v[204:207] offset:52224
 ds_write_b128 v1, v[184:187] offset:53248
 ds_write_b128 v1, v[188:191] offset:54272
 ds_write_b128 v1, v[176:179] offset:55296
 ds_write_b128 v1, v[180:183] offset:56320
 s_waitcnt lgkmcnt(0)
 v_mov_b32 v208, v32
 v_mov_b32 v209, v33
 v_mov_b32 v210, v34
 v_mov_b32 v211, v35
 v_mov_b32 v212, v36
 v_mov_b32 v213, v37
 v_mov_b32 v214, v38
 v_mov_b32 v215, v39
 v_mov_b32 v200, v40
 v_mov_b32 v201, v41
 v_mov_b32 v202, v42
 v_mov_b32 v203, v43
 v_mov_b32 v204, v44
 v_mov_b32 v205, v45
 v_mov_b32 v206, v46
 v_mov_b32 v207, v47
 v_mov_b32 v184, v48
 v_mov_b32 v185, v49
 v_mov_b32 v186, v50
 v_mov_b32 v187, v51
 v_mov_b32 v188, v52
 v_mov_b32 v189, v53
 v_mov_b32 v190, v54
 v_mov_b32 v191, v55
 v_mov_b32 v176, v56
 v_mov_b32 v177, v57
 v_mov_b32 v178, v58
 v_mov_b32 v179, v59
 v_mov_b32 v180, v60
 v_mov_b32 v181, v61
 v_mov_b32 v182, v62
 v_mov_b32 v183, v63
 s_waitcnt vmcnt(18)
 s_barrier
 v_xor_b32 v16, 0, v12
 v_add_u32 v16, 65536, v16
 ds_read_b64_tr_b16 v[32:33], v16 offset:0
 ds_read_b64_tr_b16 v[34:35], v16 offset:8192
 ds_read_b64_tr_b16 v[36:37], v16 offset:2048
 ds_read_b64_tr_b16 v[38:39], v16 offset:10240
 v_xor_b32 v16, 32, v12
 v_add_u32 v16, 65536, v16
 ds_read_b64_tr_b16 v[40:41], v16 offset:0
 ds_read_b64_tr_b16 v[42:43], v16 offset:8192
 ds_read_b64_tr_b16 v[44:45], v16 offset:2048
 ds_read_b64_tr_b16 v[46:47], v16 offset:10240
 v_xor_b32 v16, 0, v12
 v_add_u32 v16, 65536, v16
 ds_read_b64_tr_b16 v[48:49], v16 offset:16384
 ds_read_b64_tr_b16 v[50:51], v16 offset:24576
 ds_read_b64_tr_b16 v[52:53], v16 offset:18432
 ds_read_b64_tr_b16 v[54:55], v16 offset:26624
 v_xor_b32 v16, 32, v12
 v_add_u32 v16, 65536, v16
 ds_read_b64_tr_b16 v[56:57], v16 offset:16384
 ds_read_b64_tr_b16 v[58:59], v16 offset:24576
 ds_read_b64_tr_b16 v[60:61], v16 offset:18432
 ds_read_b64_tr_b16 v[62:63], v16 offset:26624
 s_waitcnt lgkmcnt(0)
 s_barrier
 ds_write_b128 v2, v[168:171] offset:16384
 ds_write_b128 v2, v[172:175] offset:17408
 ds_write_b128 v2, v[160:163] offset:18432
 ds_write_b128 v2, v[164:167] offset:19456
 ds_write_b128 v2, v[144:147] offset:20480
 ds_write_b128 v2, v[148:151] offset:21504
 ds_write_b128 v2, v[128:131] offset:22528
 ds_write_b128 v2, v[132:135] offset:23552
 s_waitcnt lgkmcnt(0)
 v_mov_b32 v168, v32
 v_mov_b32 v169, v33
 v_mov_b32 v170, v34
 v_mov_b32 v171, v35
 v_mov_b32 v172, v36
 v_mov_b32 v173, v37
 v_mov_b32 v174, v38
 v_mov_b32 v175, v39
 v_mov_b32 v160, v40
 v_mov_b32 v161, v41
 v_mov_b32 v162, v42
 v_mov_b32 v163, v43
 v_mov_b32 v164, v44
 v_mov_b32 v165, v45
 v_mov_b32 v166, v46
 v_mov_b32 v167, v47
 v_mov_b32 v144, v48
 v_mov_b32 v145, v49
 v_mov_b32 v146, v50
 v_mov_b32 v147, v51
 v_mov_b32 v148, v52
 v_mov_b32 v149, v53
 v_mov_b32 v150, v54
 v_mov_b32 v151, v55
 v_mov_b32 v128, v56
 v_mov_b32 v129, v57
 v_mov_b32 v130, v58
 v_mov_b32 v131, v59
 v_mov_b32 v132, v60
 v_mov_b32 v133, v61
 v_mov_b32 v134, v62
 v_mov_b32 v135, v63
 s_waitcnt vmcnt(10)
 s_barrier
 v_xor_b32 v16, 0, v12
 v_add_u32 v16, 98304, v16
 ds_read_b64_tr_b16 v[32:33], v16 offset:0
 ds_read_b64_tr_b16 v[34:35], v16 offset:8192
 ds_read_b64_tr_b16 v[36:37], v16 offset:2048
 ds_read_b64_tr_b16 v[38:39], v16 offset:10240
 v_xor_b32 v16, 32, v12
 v_add_u32 v16, 98304, v16
 ds_read_b64_tr_b16 v[40:41], v16 offset:0
 ds_read_b64_tr_b16 v[42:43], v16 offset:8192
 ds_read_b64_tr_b16 v[44:45], v16 offset:2048
 ds_read_b64_tr_b16 v[46:47], v16 offset:10240
 v_xor_b32 v16, 0, v12
 v_add_u32 v16, 98304, v16
 ds_read_b64_tr_b16 v[48:49], v16 offset:16384
 ds_read_b64_tr_b16 v[50:51], v16 offset:24576
 ds_read_b64_tr_b16 v[52:53], v16 offset:18432
 ds_read_b64_tr_b16 v[54:55], v16 offset:26624
 v_xor_b32 v16, 32, v12
 v_add_u32 v16, 98304, v16
 ds_read_b64_tr_b16 v[56:57], v16 offset:16384
 ds_read_b64_tr_b16 v[58:59], v16 offset:24576
 ds_read_b64_tr_b16 v[60:61], v16 offset:18432
 ds_read_b64_tr_b16 v[62:63], v16 offset:26624
 s_waitcnt lgkmcnt(0)
 s_barrier
 ds_write_b128 v3, a[136:139] offset:0
 ds_write_b128 v3, a[140:143] offset:1024
 ds_write_b128 v3, a[128:131] offset:2048
 ds_write_b128 v3, a[132:135] offset:3072
 ds_write_b128 v3, a[112:115] offset:4096
 ds_write_b128 v3, a[116:119] offset:5120
 ds_write_b128 v3, a[88:91] offset:6144
 ds_write_b128 v3, a[92:95] offset:7168
 s_waitcnt lgkmcnt(0)
 v_accvgpr_write_b32 a136, v32
 v_accvgpr_write_b32 a137, v33
 v_accvgpr_write_b32 a138, v34
 v_accvgpr_write_b32 a139, v35
 v_accvgpr_write_b32 a140, v36
 v_accvgpr_write_b32 a141, v37
 v_accvgpr_write_b32 a142, v38
 v_accvgpr_write_b32 a143, v39
 v_accvgpr_write_b32 a128, v40
 v_accvgpr_write_b32 a129, v41
 v_accvgpr_write_b32 a130, v42
 v_accvgpr_write_b32 a131, v43
 v_accvgpr_write_b32 a132, v44
 v_accvgpr_write_b32 a133, v45
 v_accvgpr_write_b32 a134, v46
 v_accvgpr_write_b32 a135, v47
 v_accvgpr_write_b32 a112, v48
 v_accvgpr_write_b32 a113, v49
 v_accvgpr_write_b32 a114, v50
 v_accvgpr_write_b32 a115, v51
 v_accvgpr_write_b32 a116, v52
 v_accvgpr_write_b32 a117, v53
 v_accvgpr_write_b32 a118, v54
 v_accvgpr_write_b32 a119, v55
 v_accvgpr_write_b32 a88, v56
 v_accvgpr_write_b32 a89, v57
 v_accvgpr_write_b32 a90, v58
 v_accvgpr_write_b32 a91, v59
 v_accvgpr_write_b32 a92, v60
 v_accvgpr_write_b32 a93, v61
 v_accvgpr_write_b32 a94, v62
 v_accvgpr_write_b32 a95, v63
 s_waitcnt vmcnt(0)
 s_barrier
 v_xor_b32 v16, 0, v12
 v_add_u32 v16, 131072, v16
 ds_read_b64_tr_b16 v[32:33], v16 offset:0
 ds_read_b64_tr_b16 v[34:35], v16 offset:8192
 ds_read_b64_tr_b16 v[36:37], v16 offset:2048
 ds_read_b64_tr_b16 v[38:39], v16 offset:10240
 v_xor_b32 v16, 32, v12
 v_add_u32 v16, 131072, v16
 ds_read_b64_tr_b16 v[40:41], v16 offset:0
 ds_read_b64_tr_b16 v[42:43], v16 offset:8192
 ds_read_b64_tr_b16 v[44:45], v16 offset:2048
 ds_read_b64_tr_b16 v[46:47], v16 offset:10240
 v_xor_b32 v16, 0, v12
 v_add_u32 v16, 131072, v16
 ds_read_b64_tr_b16 v[48:49], v16 offset:16384
 ds_read_b64_tr_b16 v[50:51], v16 offset:24576
 ds_read_b64_tr_b16 v[52:53], v16 offset:18432
 ds_read_b64_tr_b16 v[54:55], v16 offset:26624
 v_xor_b32 v16, 32, v12
 v_add_u32 v16, 131072, v16
 ds_read_b64_tr_b16 v[56:57], v16 offset:16384
 ds_read_b64_tr_b16 v[58:59], v16 offset:24576
 ds_read_b64_tr_b16 v[60:61], v16 offset:18432
 ds_read_b64_tr_b16 v[62:63], v16 offset:26624
 s_waitcnt lgkmcnt(0)
 s_barrier
 ds_write_b128 v3, a[80:83] offset:32768
 ds_write_b128 v3, a[84:87] offset:33792
 ds_write_b128 v3, a[72:75] offset:34816
 ds_write_b128 v3, a[76:79] offset:35840
 ds_write_b128 v3, a[32:35] offset:36864
 ds_write_b128 v3, a[36:39] offset:37888
 ds_write_b128 v3, a[24:27] offset:38912
 ds_write_b128 v3, a[28:31] offset:39936
 s_waitcnt lgkmcnt(0)
 v_accvgpr_write_b32 a80, v32
 v_accvgpr_write_b32 a81, v33
 v_accvgpr_write_b32 a82, v34
 v_accvgpr_write_b32 a83, v35
 v_accvgpr_write_b32 a84, v36
 v_accvgpr_write_b32 a85, v37
 v_accvgpr_write_b32 a86, v38
 v_accvgpr_write_b32 a87, v39
 v_accvgpr_write_b32 a72, v40
 v_accvgpr_write_b32 a73, v41
 v_accvgpr_write_b32 a74, v42
 v_accvgpr_write_b32 a75, v43
 v_accvgpr_write_b32 a76, v44
 v_accvgpr_write_b32 a77, v45
 v_accvgpr_write_b32 a78, v46
 v_accvgpr_write_b32 a79, v47
 v_accvgpr_write_b32 a32, v48
 v_accvgpr_write_b32 a33, v49
 v_accvgpr_write_b32 a34, v50
 v_accvgpr_write_b32 a35, v51
 v_accvgpr_write_b32 a36, v52
 v_accvgpr_write_b32 a37, v53
 v_accvgpr_write_b32 a38, v54
 v_accvgpr_write_b32 a39, v55
 v_accvgpr_write_b32 a24, v56
 v_accvgpr_write_b32 a25, v57
 v_accvgpr_write_b32 a26, v58
 v_accvgpr_write_b32 a27, v59
 v_accvgpr_write_b32 a28, v60
 v_accvgpr_write_b32 a29, v61
 v_accvgpr_write_b32 a30, v62
 v_accvgpr_write_b32 a31, v63
 v_lshlrev_b32 v5, 3, v0
 v_and_b32 v6, 0x1e0, v5
 v_and_b32 v7, 1, v0
 v_lshl_add_u32 v6, v7, 4, v6
 v_and_b32 v7, 2, v0
 v_lshl_add_u32 v6, v7, 2, v6
 v_bfe_u32 v4, v0, 2, 2
 v_lshrrev_b32 v7, 4, v0
 v_cmp_eq_u32 vcc, v4, v7
 v_and_b32 v7, 16, v1
 v_mov_b32 v5, 0x3f80
 v_lshlrev_b32 v7, v7, v5
 v_cndmask_b32 v4, 0, v7, vcc
 v_mov_b32 v5, 0
 s_lshl_b32 s59, s53, 16
 s_add_u32 s59, s59, 983040
 s_mul_i32 s15, s53, 327680
 s_add_u32 s15, s15, 225280
 s_lshl_b32 s3, s52, 6
 s_add_u32 s15, s15, s3
 s_add_u32 s64, s15, 8192
 s_add_u32 s65, s15, 172032
 s_lshr_b32 s14, s52, 4
 s_add_u32 s14, s14, 8
 s_bfe_u32 s15, s52, 0x20002
 s_and_b32 s16, s52, 3
 s_mov_b32 s84, 0x000f000f
 s_mov_b32 s85, 0
 s_lshl_b32 s57, s14, 10
 s_lshl_b32 s3, s15, 6
 s_add_u32 s57, s57, s3
 s_lshl_b32 s3, s16, 8
 s_add_u32 s57, s57, s3
 s_add_u32 s57, s57, s59
 s_add_u32 s59, s59, 4096
 s_lshl_b32 s14, s14, 7
 s_mul_i32 s15, s15, 2560
 s_add_u32 s14, s14, s15
 s_lshl_b32 s3, s16, 3
 s_add_u32 s14, s14, s3
 s_mov_b32 s8, s18
 s_and_b32 s9, s19, 0xffff
 s_mov_b32 s10, 10240
 s_mov_b32 s11, 0x00020000
 v_bfe_u32 v40, v0, 4, 1
 v_mul_u32_u24 v40, 1280, v40
 v_and_b32 v41, 7, v0
 v_lshl_add_u32 v40, v41, 1, v40
 buffer_load_ushort v44, v40, s[8:11], s14 offen offset:0
 buffer_load_ushort v45, v40, s[8:11], s14 offen offset:32
 buffer_load_ushort v46, v40, s[8:11], s14 offen offset:64
 buffer_load_ushort v47, v40, s[8:11], s14 offen offset:96
 v_lshrrev_b32 v42, 6, v1
 v_mul_u32_u24 v42, 10240, v42
 v_and_b32 v7, 48, v1
 v_add_u32 v42, v42, v7
 v_and_b32 v43, 32, v1
 v_and_b32 v7, 64, v1
 v_lshl_add_u32 v43, v7, 2, v43
 v_bfe_u32 v7, v1, 8, 1
 v_lshl_add_u32 v43, v7, 4, v43
 v_bfe_u32 v7, v1, 4, 1
 v_lshl_add_u32 v43, v7, 3, v43
 s_waitcnt vmcnt(2)
 v_lshl_or_b32 v44, v45, 16, v44
 s_waitcnt vmcnt(0)
 v_lshl_or_b32 v45, v47, 16, v46
 s_add_u32 s16, s60, 5120
 s_waitcnt vmcnt(0) lgkmcnt(0)
 s_mov_b32 s96, s44
 s_and_b32 s97, s45, 0xffff
 s_mov_b32 s98, 256
 s_mov_b32 s99, 0x00020000
 v_mov_b32 v8, 132
 s_mov_b32 s51, 0
 s_mov_b64 exec, 1
L_wb_188:
 buffer_load_dword v9, v8, s[96:99], 0 offen sc1
 s_waitcnt vmcnt(0)
 v_cmp_eq_u32 vcc, 0, v9
 s_cbranch_vccz L_wbd_189
 s_sleep 2
 s_add_u32 s51, s51, 1
 s_cmp_lt_u32 s51, 131072
 s_cbranch_scc1 L_wb_188
 s_branch L_bail
L_wbd_189:
 s_mov_b64 exec, -1
 s_mov_b32 s96, s44
 s_and_b32 s97, s45, 0xffff
 s_mov_b32 s98, 256
 s_mov_b32 s99, 0x00020000
 v_mov_b32 v8, 212
 s_mov_b32 s51, 0
 s_mov_b64 exec, 1
L_wb_190:
 buffer_load_dword v9, v8, s[96:99], 0 offen sc1
 s_waitcnt vmcnt(0)
 v_cmp_eq_u32 vcc, 0, v9
 s_cbranch_vccz L_wbd_191
 s_sleep 2
 s_add_u32 s51, s51, 1
 s_cmp_lt_u32 s51, 131072
 s_cbranch_scc1 L_wb_190
 s_branch L_bail
L_wbd_191:
 s_mov_b64 exec, -1
 s_mov_b32 s96, s44
 s_and_b32 s97, s45, 0xffff
 s_mov_b32 s98, 256
 s_mov_b32 s99, 0x00020000
 v_lshlrev_b32 v8, 5, v0
 s_mov_b32 s51, 0
L_gl_192:
 buffer_load_dword v9, v8, s[96:99], 0 offen sc1
 s_waitcnt vmcnt(0)
 v_readlane_b32 s3, v9, s48
 s_mov_b32 s80, 0
 s_nop 2
 s_cmp_ge_u32 s3, 32
 s_cbranch_scc1 L_gld_193
 s_mov_b32 s80, 0
 v_readlane_b32 s3, v9, 0
 s_nop 3
 s_add_u32 s80, s80, s3
 v_readlane_b32 s3, v9, 1
 s_nop 3
 s_add_u32 s80, s80, s3
 v_readlane_b32 s3, v9, 2
 s_nop 3
 s_add_u32 s80, s80, s3
 v_readlane_b32 s3, v9, 3
 s_nop 3
 s_add_u32 s80, s80, s3
 v_readlane_b32 s3, v9, 4
 s_nop 3
 s_add_u32 s80, s80, s3
 v_readlane_b32 s3, v9, 5
 s_nop 3
 s_add_u32 s80, s80, s3
 v_readlane_b32 s3, v9, 6
 s_nop 3
 s_add_u32 s80, s80, s3
 v_readlane_b32 s3, v9, 7
 s_nop 3
 s_add_u32 s80, s80, s3
 s_cmp_ge_u32 s80, 256
 s_cbranch_scc1 L_gld_193
 s_sleep 4
 s_add_u32 s51, s51, 1
 s_cmp_lt_u32 s51, 131072
 s_cbranch_scc1 L_gl_192
 s_branch L_bail
L_gld_193:
 s_mov_b64 exec, s[84:85]
 buffer_store_dwordx2 v[44:45], v43, s[4:7], s57 offen sc1
 s_mov_b64 exec, -1
 v_and_b32 v7, 2, v0
 v_mul_u32_u24 v7, 0x5555, v7
 v_add_u32 v0, 0x4444, v7
 s_mov_b32 m0, 2048
 s_waitcnt vmcnt(0) lgkmcnt(0)
 s_barrier
 buffer_load_dwordx4 v[32:35], v1, s[4:7], s63 offen offset:2048
 buffer_load_dwordx4 v[36:39], v1, s[4:7], s63 offen offset:3072
 buffer_load_dwordx4 v[40:43], v1, s[4:7], s81 offen offset:0
 buffer_load_dwordx4 v[44:47], v1, s[4:7], s81 offen offset:1024
 buffer_load_dwordx4 v[48:51], v1, s[4:7], s81 offen offset:2048
 buffer_load_dwordx4 v[52:55], v1, s[4:7], s81 offen offset:3072
 buffer_load_dwordx4 v[56:59], v1, s[4:7], s101 offen offset:0
 buffer_load_dwordx4 v[60:63], v1, s[4:7], s101 offen offset:1024
 ds_read_b128 v[8:11], v3 offset:49152
 ds_read_b128 v[12:15], v3 offset:49152
 ds_read_b128 v[16:19], v3 offset:49152
 ds_read_b128 v[20:23], v3 offset:49152
 s_waitcnt vmcnt(0) lgkmcnt(0)
 s_cmp_lg_u32 s80, 0
 s_cbranch_scc1 L_ch2_s
.p2align 6
L_ch2_f:
 s_mov_b32 s51, 0
L_pm_194:
 buffer_load_dwordx4 v[24:27], v1, s[4:7], s59 offen offset:0 sc1
 buffer_load_dwordx4 v[28:31], v1, s[4:7], s59 offen offset:1024 sc1
 s_add_u32 s3, s59, 4096
 buffer_load_dwordx4 v[12:15], v1, s[4:7], s3 offen offset:0 sc1
 s_waitcnt vmcnt(2)
 ds_write_b128 v1, v[24:27] offset:4096
 v_max_u32 v7, v24, v26
 s_waitcnt vmcnt(1)
 ds_write_b128 v1, v[28:31] offset:5120
 v_max3_u32 v7, v7, v28, v30
 s_waitcnt vmcnt(0)
 ds_write_b128 v1, v[12:15] offset:8192
 v_max3_u32 v7, v7, v12, v14
 v_cmp_eq_u32 vcc, -1, v7
 s_cbranch_vccnz L_rt_195
 ds_read_b128 v[12:15], v3 offset:49152
 v_smfmac_f32_16x16x64_bf16 v[16:19], v[24:27], v[32:39], v0
 ds_read_b128 v[32:35], v1 offset:26624
 ds_read_b128 v[36:39], v1 offset:27648
 v_smfmac_f32_16x16x64_bf16 v[20:23], v[24:27], v[40:47], v0
 ds_read_b128 v[40:43], v1 offset:24576
 ds_read_b128 v[44:47], v1 offset:25600
 v_smfmac_f32_16x16x64_bf16 v[16:19], v[28:31], v[48:55], v0
 v_smfmac_f32_16x16x64_bf16 v[20:23], v[28:31], v[56:63], v0
 s_waitcnt lgkmcnt(5)
 s_barrier
 buffer_load_dwordx4 v[56:59], v1, s[4:7], s63 offen offset:0
 v_smfmac_f32_16x16x64_bf16 v[8:11], v[24:27], v[168:175], v0
 s_waitcnt lgkmcnt(4)
 v_smfmac_f32_16x16x64_bf16 v[12:15], v[24:27], v[160:167], v0
 ds_read_b128 v[24:27], v1 offset:8192
 buffer_load_dwordx4 v[60:63], v1, s[4:7], s63 offen offset:1024
 v_smfmac_f32_16x16x64_bf16 v[8:11], v[28:31], v[144:151], v0
 v_smfmac_f32_16x16x64_bf16 v[12:15], v[28:31], v[128:135], v0
 ds_read_b128 v[28:31], v1 offset:0
 buffer_load_dwordx4 v[48:51], v1, s[4:7], s101 offen offset:2048
 s_waitcnt lgkmcnt(1)
 v_smfmac_f32_16x16x64_bf16 v[16:19], v[24:27], v[32:39], v0
 ds_read_b128 v[32:35], v2 offset:22528
 ds_read_b128 v[36:39], v2 offset:23552
 v_smfmac_f32_16x16x64_bf16 v[8:11], v[24:27], a[80:87], v0
 buffer_load_dwordx4 v[52:55], v1, s[4:7], s101 offen offset:3072
 v_smfmac_f32_16x16x64_bf16 v[12:15], v[24:27], a[72:79], v0
 v_smfmac_f32_16x16x64_bf16 v[20:23], v[24:27], v[40:47], v0
 ds_read_b128 v[40:43], v2 offset:20480
 ds_read_b128 v[44:47], v2 offset:21504
 ds_read_b128 v[24:27], v1 offset:1024
 s_waitcnt lgkmcnt(5)
 v_smfmac_f32_16x16x64_bf16 v[8:11], v[28:31], v[240:247], v0
 v_smfmac_f32_16x16x64_bf16 v[12:15], v[28:31], v[248:255], v0
 s_waitcnt lgkmcnt(3)
 v_smfmac_f32_16x16x64_bf16 v[16:19], v[28:31], v[32:39], v0
 ds_read_b128 v[32:35], v2 offset:18432
 ds_read_b128 v[36:39], v2 offset:19456
 v_smfmac_f32_16x16x64_bf16 v[20:23], v[28:31], v[136:143], v0
 ds_read_b128 v[28:31], v1 offset:2048
 s_waitcnt lgkmcnt(3)
 v_smfmac_f32_16x16x64_bf16 v[8:11], v[24:27], v[224:231], v0
 v_smfmac_f32_16x16x64_bf16 v[16:19], v[24:27], v[40:47], v0
 ds_read_b128 v[40:43], v2 offset:16384
 ds_read_b128 v[44:47], v2 offset:17408
 v_smfmac_f32_16x16x64_bf16 v[12:15], v[24:27], v[216:223], v0
 v_smfmac_f32_16x16x64_bf16 v[20:23], v[24:27], v[152:159], v0
 ds_read_b128 v[24:27], v1 offset:3072
 s_waitcnt lgkmcnt(3)
 v_smfmac_f32_16x16x64_bf16 v[16:19], v[28:31], v[32:39], v0
 ds_read_b128 v[32:35], v1 offset:55296
 ds_read_b128 v[36:39], v1 offset:56320
 v_smfmac_f32_16x16x64_bf16 v[8:11], v[28:31], v[208:215], v0
 v_smfmac_f32_16x16x64_bf16 v[12:15], v[28:31], v[200:207], v0
 s_waitcnt lgkmcnt(3)
 v_smfmac_f32_16x16x64_bf16 v[20:23], v[28:31], v[40:47], v0
 ds_read_b128 v[40:43], v1 offset:53248
 ds_read_b128 v[44:47], v1 offset:54272
 ds_read_b128 v[28:31], v1 offset:6144
 s_waitcnt lgkmcnt(5)
 v_smfmac_f32_16x16x64_bf16 v[8:11], v[24:27], v[184:191], v0
 v_smfmac_f32_16x16x64_bf16 v[12:15], v[24:27], v[176:183], v0
 s_waitcnt lgkmcnt(3)
 v_smfmac_f32_16x16x64_bf16 v[16:19], v[24:27], v[32:39], v0
 ds_read_b128 v[32:35], v1 offset:51200
 ds_read_b128 v[36:39], v1 offset:52224
 s_waitcnt vmcnt(2)
 v_smfmac_f32_16x16x64_bf16 v[20:23], v[24:27], v[56:63], v0
 ds_read_b128 v[24:27], v1 offset:7168
 buffer_load_dwordx4 v[56:59], v1, s[4:7], s61 offen offset:2048 sc1 nt
 s_waitcnt lgkmcnt(3)
 v_smfmac_f32_16x16x64_bf16 v[8:11], v[28:31], a[136:143], v0
 v_smfmac_f32_16x16x64_bf16 v[16:19], v[28:31], v[40:47], v0
 ds_read_b128 v[40:43], v1 offset:49152
 ds_read_b128 v[44:47], v1 offset:50176
 s_add_u32 s3, s61, 4096
 buffer_load_dwordx4 v[60:63], v1, s[4:7], s3 offen offset:2048 sc1 nt
 v_smfmac_f32_16x16x64_bf16 v[12:15], v[28:31], a[128:135], v0
 v_smfmac_f32_16x16x64_bf16 v[20:23], v[28:31], v[192:199], v0
 ds_read_b128 v[28:31], v1 offset:9216
 s_waitcnt lgkmcnt(3)
 v_smfmac_f32_16x16x64_bf16 v[16:19], v[24:27], v[32:39], v0
 v_smfmac_f32_16x16x64_bf16 v[8:11], v[24:27], a[112:119], v0
 s_add_u32 s3, s61, 67112960
 buffer_load_dwordx4 v[32:35], v1, s[4:7], s3 offen offset:0 sc1 nt
 v_smfmac_f32_16x16x64_bf16 v[12:15], v[24:27], a[88:95], v0
 s_waitcnt lgkmcnt(1)
 v_smfmac_f32_16x16x64_bf16 v[20:23], v[24:27], v[40:47], v0
 ds_read_b128 v[40:43], v3 offset:49152
 ds_read_b128 v[44:47], v3 offset:49152
 buffer_load_dwordx4 v[36:39], v1, s[4:7], s3 offen offset:1024 sc1 nt
 s_waitcnt lgkmcnt(2)
 v_smfmac_f32_16x16x64_bf16 v[8:11], v[28:31], a[32:39], v0
 v_smfmac_f32_16x16x64_bf16 v[12:15], v[28:31], a[24:31], v0
 v_lshlrev_b32 v7, 3, v1
 v_smfmac_f32_16x16x64_bf16 v[16:19], v[28:31], v[232:239], v0
 s_waitcnt vmcnt(4)
 v_smfmac_f32_16x16x64_bf16 v[20:23], v[28:31], v[48:55], v0
 s_add_u32 s3, s61, 67633152
 buffer_load_dword v7, v7, s[4:7], s3 offen sc1
 ds_read_b128 v[52:55], v1 offset:0
 v_add_f32 v8, v8, v10
 v_add_f32 v11, v9, v11
 v_cvt_pk_bf16_f32 v9, v8, v11
 v_cvt_pk_bf16_f32 v8, v8, v11
 v_add_f32 v12, v12, v14
 v_add_f32 v15, v13, v15
 v_cvt_pk_bf16_f32 v13, v12, v15
 v_cvt_pk_bf16_f32 v12, v12, v15
 v_mfma_f32_16x16x16_bf16 v[8:11], v[8:9], v[4:5], 0
 v_mfma_f32_16x16x16_bf16 v[12:15], v[12:13], v[4:5], 0
 v_add_f32 v16, v16, v18
 v_add_f32 v19, v17, v19
 v_cvt_pk_bf16_f32 v17, v16, v19
 v_cvt_pk_bf16_f32 v16, v16, v19
 v_add_f32 v20, v20, v22
 v_add_f32 v23, v21, v23
 v_cvt_pk_bf16_f32 v21, v20, v23
 v_cvt_pk_bf16_f32 v20, v20, v23
 v_mfma_f32_16x16x16_bf16 v[16:19], v[16:17], v[4:5], 0
 v_mfma_f32_16x16x16_bf16 v[20:23], v[20:21], v[4:5], 0
 s_waitcnt lgkmcnt(2)
 v_smfmac_f32_16x16x64_bf16 v[40:43], v[24:27], v[80:87], v0
 s_waitcnt lgkmcnt(1)
 v_smfmac_f32_16x16x64_bf16 v[44:47], v[24:27], v[88:95], v0
 ds_read_b128 v[24:27], v1 offset:1024
 v_cvt_pk_bf16_f32 v15, v14, v15
 v_cvt_pk_bf16_f32 v14, v12, v13
 v_cvt_pk_bf16_f32 v13, v10, v11
 v_cvt_pk_bf16_f32 v12, v8, v9
 s_waitcnt vmcnt(4)
 s_nop 0
 v_mfma_f32_16x16x32_bf16 v[8:11], v[56:59], v[12:15], 0
 v_cvt_pk_bf16_f32 v23, v22, v23
 v_cvt_pk_bf16_f32 v22, v20, v21
 v_cvt_pk_bf16_f32 v21, v18, v19
 v_cvt_pk_bf16_f32 v20, v16, v17
 s_waitcnt vmcnt(3)
 v_mfma_f32_16x16x32_bf16 v[16:19], v[60:63], v[12:15], 0
 v_mfma_f32_16x16x32_bf16 v[48:51], v[20:23], v[12:15], 0
 v_smfmac_f32_16x16x64_bf16 v[40:43], v[28:31], v[112:119], v0
 v_smfmac_f32_16x16x64_bf16 v[44:47], v[28:31], v[120:127], v0
 ds_read_b128 v[28:31], v1 offset:2048
 s_waitcnt lgkmcnt(2)
 v_smfmac_f32_16x16x64_bf16 v[40:43], v[52:55], a[160:167], v0
 v_cndmask_b32 v8, v8, v16, s[70:71]
 v_cndmask_b32 v9, v9, v17, s[70:71]
 v_cndmask_b32 v10, v10, v18, s[70:71]
 v_cndmask_b32 v11, v11, v19, s[70:71]
 ds_write_b128 v1, v[8:11] offset:12288
 ds_write_b64 v1, v[48:49] offset:15360
 v_smfmac_f32_16x16x64_bf16 v[44:47], v[52:55], a[168:175], v0
 ds_read_b128 v[52:55], v1 offset:3072
 s_waitcnt lgkmcnt(4)
 v_smfmac_f32_16x16x64_bf16 v[40:43], v[24:27], a[176:183], v0
 v_smfmac_f32_16x16x64_bf16 v[44:47], v[24:27], a[184:191], v0
 ds_read_b128 v[24:27], v1 offset:4096
 s_waitcnt lgkmcnt(4)
 v_smfmac_f32_16x16x64_bf16 v[40:43], v[28:31], a[192:199], v0
 v_smfmac_f32_16x16x64_bf16 v[44:47], v[28:31], a[200:207], v0
 ds_read_b128 v[28:31], v1 offset:5120
 s_waitcnt lgkmcnt(2)
 v_smfmac_f32_16x16x64_bf16 v[40:43], v[52:55], a[208:215], v0
 v_smfmac_f32_16x16x64_bf16 v[44:47], v[52:55], a[216:223], v0
 ds_read_b128 v[52:55], v1 offset:6144
 s_barrier
 ds_read_b128 v[56:59], v1 offset:10240
 ds_read_b128 v[60:63], v1 offset:11264
 ds_read_b128 v[16:19], v1 offset:13312
 ds_read_b128 v[12:15], v1 offset:14336
 ds_read_b128 v[48:51], v1 offset:15360
 s_waitcnt lgkmcnt(7)
 v_smfmac_f32_16x16x64_bf16 v[40:43], v[24:27], a[224:231], v0
 s_mov_b64 exec, s[68:69]
 buffer_store_dwordx4 v[20:23], v6, s[4:7], s62 offen offset:1024 sc1
 s_mov_b64 exec, -1
 v_smfmac_f32_16x16x64_bf16 v[44:47], v[24:27], a[232:239], v0
 ds_read_b128 v[24:27], v1 offset:8192
 s_waitcnt lgkmcnt(7)
 v_smfmac_f32_16x16x64_bf16 v[40:43], v[28:31], a[240:247], v0
 v_smfmac_f32_16x16x64_bf16 v[44:47], v[28:31], a[248:255], v0
 s_waitcnt lgkmcnt(6)
 v_smfmac_f32_16x16x64_bf16 v[40:43], v[52:55], v[64:71], v0
 v_smfmac_f32_16x16x64_bf16 v[44:47], v[52:55], v[72:79], v0
 s_waitcnt lgkmcnt(0)
 v_smfmac_f32_16x16x64_bf16 v[40:43], v[24:27], v[96:103], v0
 v_smfmac_f32_16x16x64_bf16 v[44:47], v[24:27], v[104:111], v0
 v_pk_add_f32 v[8:9], v[8:9], v[56:57]
 v_pk_add_f32 v[10:11], v[10:11], v[58:59]
 v_pk_add_f32 v[60:61], v[60:61], v[16:17]
 v_pk_add_f32 v[62:63], v[62:63], v[18:19]
 v_pk_add_f32 v[12:13], v[12:13], v[14:15]
 v_pk_add_f32 v[48:49], v[48:49], v[50:51]
 v_pk_add_f32 v[8:9], v[8:9], v[60:61]
 v_pk_add_f32 v[10:11], v[10:11], v[62:63]
 v_pk_add_f32 v[48:49], v[12:13], v[48:49]
 v_max3_f32 v50, v8, v9, v10
 v_max3_f32 v50, v50, v11, v48
 v_max_f32 v50, v50, v49
 v_add_f32 v40, v40, v42
 v_add_f32 v41, v41, v43
 v_max_f32_dpp v50, v50, v50 quad_perm:[2,3,0,1] row_mask:0xf bank_mask:0xf
 v_mov_b32 v51, v50
 v_add_f32 v44, v44, v46
 v_add_f32 v45, v45, v47
 v_permlane16_swap_b32 v50, v51
 v_max_f32 v50, v50, v51
 v_mov_b32 v51, v50
 v_cvt_pk_bf16_f32 v40, v40, v41
 v_cvt_pk_bf16_f32 v41, v44, v45
 v_permlane32_swap_b32 v50, v51
 v_max_f32 v50, v50, v51
 v_mul_f32 v50, s56, v50
 v_fma_f32 v48, v48, s56, -v50
 v_fma_f32 v49, v49, s56, -v50
 v_fma_f32 v8, v8, s56, -v50
 v_fma_f32 v9, v9, s56, -v50
 v_fma_f32 v10, v10, s56, -v50
 v_fma_f32 v11, v11, s56, -v50
 v_exp_f32 v48, v48
 v_lshrrev_b32 v51, 1, v1
 v_exp_f32 v49, v49
 ds_read_b128 v[56:59], v3 offset:32768
 ds_read_b128 v[60:63], v3 offset:33792
 v_exp_f32 v8, v8
 v_exp_f32 v9, v9
 ds_read_b128 v[24:27], v3 offset:4096
 ds_read_b128 v[28:31], v3 offset:5120
 v_exp_f32 v10, v10
 buffer_store_dwordx2 v[40:41], v51, s[4:7], s62 offen offset:3072 sc1
 v_exp_f32 v11, v11
 v_cvt_pk_bf16_f32 v14, v48, v49
 v_cvt_pk_bf16_f32 v12, v8, v9
 v_cvt_pk_bf16_f32 v13, v10, v11
 v_cndmask_b32 v52, 0, v14, s[68:69]
 v_cndmask_b32 v53, 0, v14, s[70:71]
 v_cndmask_b32 v22, 0, v12, s[70:71]
 v_cndmask_b32 v23, 0, v13, s[70:71]
 v_mfma_f32_16x16x16_bf16 v[44:47], v[40:41], v[52:53], 0
 v_cndmask_b32 v16, 0, v12, s[68:69]
 v_cndmask_b32 v17, 0, v13, s[68:69]
 v_mov_b32_dpp v18, v22 quad_perm:[2,3,0,1] row_mask:0xf bank_mask:0xf
 v_mov_b32_dpp v19, v23 quad_perm:[2,3,0,1] row_mask:0xf bank_mask:0xf
 v_mov_b32_dpp v20, v16 quad_perm:[2,3,0,1] row_mask:0xf bank_mask:0xf
 v_mov_b32_dpp v21, v17 quad_perm:[2,3,0,1] row_mask:0xf bank_mask:0xf
 s_waitcnt vmcnt(4)
 v_mfma_f32_16x16x32_bf16 v[44:47], v[32:35], v[16:19], v[44:47]
 v_add_f32 v54, v8, v9
 v_add_f32 v55, v48, v49
 s_waitcnt vmcnt(3)
 v_mfma_f32_16x16x32_bf16 v[44:47], v[36:39], v[20:23], v[44:47]
 v_add_f32 v54, v54, v10
 v_fma_f32 v55, v55, 0.5, v11
 v_add_f32 v54, v54, v55
 ds_read_b128 v[16:19], v3 offset:49152
 ds_read_b128 v[20:23], v3 offset:49152
 v_add_f32_dpp v54, v54, v54 quad_perm:[2,3,0,1] row_mask:0xf bank_mask:0xf
 v_mov_b32 v55, v54
 ds_read_b128 v[32:35], v3 offset:49152
 ds_read_b128 v[36:39], v3 offset:49152
 v_permlane16_swap_b32 v54, v55
 v_add_f32 v54, v54, v55
 v_mov_b32 v55, v54
 ds_read_b128 v[8:11], v3 offset:49152
 s_cmp_eq_u32 s54, 63
 v_permlane32_swap_b32 v54, v55
 v_add_f32 v54, v54, v55
 v_rcp_f32 v54, v54
 s_cbranch_scc1 L_ch2_end
 v_mul_f32 v44, v44, v54
 v_mul_f32 v45, v45, v54
 v_cvt_pk_bf16_f32 v42, v44, v45
 v_mul_f32 v46, v46, v54
 v_mul_f32 v47, v47, v54
 v_cvt_pk_bf16_f32 v43, v46, v47
 ds_write_b64 v6, v[42:43] offset:1024
 v_and_b32 v40, -9, v6
 v_mov_b32_dpp v12, v42 quad_perm:[0,1,0,1] row_mask:0xf bank_mask:0xf
 v_mov_b32_dpp v14, v42 quad_perm:[2,3,2,3] row_mask:0xf bank_mask:0xf
 v_mov_b32_dpp v13, v43 quad_perm:[0,1,0,1] row_mask:0xf bank_mask:0xf
 v_mov_b32_dpp v15, v43 quad_perm:[2,3,2,3] row_mask:0xf bank_mask:0xf
 s_waitcnt lgkmcnt(5)
 s_nop 0
 v_smfmac_f32_16x16x64_bf16 v[16:19], v[12:15], a[16:23], v0
 s_waitcnt lgkmcnt(4)
 v_smfmac_f32_16x16x64_bf16 v[20:23], v[12:15], a[48:55], v0
 s_waitcnt lgkmcnt(0)
 s_barrier
 ds_read_b128 v[48:51], v40 offset:0
 ds_read_b128 v[52:55], v40 offset:512
 ds_read_b128 v[44:47], v40 offset:1536
 v_smfmac_f32_16x16x64_bf16 v[32:35], v[12:15], v[56:63], v0
 ds_read_b128 v[56:59], v3 offset:38912
 ds_read_b128 v[60:63], v3 offset:39936
 s_mov_b32 m0, 4096
 v_smfmac_f32_16x16x64_bf16 v[36:39], v[12:15], v[24:31], v0
 ds_read_b128 v[24:27], v3 offset:36864
 ds_read_b128 v[28:31], v3 offset:37888
 buffer_load_dwordx4 v1, s[4:7], s81 offen offset:0 lds
 v_smfmac_f32_16x16x64_bf16 v[8:11], v[12:15], a[144:151], v0
 s_mov_b32 m0, 4096
 s_waitcnt lgkmcnt(6)
 v_smfmac_f32_16x16x64_bf16 v[16:19], v[48:51], a[0:7], v0
 buffer_load_dwordx4 v1, s[4:7], s81 offen offset:1024 lds
 s_waitcnt lgkmcnt(5)
 v_smfmac_f32_16x16x64_bf16 v[16:19], v[52:55], a[8:15], v0
 s_mov_b32 m0, 6144
 s_waitcnt lgkmcnt(2)
 v_smfmac_f32_16x16x64_bf16 v[16:19], v[44:47], v[56:63], v0
 ds_read_b128 v[56:59], v3 offset:34816
 ds_read_b128 v[60:63], v3 offset:35840
 buffer_load_dwordx4 v1, s[4:7], s81 offen offset:2048 lds
 s_waitcnt lgkmcnt(2)
 v_smfmac_f32_16x16x64_bf16 v[20:23], v[48:51], v[24:31], v0
 ds_read_b128 v[24:27], v3 offset:6144
 ds_read_b128 v[28:31], v3 offset:7168
 v_smfmac_f32_16x16x64_bf16 v[20:23], v[52:55], a[40:47], v0
 v_smfmac_f32_16x16x64_bf16 v[20:23], v[44:47], a[56:63], v0
 v_cvt_pk_bf16_f32 v16, v16, v17
 v_smfmac_f32_16x16x64_bf16 v[32:35], v[48:51], a[64:71], v0
 v_cvt_pk_bf16_f32 v17, v18, v19
 s_waitcnt lgkmcnt(2)
 v_smfmac_f32_16x16x64_bf16 v[32:35], v[52:55], v[56:63], v0
 ds_read_b128 v[56:59], v3 offset:2048
 ds_read_b128 v[60:63], v3 offset:3072
 v_and_or_b32 v16, v16, -2, s55
 s_waitcnt lgkmcnt(2)
 v_smfmac_f32_16x16x64_bf16 v[32:35], v[44:47], v[24:31], v0
 ds_read_b128 v[24:27], v3 offset:0
 ds_read_b128 v[28:31], v3 offset:1024
 v_cvt_pk_bf16_f32 v18, v20, v21
 v_smfmac_f32_16x16x64_bf16 v[36:39], v[48:51], a[96:103], v0
 v_cvt_pk_bf16_f32 v19, v22, v23
 v_smfmac_f32_16x16x64_bf16 v[36:39], v[52:55], a[104:111], v0
 v_and_or_b32 v18, v18, -2, s55
 buffer_store_dwordx4 v[16:19], v1, s[4:7], s60 offen offset:0
 v_smfmac_f32_16x16x64_bf16 v[36:39], v[44:47], a[120:127], v0
 v_cvt_pk_bf16_f32 v32, v32, v33
 s_waitcnt lgkmcnt(2)
 v_smfmac_f32_16x16x64_bf16 v[8:11], v[48:51], v[56:63], v0
 v_cvt_pk_bf16_f32 v33, v34, v35
 s_waitcnt lgkmcnt(0)
 v_smfmac_f32_16x16x64_bf16 v[8:11], v[52:55], v[24:31], v0
 v_and_or_b32 v32, v32, -2, s55
 v_smfmac_f32_16x16x64_bf16 v[8:11], v[44:47], a[152:159], v0
 v_cvt_pk_bf16_f32 v34, v36, v37
 v_cvt_pk_bf16_f32 v35, v38, v39
 v_and_or_b32 v34, v34, -2, s55
 buffer_store_dwordx4 v[32:35], v1, s[4:7], s60 offen offset:1024
 s_nop 3
 v_cvt_pk_bf16_f32 v8, v8, v9
 v_cvt_pk_bf16_f32 v9, v10, v11
 v_and_or_b32 v8, v8, -2, s55
 buffer_store_dwordx2 v[8:9], v1, s[4:7], s16 offen offset:0
 buffer_load_dwordx4 v[32:35], v1, s[4:7], s63 offen offset:2048
 buffer_load_dwordx4 v[36:39], v1, s[4:7], s63 offen offset:3072
 s_add_u32 s54, s54, 1
 s_add_u32 s61, s61, 524288
 s_and_b32 s3, s54, 3
 s_cselect_b32 s3, 1, -3
 s_lshl_b32 s3, s3, 17
 s_add_u32 s62, s62, s3
 s_and_b32 s3, s54, 3
 s_cselect_b32 s3, 1, -3
 s_lshl_b32 s3, s3, 14
 s_add_u32 s57, s57, s3
 s_add_u32 s59, s59, s3
 s_xor_b32 s58, s57, 32768
 v_lshrrev_b32 v56, 6, v1
 v_mul_u32_u24 v56, 10240, v56
 v_and_b32 v60, 48, v1
 v_add_u32 v56, v56, v60
 v_and_b32 v57, 32, v1
 v_and_b32 v60, 64, v1
 v_lshl_add_u32 v57, v60, 2, v57
 v_bfe_u32 v60, v1, 8, 1
 v_lshl_add_u32 v57, v60, 4, v57
 v_bfe_u32 v60, v1, 4, 1
 v_lshl_add_u32 v57, v60, 3, v57
 v_mov_b32 v60, 0x3f80
 v_mov_b32 v28, 0x3f800000
 v_cndmask_b32 v60, v60, v28, s[82:83]
 v_cndmask_b32 v28, 0, v60, s[72:73]
 v_cndmask_b32 v29, 0, v60, s[74:75]
 v_cndmask_b32 v30, 0, v60, s[76:77]
 v_cndmask_b32 v31, 0, v60, s[78:79]
 v_mov_b64 v[58:59], -1
 s_mov_b64 exec, s[84:85]
 buffer_store_dwordx2 v[58:59], v57, s[4:7], s58 offen
 s_mov_b64 exec, -1
 s_nop 15
 s_nop 15
 s_nop 15
 s_nop 15
 s_nop 15
 s_mov_b32 s51, 0
 buffer_load_dwordx4 v[8:11], v56, s[4:7], s64 offen sc1
 buffer_load_dwordx4 v[12:15], v56, s[4:7], s65 offen sc1
L_pp_196:
 s_waitcnt vmcnt(1)
 v_mfma_f32_16x16x32_bf16 v[24:27], v[28:31], v[8:11], 0
 v_bitop3_b32 v60, v8, v10, s55 bitop3:0x7e
 s_waitcnt vmcnt(0)
 v_mfma_f32_16x16x32_bf16 v[24:27], v[28:31], v[12:15], v[24:27]
 v_bitop3_b32 v61, v12, v14, s55 bitop3:0x7e
 v_bitop3_b32 v7, v60, v61, 1 bitop3:0xa8
 v_cmp_ne_u32 vcc, 0, v7
 s_cbranch_vccnz L_rt_197
 s_nop 3
 v_add_f32_dpp v24, v24, v24 row_ror:8 row_mask:0xf bank_mask:0xf
 v_add_f32_dpp v25, v25, v25 row_ror:8 row_mask:0xf bank_mask:0xf
 v_add_f32_dpp v26, v26, v26 row_ror:8 row_mask:0xf bank_mask:0xf
 v_add_f32_dpp v27, v27, v27 row_ror:8 row_mask:0xf bank_mask:0xf
 v_add_f32_dpp v24, v24, v24 row_ror:4 row_mask:0xf bank_mask:0xf
 v_add_f32_dpp v25, v25, v25 row_ror:4 row_mask:0xf bank_mask:0xf
 v_add_f32_dpp v26, v26, v26 row_ror:4 row_mask:0xf bank_mask:0xf
 v_add_f32_dpp v27, v27, v27 row_ror:4 row_mask:0xf bank_mask:0xf
 s_mov_b64 exec, s[84:85]
 v_cvt_pk_bf16_f32 v24, v24, v25
 v_cvt_pk_bf16_f32 v25, v26, v27
 buffer_store_dwordx2 v[24:25], v57, s[4:7], s57 offen
 s_mov_b64 exec, -1
 s_xor_b32 s55, s55, 1
 ds_read_b128 v[40:43], v1 offset:4096
 ds_read_b128 v[44:47], v1 offset:5120
 ds_read_b128 v[48:51], v1 offset:8192
 buffer_load_dwordx4 v[52:55], v1, s[4:7], s81 offen offset:3072
 buffer_load_dwordx4 v[56:59], v1, s[4:7], s101 offen offset:0
 buffer_load_dwordx4 v[60:63], v1, s[4:7], s101 offen offset:1024
 ds_read_b128 v[8:11], v3 offset:49152
 ds_read_b128 v[16:19], v3 offset:49152
 ds_read_b128 v[20:23], v3 offset:49152
 s_waitcnt lgkmcnt(0)
 s_nop 15
 s_nop 15
 s_nop 7
 s_branch L_ch2_f
L_rt_195:
 s_add_u32 s51, s51, 1
 s_cmp_lt_u32 s51, 131072
 s_cbranch_scc1 L_pm_194
 s_branch L_bail
L_rt_197:
 buffer_load_dwordx4 v[8:11], v56, s[4:7], s64 offen sc1
 buffer_load_dwordx4 v[12:15], v56, s[4:7], s65 offen sc1
 s_add_u32 s51, s51, 1
 s_cmp_lt_u32 s51, 131072
 s_cbranch_scc1 L_pp_196
 s_branch L_bail
.p2align 6
L_ch2_s:
 s_mov_b32 s51, 0
L_pm_198:
 buffer_load_dwordx4 v[24:27], v1, s[4:7], s59 offen offset:0 sc1
 buffer_load_dwordx4 v[28:31], v1, s[4:7], s59 offen offset:1024 sc1
 s_add_u32 s3, s59, 4096
 buffer_load_dwordx4 v[12:15], v1, s[4:7], s3 offen offset:0 sc1
 s_waitcnt vmcnt(2)
 ds_write_b128 v1, v[24:27] offset:4096
 v_max_u32 v7, v24, v26
 s_waitcnt vmcnt(1)
 ds_write_b128 v1, v[28:31] offset:5120
 v_max3_u32 v7, v7, v28, v30
 s_waitcnt vmcnt(0)
 ds_write_b128 v1, v[12:15] offset:8192
 v_max3_u32 v7, v7, v12, v14
 v_cmp_eq_u32 vcc, -1, v7
 s_cbranch_vccnz L_rt_199
 ds_read_b128 v[12:15], v3 offset:49152
 v_smfmac_f32_16x16x64_bf16 v[16:19], v[24:27], v[32:39], v0
 ds_read_b128 v[32:35], v1 offset:26624
 ds_read_b128 v[36:39], v1 offset:27648
 v_smfmac_f32_16x16x64_bf16 v[20:23], v[24:27], v[40:47], v0
 ds_read_b128 v[40:43], v1 offset:24576
 ds_read_b128 v[44:47], v1 offset:25600
 v_smfmac_f32_16x16x64_bf16 v[16:19], v[28:31], v[48:55], v0
 v_smfmac_f32_16x16x64_bf16 v[20:23], v[28:31], v[56:63], v0
 s_waitcnt lgkmcnt(5)
 s_barrier
 buffer_load_dwordx4 v[56:59], v1, s[4:7], s63 offen offset:0
 v_smfmac_f32_16x16x64_bf16 v[8:11], v[24:27], v[168:175], v0
 s_waitcnt lgkmcnt(4)
 v_smfmac_f32_16x16x64_bf16 v[12:15], v[24:27], v[160:167], v0
 ds_read_b128 v[24:27], v1 offset:8192
 buffer_load_dwordx4 v[60:63], v1, s[4:7], s63 offen offset:1024
 v_smfmac_f32_16x16x64_bf16 v[8:11], v[28:31], v[144:151], v0
 v_smfmac_f32_16x16x64_bf16 v[12:15], v[28:31], v[128:135], v0
 ds_read_b128 v[28:31], v1 offset:0
 buffer_load_dwordx4 v[48:51], v1, s[4:7], s101 offen offset:2048
 s_waitcnt lgkmcnt(1)
 v_smfmac_f32_16x16x64_bf16 v[16:19], v[24:27], v[32:39], v0
 ds_read_b128 v[32:35], v2 offset:22528
 ds_read_b128 v[36:39], v2 offset:23552
 v_smfmac_f32_16x16x64_bf16 v[8:11], v[24:27], a[80:87], v0
 buffer_load_dwordx4 v[52:55], v1, s[4:7], s101 offen offset:3072
 v_smfmac_f32_16x16x64_bf16 v[12:15], v[24:27], a[72:79], v0
 v_smfmac_f32_16x16x64_bf16 v[20:23], v[24:27], v[40:47], v0
 ds_read_b128 v[40:43], v2 offset:20480
 ds_read_b128 v[44:47], v2 offset:21504
 ds_read_b128 v[24:27], v1 offset:1024
 s_waitcnt lgkmcnt(5)
 v_smfmac_f32_16x16x64_bf16 v[8:11], v[28:31], v[240:247], v0
 v_smfmac_f32_16x16x64_bf16 v[12:15], v[28:31], v[248:255], v0
 s_waitcnt lgkmcnt(3)
 v_smfmac_f32_16x16x64_bf16 v[16:19], v[28:31], v[32:39], v0
 ds_read_b128 v[32:35], v2 offset:18432
 ds_read_b128 v[36:39], v2 offset:19456
 v_smfmac_f32_16x16x64_bf16 v[20:23], v[28:31], v[136:143], v0
 ds_read_b128 v[28:31], v1 offset:2048
 s_waitcnt lgkmcnt(3)
 v_smfmac_f32_16x16x64_bf16 v[8:11], v[24:27], v[224:231], v0
 v_smfmac_f32_16x16x64_bf16 v[16:19], v[24:27], v[40:47], v0
 ds_read_b128 v[40:43], v2 offset:16384
 ds_read_b128 v[44:47], v2 offset:17408
 v_smfmac_f32_16x16x64_bf16 v[12:15], v[24:27], v[216:223], v0
 v_smfmac_f32_16x16x64_bf16 v[20:23], v[24:27], v[152:159], v0
 ds_read_b128 v[24:27], v1 offset:3072
 s_waitcnt lgkmcnt(3)
 v_smfmac_f32_16x16x64_bf16 v[16:19], v[28:31], v[32:39], v0
 ds_read_b128 v[32:35], v1 offset:55296
 ds_read_b128 v[36:39], v1 offset:56320
 v_smfmac_f32_16x16x64_bf16 v[8:11], v[28:31], v[208:215], v0
 v_smfmac_f32_16x16x64_bf16 v[12:15], v[28:31], v[200:207], v0
 s_waitcnt lgkmcnt(3)
 v_smfmac_f32_16x16x64_bf16 v[20:23], v[28:31], v[40:47], v0
 ds_read_b128 v[40:43], v1 offset:53248
 ds_read_b128 v[44:47], v1 offset:54272
 ds_read_b128 v[28:31], v1 offset:6144
 s_waitcnt lgkmcnt(5)
 v_smfmac_f32_16x16x64_bf16 v[8:11], v[24:27], v[184:191], v0
 v_smfmac_f32_16x16x64_bf16 v[12:15], v[24:27], v[176:183], v0
 s_waitcnt lgkmcnt(3)
 v_smfmac_f32_16x16x64_bf16 v[16:19], v[24:27], v[32:39], v0
 ds_read_b128 v[32:35], v1 offset:51200
 ds_read_b128 v[36:39], v1 offset:52224
 s_waitcnt vmcnt(2)
 v_smfmac_f32_16x16x64_bf16 v[20:23], v[24:27], v[56:63], v0
 ds_read_b128 v[24:27], v1 offset:7168
 buffer_load_dwordx4 v[56:59], v1, s[4:7], s61 offen offset:2048 sc1 nt
 s_waitcnt lgkmcnt(3)
 v_smfmac_f32_16x16x64_bf16 v[8:11], v[28:31], a[136:143], v0
 v_smfmac_f32_16x16x64_bf16 v[16:19], v[28:31], v[40:47], v0
 ds_read_b128 v[40:43], v1 offset:49152
 ds_read_b128 v[44:47], v1 offset:50176
 s_add_u32 s3, s61, 4096
 buffer_load_dwordx4 v[60:63], v1, s[4:7], s3 offen offset:2048 sc1 nt
 v_smfmac_f32_16x16x64_bf16 v[12:15], v[28:31], a[128:135], v0
 v_smfmac_f32_16x16x64_bf16 v[20:23], v[28:31], v[192:199], v0
 ds_read_b128 v[28:31], v1 offset:9216
 s_waitcnt lgkmcnt(3)
 v_smfmac_f32_16x16x64_bf16 v[16:19], v[24:27], v[32:39], v0
 v_smfmac_f32_16x16x64_bf16 v[8:11], v[24:27], a[112:119], v0
 s_add_u32 s3, s61, 67112960
 buffer_load_dwordx4 v[32:35], v1, s[4:7], s3 offen offset:0 sc1 nt
 v_smfmac_f32_16x16x64_bf16 v[12:15], v[24:27], a[88:95], v0
 s_waitcnt lgkmcnt(1)
 v_smfmac_f32_16x16x64_bf16 v[20:23], v[24:27], v[40:47], v0
 ds_read_b128 v[40:43], v3 offset:49152
 ds_read_b128 v[44:47], v3 offset:49152
 buffer_load_dwordx4 v[36:39], v1, s[4:7], s3 offen offset:1024 sc1 nt
 s_waitcnt lgkmcnt(2)
 v_smfmac_f32_16x16x64_bf16 v[8:11], v[28:31], a[32:39], v0
 v_smfmac_f32_16x16x64_bf16 v[12:15], v[28:31], a[24:31], v0
 v_lshlrev_b32 v7, 3, v1
 v_smfmac_f32_16x16x64_bf16 v[16:19], v[28:31], v[232:239], v0
 s_waitcnt vmcnt(4)
 v_smfmac_f32_16x16x64_bf16 v[20:23], v[28:31], v[48:55], v0
 s_add_u32 s3, s61, 67633152
 buffer_load_dword v7, v7, s[4:7], s3 offen sc1
 ds_read_b128 v[52:55], v1 offset:0
 v_add_f32 v8, v8, v10
 v_add_f32 v11, v9, v11
 v_cvt_pk_bf16_f32 v9, v8, v11
 v_cvt_pk_bf16_f32 v8, v8, v11
 v_add_f32 v12, v12, v14
 v_add_f32 v15, v13, v15
 v_cvt_pk_bf16_f32 v13, v12, v15
 v_cvt_pk_bf16_f32 v12, v12, v15
 v_mfma_f32_16x16x16_bf16 v[8:11], v[8:9], v[4:5], 0
 v_mfma_f32_16x16x16_bf16 v[12:15], v[12:13], v[4:5], 0
 v_add_f32 v16, v16, v18
 v_add_f32 v19, v17, v19
 v_cvt_pk_bf16_f32 v17, v16, v19
 v_cvt_pk_bf16_f32 v16, v16, v19
 v_add_f32 v20, v20, v22
 v_add_f32 v23, v21, v23
 v_cvt_pk_bf16_f32 v21, v20, v23
 v_cvt_pk_bf16_f32 v20, v20, v23
 v_mfma_f32_16x16x16_bf16 v[16:19], v[16:17], v[4:5], 0
 v_mfma_f32_16x16x16_bf16 v[20:23], v[20:21], v[4:5], 0
 s_waitcnt lgkmcnt(2)
 v_smfmac_f32_16x16x64_bf16 v[40:43], v[24:27], v[80:87], v0
 s_waitcnt lgkmcnt(1)
 v_smfmac_f32_16x16x64_bf16 v[44:47], v[24:27], v[88:95], v0
 ds_read_b128 v[24:27], v1 offset:1024
 v_cvt_pk_bf16_f32 v15, v14, v15
 v_cvt_pk_bf16_f32 v14, v12, v13
 v_cvt_pk_bf16_f32 v13, v10, v11
 v_cvt_pk_bf16_f32 v12, v8, v9
 s_waitcnt vmcnt(4)
 s_nop 0
 v_mfma_f32_16x16x32_bf16 v[8:11], v[56:59], v[12:15], 0
 v_cvt_pk_bf16_f32 v23, v22, v23
 v_cvt_pk_bf16_f32 v22, v20, v21
 v_cvt_pk_bf16_f32 v21, v18, v19
 v_cvt_pk_bf16_f32 v20, v16, v17
 s_waitcnt vmcnt(3)
 v_mfma_f32_16x16x32_bf16 v[16:19], v[60:63], v[12:15], 0
 v_mfma_f32_16x16x32_bf16 v[48:51], v[20:23], v[12:15], 0
 v_smfmac_f32_16x16x64_bf16 v[40:43], v[28:31], v[112:119], v0
 v_smfmac_f32_16x16x64_bf16 v[44:47], v[28:31], v[120:127], v0
 ds_read_b128 v[28:31], v1 offset:2048
 s_waitcnt lgkmcnt(2)
 v_smfmac_f32_16x16x64_bf16 v[40:43], v[52:55], a[160:167], v0
 v_cndmask_b32 v8, v8, v16, s[70:71]
 v_cndmask_b32 v9, v9, v17, s[70:71]
 v_cndmask_b32 v10, v10, v18, s[70:71]
 v_cndmask_b32 v11, v11, v19, s[70:71]
 ds_write_b128 v1, v[8:11] offset:12288
 ds_write_b64 v1, v[48:49] offset:15360
 v_smfmac_f32_16x16x64_bf16 v[44:47], v[52:55], a[168:175], v0
 ds_read_b128 v[52:55], v1 offset:3072
 s_waitcnt lgkmcnt(4)
 v_smfmac_f32_16x16x64_bf16 v[40:43], v[24:27], a[176:183], v0
 v_smfmac_f32_16x16x64_bf16 v[44:47], v[24:27], a[184:191], v0
 ds_read_b128 v[24:27], v1 offset:4096
 s_waitcnt lgkmcnt(4)
 v_smfmac_f32_16x16x64_bf16 v[40:43], v[28:31], a[192:199], v0
 v_smfmac_f32_16x16x64_bf16 v[44:47], v[28:31], a[200:207], v0
 ds_read_b128 v[28:31], v1 offset:5120
 s_waitcnt lgkmcnt(2)
 v_smfmac_f32_16x16x64_bf16 v[40:43], v[52:55], a[208:215], v0
 v_smfmac_f32_16x16x64_bf16 v[44:47], v[52:55], a[216:223], v0
 ds_read_b128 v[52:55], v1 offset:6144
 s_barrier
 ds_read_b128 v[56:59], v1 offset:10240
 ds_read_b128 v[60:63], v1 offset:11264
 ds_read_b128 v[16:19], v1 offset:13312
 ds_read_b128 v[12:15], v1 offset:14336
 ds_read_b128 v[48:51], v1 offset:15360
 s_waitcnt lgkmcnt(7)
 v_smfmac_f32_16x16x64_bf16 v[40:43], v[24:27], a[224:231], v0
 s_mov_b64 exec, s[68:69]
 buffer_store_dwordx4 v[20:23], v6, s[4:7], s62 offen offset:1024 sc1
 s_mov_b64 exec, -1
 v_smfmac_f32_16x16x64_bf16 v[44:47], v[24:27], a[232:239], v0
 ds_read_b128 v[24:27], v1 offset:8192
 s_waitcnt lgkmcnt(7)
 v_smfmac_f32_16x16x64_bf16 v[40:43], v[28:31], a[240:247], v0
 v_smfmac_f32_16x16x64_bf16 v[44:47], v[28:31], a[248:255], v0
 s_waitcnt lgkmcnt(6)
 v_smfmac_f32_16x16x64_bf16 v[40:43], v[52:55], v[64:71], v0
 v_smfmac_f32_16x16x64_bf16 v[44:47], v[52:55], v[72:79], v0
 s_waitcnt lgkmcnt(0)
 v_smfmac_f32_16x16x64_bf16 v[40:43], v[24:27], v[96:103], v0
 v_smfmac_f32_16x16x64_bf16 v[44:47], v[24:27], v[104:111], v0
 v_pk_add_f32 v[8:9], v[8:9], v[56:57]
 v_pk_add_f32 v[10:11], v[10:11], v[58:59]
 v_pk_add_f32 v[60:61], v[60:61], v[16:17]
 v_pk_add_f32 v[62:63], v[62:63], v[18:19]
 v_pk_add_f32 v[12:13], v[12:13], v[14:15]
 v_pk_add_f32 v[48:49], v[48:49], v[50:51]
 v_pk_add_f32 v[8:9], v[8:9], v[60:61]
 v_pk_add_f32 v[10:11], v[10:11], v[62:63]
 v_pk_add_f32 v[48:49], v[12:13], v[48:49]
 v_max3_f32 v50, v8, v9, v10
 v_max3_f32 v50, v50, v11, v48
 v_max_f32 v50, v50, v49
 v_add_f32 v40, v40, v42
 v_add_f32 v41, v41, v43
 v_max_f32_dpp v50, v50, v50 quad_perm:[2,3,0,1] row_mask:0xf bank_mask:0xf
 v_mov_b32 v51, v50
 v_add_f32 v44, v44, v46
 v_add_f32 v45, v45, v47
 v_permlane16_swap_b32 v50, v51
 v_max_f32 v50, v50, v51
 v_mov_b32 v51, v50
 v_cvt_pk_bf16_f32 v40, v40, v41
 v_cvt_pk_bf16_f32 v41, v44, v45
 v_permlane32_swap_b32 v50, v51
 v_max_f32 v50, v50, v51
 v_mul_f32 v50, s56, v50
 v_fma_f32 v48, v48, s56, -v50
 v_fma_f32 v49, v49, s56, -v50
 v_fma_f32 v8, v8, s56, -v50
 v_fma_f32 v9, v9, s56, -v50
 v_fma_f32 v10, v10, s56, -v50
 v_fma_f32 v11, v11, s56, -v50
 v_exp_f32 v48, v48
 v_lshrrev_b32 v51, 1, v1
 v_exp_f32 v49, v49
 ds_read_b128 v[56:59], v3 offset:32768
 ds_read_b128 v[60:63], v3 offset:33792
 v_exp_f32 v8, v8
 v_exp_f32 v9, v9
 ds_read_b128 v[24:27], v3 offset:4096
 ds_read_b128 v[28:31], v3 offset:5120
 v_exp_f32 v10, v10
 buffer_store_dwordx2 v[40:41], v51, s[4:7], s62 offen offset:3072 sc1
 v_exp_f32 v11, v11
 v_cvt_pk_bf16_f32 v14, v48, v49
 v_cvt_pk_bf16_f32 v12, v8, v9
 v_cvt_pk_bf16_f32 v13, v10, v11
 v_cndmask_b32 v52, 0, v14, s[68:69]
 v_cndmask_b32 v53, 0, v14, s[70:71]
 v_cndmask_b32 v22, 0, v12, s[70:71]
 v_cndmask_b32 v23, 0, v13, s[70:71]
 v_mfma_f32_16x16x16_bf16 v[44:47], v[40:41], v[52:53], 0
 v_cndmask_b32 v16, 0, v12, s[68:69]
 v_cndmask_b32 v17, 0, v13, s[68:69]
 v_mov_b32_dpp v18, v22 quad_perm:[2,3,0,1] row_mask:0xf bank_mask:0xf
 v_mov_b32_dpp v19, v23 quad_perm:[2,3,0,1] row_mask:0xf bank_mask:0xf
 v_mov_b32_dpp v20, v16 quad_perm:[2,3,0,1] row_mask:0xf bank_mask:0xf
 v_mov_b32_dpp v21, v17 quad_perm:[2,3,0,1] row_mask:0xf bank_mask:0xf
 s_waitcnt vmcnt(4)
 v_mfma_f32_16x16x32_bf16 v[44:47], v[32:35], v[16:19], v[44:47]
 v_add_f32 v54, v8, v9
 v_add_f32 v55, v48, v49
 s_waitcnt vmcnt(3)
 v_mfma_f32_16x16x32_bf16 v[44:47], v[36:39], v[20:23], v[44:47]
 v_add_f32 v54, v54, v10
 v_fma_f32 v55, v55, 0.5, v11
 v_add_f32 v54, v54, v55
 ds_read_b128 v[16:19], v3 offset:49152
 ds_read_b128 v[20:23], v3 offset:49152
 v_add_f32_dpp v54, v54, v54 quad_perm:[2,3,0,1] row_mask:0xf bank_mask:0xf
 v_mov_b32 v55, v54
 ds_read_b128 v[32:35], v3 offset:49152
 ds_read_b128 v[36:39], v3 offset:49152
 v_permlane16_swap_b32 v54, v55
 v_add_f32 v54, v54, v55
 v_mov_b32 v55, v54
 ds_read_b128 v[8:11], v3 offset:49152
 s_cmp_eq_u32 s54, 63
 v_permlane32_swap_b32 v54, v55
 v_add_f32 v54, v54, v55
 v_rcp_f32 v54, v54
 s_cbranch_scc1 L_ch2_end
 v_mul_f32 v44, v44, v54
 v_mul_f32 v45, v45, v54
 v_cvt_pk_bf16_f32 v42, v44, v45
 v_mul_f32 v46, v46, v54
 v_mul_f32 v47, v47, v54
 v_cvt_pk_bf16_f32 v43, v46, v47
 ds_write_b64 v6, v[42:43] offset:1024
 v_and_b32 v40, -9, v6
 v_mov_b32_dpp v12, v42 quad_perm:[0,1,0,1] row_mask:0xf bank_mask:0xf
 v_mov_b32_dpp v14, v42 quad_perm:[2,3,2,3] row_mask:0xf bank_mask:0xf
 v_mov_b32_dpp v13, v43 quad_perm:[0,1,0,1] row_mask:0xf bank_mask:0xf
 v_mov_b32_dpp v15, v43 quad_perm:[2,3,2,3] row_mask:0xf bank_mask:0xf
 s_waitcnt lgkmcnt(5)
 s_nop 0
 v_smfmac_f32_16x16x64_bf16 v[16:19], v[12:15], a[16:23], v0
 s_waitcnt lgkmcnt(4)
 v_smfmac_f32_16x16x64_bf16 v[20:23], v[12:15], a[48:55], v0
 s_waitcnt lgkmcnt(0)
 s_barrier
 ds_read_b128 v[48:51], v40 offset:0
 ds_read_b128 v[52:55], v40 offset:512
 ds_read_b128 v[44:47], v40 offset:1536
 v_smfmac_f32_16x16x64_bf16 v[32:35], v[12:15], v[56:63], v0
 ds_read_b128 v[56:59], v3 offset:38912
 ds_read_b128 v[60:63], v3 offset:39936
 s_mov_b32 m0, 4096
 v_smfmac_f32_16x16x64_bf16 v[36:39], v[12:15], v[24:31], v0
 ds_read_b128 v[24:27], v3 offset:36864
 ds_read_b128 v[28:31], v3 offset:37888
 buffer_load_dwordx4 v1, s[4:7], s81 offen offset:0 lds
 v_smfmac_f32_16x16x64_bf16 v[8:11], v[12:15], a[144:151], v0
 s_mov_b32 m0, 4096
 s_waitcnt lgkmcnt(6)
 v_smfmac_f32_16x16x64_bf16 v[16:19], v[48:51], a[0:7], v0
 buffer_load_dwordx4 v1, s[4:7], s81 offen offset:1024 lds
 s_waitcnt lgkmcnt(5)
 v_smfmac_f32_16x16x64_bf16 v[16:19], v[52:55], a[8:15], v0
 s_mov_b32 m0, 6144
 s_waitcnt lgkmcnt(2)
 v_smfmac_f32_16x16x64_bf16 v[16:19], v[44:47], v[56:63], v0
 ds_read_b128 v[56:59], v3 offset:34816
 ds_read_b128 v[60:63], v3 offset:35840
 buffer_load_dwordx4 v1, s[4:7], s81 offen offset:2048 lds
 s_waitcnt lgkmcnt(2)
 v_smfmac_f32_16x16x64_bf16 v[20:23], v[48:51], v[24:31], v0
 ds_read_b128 v[24:27], v3 offset:6144
 ds_read_b128 v[28:31], v3 offset:7168
 v_smfmac_f32_16x16x64_bf16 v[20:23], v[52:55], a[40:47], v0
 v_smfmac_f32_16x16x64_bf16 v[20:23], v[44:47], a[56:63], v0
 v_cvt_pk_bf16_f32 v16, v16, v17
 v_smfmac_f32_16x16x64_bf16 v[32:35], v[48:51], a[64:71], v0
 v_cvt_pk_bf16_f32 v17, v18, v19
 s_waitcnt lgkmcnt(2)
 v_smfmac_f32_16x16x64_bf16 v[32:35], v[52:55], v[56:63], v0
 ds_read_b128 v[56:59], v3 offset:2048
 ds_read_b128 v[60:63], v3 offset:3072
 v_and_or_b32 v16, v16, -2, s55
 s_waitcnt lgkmcnt(2)
 v_smfmac_f32_16x16x64_bf16 v[32:35], v[44:47], v[24:31], v0
 ds_read_b128 v[24:27], v3 offset:0
 ds_read_b128 v[28:31], v3 offset:1024
 v_cvt_pk_bf16_f32 v18, v20, v21
 v_smfmac_f32_16x16x64_bf16 v[36:39], v[48:51], a[96:103], v0
 v_cvt_pk_bf16_f32 v19, v22, v23
 v_smfmac_f32_16x16x64_bf16 v[36:39], v[52:55], a[104:111], v0
 v_and_or_b32 v18, v18, -2, s55
 buffer_store_dwordx4 v[16:19], v1, s[4:7], s60 offen offset:0 sc1
 v_smfmac_f32_16x16x64_bf16 v[36:39], v[44:47], a[120:127], v0
 v_cvt_pk_bf16_f32 v32, v32, v33
 s_waitcnt lgkmcnt(2)
 v_smfmac_f32_16x16x64_bf16 v[8:11], v[48:51], v[56:63], v0
 v_cvt_pk_bf16_f32 v33, v34, v35
 s_waitcnt lgkmcnt(0)
 v_smfmac_f32_16x16x64_bf16 v[8:11], v[52:55], v[24:31], v0
 v_and_or_b32 v32, v32, -2, s55
 v_smfmac_f32_16x16x64_bf16 v[8:11], v[44:47], a[152:159], v0
 v_cvt_pk_bf16_f32 v34, v36, v37
 v_cvt_pk_bf16_f32 v35, v38, v39
 v_and_or_b32 v34, v34, -2, s55
 buffer_store_dwordx4 v[32:35], v1, s[4:7], s60 offen offset:1024 sc1
 s_nop 3
 v_cvt_pk_bf16_f32 v8, v8, v9
 v_cvt_pk_bf16_f32 v9, v10, v11
 v_and_or_b32 v8, v8, -2, s55
 buffer_store_dwordx2 v[8:9], v1, s[4:7], s16 offen offset:0 sc1
 buffer_load_dwordx4 v[32:35], v1, s[4:7], s63 offen offset:2048
 buffer_load_dwordx4 v[36:39], v1, s[4:7], s63 offen offset:3072
 s_add_u32 s54, s54, 1
 s_add_u32 s61, s61, 524288
 s_and_b32 s3, s54, 3
 s_cselect_b32 s3, 1, -3
 s_lshl_b32 s3, s3, 17
 s_add_u32 s62, s62, s3
 s_and_b32 s3, s54, 3
 s_cselect_b32 s3, 1, -3
 s_lshl_b32 s3, s3, 14
 s_add_u32 s57, s57, s3
 s_add_u32 s59, s59, s3
 s_xor_b32 s58, s57, 32768
 v_lshrrev_b32 v56, 6, v1
 v_mul_u32_u24 v56, 10240, v56
 v_and_b32 v60, 48, v1
 v_add_u32 v56, v56, v60
 v_and_b32 v57, 32, v1
 v_and_b32 v60, 64, v1
 v_lshl_add_u32 v57, v60, 2, v57
 v_bfe_u32 v60, v1, 8, 1
 v_lshl_add_u32 v57, v60, 4, v57
 v_bfe_u32 v60, v1, 4, 1
 v_lshl_add_u32 v57, v60, 3, v57
 v_mov_b32 v60, 0x3f80
 v_mov_b32 v28, 0x3f800000
 v_cndmask_b32 v60, v60, v28, s[82:83]
 v_cndmask_b32 v28, 0, v60, s[72:73]
 v_cndmask_b32 v29, 0, v60, s[74:75]
 v_cndmask_b32 v30, 0, v60, s[76:77]
 v_cndmask_b32 v31, 0, v60, s[78:79]
 v_mov_b64 v[58:59], -1
 s_mov_b64 exec, s[84:85]
 buffer_store_dwordx2 v[58:59], v57, s[4:7], s58 offen sc1
 s_mov_b64 exec, -1
 s_nop 15
 s_nop 15
 s_nop 15
 s_nop 15
 s_nop 15
 s_mov_b32 s51, 0
 buffer_load_dwordx4 v[8:11], v56, s[4:7], s64 offen sc1
 buffer_load_dwordx4 v[12:15], v56, s[4:7], s65 offen sc1
L_pp_200:
 s_waitcnt vmcnt(1)
 v_mfma_f32_16x16x32_bf16 v[24:27], v[28:31], v[8:11], 0
 v_bitop3_b32 v60, v8, v10, s55 bitop3:0x7e
 s_waitcnt vmcnt(0)
 v_mfma_f32_16x16x32_bf16 v[24:27], v[28:31], v[12:15], v[24:27]
 v_bitop3_b32 v61, v12, v14, s55 bitop3:0x7e
 v_bitop3_b32 v7, v60, v61, 1 bitop3:0xa8
 v_cmp_ne_u32 vcc, 0, v7
 s_cbranch_vccnz L_rt_201
 s_nop 3
 v_add_f32_dpp v24, v24, v24 row_ror:8 row_mask:0xf bank_mask:0xf
 v_add_f32_dpp v25, v25, v25 row_ror:8 row_mask:0xf bank_mask:0xf
 v_add_f32_dpp v26, v26, v26 row_ror:8 row_mask:0xf bank_mask:0xf
 v_add_f32_dpp v27, v27, v27 row_ror:8 row_mask:0xf bank_mask:0xf
 v_add_f32_dpp v24, v24, v24 row_ror:4 row_mask:0xf bank_mask:0xf
 v_add_f32_dpp v25, v25, v25 row_ror:4 row_mask:0xf bank_mask:0xf
 v_add_f32_dpp v26, v26, v26 row_ror:4 row_mask:0xf bank_mask:0xf
 v_add_f32_dpp v27, v27, v27 row_ror:4 row_mask:0xf bank_mask:0xf
 s_mov_b64 exec, s[84:85]
 v_cvt_pk_bf16_f32 v24, v24, v25
 v_cvt_pk_bf16_f32 v25, v26, v27
 buffer_store_dwordx2 v[24:25], v57, s[4:7], s57 offen sc1
 s_mov_b64 exec, -1
 s_xor_b32 s55, s55, 1
 ds_read_b128 v[40:43], v1 offset:4096
 ds_read_b128 v[44:47], v1 offset:5120
 ds_read_b128 v[48:51], v1 offset:8192
 buffer_load_dwordx4 v[52:55], v1, s[4:7], s81 offen offset:3072
 buffer_load_dwordx4 v[56:59], v1, s[4:7], s101 offen offset:0
 buffer_load_dwordx4 v[60:63], v1, s[4:7], s101 offen offset:1024
 ds_read_b128 v[8:11], v3 offset:49152
 ds_read_b128 v[16:19], v3 offset:49152
 ds_read_b128 v[20:23], v3 offset:49152
 s_waitcnt lgkmcnt(0)
 s_nop 15
 s_nop 15
 s_nop 7
 s_branch L_ch2_s
L_rt_199:
 s_add_u32 s51, s51, 1
 s_cmp_lt_u32 s51, 131072
 s_cbranch_scc1 L_pm_198
 s_branch L_bail
L_rt_201:
 buffer_load_dwordx4 v[8:11], v56, s[4:7], s64 offen sc1
 buffer_load_dwordx4 v[12:15], v56, s[4:7], s65 offen sc1
 s_add_u32 s51, s51, 1
 s_cmp_lt_u32 s51, 131072
 s_cbranch_scc1 L_pp_200
 s_branch L_bail
L_ch2_end:
 s_waitcnt vmcnt(0)
 s_endpgm
L_ch3:
 v_lshrrev_b32 v8, 4, v0
 s_mov_b32 s3, 1280
 v_mul_lo_u32 v8, v8, s3
 v_lshrrev_b32 v7, 3, v0
 v_and_b32 v7, 6, v7
 v_xor_b32 v7, v7, v0
 v_and_b32 v7, 15, v7
 v_lshl_add_u32 v8, v7, 4, v8
 v_xor_b32 v9, 128, v8
 v_lshrrev_b32 v10, 4, v0
 s_mov_b32 s3, 8192
 v_mul_lo_u32 v10, v10, s3
 v_lshrrev_b32 v7, 3, v0
 v_and_b32 v7, 6, v7
 v_xor_b32 v7, v7, v0
 v_and_b32 v7, 15, v7
 v_lshl_add_u32 v10, v7, 4, v10
 v_xor_b32 v11, 128, v10
 s_mov_b32 s8, s26
 s_and_b32 s9, s27, 0xffff
 s_mov_b32 s10, 5242880
 s_mul_i32 s14, s52, 163840
 s_add_u32 s14, s14, 122880
 s_mov_b32 m0, 24576
 s_nop 0
 buffer_load_dwordx4 v8, s[8:11], s14 offen lds
 s_add_u32 s14, s14, 5120
 s_mov_b32 m0, 25600
 s_nop 0
 buffer_load_dwordx4 v8, s[8:11], s14 offen lds
 s_add_u32 s14, s14, 5120
 s_mov_b32 m0, 26624
 s_nop 0
 buffer_load_dwordx4 v8, s[8:11], s14 offen lds
 s_add_u32 s14, s14, 5120
 s_mov_b32 m0, 27648
 s_nop 0
 buffer_load_dwordx4 v8, s[8:11], s14 offen lds
 s_add_u32 s14, s14, 5120
 s_mov_b32 m0, 28672
 s_nop 0
 buffer_load_dwordx4 v9, s[8:11], s14 offen lds
 s_add_u32 s14, s14, 5120
 s_mov_b32 m0, 29696
 s_nop 0
 buffer_load_dwordx4 v9, s[8:11], s14 offen lds
 s_add_u32 s14, s14, 5120
 s_mov_b32 m0, 30720
 s_nop 0
 buffer_load_dwordx4 v9, s[8:11], s14 offen lds
 s_add_u32 s14, s14, 5120
 s_mov_b32 m0, 31744
 s_nop 0
 buffer_load_dwordx4 v9, s[8:11], s14 offen lds
 s_mul_i32 s14, s52, 163840
 s_add_u32 s14, s14, 123136
 s_mov_b32 m0, 57344
 s_nop 0
 buffer_load_dwordx4 v8, s[8:11], s14 offen lds
 s_add_u32 s14, s14, 5120
 s_mov_b32 m0, 58368
 s_nop 0
 buffer_load_dwordx4 v8, s[8:11], s14 offen lds
 s_add_u32 s14, s14, 5120
 s_mov_b32 m0, 59392
 s_nop 0
 buffer_load_dwordx4 v8, s[8:11], s14 offen lds
 s_add_u32 s14, s14, 5120
 s_mov_b32 m0, 60416
 s_nop 0
 buffer_load_dwordx4 v8, s[8:11], s14 offen lds
 s_add_u32 s14, s14, 5120
 s_mov_b32 m0, 61440
 s_nop 0
 buffer_load_dwordx4 v9, s[8:11], s14 offen lds
 s_add_u32 s14, s14, 5120
 s_mov_b32 m0, 62464
 s_nop 0
 buffer_load_dwordx4 v9, s[8:11], s14 offen lds
 s_add_u32 s14, s14, 5120
 s_mov_b32 m0, 63488
 s_nop 0
 buffer_load_dwordx4 v9, s[8:11], s14 offen lds
 s_add_u32 s14, s14, 5120
 s_mov_b32 m0, 64512
 s_nop 0
 buffer_load_dwordx4 v9, s[8:11], s14 offen lds
 s_mul_i32 s14, s52, 163840
 s_add_u32 s14, s14, 123392
 s_mov_b32 m0, 90112
 s_nop 0
 buffer_load_dwordx4 v8, s[8:11], s14 offen lds
 s_add_u32 s14, s14, 5120
 s_mov_b32 m0, 91136
 s_nop 0
 buffer_load_dwordx4 v8, s[8:11], s14 offen lds
 s_add_u32 s14, s14, 5120
 s_mov_b32 m0, 92160
 s_nop 0
 buffer_load_dwordx4 v8, s[8:11], s14 offen lds
 s_add_u32 s14, s14, 5120
 s_mov_b32 m0, 93184
 s_nop 0
 buffer_load_dwordx4 v8, s[8:11], s14 offen lds
 s_add_u32 s14, s14, 5120
 s_mov_b32 m0, 94208
 s_nop 0
 buffer_load_dwordx4 v9, s[8:11], s14 offen lds
 s_add_u32 s14, s14, 5120
 s_mov_b32 m0, 95232
 s_nop 0
 buffer_load_dwordx4 v9, s[8:11], s14 offen lds
 s_add_u32 s14, s14, 5120
 s_mov_b32 m0, 96256
 s_nop 0
 buffer_load_dwordx4 v9, s[8:11], s14 offen lds
 s_add_u32 s14, s14, 5120
 s_mov_b32 m0, 97280
 s_nop 0
 buffer_load_dwordx4 v9, s[8:11], s14 offen lds
 s_mul_i32 s14, s52, 163840
 s_add_u32 s14, s14, 123648
 s_mov_b32 m0, 122880
 s_nop 0
 buffer_load_dwordx4 v8, s[8:11], s14 offen lds
 s_add_u32 s14, s14, 5120
 s_mov_b32 m0, 123904
 s_nop 0
 buffer_load_dwordx4 v8, s[8:11], s14 offen lds
 s_add_u32 s14, s14, 5120
 s_mov_b32 m0, 124928
 s_nop 0
 buffer_load_dwordx4 v8, s[8:11], s14 offen lds
 s_add_u32 s14, s14, 5120
 s_mov_b32 m0, 125952
 s_nop 0
 buffer_load_dwordx4 v8, s[8:11], s14 offen lds
 s_add_u32 s14, s14, 5120
 s_mov_b32 m0, 126976
 s_nop 0
 buffer_load_dwordx4 v9, s[8:11], s14 offen lds
 s_add_u32 s14, s14, 5120
 s_mov_b32 m0, 128000
 s_nop 0
 buffer_load_dwordx4 v9, s[8:11], s14 offen lds
 s_add_u32 s14, s14, 5120
 s_mov_b32 m0, 129024
 s_nop 0
 buffer_load_dwordx4 v9, s[8:11], s14 offen lds
 s_add_u32 s14, s14, 5120
 s_mov_b32 m0, 130048
 s_nop 0
 buffer_load_dwordx4 v9, s[8:11], s14 offen lds
 s_mul_i32 s14, s52, 163840
 s_add_u32 s14, s14, 123904
 s_mov_b32 m0, 155648
 s_nop 0
 buffer_load_dwordx4 v8, s[8:11], s14 offen lds
 s_add_u32 s14, s14, 5120
 s_mov_b32 m0, 156672
 s_nop 0
 buffer_load_dwordx4 v8, s[8:11], s14 offen lds
 s_add_u32 s14, s14, 5120
 s_mov_b32 m0, 157696
 s_nop 0
 buffer_load_dwordx4 v8, s[8:11], s14 offen lds
 s_add_u32 s14, s14, 5120
 s_mov_b32 m0, 158720
 s_nop 0
 buffer_load_dwordx4 v8, s[8:11], s14 offen lds
 s_add_u32 s14, s14, 5120
 s_mov_b32 m0, 159744
 s_nop 0
 buffer_load_dwordx4 v9, s[8:11], s14 offen lds
 s_add_u32 s14, s14, 5120
 s_mov_b32 m0, 160768
 s_nop 0
 buffer_load_dwordx4 v9, s[8:11], s14 offen lds
 s_add_u32 s14, s14, 5120
 s_mov_b32 m0, 161792
 s_nop 0
 buffer_load_dwordx4 v9, s[8:11], s14 offen lds
 s_add_u32 s14, s14, 5120
 s_mov_b32 m0, 162816
 s_nop 0
 buffer_load_dwordx4 v9, s[8:11], s14 offen lds
 v_lshrrev_b32 v20, 4, v0
 v_bfe_u32 v21, v0, 2, 1
 v_bfe_u32 v22, v0, 3, 1
 v_and_b32 v23, 1, v20
 v_lshrrev_b32 v24, 1, v20
 v_and_b32 v25, 3, v0
 v_lshlrev_b32 v25, 3, v25
 v_lshl_add_u32 v26, v22, 1, v23
 v_lshl_add_u32 v27, v21, 2, v26
 v_lshl_add_u32 v26, v24, 2, v26
 v_lshl_add_u32 v26, v21, 4, v26
 v_xor_b32 v27, 6, v27
 v_lshl_add_u32 v27, v27, 5, v25
 v_lshl_add_u32 v12, v26, 8, v27
 v_lshl_add_u32 v26, v24, 2, v21
 v_lshl_add_u32 v26, v23, 4, v26
 v_lshl_add_u32 v27, v23, 2, v21
 v_lshl_add_u32 v27, v22, 1, v27
 v_lshl_add_u32 v27, v27, 5, v25
 v_lshl_add_u32 v14, v26, 8, v27
 v_lshlrev_b32 v1, 4, v0
 v_add_u32 v2, 65536, v1
 v_add_u32 v3, 114688, v1
 s_waitcnt vmcnt(32)
 s_barrier
 s_waitcnt lgkmcnt(0)
 s_barrier
 s_mov_b32 s8, s24
 s_and_b32 s9, s25, 0xffff
 s_mov_b32 s10, 5242880
 s_lshl_b32 s14, s52, 8
 s_add_u32 s14, s14, 786432
 s_mov_b32 m0, 24576
 s_nop 0
 buffer_load_dwordx4 v10, s[8:11], s14 offen lds
 s_add_u32 s14, s14, 32768
 s_mov_b32 m0, 25600
 s_nop 0
 buffer_load_dwordx4 v10, s[8:11], s14 offen lds
 s_add_u32 s14, s14, 32768
 s_mov_b32 m0, 26624
 s_nop 0
 buffer_load_dwordx4 v10, s[8:11], s14 offen lds
 s_add_u32 s14, s14, 32768
 s_mov_b32 m0, 27648
 s_nop 0
 buffer_load_dwordx4 v10, s[8:11], s14 offen lds
 s_add_u32 s14, s14, 32768
 s_mov_b32 m0, 28672
 s_nop 0
 buffer_load_dwordx4 v11, s[8:11], s14 offen lds
 s_add_u32 s14, s14, 32768
 s_mov_b32 m0, 29696
 s_nop 0
 buffer_load_dwordx4 v11, s[8:11], s14 offen lds
 s_add_u32 s14, s14, 32768
 s_mov_b32 m0, 30720
 s_nop 0
 buffer_load_dwordx4 v11, s[8:11], s14 offen lds
 s_add_u32 s14, s14, 32768
 s_mov_b32 m0, 31744
 s_nop 0
 buffer_load_dwordx4 v11, s[8:11], s14 offen lds
 s_waitcnt vmcnt(32)
 s_barrier
 s_waitcnt lgkmcnt(0)
 s_barrier
 s_lshl_b32 s14, s52, 8
 s_add_u32 s14, s14, 1835008
 s_mov_b32 m0, 57344
 s_nop 0
 buffer_load_dwordx4 v10, s[8:11], s14 offen lds
 s_add_u32 s14, s14, 32768
 s_mov_b32 m0, 58368
 s_nop 0
 buffer_load_dwordx4 v10, s[8:11], s14 offen lds
 s_add_u32 s14, s14, 32768
 s_mov_b32 m0, 59392
 s_nop 0
 buffer_load_dwordx4 v10, s[8:11], s14 offen lds
 s_add_u32 s14, s14, 32768
 s_mov_b32 m0, 60416
 s_nop 0
 buffer_load_dwordx4 v10, s[8:11], s14 offen lds
 s_add_u32 s14, s14, 32768
 s_mov_b32 m0, 61440
 s_nop 0
 buffer_load_dwordx4 v11, s[8:11], s14 offen lds
 s_add_u32 s14, s14, 32768
 s_mov_b32 m0, 62464
 s_nop 0
 buffer_load_dwordx4 v11, s[8:11], s14 offen lds
 s_add_u32 s14, s14, 32768
 s_mov_b32 m0, 63488
 s_nop 0
 buffer_load_dwordx4 v11, s[8:11], s14 offen lds
 s_add_u32 s14, s14, 32768
 s_mov_b32 m0, 64512
 s_nop 0
 buffer_load_dwordx4 v11, s[8:11], s14 offen lds
 s_waitcnt vmcnt(32)
 s_barrier
 s_waitcnt lgkmcnt(0)
 s_barrier
 s_lshl_b32 s14, s52, 8
 s_add_u32 s14, s14, 2883584
 s_mov_b32 m0, 90112
 s_nop 0
 buffer_load_dwordx4 v10, s[8:11], s14 offen lds
 s_add_u32 s14, s14, 32768
 s_mov_b32 m0, 91136
 s_nop 0
 buffer_load_dwordx4 v10, s[8:11], s14 offen lds
 s_add_u32 s14, s14, 32768
 s_mov_b32 m0, 92160
 s_nop 0
 buffer_load_dwordx4 v10, s[8:11], s14 offen lds
 s_add_u32 s14, s14, 32768
 s_mov_b32 m0, 93184
 s_nop 0
 buffer_load_dwordx4 v10, s[8:11], s14 offen lds
 s_add_u32 s14, s14, 32768
 s_mov_b32 m0, 94208
 s_nop 0
 buffer_load_dwordx4 v11, s[8:11], s14 offen lds
 s_add_u32 s14, s14, 32768
 s_mov_b32 m0, 95232
 s_nop 0
 buffer_load_dwordx4 v11, s[8:11], s14 offen lds
 s_add_u32 s14, s14, 32768
 s_mov_b32 m0, 96256
 s_nop 0
 buffer_load_dwordx4 v11, s[8:11], s14 offen lds
 s_add_u32 s14, s14, 32768
 s_mov_b32 m0, 97280
 s_nop 0
 buffer_load_dwordx4 v11, s[8:11], s14 offen lds
 s_waitcnt vmcnt(32)
 s_barrier
 v_xor_b32 v16, 0, v14
 v_add_u32 v16, 98304, v16
 v_xor_b32 v17, 64, v16
 ds_read_b64_tr_b16 a[0:1], v16 offset:0
 ds_read_b64_tr_b16 a[2:3], v17 offset:512
 ds_read_b64_tr_b16 a[4:5], v16 offset:2048
 ds_read_b64_tr_b16 a[6:7], v17 offset:2560
 v_xor_b32 v16, 0, v14
 v_add_u32 v16, 98304, v16
 v_xor_b32 v17, 64, v16
 ds_read_b64_tr_b16 a[8:9], v16 offset:8192
 ds_read_b64_tr_b16 a[10:11], v17 offset:8704
 ds_read_b64_tr_b16 a[12:13], v16 offset:10240
 ds_read_b64_tr_b16 a[14:15], v17 offset:10752
 v_xor_b32 v16, 0, v14
 v_add_u32 v16, 98304, v16
 v_xor_b32 v17, 64, v16
 ds_read_b64_tr_b16 a[16:17], v16 offset:16384
 ds_read_b64_tr_b16 a[18:19], v17 offset:16896
 ds_read_b64_tr_b16 a[20:21], v16 offset:18432
 ds_read_b64_tr_b16 a[22:23], v17 offset:18944
 v_xor_b32 v16, 0, v14
 v_add_u32 v16, 98304, v16
 v_xor_b32 v17, 64, v16
 ds_read_b64_tr_b16 a[24:25], v16 offset:24576
 ds_read_b64_tr_b16 a[26:27], v17 offset:25088
 ds_read_b64_tr_b16 a[28:29], v16 offset:26624
 ds_read_b64_tr_b16 a[30:31], v17 offset:27136
 v_xor_b32 v16, 32, v14
 v_add_u32 v16, 98304, v16
 v_xor_b32 v17, 64, v16
 ds_read_b64_tr_b16 a[32:33], v16 offset:0
 ds_read_b64_tr_b16 a[34:35], v17 offset:512
 ds_read_b64_tr_b16 a[36:37], v16 offset:2048
 ds_read_b64_tr_b16 a[38:39], v17 offset:2560
 v_xor_b32 v16, 32, v14
 v_add_u32 v16, 98304, v16
 v_xor_b32 v17, 64, v16
 ds_read_b64_tr_b16 a[40:41], v16 offset:8192
 ds_read_b64_tr_b16 a[42:43], v17 offset:8704
 ds_read_b64_tr_b16 a[44:45], v16 offset:10240
 ds_read_b64_tr_b16 a[46:47], v17 offset:10752
 v_xor_b32 v16, 32, v14
 v_add_u32 v16, 98304, v16
 v_xor_b32 v17, 64, v16
 ds_read_b64_tr_b16 a[48:49], v16 offset:16384
 ds_read_b64_tr_b16 a[50:51], v17 offset:16896
 ds_read_b64_tr_b16 a[52:53], v16 offset:18432
 ds_read_b64_tr_b16 a[54:55], v17 offset:18944
 v_xor_b32 v16, 32, v14
 v_add_u32 v16, 98304, v16
 v_xor_b32 v17, 64, v16
 ds_read_b64_tr_b16 a[56:57], v16 offset:24576
 ds_read_b64_tr_b16 a[58:59], v17 offset:25088
 ds_read_b64_tr_b16 a[60:61], v16 offset:26624
 ds_read_b64_tr_b16 a[62:63], v17 offset:27136
 v_xor_b32 v16, 128, v14
 v_add_u32 v16, 98304, v16
 v_xor_b32 v17, 64, v16
 ds_read_b64_tr_b16 a[64:65], v16 offset:0
 ds_read_b64_tr_b16 a[66:67], v17 offset:512
 ds_read_b64_tr_b16 a[68:69], v16 offset:2048
 ds_read_b64_tr_b16 a[70:71], v17 offset:2560
 v_xor_b32 v16, 128, v14
 v_add_u32 v16, 98304, v16
 v_xor_b32 v17, 64, v16
 ds_read_b64_tr_b16 a[72:73], v16 offset:8192
 ds_read_b64_tr_b16 a[74:75], v17 offset:8704
 ds_read_b64_tr_b16 a[76:77], v16 offset:10240
 ds_read_b64_tr_b16 a[78:79], v17 offset:10752
 v_xor_b32 v16, 128, v14
 v_add_u32 v16, 98304, v16
 v_xor_b32 v17, 64, v16
 ds_read_b64_tr_b16 a[80:81], v16 offset:16384
 ds_read_b64_tr_b16 a[82:83], v17 offset:16896
 ds_read_b64_tr_b16 a[84:85], v16 offset:18432
 ds_read_b64_tr_b16 a[86:87], v17 offset:18944
 v_xor_b32 v16, 128, v14
 v_add_u32 v16, 98304, v16
 v_xor_b32 v17, 64, v16
 ds_read_b64_tr_b16 a[88:89], v16 offset:24576
 ds_read_b64_tr_b16 a[90:91], v17 offset:25088
 ds_read_b64_tr_b16 a[92:93], v16 offset:26624
 ds_read_b64_tr_b16 a[94:95], v17 offset:27136
 v_xor_b32 v16, 160, v14
 v_add_u32 v16, 98304, v16
 v_xor_b32 v17, 64, v16
 ds_read_b64_tr_b16 a[96:97], v16 offset:0
 ds_read_b64_tr_b16 a[98:99], v17 offset:512
 ds_read_b64_tr_b16 a[100:101], v16 offset:2048
 ds_read_b64_tr_b16 a[102:103], v17 offset:2560
 v_xor_b32 v16, 160, v14
 v_add_u32 v16, 98304, v16
 v_xor_b32 v17, 64, v16
 ds_read_b64_tr_b16 a[104:105], v16 offset:8192
 ds_read_b64_tr_b16 a[106:107], v17 offset:8704
 ds_read_b64_tr_b16 a[108:109], v16 offset:10240
 ds_read_b64_tr_b16 a[110:111], v17 offset:10752
 v_xor_b32 v16, 160, v14
 v_add_u32 v16, 98304, v16
 v_xor_b32 v17, 64, v16
 ds_read_b64_tr_b16 a[112:113], v16 offset:16384
 ds_read_b64_tr_b16 a[114:115], v17 offset:16896
 ds_read_b64_tr_b16 a[116:117], v16 offset:18432
 ds_read_b64_tr_b16 a[118:119], v17 offset:18944
 v_xor_b32 v16, 160, v14
 v_add_u32 v16, 98304, v16
 v_xor_b32 v17, 64, v16
 ds_read_b64_tr_b16 a[120:121], v16 offset:24576
 ds_read_b64_tr_b16 a[122:123], v17 offset:25088
 ds_read_b64_tr_b16 a[124:125], v16 offset:26624
 ds_read_b64_tr_b16 a[126:127], v17 offset:27136
 s_waitcnt lgkmcnt(0)
 s_barrier
 s_lshl_b32 s14, s52, 8
 s_add_u32 s14, s14, 3932160
 s_mov_b32 m0, 122880
 s_nop 0
 buffer_load_dwordx4 v10, s[8:11], s14 offen lds
 s_add_u32 s14, s14, 32768
 s_mov_b32 m0, 123904
 s_nop 0
 buffer_load_dwordx4 v10, s[8:11], s14 offen lds
 s_add_u32 s14, s14, 32768
 s_mov_b32 m0, 124928
 s_nop 0
 buffer_load_dwordx4 v10, s[8:11], s14 offen lds
 s_add_u32 s14, s14, 32768
 s_mov_b32 m0, 125952
 s_nop 0
 buffer_load_dwordx4 v10, s[8:11], s14 offen lds
 s_add_u32 s14, s14, 32768
 s_mov_b32 m0, 126976
 s_nop 0
 buffer_load_dwordx4 v11, s[8:11], s14 offen lds
 s_add_u32 s14, s14, 32768
 s_mov_b32 m0, 128000
 s_nop 0
 buffer_load_dwordx4 v11, s[8:11], s14 offen lds
 s_add_u32 s14, s14, 32768
 s_mov_b32 m0, 129024
 s_nop 0
 buffer_load_dwordx4 v11, s[8:11], s14 offen lds
 s_add_u32 s14, s14, 32768
 s_mov_b32 m0, 130048
 s_nop 0
 buffer_load_dwordx4 v11, s[8:11], s14 offen lds
 s_waitcnt vmcnt(32)
 s_barrier
 v_xor_b32 v16, 160, v14
 v_add_u32 v16, 131072, v16
 v_xor_b32 v17, 64, v16
 ds_read_b64_tr_b16 a[128:129], v16 offset:0
 ds_read_b64_tr_b16 a[130:131], v17 offset:512
 ds_read_b64_tr_b16 a[132:133], v16 offset:2048
 ds_read_b64_tr_b16 a[134:135], v17 offset:2560
 v_xor_b32 v16, 160, v14
 v_add_u32 v16, 131072, v16
 v_xor_b32 v17, 64, v16
 ds_read_b64_tr_b16 a[136:137], v16 offset:8192
 ds_read_b64_tr_b16 a[138:139], v17 offset:8704
 ds_read_b64_tr_b16 a[140:141], v16 offset:10240
 ds_read_b64_tr_b16 a[142:143], v17 offset:10752
 v_xor_b32 v16, 160, v14
 v_add_u32 v16, 131072, v16
 v_xor_b32 v17, 64, v16
 ds_read_b64_tr_b16 a[144:145], v16 offset:16384
 ds_read_b64_tr_b16 a[146:147], v17 offset:16896
 ds_read_b64_tr_b16 a[148:149], v16 offset:18432
 ds_read_b64_tr_b16 a[150:151], v17 offset:18944
 v_xor_b32 v16, 160, v14
 v_add_u32 v16, 131072, v16
 v_xor_b32 v17, 64, v16
 ds_read_b64_tr_b16 a[152:153], v16 offset:24576
 ds_read_b64_tr_b16 a[154:155], v17 offset:25088
 ds_read_b64_tr_b16 a[156:157], v16 offset:26624
 ds_read_b64_tr_b16 a[158:159], v17 offset:27136
 s_waitcnt lgkmcnt(0)
 s_barrier
 s_lshl_b32 s14, s52, 8
 s_add_u32 s14, s14, 4980736
 s_mov_b32 m0, 155648
 s_nop 0
 buffer_load_dwordx4 v10, s[8:11], s14 offen lds
 s_add_u32 s14, s14, 32768
 s_mov_b32 m0, 156672
 s_nop 0
 buffer_load_dwordx4 v10, s[8:11], s14 offen lds
 s_add_u32 s14, s14, 32768
 s_mov_b32 m0, 157696
 s_nop 0
 buffer_load_dwordx4 v10, s[8:11], s14 offen lds
 s_add_u32 s14, s14, 32768
 s_mov_b32 m0, 158720
 s_nop 0
 buffer_load_dwordx4 v10, s[8:11], s14 offen lds
 s_add_u32 s14, s14, 32768
 s_mov_b32 m0, 159744
 s_nop 0
 buffer_load_dwordx4 v11, s[8:11], s14 offen lds
 s_add_u32 s14, s14, 32768
 s_mov_b32 m0, 160768
 s_nop 0
 buffer_load_dwordx4 v11, s[8:11], s14 offen lds
 s_add_u32 s14, s14, 32768
 s_mov_b32 m0, 161792
 s_nop 0
 buffer_load_dwordx4 v11, s[8:11], s14 offen lds
 s_add_u32 s14, s14, 32768
 s_mov_b32 m0, 162816
 s_nop 0
 buffer_load_dwordx4 v11, s[8:11], s14 offen lds
 s_waitcnt vmcnt(32)
 s_barrier
 v_xor_b32 v16, 0, v12
 v_add_u32 v16, 0, v16
 ds_read_b64_tr_b16 a[160:161], v16 offset:0
 ds_read_b64_tr_b16 a[162:163], v16 offset:8192
 ds_read_b64_tr_b16 a[164:165], v16 offset:2048
 ds_read_b64_tr_b16 a[166:167], v16 offset:10240
 v_xor_b32 v16, 32, v12
 v_add_u32 v16, 0, v16
 ds_read_b64_tr_b16 a[168:169], v16 offset:0
 ds_read_b64_tr_b16 a[170:171], v16 offset:8192
 ds_read_b64_tr_b16 a[172:173], v16 offset:2048
 ds_read_b64_tr_b16 a[174:175], v16 offset:10240
 v_xor_b32 v16, 0, v12
 v_add_u32 v16, 0, v16
 ds_read_b64_tr_b16 a[176:177], v16 offset:16384
 ds_read_b64_tr_b16 a[178:179], v16 offset:24576
 ds_read_b64_tr_b16 a[180:181], v16 offset:18432
 ds_read_b64_tr_b16 a[182:183], v16 offset:26624
 v_xor_b32 v16, 32, v12
 v_add_u32 v16, 0, v16
 ds_read_b64_tr_b16 a[184:185], v16 offset:16384
 ds_read_b64_tr_b16 a[186:187], v16 offset:24576
 ds_read_b64_tr_b16 a[188:189], v16 offset:18432
 ds_read_b64_tr_b16 a[190:191], v16 offset:26624
 s_waitcnt lgkmcnt(0)
 s_barrier
 s_mov_b32 s8, s22
 s_and_b32 s9, s23, 0xffff
 s_mov_b32 s10, 5242880
 s_lshl_b32 s14, s52, 8
 s_add_u32 s14, s14, 786432
 s_mov_b32 m0, 24576
 s_nop 0
 buffer_load_dwordx4 v10, s[8:11], s14 offen lds
 s_add_u32 s14, s14, 32768
 s_mov_b32 m0, 25600
 s_nop 0
 buffer_load_dwordx4 v10, s[8:11], s14 offen lds
 s_add_u32 s14, s14, 32768
 s_mov_b32 m0, 26624
 s_nop 0
 buffer_load_dwordx4 v10, s[8:11], s14 offen lds
 s_add_u32 s14, s14, 32768
 s_mov_b32 m0, 27648
 s_nop 0
 buffer_load_dwordx4 v10, s[8:11], s14 offen lds
 s_add_u32 s14, s14, 32768
 s_mov_b32 m0, 28672
 s_nop 0
 buffer_load_dwordx4 v11, s[8:11], s14 offen lds
 s_add_u32 s14, s14, 32768
 s_mov_b32 m0, 29696
 s_nop 0
 buffer_load_dwordx4 v11, s[8:11], s14 offen lds
 s_add_u32 s14, s14, 32768
 s_mov_b32 m0, 30720
 s_nop 0
 buffer_load_dwordx4 v11, s[8:11], s14 offen lds
 s_add_u32 s14, s14, 32768
 s_mov_b32 m0, 31744
 s_nop 0
 buffer_load_dwordx4 v11, s[8:11], s14 offen lds
 s_waitcnt vmcnt(32)
 s_barrier
 v_xor_b32 v16, 0, v12
 v_add_u32 v16, 32768, v16
 ds_read_b64_tr_b16 a[192:193], v16 offset:0
 ds_read_b64_tr_b16 a[194:195], v16 offset:8192
 ds_read_b64_tr_b16 a[196:197], v16 offset:2048
 ds_read_b64_tr_b16 a[198:199], v16 offset:10240
 v_xor_b32 v16, 32, v12
 v_add_u32 v16, 32768, v16
 ds_read_b64_tr_b16 a[200:201], v16 offset:0
 ds_read_b64_tr_b16 a[202:203], v16 offset:8192
 ds_read_b64_tr_b16 a[204:205], v16 offset:2048
 ds_read_b64_tr_b16 a[206:207], v16 offset:10240
 v_xor_b32 v16, 0, v12
 v_add_u32 v16, 32768, v16
 ds_read_b64_tr_b16 a[208:209], v16 offset:16384
 ds_read_b64_tr_b16 a[210:211], v16 offset:24576
 ds_read_b64_tr_b16 a[212:213], v16 offset:18432
 ds_read_b64_tr_b16 a[214:215], v16 offset:26624
 v_xor_b32 v16, 32, v12
 v_add_u32 v16, 32768, v16
 ds_read_b64_tr_b16 a[216:217], v16 offset:16384
 ds_read_b64_tr_b16 a[218:219], v16 offset:24576
 ds_read_b64_tr_b16 a[220:221], v16 offset:18432
 ds_read_b64_tr_b16 a[222:223], v16 offset:26624
 s_waitcnt lgkmcnt(0)
 s_barrier
 s_lshl_b32 s14, s52, 8
 s_add_u32 s14, s14, 1835008
 s_mov_b32 m0, 57344
 s_nop 0
 buffer_load_dwordx4 v10, s[8:11], s14 offen lds
 s_add_u32 s14, s14, 32768
 s_mov_b32 m0, 58368
 s_nop 0
 buffer_load_dwordx4 v10, s[8:11], s14 offen lds
 s_add_u32 s14, s14, 32768
 s_mov_b32 m0, 59392
 s_nop 0
 buffer_load_dwordx4 v10, s[8:11], s14 offen lds
 s_add_u32 s14, s14, 32768
 s_mov_b32 m0, 60416
 s_nop 0
 buffer_load_dwordx4 v10, s[8:11], s14 offen lds
 s_add_u32 s14, s14, 32768
 s_mov_b32 m0, 61440
 s_nop 0
 buffer_load_dwordx4 v11, s[8:11], s14 offen lds
 s_add_u32 s14, s14, 32768
 s_mov_b32 m0, 62464
 s_nop 0
 buffer_load_dwordx4 v11, s[8:11], s14 offen lds
 s_add_u32 s14, s14, 32768
 s_mov_b32 m0, 63488
 s_nop 0
 buffer_load_dwordx4 v11, s[8:11], s14 offen lds
 s_add_u32 s14, s14, 32768
 s_mov_b32 m0, 64512
 s_nop 0
 buffer_load_dwordx4 v11, s[8:11], s14 offen lds
 s_waitcnt vmcnt(32)
 s_barrier
 v_xor_b32 v16, 0, v12
 v_add_u32 v16, 65536, v16
 ds_read_b64_tr_b16 a[224:225], v16 offset:0
 ds_read_b64_tr_b16 a[226:227], v16 offset:8192
 ds_read_b64_tr_b16 a[228:229], v16 offset:2048
 ds_read_b64_tr_b16 a[230:231], v16 offset:10240
 v_xor_b32 v16, 32, v12
 v_add_u32 v16, 65536, v16
 ds_read_b64_tr_b16 a[232:233], v16 offset:0
 ds_read_b64_tr_b16 a[234:235], v16 offset:8192
 ds_read_b64_tr_b16 a[236:237], v16 offset:2048
 ds_read_b64_tr_b16 a[238:239], v16 offset:10240
 v_xor_b32 v16, 0, v12
 v_add_u32 v16, 65536, v16
 ds_read_b64_tr_b16 a[240:241], v16 offset:16384
 ds_read_b64_tr_b16 a[242:243], v16 offset:24576
 ds_read_b64_tr_b16 a[244:245], v16 offset:18432
 ds_read_b64_tr_b16 a[246:247], v16 offset:26624
 v_xor_b32 v16, 32, v12
 v_add_u32 v16, 65536, v16
 ds_read_b64_tr_b16 a[248:249], v16 offset:16384
 ds_read_b64_tr_b16 a[250:251], v16 offset:24576
 ds_read_b64_tr_b16 a[252:253], v16 offset:18432
 ds_read_b64_tr_b16 a[254:255], v16 offset:26624
 s_waitcnt lgkmcnt(0)
 s_barrier
 s_lshl_b32 s14, s52, 8
 s_add_u32 s14, s14, 2883584
 s_mov_b32 m0, 90112
 s_nop 0
 buffer_load_dwordx4 v10, s[8:11], s14 offen lds
 s_add_u32 s14, s14, 32768
 s_mov_b32 m0, 91136
 s_nop 0
 buffer_load_dwordx4 v10, s[8:11], s14 offen lds
 s_add_u32 s14, s14, 32768
 s_mov_b32 m0, 92160
 s_nop 0
 buffer_load_dwordx4 v10, s[8:11], s14 offen lds
 s_add_u32 s14, s14, 32768
 s_mov_b32 m0, 93184
 s_nop 0
 buffer_load_dwordx4 v10, s[8:11], s14 offen lds
 s_add_u32 s14, s14, 32768
 s_mov_b32 m0, 94208
 s_nop 0
 buffer_load_dwordx4 v11, s[8:11], s14 offen lds
 s_add_u32 s14, s14, 32768
 s_mov_b32 m0, 95232
 s_nop 0
 buffer_load_dwordx4 v11, s[8:11], s14 offen lds
 s_add_u32 s14, s14, 32768
 s_mov_b32 m0, 96256
 s_nop 0
 buffer_load_dwordx4 v11, s[8:11], s14 offen lds
 s_add_u32 s14, s14, 32768
 s_mov_b32 m0, 97280
 s_nop 0
 buffer_load_dwordx4 v11, s[8:11], s14 offen lds
 s_waitcnt vmcnt(32)
 s_barrier
 v_xor_b32 v16, 0, v12
 v_add_u32 v16, 98304, v16
 ds_read_b64_tr_b16 v[64:65], v16 offset:0
 ds_read_b64_tr_b16 v[66:67], v16 offset:8192
 ds_read_b64_tr_b16 v[68:69], v16 offset:2048
 ds_read_b64_tr_b16 v[70:71], v16 offset:10240
 v_xor_b32 v16, 32, v12
 v_add_u32 v16, 98304, v16
 ds_read_b64_tr_b16 v[72:73], v16 offset:0
 ds_read_b64_tr_b16 v[74:75], v16 offset:8192
 ds_read_b64_tr_b16 v[76:77], v16 offset:2048
 ds_read_b64_tr_b16 v[78:79], v16 offset:10240
 v_xor_b32 v16, 0, v12
 v_add_u32 v16, 98304, v16
 ds_read_b64_tr_b16 v[80:81], v16 offset:16384
 ds_read_b64_tr_b16 v[82:83], v16 offset:24576
 ds_read_b64_tr_b16 v[84:85], v16 offset:18432
 ds_read_b64_tr_b16 v[86:87], v16 offset:26624
 v_xor_b32 v16, 32, v12
 v_add_u32 v16, 98304, v16
 ds_read_b64_tr_b16 v[88:89], v16 offset:16384
 ds_read_b64_tr_b16 v[90:91], v16 offset:24576
 ds_read_b64_tr_b16 v[92:93], v16 offset:18432
 ds_read_b64_tr_b16 v[94:95], v16 offset:26624
 s_waitcnt lgkmcnt(0)
 s_barrier
 s_lshl_b32 s14, s52, 8
 s_add_u32 s14, s14, 3932160
 s_mov_b32 m0, 122880
 s_nop 0
 buffer_load_dwordx4 v10, s[8:11], s14 offen lds
 s_add_u32 s14, s14, 32768
 s_mov_b32 m0, 123904
 s_nop 0
 buffer_load_dwordx4 v10, s[8:11], s14 offen lds
 s_add_u32 s14, s14, 32768
 s_mov_b32 m0, 124928
 s_nop 0
 buffer_load_dwordx4 v10, s[8:11], s14 offen lds
 s_add_u32 s14, s14, 32768
 s_mov_b32 m0, 125952
 s_nop 0
 buffer_load_dwordx4 v10, s[8:11], s14 offen lds
 s_add_u32 s14, s14, 32768
 s_mov_b32 m0, 126976
 s_nop 0
 buffer_load_dwordx4 v11, s[8:11], s14 offen lds
 s_add_u32 s14, s14, 32768
 s_mov_b32 m0, 128000
 s_nop 0
 buffer_load_dwordx4 v11, s[8:11], s14 offen lds
 s_add_u32 s14, s14, 32768
 s_mov_b32 m0, 129024
 s_nop 0
 buffer_load_dwordx4 v11, s[8:11], s14 offen lds
 s_add_u32 s14, s14, 32768
 s_mov_b32 m0, 130048
 s_nop 0
 buffer_load_dwordx4 v11, s[8:11], s14 offen lds
 s_waitcnt vmcnt(32)
 s_barrier
 v_xor_b32 v16, 0, v12
 v_add_u32 v16, 131072, v16
 ds_read_b64_tr_b16 v[96:97], v16 offset:0
 ds_read_b64_tr_b16 v[98:99], v16 offset:8192
 ds_read_b64_tr_b16 v[100:101], v16 offset:2048
 ds_read_b64_tr_b16 v[102:103], v16 offset:10240
 v_xor_b32 v16, 32, v12
 v_add_u32 v16, 131072, v16
 ds_read_b64_tr_b16 v[104:105], v16 offset:0
 ds_read_b64_tr_b16 v[106:107], v16 offset:8192
 ds_read_b64_tr_b16 v[108:109], v16 offset:2048
 ds_read_b64_tr_b16 v[110:111], v16 offset:10240
 v_xor_b32 v16, 0, v12
 v_add_u32 v16, 131072, v16
 ds_read_b64_tr_b16 v[112:113], v16 offset:16384
 ds_read_b64_tr_b16 v[114:115], v16 offset:24576
 ds_read_b64_tr_b16 v[116:117], v16 offset:18432
 ds_read_b64_tr_b16 v[118:119], v16 offset:26624
 v_xor_b32 v16, 32, v12
 v_add_u32 v16, 131072, v16
 ds_read_b64_tr_b16 v[120:121], v16 offset:16384
 ds_read_b64_tr_b16 v[122:123], v16 offset:24576
 ds_read_b64_tr_b16 v[124:125], v16 offset:18432
 ds_read_b64_tr_b16 v[126:127], v16 offset:26624
 s_waitcnt lgkmcnt(0)
 s_barrier
 s_lshl_b32 s14, s52, 8
 s_add_u32 s14, s14, 4980736
 s_mov_b32 m0, 155648
 s_nop 0
 buffer_load_dwordx4 v10, s[8:11], s14 offen lds
 s_add_u32 s14, s14, 32768
 s_mov_b32 m0, 156672
 s_nop 0
 buffer_load_dwordx4 v10, s[8:11], s14 offen lds
 s_add_u32 s14, s14, 32768
 s_mov_b32 m0, 157696
 s_nop 0
 buffer_load_dwordx4 v10, s[8:11], s14 offen lds
 s_add_u32 s14, s14, 32768
 s_mov_b32 m0, 158720
 s_nop 0
 buffer_load_dwordx4 v10, s[8:11], s14 offen lds
 s_add_u32 s14, s14, 32768
 s_mov_b32 m0, 159744
 s_nop 0
 buffer_load_dwordx4 v11, s[8:11], s14 offen lds
 s_add_u32 s14, s14, 32768
 s_mov_b32 m0, 160768
 s_nop 0
 buffer_load_dwordx4 v11, s[8:11], s14 offen lds
 s_add_u32 s14, s14, 32768
 s_mov_b32 m0, 161792
 s_nop 0
 buffer_load_dwordx4 v11, s[8:11], s14 offen lds
 s_add_u32 s14, s14, 32768
 s_mov_b32 m0, 162816
 s_nop 0
 buffer_load_dwordx4 v11, s[8:11], s14 offen lds
 s_waitcnt vmcnt(32)
 s_barrier
 v_xor_b32 v16, 0, v12
 v_add_u32 v16, 0, v16
 ds_read_b64_tr_b16 v[128:129], v16 offset:0
 ds_read_b64_tr_b16 v[130:131], v16 offset:8192
 ds_read_b64_tr_b16 v[132:133], v16 offset:2048
 ds_read_b64_tr_b16 v[134:135], v16 offset:10240
 v_xor_b32 v16, 32, v12
 v_add_u32 v16, 0, v16
 ds_read_b64_tr_b16 v[136:137], v16 offset:0
 ds_read_b64_tr_b16 v[138:139], v16 offset:8192
 ds_read_b64_tr_b16 v[140:141], v16 offset:2048
 ds_read_b64_tr_b16 v[142:143], v16 offset:10240
 v_xor_b32 v16, 0, v12
 v_add_u32 v16, 0, v16
 ds_read_b64_tr_b16 v[144:145], v16 offset:16384
 ds_read_b64_tr_b16 v[146:147], v16 offset:24576
 ds_read_b64_tr_b16 v[148:149], v16 offset:18432
 ds_read_b64_tr_b16 v[150:151], v16 offset:26624
 v_xor_b32 v16, 32, v12
 v_add_u32 v16, 0, v16
 ds_read_b64_tr_b16 v[152:153], v16 offset:16384
 ds_read_b64_tr_b16 v[154:155], v16 offset:24576
 ds_read_b64_tr_b16 v[156:157], v16 offset:18432
 ds_read_b64_tr_b16 v[158:159], v16 offset:26624
 s_waitcnt lgkmcnt(0)
 s_barrier
 s_mov_b32 s8, s20
 s_and_b32 s9, s21, 0xffff
 s_mov_b32 s10, 5242880
 s_lshl_b32 s14, s52, 8
 s_add_u32 s14, s14, 786432
 s_mov_b32 m0, 24576
 s_nop 0
 buffer_load_dwordx4 v10, s[8:11], s14 offen lds
 s_add_u32 s14, s14, 32768
 s_mov_b32 m0, 25600
 s_nop 0
 buffer_load_dwordx4 v10, s[8:11], s14 offen lds
 s_add_u32 s14, s14, 32768
 s_mov_b32 m0, 26624
 s_nop 0
 buffer_load_dwordx4 v10, s[8:11], s14 offen lds
 s_add_u32 s14, s14, 32768
 s_mov_b32 m0, 27648
 s_nop 0
 buffer_load_dwordx4 v10, s[8:11], s14 offen lds
 s_add_u32 s14, s14, 32768
 s_mov_b32 m0, 28672
 s_nop 0
 buffer_load_dwordx4 v11, s[8:11], s14 offen lds
 s_add_u32 s14, s14, 32768
 s_mov_b32 m0, 29696
 s_nop 0
 buffer_load_dwordx4 v11, s[8:11], s14 offen lds
 s_add_u32 s14, s14, 32768
 s_mov_b32 m0, 30720
 s_nop 0
 buffer_load_dwordx4 v11, s[8:11], s14 offen lds
 s_add_u32 s14, s14, 32768
 s_mov_b32 m0, 31744
 s_nop 0
 buffer_load_dwordx4 v11, s[8:11], s14 offen lds
 s_waitcnt vmcnt(32)
 s_barrier
 v_xor_b32 v16, 0, v12
 v_add_u32 v16, 32768, v16
 ds_read_b64_tr_b16 v[160:161], v16 offset:0
 ds_read_b64_tr_b16 v[162:163], v16 offset:8192
 ds_read_b64_tr_b16 v[164:165], v16 offset:2048
 ds_read_b64_tr_b16 v[166:167], v16 offset:10240
 v_xor_b32 v16, 32, v12
 v_add_u32 v16, 32768, v16
 ds_read_b64_tr_b16 v[168:169], v16 offset:0
 ds_read_b64_tr_b16 v[170:171], v16 offset:8192
 ds_read_b64_tr_b16 v[172:173], v16 offset:2048
 ds_read_b64_tr_b16 v[174:175], v16 offset:10240
 v_xor_b32 v16, 0, v12
 v_add_u32 v16, 32768, v16
 ds_read_b64_tr_b16 v[176:177], v16 offset:16384
 ds_read_b64_tr_b16 v[178:179], v16 offset:24576
 ds_read_b64_tr_b16 v[180:181], v16 offset:18432
 ds_read_b64_tr_b16 v[182:183], v16 offset:26624
 v_xor_b32 v16, 32, v12
 v_add_u32 v16, 32768, v16
 ds_read_b64_tr_b16 v[32:33], v16 offset:16384
 ds_read_b64_tr_b16 v[34:35], v16 offset:24576
 ds_read_b64_tr_b16 v[36:37], v16 offset:18432
 ds_read_b64_tr_b16 v[38:39], v16 offset:26624
 s_add_u32 s3, s63, 0
 s_waitcnt lgkmcnt(2)
 buffer_store_dwordx4 v[32:35], v1, s[4:7], s3 offen offset:0
 s_waitcnt lgkmcnt(0)
 buffer_store_dwordx4 v[36:39], v1, s[4:7], s3 offen offset:1024
 s_waitcnt lgkmcnt(0)
 s_barrier
 s_lshl_b32 s14, s52, 8
 s_add_u32 s14, s14, 1835008
 s_mov_b32 m0, 57344
 s_nop 0
 buffer_load_dwordx4 v10, s[8:11], s14 offen lds
 s_add_u32 s14, s14, 32768
 s_mov_b32 m0, 58368
 s_nop 0
 buffer_load_dwordx4 v10, s[8:11], s14 offen lds
 s_add_u32 s14, s14, 32768
 s_mov_b32 m0, 59392
 s_nop 0
 buffer_load_dwordx4 v10, s[8:11], s14 offen lds
 s_add_u32 s14, s14, 32768
 s_mov_b32 m0, 60416
 s_nop 0
 buffer_load_dwordx4 v10, s[8:11], s14 offen lds
 s_add_u32 s14, s14, 32768
 s_mov_b32 m0, 61440
 s_nop 0
 buffer_load_dwordx4 v11, s[8:11], s14 offen lds
 s_add_u32 s14, s14, 32768
 s_mov_b32 m0, 62464
 s_nop 0
 buffer_load_dwordx4 v11, s[8:11], s14 offen lds
 s_add_u32 s14, s14, 32768
 s_mov_b32 m0, 63488
 s_nop 0
 buffer_load_dwordx4 v11, s[8:11], s14 offen lds
 s_add_u32 s14, s14, 32768
 s_mov_b32 m0, 64512
 s_nop 0
 buffer_load_dwordx4 v11, s[8:11], s14 offen lds
 s_waitcnt vmcnt(34)
 s_barrier
 v_xor_b32 v16, 0, v12
 v_add_u32 v16, 65536, v16
 ds_read_b64_tr_b16 v[184:185], v16 offset:0
 ds_read_b64_tr_b16 v[186:187], v16 offset:8192
 ds_read_b64_tr_b16 v[188:189], v16 offset:2048
 ds_read_b64_tr_b16 v[190:191], v16 offset:10240
 v_xor_b32 v16, 32, v12
 v_add_u32 v16, 65536, v16
 ds_read_b64_tr_b16 v[192:193], v16 offset:0
 ds_read_b64_tr_b16 v[194:195], v16 offset:8192
 ds_read_b64_tr_b16 v[196:197], v16 offset:2048
 ds_read_b64_tr_b16 v[198:199], v16 offset:10240
 v_xor_b32 v16, 0, v12
 v_add_u32 v16, 65536, v16
 ds_read_b64_tr_b16 v[200:201], v16 offset:16384
 ds_read_b64_tr_b16 v[202:203], v16 offset:24576
 ds_read_b64_tr_b16 v[204:205], v16 offset:18432
 ds_read_b64_tr_b16 v[206:207], v16 offset:26624
 v_xor_b32 v16, 32, v12
 v_add_u32 v16, 65536, v16
 ds_read_b64_tr_b16 v[208:209], v16 offset:16384
 ds_read_b64_tr_b16 v[210:211], v16 offset:24576
 ds_read_b64_tr_b16 v[212:213], v16 offset:18432
 ds_read_b64_tr_b16 v[214:215], v16 offset:26624
 s_waitcnt lgkmcnt(0)
 s_barrier
 s_lshl_b32 s14, s52, 8
 s_add_u32 s14, s14, 2883584
 s_mov_b32 m0, 90112
 s_nop 0
 buffer_load_dwordx4 v10, s[8:11], s14 offen lds
 s_add_u32 s14, s14, 32768
 s_mov_b32 m0, 91136
 s_nop 0
 buffer_load_dwordx4 v10, s[8:11], s14 offen lds
 s_add_u32 s14, s14, 32768
 s_mov_b32 m0, 92160
 s_nop 0
 buffer_load_dwordx4 v10, s[8:11], s14 offen lds
 s_add_u32 s14, s14, 32768
 s_mov_b32 m0, 93184
 s_nop 0
 buffer_load_dwordx4 v10, s[8:11], s14 offen lds
 s_add_u32 s14, s14, 32768
 s_mov_b32 m0, 94208
 s_nop 0
 buffer_load_dwordx4 v11, s[8:11], s14 offen lds
 s_add_u32 s14, s14, 32768
 s_mov_b32 m0, 95232
 s_nop 0
 buffer_load_dwordx4 v11, s[8:11], s14 offen lds
 s_add_u32 s14, s14, 32768
 s_mov_b32 m0, 96256
 s_nop 0
 buffer_load_dwordx4 v11, s[8:11], s14 offen lds
 s_add_u32 s14, s14, 32768
 s_mov_b32 m0, 97280
 s_nop 0
 buffer_load_dwordx4 v11, s[8:11], s14 offen lds
 s_waitcnt vmcnt(34)
 s_barrier
 v_xor_b32 v16, 0, v12
 v_add_u32 v16, 98304, v16
 ds_read_b64_tr_b16 v[40:41], v16 offset:0
 ds_read_b64_tr_b16 v[42:43], v16 offset:8192
 ds_read_b64_tr_b16 v[44:45], v16 offset:2048
 ds_read_b64_tr_b16 v[46:47], v16 offset:10240
 s_add_u32 s3, s63, 2048
 s_waitcnt lgkmcnt(2)
 buffer_store_dwordx4 v[40:43], v1, s[4:7], s3 offen offset:0
 s_waitcnt lgkmcnt(0)
 buffer_store_dwordx4 v[44:47], v1, s[4:7], s3 offen offset:1024
 v_xor_b32 v16, 32, v12
 v_add_u32 v16, 98304, v16
 ds_read_b64_tr_b16 v[48:49], v16 offset:0
 ds_read_b64_tr_b16 v[50:51], v16 offset:8192
 ds_read_b64_tr_b16 v[52:53], v16 offset:2048
 ds_read_b64_tr_b16 v[54:55], v16 offset:10240
 s_add_u32 s3, s63, 4096
 s_waitcnt lgkmcnt(2)
 buffer_store_dwordx4 v[48:51], v1, s[4:7], s3 offen offset:0
 s_waitcnt lgkmcnt(0)
 buffer_store_dwordx4 v[52:55], v1, s[4:7], s3 offen offset:1024
 v_xor_b32 v16, 0, v12
 v_add_u32 v16, 98304, v16
 ds_read_b64_tr_b16 v[56:57], v16 offset:16384
 ds_read_b64_tr_b16 v[58:59], v16 offset:24576
 ds_read_b64_tr_b16 v[60:61], v16 offset:18432
 ds_read_b64_tr_b16 v[62:63], v16 offset:26624
 s_add_u32 s3, s63, 6144
 s_waitcnt lgkmcnt(2)
 buffer_store_dwordx4 v[56:59], v1, s[4:7], s3 offen offset:0
 s_waitcnt lgkmcnt(0)
 buffer_store_dwordx4 v[60:63], v1, s[4:7], s3 offen offset:1024
 v_xor_b32 v16, 32, v12
 v_add_u32 v16, 98304, v16
 ds_read_b64_tr_b16 v[32:33], v16 offset:16384
 ds_read_b64_tr_b16 v[34:35], v16 offset:24576
 ds_read_b64_tr_b16 v[36:37], v16 offset:18432
 ds_read_b64_tr_b16 v[38:39], v16 offset:26624
 s_add_u32 s3, s63, 8192
 s_waitcnt lgkmcnt(2)
 buffer_store_dwordx4 v[32:35], v1, s[4:7], s3 offen offset:0
 s_waitcnt lgkmcnt(0)
 buffer_store_dwordx4 v[36:39], v1, s[4:7], s3 offen offset:1024
 s_waitcnt lgkmcnt(0)
 s_barrier
 s_lshl_b32 s14, s52, 8
 s_add_u32 s14, s14, 3932160
 s_mov_b32 m0, 122880
 s_nop 0
 buffer_load_dwordx4 v10, s[8:11], s14 offen lds
 s_add_u32 s14, s14, 32768
 s_mov_b32 m0, 123904
 s_nop 0
 buffer_load_dwordx4 v10, s[8:11], s14 offen lds
 s_add_u32 s14, s14, 32768
 s_mov_b32 m0, 124928
 s_nop 0
 buffer_load_dwordx4 v10, s[8:11], s14 offen lds
 s_add_u32 s14, s14, 32768
 s_mov_b32 m0, 125952
 s_nop 0
 buffer_load_dwordx4 v10, s[8:11], s14 offen lds
 s_add_u32 s14, s14, 32768
 s_mov_b32 m0, 126976
 s_nop 0
 buffer_load_dwordx4 v11, s[8:11], s14 offen lds
 s_add_u32 s14, s14, 32768
 s_mov_b32 m0, 128000
 s_nop 0
 buffer_load_dwordx4 v11, s[8:11], s14 offen lds
 s_add_u32 s14, s14, 32768
 s_mov_b32 m0, 129024
 s_nop 0
 buffer_load_dwordx4 v11, s[8:11], s14 offen lds
 s_add_u32 s14, s14, 32768
 s_mov_b32 m0, 130048
 s_nop 0
 buffer_load_dwordx4 v11, s[8:11], s14 offen lds
 s_waitcnt vmcnt(42)
 s_barrier
 v_xor_b32 v16, 0, v12
 v_add_u32 v16, 131072, v16
 ds_read_b64_tr_b16 v[216:217], v16 offset:0
 ds_read_b64_tr_b16 v[218:219], v16 offset:8192
 ds_read_b64_tr_b16 v[220:221], v16 offset:2048
 ds_read_b64_tr_b16 v[222:223], v16 offset:10240
 v_xor_b32 v16, 32, v12
 v_add_u32 v16, 131072, v16
 ds_read_b64_tr_b16 v[40:41], v16 offset:0
 ds_read_b64_tr_b16 v[42:43], v16 offset:8192
 ds_read_b64_tr_b16 v[44:45], v16 offset:2048
 ds_read_b64_tr_b16 v[46:47], v16 offset:10240
 s_add_u32 s3, s63, 10240
 s_waitcnt lgkmcnt(2)
 buffer_store_dwordx4 v[40:43], v1, s[4:7], s3 offen offset:0
 s_waitcnt lgkmcnt(0)
 buffer_store_dwordx4 v[44:47], v1, s[4:7], s3 offen offset:1024
 v_xor_b32 v16, 0, v12
 v_add_u32 v16, 131072, v16
 ds_read_b64_tr_b16 v[224:225], v16 offset:16384
 ds_read_b64_tr_b16 v[226:227], v16 offset:24576
 ds_read_b64_tr_b16 v[228:229], v16 offset:18432
 ds_read_b64_tr_b16 v[230:231], v16 offset:26624
 v_xor_b32 v16, 32, v12
 v_add_u32 v16, 131072, v16
 ds_read_b64_tr_b16 v[232:233], v16 offset:16384
 ds_read_b64_tr_b16 v[234:235], v16 offset:24576
 ds_read_b64_tr_b16 v[236:237], v16 offset:18432
 ds_read_b64_tr_b16 v[238:239], v16 offset:26624
 s_waitcnt lgkmcnt(0)
 s_barrier
 s_lshl_b32 s14, s52, 8
 s_add_u32 s14, s14, 4980736
 s_mov_b32 m0, 155648
 s_nop 0
 buffer_load_dwordx4 v10, s[8:11], s14 offen lds
 s_add_u32 s14, s14, 32768
 s_mov_b32 m0, 156672
 s_nop 0
 buffer_load_dwordx4 v10, s[8:11], s14 offen lds
 s_add_u32 s14, s14, 32768
 s_mov_b32 m0, 157696
 s_nop 0
 buffer_load_dwordx4 v10, s[8:11], s14 offen lds
 s_add_u32 s14, s14, 32768
 s_mov_b32 m0, 158720
 s_nop 0
 buffer_load_dwordx4 v10, s[8:11], s14 offen lds
 s_add_u32 s14, s14, 32768
 s_mov_b32 m0, 159744
 s_nop 0
 buffer_load_dwordx4 v11, s[8:11], s14 offen lds
 s_add_u32 s14, s14, 32768
 s_mov_b32 m0, 160768
 s_nop 0
 buffer_load_dwordx4 v11, s[8:11], s14 offen lds
 s_add_u32 s14, s14, 32768
 s_mov_b32 m0, 161792
 s_nop 0
 buffer_load_dwordx4 v11, s[8:11], s14 offen lds
 s_add_u32 s14, s14, 32768
 s_mov_b32 m0, 162816
 s_nop 0
 buffer_load_dwordx4 v11, s[8:11], s14 offen lds
 s_waitcnt vmcnt(44)
 s_barrier
 v_xor_b32 v16, 0, v12
 v_add_u32 v16, 0, v16
 ds_read_b64_tr_b16 v[240:241], v16 offset:0
 ds_read_b64_tr_b16 v[242:243], v16 offset:8192
 ds_read_b64_tr_b16 v[244:245], v16 offset:2048
 ds_read_b64_tr_b16 v[246:247], v16 offset:10240
 v_xor_b32 v16, 32, v12
 v_add_u32 v16, 0, v16
 ds_read_b64_tr_b16 v[248:249], v16 offset:0
 ds_read_b64_tr_b16 v[250:251], v16 offset:8192
 ds_read_b64_tr_b16 v[252:253], v16 offset:2048
 ds_read_b64_tr_b16 v[254:255], v16 offset:10240
 v_xor_b32 v16, 0, v12
 v_add_u32 v16, 0, v16
 ds_read_b64_tr_b16 v[32:33], v16 offset:16384
 ds_read_b64_tr_b16 v[34:35], v16 offset:24576
 ds_read_b64_tr_b16 v[36:37], v16 offset:18432
 ds_read_b64_tr_b16 v[38:39], v16 offset:26624
 v_xor_b32 v16, 32, v12
 v_add_u32 v16, 0, v16
 ds_read_b64_tr_b16 v[40:41], v16 offset:16384
 ds_read_b64_tr_b16 v[42:43], v16 offset:24576
 ds_read_b64_tr_b16 v[44:45], v16 offset:18432
 ds_read_b64_tr_b16 v[46:47], v16 offset:26624
 s_waitcnt lgkmcnt(0)
 s_barrier
 ds_write_b128 v1, v[232:235] offset:28672
 ds_write_b128 v1, v[236:239] offset:29696
 ds_write_b128 v1, v[224:227] offset:30720
 ds_write_b128 v1, v[228:231] offset:31744
 s_waitcnt lgkmcnt(0)
 v_mov_b32 v232, v32
 v_mov_b32 v233, v33
 v_mov_b32 v234, v34
 v_mov_b32 v235, v35
 v_mov_b32 v236, v36
 v_mov_b32 v237, v37
 v_mov_b32 v238, v38
 v_mov_b32 v239, v39
 v_mov_b32 v224, v40
 v_mov_b32 v225, v41
 v_mov_b32 v226, v42
 v_mov_b32 v227, v43
 v_mov_b32 v228, v44
 v_mov_b32 v229, v45
 v_mov_b32 v230, v46
 v_mov_b32 v231, v47
 s_waitcnt vmcnt(34)
 s_barrier
 v_xor_b32 v16, 0, v12
 v_add_u32 v16, 32768, v16
 ds_read_b64_tr_b16 v[32:33], v16 offset:0
 ds_read_b64_tr_b16 v[34:35], v16 offset:8192
 ds_read_b64_tr_b16 v[36:37], v16 offset:2048
 ds_read_b64_tr_b16 v[38:39], v16 offset:10240
 v_xor_b32 v16, 32, v12
 v_add_u32 v16, 32768, v16
 ds_read_b64_tr_b16 v[40:41], v16 offset:0
 ds_read_b64_tr_b16 v[42:43], v16 offset:8192
 ds_read_b64_tr_b16 v[44:45], v16 offset:2048
 ds_read_b64_tr_b16 v[46:47], v16 offset:10240
 v_xor_b32 v16, 0, v12
 v_add_u32 v16, 32768, v16
 ds_read_b64_tr_b16 v[48:49], v16 offset:16384
 ds_read_b64_tr_b16 v[50:51], v16 offset:24576
 ds_read_b64_tr_b16 v[52:53], v16 offset:18432
 ds_read_b64_tr_b16 v[54:55], v16 offset:26624
 v_xor_b32 v16, 32, v12
 v_add_u32 v16, 32768, v16
 ds_read_b64_tr_b16 v[56:57], v16 offset:16384
 ds_read_b64_tr_b16 v[58:59], v16 offset:24576
 ds_read_b64_tr_b16 v[60:61], v16 offset:18432
 ds_read_b64_tr_b16 v[62:63], v16 offset:26624
 s_waitcnt lgkmcnt(0)
 s_barrier
 ds_write_b128 v1, v[208:211] offset:57344
 ds_write_b128 v1, v[212:215] offset:58368
 ds_write_b128 v1, v[200:203] offset:59392
 ds_write_b128 v1, v[204:207] offset:60416
 ds_write_b128 v1, v[184:187] offset:61440
 ds_write_b128 v1, v[188:191] offset:62464
 ds_write_b128 v1, v[176:179] offset:63488
 ds_write_b128 v1, v[180:183] offset:64512
 s_waitcnt lgkmcnt(0)
 v_mov_b32 v208, v32
 v_mov_b32 v209, v33
 v_mov_b32 v210, v34
 v_mov_b32 v211, v35
 v_mov_b32 v212, v36
 v_mov_b32 v213, v37
 v_mov_b32 v214, v38
 v_mov_b32 v215, v39
 v_mov_b32 v200, v40
 v_mov_b32 v201, v41
 v_mov_b32 v202, v42
 v_mov_b32 v203, v43
 v_mov_b32 v204, v44
 v_mov_b32 v205, v45
 v_mov_b32 v206, v46
 v_mov_b32 v207, v47
 v_mov_b32 v184, v48
 v_mov_b32 v185, v49
 v_mov_b32 v186, v50
 v_mov_b32 v187, v51
 v_mov_b32 v188, v52
 v_mov_b32 v189, v53
 v_mov_b32 v190, v54
 v_mov_b32 v191, v55
 v_mov_b32 v176, v56
 v_mov_b32 v177, v57
 v_mov_b32 v178, v58
 v_mov_b32 v179, v59
 v_mov_b32 v180, v60
 v_mov_b32 v181, v61
 v_mov_b32 v182, v62
 v_mov_b32 v183, v63
 s_waitcnt vmcnt(26)
 s_barrier
 v_xor_b32 v16, 0, v12
 v_add_u32 v16, 65536, v16
 ds_read_b64_tr_b16 v[32:33], v16 offset:0
 ds_read_b64_tr_b16 v[34:35], v16 offset:8192
 ds_read_b64_tr_b16 v[36:37], v16 offset:2048
 ds_read_b64_tr_b16 v[38:39], v16 offset:10240
 v_xor_b32 v16, 32, v12
 v_add_u32 v16, 65536, v16
 ds_read_b64_tr_b16 v[40:41], v16 offset:0
 ds_read_b64_tr_b16 v[42:43], v16 offset:8192
 ds_read_b64_tr_b16 v[44:45], v16 offset:2048
 ds_read_b64_tr_b16 v[46:47], v16 offset:10240
 v_xor_b32 v16, 0, v12
 v_add_u32 v16, 65536, v16
 ds_read_b64_tr_b16 v[48:49], v16 offset:16384
 ds_read_b64_tr_b16 v[50:51], v16 offset:24576
 ds_read_b64_tr_b16 v[52:53], v16 offset:18432
 ds_read_b64_tr_b16 v[54:55], v16 offset:26624
 v_xor_b32 v16, 32, v12
 v_add_u32 v16, 65536, v16
 ds_read_b64_tr_b16 v[56:57], v16 offset:16384
 ds_read_b64_tr_b16 v[58:59], v16 offset:24576
 ds_read_b64_tr_b16 v[60:61], v16 offset:18432
 ds_read_b64_tr_b16 v[62:63], v16 offset:26624
 s_waitcnt lgkmcnt(0)
 s_barrier
 ds_write_b128 v2, v[168:171] offset:24576
 ds_write_b128 v2, v[172:175] offset:25600
 ds_write_b128 v2, v[160:163] offset:26624
 ds_write_b128 v2, v[164:167] offset:27648
 ds_write_b128 v2, v[144:147] offset:28672
 ds_write_b128 v2, v[148:151] offset:29696
 ds_write_b128 v2, v[128:131] offset:30720
 ds_write_b128 v2, v[132:135] offset:31744
 s_waitcnt lgkmcnt(0)
 v_mov_b32 v168, v32
 v_mov_b32 v169, v33
 v_mov_b32 v170, v34
 v_mov_b32 v171, v35
 v_mov_b32 v172, v36
 v_mov_b32 v173, v37
 v_mov_b32 v174, v38
 v_mov_b32 v175, v39
 v_mov_b32 v160, v40
 v_mov_b32 v161, v41
 v_mov_b32 v162, v42
 v_mov_b32 v163, v43
 v_mov_b32 v164, v44
 v_mov_b32 v165, v45
 v_mov_b32 v166, v46
 v_mov_b32 v167, v47
 v_mov_b32 v144, v48
 v_mov_b32 v145, v49
 v_mov_b32 v146, v50
 v_mov_b32 v147, v51
 v_mov_b32 v148, v52
 v_mov_b32 v149, v53
 v_mov_b32 v150, v54
 v_mov_b32 v151, v55
 v_mov_b32 v128, v56
 v_mov_b32 v129, v57
 v_mov_b32 v130, v58
 v_mov_b32 v131, v59
 v_mov_b32 v132, v60
 v_mov_b32 v133, v61
 v_mov_b32 v134, v62
 v_mov_b32 v135, v63
 s_waitcnt vmcnt(10)
 s_barrier
 v_xor_b32 v16, 0, v12
 v_add_u32 v16, 98304, v16
 ds_read_b64_tr_b16 v[32:33], v16 offset:0
 ds_read_b64_tr_b16 v[34:35], v16 offset:8192
 ds_read_b64_tr_b16 v[36:37], v16 offset:2048
 ds_read_b64_tr_b16 v[38:39], v16 offset:10240
 v_xor_b32 v16, 32, v12
 v_add_u32 v16, 98304, v16
 ds_read_b64_tr_b16 v[40:41], v16 offset:0
 ds_read_b64_tr_b16 v[42:43], v16 offset:8192
 ds_read_b64_tr_b16 v[44:45], v16 offset:2048
 ds_read_b64_tr_b16 v[46:47], v16 offset:10240
 v_xor_b32 v16, 0, v12
 v_add_u32 v16, 98304, v16
 ds_read_b64_tr_b16 v[48:49], v16 offset:16384
 ds_read_b64_tr_b16 v[50:51], v16 offset:24576
 ds_read_b64_tr_b16 v[52:53], v16 offset:18432
 ds_read_b64_tr_b16 v[54:55], v16 offset:26624
 v_xor_b32 v16, 32, v12
 v_add_u32 v16, 98304, v16
 ds_read_b64_tr_b16 v[56:57], v16 offset:16384
 ds_read_b64_tr_b16 v[58:59], v16 offset:24576
 ds_read_b64_tr_b16 v[60:61], v16 offset:18432
 ds_read_b64_tr_b16 v[62:63], v16 offset:26624
 s_waitcnt lgkmcnt(0)
 s_barrier
 ds_write_b128 v3, a[136:139] offset:8192
 ds_write_b128 v3, a[140:143] offset:9216
 ds_write_b128 v3, a[128:131] offset:10240
 ds_write_b128 v3, a[132:135] offset:11264
 ds_write_b128 v3, a[120:123] offset:12288
 ds_write_b128 v3, a[124:127] offset:13312
 ds_write_b128 v3, a[88:91] offset:14336
 ds_write_b128 v3, a[92:95] offset:15360
 s_waitcnt lgkmcnt(0)
 v_accvgpr_write_b32 a136, v32
 v_accvgpr_write_b32 a137, v33
 v_accvgpr_write_b32 a138, v34
 v_accvgpr_write_b32 a139, v35
 v_accvgpr_write_b32 a140, v36
 v_accvgpr_write_b32 a141, v37
 v_accvgpr_write_b32 a142, v38
 v_accvgpr_write_b32 a143, v39
 v_accvgpr_write_b32 a128, v40
 v_accvgpr_write_b32 a129, v41
 v_accvgpr_write_b32 a130, v42
 v_accvgpr_write_b32 a131, v43
 v_accvgpr_write_b32 a132, v44
 v_accvgpr_write_b32 a133, v45
 v_accvgpr_write_b32 a134, v46
 v_accvgpr_write_b32 a135, v47
 v_accvgpr_write_b32 a120, v48
 v_accvgpr_write_b32 a121, v49
 v_accvgpr_write_b32 a122, v50
 v_accvgpr_write_b32 a123, v51
 v_accvgpr_write_b32 a124, v52
 v_accvgpr_write_b32 a125, v53
 v_accvgpr_write_b32 a126, v54
 v_accvgpr_write_b32 a127, v55
 v_accvgpr_write_b32 a88, v56
 v_accvgpr_write_b32 a89, v57
 v_accvgpr_write_b32 a90, v58
 v_accvgpr_write_b32 a91, v59
 v_accvgpr_write_b32 a92, v60
 v_accvgpr_write_b32 a93, v61
 v_accvgpr_write_b32 a94, v62
 v_accvgpr_write_b32 a95, v63
 s_waitcnt vmcnt(0)
 s_barrier
 v_xor_b32 v16, 0, v12
 v_add_u32 v16, 131072, v16
 ds_read_b64_tr_b16 v[32:33], v16 offset:0
 ds_read_b64_tr_b16 v[34:35], v16 offset:8192
 ds_read_b64_tr_b16 v[36:37], v16 offset:2048
 ds_read_b64_tr_b16 v[38:39], v16 offset:10240
 v_xor_b32 v16, 32, v12
 v_add_u32 v16, 131072, v16
 ds_read_b64_tr_b16 v[40:41], v16 offset:0
 ds_read_b64_tr_b16 v[42:43], v16 offset:8192
 ds_read_b64_tr_b16 v[44:45], v16 offset:2048
 ds_read_b64_tr_b16 v[46:47], v16 offset:10240
 v_xor_b32 v16, 0, v12
 v_add_u32 v16, 131072, v16
 ds_read_b64_tr_b16 v[48:49], v16 offset:16384
 ds_read_b64_tr_b16 v[50:51], v16 offset:24576
 ds_read_b64_tr_b16 v[52:53], v16 offset:18432
 ds_read_b64_tr_b16 v[54:55], v16 offset:26624
 v_xor_b32 v16, 32, v12
 v_add_u32 v16, 131072, v16
 ds_read_b64_tr_b16 v[56:57], v16 offset:16384
 ds_read_b64_tr_b16 v[58:59], v16 offset:24576
 ds_read_b64_tr_b16 v[60:61], v16 offset:18432
 ds_read_b64_tr_b16 v[62:63], v16 offset:26624
 s_waitcnt lgkmcnt(0)
 s_barrier
 ds_write_b128 v3, a[80:83] offset:40960
 ds_write_b128 v3, a[84:87] offset:41984
 ds_write_b128 v3, a[72:75] offset:43008
 ds_write_b128 v3, a[76:79] offset:44032
 ds_write_b128 v3, a[32:35] offset:45056
 ds_write_b128 v3, a[36:39] offset:46080
 ds_write_b128 v3, a[16:19] offset:47104
 ds_write_b128 v3, a[20:23] offset:48128
 s_waitcnt lgkmcnt(0)
 v_accvgpr_write_b32 a80, v32
 v_accvgpr_write_b32 a81, v33
 v_accvgpr_write_b32 a82, v34
 v_accvgpr_write_b32 a83, v35
 v_accvgpr_write_b32 a84, v36
 v_accvgpr_write_b32 a85, v37
 v_accvgpr_write_b32 a86, v38
 v_accvgpr_write_b32 a87, v39
 v_accvgpr_write_b32 a72, v40
 v_accvgpr_write_b32 a73, v41
 v_accvgpr_write_b32 a74, v42
 v_accvgpr_write_b32 a75, v43
 v_accvgpr_write_b32 a76, v44
 v_accvgpr_write_b32 a77, v45
 v_accvgpr_write_b32 a78, v46
 v_accvgpr_write_b32 a79, v47
 v_accvgpr_write_b32 a32, v48
 v_accvgpr_write_b32 a33, v49
 v_accvgpr_write_b32 a34, v50
 v_accvgpr_write_b32 a35, v51
 v_accvgpr_write_b32 a36, v52
 v_accvgpr_write_b32 a37, v53
 v_accvgpr_write_b32 a38, v54
 v_accvgpr_write_b32 a39, v55
 v_accvgpr_write_b32 a16, v56
 v_accvgpr_write_b32 a17, v57
 v_accvgpr_write_b32 a18, v58
 v_accvgpr_write_b32 a19, v59
 v_accvgpr_write_b32 a20, v60
 v_accvgpr_write_b32 a21, v61
 v_accvgpr_write_b32 a22, v62
 v_accvgpr_write_b32 a23, v63
 v_lshlrev_b32 v5, 3, v0
 v_and_b32 v6, 0x1e0, v5
 v_and_b32 v7, 1, v0
 v_lshl_add_u32 v6, v7, 4, v6
 v_and_b32 v7, 2, v0
 v_lshl_add_u32 v6, v7, 2, v6
 v_bfe_u32 v4, v0, 2, 2
 v_lshrrev_b32 v7, 4, v0
 v_cmp_eq_u32 vcc, v4, v7
 v_and_b32 v7, 16, v1
 v_mov_b32 v5, 0x3f80
 v_lshlrev_b32 v7, v7, v5
 v_cndmask_b32 v4, 0, v7, vcc
 v_mov_b32 v5, 0
 s_lshl_b32 s59, s53, 16
 s_add_u32 s59, s59, 983040
 s_mul_i32 s15, s53, 327680
 s_add_u32 s15, s15, 225280
 s_lshl_b32 s3, s52, 6
 s_add_u32 s15, s15, s3
 s_add_u32 s64, s15, 8192
 s_add_u32 s65, s15, 172032
 s_lshr_b32 s14, s52, 4
 s_add_u32 s14, s14, 8
 s_bfe_u32 s15, s52, 0x20002
 s_and_b32 s16, s52, 3
 s_mov_b32 s84, 0x000f000f
 s_mov_b32 s85, 0
 s_lshl_b32 s57, s14, 10
 s_lshl_b32 s3, s15, 6
 s_add_u32 s57, s57, s3
 s_lshl_b32 s3, s16, 8
 s_add_u32 s57, s57, s3
 s_add_u32 s57, s57, s59
 s_add_u32 s59, s59, 6144
 s_add_u32 s16, s60, 3072
 s_waitcnt vmcnt(0) lgkmcnt(0)
 s_mov_b32 s96, s44
 s_and_b32 s97, s45, 0xffff
 s_mov_b32 s98, 256
 s_mov_b32 s99, 0x00020000
 v_mov_b32 v8, 132
 s_mov_b32 s51, 0
 s_mov_b64 exec, 1
L_wb_202:
 buffer_load_dword v9, v8, s[96:99], 0 offen sc1
 s_waitcnt vmcnt(0)
 v_cmp_eq_u32 vcc, 0, v9
 s_cbranch_vccz L_wbd_203
 s_sleep 2
 s_add_u32 s51, s51, 1
 s_cmp_lt_u32 s51, 131072
 s_cbranch_scc1 L_wb_202
 s_branch L_bail
L_wbd_203:
 s_mov_b64 exec, -1
 s_mov_b32 s96, s44
 s_and_b32 s97, s45, 0xffff
 s_mov_b32 s98, 256
 s_mov_b32 s99, 0x00020000
 v_mov_b32 v8, 212
 s_mov_b32 s51, 0
 s_mov_b64 exec, 1
L_wb_204:
 buffer_load_dword v9, v8, s[96:99], 0 offen sc1
 s_waitcnt vmcnt(0)
 v_cmp_eq_u32 vcc, 0, v9
 s_cbranch_vccz L_wbd_205
 s_sleep 2
 s_add_u32 s51, s51, 1
 s_cmp_lt_u32 s51, 131072
 s_cbranch_scc1 L_wb_204
 s_branch L_bail
L_wbd_205:
 s_mov_b64 exec, -1
 s_mov_b32 s96, s44
 s_and_b32 s97, s45, 0xffff
 s_mov_b32 s98, 256
 s_mov_b32 s99, 0x00020000
 v_lshlrev_b32 v8, 5, v0
 s_mov_b32 s51, 0
L_gl_206:
 buffer_load_dword v9, v8, s[96:99], 0 offen sc1
 s_waitcnt vmcnt(0)
 v_readlane_b32 s3, v9, s48
 s_mov_b32 s80, 0
 s_nop 2
 s_cmp_ge_u32 s3, 32
 s_cbranch_scc1 L_gld_207
 s_mov_b32 s80, 0
 v_readlane_b32 s3, v9, 0
 s_nop 3
 s_add_u32 s80, s80, s3
 v_readlane_b32 s3, v9, 1
 s_nop 3
 s_add_u32 s80, s80, s3
 v_readlane_b32 s3, v9, 2
 s_nop 3
 s_add_u32 s80, s80, s3
 v_readlane_b32 s3, v9, 3
 s_nop 3
 s_add_u32 s80, s80, s3
 v_readlane_b32 s3, v9, 4
 s_nop 3
 s_add_u32 s80, s80, s3
 v_readlane_b32 s3, v9, 5
 s_nop 3
 s_add_u32 s80, s80, s3
 v_readlane_b32 s3, v9, 6
 s_nop 3
 s_add_u32 s80, s80, s3
 v_readlane_b32 s3, v9, 7
 s_nop 3
 s_add_u32 s80, s80, s3
 s_cmp_ge_u32 s80, 256
 s_cbranch_scc1 L_gld_207
 s_sleep 4
 s_add_u32 s51, s51, 1
 s_cmp_lt_u32 s51, 131072
 s_cbranch_scc1 L_gl_206
 s_branch L_bail
L_gld_207:
 s_mov_b32 s51, 0
L_f0_208:
 v_mov_b32 v7, 0
 s_mov_b64 exec, 1
 buffer_atomic_add v7, off, s[4:7], s12 sc0
 s_mov_b64 exec, -1
 s_waitcnt vmcnt(0)
 v_readfirstlane_b32 s3, v7
 s_nop 3
 s_cmp_ge_u32 s3, 8
 s_cbranch_scc1 L_f0d_209
 s_sleep 8
 s_add_u32 s51, s51, 1
 s_cmp_lt_u32 s51, 131072
 s_cbranch_scc1 L_f0_208
 s_branch L_bail
L_f0d_209:
 s_add_u32 s12, s12, 4
 v_and_b32 v7, 2, v0
 v_mul_u32_u24 v7, 0x5555, v7
 v_add_u32 v0, 0x4444, v7
 s_mov_b32 m0, 2048
 s_waitcnt vmcnt(0) lgkmcnt(0)
 s_barrier
 buffer_load_dwordx4 v[32:35], v1, s[4:7], s63 offen offset:2048
 buffer_load_dwordx4 v[36:39], v1, s[4:7], s63 offen offset:3072
 buffer_load_dwordx4 v[40:43], v1, s[4:7], s81 offen offset:0
 buffer_load_dwordx4 v[44:47], v1, s[4:7], s81 offen offset:1024
 buffer_load_dwordx4 v[48:51], v1, s[4:7], s81 offen offset:2048
 buffer_load_dwordx4 v[52:55], v1, s[4:7], s81 offen offset:3072
 buffer_load_dwordx4 v[56:59], v1, s[4:7], s101 offen offset:0
 buffer_load_dwordx4 v[60:63], v1, s[4:7], s101 offen offset:1024
 ds_read_b128 v[8:11], v3 offset:49152
 ds_read_b128 v[12:15], v3 offset:49152
 ds_read_b128 v[16:19], v3 offset:49152
 ds_read_b128 v[20:23], v3 offset:49152
 s_waitcnt vmcnt(0) lgkmcnt(0)
 s_cmp_lg_u32 s80, 0
 s_cbranch_scc1 L_ch3_s
.p2align 6
L_ch3_f:
 s_mov_b32 s51, 0
L_pm_210:
 buffer_load_dwordx4 v[24:27], v1, s[4:7], s59 offen offset:0 sc1
 buffer_load_dwordx4 v[28:31], v1, s[4:7], s59 offen offset:1024 sc1
 s_add_u32 s3, s59, 3072
 buffer_load_dwordx4 v[12:15], v1, s[4:7], s3 offen offset:0 sc1
 s_waitcnt vmcnt(2)
 ds_write_b128 v1, v[24:27] offset:6144
 v_max_u32 v7, v24, v26
 s_waitcnt vmcnt(1)
 ds_write_b128 v1, v[28:31] offset:7168
 v_max3_u32 v7, v7, v28, v30
 s_waitcnt vmcnt(0)
 ds_write_b128 v1, v[12:15] offset:9216
 v_max3_u32 v7, v7, v12, v14
 v_cmp_eq_u32 vcc, -1, v7
 s_cbranch_vccnz L_rt_211
 ds_read_b128 v[12:15], v3 offset:49152
 v_smfmac_f32_16x16x64_bf16 v[16:19], v[24:27], v[32:39], v0
 ds_read_b128 v[32:35], v1 offset:30720
 ds_read_b128 v[36:39], v1 offset:31744
 v_smfmac_f32_16x16x64_bf16 v[20:23], v[24:27], v[40:47], v0
 ds_read_b128 v[40:43], v1 offset:28672
 ds_read_b128 v[44:47], v1 offset:29696
 v_smfmac_f32_16x16x64_bf16 v[16:19], v[28:31], v[48:55], v0
 v_smfmac_f32_16x16x64_bf16 v[20:23], v[28:31], v[56:63], v0
 s_waitcnt lgkmcnt(5)
 s_barrier
 buffer_load_dwordx4 v[56:59], v1, s[4:7], s63 offen offset:0
 v_smfmac_f32_16x16x64_bf16 v[8:11], v[24:27], a[136:143], v0
 s_waitcnt lgkmcnt(4)
 v_smfmac_f32_16x16x64_bf16 v[12:15], v[24:27], a[128:135], v0
 ds_read_b128 v[24:27], v1 offset:9216
 buffer_load_dwordx4 v[60:63], v1, s[4:7], s63 offen offset:1024
 v_smfmac_f32_16x16x64_bf16 v[8:11], v[28:31], a[120:127], v0
 v_smfmac_f32_16x16x64_bf16 v[12:15], v[28:31], a[88:95], v0
 ds_read_b128 v[28:31], v1 offset:0
 buffer_load_dwordx4 v[48:51], v1, s[4:7], s101 offen offset:2048
 s_waitcnt lgkmcnt(1)
 v_smfmac_f32_16x16x64_bf16 v[16:19], v[24:27], v[32:39], v0
 ds_read_b128 v[32:35], v2 offset:30720
 ds_read_b128 v[36:39], v2 offset:31744
 v_smfmac_f32_16x16x64_bf16 v[8:11], v[24:27], a[32:39], v0
 buffer_load_dwordx4 v[52:55], v1, s[4:7], s101 offen offset:3072
 v_smfmac_f32_16x16x64_bf16 v[12:15], v[24:27], a[16:23], v0
 v_smfmac_f32_16x16x64_bf16 v[20:23], v[24:27], v[40:47], v0
 ds_read_b128 v[40:43], v2 offset:28672
 ds_read_b128 v[44:47], v2 offset:29696
 ds_read_b128 v[24:27], v1 offset:1024
 s_waitcnt lgkmcnt(5)
 v_smfmac_f32_16x16x64_bf16 v[8:11], v[28:31], v[240:247], v0
 v_smfmac_f32_16x16x64_bf16 v[12:15], v[28:31], v[248:255], v0
 s_waitcnt lgkmcnt(3)
 v_smfmac_f32_16x16x64_bf16 v[16:19], v[28:31], v[32:39], v0
 ds_read_b128 v[32:35], v2 offset:26624
 ds_read_b128 v[36:39], v2 offset:27648
 v_smfmac_f32_16x16x64_bf16 v[20:23], v[28:31], v[136:143], v0
 ds_read_b128 v[28:31], v1 offset:2048
 s_waitcnt lgkmcnt(3)
 v_smfmac_f32_16x16x64_bf16 v[8:11], v[24:27], v[232:239], v0
 v_smfmac_f32_16x16x64_bf16 v[16:19], v[24:27], v[40:47], v0
 ds_read_b128 v[40:43], v2 offset:24576
 ds_read_b128 v[44:47], v2 offset:25600
 v_smfmac_f32_16x16x64_bf16 v[12:15], v[24:27], v[224:231], v0
 v_smfmac_f32_16x16x64_bf16 v[20:23], v[24:27], v[152:159], v0
 ds_read_b128 v[24:27], v1 offset:3072
 s_waitcnt lgkmcnt(3)
 v_smfmac_f32_16x16x64_bf16 v[16:19], v[28:31], v[32:39], v0
 ds_read_b128 v[32:35], v1 offset:63488
 ds_read_b128 v[36:39], v1 offset:64512
 v_smfmac_f32_16x16x64_bf16 v[8:11], v[28:31], v[208:215], v0
 v_smfmac_f32_16x16x64_bf16 v[12:15], v[28:31], v[200:207], v0
 s_waitcnt lgkmcnt(3)
 v_smfmac_f32_16x16x64_bf16 v[20:23], v[28:31], v[40:47], v0
 ds_read_b128 v[40:43], v1 offset:61440
 ds_read_b128 v[44:47], v1 offset:62464
 ds_read_b128 v[28:31], v1 offset:4096
 s_waitcnt lgkmcnt(5)
 v_smfmac_f32_16x16x64_bf16 v[8:11], v[24:27], v[184:191], v0
 v_smfmac_f32_16x16x64_bf16 v[12:15], v[24:27], v[176:183], v0
 s_waitcnt lgkmcnt(3)
 v_smfmac_f32_16x16x64_bf16 v[16:19], v[24:27], v[32:39], v0
 ds_read_b128 v[32:35], v1 offset:59392
 ds_read_b128 v[36:39], v1 offset:60416
 s_waitcnt vmcnt(2)
 v_smfmac_f32_16x16x64_bf16 v[20:23], v[24:27], v[56:63], v0
 ds_read_b128 v[24:27], v1 offset:5120
 buffer_load_dwordx4 v[56:59], v1, s[4:7], s61 offen offset:3072 sc1 nt
 s_waitcnt lgkmcnt(3)
 v_smfmac_f32_16x16x64_bf16 v[8:11], v[28:31], v[168:175], v0
 v_smfmac_f32_16x16x64_bf16 v[16:19], v[28:31], v[40:47], v0
 ds_read_b128 v[40:43], v1 offset:57344
 ds_read_b128 v[44:47], v1 offset:58368
 s_add_u32 s3, s61, 4096
 buffer_load_dwordx4 v[60:63], v1, s[4:7], s3 offen offset:3072 sc1 nt
 v_smfmac_f32_16x16x64_bf16 v[12:15], v[28:31], v[160:167], v0
 v_smfmac_f32_16x16x64_bf16 v[20:23], v[28:31], v[192:199], v0
 ds_read_b128 v[28:31], v1 offset:8192
 s_waitcnt lgkmcnt(3)
 v_smfmac_f32_16x16x64_bf16 v[16:19], v[24:27], v[32:39], v0
 v_smfmac_f32_16x16x64_bf16 v[8:11], v[24:27], v[144:151], v0
 s_add_u32 s3, s61, 67115008
 buffer_load_dwordx4 v[32:35], v1, s[4:7], s3 offen offset:0 sc1 nt
 v_smfmac_f32_16x16x64_bf16 v[12:15], v[24:27], v[128:135], v0
 s_waitcnt lgkmcnt(1)
 v_smfmac_f32_16x16x64_bf16 v[20:23], v[24:27], v[40:47], v0
 ds_read_b128 v[40:43], v3 offset:49152
 ds_read_b128 v[44:47], v3 offset:49152
 buffer_load_dwordx4 v[36:39], v1, s[4:7], s3 offen offset:1024 sc1 nt
 s_waitcnt lgkmcnt(2)
 v_smfmac_f32_16x16x64_bf16 v[8:11], v[28:31], a[80:87], v0
 v_smfmac_f32_16x16x64_bf16 v[12:15], v[28:31], a[72:79], v0
 v_smfmac_f32_16x16x64_bf16 v[16:19], v[28:31], v[216:223], v0
 s_waitcnt vmcnt(4)
 v_smfmac_f32_16x16x64_bf16 v[20:23], v[28:31], v[48:55], v0
 ds_read_b128 v[52:55], v1 offset:0
 v_add_f32 v8, v8, v10
 v_add_f32 v11, v9, v11
 v_cvt_pk_bf16_f32 v9, v8, v11
 v_cvt_pk_bf16_f32 v8, v8, v11
 v_add_f32 v12, v12, v14
 v_add_f32 v15, v13, v15
 v_cvt_pk_bf16_f32 v13, v12, v15
 v_cvt_pk_bf16_f32 v12, v12, v15
 v_mfma_f32_16x16x16_bf16 v[8:11], v[8:9], v[4:5], 0
 v_mfma_f32_16x16x16_bf16 v[12:15], v[12:13], v[4:5], 0
 v_add_f32 v16, v16, v18
 v_add_f32 v19, v17, v19
 v_cvt_pk_bf16_f32 v17, v16, v19
 v_cvt_pk_bf16_f32 v16, v16, v19
 v_add_f32 v20, v20, v22
 v_add_f32 v23, v21, v23
 v_cvt_pk_bf16_f32 v21, v20, v23
 v_cvt_pk_bf16_f32 v20, v20, v23
 v_mfma_f32_16x16x16_bf16 v[16:19], v[16:17], v[4:5], 0
 v_mfma_f32_16x16x16_bf16 v[20:23], v[20:21], v[4:5], 0
 s_waitcnt lgkmcnt(2)
 v_smfmac_f32_16x16x64_bf16 v[40:43], v[24:27], a[240:247], v0
 s_waitcnt lgkmcnt(1)
 v_smfmac_f32_16x16x64_bf16 v[44:47], v[24:27], a[248:255], v0
 ds_read_b128 v[24:27], v1 offset:1024
 v_cvt_pk_bf16_f32 v15, v14, v15
 v_cvt_pk_bf16_f32 v14, v12, v13
 v_cvt_pk_bf16_f32 v13, v10, v11
 v_cvt_pk_bf16_f32 v12, v8, v9
 s_waitcnt vmcnt(3)
 s_nop 0
 v_mfma_f32_16x16x32_bf16 v[8:11], v[56:59], v[12:15], 0
 v_cvt_pk_bf16_f32 v23, v22, v23
 v_cvt_pk_bf16_f32 v22, v20, v21
 v_cvt_pk_bf16_f32 v21, v18, v19
 v_cvt_pk_bf16_f32 v20, v16, v17
 s_waitcnt vmcnt(2)
 v_mfma_f32_16x16x32_bf16 v[16:19], v[60:63], v[12:15], 0
 v_mfma_f32_16x16x32_bf16 v[48:51], v[20:23], v[12:15], 0
 v_smfmac_f32_16x16x64_bf16 v[40:43], v[28:31], v[96:103], v0
 v_smfmac_f32_16x16x64_bf16 v[44:47], v[28:31], v[104:111], v0
 ds_read_b128 v[28:31], v1 offset:2048
 s_waitcnt lgkmcnt(2)
 v_smfmac_f32_16x16x64_bf16 v[40:43], v[52:55], a[160:167], v0
 v_cndmask_b32 v8, v8, v16, s[70:71]
 v_cndmask_b32 v9, v9, v17, s[70:71]
 v_cndmask_b32 v10, v10, v18, s[70:71]
 v_cndmask_b32 v11, v11, v19, s[70:71]
 ds_write_b128 v1, v[8:11] offset:13312
 ds_write_b64 v1, v[48:49] offset:15368
 v_smfmac_f32_16x16x64_bf16 v[44:47], v[52:55], a[168:175], v0
 ds_read_b128 v[52:55], v1 offset:3072
 s_waitcnt lgkmcnt(4)
 v_smfmac_f32_16x16x64_bf16 v[40:43], v[24:27], a[176:183], v0
 v_smfmac_f32_16x16x64_bf16 v[44:47], v[24:27], a[184:191], v0
 ds_read_b128 v[24:27], v1 offset:4096
 s_waitcnt lgkmcnt(4)
 v_smfmac_f32_16x16x64_bf16 v[40:43], v[28:31], a[192:199], v0
 v_smfmac_f32_16x16x64_bf16 v[44:47], v[28:31], a[200:207], v0
 ds_read_b128 v[28:31], v1 offset:6144
 s_waitcnt lgkmcnt(2)
 v_smfmac_f32_16x16x64_bf16 v[40:43], v[52:55], a[208:215], v0
 v_smfmac_f32_16x16x64_bf16 v[44:47], v[52:55], a[216:223], v0
 ds_read_b128 v[52:55], v1 offset:7168
 s_barrier
 ds_read_b128 v[56:59], v1 offset:10240
 ds_read_b128 v[60:63], v1 offset:11264
 ds_read_b128 v[16:19], v1 offset:12288
 ds_read_b128 v[12:15], v1 offset:14336
 ds_read_b128 v[48:51], v1 offset:15360
 s_waitcnt lgkmcnt(7)
 v_smfmac_f32_16x16x64_bf16 v[40:43], v[24:27], a[224:231], v0
 s_mov_b64 exec, s[68:69]
 buffer_store_dwordx4 v[20:23], v6, s[4:7], s62 offen offset:1536 sc1
 s_mov_b64 exec, -1
 v_smfmac_f32_16x16x64_bf16 v[44:47], v[24:27], a[232:239], v0
 ds_read_b128 v[24:27], v1 offset:9216
 v_mov_b32 v7, 0
 s_waitcnt lgkmcnt(7)
 v_smfmac_f32_16x16x64_bf16 v[40:43], v[28:31], v[64:71], v0
 s_mov_b64 exec, 1
 buffer_atomic_add v7, off, s[4:7], s12 sc0
 s_mov_b64 exec, 2
 buffer_atomic_add v7, off, s[4:7], s13 sc0
 s_mov_b64 exec, -1
 v_smfmac_f32_16x16x64_bf16 v[44:47], v[28:31], v[72:79], v0
 s_waitcnt lgkmcnt(6)
 v_smfmac_f32_16x16x64_bf16 v[40:43], v[52:55], v[80:87], v0
 v_smfmac_f32_16x16x64_bf16 v[44:47], v[52:55], v[88:95], v0
 s_waitcnt lgkmcnt(0)
 v_smfmac_f32_16x16x64_bf16 v[40:43], v[24:27], v[112:119], v0
 v_smfmac_f32_16x16x64_bf16 v[44:47], v[24:27], v[120:127], v0
 v_pk_add_f32 v[8:9], v[8:9], v[56:57]
 v_pk_add_f32 v[10:11], v[10:11], v[58:59]
 v_pk_add_f32 v[60:61], v[60:61], v[16:17]
 v_pk_add_f32 v[62:63], v[62:63], v[18:19]
 v_pk_add_f32 v[12:13], v[12:13], v[14:15]
 v_pk_add_f32 v[48:49], v[48:49], v[50:51]
 v_pk_add_f32 v[8:9], v[8:9], v[60:61]
 v_pk_add_f32 v[10:11], v[10:11], v[62:63]
 v_pk_add_f32 v[48:49], v[12:13], v[48:49]
 v_max3_f32 v50, v8, v9, v10
 v_max3_f32 v50, v50, v11, v48
 v_max_f32 v50, v50, v49
 v_add_f32 v40, v40, v42
 v_add_f32 v41, v41, v43
 v_max_f32_dpp v50, v50, v50 quad_perm:[2,3,0,1] row_mask:0xf bank_mask:0xf
 v_mov_b32 v51, v50
 v_add_f32 v44, v44, v46
 v_add_f32 v45, v45, v47
 v_permlane16_swap_b32 v50, v51
 v_max_f32 v50, v50, v51
 v_mov_b32 v51, v50
 v_cvt_pk_bf16_f32 v40, v40, v41
 v_cvt_pk_bf16_f32 v41, v44, v45
 v_permlane32_swap_b32 v50, v51
 v_max_f32 v50, v50, v51
 v_mul_f32 v50, s56, v50
 v_fma_f32 v48, v48, s56, -v50
 v_fma_f32 v49, v49, s56, -v50
 v_fma_f32 v8, v8, s56, -v50
 v_fma_f32 v9, v9, s56, -v50
 v_fma_f32 v10, v10, s56, -v50
 v_fma_f32 v11, v11, s56, -v50
 v_exp_f32 v48, v48
 v_lshrrev_b32 v51, 1, v1
 v_exp_f32 v49, v49
 ds_read_b128 v[56:59], v3 offset:14336
 ds_read_b128 v[60:63], v3 offset:15360
 v_exp_f32 v8, v8
 v_exp_f32 v9, v9
 ds_read_b128 v[24:27], v3 offset:12288
 ds_read_b128 v[28:31], v3 offset:13312
 v_exp_f32 v10, v10
 buffer_store_dwordx2 v[40:41], v51, s[4:7], s62 offen offset:3584 sc1
 v_exp_f32 v11, v11
 v_cvt_pk_bf16_f32 v14, v48, v49
 v_cvt_pk_bf16_f32 v12, v8, v9
 v_cvt_pk_bf16_f32 v13, v10, v11
 v_cndmask_b32 v52, 0, v14, s[68:69]
 v_cndmask_b32 v53, 0, v14, s[70:71]
 v_cndmask_b32 v22, 0, v12, s[70:71]
 v_cndmask_b32 v23, 0, v13, s[70:71]
 v_mfma_f32_16x16x16_bf16 v[44:47], v[40:41], v[52:53], 0
 v_cndmask_b32 v16, 0, v12, s[68:69]
 v_cndmask_b32 v17, 0, v13, s[68:69]
 v_mov_b32_dpp v18, v22 quad_perm:[2,3,0,1] row_mask:0xf bank_mask:0xf
 v_mov_b32_dpp v19, v23 quad_perm:[2,3,0,1] row_mask:0xf bank_mask:0xf
 v_mov_b32_dpp v20, v16 quad_perm:[2,3,0,1] row_mask:0xf bank_mask:0xf
 v_mov_b32_dpp v21, v17 quad_perm:[2,3,0,1] row_mask:0xf bank_mask:0xf
 s_waitcnt vmcnt(5)
 v_mfma_f32_16x16x32_bf16 v[44:47], v[32:35], v[16:19], v[44:47]
 v_add_f32 v54, v8, v9
 v_add_f32 v55, v48, v49
 s_waitcnt vmcnt(4)
 v_mfma_f32_16x16x32_bf16 v[44:47], v[36:39], v[20:23], v[44:47]
 v_add_f32 v54, v54, v10
 v_fma_f32 v55, v55, 0.5, v11
 v_add_f32 v54, v54, v55
 ds_read_b128 v[16:19], v3 offset:49152
 ds_read_b128 v[20:23], v3 offset:49152
 v_add_f32_dpp v54, v54, v54 quad_perm:[2,3,0,1] row_mask:0xf bank_mask:0xf
 v_mov_b32 v55, v54
 ds_read_b128 v[32:35], v3 offset:49152
 ds_read_b128 v[36:39], v3 offset:49152
 v_permlane16_swap_b32 v54, v55
 v_add_f32 v54, v54, v55
 v_mov_b32 v55, v54
 ds_read_b128 v[8:11], v3 offset:49152
 s_cmp_eq_u32 s54, 63
 v_permlane32_swap_b32 v54, v55
 v_add_f32 v54, v54, v55
 v_rcp_f32 v54, v54
 s_cbranch_scc1 L_ch3_end
 v_mul_f32 v44, v44, v54
 v_mul_f32 v45, v45, v54
 v_cvt_pk_bf16_f32 v42, v44, v45
 v_mul_f32 v46, v46, v54
 v_mul_f32 v47, v47, v54
 v_cvt_pk_bf16_f32 v43, v46, v47
 ds_write_b64 v6, v[42:43] offset:1536
 v_and_b32 v40, -9, v6
 v_mov_b32_dpp v12, v42 quad_perm:[0,1,0,1] row_mask:0xf bank_mask:0xf
 v_mov_b32_dpp v14, v42 quad_perm:[2,3,2,3] row_mask:0xf bank_mask:0xf
 v_mov_b32_dpp v13, v43 quad_perm:[0,1,0,1] row_mask:0xf bank_mask:0xf
 v_mov_b32_dpp v15, v43 quad_perm:[2,3,2,3] row_mask:0xf bank_mask:0xf
 s_waitcnt lgkmcnt(5)
 s_nop 0
 v_smfmac_f32_16x16x64_bf16 v[16:19], v[12:15], a[24:31], v0
 s_waitcnt lgkmcnt(4)
 v_smfmac_f32_16x16x64_bf16 v[20:23], v[12:15], a[56:63], v0
 s_waitcnt lgkmcnt(0)
 s_barrier
 ds_read_b128 v[48:51], v40 offset:0
 ds_read_b128 v[52:55], v40 offset:512
 ds_read_b128 v[44:47], v40 offset:1024
 v_smfmac_f32_16x16x64_bf16 v[32:35], v[12:15], v[56:63], v0
 ds_read_b128 v[56:59], v3 offset:47104
 ds_read_b128 v[60:63], v3 offset:48128
 s_mov_b32 m0, 6144
 v_smfmac_f32_16x16x64_bf16 v[36:39], v[12:15], v[24:31], v0
 ds_read_b128 v[24:27], v3 offset:45056
 ds_read_b128 v[28:31], v3 offset:46080
 buffer_load_dwordx4 v1, s[4:7], s81 offen offset:0 lds
 v_smfmac_f32_16x16x64_bf16 v[8:11], v[12:15], a[152:159], v0
 s_mov_b32 m0, 6144
 s_waitcnt lgkmcnt(6)
 v_smfmac_f32_16x16x64_bf16 v[16:19], v[48:51], a[0:7], v0
 buffer_load_dwordx4 v1, s[4:7], s81 offen offset:1024 lds
 s_waitcnt lgkmcnt(5)
 v_smfmac_f32_16x16x64_bf16 v[16:19], v[52:55], a[8:15], v0
 s_mov_b32 m0, 7168
 s_waitcnt lgkmcnt(2)
 v_smfmac_f32_16x16x64_bf16 v[16:19], v[44:47], v[56:63], v0
 ds_read_b128 v[56:59], v3 offset:43008
 ds_read_b128 v[60:63], v3 offset:44032
 buffer_load_dwordx4 v1, s[4:7], s81 offen offset:2048 lds
 s_waitcnt lgkmcnt(2)
 v_smfmac_f32_16x16x64_bf16 v[20:23], v[48:51], v[24:31], v0
 ds_read_b128 v[24:27], v3 offset:40960
 ds_read_b128 v[28:31], v3 offset:41984
 v_smfmac_f32_16x16x64_bf16 v[20:23], v[52:55], a[40:47], v0
 v_smfmac_f32_16x16x64_bf16 v[20:23], v[44:47], a[48:55], v0
 v_cvt_pk_bf16_f32 v16, v16, v17
 v_smfmac_f32_16x16x64_bf16 v[32:35], v[48:51], a[64:71], v0
 v_cvt_pk_bf16_f32 v17, v18, v19
 s_waitcnt lgkmcnt(2)
 v_smfmac_f32_16x16x64_bf16 v[32:35], v[52:55], v[56:63], v0
 ds_read_b128 v[56:59], v3 offset:10240
 ds_read_b128 v[60:63], v3 offset:11264
 v_and_or_b32 v16, v16, -2, s55
 s_waitcnt lgkmcnt(2)
 v_smfmac_f32_16x16x64_bf16 v[32:35], v[44:47], v[24:31], v0
 ds_read_b128 v[24:27], v3 offset:8192
 ds_read_b128 v[28:31], v3 offset:9216
 v_cvt_pk_bf16_f32 v18, v20, v21
 v_smfmac_f32_16x16x64_bf16 v[36:39], v[48:51], a[96:103], v0
 v_cvt_pk_bf16_f32 v19, v22, v23
 v_smfmac_f32_16x16x64_bf16 v[36:39], v[52:55], a[104:111], v0
 v_and_or_b32 v18, v18, -2, s55
 buffer_store_dwordx4 v[16:19], v1, s[4:7], s60 offen offset:0
 v_smfmac_f32_16x16x64_bf16 v[36:39], v[44:47], a[112:119], v0
 v_cvt_pk_bf16_f32 v32, v32, v33
 s_waitcnt lgkmcnt(2)
 v_smfmac_f32_16x16x64_bf16 v[8:11], v[48:51], v[56:63], v0
 v_cvt_pk_bf16_f32 v33, v34, v35
 s_waitcnt lgkmcnt(0)
 v_smfmac_f32_16x16x64_bf16 v[8:11], v[52:55], v[24:31], v0
 v_and_or_b32 v32, v32, -2, s55
 v_smfmac_f32_16x16x64_bf16 v[8:11], v[44:47], a[144:151], v0
 v_cvt_pk_bf16_f32 v34, v36, v37
 v_cvt_pk_bf16_f32 v35, v38, v39
 v_and_or_b32 v34, v34, -2, s55
 buffer_store_dwordx4 v[32:35], v1, s[4:7], s60 offen offset:1024
 s_nop 3
 v_cvt_pk_bf16_f32 v8, v8, v9
 v_cvt_pk_bf16_f32 v9, v10, v11
 v_and_or_b32 v8, v8, -2, s55
 buffer_store_dwordx2 v[8:9], v1, s[4:7], s16 offen offset:8
 buffer_load_dwordx4 v[32:35], v1, s[4:7], s63 offen offset:2048
 buffer_load_dwordx4 v[36:39], v1, s[4:7], s63 offen offset:3072
 s_add_u32 s54, s54, 1
 s_add_u32 s61, s61, 524288
 s_and_b32 s3, s54, 3
 s_cselect_b32 s3, 1, -3
 s_lshl_b32 s3, s3, 17
 s_add_u32 s62, s62, s3
 s_and_b32 s3, s54, 3
 s_cselect_b32 s3, 1, -3
 s_lshl_b32 s3, s3, 14
 s_add_u32 s57, s57, s3
 s_add_u32 s59, s59, s3
 s_xor_b32 s58, s57, 32768
 s_mov_b32 s51, 0
L_fl_212:
 s_waitcnt vmcnt(9)
 v_readlane_b32 s14, v7, 0
 v_readlane_b32 s15, v7, 1
 s_nop 3
 s_cmp_lt_u32 s14, 8
 s_cbranch_scc1 L_fr_213
 s_add_u32 s15, s15, 4
 s_cmp_le_u32 s15, s54
 s_cbranch_scc1 L_fr_213
 s_add_u32 s12, s12, 4
 s_nop 15
 s_nop 15
 s_nop 15
 s_nop 15
 s_nop 15
 s_nop 15
 s_nop 15
 s_nop 15
 s_nop 15
 s_nop 15
 s_nop 15
 s_nop 15
 s_nop 15
 s_nop 11
 s_xor_b32 s55, s55, 1
 s_waitcnt vmcnt(5)
 ds_read_b128 v[40:43], v1 offset:6144
 ds_read_b128 v[44:47], v1 offset:7168
 ds_read_b128 v[48:51], v1 offset:9216
 buffer_load_dwordx4 v[52:55], v1, s[4:7], s81 offen offset:3072
 buffer_load_dwordx4 v[56:59], v1, s[4:7], s101 offen offset:0
 buffer_load_dwordx4 v[60:63], v1, s[4:7], s101 offen offset:1024
 ds_read_b128 v[8:11], v3 offset:49152
 ds_read_b128 v[16:19], v3 offset:49152
 ds_read_b128 v[20:23], v3 offset:49152
 s_waitcnt lgkmcnt(0)
 s_nop 15
 s_nop 15
 s_nop 7
 s_branch L_ch3_f
L_rt_211:
 s_add_u32 s51, s51, 1
 s_cmp_lt_u32 s51, 131072
 s_cbranch_scc1 L_pm_210
 s_branch L_bail
L_fr_213:
 s_sleep 4
 v_mov_b32 v7, 0
 s_mov_b64 exec, 1
 buffer_atomic_add v7, off, s[4:7], s12 sc0
 s_mov_b64 exec, 2
 buffer_atomic_add v7, off, s[4:7], s13 sc0
 s_mov_b64 exec, -1
 s_waitcnt vmcnt(0)
 s_add_u32 s51, s51, 1
 s_cmp_lt_u32 s51, 131072
 s_cbranch_scc1 L_fl_212
 s_branch L_bail
.p2align 6
L_ch3_s:
 s_mov_b32 s51, 0
L_pm_214:
 buffer_load_dwordx4 v[24:27], v1, s[4:7], s59 offen offset:0 sc1
 buffer_load_dwordx4 v[28:31], v1, s[4:7], s59 offen offset:1024 sc1
 s_add_u32 s3, s59, 3072
 buffer_load_dwordx4 v[12:15], v1, s[4:7], s3 offen offset:0 sc1
 s_waitcnt vmcnt(2)
 ds_write_b128 v1, v[24:27] offset:6144
 v_max_u32 v7, v24, v26
 s_waitcnt vmcnt(1)
 ds_write_b128 v1, v[28:31] offset:7168
 v_max3_u32 v7, v7, v28, v30
 s_waitcnt vmcnt(0)
 ds_write_b128 v1, v[12:15] offset:9216
 v_max3_u32 v7, v7, v12, v14
 v_cmp_eq_u32 vcc, -1, v7
 s_cbranch_vccnz L_rt_215
 ds_read_b128 v[12:15], v3 offset:49152
 v_smfmac_f32_16x16x64_bf16 v[16:19], v[24:27], v[32:39], v0
 ds_read_b128 v[32:35], v1 offset:30720
 ds_read_b128 v[36:39], v1 offset:31744
 v_smfmac_f32_16x16x64_bf16 v[20:23], v[24:27], v[40:47], v0
 ds_read_b128 v[40:43], v1 offset:28672
 ds_read_b128 v[44:47], v1 offset:29696
 v_smfmac_f32_16x16x64_bf16 v[16:19], v[28:31], v[48:55], v0
 v_smfmac_f32_16x16x64_bf16 v[20:23], v[28:31], v[56:63], v0
 s_waitcnt lgkmcnt(5)
 s_barrier
 buffer_load_dwordx4 v[56:59], v1, s[4:7], s63 offen offset:0
 v_smfmac_f32_16x16x64_bf16 v[8:11], v[24:27], a[136:143], v0
 s_waitcnt lgkmcnt(4)
 v_smfmac_f32_16x16x64_bf16 v[12:15], v[24:27], a[128:135], v0
 ds_read_b128 v[24:27], v1 offset:9216
 buffer_load_dwordx4 v[60:63], v1, s[4:7], s63 offen offset:1024
 v_smfmac_f32_16x16x64_bf16 v[8:11], v[28:31], a[120:127], v0
 v_smfmac_f32_16x16x64_bf16 v[12:15], v[28:31], a[88:95], v0
 ds_read_b128 v[28:31], v1 offset:0
 buffer_load_dwordx4 v[48:51], v1, s[4:7], s101 offen offset:2048
 s_waitcnt lgkmcnt(1)
 v_smfmac_f32_16x16x64_bf16 v[16:19], v[24:27], v[32:39], v0
 ds_read_b128 v[32:35], v2 offset:30720
 ds_read_b128 v[36:39], v2 offset:31744
 v_smfmac_f32_16x16x64_bf16 v[8:11], v[24:27], a[32:39], v0
 buffer_load_dwordx4 v[52:55], v1, s[4:7], s101 offen offset:3072
 v_smfmac_f32_16x16x64_bf16 v[12:15], v[24:27], a[16:23], v0
 v_smfmac_f32_16x16x64_bf16 v[20:23], v[24:27], v[40:47], v0
 ds_read_b128 v[40:43], v2 offset:28672
 ds_read_b128 v[44:47], v2 offset:29696
 ds_read_b128 v[24:27], v1 offset:1024
 s_waitcnt lgkmcnt(5)
 v_smfmac_f32_16x16x64_bf16 v[8:11], v[28:31], v[240:247], v0
 v_smfmac_f32_16x16x64_bf16 v[12:15], v[28:31], v[248:255], v0
 s_waitcnt lgkmcnt(3)
 v_smfmac_f32_16x16x64_bf16 v[16:19], v[28:31], v[32:39], v0
 ds_read_b128 v[32:35], v2 offset:26624
 ds_read_b128 v[36:39], v2 offset:27648
 v_smfmac_f32_16x16x64_bf16 v[20:23], v[28:31], v[136:143], v0
 ds_read_b128 v[28:31], v1 offset:2048
 s_waitcnt lgkmcnt(3)
 v_smfmac_f32_16x16x64_bf16 v[8:11], v[24:27], v[232:239], v0
 v_smfmac_f32_16x16x64_bf16 v[16:19], v[24:27], v[40:47], v0
 ds_read_b128 v[40:43], v2 offset:24576
 ds_read_b128 v[44:47], v2 offset:25600
 v_smfmac_f32_16x16x64_bf16 v[12:15], v[24:27], v[224:231], v0
 v_smfmac_f32_16x16x64_bf16 v[20:23], v[24:27], v[152:159], v0
 ds_read_b128 v[24:27], v1 offset:3072
 s_waitcnt lgkmcnt(3)
 v_smfmac_f32_16x16x64_bf16 v[16:19], v[28:31], v[32:39], v0
 ds_read_b128 v[32:35], v1 offset:63488
 ds_read_b128 v[36:39], v1 offset:64512
 v_smfmac_f32_16x16x64_bf16 v[8:11], v[28:31], v[208:215], v0
 v_smfmac_f32_16x16x64_bf16 v[12:15], v[28:31], v[200:207], v0
 s_waitcnt lgkmcnt(3)
 v_smfmac_f32_16x16x64_bf16 v[20:23], v[28:31], v[40:47], v0
 ds_read_b128 v[40:43], v1 offset:61440
 ds_read_b128 v[44:47], v1 offset:62464
 ds_read_b128 v[28:31], v1 offset:4096
 s_waitcnt lgkmcnt(5)
 v_smfmac_f32_16x16x64_bf16 v[8:11], v[24:27], v[184:191], v0
 v_smfmac_f32_16x16x64_bf16 v[12:15], v[24:27], v[176:183], v0
 s_waitcnt lgkmcnt(3)
 v_smfmac_f32_16x16x64_bf16 v[16:19], v[24:27], v[32:39], v0
 ds_read_b128 v[32:35], v1 offset:59392
 ds_read_b128 v[36:39], v1 offset:60416
 s_waitcnt vmcnt(2)
 v_smfmac_f32_16x16x64_bf16 v[20:23], v[24:27], v[56:63], v0
 ds_read_b128 v[24:27], v1 offset:5120
 buffer_load_dwordx4 v[56:59], v1, s[4:7], s61 offen offset:3072 sc1 nt
 s_waitcnt lgkmcnt(3)
 v_smfmac_f32_16x16x64_bf16 v[8:11], v[28:31], v[168:175], v0
 v_smfmac_f32_16x16x64_bf16 v[16:19], v[28:31], v[40:47], v0
 ds_read_b128 v[40:43], v1 offset:57344
 ds_read_b128 v[44:47], v1 offset:58368
 s_add_u32 s3, s61, 4096
 buffer_load_dwordx4 v[60:63], v1, s[4:7], s3 offen offset:3072 sc1 nt
 v_smfmac_f32_16x16x64_bf16 v[12:15], v[28:31], v[160:167], v0
 v_smfmac_f32_16x16x64_bf16 v[20:23], v[28:31], v[192:199], v0
 ds_read_b128 v[28:31], v1 offset:8192
 s_waitcnt lgkmcnt(3)
 v_smfmac_f32_16x16x64_bf16 v[16:19], v[24:27], v[32:39], v0
 v_smfmac_f32_16x16x64_bf16 v[8:11], v[24:27], v[144:151], v0
 s_add_u32 s3, s61, 67115008
 buffer_load_dwordx4 v[32:35], v1, s[4:7], s3 offen offset:0 sc1 nt
 v_smfmac_f32_16x16x64_bf16 v[12:15], v[24:27], v[128:135], v0
 s_waitcnt lgkmcnt(1)
 v_smfmac_f32_16x16x64_bf16 v[20:23], v[24:27], v[40:47], v0
 ds_read_b128 v[40:43], v3 offset:49152
 ds_read_b128 v[44:47], v3 offset:49152
 buffer_load_dwordx4 v[36:39], v1, s[4:7], s3 offen offset:1024 sc1 nt
 s_waitcnt lgkmcnt(2)
 v_smfmac_f32_16x16x64_bf16 v[8:11], v[28:31], a[80:87], v0
 v_smfmac_f32_16x16x64_bf16 v[12:15], v[28:31], a[72:79], v0
 v_smfmac_f32_16x16x64_bf16 v[16:19], v[28:31], v[216:223], v0
 s_waitcnt vmcnt(4)
 v_smfmac_f32_16x16x64_bf16 v[20:23], v[28:31], v[48:55], v0
 ds_read_b128 v[52:55], v1 offset:0
 v_add_f32 v8, v8, v10
 v_add_f32 v11, v9, v11
 v_cvt_pk_bf16_f32 v9, v8, v11
 v_cvt_pk_bf16_f32 v8, v8, v11
 v_add_f32 v12, v12, v14
 v_add_f32 v15, v13, v15
 v_cvt_pk_bf16_f32 v13, v12, v15
 v_cvt_pk_bf16_f32 v12, v12, v15
 v_mfma_f32_16x16x16_bf16 v[8:11], v[8:9], v[4:5], 0
 v_mfma_f32_16x16x16_bf16 v[12:15], v[12:13], v[4:5], 0
 v_add_f32 v16, v16, v18
 v_add_f32 v19, v17, v19
 v_cvt_pk_bf16_f32 v17, v16, v19
 v_cvt_pk_bf16_f32 v16, v16, v19
 v_add_f32 v20, v20, v22
 v_add_f32 v23, v21, v23
 v_cvt_pk_bf16_f32 v21, v20, v23
 v_cvt_pk_bf16_f32 v20, v20, v23
 v_mfma_f32_16x16x16_bf16 v[16:19], v[16:17], v[4:5], 0
 v_mfma_f32_16x16x16_bf16 v[20:23], v[20:21], v[4:5], 0
 s_waitcnt lgkmcnt(2)
 v_smfmac_f32_16x16x64_bf16 v[40:43], v[24:27], a[240:247], v0
 s_waitcnt lgkmcnt(1)
 v_smfmac_f32_16x16x64_bf16 v[44:47], v[24:27], a[248:255], v0
 ds_read_b128 v[24:27], v1 offset:1024
 v_cvt_pk_bf16_f32 v15, v14, v15
 v_cvt_pk_bf16_f32 v14, v12, v13
 v_cvt_pk_bf16_f32 v13, v10, v11
 v_cvt_pk_bf16_f32 v12, v8, v9
 s_waitcnt vmcnt(3)
 s_nop 0
 v_mfma_f32_16x16x32_bf16 v[8:11], v[56:59], v[12:15], 0
 v_cvt_pk_bf16_f32 v23, v22, v23
 v_cvt_pk_bf16_f32 v22, v20, v21
 v_cvt_pk_bf16_f32 v21, v18, v19
 v_cvt_pk_bf16_f32 v20, v16, v17
 s_waitcnt vmcnt(2)
 v_mfma_f32_16x16x32_bf16 v[16:19], v[60:63], v[12:15], 0
 v_mfma_f32_16x16x32_bf16 v[48:51], v[20:23], v[12:15], 0
 v_smfmac_f32_16x16x64_bf16 v[40:43], v[28:31], v[96:103], v0
 v_smfmac_f32_16x16x64_bf16 v[44:47], v[28:31], v[104:111], v0
 ds_read_b128 v[28:31], v1 offset:2048
 s_waitcnt lgkmcnt(2)
 v_smfmac_f32_16x16x64_bf16 v[40:43], v[52:55], a[160:167], v0
 v_cndmask_b32 v8, v8, v16, s[70:71]
 v_cndmask_b32 v9, v9, v17, s[70:71]
 v_cndmask_b32 v10, v10, v18, s[70:71]
 v_cndmask_b32 v11, v11, v19, s[70:71]
 ds_write_b128 v1, v[8:11] offset:13312
 ds_write_b64 v1, v[48:49] offset:15368
 v_smfmac_f32_16x16x64_bf16 v[44:47], v[52:55], a[168:175], v0
 ds_read_b128 v[52:55], v1 offset:3072
 s_waitcnt lgkmcnt(4)
 v_smfmac_f32_16x16x64_bf16 v[40:43], v[24:27], a[176:183], v0
 v_smfmac_f32_16x16x64_bf16 v[44:47], v[24:27], a[184:191], v0
 ds_read_b128 v[24:27], v1 offset:4096
 s_waitcnt lgkmcnt(4)
 v_smfmac_f32_16x16x64_bf16 v[40:43], v[28:31], a[192:199], v0
 v_smfmac_f32_16x16x64_bf16 v[44:47], v[28:31], a[200:207], v0
 ds_read_b128 v[28:31], v1 offset:6144
 s_waitcnt lgkmcnt(2)
 v_smfmac_f32_16x16x64_bf16 v[40:43], v[52:55], a[208:215], v0
 v_smfmac_f32_16x16x64_bf16 v[44:47], v[52:55], a[216:223], v0
 ds_read_b128 v[52:55], v1 offset:7168
 s_barrier
 ds_read_b128 v[56:59], v1 offset:10240
 ds_read_b128 v[60:63], v1 offset:11264
 ds_read_b128 v[16:19], v1 offset:12288
 ds_read_b128 v[12:15], v1 offset:14336
 ds_read_b128 v[48:51], v1 offset:15360
 s_waitcnt lgkmcnt(7)
 v_smfmac_f32_16x16x64_bf16 v[40:43], v[24:27], a[224:231], v0
 s_mov_b64 exec, s[68:69]
 buffer_store_dwordx4 v[20:23], v6, s[4:7], s62 offen offset:1536 sc1
 s_mov_b64 exec, -1
 v_smfmac_f32_16x16x64_bf16 v[44:47], v[24:27], a[232:239], v0
 ds_read_b128 v[24:27], v1 offset:9216
 v_mov_b32 v7, 0
 s_waitcnt lgkmcnt(7)
 v_smfmac_f32_16x16x64_bf16 v[40:43], v[28:31], v[64:71], v0
 s_mov_b64 exec, 1
 buffer_atomic_add v7, off, s[4:7], s12 sc0
 s_mov_b64 exec, 2
 buffer_atomic_add v7, off, s[4:7], s13 sc0
 s_mov_b64 exec, -1
 v_smfmac_f32_16x16x64_bf16 v[44:47], v[28:31], v[72:79], v0
 s_waitcnt lgkmcnt(6)
 v_smfmac_f32_16x16x64_bf16 v[40:43], v[52:55], v[80:87], v0
 v_smfmac_f32_16x16x64_bf16 v[44:47], v[52:55], v[88:95], v0
 s_waitcnt lgkmcnt(0)
 v_smfmac_f32_16x16x64_bf16 v[40:43], v[24:27], v[112:119], v0
 v_smfmac_f32_16x16x64_bf16 v[44:47], v[24:27], v[120:127], v0
 v_pk_add_f32 v[8:9], v[8:9], v[56:57]
 v_pk_add_f32 v[10:11], v[10:11], v[58:59]
 v_pk_add_f32 v[60:61], v[60:61], v[16:17]
 v_pk_add_f32 v[62:63], v[62:63], v[18:19]
 v_pk_add_f32 v[12:13], v[12:13], v[14:15]
 v_pk_add_f32 v[48:49], v[48:49], v[50:51]
 v_pk_add_f32 v[8:9], v[8:9], v[60:61]
 v_pk_add_f32 v[10:11], v[10:11], v[62:63]
 v_pk_add_f32 v[48:49], v[12:13], v[48:49]
 v_max3_f32 v50, v8, v9, v10
 v_max3_f32 v50, v50, v11, v48
 v_max_f32 v50, v50, v49
 v_add_f32 v40, v40, v42
 v_add_f32 v41, v41, v43
 v_max_f32_dpp v50, v50, v50 quad_perm:[2,3,0,1] row_mask:0xf bank_mask:0xf
 v_mov_b32 v51, v50
 v_add_f32 v44, v44, v46
 v_add_f32 v45, v45, v47
 v_permlane16_swap_b32 v50, v51
 v_max_f32 v50, v50, v51
 v_mov_b32 v51, v50
 v_cvt_pk_bf16_f32 v40, v40, v41
 v_cvt_pk_bf16_f32 v41, v44, v45
 v_permlane32_swap_b32 v50, v51
 v_max_f32 v50, v50, v51
 v_mul_f32 v50, s56, v50
 v_fma_f32 v48, v48, s56, -v50
 v_fma_f32 v49, v49, s56, -v50
 v_fma_f32 v8, v8, s56, -v50
 v_fma_f32 v9, v9, s56, -v50
 v_fma_f32 v10, v10, s56, -v50
 v_fma_f32 v11, v11, s56, -v50
 v_exp_f32 v48, v48
 v_lshrrev_b32 v51, 1, v1
 v_exp_f32 v49, v49
 ds_read_b128 v[56:59], v3 offset:14336
 ds_read_b128 v[60:63], v3 offset:15360
 v_exp_f32 v8, v8
 v_exp_f32 v9, v9
 ds_read_b128 v[24:27], v3 offset:12288
 ds_read_b128 v[28:31], v3 offset:13312
 v_exp_f32 v10, v10
 buffer_store_dwordx2 v[40:41], v51, s[4:7], s62 offen offset:3584 sc1
 v_exp_f32 v11, v11
 v_cvt_pk_bf16_f32 v14, v48, v49
 v_cvt_pk_bf16_f32 v12, v8, v9
 v_cvt_pk_bf16_f32 v13, v10, v11
 v_cndmask_b32 v52, 0, v14, s[68:69]
 v_cndmask_b32 v53, 0, v14, s[70:71]
 v_cndmask_b32 v22, 0, v12, s[70:71]
 v_cndmask_b32 v23, 0, v13, s[70:71]
 v_mfma_f32_16x16x16_bf16 v[44:47], v[40:41], v[52:53], 0
 v_cndmask_b32 v16, 0, v12, s[68:69]
 v_cndmask_b32 v17, 0, v13, s[68:69]
 v_mov_b32_dpp v18, v22 quad_perm:[2,3,0,1] row_mask:0xf bank_mask:0xf
 v_mov_b32_dpp v19, v23 quad_perm:[2,3,0,1] row_mask:0xf bank_mask:0xf
 v_mov_b32_dpp v20, v16 quad_perm:[2,3,0,1] row_mask:0xf bank_mask:0xf
 v_mov_b32_dpp v21, v17 quad_perm:[2,3,0,1] row_mask:0xf bank_mask:0xf
 s_waitcnt vmcnt(5)
 v_mfma_f32_16x16x32_bf16 v[44:47], v[32:35], v[16:19], v[44:47]
 v_add_f32 v54, v8, v9
 v_add_f32 v55, v48, v49
 s_waitcnt vmcnt(4)
 v_mfma_f32_16x16x32_bf16 v[44:47], v[36:39], v[20:23], v[44:47]
 v_add_f32 v54, v54, v10
 v_fma_f32 v55, v55, 0.5, v11
 v_add_f32 v54, v54, v55
 ds_read_b128 v[16:19], v3 offset:49152
 ds_read_b128 v[20:23], v3 offset:49152
 v_add_f32_dpp v54, v54, v54 quad_perm:[2,3,0,1] row_mask:0xf bank_mask:0xf
 v_mov_b32 v55, v54
 ds_read_b128 v[32:35], v3 offset:49152
 ds_read_b128 v[36:39], v3 offset:49152
 v_permlane16_swap_b32 v54, v55
 v_add_f32 v54, v54, v55
 v_mov_b32 v55, v54
 ds_read_b128 v[8:11], v3 offset:49152
 s_cmp_eq_u32 s54, 63
 v_permlane32_swap_b32 v54, v55
 v_add_f32 v54, v54, v55
 v_rcp_f32 v54, v54
 s_cbranch_scc1 L_ch3_end
 v_mul_f32 v44, v44, v54
 v_mul_f32 v45, v45, v54
 v_cvt_pk_bf16_f32 v42, v44, v45
 v_mul_f32 v46, v46, v54
 v_mul_f32 v47, v47, v54
 v_cvt_pk_bf16_f32 v43, v46, v47
 ds_write_b64 v6, v[42:43] offset:1536
 v_and_b32 v40, -9, v6
 v_mov_b32_dpp v12, v42 quad_perm:[0,1,0,1] row_mask:0xf bank_mask:0xf
 v_mov_b32_dpp v14, v42 quad_perm:[2,3,2,3] row_mask:0xf bank_mask:0xf
 v_mov_b32_dpp v13, v43 quad_perm:[0,1,0,1] row_mask:0xf bank_mask:0xf
 v_mov_b32_dpp v15, v43 quad_perm:[2,3,2,3] row_mask:0xf bank_mask:0xf
 s_waitcnt lgkmcnt(5)
 s_nop 0
 v_smfmac_f32_16x16x64_bf16 v[16:19], v[12:15], a[24:31], v0
 s_waitcnt lgkmcnt(4)
 v_smfmac_f32_16x16x64_bf16 v[20:23], v[12:15], a[56:63], v0
 s_waitcnt lgkmcnt(0)
 s_barrier
 ds_read_b128 v[48:51], v40 offset:0
 ds_read_b128 v[52:55], v40 offset:512
 ds_read_b128 v[44:47], v40 offset:1024
 v_smfmac_f32_16x16x64_bf16 v[32:35], v[12:15], v[56:63], v0
 ds_read_b128 v[56:59], v3 offset:47104
 ds_read_b128 v[60:63], v3 offset:48128
 s_mov_b32 m0, 6144
 v_smfmac_f32_16x16x64_bf16 v[36:39], v[12:15], v[24:31], v0
 ds_read_b128 v[24:27], v3 offset:45056
 ds_read_b128 v[28:31], v3 offset:46080
 buffer_load_dwordx4 v1, s[4:7], s81 offen offset:0 lds
 v_smfmac_f32_16x16x64_bf16 v[8:11], v[12:15], a[152:159], v0
 s_mov_b32 m0, 6144
 s_waitcnt lgkmcnt(6)
 v_smfmac_f32_16x16x64_bf16 v[16:19], v[48:51], a[0:7], v0
 buffer_load_dwordx4 v1, s[4:7], s81 offen offset:1024 lds
 s_waitcnt lgkmcnt(5)
 v_smfmac_f32_16x16x64_bf16 v[16:19], v[52:55], a[8:15], v0
 s_mov_b32 m0, 7168
 s_waitcnt lgkmcnt(2)
 v_smfmac_f32_16x16x64_bf16 v[16:19], v[44:47], v[56:63], v0
 ds_read_b128 v[56:59], v3 offset:43008
 ds_read_b128 v[60:63], v3 offset:44032
 buffer_load_dwordx4 v1, s[4:7], s81 offen offset:2048 lds
 s_waitcnt lgkmcnt(2)
 v_smfmac_f32_16x16x64_bf16 v[20:23], v[48:51], v[24:31], v0
 ds_read_b128 v[24:27], v3 offset:40960
 ds_read_b128 v[28:31], v3 offset:41984
 v_smfmac_f32_16x16x64_bf16 v[20:23], v[52:55], a[40:47], v0
 v_smfmac_f32_16x16x64_bf16 v[20:23], v[44:47], a[48:55], v0
 v_cvt_pk_bf16_f32 v16, v16, v17
 v_smfmac_f32_16x16x64_bf16 v[32:35], v[48:51], a[64:71], v0
 v_cvt_pk_bf16_f32 v17, v18, v19
 s_waitcnt lgkmcnt(2)
 v_smfmac_f32_16x16x64_bf16 v[32:35], v[52:55], v[56:63], v0
 ds_read_b128 v[56:59], v3 offset:10240
 ds_read_b128 v[60:63], v3 offset:11264
 v_and_or_b32 v16, v16, -2, s55
 s_waitcnt lgkmcnt(2)
 v_smfmac_f32_16x16x64_bf16 v[32:35], v[44:47], v[24:31], v0
 ds_read_b128 v[24:27], v3 offset:8192
 ds_read_b128 v[28:31], v3 offset:9216
 v_cvt_pk_bf16_f32 v18, v20, v21
 v_smfmac_f32_16x16x64_bf16 v[36:39], v[48:51], a[96:103], v0
 v_cvt_pk_bf16_f32 v19, v22, v23
 v_smfmac_f32_16x16x64_bf16 v[36:39], v[52:55], a[104:111], v0
 v_and_or_b32 v18, v18, -2, s55
 buffer_store_dwordx4 v[16:19], v1, s[4:7], s60 offen offset:0 sc1
 v_smfmac_f32_16x16x64_bf16 v[36:39], v[44:47], a[112:119], v0
 v_cvt_pk_bf16_f32 v32, v32, v33
 s_waitcnt lgkmcnt(2)
 v_smfmac_f32_16x16x64_bf16 v[8:11], v[48:51], v[56:63], v0
 v_cvt_pk_bf16_f32 v33, v34, v35
 s_waitcnt lgkmcnt(0)
 v_smfmac_f32_16x16x64_bf16 v[8:11], v[52:55], v[24:31], v0
 v_and_or_b32 v32, v32, -2, s55
 v_smfmac_f32_16x16x64_bf16 v[8:11], v[44:47], a[144:151], v0
 v_cvt_pk_bf16_f32 v34, v36, v37
 v_cvt_pk_bf16_f32 v35, v38, v39
 v_and_or_b32 v34, v34, -2, s55
 buffer_store_dwordx4 v[32:35], v1, s[4:7], s60 offen offset:1024 sc1
 s_nop 3
 v_cvt_pk_bf16_f32 v8, v8, v9
 v_cvt_pk_bf16_f32 v9, v10, v11
 v_and_or_b32 v8, v8, -2, s55
 buffer_store_dwordx2 v[8:9], v1, s[4:7], s16 offen offset:8 sc1
 buffer_load_dwordx4 v[32:35], v1, s[4:7], s63 offen offset:2048
 buffer_load_dwordx4 v[36:39], v1, s[4:7], s63 offen offset:3072
 s_add_u32 s54, s54, 1
 s_add_u32 s61, s61, 524288
 s_and_b32 s3, s54, 3
 s_cselect_b32 s3, 1, -3
 s_lshl_b32 s3, s3, 17
 s_add_u32 s62, s62, s3
 s_and_b32 s3, s54, 3
 s_cselect_b32 s3, 1, -3
 s_lshl_b32 s3, s3, 14
 s_add_u32 s57, s57, s3
 s_add_u32 s59, s59, s3
 s_xor_b32 s58, s57, 32768
 s_mov_b32 s51, 0
L_fl_216:
 s_waitcnt vmcnt(9)
 v_readlane_b32 s14, v7, 0
 v_readlane_b32 s15, v7, 1
 s_nop 3
 s_cmp_lt_u32 s14, 8
 s_cbranch_scc1 L_fr_217
 s_add_u32 s15, s15, 4
 s_cmp_le_u32 s15, s54
 s_cbranch_scc1 L_fr_217
 s_add_u32 s12, s12, 4
 s_nop 15
 s_nop 15
 s_nop 15
 s_nop 15
 s_nop 15
 s_nop 15
 s_nop 15
 s_nop 15
 s_nop 15
 s_nop 15
 s_nop 15
 s_nop 15
 s_nop 15
 s_nop 11
 s_xor_b32 s55, s55, 1
 s_waitcnt vmcnt(5)
 ds_read_b128 v[40:43], v1 offset:6144
 ds_read_b128 v[44:47], v1 offset:7168
 ds_read_b128 v[48:51], v1 offset:9216
 buffer_load_dwordx4 v[52:55], v1, s[4:7], s81 offen offset:3072
 buffer_load_dwordx4 v[56:59], v1, s[4:7], s101 offen offset:0
 buffer_load_dwordx4 v[60:63], v1, s[4:7], s101 offen offset:1024
 ds_read_b128 v[8:11], v3 offset:49152
 ds_read_b128 v[16:19], v3 offset:49152
 ds_read_b128 v[20:23], v3 offset:49152
 s_waitcnt lgkmcnt(0)
 s_nop 15
 s_nop 15
 s_nop 7
 s_branch L_ch3_s
L_rt_215:
 s_add_u32 s51, s51, 1
 s_cmp_lt_u32 s51, 131072
 s_cbranch_scc1 L_pm_214
 s_branch L_bail
L_fr_217:
 s_sleep 4
 v_mov_b32 v7, 0
 s_mov_b64 exec, 1
 buffer_atomic_add v7, off, s[4:7], s12 sc0
 s_mov_b64 exec, 2
 buffer_atomic_add v7, off, s[4:7], s13 sc0
 s_mov_b64 exec, -1
 s_waitcnt vmcnt(0)
 s_add_u32 s51, s51, 1
 s_cmp_lt_u32 s51, 131072
 s_cbranch_scc1 L_fl_216
 s_branch L_bail
L_ch3_end:
 s_waitcnt vmcnt(0)
 s_endpgm
L_code_end:
 s_endpgm
.section .rodata,"a"
.p2align 6
.amdhsa_kernel interleave_layers__memory_aug_recurrent_mem_tr__ssm_conv_h3__prompt_kernel
  .amdhsa_next_free_vgpr 512
  .amdhsa_next_free_sgpr 102
  .amdhsa_accum_offset 256
  .amdhsa_group_segment_fixed_size 0
  .amdhsa_kernarg_size 128
  .amdhsa_user_sgpr_count 2
  .amdhsa_user_sgpr_kernarg_segment_ptr 1
  .amdhsa_system_sgpr_workgroup_id_x 1
  .amdhsa_float_denorm_mode_32 3
.end_amdhsa_kernel
.text
```
